```python
import torch

def _softmax(x, axis=-1):
    return torch.softmax(x, dim=axis)

def _gelu(x):
    return torch.nn.functional.gelu(x, approximate='tanh')

def _silu(x):
    return torch.nn.functional.silu(x)

def _sigmoid(x):
    return torch.sigmoid(x)

def _layernorm(x, axis=-1, eps=1e-05):
    m = x.mean(dim=axis, keepdim=True)
    v = x.var(dim=axis, keepdim=True, unbiased=False)
    return (x - m) / torch.sqrt(v + eps)

def _scatter_add(tgt, idx, src, axis=0):
    return tgt.clone().index_add_(axis, idx, src)

def _segment_sum(src, seg, n):
    out = torch.zeros((n,) + src.shape[1:], dtype=src.dtype)
    return out.index_add_(0, seg, src)

def _pad(x, pw):
    flat = tuple((v for pair in reversed(pw) for v in pair))
    return torch.nn.functional.pad(x, flat)
kernel_name = 'concat_heads__spectral_gfnet__memory_aug_recurrent_mem_tr__prompt'

def setup_inputs():

    _w = lambda a: (lambda t: t.to(torch.bfloat16) if t.is_floating_point() else t)(torch.as_tensor(a))

    def _A_setup():
        B, S, D = (1, 2048, 640)
        Df = D // 2 + 1
        return {'x': _w((lambda *s: torch.randn(*s, dtype=torch.bfloat16) * 0.05)(B, S, D)), 'w_r': _w((lambda *s: torch.randn(*s, dtype=torch.bfloat16) * 3.2)(S, Df) * 0.02), 'w_i': _w((lambda *s: torch.randn(*s, dtype=torch.bfloat16) * 3.2)(S, Df) * 0.02)}
    _A_in = _A_setup()

    def _B_setup():
        B, S, Dm = (1, 2048, 640)
        H, Dh = (32, 128)
        M, seg = (8, 32)
        seg = min(seg, S)
        S = S // seg * seg
        return {'x': _w((lambda *s: torch.randn(*s, dtype=torch.bfloat16) * 0.05)(B, S, Dm)), 'mem0': _w((lambda *s: torch.randn(*s, dtype=torch.bfloat16) * 0.4)(B, M, Dm)), 'Wq': _w((lambda *s: torch.randn(*s, dtype=torch.bfloat16) * 6.4)(Dm, H, Dh) * Dm ** (-0.5)), 'Wk': _w((lambda *s: torch.randn(*s, dtype=torch.bfloat16) * 6.4)(Dm, H, Dh) * Dm ** (-0.5)), 'Wv': _w((lambda *s: torch.randn(*s, dtype=torch.bfloat16) * 0.4)(Dm, H, Dh) * Dm ** (-0.5)), 'Wo': _w((lambda *s: torch.randn(*s, dtype=torch.bfloat16) * 0.4)(H, Dh, Dm) * (H * Dh) ** (-0.5)), 'seg_len': seg}
    _B_in = _B_setup()
    return {'A_x': _A_in['x'], 'A_w_r': _A_in['w_r'], 'A_w_i': _A_in['w_i'], 'B_x': _B_in['x'], 'B_mem0': _B_in['mem0'], 'B_Wq': _B_in['Wq'], 'B_Wk': _B_in['Wk'], 'B_Wv': _B_in['Wv'], 'B_Wo': _B_in['Wo'], 'B_seg_len': _B_in['seg_len']}

def reference(A_x, A_w_r, A_w_i, B_x, B_mem0, B_Wq, B_Wk, B_Wv, B_Wo, B_seg_len):

    def _A_ref(x, w_r, w_i):
        B, S, D = x.shape
        X = (lambda x, axes=(-2, -1): torch.fft.rfft2(x.float(), dim=axes))(x, axes=(-2, -1))
        W = w_r + 1j * w_i
        X = X * W
        y = (lambda x, s, axes=(-2, -1): torch.fft.irfft2(x, s=s, dim=axes).to(torch.bfloat16))(X, (S, D), axes=(-2, -1))
        return y

    def _B_ref(x, mem0, Wq, Wk, Wv, Wo, seg_len):
        B, S, Dm = x.shape
        H, Dh = (Wq.shape[1], Wq.shape[2])
        M = mem0.shape[1]
        scale = Dh ** (-0.5)
        n_seg = S // seg_len
        L = M + seg_len
        idx = torch.arange(L)
        mask = (idx[:, None] < M) | (idx[:, None] >= idx[None, :])
        mem = mem0
        outs = []
        for s in range(n_seg):
            xs = x[:, s * seg_len:(s + 1) * seg_len, :].clone()
            h = torch.concatenate([mem, xs], axis=1)
            q = torch.einsum('btd,dhe->bhte', h, Wq)
            k = torch.einsum('btd,dhe->bhte', h, Wk)
            v = torch.einsum('btd,dhe->bhte', h, Wv)
            scores = torch.einsum('bhqe,bhke->bhqk', q, k) * scale
            scores = torch.where(mask[None, None], scores, -1000000000.0)
            p = _softmax(scores, axis=-1)
            o = torch.einsum('bhqk,bhke->bhqe', p, v)
            o = torch.einsum('bhte,hed->btd', o, Wo)
            mem = o[:, :M, :].clone()
            outs.append(o[:, M:, :])
        return torch.concatenate(outs, axis=1)
    a = _A_ref(A_x, A_w_r, A_w_i)
    b = _B_ref(B_x, B_mem0, B_Wq, B_Wk, B_Wv, B_Wo, B_seg_len)
    return torch.concatenate([a, b], axis=-1)
```

```asm
; @launch kernel=main_kernel grid=(256,1,1) block=(256,1,1) lds=163840
.amdgcn_target "amdgcn-amd-amdhsa--gfx950"
.text
.globl main_kernel
.p2align 8
.type main_kernel,@function
main_kernel:
    s_cmp_ge_u32 s2, 256
    s_cbranch_scc1 Lend_1
    s_mov_b32 s97, 0
Lentry_3:
    s_waitcnt vmcnt(0) lgkmcnt(0)
    s_load_dwordx8 s[16:23], s[0:1], 32
    s_load_dwordx2 s[24:25], s[0:1], 64
    s_load_dwordx4 s[28:31], s[0:1], 88
    v_and_b32 v1, 63, v0
    v_lshrrev_b32 v5, 6, v0
    v_and_b32 v2, 15, v0
    v_readfirstlane_b32 s40, v5
    v_bfe_u32 v3, v0, 4, 2
    v_and_b32 v4, 7, v0
    s_waitcnt lgkmcnt(0)
    s_mov_b32 s4, s30
    s_and_b32 s5, s31, 0xffff
    s_mov_b32 s6, 0x10000000
    s_mov_b32 s7, 0x00020000
    s_mov_b32 s8, s16
    s_and_b32 s9, s17, 0xffff
    s_mov_b32 s10, 0x2800
    s_mov_b32 s11, 0x00020000
    s_mov_b32 s32, s28
    s_and_b32 s33, s29, 0xffff
    s_mov_b32 s34, 0x100
    s_mov_b32 s35, 0x00020000
    s_mov_b32 s12, s18
    s_and_b32 s13, s19, 0xffff
    s_mov_b32 s14, 0x500000
    s_mov_b32 s15, 0x00020000
    s_mov_b32 s43, s97
    s_cmp_lg_u32 s97, 0
    s_cbranch_scc1 Lhave_4
    s_getreg_b32 s98, hwreg(HW_REG_XCC_ID)
    s_and_b32 s98, s98, 7
    s_add_u32 s61, s4, 0x91fffff
    s_and_b32 s61, s61, 0xffe00000
    s_sub_u32 s61, s61, s4
    s_sub_u32 s61, s61, 0x9000000
    v_lshlrev_b32 v5, 4, v0
    s_add_u32 s60, s2, 0
    s_lshl_b32 s62, s60, 12
    s_add_u32 s63, s62, 0x8c00000
    s_mov_b32 s64, 0
    s_add_u32 s65, s62, 0x8dc8000
    s_cmp_ge_u32 s60, 56
    s_cselect_b32 s63, s65, s63
    s_cselect_b32 s64, -1, s64
    s_add_u32 s65, s62, 0x8e08000
    s_cmp_ge_u32 s60, 248
    s_cselect_b32 s63, s65, s63
    s_cselect_b32 s64, -1, s64
    s_add_u32 s65, s62, 0x8eb8000
    s_add_u32 s65, s65, s61
    s_cmp_ge_u32 s60, 328
    s_cselect_b32 s63, s65, s63
    s_cselect_b32 s64, -1, s64
    s_cmp_ge_u32 s60, 712
    s_cselect_b32 s63, 0x7ff00000, s63
    v_mov_b32 v64, s64
    v_mov_b32 v65, s64
    v_mov_b32 v66, s64
    v_mov_b32 v67, s64
    buffer_store_dwordx4 v[64:67], v5, s[4:7], s63 offen sc1
    s_add_u32 s60, s2, 256
    s_lshl_b32 s62, s60, 12
    s_add_u32 s63, s62, 0x8c00000
    s_mov_b32 s64, 0
    s_add_u32 s65, s62, 0x8dc8000
    s_cmp_ge_u32 s60, 56
    s_cselect_b32 s63, s65, s63
    s_cselect_b32 s64, -1, s64
    s_add_u32 s65, s62, 0x8e08000
    s_cmp_ge_u32 s60, 248
    s_cselect_b32 s63, s65, s63
    s_cselect_b32 s64, -1, s64
    s_add_u32 s65, s62, 0x8eb8000
    s_add_u32 s65, s65, s61
    s_cmp_ge_u32 s60, 328
    s_cselect_b32 s63, s65, s63
    s_cselect_b32 s64, -1, s64
    s_cmp_ge_u32 s60, 712
    s_cselect_b32 s63, 0x7ff00000, s63
    v_mov_b32 v68, s64
    v_mov_b32 v69, s64
    v_mov_b32 v70, s64
    v_mov_b32 v71, s64
    buffer_store_dwordx4 v[68:71], v5, s[4:7], s63 offen sc1
    s_add_u32 s60, s2, 512
    s_lshl_b32 s62, s60, 12
    s_add_u32 s63, s62, 0x8c00000
    s_mov_b32 s64, 0
    s_add_u32 s65, s62, 0x8dc8000
    s_cmp_ge_u32 s60, 56
    s_cselect_b32 s63, s65, s63
    s_cselect_b32 s64, -1, s64
    s_add_u32 s65, s62, 0x8e08000
    s_cmp_ge_u32 s60, 248
    s_cselect_b32 s63, s65, s63
    s_cselect_b32 s64, -1, s64
    s_add_u32 s65, s62, 0x8eb8000
    s_add_u32 s65, s65, s61
    s_cmp_ge_u32 s60, 328
    s_cselect_b32 s63, s65, s63
    s_cselect_b32 s64, -1, s64
    s_cmp_ge_u32 s60, 712
    s_cselect_b32 s63, 0x7ff00000, s63
    v_mov_b32 v72, s64
    v_mov_b32 v73, s64
    v_mov_b32 v74, s64
    v_mov_b32 v75, s64
    buffer_store_dwordx4 v[72:75], v5, s[4:7], s63 offen sc1
    s_cmp_lg_u32 s40, 0
    s_cbranch_scc1 Lel_5
    s_lshl_b32 s48, s98, 5
    s_add_u32 s48, s48, 16
    v_mov_b32 v5, s48
    v_mov_b32 v6, 1
    s_mov_b64 exec, 1
    buffer_atomic_add v6, v5, s[32:35], 0 offen sc0
    v_mov_b32 v5, 163824
    s_waitcnt vmcnt(0)
    ds_write_b32 v5, v6
    s_waitcnt lgkmcnt(0)
    s_mov_b64 exec, -1
Lel_5:
    s_waitcnt vmcnt(0)
    s_barrier
    v_mov_b32 v5, 163824
    ds_read_b32 v6, v5
    s_waitcnt lgkmcnt(0)
    v_readfirstlane_b32 s99, v6
    s_nop 3
    s_barrier
    s_cmp_lg_u32 s40, 0
    s_cbranch_scc1 Lid_6
    s_mov_b64 exec, 1
    s_lshl_b32 s48, s98, 5
    s_add_u32 s48, s48, 20
    v_mov_b32 v5, s48
    v_mov_b32 v6, 1
    buffer_atomic_add v6, v5, s[32:35], 0 offen
    s_mov_b64 exec, -1
Lid_6:
    s_cmp_lt_u32 s99, 32
    s_cbranch_scc1 Lsp_7
    s_cmp_lg_u32 s97, 0
    s_cbranch_scc1 Lcf_8
    s_cmp_lg_u32 s40, 0
    s_cbranch_scc1 Lcf0_9
    s_load_dwordx2 s[88:89], s[0:1], 88
    v_and_b32 v4, 7, v0
    v_lshlrev_b32 v4, 5, v4
    v_bfe_u32 v5, v0, 3, 1
    v_lshl_add_u32 v4, v5, 2, v4
    v_add_u32 v4, 16, v4
    s_mov_b64 exec, 0xffff
    s_mov_b32 s43, 0
    s_waitcnt lgkmcnt(0)
    s_and_b32 s89, s89, 0xffff
    s_mov_b32 s90, 256
    s_mov_b32 s91, 0x00020000
Lcfp_10:
    buffer_load_dword v5, v4, s[88:91], 0 offen sc1
    s_waitcnt vmcnt(0)
    v_readlane_b32 s60, v5, 0
    v_readlane_b32 s61, v5, 1
    v_readlane_b32 s62, v5, 2
    v_readlane_b32 s63, v5, 3
    v_readlane_b32 s64, v5, 4
    v_readlane_b32 s65, v5, 5
    v_readlane_b32 s66, v5, 6
    v_readlane_b32 s67, v5, 7
    v_readlane_b32 s48, v5, 8
    v_readlane_b32 s49, v5, 9
    s_nop 3
    s_add_u32 s48, s48, s49
    v_readlane_b32 s49, v5, 10
    s_nop 3
    s_add_u32 s48, s48, s49
    v_readlane_b32 s49, v5, 11
    s_nop 3
    s_add_u32 s48, s48, s49
    v_readlane_b32 s49, v5, 12
    s_nop 3
    s_add_u32 s48, s48, s49
    v_readlane_b32 s49, v5, 13
    s_nop 3
    s_add_u32 s48, s48, s49
    v_readlane_b32 s49, v5, 14
    s_nop 3
    s_add_u32 s48, s48, s49
    v_readlane_b32 s49, v5, 15
    s_nop 3
    s_add_u32 s48, s48, s49
    s_add_u32 s43, s43, 1
    s_cmp_gt_u32 s43, 400000
    s_cbranch_scc0 Lcfo_11
    s_endpgm
Lcfo_11:
    s_cmp_lt_u32 s48, 256
    s_cbranch_scc1 Lcfp_10
    s_min_u32 s48, s60, s61
    s_min_u32 s48, s48, s62
    s_min_u32 s48, s48, s63
    s_min_u32 s48, s48, s64
    s_min_u32 s48, s48, s65
    s_min_u32 s48, s48, s66
    s_min_u32 s48, s48, s67
    s_mov_b32 s49, s99
    s_cmp_gt_u32 s98, 0
    s_cselect_b32 s43, s60, 0
    s_add_u32 s49, s49, s43
    s_cmp_gt_u32 s98, 1
    s_cselect_b32 s43, s61, 0
    s_add_u32 s49, s49, s43
    s_cmp_gt_u32 s98, 2
    s_cselect_b32 s43, s62, 0
    s_add_u32 s49, s49, s43
    s_cmp_gt_u32 s98, 3
    s_cselect_b32 s43, s63, 0
    s_add_u32 s49, s49, s43
    s_cmp_gt_u32 s98, 4
    s_cselect_b32 s43, s64, 0
    s_add_u32 s49, s49, s43
    s_cmp_gt_u32 s98, 5
    s_cselect_b32 s43, s65, 0
    s_add_u32 s49, s49, s43
    s_cmp_gt_u32 s98, 6
    s_cselect_b32 s43, s66, 0
    s_add_u32 s49, s49, s43
    s_or_b32 s49, s49, 0x300
    s_lshl_b32 s43, s98, 5
    s_add_u32 s43, s43, s99
    s_or_b32 s43, s43, 0x200
    s_cmp_ge_u32 s48, 32
    s_cselect_b32 s43, s43, s49
    s_mov_b64 exec, 1
    v_mov_b32 v4, 163824
    v_mov_b32 v5, s43
    ds_write_b32 v4, v5
    s_waitcnt lgkmcnt(0)
    s_mov_b64 exec, -1
Lcf0_9:
    s_barrier
    v_mov_b32 v4, 163824
    ds_read_b32 v5, v4
    s_waitcnt lgkmcnt(0)
    v_readfirstlane_b32 s97, v5
    s_nop 3
    s_barrier
    s_branch Lentry_3
Lcf_8:
Lsp_7:
    s_lshl_b32 s43, s98, 5
    s_add_u32 s43, s43, s99
Lhave_4:
    s_bfe_u32 s42, s43, 0x10008
    s_and_b32 s43, s43, 255
    s_cmp_ge_u32 s43, 128
    s_cbranch_scc0 Lrrole_13
    s_branch Lwrole_12
Lrrole_13:
    s_lshr_b32 s38, s43, 4
    s_and_b32 s39, s43, 15
    s_lshl_b32 s71, s43, 8
    s_add_u32 s71, s71, 0x8d00000
    s_mov_b32 s54, -1
    s_mov_b32 s55, 0
    s_mov_b32 s58, 0x3e0293ee
    v_mov_b32 v37, 0xff800000
    v_mov_b32 v44, 0x3f803f80
    v_mov_b32 v48, -1
    v_mov_b32 v45, 0x3f803f80
    v_mov_b32 v49, -1
    v_mov_b32 v46, 0x3f803f80
    v_mov_b32 v50, -1
    v_mov_b32 v47, 0x3f803f80
    v_mov_b32 v51, -1
    s_lshr_b32 s48, s39, 2
    s_lshl_b32 s50, s38, 2
    s_add_u32 s50, s50, s48
    s_and_b32 s48, s39, 3
    s_lshl_b32 s49, s50, 8
    s_lshl_b32 s43, s48, 6
    s_add_u32 s49, s49, s43
    s_mul_i32 s43, s40, 1310720
    s_add_u32 s49, s49, s43
    v_lshrrev_b32 v5, 2, v1
    v_lshlrev_b32 v5, 13, v5
    v_and_b32 v6, 3, v1
    v_lshl_add_u32 v5, v6, 4, v5
    v_add_u32 v5, s49, v5
    s_mov_b32 s43, 0
    buffer_load_dwordx4 v[64:67], v5, s[12:15], s43 offen
    s_mov_b32 s43, 131072
    buffer_load_dwordx4 v[68:71], v5, s[12:15], s43 offen
    s_mov_b32 s43, 262144
    buffer_load_dwordx4 v[72:75], v5, s[12:15], s43 offen
    s_mov_b32 s43, 393216
    buffer_load_dwordx4 v[76:79], v5, s[12:15], s43 offen
    s_mov_b32 s43, 524288
    buffer_load_dwordx4 v[80:83], v5, s[12:15], s43 offen
    s_mov_b32 s43, 655360
    buffer_load_dwordx4 v[84:87], v5, s[12:15], s43 offen
    s_mov_b32 s43, 786432
    buffer_load_dwordx4 v[88:91], v5, s[12:15], s43 offen
    s_mov_b32 s43, 917504
    buffer_load_dwordx4 v[92:95], v5, s[12:15], s43 offen
    s_mov_b32 s43, 1048576
    buffer_load_dwordx4 v[96:99], v5, s[12:15], s43 offen
    s_mov_b32 s43, 1179648
    buffer_load_dwordx4 v[100:103], v5, s[12:15], s43 offen
    s_mov_b32 s12, s20
    s_and_b32 s13, s21, 0xffff
    s_mov_b32 s14, 0x500000
    s_mov_b32 s15, 0x00020000
    s_mov_b32 s43, 0
    buffer_load_dwordx4 v[104:107], v5, s[12:15], s43 offen
    s_mov_b32 s43, 131072
    buffer_load_dwordx4 v[108:111], v5, s[12:15], s43 offen
    s_mov_b32 s43, 262144
    buffer_load_dwordx4 v[112:115], v5, s[12:15], s43 offen
    s_mov_b32 s43, 393216
    buffer_load_dwordx4 v[116:119], v5, s[12:15], s43 offen
    s_mov_b32 s43, 524288
    buffer_load_dwordx4 v[120:123], v5, s[12:15], s43 offen
    s_mov_b32 s43, 655360
    buffer_load_dwordx4 v[124:127], v5, s[12:15], s43 offen
    s_mov_b32 s43, 786432
    buffer_load_dwordx4 v[128:131], v5, s[12:15], s43 offen
    s_mov_b32 s43, 917504
    buffer_load_dwordx4 v[132:135], v5, s[12:15], s43 offen
    s_mov_b32 s43, 1048576
    buffer_load_dwordx4 v[136:139], v5, s[12:15], s43 offen
    s_mov_b32 s43, 1179648
    buffer_load_dwordx4 v[140:143], v5, s[12:15], s43 offen
    s_mov_b32 s12, s22
    s_and_b32 s13, s23, 0xffff
    s_mov_b32 s14, 0x500000
    s_mov_b32 s15, 0x00020000
    s_mov_b32 s43, 0
    buffer_load_dwordx4 v[144:147], v5, s[12:15], s43 offen
    s_mov_b32 s43, 131072
    buffer_load_dwordx4 v[148:151], v5, s[12:15], s43 offen
    s_mov_b32 s43, 262144
    buffer_load_dwordx4 v[152:155], v5, s[12:15], s43 offen
    s_mov_b32 s43, 393216
    buffer_load_dwordx4 v[156:159], v5, s[12:15], s43 offen
    s_mov_b32 s43, 524288
    buffer_load_dwordx4 v[160:163], v5, s[12:15], s43 offen
    s_mov_b32 s43, 655360
    buffer_load_dwordx4 v[164:167], v5, s[12:15], s43 offen
    s_mov_b32 s43, 786432
    buffer_load_dwordx4 v[168:171], v5, s[12:15], s43 offen
    s_mov_b32 s43, 917504
    buffer_load_dwordx4 v[172:175], v5, s[12:15], s43 offen
    s_mov_b32 s43, 1048576
    buffer_load_dwordx4 v[176:179], v5, s[12:15], s43 offen
    s_mov_b32 s43, 1179648
    buffer_load_dwordx4 v[180:183], v5, s[12:15], s43 offen
    s_mov_b32 s12, s24
    s_and_b32 s13, s25, 0xffff
    s_mov_b32 s14, 0x500000
    s_mov_b32 s15, 0x00020000
    s_lshl_b32 s49, s38, 2
    s_add_u32 s49, s49, s40
    s_mul_i32 s49, s49, 163840
    s_mul_i32 s43, s39, 80
    s_add_u32 s49, s49, s43
    v_lshrrev_b32 v6, 3, v1
    v_mul_u32_u24 v6, 1280, v6
    v_and_b32 v7, 7, v1
    v_lshl_add_u32 v6, v7, 4, v6
    v_add_u32 v6, s49, v6
    s_mov_b32 s43, 0
    buffer_load_dwordx4 v[184:187], v6, s[12:15], s43 offen
    s_mov_b32 s43, 10240
    buffer_load_dwordx4 v[188:191], v6, s[12:15], s43 offen
    s_mov_b32 s43, 20480
    buffer_load_dwordx4 v[192:195], v6, s[12:15], s43 offen
    s_mov_b32 s43, 30720
    buffer_load_dwordx4 v[196:199], v6, s[12:15], s43 offen
    s_mov_b32 s43, 40960
    buffer_load_dwordx4 v[200:203], v6, s[12:15], s43 offen
    s_mov_b32 s43, 51200
    buffer_load_dwordx4 v[204:207], v6, s[12:15], s43 offen
    s_mov_b32 s43, 61440
    buffer_load_dwordx4 v[208:211], v6, s[12:15], s43 offen
    s_mov_b32 s43, 71680
    buffer_load_dwordx4 v[212:215], v6, s[12:15], s43 offen
    s_mov_b32 s43, 81920
    buffer_load_dwordx4 v[216:219], v6, s[12:15], s43 offen
    s_mov_b32 s43, 92160
    buffer_load_dwordx4 v[220:223], v6, s[12:15], s43 offen
    s_mov_b32 s43, 102400
    buffer_load_dwordx4 v[224:227], v6, s[12:15], s43 offen
    s_mov_b32 s43, 112640
    buffer_load_dwordx4 v[228:231], v6, s[12:15], s43 offen
    s_mov_b32 s43, 122880
    buffer_load_dwordx4 v[232:235], v6, s[12:15], s43 offen
    s_mov_b32 s43, 133120
    buffer_load_dwordx4 v[236:239], v6, s[12:15], s43 offen
    s_mov_b32 s43, 143360
    buffer_load_dwordx4 v[240:243], v6, s[12:15], s43 offen
    s_mov_b32 s43, 153600
    buffer_load_dwordx4 v[244:247], v6, s[12:15], s43 offen
    s_lshl_b32 s49, s40, 14
    v_lshlrev_b32 v5, 4, v1
    v_add_u32 v5, s49, v5
    v_lshrrev_b32 v6, 2, v2
    v_lshl_add_u32 v7, v3, 3, v6
    v_lshlrev_b32 v7, 6, v7
    v_and_b32 v8, 3, v2
    v_lshl_add_u32 v7, v8, 3, v7
    v_add_u32 v7, s49, v7
    s_waitcnt vmcnt(36)
    ds_write_b128 v5, v[64:67] offset:0
    ds_write_b128 v5, v[68:71] offset:1024
    ds_write_b128 v5, v[72:75] offset:2048
    ds_write_b128 v5, v[76:79] offset:3072
    ds_write_b128 v5, v[80:83] offset:4096
    ds_write_b128 v5, v[84:87] offset:5120
    ds_write_b128 v5, v[88:91] offset:6144
    ds_write_b128 v5, v[92:95] offset:7168
    ds_write_b128 v5, v[96:99] offset:8192
    ds_write_b128 v5, v[100:103] offset:9216
    ds_read_b64_tr_b16 a[0:1], v7 offset:0
    ds_read_b64_tr_b16 a[2:3], v7 offset:256
    ds_read_b64_tr_b16 a[4:5], v7 offset:2048
    ds_read_b64_tr_b16 a[6:7], v7 offset:2304
    ds_read_b64_tr_b16 a[8:9], v7 offset:4096
    ds_read_b64_tr_b16 a[10:11], v7 offset:4352
    ds_read_b64_tr_b16 a[12:13], v7 offset:6144
    ds_read_b64_tr_b16 a[14:15], v7 offset:6400
    ds_read_b64_tr_b16 a[16:17], v7 offset:8192
    ds_read_b64_tr_b16 a[18:19], v7 offset:8448
    s_waitcnt lgkmcnt(0)
    ds_read_b64_tr_b16 a[20:21], v7 offset:32
    ds_read_b64_tr_b16 a[22:23], v7 offset:288
    ds_read_b64_tr_b16 a[24:25], v7 offset:2080
    ds_read_b64_tr_b16 a[26:27], v7 offset:2336
    ds_read_b64_tr_b16 a[28:29], v7 offset:4128
    ds_read_b64_tr_b16 a[30:31], v7 offset:4384
    ds_read_b64_tr_b16 a[32:33], v7 offset:6176
    ds_read_b64_tr_b16 a[34:35], v7 offset:6432
    ds_read_b64_tr_b16 a[36:37], v7 offset:8224
    ds_read_b64_tr_b16 a[38:39], v7 offset:8480
    s_waitcnt lgkmcnt(0)
    s_waitcnt vmcnt(26)
    ds_write_b128 v5, v[104:107] offset:0
    ds_write_b128 v5, v[108:111] offset:1024
    ds_write_b128 v5, v[112:115] offset:2048
    ds_write_b128 v5, v[116:119] offset:3072
    ds_write_b128 v5, v[120:123] offset:4096
    ds_write_b128 v5, v[124:127] offset:5120
    ds_write_b128 v5, v[128:131] offset:6144
    ds_write_b128 v5, v[132:135] offset:7168
    ds_write_b128 v5, v[136:139] offset:8192
    ds_write_b128 v5, v[140:143] offset:9216
    ds_read_b64_tr_b16 a[40:41], v7 offset:0
    ds_read_b64_tr_b16 a[42:43], v7 offset:256
    ds_read_b64_tr_b16 a[44:45], v7 offset:2048
    ds_read_b64_tr_b16 a[46:47], v7 offset:2304
    ds_read_b64_tr_b16 a[48:49], v7 offset:4096
    ds_read_b64_tr_b16 a[50:51], v7 offset:4352
    ds_read_b64_tr_b16 a[52:53], v7 offset:6144
    ds_read_b64_tr_b16 a[54:55], v7 offset:6400
    ds_read_b64_tr_b16 a[56:57], v7 offset:8192
    ds_read_b64_tr_b16 a[58:59], v7 offset:8448
    s_waitcnt lgkmcnt(0)
    ds_read_b64_tr_b16 a[60:61], v7 offset:32
    ds_read_b64_tr_b16 a[62:63], v7 offset:288
    ds_read_b64_tr_b16 a[64:65], v7 offset:2080
    ds_read_b64_tr_b16 a[66:67], v7 offset:2336
    ds_read_b64_tr_b16 a[68:69], v7 offset:4128
    ds_read_b64_tr_b16 a[70:71], v7 offset:4384
    ds_read_b64_tr_b16 a[72:73], v7 offset:6176
    ds_read_b64_tr_b16 a[74:75], v7 offset:6432
    ds_read_b64_tr_b16 a[76:77], v7 offset:8224
    ds_read_b64_tr_b16 a[78:79], v7 offset:8480
    s_waitcnt lgkmcnt(0)
    s_waitcnt vmcnt(16)
    ds_write_b128 v5, v[144:147] offset:0
    ds_write_b128 v5, v[148:151] offset:1024
    ds_write_b128 v5, v[152:155] offset:2048
    ds_write_b128 v5, v[156:159] offset:3072
    ds_write_b128 v5, v[160:163] offset:4096
    ds_write_b128 v5, v[164:167] offset:5120
    ds_write_b128 v5, v[168:171] offset:6144
    ds_write_b128 v5, v[172:175] offset:7168
    ds_write_b128 v5, v[176:179] offset:8192
    ds_write_b128 v5, v[180:183] offset:9216
    ds_read_b64_tr_b16 a[80:81], v7 offset:0
    ds_read_b64_tr_b16 a[82:83], v7 offset:256
    ds_read_b64_tr_b16 a[84:85], v7 offset:2048
    ds_read_b64_tr_b16 a[86:87], v7 offset:2304
    ds_read_b64_tr_b16 a[88:89], v7 offset:4096
    ds_read_b64_tr_b16 a[90:91], v7 offset:4352
    ds_read_b64_tr_b16 a[92:93], v7 offset:6144
    ds_read_b64_tr_b16 a[94:95], v7 offset:6400
    ds_read_b64_tr_b16 a[96:97], v7 offset:8192
    ds_read_b64_tr_b16 a[98:99], v7 offset:8448
    s_waitcnt lgkmcnt(0)
    ds_read_b64_tr_b16 a[100:101], v7 offset:32
    ds_read_b64_tr_b16 a[102:103], v7 offset:288
    ds_read_b64_tr_b16 a[104:105], v7 offset:2080
    ds_read_b64_tr_b16 a[106:107], v7 offset:2336
    ds_read_b64_tr_b16 a[108:109], v7 offset:4128
    ds_read_b64_tr_b16 a[110:111], v7 offset:4384
    ds_read_b64_tr_b16 a[112:113], v7 offset:6176
    ds_read_b64_tr_b16 a[114:115], v7 offset:6432
    ds_read_b64_tr_b16 a[116:117], v7 offset:8224
    ds_read_b64_tr_b16 a[118:119], v7 offset:8480
    s_waitcnt lgkmcnt(0)
    v_lshl_add_u32 v7, v3, 2, v6
    v_lshlrev_b32 v7, 7, v7
    v_lshl_add_u32 v7, v8, 3, v7
    v_add_u32 v7, s49, v7
    s_waitcnt vmcnt(0)
    ds_write_b128 v5, v[184:187] offset:0
    ds_write_b128 v5, v[188:191] offset:1024
    ds_write_b128 v5, v[192:195] offset:2048
    ds_write_b128 v5, v[196:199] offset:3072
    ds_write_b128 v5, v[200:203] offset:4096
    ds_write_b128 v5, v[204:207] offset:5120
    ds_write_b128 v5, v[208:211] offset:6144
    ds_write_b128 v5, v[212:215] offset:7168
    s_waitcnt lgkmcnt(0)
    ds_write_b128 v5, v[216:219] offset:8192
    ds_write_b128 v5, v[220:223] offset:9216
    ds_write_b128 v5, v[224:227] offset:10240
    ds_write_b128 v5, v[228:231] offset:11264
    ds_write_b128 v5, v[232:235] offset:12288
    ds_write_b128 v5, v[236:239] offset:13312
    ds_write_b128 v5, v[240:243] offset:14336
    ds_write_b128 v5, v[244:247] offset:15360
    s_waitcnt lgkmcnt(0)
    ds_read_b64_tr_b16 a[120:121], v7 offset:0
    ds_read_b64_tr_b16 a[122:123], v7 offset:2048
    ds_read_b64_tr_b16 a[124:125], v7 offset:4096
    ds_read_b64_tr_b16 a[126:127], v7 offset:6144
    ds_read_b64_tr_b16 a[128:129], v7 offset:8192
    ds_read_b64_tr_b16 a[130:131], v7 offset:10240
    ds_read_b64_tr_b16 a[132:133], v7 offset:12288
    ds_read_b64_tr_b16 a[134:135], v7 offset:14336
    s_waitcnt lgkmcnt(0)
    ds_read_b64_tr_b16 a[136:137], v7 offset:32
    ds_read_b64_tr_b16 a[138:139], v7 offset:2080
    ds_read_b64_tr_b16 a[140:141], v7 offset:4128
    ds_read_b64_tr_b16 a[142:143], v7 offset:6176
    ds_read_b64_tr_b16 a[144:145], v7 offset:8224
    ds_read_b64_tr_b16 a[146:147], v7 offset:10272
    ds_read_b64_tr_b16 a[148:149], v7 offset:12320
    ds_read_b64_tr_b16 a[150:151], v7 offset:14368
    s_waitcnt lgkmcnt(0)
    ds_read_b64_tr_b16 a[152:153], v7 offset:64
    ds_read_b64_tr_b16 a[154:155], v7 offset:2112
    ds_read_b64_tr_b16 a[156:157], v7 offset:4160
    ds_read_b64_tr_b16 a[158:159], v7 offset:6208
    ds_read_b64_tr_b16 a[160:161], v7 offset:8256
    ds_read_b64_tr_b16 a[162:163], v7 offset:10304
    ds_read_b64_tr_b16 a[164:165], v7 offset:12352
    ds_read_b64_tr_b16 a[166:167], v7 offset:14400
    s_waitcnt lgkmcnt(0)
    s_cmp_lg_u32 s97, 0
    s_cbranch_scc1 Lcf_14
    s_cmp_lg_u32 s40, 0
    s_cbranch_scc1 Lcf0_15
    s_load_dwordx2 s[88:89], s[0:1], 88
    v_and_b32 v4, 7, v0
    v_lshlrev_b32 v4, 5, v4
    v_bfe_u32 v5, v0, 3, 1
    v_lshl_add_u32 v4, v5, 2, v4
    v_add_u32 v4, 16, v4
    s_mov_b64 exec, 0xffff
    s_mov_b32 s43, 0
    s_waitcnt lgkmcnt(0)
    s_and_b32 s89, s89, 0xffff
    s_mov_b32 s90, 256
    s_mov_b32 s91, 0x00020000
Lcfp_16:
    buffer_load_dword v5, v4, s[88:91], 0 offen sc1
    s_waitcnt vmcnt(0)
    v_readlane_b32 s60, v5, 0
    v_readlane_b32 s61, v5, 1
    v_readlane_b32 s62, v5, 2
    v_readlane_b32 s63, v5, 3
    v_readlane_b32 s64, v5, 4
    v_readlane_b32 s65, v5, 5
    v_readlane_b32 s66, v5, 6
    v_readlane_b32 s67, v5, 7
    v_readlane_b32 s48, v5, 8
    v_readlane_b32 s49, v5, 9
    s_nop 3
    s_add_u32 s48, s48, s49
    v_readlane_b32 s49, v5, 10
    s_nop 3
    s_add_u32 s48, s48, s49
    v_readlane_b32 s49, v5, 11
    s_nop 3
    s_add_u32 s48, s48, s49
    v_readlane_b32 s49, v5, 12
    s_nop 3
    s_add_u32 s48, s48, s49
    v_readlane_b32 s49, v5, 13
    s_nop 3
    s_add_u32 s48, s48, s49
    v_readlane_b32 s49, v5, 14
    s_nop 3
    s_add_u32 s48, s48, s49
    v_readlane_b32 s49, v5, 15
    s_nop 3
    s_add_u32 s48, s48, s49
    s_add_u32 s43, s43, 1
    s_cmp_gt_u32 s43, 400000
    s_cbranch_scc0 Lcfo_17
    s_endpgm
Lcfo_17:
    s_cmp_lt_u32 s48, 256
    s_cbranch_scc1 Lcfp_16
    s_min_u32 s48, s60, s61
    s_min_u32 s48, s48, s62
    s_min_u32 s48, s48, s63
    s_min_u32 s48, s48, s64
    s_min_u32 s48, s48, s65
    s_min_u32 s48, s48, s66
    s_min_u32 s48, s48, s67
    s_mov_b32 s49, s99
    s_cmp_gt_u32 s98, 0
    s_cselect_b32 s43, s60, 0
    s_add_u32 s49, s49, s43
    s_cmp_gt_u32 s98, 1
    s_cselect_b32 s43, s61, 0
    s_add_u32 s49, s49, s43
    s_cmp_gt_u32 s98, 2
    s_cselect_b32 s43, s62, 0
    s_add_u32 s49, s49, s43
    s_cmp_gt_u32 s98, 3
    s_cselect_b32 s43, s63, 0
    s_add_u32 s49, s49, s43
    s_cmp_gt_u32 s98, 4
    s_cselect_b32 s43, s64, 0
    s_add_u32 s49, s49, s43
    s_cmp_gt_u32 s98, 5
    s_cselect_b32 s43, s65, 0
    s_add_u32 s49, s49, s43
    s_cmp_gt_u32 s98, 6
    s_cselect_b32 s43, s66, 0
    s_add_u32 s49, s49, s43
    s_or_b32 s49, s49, 0x300
    s_lshl_b32 s43, s98, 5
    s_add_u32 s43, s43, s99
    s_or_b32 s43, s43, 0x200
    s_cmp_ge_u32 s48, 32
    s_cselect_b32 s43, s43, s49
    s_mov_b64 exec, 1
    v_mov_b32 v4, 163824
    v_mov_b32 v5, s43
    ds_write_b32 v4, v5
    s_waitcnt lgkmcnt(0)
    s_mov_b64 exec, -1
Lcf0_15:
    s_barrier
    v_mov_b32 v4, 163824
    ds_read_b32 v5, v4
    s_waitcnt lgkmcnt(0)
    v_readfirstlane_b32 s97, v5
    s_nop 3
    s_barrier
    s_bitcmp1_b32 s97, 8
    s_cbranch_scc0 Lcf_14
    s_branch Lentry_3
Lcf_14:
    v_and_b32 v4, 7, v0
    s_load_dwordx4 s[24:27], s[0:1], 8
    s_lshl_b32 s59, s38, 4
    s_add_u32 s59, s59, s39
    s_waitcnt lgkmcnt(0)
    s_cmp_lg_u32 s59, 0
    s_cbranch_scc1 Lcy_20
    s_branch Lcx_19
Lcy_20:
    s_sub_u32 s59, s59, 1
    s_mov_b32 s8, s24
    s_and_b32 s9, s25, 0xffff
    s_mov_b32 s10, 0x141000
    s_mov_b32 s11, 0x00020000
    s_mov_b32 s12, s26
    s_and_b32 s13, s27, 0xffff
    s_mov_b32 s14, 0x141000
    s_mov_b32 s15, 0x00020000
    v_and_b32 v1, 63, v0
    s_add_u32 s3, s59, 0
    s_lshl_b32 s3, s3, 2
    s_add_u32 s3, s3, s40
    s_and_b32 s16, s3, 511
    s_lshr_b32 s17, s3, 9
    s_lshl_b32 s17, s17, 6
    v_add_u32 v2, s17, v1
    v_mov_b32 v3, s16
    s_sub_u32 s17, s3, 2560
    s_lshl_b32 s17, s17, 6
    v_add_u32 v5, s17, v1
    s_cmp_ge_u32 s3, 2560
    s_cselect_b64 vcc, -1, 0
    v_mov_b32 v6, 320
    v_cndmask_b32 v2, v2, v6, vcc
    v_cndmask_b32 v3, v3, v5, vcc
    v_and_b32 v5, 15, v3
    v_bfe_u32 v6, v3, 4, 4
    v_lshl_add_u32 v5, v6, 7, v5
    v_mul_u32_u24 v5, 642, v5
    v_lshl_add_u32 v5, v2, 1, v5
    v_lshlrev_b32 v7, 13, v2
    v_lshl_add_u32 v72, v3, 4, v7
    s_cmp_ge_u32 s3, 2568
    s_cselect_b32 s17, 0x7ff00000, 0
    v_or_b32 v72, s17, v72
    v_or_b32 v5, s17, v5
    v_lshrrev_b32 v6, 8, v3
    v_cmp_eq_u32 vcc, 0, v6
    v_mov_b32 v6, 0x7ff00000
    s_nop 0
    v_cndmask_b32 v7, v6, v5, vcc
    v_cndmask_b32 v5, v5, v6, vcc
    s_mov_b64 s[16:17], exec
    s_and_b64 exec, s[16:17], vcc
    s_cbranch_execz Lwts_21
    s_mov_b32 s18, 0
    buffer_load_ushort v64, v7, s[8:11], s18 offen
    s_mov_b32 s18, 20544
    buffer_load_ushort v65, v7, s[8:11], s18 offen
    s_mov_b32 s18, 41088
    buffer_load_ushort v66, v7, s[8:11], s18 offen
    s_mov_b32 s18, 61632
    buffer_load_ushort v67, v7, s[8:11], s18 offen
    s_mov_b32 s18, 10272
    buffer_load_ushort v68, v7, s[8:11], s18 offen
    s_mov_b32 s18, 30816
    buffer_load_ushort v69, v7, s[8:11], s18 offen
    s_mov_b32 s18, 51360
    buffer_load_ushort v70, v7, s[8:11], s18 offen
    s_mov_b32 s18, 71904
    buffer_load_ushort v71, v7, s[8:11], s18 offen
Lwts_21:
    s_andn2_b64 exec, s[16:17], vcc
    s_cbranch_execz Lwts_22
    s_mov_b32 s18, 0
    buffer_load_ushort v64, v5, s[12:15], s18 offen
    s_mov_b32 s18, 20544
    buffer_load_ushort v65, v5, s[12:15], s18 offen
    s_mov_b32 s18, 41088
    buffer_load_ushort v66, v5, s[12:15], s18 offen
    s_mov_b32 s18, 61632
    buffer_load_ushort v67, v5, s[12:15], s18 offen
    s_mov_b32 s18, 10272
    buffer_load_ushort v68, v5, s[12:15], s18 offen
    s_mov_b32 s18, 30816
    buffer_load_ushort v69, v5, s[12:15], s18 offen
    s_mov_b32 s18, 51360
    buffer_load_ushort v70, v5, s[12:15], s18 offen
    s_mov_b32 s18, 71904
    buffer_load_ushort v71, v5, s[12:15], s18 offen
Lwts_22:
    s_mov_b64 exec, s[16:17]
    s_add_u32 s3, s59, 127
    s_lshl_b32 s3, s3, 2
    s_add_u32 s3, s3, s40
    s_and_b32 s16, s3, 511
    s_lshr_b32 s17, s3, 9
    s_lshl_b32 s17, s17, 6
    v_add_u32 v2, s17, v1
    v_mov_b32 v3, s16
    s_sub_u32 s17, s3, 2560
    s_lshl_b32 s17, s17, 6
    v_add_u32 v5, s17, v1
    s_cmp_ge_u32 s3, 2560
    s_cselect_b64 vcc, -1, 0
    v_mov_b32 v6, 320
    v_cndmask_b32 v2, v2, v6, vcc
    v_cndmask_b32 v3, v3, v5, vcc
    v_and_b32 v5, 15, v3
    v_bfe_u32 v6, v3, 4, 4
    v_lshl_add_u32 v5, v6, 7, v5
    v_mul_u32_u24 v5, 642, v5
    v_lshl_add_u32 v5, v2, 1, v5
    v_lshlrev_b32 v7, 13, v2
    v_lshl_add_u32 v84, v3, 4, v7
    s_cmp_ge_u32 s3, 2568
    s_cselect_b32 s17, 0x7ff00000, 0
    v_or_b32 v84, s17, v84
    v_or_b32 v5, s17, v5
    v_lshrrev_b32 v6, 8, v3
    v_cmp_eq_u32 vcc, 0, v6
    v_mov_b32 v6, 0x7ff00000
    s_nop 0
    v_cndmask_b32 v7, v6, v5, vcc
    v_cndmask_b32 v5, v5, v6, vcc
    s_mov_b64 s[16:17], exec
    s_and_b64 exec, s[16:17], vcc
    s_cbranch_execz Lwts_23
    s_mov_b32 s18, 0
    buffer_load_ushort v76, v7, s[8:11], s18 offen
    s_mov_b32 s18, 20544
    buffer_load_ushort v77, v7, s[8:11], s18 offen
    s_mov_b32 s18, 41088
    buffer_load_ushort v78, v7, s[8:11], s18 offen
    s_mov_b32 s18, 61632
    buffer_load_ushort v79, v7, s[8:11], s18 offen
    s_mov_b32 s18, 10272
    buffer_load_ushort v80, v7, s[8:11], s18 offen
    s_mov_b32 s18, 30816
    buffer_load_ushort v81, v7, s[8:11], s18 offen
    s_mov_b32 s18, 51360
    buffer_load_ushort v82, v7, s[8:11], s18 offen
    s_mov_b32 s18, 71904
    buffer_load_ushort v83, v7, s[8:11], s18 offen
Lwts_23:
    s_andn2_b64 exec, s[16:17], vcc
    s_cbranch_execz Lwts_24
    s_mov_b32 s18, 0
    buffer_load_ushort v76, v5, s[12:15], s18 offen
    s_mov_b32 s18, 20544
    buffer_load_ushort v77, v5, s[12:15], s18 offen
    s_mov_b32 s18, 41088
    buffer_load_ushort v78, v5, s[12:15], s18 offen
    s_mov_b32 s18, 61632
    buffer_load_ushort v79, v5, s[12:15], s18 offen
    s_mov_b32 s18, 10272
    buffer_load_ushort v80, v5, s[12:15], s18 offen
    s_mov_b32 s18, 30816
    buffer_load_ushort v81, v5, s[12:15], s18 offen
    s_mov_b32 s18, 51360
    buffer_load_ushort v82, v5, s[12:15], s18 offen
    s_mov_b32 s18, 71904
    buffer_load_ushort v83, v5, s[12:15], s18 offen
Lwts_24:
    s_mov_b64 exec, s[16:17]
    s_add_u32 s3, s59, 254
    s_lshl_b32 s3, s3, 2
    s_add_u32 s3, s3, s40
    s_and_b32 s16, s3, 511
    s_lshr_b32 s17, s3, 9
    s_lshl_b32 s17, s17, 6
    v_add_u32 v2, s17, v1
    v_mov_b32 v3, s16
    s_sub_u32 s17, s3, 2560
    s_lshl_b32 s17, s17, 6
    v_add_u32 v5, s17, v1
    s_cmp_ge_u32 s3, 2560
    s_cselect_b64 vcc, -1, 0
    v_mov_b32 v6, 320
    v_cndmask_b32 v2, v2, v6, vcc
    v_cndmask_b32 v3, v3, v5, vcc
    v_and_b32 v5, 15, v3
    v_bfe_u32 v6, v3, 4, 4
    v_lshl_add_u32 v5, v6, 7, v5
    v_mul_u32_u24 v5, 642, v5
    v_lshl_add_u32 v5, v2, 1, v5
    v_lshlrev_b32 v7, 13, v2
    v_lshl_add_u32 v96, v3, 4, v7
    s_cmp_ge_u32 s3, 2568
    s_cselect_b32 s17, 0x7ff00000, 0
    v_or_b32 v96, s17, v96
    v_or_b32 v5, s17, v5
    v_lshrrev_b32 v6, 8, v3
    v_cmp_eq_u32 vcc, 0, v6
    v_mov_b32 v6, 0x7ff00000
    s_nop 0
    v_cndmask_b32 v7, v6, v5, vcc
    v_cndmask_b32 v5, v5, v6, vcc
    s_mov_b64 s[16:17], exec
    s_and_b64 exec, s[16:17], vcc
    s_cbranch_execz Lwts_25
    s_mov_b32 s18, 0
    buffer_load_ushort v88, v7, s[8:11], s18 offen
    s_mov_b32 s18, 20544
    buffer_load_ushort v89, v7, s[8:11], s18 offen
    s_mov_b32 s18, 41088
    buffer_load_ushort v90, v7, s[8:11], s18 offen
    s_mov_b32 s18, 61632
    buffer_load_ushort v91, v7, s[8:11], s18 offen
    s_mov_b32 s18, 10272
    buffer_load_ushort v92, v7, s[8:11], s18 offen
    s_mov_b32 s18, 30816
    buffer_load_ushort v93, v7, s[8:11], s18 offen
    s_mov_b32 s18, 51360
    buffer_load_ushort v94, v7, s[8:11], s18 offen
    s_mov_b32 s18, 71904
    buffer_load_ushort v95, v7, s[8:11], s18 offen
Lwts_25:
    s_andn2_b64 exec, s[16:17], vcc
    s_cbranch_execz Lwts_26
    s_mov_b32 s18, 0
    buffer_load_ushort v88, v5, s[12:15], s18 offen
    s_mov_b32 s18, 20544
    buffer_load_ushort v89, v5, s[12:15], s18 offen
    s_mov_b32 s18, 41088
    buffer_load_ushort v90, v5, s[12:15], s18 offen
    s_mov_b32 s18, 61632
    buffer_load_ushort v91, v5, s[12:15], s18 offen
    s_mov_b32 s18, 10272
    buffer_load_ushort v92, v5, s[12:15], s18 offen
    s_mov_b32 s18, 30816
    buffer_load_ushort v93, v5, s[12:15], s18 offen
    s_mov_b32 s18, 51360
    buffer_load_ushort v94, v5, s[12:15], s18 offen
    s_mov_b32 s18, 71904
    buffer_load_ushort v95, v5, s[12:15], s18 offen
Lwts_26:
    s_mov_b64 exec, s[16:17]
    s_add_u32 s3, s59, 381
    s_lshl_b32 s3, s3, 2
    s_add_u32 s3, s3, s40
    s_and_b32 s16, s3, 511
    s_lshr_b32 s17, s3, 9
    s_lshl_b32 s17, s17, 6
    v_add_u32 v2, s17, v1
    v_mov_b32 v3, s16
    s_sub_u32 s17, s3, 2560
    s_lshl_b32 s17, s17, 6
    v_add_u32 v5, s17, v1
    s_cmp_ge_u32 s3, 2560
    s_cselect_b64 vcc, -1, 0
    v_mov_b32 v6, 320
    v_cndmask_b32 v2, v2, v6, vcc
    v_cndmask_b32 v3, v3, v5, vcc
    v_and_b32 v5, 15, v3
    v_bfe_u32 v6, v3, 4, 4
    v_lshl_add_u32 v5, v6, 7, v5
    v_mul_u32_u24 v5, 642, v5
    v_lshl_add_u32 v5, v2, 1, v5
    v_lshlrev_b32 v7, 13, v2
    v_lshl_add_u32 v108, v3, 4, v7
    s_cmp_ge_u32 s3, 2568
    s_cselect_b32 s17, 0x7ff00000, 0
    v_or_b32 v108, s17, v108
    v_or_b32 v5, s17, v5
    v_lshrrev_b32 v6, 8, v3
    v_cmp_eq_u32 vcc, 0, v6
    v_mov_b32 v6, 0x7ff00000
    s_nop 0
    v_cndmask_b32 v7, v6, v5, vcc
    v_cndmask_b32 v5, v5, v6, vcc
    s_mov_b64 s[16:17], exec
    s_and_b64 exec, s[16:17], vcc
    s_cbranch_execz Lwts_27
    s_mov_b32 s18, 0
    buffer_load_ushort v100, v7, s[8:11], s18 offen
    s_mov_b32 s18, 20544
    buffer_load_ushort v101, v7, s[8:11], s18 offen
    s_mov_b32 s18, 41088
    buffer_load_ushort v102, v7, s[8:11], s18 offen
    s_mov_b32 s18, 61632
    buffer_load_ushort v103, v7, s[8:11], s18 offen
    s_mov_b32 s18, 10272
    buffer_load_ushort v104, v7, s[8:11], s18 offen
    s_mov_b32 s18, 30816
    buffer_load_ushort v105, v7, s[8:11], s18 offen
    s_mov_b32 s18, 51360
    buffer_load_ushort v106, v7, s[8:11], s18 offen
    s_mov_b32 s18, 71904
    buffer_load_ushort v107, v7, s[8:11], s18 offen
Lwts_27:
    s_andn2_b64 exec, s[16:17], vcc
    s_cbranch_execz Lwts_28
    s_mov_b32 s18, 0
    buffer_load_ushort v100, v5, s[12:15], s18 offen
    s_mov_b32 s18, 20544
    buffer_load_ushort v101, v5, s[12:15], s18 offen
    s_mov_b32 s18, 41088
    buffer_load_ushort v102, v5, s[12:15], s18 offen
    s_mov_b32 s18, 61632
    buffer_load_ushort v103, v5, s[12:15], s18 offen
    s_mov_b32 s18, 10272
    buffer_load_ushort v104, v5, s[12:15], s18 offen
    s_mov_b32 s18, 30816
    buffer_load_ushort v105, v5, s[12:15], s18 offen
    s_mov_b32 s18, 51360
    buffer_load_ushort v106, v5, s[12:15], s18 offen
    s_mov_b32 s18, 71904
    buffer_load_ushort v107, v5, s[12:15], s18 offen
Lwts_28:
    s_mov_b64 exec, s[16:17]
    s_add_u32 s3, s59, 508
    s_lshl_b32 s3, s3, 2
    s_add_u32 s3, s3, s40
    s_and_b32 s16, s3, 511
    s_lshr_b32 s17, s3, 9
    s_lshl_b32 s17, s17, 6
    v_add_u32 v2, s17, v1
    v_mov_b32 v3, s16
    s_sub_u32 s17, s3, 2560
    s_lshl_b32 s17, s17, 6
    v_add_u32 v5, s17, v1
    s_cmp_ge_u32 s3, 2560
    s_cselect_b64 vcc, -1, 0
    v_mov_b32 v6, 320
    v_cndmask_b32 v2, v2, v6, vcc
    v_cndmask_b32 v3, v3, v5, vcc
    v_and_b32 v5, 15, v3
    v_bfe_u32 v6, v3, 4, 4
    v_lshl_add_u32 v5, v6, 7, v5
    v_mul_u32_u24 v5, 642, v5
    v_lshl_add_u32 v5, v2, 1, v5
    v_lshlrev_b32 v7, 13, v2
    v_lshl_add_u32 v120, v3, 4, v7
    s_cmp_ge_u32 s3, 2568
    s_cselect_b32 s17, 0x7ff00000, 0
    v_or_b32 v120, s17, v120
    v_or_b32 v5, s17, v5
    v_lshrrev_b32 v6, 8, v3
    v_cmp_eq_u32 vcc, 0, v6
    v_mov_b32 v6, 0x7ff00000
    s_nop 0
    v_cndmask_b32 v7, v6, v5, vcc
    v_cndmask_b32 v5, v5, v6, vcc
    s_mov_b64 s[16:17], exec
    s_and_b64 exec, s[16:17], vcc
    s_cbranch_execz Lwts_29
    s_mov_b32 s18, 0
    buffer_load_ushort v112, v7, s[8:11], s18 offen
    s_mov_b32 s18, 20544
    buffer_load_ushort v113, v7, s[8:11], s18 offen
    s_mov_b32 s18, 41088
    buffer_load_ushort v114, v7, s[8:11], s18 offen
    s_mov_b32 s18, 61632
    buffer_load_ushort v115, v7, s[8:11], s18 offen
    s_mov_b32 s18, 10272
    buffer_load_ushort v116, v7, s[8:11], s18 offen
    s_mov_b32 s18, 30816
    buffer_load_ushort v117, v7, s[8:11], s18 offen
    s_mov_b32 s18, 51360
    buffer_load_ushort v118, v7, s[8:11], s18 offen
    s_mov_b32 s18, 71904
    buffer_load_ushort v119, v7, s[8:11], s18 offen
Lwts_29:
    s_andn2_b64 exec, s[16:17], vcc
    s_cbranch_execz Lwts_30
    s_mov_b32 s18, 0
    buffer_load_ushort v112, v5, s[12:15], s18 offen
    s_mov_b32 s18, 20544
    buffer_load_ushort v113, v5, s[12:15], s18 offen
    s_mov_b32 s18, 41088
    buffer_load_ushort v114, v5, s[12:15], s18 offen
    s_mov_b32 s18, 61632
    buffer_load_ushort v115, v5, s[12:15], s18 offen
    s_mov_b32 s18, 10272
    buffer_load_ushort v116, v5, s[12:15], s18 offen
    s_mov_b32 s18, 30816
    buffer_load_ushort v117, v5, s[12:15], s18 offen
    s_mov_b32 s18, 51360
    buffer_load_ushort v118, v5, s[12:15], s18 offen
    s_mov_b32 s18, 71904
    buffer_load_ushort v119, v5, s[12:15], s18 offen
Lwts_30:
    s_mov_b64 exec, s[16:17]
    s_add_u32 s3, s59, 635
    s_lshl_b32 s3, s3, 2
    s_add_u32 s3, s3, s40
    s_and_b32 s16, s3, 511
    s_lshr_b32 s17, s3, 9
    s_lshl_b32 s17, s17, 6
    v_add_u32 v2, s17, v1
    v_mov_b32 v3, s16
    s_sub_u32 s17, s3, 2560
    s_lshl_b32 s17, s17, 6
    v_add_u32 v5, s17, v1
    s_cmp_ge_u32 s3, 2560
    s_cselect_b64 vcc, -1, 0
    v_mov_b32 v6, 320
    v_cndmask_b32 v2, v2, v6, vcc
    v_cndmask_b32 v3, v3, v5, vcc
    v_and_b32 v5, 15, v3
    v_bfe_u32 v6, v3, 4, 4
    v_lshl_add_u32 v5, v6, 7, v5
    v_mul_u32_u24 v5, 642, v5
    v_lshl_add_u32 v5, v2, 1, v5
    v_lshlrev_b32 v7, 13, v2
    v_lshl_add_u32 v132, v3, 4, v7
    s_cmp_ge_u32 s3, 2568
    s_cselect_b32 s17, 0x7ff00000, 0
    v_or_b32 v132, s17, v132
    v_or_b32 v5, s17, v5
    v_lshrrev_b32 v6, 8, v3
    v_cmp_eq_u32 vcc, 0, v6
    v_mov_b32 v6, 0x7ff00000
    s_nop 0
    v_cndmask_b32 v7, v6, v5, vcc
    v_cndmask_b32 v5, v5, v6, vcc
    s_mov_b64 s[16:17], exec
    s_and_b64 exec, s[16:17], vcc
    s_cbranch_execz Lwts_31
    s_mov_b32 s18, 0
    buffer_load_ushort v124, v7, s[8:11], s18 offen
    s_mov_b32 s18, 20544
    buffer_load_ushort v125, v7, s[8:11], s18 offen
    s_mov_b32 s18, 41088
    buffer_load_ushort v126, v7, s[8:11], s18 offen
    s_mov_b32 s18, 61632
    buffer_load_ushort v127, v7, s[8:11], s18 offen
    s_mov_b32 s18, 10272
    buffer_load_ushort v128, v7, s[8:11], s18 offen
    s_mov_b32 s18, 30816
    buffer_load_ushort v129, v7, s[8:11], s18 offen
    s_mov_b32 s18, 51360
    buffer_load_ushort v130, v7, s[8:11], s18 offen
    s_mov_b32 s18, 71904
    buffer_load_ushort v131, v7, s[8:11], s18 offen
Lwts_31:
    s_andn2_b64 exec, s[16:17], vcc
    s_cbranch_execz Lwts_32
    s_mov_b32 s18, 0
    buffer_load_ushort v124, v5, s[12:15], s18 offen
    s_mov_b32 s18, 20544
    buffer_load_ushort v125, v5, s[12:15], s18 offen
    s_mov_b32 s18, 41088
    buffer_load_ushort v126, v5, s[12:15], s18 offen
    s_mov_b32 s18, 61632
    buffer_load_ushort v127, v5, s[12:15], s18 offen
    s_mov_b32 s18, 10272
    buffer_load_ushort v128, v5, s[12:15], s18 offen
    s_mov_b32 s18, 30816
    buffer_load_ushort v129, v5, s[12:15], s18 offen
    s_mov_b32 s18, 51360
    buffer_load_ushort v130, v5, s[12:15], s18 offen
    s_mov_b32 s18, 71904
    buffer_load_ushort v131, v5, s[12:15], s18 offen
Lwts_32:
    s_mov_b64 exec, s[16:17]
    s_waitcnt vmcnt(0)
    s_mov_b32 s18, 0x9e00000
    v_lshl_or_b32 v64, v65, 16, v64
    v_lshl_or_b32 v65, v67, 16, v66
    v_lshl_or_b32 v66, v69, 16, v68
    v_lshl_or_b32 v67, v71, 16, v70
    buffer_store_dwordx4 v[64:67], v72, s[4:7], s18 offen sc1
    v_lshl_or_b32 v76, v77, 16, v76
    v_lshl_or_b32 v77, v79, 16, v78
    v_lshl_or_b32 v78, v81, 16, v80
    v_lshl_or_b32 v79, v83, 16, v82
    buffer_store_dwordx4 v[76:79], v84, s[4:7], s18 offen sc1
    v_lshl_or_b32 v88, v89, 16, v88
    v_lshl_or_b32 v89, v91, 16, v90
    v_lshl_or_b32 v90, v93, 16, v92
    v_lshl_or_b32 v91, v95, 16, v94
    buffer_store_dwordx4 v[88:91], v96, s[4:7], s18 offen sc1
    v_lshl_or_b32 v100, v101, 16, v100
    v_lshl_or_b32 v101, v103, 16, v102
    v_lshl_or_b32 v102, v105, 16, v104
    v_lshl_or_b32 v103, v107, 16, v106
    buffer_store_dwordx4 v[100:103], v108, s[4:7], s18 offen sc1
    v_lshl_or_b32 v112, v113, 16, v112
    v_lshl_or_b32 v113, v115, 16, v114
    v_lshl_or_b32 v114, v117, 16, v116
    v_lshl_or_b32 v115, v119, 16, v118
    buffer_store_dwordx4 v[112:115], v120, s[4:7], s18 offen sc1
    v_lshl_or_b32 v124, v125, 16, v124
    v_lshl_or_b32 v125, v127, 16, v126
    v_lshl_or_b32 v126, v129, 16, v128
    v_lshl_or_b32 v127, v131, 16, v130
    buffer_store_dwordx4 v[124:127], v132, s[4:7], s18 offen sc1
Lcu_18:
    s_cmp_eq_u32 s59, 200
    s_cbranch_scc1 Lsm_34
    s_lshl_b32 s3, s59, 8
    v_add_u32 v1, s3, v0
    s_mov_b32 s8, 53687092
    v_mul_hi_u32 v2, v1, s8
    v_mul_u32_u24 v3, 80, v2
    v_sub_u32 v3, v1, v3
    v_lshlrev_b32 v3, 3, v3
    s_mov_b32 s9, 6710887
    s_mov_b32 s10, 0x3acccccd
    s_mov_b32 s11, 0x354ccccd
    s_mov_b32 s12, 0x35cccccd
    v_add_u32 v4, 0, v3
    v_subrev_u32 v5, 320, v4
    v_cmp_lt_u32 vcc, 320, v4
    s_nop 1
    v_cndmask_b32 v5, v4, v5, vcc
    v_mul_u32_u24 v6, v5, v2
    v_mul_hi_u32 v7, v6, s9
    v_mul_u32_u24 v7, 640, v7
    v_sub_u32 v6, v6, v7
    v_cvt_f32_u32 v6, v6
    v_mul_f32 v6, s10, v6
    v_cos_f32 v7, v6
    v_sin_f32 v8, v6
    s_nop 1
    v_cndmask_b32 v16, v7, -v8, vcc
    v_cmp_eq_u32 vcc, 0, v4
    v_mov_b32 v9, 320
    v_cmp_eq_u32 s[14:15], v9, v4
    s_nop 1
    s_or_b64 vcc, vcc, s[14:15]
    v_mov_b32 v9, s12
    v_mov_b32 v10, s11
    v_cndmask_b32 v9, v9, v10, vcc
    v_mul_f32 v24, v16, v9
    v_add_u32 v4, 1, v3
    v_subrev_u32 v5, 320, v4
    v_cmp_lt_u32 vcc, 320, v4
    s_nop 1
    v_cndmask_b32 v5, v4, v5, vcc
    v_mul_u32_u24 v6, v5, v2
    v_mul_hi_u32 v7, v6, s9
    v_mul_u32_u24 v7, 640, v7
    v_sub_u32 v6, v6, v7
    v_cvt_f32_u32 v6, v6
    v_mul_f32 v6, s10, v6
    v_cos_f32 v7, v6
    v_sin_f32 v8, v6
    s_nop 1
    v_cndmask_b32 v17, v7, -v8, vcc
    v_cmp_eq_u32 vcc, 0, v4
    v_mov_b32 v9, 320
    v_cmp_eq_u32 s[14:15], v9, v4
    s_nop 1
    s_or_b64 vcc, vcc, s[14:15]
    v_mov_b32 v9, s12
    v_mov_b32 v10, s11
    v_cndmask_b32 v9, v9, v10, vcc
    v_mul_f32 v25, v17, v9
    v_add_u32 v4, 2, v3
    v_subrev_u32 v5, 320, v4
    v_cmp_lt_u32 vcc, 320, v4
    s_nop 1
    v_cndmask_b32 v5, v4, v5, vcc
    v_mul_u32_u24 v6, v5, v2
    v_mul_hi_u32 v7, v6, s9
    v_mul_u32_u24 v7, 640, v7
    v_sub_u32 v6, v6, v7
    v_cvt_f32_u32 v6, v6
    v_mul_f32 v6, s10, v6
    v_cos_f32 v7, v6
    v_sin_f32 v8, v6
    s_nop 1
    v_cndmask_b32 v18, v7, -v8, vcc
    v_cmp_eq_u32 vcc, 0, v4
    v_mov_b32 v9, 320
    v_cmp_eq_u32 s[14:15], v9, v4
    s_nop 1
    s_or_b64 vcc, vcc, s[14:15]
    v_mov_b32 v9, s12
    v_mov_b32 v10, s11
    v_cndmask_b32 v9, v9, v10, vcc
    v_mul_f32 v26, v18, v9
    v_add_u32 v4, 3, v3
    v_subrev_u32 v5, 320, v4
    v_cmp_lt_u32 vcc, 320, v4
    s_nop 1
    v_cndmask_b32 v5, v4, v5, vcc
    v_mul_u32_u24 v6, v5, v2
    v_mul_hi_u32 v7, v6, s9
    v_mul_u32_u24 v7, 640, v7
    v_sub_u32 v6, v6, v7
    v_cvt_f32_u32 v6, v6
    v_mul_f32 v6, s10, v6
    v_cos_f32 v7, v6
    v_sin_f32 v8, v6
    s_nop 1
    v_cndmask_b32 v19, v7, -v8, vcc
    v_cmp_eq_u32 vcc, 0, v4
    v_mov_b32 v9, 320
    v_cmp_eq_u32 s[14:15], v9, v4
    s_nop 1
    s_or_b64 vcc, vcc, s[14:15]
    v_mov_b32 v9, s12
    v_mov_b32 v10, s11
    v_cndmask_b32 v9, v9, v10, vcc
    v_mul_f32 v27, v19, v9
    v_add_u32 v4, 4, v3
    v_subrev_u32 v5, 320, v4
    v_cmp_lt_u32 vcc, 320, v4
    s_nop 1
    v_cndmask_b32 v5, v4, v5, vcc
    v_mul_u32_u24 v6, v5, v2
    v_mul_hi_u32 v7, v6, s9
    v_mul_u32_u24 v7, 640, v7
    v_sub_u32 v6, v6, v7
    v_cvt_f32_u32 v6, v6
    v_mul_f32 v6, s10, v6
    v_cos_f32 v7, v6
    v_sin_f32 v8, v6
    s_nop 1
    v_cndmask_b32 v20, v7, -v8, vcc
    v_cmp_eq_u32 vcc, 0, v4
    v_mov_b32 v9, 320
    v_cmp_eq_u32 s[14:15], v9, v4
    s_nop 1
    s_or_b64 vcc, vcc, s[14:15]
    v_mov_b32 v9, s12
    v_mov_b32 v10, s11
    v_cndmask_b32 v9, v9, v10, vcc
    v_mul_f32 v28, v20, v9
    v_add_u32 v4, 5, v3
    v_subrev_u32 v5, 320, v4
    v_cmp_lt_u32 vcc, 320, v4
    s_nop 1
    v_cndmask_b32 v5, v4, v5, vcc
    v_mul_u32_u24 v6, v5, v2
    v_mul_hi_u32 v7, v6, s9
    v_mul_u32_u24 v7, 640, v7
    v_sub_u32 v6, v6, v7
    v_cvt_f32_u32 v6, v6
    v_mul_f32 v6, s10, v6
    v_cos_f32 v7, v6
    v_sin_f32 v8, v6
    s_nop 1
    v_cndmask_b32 v21, v7, -v8, vcc
    v_cmp_eq_u32 vcc, 0, v4
    v_mov_b32 v9, 320
    v_cmp_eq_u32 s[14:15], v9, v4
    s_nop 1
    s_or_b64 vcc, vcc, s[14:15]
    v_mov_b32 v9, s12
    v_mov_b32 v10, s11
    v_cndmask_b32 v9, v9, v10, vcc
    v_mul_f32 v29, v21, v9
    v_add_u32 v4, 6, v3
    v_subrev_u32 v5, 320, v4
    v_cmp_lt_u32 vcc, 320, v4
    s_nop 1
    v_cndmask_b32 v5, v4, v5, vcc
    v_mul_u32_u24 v6, v5, v2
    v_mul_hi_u32 v7, v6, s9
    v_mul_u32_u24 v7, 640, v7
    v_sub_u32 v6, v6, v7
    v_cvt_f32_u32 v6, v6
    v_mul_f32 v6, s10, v6
    v_cos_f32 v7, v6
    v_sin_f32 v8, v6
    s_nop 1
    v_cndmask_b32 v22, v7, -v8, vcc
    v_cmp_eq_u32 vcc, 0, v4
    v_mov_b32 v9, 320
    v_cmp_eq_u32 s[14:15], v9, v4
    s_nop 1
    s_or_b64 vcc, vcc, s[14:15]
    v_mov_b32 v9, s12
    v_mov_b32 v10, s11
    v_cndmask_b32 v9, v9, v10, vcc
    v_mul_f32 v30, v22, v9
    v_add_u32 v4, 7, v3
    v_subrev_u32 v5, 320, v4
    v_cmp_lt_u32 vcc, 320, v4
    s_nop 1
    v_cndmask_b32 v5, v4, v5, vcc
    v_mul_u32_u24 v6, v5, v2
    v_mul_hi_u32 v7, v6, s9
    v_mul_u32_u24 v7, 640, v7
    v_sub_u32 v6, v6, v7
    v_cvt_f32_u32 v6, v6
    v_mul_f32 v6, s10, v6
    v_cos_f32 v7, v6
    v_sin_f32 v8, v6
    s_nop 1
    v_cndmask_b32 v23, v7, -v8, vcc
    v_cmp_eq_u32 vcc, 0, v4
    v_mov_b32 v9, 320
    v_cmp_eq_u32 s[14:15], v9, v4
    s_nop 1
    s_or_b64 vcc, vcc, s[14:15]
    v_mov_b32 v9, s12
    v_mov_b32 v10, s11
    v_cndmask_b32 v9, v9, v10, vcc
    v_mul_f32 v31, v23, v9
    v_cvt_pk_bf16_f32 v32, v16, v17
    v_lshlrev_b32 v4, 16, v32
    v_and_b32 v5, 0xffff0000, v32
    v_sub_f32 v4, v16, v4
    v_sub_f32 v5, v17, v5
    v_cvt_pk_bf16_f32 v36, v4, v5
    v_cvt_pk_bf16_f32 v40, v24, v25
    v_lshlrev_b32 v4, 16, v40
    v_and_b32 v5, 0xffff0000, v40
    v_sub_f32 v4, v24, v4
    v_sub_f32 v5, v25, v5
    v_cvt_pk_bf16_f32 v44, v4, v5
    v_cvt_pk_bf16_f32 v33, v18, v19
    v_lshlrev_b32 v4, 16, v33
    v_and_b32 v5, 0xffff0000, v33
    v_sub_f32 v4, v18, v4
    v_sub_f32 v5, v19, v5
    v_cvt_pk_bf16_f32 v37, v4, v5
    v_cvt_pk_bf16_f32 v41, v26, v27
    v_lshlrev_b32 v4, 16, v41
    v_and_b32 v5, 0xffff0000, v41
    v_sub_f32 v4, v26, v4
    v_sub_f32 v5, v27, v5
    v_cvt_pk_bf16_f32 v45, v4, v5
    v_cvt_pk_bf16_f32 v34, v20, v21
    v_lshlrev_b32 v4, 16, v34
    v_and_b32 v5, 0xffff0000, v34
    v_sub_f32 v4, v20, v4
    v_sub_f32 v5, v21, v5
    v_cvt_pk_bf16_f32 v38, v4, v5
    v_cvt_pk_bf16_f32 v42, v28, v29
    v_lshlrev_b32 v4, 16, v42
    v_and_b32 v5, 0xffff0000, v42
    v_sub_f32 v4, v28, v4
    v_sub_f32 v5, v29, v5
    v_cvt_pk_bf16_f32 v46, v4, v5
    v_cvt_pk_bf16_f32 v35, v22, v23
    v_lshlrev_b32 v4, 16, v35
    v_and_b32 v5, 0xffff0000, v35
    v_sub_f32 v4, v22, v4
    v_sub_f32 v5, v23, v5
    v_cvt_pk_bf16_f32 v39, v4, v5
    v_cvt_pk_bf16_f32 v43, v30, v31
    v_lshlrev_b32 v4, 16, v43
    v_and_b32 v5, 0xffff0000, v43
    v_sub_f32 v4, v30, v4
    v_sub_f32 v5, v31, v5
    v_cvt_pk_bf16_f32 v47, v4, v5
    v_mul_u32_u24 v4, 1280, v2
    v_lshl_add_u32 v4, v3, 1, v4
    v_mul_u32_u24 v5, 3840, v2
    v_lshl_add_u32 v5, v3, 1, v5
    s_mov_b32 s8, 0x9800000
    s_mov_b32 s9, 0x9900000
    s_mov_b32 s10, 0x9a00000
    buffer_store_dwordx4 v[32:35], v4, s[4:7], s8 offen sc1
    buffer_store_dwordx4 v[36:39], v4, s[4:7], s9 offen sc1
    buffer_store_dwordx4 v[44:47], v5, s[4:7], s10 offen sc1
    buffer_store_dwordx4 v[40:43], v5, s[4:7], s10 offen offset:1280 sc1
    buffer_store_dwordx4 v[40:43], v5, s[4:7], s10 offen offset:2560 sc1
    s_branch Lcend_33
Lsm_34:
    v_and_b32 v1, 63, v0
    v_and_b32 v2, 15, v0
    v_bfe_u32 v3, v0, 4, 2
    v_lshrrev_b32 v4, 6, v0
    v_lshlrev_b32 v5, 4, v1
    v_lshl_add_u32 v7, v4, 4, v2
    v_lshl_add_u32 v8, v3, 2, 0
    v_mul_u32_u24 v8, v8, v7
    v_and_b32 v8, 63, v8
    v_cvt_f32_u32 v8, v8
    v_mul_f32 v8, 0x3c800000, v8
    v_cos_f32 v16, v8
    v_sin_f32 v24, v8
    v_lshl_add_u32 v8, v3, 2, 1
    v_mul_u32_u24 v8, v8, v7
    v_and_b32 v8, 63, v8
    v_cvt_f32_u32 v8, v8
    v_mul_f32 v8, 0x3c800000, v8
    v_cos_f32 v17, v8
    v_sin_f32 v25, v8
    v_lshl_add_u32 v8, v3, 2, 2
    v_mul_u32_u24 v8, v8, v7
    v_and_b32 v8, 63, v8
    v_cvt_f32_u32 v8, v8
    v_mul_f32 v8, 0x3c800000, v8
    v_cos_f32 v18, v8
    v_sin_f32 v26, v8
    v_lshl_add_u32 v8, v3, 2, 3
    v_mul_u32_u24 v8, v8, v7
    v_and_b32 v8, 63, v8
    v_cvt_f32_u32 v8, v8
    v_mul_f32 v8, 0x3c800000, v8
    v_cos_f32 v19, v8
    v_sin_f32 v27, v8
    v_lshl_add_u32 v8, v3, 2, 16
    v_mul_u32_u24 v8, v8, v7
    v_and_b32 v8, 63, v8
    v_cvt_f32_u32 v8, v8
    v_mul_f32 v8, 0x3c800000, v8
    v_cos_f32 v20, v8
    v_sin_f32 v28, v8
    v_lshl_add_u32 v8, v3, 2, 17
    v_mul_u32_u24 v8, v8, v7
    v_and_b32 v8, 63, v8
    v_cvt_f32_u32 v8, v8
    v_mul_f32 v8, 0x3c800000, v8
    v_cos_f32 v21, v8
    v_sin_f32 v29, v8
    v_lshl_add_u32 v8, v3, 2, 18
    v_mul_u32_u24 v8, v8, v7
    v_and_b32 v8, 63, v8
    v_cvt_f32_u32 v8, v8
    v_mul_f32 v8, 0x3c800000, v8
    v_cos_f32 v22, v8
    v_sin_f32 v30, v8
    v_lshl_add_u32 v8, v3, 2, 19
    v_mul_u32_u24 v8, v8, v7
    v_and_b32 v8, 63, v8
    v_cvt_f32_u32 v8, v8
    v_mul_f32 v8, 0x3c800000, v8
    v_cos_f32 v23, v8
    v_sin_f32 v31, v8
    s_nop 1
    v_cvt_pk_bf16_f32 v32, v16, v17
    v_lshlrev_b32 v9, 16, v32
    v_and_b32 v10, 0xffff0000, v32
    v_sub_f32 v9, v16, v9
    v_sub_f32 v10, v17, v10
    v_cvt_pk_bf16_f32 v36, v9, v10
    v_cvt_pk_bf16_f32 v40, v24, v25
    v_lshlrev_b32 v9, 16, v40
    v_and_b32 v10, 0xffff0000, v40
    v_sub_f32 v9, v24, v9
    v_sub_f32 v10, v25, v10
    v_cvt_pk_bf16_f32 v44, v9, v10
    v_cvt_pk_bf16_f32 v33, v18, v19
    v_lshlrev_b32 v9, 16, v33
    v_and_b32 v10, 0xffff0000, v33
    v_sub_f32 v9, v18, v9
    v_sub_f32 v10, v19, v10
    v_cvt_pk_bf16_f32 v37, v9, v10
    v_cvt_pk_bf16_f32 v41, v26, v27
    v_lshlrev_b32 v9, 16, v41
    v_and_b32 v10, 0xffff0000, v41
    v_sub_f32 v9, v26, v9
    v_sub_f32 v10, v27, v10
    v_cvt_pk_bf16_f32 v45, v9, v10
    v_cvt_pk_bf16_f32 v34, v20, v21
    v_lshlrev_b32 v9, 16, v34
    v_and_b32 v10, 0xffff0000, v34
    v_sub_f32 v9, v20, v9
    v_sub_f32 v10, v21, v10
    v_cvt_pk_bf16_f32 v38, v9, v10
    v_cvt_pk_bf16_f32 v42, v28, v29
    v_lshlrev_b32 v9, 16, v42
    v_and_b32 v10, 0xffff0000, v42
    v_sub_f32 v9, v28, v9
    v_sub_f32 v10, v29, v10
    v_cvt_pk_bf16_f32 v46, v9, v10
    v_cvt_pk_bf16_f32 v35, v22, v23
    v_lshlrev_b32 v9, 16, v35
    v_and_b32 v10, 0xffff0000, v35
    v_sub_f32 v9, v22, v9
    v_sub_f32 v10, v23, v10
    v_cvt_pk_bf16_f32 v39, v9, v10
    v_cvt_pk_bf16_f32 v43, v30, v31
    v_lshlrev_b32 v9, 16, v43
    v_and_b32 v10, 0xffff0000, v43
    v_sub_f32 v9, v30, v9
    v_sub_f32 v10, v31, v10
    v_cvt_pk_bf16_f32 v47, v9, v10
    v_lshl_add_u32 v8, v4, 11, v5
    s_mov_b32 s8, 0x9d02000
    buffer_store_dwordx4 v[32:35], v8, s[4:7], s8 offen sc1
    s_mov_b32 s8, 0x9d04000
    buffer_store_dwordx4 v[36:39], v8, s[4:7], s8 offen sc1
    s_mov_b32 s8, 0x9d06000
    buffer_store_dwordx4 v[40:43], v8, s[4:7], s8 offen sc1
    s_mov_b32 s8, 0x9d08000
    buffer_store_dwordx4 v[44:47], v8, s[4:7], s8 offen sc1
    s_nop 1
    v_lshl_add_u32 v8, v3, 2, 32
    v_mul_u32_u24 v8, v8, v7
    v_and_b32 v8, 63, v8
    v_cvt_f32_u32 v8, v8
    v_mul_f32 v8, 0x3c800000, v8
    v_cos_f32 v16, v8
    v_sin_f32 v24, v8
    v_lshl_add_u32 v8, v3, 2, 33
    v_mul_u32_u24 v8, v8, v7
    v_and_b32 v8, 63, v8
    v_cvt_f32_u32 v8, v8
    v_mul_f32 v8, 0x3c800000, v8
    v_cos_f32 v17, v8
    v_sin_f32 v25, v8
    v_lshl_add_u32 v8, v3, 2, 34
    v_mul_u32_u24 v8, v8, v7
    v_and_b32 v8, 63, v8
    v_cvt_f32_u32 v8, v8
    v_mul_f32 v8, 0x3c800000, v8
    v_cos_f32 v18, v8
    v_sin_f32 v26, v8
    v_lshl_add_u32 v8, v3, 2, 35
    v_mul_u32_u24 v8, v8, v7
    v_and_b32 v8, 63, v8
    v_cvt_f32_u32 v8, v8
    v_mul_f32 v8, 0x3c800000, v8
    v_cos_f32 v19, v8
    v_sin_f32 v27, v8
    v_lshl_add_u32 v8, v3, 2, 48
    v_mul_u32_u24 v8, v8, v7
    v_and_b32 v8, 63, v8
    v_cvt_f32_u32 v8, v8
    v_mul_f32 v8, 0x3c800000, v8
    v_cos_f32 v20, v8
    v_sin_f32 v28, v8
    v_lshl_add_u32 v8, v3, 2, 49
    v_mul_u32_u24 v8, v8, v7
    v_and_b32 v8, 63, v8
    v_cvt_f32_u32 v8, v8
    v_mul_f32 v8, 0x3c800000, v8
    v_cos_f32 v21, v8
    v_sin_f32 v29, v8
    v_lshl_add_u32 v8, v3, 2, 50
    v_mul_u32_u24 v8, v8, v7
    v_and_b32 v8, 63, v8
    v_cvt_f32_u32 v8, v8
    v_mul_f32 v8, 0x3c800000, v8
    v_cos_f32 v22, v8
    v_sin_f32 v30, v8
    v_lshl_add_u32 v8, v3, 2, 51
    v_mul_u32_u24 v8, v8, v7
    v_and_b32 v8, 63, v8
    v_cvt_f32_u32 v8, v8
    v_mul_f32 v8, 0x3c800000, v8
    v_cos_f32 v23, v8
    v_sin_f32 v31, v8
    s_nop 1
    v_cvt_pk_bf16_f32 v32, v16, v17
    v_lshlrev_b32 v9, 16, v32
    v_and_b32 v10, 0xffff0000, v32
    v_sub_f32 v9, v16, v9
    v_sub_f32 v10, v17, v10
    v_cvt_pk_bf16_f32 v36, v9, v10
    v_cvt_pk_bf16_f32 v40, v24, v25
    v_lshlrev_b32 v9, 16, v40
    v_and_b32 v10, 0xffff0000, v40
    v_sub_f32 v9, v24, v9
    v_sub_f32 v10, v25, v10
    v_cvt_pk_bf16_f32 v44, v9, v10
    v_cvt_pk_bf16_f32 v33, v18, v19
    v_lshlrev_b32 v9, 16, v33
    v_and_b32 v10, 0xffff0000, v33
    v_sub_f32 v9, v18, v9
    v_sub_f32 v10, v19, v10
    v_cvt_pk_bf16_f32 v37, v9, v10
    v_cvt_pk_bf16_f32 v41, v26, v27
    v_lshlrev_b32 v9, 16, v41
    v_and_b32 v10, 0xffff0000, v41
    v_sub_f32 v9, v26, v9
    v_sub_f32 v10, v27, v10
    v_cvt_pk_bf16_f32 v45, v9, v10
    v_cvt_pk_bf16_f32 v34, v20, v21
    v_lshlrev_b32 v9, 16, v34
    v_and_b32 v10, 0xffff0000, v34
    v_sub_f32 v9, v20, v9
    v_sub_f32 v10, v21, v10
    v_cvt_pk_bf16_f32 v38, v9, v10
    v_cvt_pk_bf16_f32 v42, v28, v29
    v_lshlrev_b32 v9, 16, v42
    v_and_b32 v10, 0xffff0000, v42
    v_sub_f32 v9, v28, v9
    v_sub_f32 v10, v29, v10
    v_cvt_pk_bf16_f32 v46, v9, v10
    v_cvt_pk_bf16_f32 v35, v22, v23
    v_lshlrev_b32 v9, 16, v35
    v_and_b32 v10, 0xffff0000, v35
    v_sub_f32 v9, v22, v9
    v_sub_f32 v10, v23, v10
    v_cvt_pk_bf16_f32 v39, v9, v10
    v_cvt_pk_bf16_f32 v43, v30, v31
    v_lshlrev_b32 v9, 16, v43
    v_and_b32 v10, 0xffff0000, v43
    v_sub_f32 v9, v30, v9
    v_sub_f32 v10, v31, v10
    v_cvt_pk_bf16_f32 v47, v9, v10
    v_lshl_add_u32 v8, v4, 11, v5
    s_mov_b32 s8, 0x9d02400
    buffer_store_dwordx4 v[32:35], v8, s[4:7], s8 offen sc1
    s_mov_b32 s8, 0x9d04400
    buffer_store_dwordx4 v[36:39], v8, s[4:7], s8 offen sc1
    s_mov_b32 s8, 0x9d06400
    buffer_store_dwordx4 v[40:43], v8, s[4:7], s8 offen sc1
    s_mov_b32 s8, 0x9d08400
    buffer_store_dwordx4 v[44:47], v8, s[4:7], s8 offen sc1
    s_nop 1
    v_and_b32 v11, 1, v4
    v_lshl_add_u32 v7, v11, 4, v2
    v_lshl_add_u32 v8, v3, 2, 0
    v_mul_u32_u24 v8, v8, v7
    v_and_b32 v8, 31, v8
    v_cvt_f32_u32 v8, v8
    v_mul_f32 v8, 0x3d000000, v8
    v_cos_f32 v16, v8
    v_sin_f32 v24, v8
    v_lshl_add_u32 v8, v3, 2, 1
    v_mul_u32_u24 v8, v8, v7
    v_and_b32 v8, 31, v8
    v_cvt_f32_u32 v8, v8
    v_mul_f32 v8, 0x3d000000, v8
    v_cos_f32 v17, v8
    v_sin_f32 v25, v8
    v_lshl_add_u32 v8, v3, 2, 2
    v_mul_u32_u24 v8, v8, v7
    v_and_b32 v8, 31, v8
    v_cvt_f32_u32 v8, v8
    v_mul_f32 v8, 0x3d000000, v8
    v_cos_f32 v18, v8
    v_sin_f32 v26, v8
    v_lshl_add_u32 v8, v3, 2, 3
    v_mul_u32_u24 v8, v8, v7
    v_and_b32 v8, 31, v8
    v_cvt_f32_u32 v8, v8
    v_mul_f32 v8, 0x3d000000, v8
    v_cos_f32 v19, v8
    v_sin_f32 v27, v8
    v_lshl_add_u32 v8, v3, 2, 16
    v_mul_u32_u24 v8, v8, v7
    v_and_b32 v8, 31, v8
    v_cvt_f32_u32 v8, v8
    v_mul_f32 v8, 0x3d000000, v8
    v_cos_f32 v20, v8
    v_sin_f32 v28, v8
    v_lshl_add_u32 v8, v3, 2, 17
    v_mul_u32_u24 v8, v8, v7
    v_and_b32 v8, 31, v8
    v_cvt_f32_u32 v8, v8
    v_mul_f32 v8, 0x3d000000, v8
    v_cos_f32 v21, v8
    v_sin_f32 v29, v8
    v_lshl_add_u32 v8, v3, 2, 18
    v_mul_u32_u24 v8, v8, v7
    v_and_b32 v8, 31, v8
    v_cvt_f32_u32 v8, v8
    v_mul_f32 v8, 0x3d000000, v8
    v_cos_f32 v22, v8
    v_sin_f32 v30, v8
    v_lshl_add_u32 v8, v3, 2, 19
    v_mul_u32_u24 v8, v8, v7
    v_and_b32 v8, 31, v8
    v_cvt_f32_u32 v8, v8
    v_mul_f32 v8, 0x3d000000, v8
    v_cos_f32 v23, v8
    v_sin_f32 v31, v8
    s_nop 1
    v_cvt_pk_bf16_f32 v32, v16, v17
    v_lshlrev_b32 v9, 16, v32
    v_and_b32 v10, 0xffff0000, v32
    v_sub_f32 v9, v16, v9
    v_sub_f32 v10, v17, v10
    v_cvt_pk_bf16_f32 v36, v9, v10
    v_cvt_pk_bf16_f32 v40, v24, v25
    v_lshlrev_b32 v9, 16, v40
    v_and_b32 v10, 0xffff0000, v40
    v_sub_f32 v9, v24, v9
    v_sub_f32 v10, v25, v10
    v_cvt_pk_bf16_f32 v44, v9, v10
    v_cvt_pk_bf16_f32 v33, v18, v19
    v_lshlrev_b32 v9, 16, v33
    v_and_b32 v10, 0xffff0000, v33
    v_sub_f32 v9, v18, v9
    v_sub_f32 v10, v19, v10
    v_cvt_pk_bf16_f32 v37, v9, v10
    v_cvt_pk_bf16_f32 v41, v26, v27
    v_lshlrev_b32 v9, 16, v41
    v_and_b32 v10, 0xffff0000, v41
    v_sub_f32 v9, v26, v9
    v_sub_f32 v10, v27, v10
    v_cvt_pk_bf16_f32 v45, v9, v10
    v_cvt_pk_bf16_f32 v34, v20, v21
    v_lshlrev_b32 v9, 16, v34
    v_and_b32 v10, 0xffff0000, v34
    v_sub_f32 v9, v20, v9
    v_sub_f32 v10, v21, v10
    v_cvt_pk_bf16_f32 v38, v9, v10
    v_cvt_pk_bf16_f32 v42, v28, v29
    v_lshlrev_b32 v9, 16, v42
    v_and_b32 v10, 0xffff0000, v42
    v_sub_f32 v9, v28, v9
    v_sub_f32 v10, v29, v10
    v_cvt_pk_bf16_f32 v46, v9, v10
    v_cvt_pk_bf16_f32 v35, v22, v23
    v_lshlrev_b32 v9, 16, v35
    v_and_b32 v10, 0xffff0000, v35
    v_sub_f32 v9, v22, v9
    v_sub_f32 v10, v23, v10
    v_cvt_pk_bf16_f32 v39, v9, v10
    v_cvt_pk_bf16_f32 v43, v30, v31
    v_lshlrev_b32 v9, 16, v43
    v_and_b32 v10, 0xffff0000, v43
    v_sub_f32 v9, v30, v9
    v_sub_f32 v10, v31, v10
    v_cvt_pk_bf16_f32 v47, v9, v10
    v_lshl_add_u32 v8, v11, 10, v5
    s_mov_b32 s8, 0x9d00000
    buffer_store_dwordx4 v[32:35], v8, s[4:7], s8 offen sc1
    s_mov_b32 s8, 0x9d00800
    buffer_store_dwordx4 v[36:39], v8, s[4:7], s8 offen sc1
    s_mov_b32 s8, 0x9d01000
    buffer_store_dwordx4 v[40:43], v8, s[4:7], s8 offen sc1
    s_mov_b32 s8, 0x9d01800
    buffer_store_dwordx4 v[44:47], v8, s[4:7], s8 offen sc1
    s_nop 1
    v_lshl_add_u32 v8, v3, 2, 0
    v_lshl_add_u32 v8, v4, 4, v8
    v_add_u32 v9, 0, v2
    v_mul_u32_u24 v8, v8, v9
    v_cvt_f32_u32 v8, v8
    v_mul_f32 v8, 0x3a000000, v8
    v_cos_f32 v16, v8
    v_sin_f32 v20, v8
    v_lshl_add_u32 v8, v3, 2, 1
    v_lshl_add_u32 v8, v4, 4, v8
    v_add_u32 v9, 0, v2
    v_mul_u32_u24 v8, v8, v9
    v_cvt_f32_u32 v8, v8
    v_mul_f32 v8, 0x3a000000, v8
    v_cos_f32 v17, v8
    v_sin_f32 v21, v8
    v_lshl_add_u32 v8, v3, 2, 2
    v_lshl_add_u32 v8, v4, 4, v8
    v_add_u32 v9, 0, v2
    v_mul_u32_u24 v8, v8, v9
    v_cvt_f32_u32 v8, v8
    v_mul_f32 v8, 0x3a000000, v8
    v_cos_f32 v18, v8
    v_sin_f32 v22, v8
    v_lshl_add_u32 v8, v3, 2, 3
    v_lshl_add_u32 v8, v4, 4, v8
    v_add_u32 v9, 0, v2
    v_mul_u32_u24 v8, v8, v9
    v_cvt_f32_u32 v8, v8
    v_mul_f32 v8, 0x3a000000, v8
    v_cos_f32 v19, v8
    v_sin_f32 v23, v8
    v_lshl_add_u32 v8, v4, 11, v5
    s_mov_b32 s8, 0x9d0a000
    s_mov_b32 s9, 0x9d0c000
    buffer_store_dwordx4 v[16:19], v8, s[4:7], s8 offen sc1
    buffer_store_dwordx4 v[20:23], v8, s[4:7], s9 offen sc1
    s_nop 1
    v_lshl_add_u32 v8, v3, 2, 0
    v_lshl_add_u32 v8, v4, 4, v8
    v_add_u32 v9, 16, v2
    v_mul_u32_u24 v8, v8, v9
    v_cvt_f32_u32 v8, v8
    v_mul_f32 v8, 0x3a000000, v8
    v_cos_f32 v16, v8
    v_sin_f32 v20, v8
    v_lshl_add_u32 v8, v3, 2, 1
    v_lshl_add_u32 v8, v4, 4, v8
    v_add_u32 v9, 16, v2
    v_mul_u32_u24 v8, v8, v9
    v_cvt_f32_u32 v8, v8
    v_mul_f32 v8, 0x3a000000, v8
    v_cos_f32 v17, v8
    v_sin_f32 v21, v8
    v_lshl_add_u32 v8, v3, 2, 2
    v_lshl_add_u32 v8, v4, 4, v8
    v_add_u32 v9, 16, v2
    v_mul_u32_u24 v8, v8, v9
    v_cvt_f32_u32 v8, v8
    v_mul_f32 v8, 0x3a000000, v8
    v_cos_f32 v18, v8
    v_sin_f32 v22, v8
    v_lshl_add_u32 v8, v3, 2, 3
    v_lshl_add_u32 v8, v4, 4, v8
    v_add_u32 v9, 16, v2
    v_mul_u32_u24 v8, v8, v9
    v_cvt_f32_u32 v8, v8
    v_mul_f32 v8, 0x3a000000, v8
    v_cos_f32 v19, v8
    v_sin_f32 v23, v8
    v_lshl_add_u32 v8, v4, 11, v5
    s_mov_b32 s8, 0x9d0a400
    s_mov_b32 s9, 0x9d0c400
    buffer_store_dwordx4 v[16:19], v8, s[4:7], s8 offen sc1
    buffer_store_dwordx4 v[20:23], v8, s[4:7], s9 offen sc1
    s_nop 1
    v_lshl_add_u32 v8, v4, 4, v2
    v_lshl_add_u32 v9, v3, 2, 0
    v_mul_u32_u24 v8, v8, v9
    v_cvt_f32_u32 v8, v8
    v_mul_f32 v8, 0x3a000000, v8
    v_cos_f32 v16, v8
    v_sin_f32 v20, v8
    v_lshl_add_u32 v8, v4, 4, v2
    v_lshl_add_u32 v9, v3, 2, 1
    v_mul_u32_u24 v8, v8, v9
    v_cvt_f32_u32 v8, v8
    v_mul_f32 v8, 0x3a000000, v8
    v_cos_f32 v17, v8
    v_sin_f32 v21, v8
    v_lshl_add_u32 v8, v4, 4, v2
    v_lshl_add_u32 v9, v3, 2, 2
    v_mul_u32_u24 v8, v8, v9
    v_cvt_f32_u32 v8, v8
    v_mul_f32 v8, 0x3a000000, v8
    v_cos_f32 v18, v8
    v_sin_f32 v22, v8
    v_lshl_add_u32 v8, v4, 4, v2
    v_lshl_add_u32 v9, v3, 2, 3
    v_mul_u32_u24 v8, v8, v9
    v_cvt_f32_u32 v8, v8
    v_mul_f32 v8, 0x3a000000, v8
    v_cos_f32 v19, v8
    v_sin_f32 v23, v8
    v_lshl_add_u32 v8, v4, 10, v5
    s_mov_b32 s8, 0x9d0e000
    s_mov_b32 s9, 0x9d10000
    buffer_store_dwordx4 v[16:19], v8, s[4:7], s8 offen sc1
    buffer_store_dwordx4 v[20:23], v8, s[4:7], s9 offen sc1
    s_nop 1
    v_lshl_add_u32 v8, v4, 4, v2
    v_lshl_add_u32 v9, v3, 2, 16
    v_mul_u32_u24 v8, v8, v9
    v_cvt_f32_u32 v8, v8
    v_mul_f32 v8, 0x3a000000, v8
    v_cos_f32 v16, v8
    v_sin_f32 v20, v8
    v_lshl_add_u32 v8, v4, 4, v2
    v_lshl_add_u32 v9, v3, 2, 17
    v_mul_u32_u24 v8, v8, v9
    v_cvt_f32_u32 v8, v8
    v_mul_f32 v8, 0x3a000000, v8
    v_cos_f32 v17, v8
    v_sin_f32 v21, v8
    v_lshl_add_u32 v8, v4, 4, v2
    v_lshl_add_u32 v9, v3, 2, 18
    v_mul_u32_u24 v8, v8, v9
    v_cvt_f32_u32 v8, v8
    v_mul_f32 v8, 0x3a000000, v8
    v_cos_f32 v18, v8
    v_sin_f32 v22, v8
    v_lshl_add_u32 v8, v4, 4, v2
    v_lshl_add_u32 v9, v3, 2, 19
    v_mul_u32_u24 v8, v8, v9
    v_cvt_f32_u32 v8, v8
    v_mul_f32 v8, 0x3a000000, v8
    v_cos_f32 v19, v8
    v_sin_f32 v23, v8
    v_lshl_add_u32 v8, v4, 10, v5
    s_mov_b32 s8, 0x9d0f000
    s_mov_b32 s9, 0x9d11000
    buffer_store_dwordx4 v[16:19], v8, s[4:7], s8 offen sc1
    buffer_store_dwordx4 v[20:23], v8, s[4:7], s9 offen sc1
    s_nop 1
    s_branch Lcend_33
Lcend_33:
    s_nop 1
    s_add_u32 s59, s59, 127
    s_cmp_le_u32 s59, 200
    s_cbranch_scc1 Lcu_18
Lcx_19:
    s_waitcnt vmcnt(0)
    s_barrier
    s_mov_b64 exec, 1
    v_mov_b32 v1, 1
    v_mov_b32 v2, 0
    s_mov_b32 s48, 0x8c27100
    buffer_atomic_add v1, v2, s[4:7], s48 offen
    s_mov_b64 exec, -1
    s_load_dwordx2 s[16:17], s[0:1], 32
    v_and_b32 v1, 63, v0
    v_and_b32 v2, 15, v0
    v_bfe_u32 v3, v0, 4, 2
    v_and_b32 v4, 7, v0
    v_mov_b32 v37, 0xff800000
    v_mov_b32 v44, 0x3f803f80
    v_mov_b32 v48, -1
    v_mov_b32 v45, 0x3f803f80
    v_mov_b32 v49, -1
    v_mov_b32 v46, 0x3f803f80
    v_mov_b32 v50, -1
    v_mov_b32 v47, 0x3f803f80
    v_mov_b32 v51, -1
    s_waitcnt lgkmcnt(0)
    s_mov_b32 s8, s16
    s_and_b32 s9, s17, 0xffff
    s_mov_b32 s10, 0x2800
    s_mov_b32 s11, 0x00020000
    v_mul_u32_u24 v5, 1280, v4
    v_lshl_add_u32 v5, v3, 4, v5
    s_mul_i32 s48, s40, 320
    v_add_u32 v5, s48, v5
    v_add_u32 v213, 256, v5
    v_lshrrev_b32 v6, 3, v2
    v_lshl_add_u32 v212, v6, 6, v5
    s_mul_i32 s48, s40, 2560
    v_lshlrev_b32 v5, 4, v1
    v_add_u32 v9, s48, v5
    v_lshl_add_u32 v6, v3, 3, v4
    v_lshlrev_b32 v6, 4, v6
    s_add_u32 s48, s48, 2048
    v_add_u32 v10, s48, v6
    s_lshl_b32 s49, s38, 2
    s_add_u32 s49, s49, s40
    s_mul_i32 s48, s49, 6144
    v_add_u32 v18, s48, v5
    v_add_u32 v19, 2048, v18
    s_lshl_b32 s48, s49, 13
    v_add_u32 v33, s48, v5
    v_add_u32 v34, 4096, v33
    s_mul_i32 s48, s49, 40960
    s_mul_i32 s43, s39, 2560
    s_add_u32 s48, s48, s43
    v_lshrrev_b32 v7, 3, v2
    v_lshl_add_u32 v35, v7, 9, v6
    v_add_u32 v35, s48, v35
    v_mov_b32 v41, 0x7ff00000
    v_cmp_gt_u32 vcc, 8, v2
    s_nop 1
    v_cndmask_b32 v41, v41, v35, vcc
    s_mul_i32 s48, s40, 3072
    s_add_u32 s43, s48, 65536
    v_add_u32 v11, s43, v5
    s_add_u32 s43, s48, 77824
    v_add_u32 v20, s43, v5
    s_mul_i32 s48, s40, 32
    s_add_u32 s48, s48, 0
    v_add_u32 v5, s48, v1
    v_lshrrev_b32 v6, 6, v5
    v_bfe_u32 v7, v5, 1, 3
    v_bfe_u32 v8, v5, 4, 2
    v_and_b32 v5, 1, v5
    v_lshl_add_u32 v12, v8, 4, v7
    v_lshlrev_b32 v13, 4, v12
    v_lshl_add_u32 v12, v5, 3, v12
    v_lshlrev_b32 v12, 4, v12
    v_lshl_add_u32 v12, v6, 10, v12
    v_add_u32 v12, 65536, v12
    s_and_b32 s48, s39, 3
    s_lshr_b32 s49, s48, 1
    s_lshl_b32 s49, s49, 10
    s_and_b32 s43, s48, 1
    s_lshl_b32 s43, s43, 7
    s_add_u32 s49, s49, s43
    s_mul_i32 s43, s50, 6144
    s_add_u32 s49, s49, s43
    v_add_u32 v13, s49, v13
    v_lshl_add_u32 v13, v5, 3, v13
    v_lshl_add_u32 v13, v6, 11, v13
    s_lshl_b32 s49, s48, 9
    s_lshl_b32 s43, s50, 11
    s_add_u32 s49, s49, s43
    s_add_u32 s49, s49, 0x0
    v_lshl_add_u32 v7, v8, 3, v7
    v_lshlrev_b32 v7, 4, v7
    v_lshl_add_u32 v7, v5, 3, v7
    v_add_u32 v14, s49, v7
    v_mov_b32 v8, 0x7ff00000
    v_cmp_eq_u32 vcc, 0, v6
    s_nop 1
    v_cndmask_b32 v14, v14, v8, vcc
    v_cmp_gt_u32 vcc, 32, v1
    s_nop 1
    v_cndmask_b32 v14, v8, v14, vcc
    v_cndmask_b32 v13, v8, v13, vcc
    v_cndmask_b32 v12, v11, v12, vcc
    s_mul_i32 s48, s40, 16
    s_add_u32 s48, s48, 128
    v_add_u32 v5, s48, v1
    v_lshrrev_b32 v6, 6, v5
    v_bfe_u32 v7, v5, 1, 3
    v_bfe_u32 v8, v5, 4, 2
    v_and_b32 v5, 1, v5
    v_lshl_add_u32 v15, v8, 4, v7
    v_lshlrev_b32 v16, 4, v15
    v_lshl_add_u32 v15, v5, 3, v15
    v_lshlrev_b32 v15, 4, v15
    v_lshl_add_u32 v15, v6, 10, v15
    v_add_u32 v15, 65536, v15
    s_and_b32 s48, s39, 3
    s_lshr_b32 s49, s48, 1
    s_lshl_b32 s49, s49, 10
    s_and_b32 s43, s48, 1
    s_lshl_b32 s43, s43, 7
    s_add_u32 s49, s49, s43
    s_mul_i32 s43, s50, 6144
    s_add_u32 s49, s49, s43
    v_add_u32 v16, s49, v16
    v_lshl_add_u32 v16, v5, 3, v16
    v_lshl_add_u32 v16, v6, 11, v16
    s_lshl_b32 s49, s48, 9
    s_lshl_b32 s43, s50, 11
    s_add_u32 s49, s49, s43
    s_add_u32 s49, s49, 0x400000
    v_lshl_add_u32 v7, v8, 3, v7
    v_lshlrev_b32 v7, 4, v7
    v_lshl_add_u32 v7, v5, 3, v7
    v_add_u32 v17, s49, v7
    v_mov_b32 v8, 0x7ff00000
    v_cmp_eq_u32 vcc, 0, v6
    s_nop 1
    v_cndmask_b32 v17, v17, v8, vcc
    v_cmp_gt_u32 vcc, 16, v1
    s_nop 1
    v_cndmask_b32 v17, v8, v17, vcc
    v_cndmask_b32 v16, v8, v16, vcc
    v_cndmask_b32 v15, v11, v15, vcc
    s_and_b32 s48, s38, 1
    s_cmp_lt_u32 s40, 2
    s_cselect_b32 s48, s40, s48
    v_lshrrev_b32 v6, 3, v1
    v_and_b32 v7, 1, v1
    v_lshl_add_u32 v5, v6, 1, v7
    v_bfe_u32 v7, v1, 1, 2
    s_lshl_b32 s49, s48, 2
    v_add_u32 v7, s49, v7
    v_and_b32 v8, 3, v5
    v_lshl_add_u32 v8, v8, 4, v7
    v_lshlrev_b32 v8, 4, v8
    v_lshrrev_b32 v5, 2, v5
    v_lshl_add_u32 v8, v5, 10, v8
    v_add_u32 v21, 77824, v8
    s_mul_i32 s43, s39, 43
    s_lshr_b32 s43, s43, 8
    s_mul_i32 s49, s39, 1280
    s_mul_i32 s43, s43, 8704
    s_add_u32 s49, s49, s43
    s_mul_i32 s48, s48, 640
    s_add_u32 s48, s48, s49
    v_lshlrev_b32 v5, 4, v1
    v_add_u32 v22, s48, v5
    s_xor_b32 s49, s38, 1
    s_mul_i32 s49, s49, 49152
    v_add_u32 v25, s49, v22
    s_xor_b32 s49, s38, 2
    s_mul_i32 s49, s49, 49152
    v_add_u32 v26, s49, v22
    s_xor_b32 s49, s38, 3
    s_mul_i32 s49, s49, 49152
    v_add_u32 v27, s49, v22
    s_xor_b32 s49, s38, 4
    s_mul_i32 s49, s49, 49152
    v_add_u32 v28, s49, v22
    s_xor_b32 s49, s38, 5
    s_mul_i32 s49, s49, 49152
    v_add_u32 v29, s49, v22
    s_xor_b32 s49, s38, 6
    s_mul_i32 s49, s49, 49152
    v_add_u32 v30, s49, v22
    s_xor_b32 s49, s38, 7
    s_mul_i32 s49, s49, 49152
    v_add_u32 v31, s49, v22
    s_mul_i32 s48, s39, 5
    v_add_u32 v6, s48, v6
    v_lshlrev_b32 v32, 4, v7
    v_and_b32 v7, 1, v1
    v_lshl_add_u32 v32, v7, 3, v32
    v_mul_u32_u24 v7, 205, v6
    v_lshrrev_b32 v7, 12, v7
    v_mul_u32_u24 v8, 20, v7
    v_sub_u32 v6, v6, v8
    v_mul_u32_u24 v7, 2560, v7
    v_add_u32 v32, v32, v7
    v_and_b32 v7, 3, v6
    v_lshrrev_b32 v6, 2, v6
    v_lshrrev_b32 v8, 1, v6
    v_lshl_add_u32 v32, v8, 10, v32
    v_and_b32 v8, 1, v6
    v_lshl_add_u32 v32, v8, 7, v32
    v_lshlrev_b32 v8, 8, v7
    v_lshlrev_b32 v7, 7, v7
    v_cmp_gt_u32 vcc, 4, v6
    s_nop 1
    v_cndmask_b32 v7, v7, v8, vcc
    v_add_u32 v32, v32, v7
    s_lshl_b32 s48, s39, 1
    s_and_b32 s49, s40, 1
    s_add_u32 s48, s48, s49
    s_lshl_b32 s48, s48, 10
    s_lshl_b32 s49, s38, 15
    s_add_u32 s48, s48, s49
    v_lshlrev_b32 v36, 4, v1
    v_add_u32 v36, s48, v36
    s_lshl_b32 s48, s38, 9
    v_and_b32 v5, 3, v1
    v_lshlrev_b32 v5, 7, v5
    v_add_u32 v38, s48, v5
    v_bfe_u32 v5, v1, 2, 1
    v_mul_u32_u24 v5, 0x26180, v5
    v_add_u32 v38, v38, v5
    s_lshl_b32 s48, s50, 7
    v_mov_b32 v39, s48
    v_mov_b32 v5, 0x7ff00000
    v_cmp_eq_u32 vcc, 0, v1
    s_nop 1
    v_cndmask_b32 v39, v5, v39, vcc
    v_mov_b32 v40, 1
    s_add_u32 s101, s4, 0x91fffff
    s_and_b32 s101, s101, 0xffe00000
    s_sub_u32 s101, s101, s4
    s_lshl_b32 s48, s38, 4
    s_add_u32 s48, s48, s39
    s_add_u32 s48, s48, s40
    s_cmp_lg_u32 s48, 0
    s_cbranch_scc1 Lncal_36
    s_mov_b64 exec, 1
    v_mov_b32 v5, 0
    s_mov_b32 s60, 0x7fffffff
    s_mov_b32 s61, 0x7fffffff
    s_add_u32 s48, s101, 0x1c0000
    buffer_store_dword v5, v5, s[4:7], s48 offen sc1
    s_waitcnt vmcnt(0)
    s_memtime s[62:63]
    s_waitcnt lgkmcnt(0)
    buffer_load_dword v6, v5, s[4:7], s48 offen sc1
    s_waitcnt vmcnt(0)
    s_memtime s[64:65]
    s_waitcnt lgkmcnt(0)
    s_sub_u32 s64, s64, s62
    s_min_u32 s60, s60, s64
    s_add_u32 s48, s101, 0x1c2000
    buffer_store_dword v5, v5, s[4:7], s48 offen sc1
    s_waitcnt vmcnt(0)
    s_memtime s[62:63]
    s_waitcnt lgkmcnt(0)
    buffer_load_dword v6, v5, s[4:7], s48 offen sc1
    s_waitcnt vmcnt(0)
    s_memtime s[64:65]
    s_waitcnt lgkmcnt(0)
    s_sub_u32 s64, s64, s62
    s_min_u32 s61, s61, s64
    s_add_u32 s48, s101, 0x1c0000
    buffer_store_dword v5, v5, s[4:7], s48 offen sc1
    s_waitcnt vmcnt(0)
    s_memtime s[62:63]
    s_waitcnt lgkmcnt(0)
    buffer_load_dword v6, v5, s[4:7], s48 offen sc1
    s_waitcnt vmcnt(0)
    s_memtime s[64:65]
    s_waitcnt lgkmcnt(0)
    s_sub_u32 s64, s64, s62
    s_min_u32 s60, s60, s64
    s_add_u32 s48, s101, 0x1c2000
    buffer_store_dword v5, v5, s[4:7], s48 offen sc1
    s_waitcnt vmcnt(0)
    s_memtime s[62:63]
    s_waitcnt lgkmcnt(0)
    buffer_load_dword v6, v5, s[4:7], s48 offen sc1
    s_waitcnt vmcnt(0)
    s_memtime s[64:65]
    s_waitcnt lgkmcnt(0)
    s_sub_u32 s64, s64, s62
    s_min_u32 s61, s61, s64
    s_add_u32 s48, s101, 0x1c0000
    buffer_store_dword v5, v5, s[4:7], s48 offen sc1
    s_waitcnt vmcnt(0)
    s_memtime s[62:63]
    s_waitcnt lgkmcnt(0)
    buffer_load_dword v6, v5, s[4:7], s48 offen sc1
    s_waitcnt vmcnt(0)
    s_memtime s[64:65]
    s_waitcnt lgkmcnt(0)
    s_sub_u32 s64, s64, s62
    s_min_u32 s60, s60, s64
    s_add_u32 s48, s101, 0x1c2000
    buffer_store_dword v5, v5, s[4:7], s48 offen sc1
    s_waitcnt vmcnt(0)
    s_memtime s[62:63]
    s_waitcnt lgkmcnt(0)
    buffer_load_dword v6, v5, s[4:7], s48 offen sc1
    s_waitcnt vmcnt(0)
    s_memtime s[64:65]
    s_waitcnt lgkmcnt(0)
    s_sub_u32 s64, s64, s62
    s_min_u32 s61, s61, s64
    s_add_u32 s48, s101, 0x1c0000
    buffer_store_dword v5, v5, s[4:7], s48 offen sc1
    s_waitcnt vmcnt(0)
    s_memtime s[62:63]
    s_waitcnt lgkmcnt(0)
    buffer_load_dword v6, v5, s[4:7], s48 offen sc1
    s_waitcnt vmcnt(0)
    s_memtime s[64:65]
    s_waitcnt lgkmcnt(0)
    s_sub_u32 s64, s64, s62
    s_min_u32 s60, s60, s64
    s_add_u32 s48, s101, 0x1c2000
    buffer_store_dword v5, v5, s[4:7], s48 offen sc1
    s_waitcnt vmcnt(0)
    s_memtime s[62:63]
    s_waitcnt lgkmcnt(0)
    buffer_load_dword v6, v5, s[4:7], s48 offen sc1
    s_waitcnt vmcnt(0)
    s_memtime s[64:65]
    s_waitcnt lgkmcnt(0)
    s_sub_u32 s64, s64, s62
    s_min_u32 s61, s61, s64
    s_add_u32 s48, s101, 0x1c0000
    buffer_store_dword v5, v5, s[4:7], s48 offen sc1
    s_waitcnt vmcnt(0)
    s_memtime s[62:63]
    s_waitcnt lgkmcnt(0)
    buffer_load_dword v6, v5, s[4:7], s48 offen sc1
    s_waitcnt vmcnt(0)
    s_memtime s[64:65]
    s_waitcnt lgkmcnt(0)
    s_sub_u32 s64, s64, s62
    s_min_u32 s60, s60, s64
    s_add_u32 s48, s101, 0x1c2000
    buffer_store_dword v5, v5, s[4:7], s48 offen sc1
    s_waitcnt vmcnt(0)
    s_memtime s[62:63]
    s_waitcnt lgkmcnt(0)
    buffer_load_dword v6, v5, s[4:7], s48 offen sc1
    s_waitcnt vmcnt(0)
    s_memtime s[64:65]
    s_waitcnt lgkmcnt(0)
    s_sub_u32 s64, s64, s62
    s_min_u32 s61, s61, s64
    s_add_u32 s48, s101, 0x1c0000
    buffer_store_dword v5, v5, s[4:7], s48 offen sc1
    s_waitcnt vmcnt(0)
    s_memtime s[62:63]
    s_waitcnt lgkmcnt(0)
    buffer_load_dword v6, v5, s[4:7], s48 offen sc1
    s_waitcnt vmcnt(0)
    s_memtime s[64:65]
    s_waitcnt lgkmcnt(0)
    s_sub_u32 s64, s64, s62
    s_min_u32 s60, s60, s64
    s_add_u32 s48, s101, 0x1c2000
    buffer_store_dword v5, v5, s[4:7], s48 offen sc1
    s_waitcnt vmcnt(0)
    s_memtime s[62:63]
    s_waitcnt lgkmcnt(0)
    buffer_load_dword v6, v5, s[4:7], s48 offen sc1
    s_waitcnt vmcnt(0)
    s_memtime s[64:65]
    s_waitcnt lgkmcnt(0)
    s_sub_u32 s64, s64, s62
    s_min_u32 s61, s61, s64
    s_cmp_le_u32 s60, s61
    s_cselect_b32 s48, 1, 2
    v_mov_b32 v6, s48
    s_mov_b32 s48, 0x8c37180
    buffer_store_dword v6, v5, s[4:7], s48 offen sc1
    s_mov_b64 exec, -1
Lncal_36:
    v_mov_b32 v5, 0
    s_mov_b32 s49, 0x8c37180
    s_mov_b32 s43, 0
Lpp_37:
    buffer_load_dword v6, v5, s[4:7], s49 offen sc1
    s_waitcnt vmcnt(0)
    v_cmp_eq_u32 vcc, 0, v6
    s_cbranch_vccz Lppd_38
    s_sleep 4
    s_add_u32 s43, s43, 1
    s_cmp_lt_u32 s43, 400000
    s_cbranch_scc1 Lpp_37
    s_mov_b32 s48, 6
    s_branch Lfail_2
Lppd_38:
    v_cmp_eq_u32 vcc, 2, v6
    s_cmp_lg_u64 vcc, 0
    s_cselect_b32 s48, 8192, 0
    s_add_u32 s101, s101, s48
    s_mov_b32 s41, 0
    s_lshl_b32 s49, s41, 12
    s_add_u32 s49, s49, 0x8c01000
    s_mov_b32 s43, 0
Lkf_39:
    buffer_load_dword v5, v38, s[4:7], s49 offen sc1
    s_waitcnt vmcnt(0)
    v_cmp_eq_u32 vcc, 0, v5
    s_cbranch_vccz Lkfd_40
    s_sleep 4
    s_add_u32 s43, s43, 1
    s_cmp_lt_u32 s43, 400000
    s_cbranch_scc1 Lkf_39
    s_mov_b32 s48, 5
    s_branch Lfail_2
Lkfd_40:
    s_mov_b32 s44, 0x7200000
    s_mov_b32 s47, 0x0
    s_mov_b32 s51, 0x2000000
    buffer_load_dwordx4 a[168:171], v33, s[4:7], s47 offen offset:0
    buffer_load_dwordx4 a[172:175], v33, s[4:7], s47 offen offset:1024
    buffer_load_dwordx4 a[176:179], v33, s[4:7], s47 offen offset:2048
    buffer_load_dwordx4 a[180:183], v33, s[4:7], s47 offen offset:3072
    buffer_load_dwordx4 a[184:187], v34, s[4:7], s47 offen offset:0
    buffer_load_dwordx4 a[188:191], v34, s[4:7], s47 offen offset:1024
    buffer_load_dwordx4 a[192:195], v34, s[4:7], s47 offen offset:2048
    buffer_load_dwordx4 a[196:199], v34, s[4:7], s47 offen offset:3072
    buffer_load_dwordx4 a[212:215], v35, s[4:7], s51 offen offset:0
    buffer_load_dwordx4 a[216:219], v35, s[4:7], s51 offen offset:1024
    buffer_load_dwordx4 a[220:223], v41, s[4:7], s51 offen offset:2048
    s_and_b32 s48, s41, 3
    s_add_u32 s49, s41, 3
    s_and_b32 s49, s49, 3
    s_mul_i32 s90, s48, 196608
    s_add_u32 s90, s90, 0x8e00000
    s_mul_i32 s93, s49, 196608
    s_add_u32 s93, s93, 0x8e00000
    s_mul_i32 s91, s48, 393216
    s_add_u32 s91, s91, s101
    s_add_u32 s94, s41, 2
    s_and_b32 s94, s94, 3
    s_mul_i32 s94, s94, 393216
    s_add_u32 s94, s94, s101
    s_mul_i32 s43, s38, 49152
    s_add_u32 s94, s94, s43
    s_add_u32 s45, s91, s43
    s_lshr_b32 s43, s38, 1
    s_mul_i32 s43, s43, 10240
    s_add_u32 s43, s43, 0x8f00000
    s_mul_i32 s95, s49, 81920
    s_add_u32 s95, s95, s43
    s_add_u32 s48, s41, 1
    s_and_b32 s48, s48, 3
    s_mul_i32 s92, s48, 81920
    s_add_u32 s92, s92, s43
    s_add_u32 s47, s47, 262144
    s_add_u32 s51, s51, 1310720
    s_add_u32 s96, s47, 262144
    s_min_u32 s96, s96, 16515072
    buffer_load_dwordx4 v[60:63], v212, s[8:11], 0 offen
    buffer_load_dwordx4 v[64:67], v212, s[8:11], 0 offen offset:128
    buffer_load_dwordx4 v[68:71], v213, s[8:11], 0 offen
    s_waitcnt vmcnt(0)
Lloop_41:
    v_mfma_f32_16x16x32_bf16 v[80:83], a[0:3], v[60:63], 0
    v_mov_b32_dpp v72, v60 row_ror:8 row_mask:0xf bank_mask:0xf
    v_mov_b32_dpp v73, v61 row_ror:8 row_mask:0xf bank_mask:0xf
    v_mfma_f32_16x16x32_bf16 v[84:87], a[20:23], v[60:63], 0
    v_mov_b32_dpp v74, v62 row_ror:8 row_mask:0xf bank_mask:0xf
    v_mov_b32_dpp v75, v63 row_ror:8 row_mask:0xf bank_mask:0xf
    v_mfma_f32_16x16x32_bf16 v[88:91], a[40:43], v[60:63], 0
    v_mov_b32_dpp v76, v64 row_ror:8 row_mask:0xf bank_mask:0xf
    v_mov_b32_dpp v77, v65 row_ror:8 row_mask:0xf bank_mask:0xf
    v_mfma_f32_16x16x32_bf16 v[92:95], a[60:63], v[60:63], 0
    v_mov_b32_dpp v78, v66 row_ror:8 row_mask:0xf bank_mask:0xf
    v_mov_b32_dpp v79, v67 row_ror:8 row_mask:0xf bank_mask:0xf
    v_mfma_f32_16x16x32_bf16 v[80:83], a[8:11], v[64:67], v[80:83]
    v_accvgpr_mov_b32 a200, a212
    v_accvgpr_mov_b32 a201, a213
    v_mfma_f32_16x16x32_bf16 v[84:87], a[28:31], v[64:67], v[84:87]
    v_accvgpr_mov_b32 a202, a214
    v_accvgpr_mov_b32 a203, a215
    v_mfma_f32_16x16x32_bf16 v[88:91], a[48:51], v[64:67], v[88:91]
    v_accvgpr_mov_b32 a204, a216
    v_accvgpr_mov_b32 a205, a217
    v_mfma_f32_16x16x32_bf16 v[92:95], a[68:71], v[64:67], v[92:95]
    v_accvgpr_mov_b32 a206, a218
    v_accvgpr_mov_b32 a207, a219
    v_mfma_f32_16x16x32_bf16 v[80:83], a[4:7], v[72:75], v[80:83]
    v_accvgpr_mov_b32 a208, a220
    v_accvgpr_mov_b32 a209, a221
    v_mfma_f32_16x16x32_bf16 v[84:87], a[24:27], v[72:75], v[84:87]
    v_accvgpr_mov_b32 a210, a222
    v_accvgpr_mov_b32 a211, a223
    v_mfma_f32_16x16x32_bf16 v[88:91], a[44:47], v[72:75], v[88:91]
    v_mfma_f32_16x16x32_bf16 v[92:95], a[64:67], v[72:75], v[92:95]
    v_mfma_f32_16x16x32_bf16 v[80:83], a[12:15], v[76:79], v[80:83]
    v_mfma_f32_16x16x32_bf16 v[80:83], a[16:19], v[68:71], v[80:83]
    v_mfma_f32_16x16x32_bf16 v[84:87], a[32:35], v[76:79], v[84:87]
    v_mfma_f32_16x16x32_bf16 v[84:87], a[36:39], v[68:71], v[84:87]
    v_mfma_f32_16x16x32_bf16 v[88:91], a[52:55], v[76:79], v[88:91]
    v_mfma_f32_16x16x32_bf16 v[88:91], a[56:59], v[68:71], v[88:91]
    v_mfma_f32_16x16x32_bf16 v[92:95], a[72:75], v[76:79], v[92:95]
    v_mfma_f32_16x16x32_bf16 v[92:95], a[76:79], v[68:71], v[92:95]
    s_nop 3
    v_mov_b32_dpp v80, v84 row_ror:8 row_mask:0xf bank_mask:0xc
    v_mov_b32_dpp v81, v85 row_ror:8 row_mask:0xf bank_mask:0xc
    v_mov_b32_dpp v82, v86 row_ror:8 row_mask:0xf bank_mask:0xc
    v_mov_b32_dpp v83, v87 row_ror:8 row_mask:0xf bank_mask:0xc
    ds_write_b128 v11, v[80:83] offset:0
    v_mov_b32_dpp v88, v92 row_ror:8 row_mask:0xf bank_mask:0xc
    v_mov_b32_dpp v89, v93 row_ror:8 row_mask:0xf bank_mask:0xc
    v_mov_b32_dpp v90, v94 row_ror:8 row_mask:0xf bank_mask:0xc
    v_mov_b32_dpp v91, v95 row_ror:8 row_mask:0xf bank_mask:0xc
    ds_write_b128 v11, v[88:91] offset:1024
    s_waitcnt lgkmcnt(0)
    s_barrier
    ds_read_b128 v[212:215], v12 offset:0
    ds_read_b128 v[216:219], v12 offset:3072
    ds_read_b128 v[220:223], v12 offset:6144
    ds_read_b128 v[224:227], v12 offset:9216
    s_waitcnt lgkmcnt(2)
    v_pk_add_f32 v[212:213], v[212:213], v[216:217]
    v_pk_add_f32 v[214:215], v[214:215], v[218:219]
    s_waitcnt lgkmcnt(0)
    v_pk_add_f32 v[220:221], v[220:221], v[224:225]
    v_pk_add_f32 v[222:223], v[222:223], v[226:227]
    v_pk_add_f32 v[212:213], v[212:213], v[220:221]
    v_pk_add_f32 v[214:215], v[214:215], v[222:223]
    v_cvt_pk_bf16_f32 v56, v212, v213
    v_cvt_pk_bf16_f32 v57, v214, v215
    v_min_u32 v56, 0xfffffffe, v56
    v_min_u32 v57, 0xfffffffe, v57
    s_cmp_lg_u32 s42, 0
    s_cbranch_scc1 Lsl_42
    buffer_store_dwordx2 v[56:57], v13, s[4:7], s90 offen
    s_branch Lsl_43
Lsl_42:
    buffer_store_dwordx2 v[56:57], v13, s[4:7], s90 offen sc1
Lsl_43:
    v_mfma_f32_16x16x32_bf16 v[96:99], a[80:83], v[60:63], 0
    v_mfma_f32_16x16x32_bf16 v[100:103], a[100:103], v[60:63], 0
    v_mfma_f32_16x16x32_bf16 v[96:99], a[84:87], v[72:75], v[96:99]
    v_mfma_f32_16x16x32_bf16 v[100:103], a[104:107], v[72:75], v[100:103]
    v_mfma_f32_16x16x32_bf16 v[96:99], a[88:91], v[64:67], v[96:99]
    v_mfma_f32_16x16x32_bf16 v[100:103], a[108:111], v[64:67], v[100:103]
    v_mfma_f32_16x16x32_bf16 v[96:99], a[92:95], v[76:79], v[96:99]
    v_mfma_f32_16x16x32_bf16 v[100:103], a[112:115], v[76:79], v[100:103]
    v_mfma_f32_16x16x32_bf16 v[96:99], a[96:99], v[68:71], v[96:99]
    v_mfma_f32_16x16x32_bf16 v[100:103], a[116:119], v[68:71], v[100:103]
    s_nop 7
    v_mov_b32_dpp v96, v100 row_ror:8 row_mask:0xf bank_mask:0xc
    v_mov_b32_dpp v97, v101 row_ror:8 row_mask:0xf bank_mask:0xc
    v_mov_b32_dpp v98, v102 row_ror:8 row_mask:0xf bank_mask:0xc
    v_mov_b32_dpp v99, v103 row_ror:8 row_mask:0xf bank_mask:0xc
    ds_write_b128 v11, v[96:99] offset:2048
    buffer_load_dwordx4 v[104:107], v18, s[4:7], s90 offen sc1
    buffer_load_dwordx4 v[108:111], v18, s[4:7], s90 offen offset:1024 sc1
    buffer_load_dwordx4 v[120:123], v19, s[4:7], s90 offen offset:0 sc1
    buffer_load_dwordx4 v[128:131], v19, s[4:7], s90 offen offset:1024 sc1
    s_waitcnt lgkmcnt(0)
    s_barrier
    ds_read_b128 v[212:215], v15 offset:0
    ds_read_b128 v[216:219], v15 offset:3072
    ds_read_b128 v[220:223], v15 offset:6144
    ds_read_b128 v[224:227], v15 offset:9216
    s_waitcnt lgkmcnt(2)
    v_pk_add_f32 v[212:213], v[212:213], v[216:217]
    v_pk_add_f32 v[214:215], v[214:215], v[218:219]
    s_waitcnt lgkmcnt(0)
    v_pk_add_f32 v[220:221], v[220:221], v[224:225]
    v_pk_add_f32 v[222:223], v[222:223], v[226:227]
    v_pk_add_f32 v[212:213], v[212:213], v[220:221]
    v_pk_add_f32 v[214:215], v[214:215], v[222:223]
    v_cvt_pk_bf16_f32 v58, v212, v213
    v_cvt_pk_bf16_f32 v59, v214, v215
    v_min_u32 v58, 0xfffffffe, v58
    v_min_u32 v59, 0xfffffffe, v59
    s_cmp_eq_u32 s41, 63
    s_cbranch_scc1 Lfin_44
    s_cmp_lg_u32 s42, 0
    s_cbranch_scc1 Lsl_45
    buffer_store_dwordx2 v[58:59], v16, s[4:7], s90 offen
    s_branch Lsl_46
Lsl_45:
    buffer_store_dwordx2 v[58:59], v16, s[4:7], s90 offen sc1
Lsl_46:
    s_mov_b32 s43, 0
    s_waitcnt vmcnt(3)
    v_max3_u32 v5, v104, v105, v106
    v_max3_u32 v5, v5, v107, v108
    v_max3_u32 v5, v5, v109, v110
    v_max_u32 v5, v5, v111
    v_cmp_eq_u32 vcc, -1, v5
    s_cbranch_vccz Lpad_48
Lpa_47:
    buffer_load_dwordx4 v[104:107], v18, s[4:7], s90 offen sc1
    buffer_load_dwordx4 v[108:111], v18, s[4:7], s90 offen offset:1024 sc1
    buffer_load_dwordx4 v[120:123], v19, s[4:7], s90 offen offset:0 sc1
    buffer_load_dwordx4 v[128:131], v19, s[4:7], s90 offen offset:1024 sc1
    s_waitcnt vmcnt(0)
    v_max3_u32 v5, v104, v105, v106
    v_max3_u32 v5, v5, v107, v108
    v_max3_u32 v5, v5, v109, v110
    v_max_u32 v5, v5, v111
    v_cmp_eq_u32 vcc, -1, v5
    s_cbranch_vccz Lpad_48
    s_add_u32 s43, s43, 1
    s_cmp_lt_u32 s43, 400000
    s_cbranch_scc1 Lpa_47
    s_mov_b32 s48, 1
    s_branch Lfail_2
Lpad_48:
    v_mfma_f32_16x16x32_bf16 v[152:155], a[168:171], v[104:107], 0
    v_mov_b32_dpp v112, v104 row_ror:8 row_mask:0xf bank_mask:0xf
    v_mov_b32_dpp v113, v105 row_ror:8 row_mask:0xf bank_mask:0xf
    v_mov_b32_dpp v114, v106 row_ror:8 row_mask:0xf bank_mask:0xf
    v_mov_b32_dpp v115, v107 row_ror:8 row_mask:0xf bank_mask:0xf
    v_mfma_f32_16x16x32_bf16 v[156:159], a[184:187], v[104:107], 0
    v_mov_b32_dpp v116, v108 row_ror:8 row_mask:0xf bank_mask:0xf
    v_mov_b32_dpp v117, v109 row_ror:8 row_mask:0xf bank_mask:0xf
    v_mov_b32_dpp v118, v110 row_ror:8 row_mask:0xf bank_mask:0xf
    v_mov_b32_dpp v119, v111 row_ror:8 row_mask:0xf bank_mask:0xf
    s_mov_b32 s43, 0
    s_waitcnt vmcnt(1)
Lkv_49:
    v_max3_u32 v5, v120, v121, v122
    v_max3_u32 v5, v5, v123, v128
    v_max3_u32 v5, v5, v129, v130
    v_max_u32 v5, v5, v131
    v_cmp_eq_u32 vcc, -1, v5
    s_cbranch_vccz Lkvd_50
    buffer_load_dwordx4 v[120:123], v19, s[4:7], s90 offen offset:0 sc1
    buffer_load_dwordx4 v[128:131], v19, s[4:7], s90 offen offset:1024 sc1
    s_waitcnt vmcnt(0)
    s_add_u32 s43, s43, 1
    s_cmp_lt_u32 s43, 400000
    s_cbranch_scc1 Lkv_49
    s_mov_b32 s48, 2
    s_branch Lfail_2
Lkvd_50:
    v_mfma_f32_16x16x32_bf16 v[160:163], v[120:123], v[104:107], 0
    v_mov_b32_dpp v124, v120 row_ror:8 row_mask:0xf bank_mask:0xf
    v_mov_b32_dpp v125, v121 row_ror:8 row_mask:0xf bank_mask:0xf
    v_mov_b32_dpp v126, v122 row_ror:8 row_mask:0xf bank_mask:0xf
    v_mov_b32_dpp v127, v123 row_ror:8 row_mask:0xf bank_mask:0xf
    v_mfma_f32_16x16x32_bf16 v[152:155], a[176:179], v[108:111], v[152:155]
    v_mfma_f32_16x16x32_bf16 v[156:159], a[192:195], v[108:111], v[156:159]
    v_mfma_f32_16x16x32_bf16 v[160:163], v[128:131], v[108:111], v[160:163]
    v_mov_b32_dpp v132, v128 row_ror:8 row_mask:0xf bank_mask:0xf
    v_mov_b32_dpp v133, v129 row_ror:8 row_mask:0xf bank_mask:0xf
    v_mov_b32_dpp v134, v130 row_ror:8 row_mask:0xf bank_mask:0xf
    v_mov_b32_dpp v135, v131 row_ror:8 row_mask:0xf bank_mask:0xf
    v_mfma_f32_16x16x32_bf16 v[152:155], a[172:175], v[112:115], v[152:155]
    v_mfma_f32_16x16x32_bf16 v[156:159], a[188:191], v[112:115], v[156:159]
    v_mfma_f32_16x16x32_bf16 v[160:163], v[124:127], v[112:115], v[160:163]
    v_mfma_f32_16x16x32_bf16 v[152:155], a[180:183], v[116:119], v[152:155]
    v_mfma_f32_16x16x32_bf16 v[156:159], a[196:199], v[116:119], v[156:159]
    v_mfma_f32_16x16x32_bf16 v[160:163], v[132:135], v[116:119], v[160:163]
    buffer_load_dwordx4 v[136:139], v19, s[4:7], s90 offen offset:2048 sc1
    buffer_load_dwordx4 v[144:147], v19, s[4:7], s90 offen offset:3072 sc1
    s_nop 4
    v_max3_f32 v192, v152, v153, v154
    v_max3_f32 v192, v192, v155, v156
    v_max3_f32 v192, v192, v157, v158
    v_cndmask_b32 v160, v37, v160, s[54:55]
    v_cndmask_b32 v161, v37, v161, s[54:55]
    v_cndmask_b32 v162, v37, v162, s[54:55]
    v_cndmask_b32 v163, v37, v163, s[54:55]
    v_max3_f32 v192, v192, v159, v160
    v_max3_f32 v192, v192, v161, v162
    v_max_f32 v192, v192, v163
    v_mov_b32 v193, v192
    s_nop 1
    v_permlane16_swap_b32 v192, v193
    s_nop 0
    v_max_f32 v192, v192, v193
    v_mov_b32 v193, v192
    s_nop 1
    v_permlane32_swap_b32 v192, v193
    s_nop 0
    v_max_f32 v192, v192, v193
    v_mul_f32 v192, s58, v192
    v_fma_f32 v152, v152, s58, -v192
    v_fma_f32 v153, v153, s58, -v192
    v_fma_f32 v154, v154, s58, -v192
    v_fma_f32 v155, v155, s58, -v192
    v_fma_f32 v156, v156, s58, -v192
    v_fma_f32 v157, v157, s58, -v192
    v_fma_f32 v158, v158, s58, -v192
    v_fma_f32 v159, v159, s58, -v192
    v_fma_f32 v160, v160, s58, -v192
    v_fma_f32 v161, v161, s58, -v192
    v_fma_f32 v162, v162, s58, -v192
    v_fma_f32 v163, v163, s58, -v192
    v_exp_f32 v152, v152
    v_exp_f32 v153, v153
    v_exp_f32 v154, v154
    v_exp_f32 v155, v155
    s_mov_b32 s43, 0
Lv_51:
    s_waitcnt vmcnt(0)
    v_max3_u32 v5, v136, v137, v138
    v_max3_u32 v5, v5, v139, v144
    v_max3_u32 v5, v5, v145, v146
    v_max_u32 v5, v5, v147
    v_cmp_eq_u32 vcc, -1, v5
    s_cbranch_vccz Lvd_52
    buffer_load_dwordx4 v[136:139], v19, s[4:7], s90 offen offset:2048 sc1
    buffer_load_dwordx4 v[144:147], v19, s[4:7], s90 offen offset:3072 sc1
    s_add_u32 s43, s43, 1
    s_cmp_lt_u32 s43, 400000
    s_cbranch_scc1 Lv_51
    s_mov_b32 s48, 2
    s_branch Lfail_2
Lvd_52:
    v_mfma_f32_16x16x32_bf16 v[164:167], v[136:139], a[120:123], 0
    v_mov_b32_dpp v140, v136 row_ror:8 row_mask:0xf bank_mask:0xf
    v_mov_b32_dpp v141, v137 row_ror:8 row_mask:0xf bank_mask:0xf
    v_mfma_f32_16x16x32_bf16 v[168:171], v[136:139], a[136:139], 0
    v_mov_b32_dpp v142, v138 row_ror:8 row_mask:0xf bank_mask:0xf
    v_mov_b32_dpp v143, v139 row_ror:8 row_mask:0xf bank_mask:0xf
    v_mfma_f32_16x16x32_bf16 v[172:175], v[136:139], a[152:155], 0
    v_mov_b32_dpp v148, v144 row_ror:8 row_mask:0xf bank_mask:0xf
    v_mov_b32_dpp v149, v145 row_ror:8 row_mask:0xf bank_mask:0xf
    v_mfma_f32_16x16x32_bf16 v[164:167], v[144:147], a[128:131], v[164:167]
    v_mov_b32_dpp v150, v146 row_ror:8 row_mask:0xf bank_mask:0xf
    v_mov_b32_dpp v151, v147 row_ror:8 row_mask:0xf bank_mask:0xf
    v_mfma_f32_16x16x32_bf16 v[168:171], v[144:147], a[144:147], v[168:171]
    v_exp_f32 v156, v156
    v_exp_f32 v157, v157
    v_mfma_f32_16x16x32_bf16 v[172:175], v[144:147], a[160:163], v[172:175]
    v_exp_f32 v158, v158
    v_exp_f32 v159, v159
    v_mfma_f32_16x16x32_bf16 v[164:167], v[140:143], a[124:127], v[164:167]
    v_exp_f32 v160, v160
    v_exp_f32 v161, v161
    v_mfma_f32_16x16x32_bf16 v[168:171], v[140:143], a[140:143], v[168:171]
    v_exp_f32 v162, v162
    v_exp_f32 v163, v163
    v_mfma_f32_16x16x32_bf16 v[172:175], v[140:143], a[156:159], v[172:175]
    s_nop 0
    v_cvt_pk_bf16_f32 v184, v152, v153
    v_mfma_f32_16x16x32_bf16 v[164:167], v[148:151], a[132:135], v[164:167]
    v_cvt_pk_bf16_f32 v185, v154, v155
    v_cvt_pk_bf16_f32 v186, v156, v157
    v_mfma_f32_16x16x32_bf16 v[168:171], v[148:151], a[148:151], v[168:171]
    v_cvt_pk_bf16_f32 v187, v158, v159
    v_cvt_pk_bf16_f32 v190, v160, v161
    v_mfma_f32_16x16x32_bf16 v[172:175], v[148:151], a[164:167], v[172:175]
    v_cvt_pk_bf16_f32 v191, v162, v163
    v_mfma_f32_16x16x32_bf16 v[196:199], v[44:47], v[184:187], 0
    v_mfma_f32_16x16x32_bf16 v[200:203], a[200:203], v[184:187], 0
    buffer_load_dwordx4 a[212:215], v35, s[4:7], s51 offen offset:0
    v_mfma_f32_16x16x32_bf16 v[204:207], a[204:207], v[184:187], 0
    buffer_load_dwordx4 a[216:219], v35, s[4:7], s51 offen offset:1024
    v_mfma_f32_16x16x32_bf16 v[208:211], a[208:211], v[184:187], 0
    buffer_load_dwordx4 a[220:223], v41, s[4:7], s51 offen offset:2048
    v_mfma_f32_16x16x16_bf16 v[196:199], v[44:45], v[190:191], v[196:199]
    buffer_load_dwordx4 a[168:171], v33, s[4:7], s47 offen offset:0
    buffer_load_dwordx4 a[172:175], v33, s[4:7], s47 offen offset:1024
    v_cvt_pk_bf16_f32 v176, v164, v165
    v_cvt_pk_bf16_f32 v177, v166, v167
    v_cvt_pk_bf16_f32 v178, v168, v169
    v_cvt_pk_bf16_f32 v179, v170, v171
    v_cvt_pk_bf16_f32 v180, v172, v173
    v_cvt_pk_bf16_f32 v181, v174, v175
    buffer_load_dwordx4 a[176:179], v33, s[4:7], s47 offen offset:2048
    v_rcp_f32 v194, v196
    v_mfma_f32_16x16x16_bf16 v[200:203], v[176:177], v[190:191], v[200:203]
    v_mfma_f32_16x16x16_bf16 v[204:207], v[178:179], v[190:191], v[204:207]
    v_mfma_f32_16x16x16_bf16 v[208:211], v[180:181], v[190:191], v[208:211]
    v_mov_b32 v195, v194
    buffer_load_dwordx4 a[180:183], v33, s[4:7], s47 offen offset:3072
    buffer_load_dwordx4 a[184:187], v34, s[4:7], s47 offen offset:0
    buffer_load_dwordx4 a[188:191], v34, s[4:7], s47 offen offset:1024
    buffer_load_dwordx4 a[192:195], v34, s[4:7], s47 offen offset:2048
    buffer_load_dwordx4 a[196:199], v34, s[4:7], s47 offen offset:3072
    s_nop 0
    v_pk_mul_f32 v[200:201], v[200:201], v[194:195]
    v_pk_mul_f32 v[202:203], v[202:203], v[194:195]
    ds_write_b128 v20, v[200:203] offset:0
    v_pk_mul_f32 v[204:205], v[204:205], v[194:195]
    v_pk_mul_f32 v[206:207], v[206:207], v[194:195]
    ds_write_b128 v20, v[204:207] offset:1024
    v_pk_mul_f32 v[208:209], v[208:209], v[194:195]
    v_pk_mul_f32 v[210:211], v[210:211], v[194:195]
    ds_write_b128 v20, v[208:211] offset:2048
    s_waitcnt lgkmcnt(0)
    s_barrier
    s_mov_b32 exec_hi, 0xff
    ds_read_b128 v[212:215], v21 offset:0
    ds_read_b128 v[216:219], v21 offset:3072
    ds_read_b128 v[220:223], v21 offset:6144
    ds_read_b128 v[224:227], v21 offset:9216
    s_waitcnt lgkmcnt(2)
    v_add_f32 v212, v212, v216
    v_add_f32 v213, v213, v217
    v_add_f32 v214, v214, v218
    v_add_f32 v215, v215, v219
    s_waitcnt lgkmcnt(0)
    v_add_f32 v220, v220, v224
    v_add_f32 v221, v221, v225
    v_add_f32 v222, v222, v226
    v_add_f32 v223, v223, v227
    v_add_f32 v212, v212, v220
    v_add_f32 v213, v213, v221
    v_add_f32 v214, v214, v222
    v_add_f32 v215, v215, v223
    s_cmp_ge_u32 s40, 2
    s_cbranch_scc1 Lpw_53
    v_min_u32 v212, 0xfffffffe, v212
    v_min_u32 v213, 0xfffffffe, v213
    v_min_u32 v214, 0xfffffffe, v214
    v_min_u32 v215, 0xfffffffe, v215
    buffer_store_dwordx4 v[212:215], v22, s[4:7], s45 offen sc1
    s_mov_b64 exec, -1
    buffer_store_dwordx2 v[56:57], v14, s[4:7], s44 offen sc1
    buffer_store_dwordx2 v[58:59], v17, s[4:7], s44 offen sc1
    s_and_b32 s48, s41, 3
    s_cmp_lg_u32 s48, 0
    s_cbranch_scc1 Lns_55
    s_cmp_eq_u32 s41, 0
    s_cbranch_scc1 Lns_55
    s_lshr_b32 s48, s41, 2
    s_sub_u32 s48, s48, 1
    s_lshl_b32 s49, s48, 12
    s_add_u32 s49, s49, 0x8c11000
    buffer_atomic_add v40, v39, s[4:7], s49 offen
Lns_55:
    s_cmp_lg_u32 s41, 62
    s_cbranch_scc1 Lns_56
    s_mov_b32 s48, 16
    s_lshl_b32 s49, s48, 12
    s_add_u32 s49, s49, 0x8c11000
    buffer_atomic_add v40, v39, s[4:7], s49 offen
Lns_56:
    s_cmp_lg_u32 s42, 0
    s_cbranch_scc1 Lsl_57
    buffer_store_dwordx2 v[48:49], v13, s[4:7], s93 offen
    s_branch Lsl_58
Lsl_57:
    buffer_store_dwordx2 v[48:49], v13, s[4:7], s93 offen sc1
Lsl_58:
    s_cmp_lg_u32 s42, 0
    s_cbranch_scc1 Lsl_59
    buffer_store_dwordx2 v[48:49], v16, s[4:7], s93 offen
    s_branch Lsl_60
Lsl_59:
    buffer_store_dwordx2 v[48:49], v16, s[4:7], s93 offen sc1
Lsl_60:
    s_mov_b32 exec_hi, 0xff
    buffer_store_dwordx4 v[48:51], v22, s[4:7], s94 offen sc1
    s_mov_b64 exec, -1
    buffer_load_dwordx4 v[52:55], v36, s[4:7], s96 offen
    s_sleep 24
    s_branch Lcdone_54
Lpw_53:
    s_cmp_eq_u32 s40, 3
    s_cbranch_scc1 Lw3_61
    s_mov_b64 exec, -1
    buffer_store_dwordx2 v[56:57], v14, s[4:7], s44 offen sc1
    buffer_store_dwordx2 v[58:59], v17, s[4:7], s44 offen sc1
    s_and_b32 s48, s41, 3
    s_cmp_lg_u32 s48, 0
    s_cbranch_scc1 Lns_62
    s_cmp_eq_u32 s41, 0
    s_cbranch_scc1 Lns_62
    s_lshr_b32 s48, s41, 2
    s_sub_u32 s48, s48, 1
    s_lshl_b32 s49, s48, 12
    s_add_u32 s49, s49, 0x8c11000
    buffer_atomic_add v40, v39, s[4:7], s49 offen
Lns_62:
    s_cmp_lg_u32 s41, 62
    s_cbranch_scc1 Lns_63
    s_mov_b32 s48, 16
    s_lshl_b32 s49, s48, 12
    s_add_u32 s49, s49, 0x8c11000
    buffer_atomic_add v40, v39, s[4:7], s49 offen
Lns_63:
    s_cmp_lg_u32 s42, 0
    s_cbranch_scc1 Lsl_64
    buffer_store_dwordx2 v[48:49], v13, s[4:7], s93 offen
    s_branch Lsl_65
Lsl_64:
    buffer_store_dwordx2 v[48:49], v13, s[4:7], s93 offen sc1
Lsl_65:
    s_cmp_lg_u32 s42, 0
    s_cbranch_scc1 Lsl_66
    buffer_store_dwordx2 v[48:49], v16, s[4:7], s93 offen
    s_branch Lsl_67
Lsl_66:
    buffer_store_dwordx2 v[48:49], v16, s[4:7], s93 offen sc1
Lsl_67:
    s_mov_b32 exec_hi, 0xff
    s_cmp_lg_u32 s42, 0
    s_cbranch_scc1 Lsl_68
    buffer_store_dwordx2 v[48:49], v32, s[4:7], s95 offen
    s_branch Lsl_69
Lsl_68:
    buffer_store_dwordx2 v[48:49], v32, s[4:7], s95 offen sc1
Lsl_69:
    s_mov_b32 s59, s91
    s_add_u32 s41, s41, 1
    s_add_u32 s44, s44, 65536
    s_mov_b32 s46, s92
    s_and_b32 s48, s41, 3
    s_add_u32 s49, s41, 3
    s_and_b32 s49, s49, 3
    s_mul_i32 s90, s48, 196608
    s_add_u32 s90, s90, 0x8e00000
    s_mul_i32 s93, s49, 196608
    s_add_u32 s93, s93, 0x8e00000
    s_mul_i32 s91, s48, 393216
    s_add_u32 s91, s91, s101
    s_add_u32 s94, s41, 2
    s_and_b32 s94, s94, 3
    s_mul_i32 s94, s94, 393216
    s_add_u32 s94, s94, s101
    s_mul_i32 s43, s38, 49152
    s_add_u32 s94, s94, s43
    s_add_u32 s45, s91, s43
    s_lshr_b32 s43, s38, 1
    s_mul_i32 s43, s43, 10240
    s_add_u32 s43, s43, 0x8f00000
    s_mul_i32 s95, s49, 81920
    s_add_u32 s95, s95, s43
    s_add_u32 s48, s41, 1
    s_and_b32 s48, s48, 3
    s_mul_i32 s92, s48, 81920
    s_add_u32 s92, s92, s43
    s_add_u32 s47, s47, 262144
    s_add_u32 s51, s51, 1310720
    s_add_u32 s96, s47, 262144
    s_min_u32 s96, s96, 16515072
    s_sleep 7
    s_mov_b32 s43, 0
Lpoll_70:
    buffer_load_dwordx4 v[120:123], v25, s[4:7], s59 offen sc1
    buffer_load_dwordx4 v[124:127], v26, s[4:7], s59 offen sc1
    buffer_load_dwordx4 v[128:131], v27, s[4:7], s59 offen sc1
    buffer_load_dwordx4 v[132:135], v28, s[4:7], s59 offen sc1
    buffer_load_dwordx4 v[136:139], v29, s[4:7], s59 offen sc1
    buffer_load_dwordx4 v[140:143], v30, s[4:7], s59 offen sc1
    buffer_load_dwordx4 v[144:147], v31, s[4:7], s59 offen sc1
    s_waitcnt vmcnt(0)
    v_max3_u32 v5, v120, v121, v122
    v_max3_u32 v5, v5, v123, v124
    v_max3_u32 v5, v5, v125, v126
    v_max3_u32 v5, v5, v127, v128
    v_max3_u32 v5, v5, v129, v130
    v_max3_u32 v5, v5, v131, v132
    v_max3_u32 v5, v5, v133, v134
    v_max3_u32 v5, v5, v135, v136
    v_max3_u32 v5, v5, v137, v138
    v_max3_u32 v5, v5, v139, v140
    v_max3_u32 v5, v5, v141, v142
    v_max3_u32 v5, v5, v143, v144
    v_max3_u32 v5, v5, v145, v146
    v_max_u32 v5, v5, v147
    v_cmp_eq_u32 vcc, -1, v5
    s_cbranch_vccz Lpd_71
    s_add_u32 s43, s43, 1
    s_cmp_lt_u32 s43, 400000
    s_cbranch_scc1 Lpoll_70
    s_mov_b32 s48, 3
    s_branch Lfail_2
Lpd_71:
    v_pk_add_f32 v[212:213], v[212:213], v[120:121]
    v_pk_add_f32 v[216:217], v[124:125], v[128:129]
    v_pk_add_f32 v[220:221], v[132:133], v[136:137]
    v_pk_add_f32 v[224:225], v[140:141], v[144:145]
    v_pk_add_f32 v[214:215], v[214:215], v[122:123]
    v_pk_add_f32 v[218:219], v[126:127], v[130:131]
    v_pk_add_f32 v[222:223], v[134:135], v[138:139]
    v_pk_add_f32 v[226:227], v[142:143], v[146:147]
    v_pk_add_f32 v[212:213], v[212:213], v[216:217]
    v_pk_add_f32 v[220:221], v[220:221], v[224:225]
    v_pk_add_f32 v[214:215], v[214:215], v[218:219]
    v_pk_add_f32 v[222:223], v[222:223], v[226:227]
    v_pk_add_f32 v[212:213], v[212:213], v[220:221]
    v_pk_add_f32 v[214:215], v[214:215], v[222:223]
    v_cvt_pk_bf16_f32 v216, v212, v213
    v_cvt_pk_bf16_f32 v217, v214, v215
    v_min_u32 v216, 0xfffffffe, v216
    v_min_u32 v217, 0xfffffffe, v217
    s_cmp_lg_u32 s42, 0
    s_cbranch_scc1 Lsl_72
    buffer_store_dwordx2 v[216:217], v32, s[4:7], s46 offen
    s_branch Lsl_73
Lsl_72:
    buffer_store_dwordx2 v[216:217], v32, s[4:7], s46 offen sc1
Lsl_73:
    s_mov_b64 exec, -1
    s_branch Ldp_74
Lw3_61:
    s_mov_b64 exec, -1
    buffer_store_dwordx2 v[56:57], v14, s[4:7], s44 offen sc1
    buffer_store_dwordx2 v[58:59], v17, s[4:7], s44 offen sc1
    s_and_b32 s48, s41, 3
    s_cmp_lg_u32 s48, 0
    s_cbranch_scc1 Lns_75
    s_cmp_eq_u32 s41, 0
    s_cbranch_scc1 Lns_75
    s_lshr_b32 s48, s41, 2
    s_sub_u32 s48, s48, 1
    s_lshl_b32 s49, s48, 12
    s_add_u32 s49, s49, 0x8c11000
    buffer_atomic_add v40, v39, s[4:7], s49 offen
Lns_75:
    s_cmp_lg_u32 s41, 62
    s_cbranch_scc1 Lns_76
    s_mov_b32 s48, 16
    s_lshl_b32 s49, s48, 12
    s_add_u32 s49, s49, 0x8c11000
    buffer_atomic_add v40, v39, s[4:7], s49 offen
Lns_76:
    s_cmp_lg_u32 s42, 0
    s_cbranch_scc1 Lsl_77
    buffer_store_dwordx2 v[48:49], v13, s[4:7], s93 offen
    s_branch Lsl_78
Lsl_77:
    buffer_store_dwordx2 v[48:49], v13, s[4:7], s93 offen sc1
Lsl_78:
    s_cmp_lg_u32 s42, 0
    s_cbranch_scc1 Lsl_79
    buffer_store_dwordx2 v[48:49], v16, s[4:7], s93 offen
    s_branch Lsl_80
Lsl_79:
    buffer_store_dwordx2 v[48:49], v16, s[4:7], s93 offen sc1
Lsl_80:
    s_mov_b64 exec, -1
    s_and_b32 s48, s41, 3
    s_cmp_lg_u32 s48, 1
    s_cbranch_scc1 Lnf_81
    s_add_u32 s59, s41, 3
    s_lshr_b32 s59, s59, 2
    s_cmp_gt_u32 s59, 15
    s_cbranch_scc1 Lnf_81
    s_lshl_b32 s49, s59, 12
    s_add_u32 s49, s49, 0x8c01000
    s_mov_b32 s43, 0
Lkf_82:
    buffer_load_dword v5, v38, s[4:7], s49 offen sc1
    s_waitcnt vmcnt(0)
    v_cmp_eq_u32 vcc, 0, v5
    s_cbranch_vccz Lkfd_83
    s_sleep 4
    s_add_u32 s43, s43, 1
    s_cmp_lt_u32 s43, 400000
    s_cbranch_scc1 Lkf_82
    s_mov_b32 s48, 5
    s_branch Lfail_2
Lkfd_83:
    s_branch Lcdone_54
Lnf_81:
    s_sleep 24
Lcdone_54:
    s_mov_b64 exec, -1
    s_add_u32 s41, s41, 1
    s_add_u32 s44, s44, 65536
    s_mov_b32 s46, s92
    s_and_b32 s48, s41, 3
    s_add_u32 s49, s41, 3
    s_and_b32 s49, s49, 3
    s_mul_i32 s90, s48, 196608
    s_add_u32 s90, s90, 0x8e00000
    s_mul_i32 s93, s49, 196608
    s_add_u32 s93, s93, 0x8e00000
    s_mul_i32 s91, s48, 393216
    s_add_u32 s91, s91, s101
    s_add_u32 s94, s41, 2
    s_and_b32 s94, s94, 3
    s_mul_i32 s94, s94, 393216
    s_add_u32 s94, s94, s101
    s_mul_i32 s43, s38, 49152
    s_add_u32 s94, s94, s43
    s_add_u32 s45, s91, s43
    s_lshr_b32 s43, s38, 1
    s_mul_i32 s43, s43, 10240
    s_add_u32 s43, s43, 0x8f00000
    s_mul_i32 s95, s49, 81920
    s_add_u32 s95, s95, s43
    s_add_u32 s48, s41, 1
    s_and_b32 s48, s48, 3
    s_mul_i32 s92, s48, 81920
    s_add_u32 s92, s92, s43
    s_add_u32 s47, s47, 262144
    s_add_u32 s51, s51, 1310720
    s_add_u32 s96, s47, 262144
    s_min_u32 s96, s96, 16515072
Ldp_74:
    s_mov_b32 s43, 0
Lpoll_84:
    buffer_load_dwordx4 v[60:63], v9, s[4:7], s46 offen sc1
    buffer_load_dwordx4 v[64:67], v9, s[4:7], s46 offen offset:1024 sc1
    buffer_load_dwordx4 v[68:71], v10, s[4:7], s46 offen sc1
    s_waitcnt vmcnt(0)
    v_max3_u32 v5, v60, v61, v62
    v_max3_u32 v5, v5, v63, v64
    v_max3_u32 v5, v5, v65, v66
    v_max3_u32 v5, v5, v67, v68
    v_max3_u32 v5, v5, v69, v70
    v_max_u32 v5, v5, v71
    v_cmp_eq_u32 vcc, -1, v5
    s_cbranch_vccz Lpd_85
    s_add_u32 s43, s43, 1
    s_cmp_lt_u32 s43, 400000
    s_cbranch_scc1 Lpoll_84
    s_mov_b32 s48, 4
    s_branch Lfail_2
Lpd_85:
    s_branch Lloop_41
Lfin_44:
    s_mov_b64 exec, -1
    buffer_store_dwordx2 v[56:57], v14, s[4:7], s44 offen sc1
    buffer_store_dwordx2 v[58:59], v17, s[4:7], s44 offen sc1
    s_mov_b64 exec, -1
    s_waitcnt vmcnt(0)
    s_mov_b32 s48, 15
    s_lshl_b32 s49, s48, 12
    s_add_u32 s49, s49, 0x8c11000
    buffer_atomic_add v40, v39, s[4:7], s49 offen
    s_branch Lend_1
Lfail_2:
    s_mov_b64 exec, 1
    v_mov_b32 v5, s48
    v_mov_b32 v6, 0
    v_or_b32 v5, 0x100, v5
    buffer_store_dword v5, v6, s[32:35], 0 offen
Lend_1:
    s_endpgm
Lwrole_12:
    s_sub_u32 s54, s43, 128
    s_mov_b32 s70, s54
    s_load_dwordx4 s[24:27], s[0:1], 24
    s_load_dwordx8 s[28:35], s[0:1], 40
    s_load_dwordx2 s[36:37], s[0:1], 96
    s_load_dwordx2 s[38:39], s[0:1], 80
    s_load_dwordx2 s[76:77], s[0:1], 0
    v_and_b32 v1, 63, v0
    v_lshrrev_b32 v5, 6, v0
    v_and_b32 v2, 15, v0
    v_readfirstlane_b32 s42, v5
    v_bfe_u32 v3, v0, 4, 2
    s_waitcnt lgkmcnt(0)
    s_mov_b32 s4, s36
    s_and_b32 s5, s37, 0xffff
    s_mov_b32 s6, 0x10000000
    s_mov_b32 s7, 0x00020000
    s_lshr_b32 s72, s70, 5
    s_lshl_b32 s72, s72, 3
    s_and_b32 s44, s70, 7
    s_add_u32 s72, s72, s44
    s_bfe_u32 s71, s70, 0x20003
    s_lshl_b32 s80, s70, 8
    s_add_u32 s80, s80, 0x8d10000
    s_cmp_lt_u32 s71, 2
    s_cbranch_scc1 Lcg_88
    s_branch Lcs_87
Lcg_88:
    s_mov_b32 s40, s71
    s_mov_b32 s41, s72
    s_mov_b32 s8, s24
    s_and_b32 s9, s25, 0xffff
    s_mov_b32 s10, 0x280000
    s_mov_b32 s11, 0x00020000
    s_mov_b32 s12, s30
    s_and_b32 s13, s31, 0xffff
    s_mov_b32 s14, 0x500000
    s_mov_b32 s15, 0x00020000
    s_mov_b32 s16, s32
    s_and_b32 s17, s33, 0xffff
    s_mov_b32 s18, 0x500000
    s_mov_b32 s19, 0x00020000
    s_mov_b32 s20, s34
    s_and_b32 s21, s35, 0xffff
    s_mov_b32 s22, 0x500000
    s_mov_b32 s23, 0x00020000
    s_and_b32 s44, s42, 1
    s_lshl_b32 s44, s44, 2
    v_or_b32 v6, s44, v3
    v_lshrrev_b32 v7, 1, v2
    v_xor_b32 v7, v7, v6
    v_and_b32 v8, 1, v2
    v_lshl_add_u32 v7, v7, 1, v8
    v_lshlrev_b32 v7, 4, v7
    v_mul_u32_u24 v8, 8192, v3
    v_add_u32 v7, v7, v8
    s_mul_i32 s44, s42, 65536
    s_lshl_b32 s45, s41, 8
    s_add_u32 s44, s44, s45
    v_add_u32 v9, s44, v7
    v_lshrrev_b32 v6, 2, v1
    v_mul_u32_u24 v6, 1280, v6
    v_and_b32 v7, 3, v1
    v_xor_b32 v7, v7, v3
    v_lshl_add_u32 v6, v7, 4, v6
    s_lshl_b32 s44, s40, 2
    s_add_u32 s44, s44, s42
    s_mul_i32 s44, s44, 40960
    v_add_u32 v10, s44, v6
    v_lshrrev_b32 v6, 2, v2
    v_and_b32 v7, 1, v3
    v_lshl_or_b32 v7, v7, 2, v6
    v_lshl_add_u32 v6, v3, 3, v6
    v_lshlrev_b32 v6, 8, v6
    v_and_b32 v8, 3, v2
    v_lshl_add_u32 v6, v8, 3, v6
    v_xor_b32 v8, 0, v7
    v_lshl_add_u32 v12, v8, 5, v6
    v_add_u32 v20, 0x10000, v12
    v_xor_b32 v8, 1, v7
    v_lshl_add_u32 v13, v8, 5, v6
    v_add_u32 v21, 0x10000, v13
    v_xor_b32 v8, 2, v7
    v_lshl_add_u32 v14, v8, 5, v6
    v_add_u32 v22, 0x10000, v14
    v_xor_b32 v8, 3, v7
    v_lshl_add_u32 v15, v8, 5, v6
    v_add_u32 v23, 0x10000, v15
    v_xor_b32 v8, 4, v7
    v_lshl_add_u32 v16, v8, 5, v6
    v_add_u32 v24, 0x10000, v16
    v_xor_b32 v8, 5, v7
    v_lshl_add_u32 v17, v8, 5, v6
    v_add_u32 v25, 0x10000, v17
    v_xor_b32 v8, 6, v7
    v_lshl_add_u32 v18, v8, 5, v6
    v_add_u32 v26, 0x10000, v18
    v_xor_b32 v8, 7, v7
    v_lshl_add_u32 v19, v8, 5, v6
    v_add_u32 v27, 0x10000, v19
    v_lshrrev_b32 v6, 2, v2
    v_xor_b32 v6, v6, v3
    v_lshlrev_b32 v6, 4, v6
    v_lshl_add_u32 v6, v2, 6, v6
    s_mul_i32 s44, s42, 2048
    s_add_u32 s44, s44, 8192
    v_add_u32 v28, s44, v6
    v_add_u32 v29, 0x10000, v28
    s_lshl_b32 s50, s42, 11
    s_mov_b32 s51, s44
    s_mov_b32 s46, 0
    s_mov_b32 s47, 0x0
    s_mov_b32 s53, 0
    s_add_u32 m0, s50, 0
    s_add_u32 s52, s46, 0x0
    buffer_load_dwordx4 v9, s[16:19], s52 offen lds
    s_add_u32 m0, s50, 1024
    s_add_u32 s52, s46, 0x8000
    buffer_load_dwordx4 v9, s[16:19], s52 offen lds
    s_add_u32 m0, s51, 0
    s_add_u32 s52, s47, 0
    buffer_load_dwordx4 v10, s[8:11], s52 offen lds
    s_add_u32 m0, s51, 1024
    s_add_u32 s52, s47, 20480
    buffer_load_dwordx4 v10, s[8:11], s52 offen lds
    s_add_u32 s46, s46, 262144
    s_add_u32 s47, s47, 64
    s_add_u32 m0, s50, 16384
    s_add_u32 s52, s46, 0x0
    buffer_load_dwordx4 v9, s[16:19], s52 offen lds
    s_add_u32 m0, s50, 17408
    s_add_u32 s52, s46, 0x8000
    buffer_load_dwordx4 v9, s[16:19], s52 offen lds
    s_add_u32 m0, s51, 16384
    s_add_u32 s52, s47, 0
    buffer_load_dwordx4 v10, s[8:11], s52 offen lds
    s_add_u32 m0, s51, 17408
    s_add_u32 s52, s47, 20480
    buffer_load_dwordx4 v10, s[8:11], s52 offen lds
    s_add_u32 s46, s46, 262144
    s_add_u32 s47, s47, 64
    s_add_u32 m0, s50, 32768
    s_add_u32 s52, s46, 0x0
    buffer_load_dwordx4 v9, s[16:19], s52 offen lds
    s_add_u32 m0, s50, 33792
    s_add_u32 s52, s46, 0x8000
    buffer_load_dwordx4 v9, s[16:19], s52 offen lds
    s_add_u32 m0, s51, 32768
    s_add_u32 s52, s47, 0
    buffer_load_dwordx4 v10, s[8:11], s52 offen lds
    s_add_u32 m0, s51, 33792
    s_add_u32 s52, s47, 20480
    buffer_load_dwordx4 v10, s[8:11], s52 offen lds
    s_add_u32 s46, s46, 262144
    s_add_u32 s47, s47, 64
    s_add_u32 m0, s50, 49152
    s_add_u32 s52, s46, 0x0
    buffer_load_dwordx4 v9, s[16:19], s52 offen lds
    s_add_u32 m0, s50, 50176
    s_add_u32 s52, s46, 0x8000
    buffer_load_dwordx4 v9, s[16:19], s52 offen lds
    s_add_u32 m0, s51, 49152
    s_add_u32 s52, s47, 0
    buffer_load_dwordx4 v10, s[8:11], s52 offen lds
    s_add_u32 m0, s51, 50176
    s_add_u32 s52, s47, 20480
    buffer_load_dwordx4 v10, s[8:11], s52 offen lds
    s_add_u32 s46, s46, 262144
    s_add_u32 s47, s47, 64
    v_accvgpr_write_b32 a0, 0
    v_accvgpr_write_b32 a1, 0
    v_accvgpr_write_b32 a2, 0
    v_accvgpr_write_b32 a3, 0
    v_accvgpr_write_b32 a4, 0
    v_accvgpr_write_b32 a5, 0
    v_accvgpr_write_b32 a6, 0
    v_accvgpr_write_b32 a7, 0
    v_accvgpr_write_b32 a8, 0
    v_accvgpr_write_b32 a9, 0
    v_accvgpr_write_b32 a10, 0
    v_accvgpr_write_b32 a11, 0
    v_accvgpr_write_b32 a12, 0
    v_accvgpr_write_b32 a13, 0
    v_accvgpr_write_b32 a14, 0
    v_accvgpr_write_b32 a15, 0
    v_accvgpr_write_b32 a16, 0
    v_accvgpr_write_b32 a17, 0
    v_accvgpr_write_b32 a18, 0
    v_accvgpr_write_b32 a19, 0
    v_accvgpr_write_b32 a20, 0
    v_accvgpr_write_b32 a21, 0
    v_accvgpr_write_b32 a22, 0
    v_accvgpr_write_b32 a23, 0
    v_accvgpr_write_b32 a24, 0
    v_accvgpr_write_b32 a25, 0
    v_accvgpr_write_b32 a26, 0
    v_accvgpr_write_b32 a27, 0
    v_accvgpr_write_b32 a28, 0
    v_accvgpr_write_b32 a29, 0
    v_accvgpr_write_b32 a30, 0
    v_accvgpr_write_b32 a31, 0
    v_accvgpr_write_b32 a32, 0
    v_accvgpr_write_b32 a33, 0
    v_accvgpr_write_b32 a34, 0
    v_accvgpr_write_b32 a35, 0
    v_accvgpr_write_b32 a36, 0
    v_accvgpr_write_b32 a37, 0
    v_accvgpr_write_b32 a38, 0
    v_accvgpr_write_b32 a39, 0
    v_accvgpr_write_b32 a40, 0
    v_accvgpr_write_b32 a41, 0
    v_accvgpr_write_b32 a42, 0
    v_accvgpr_write_b32 a43, 0
    v_accvgpr_write_b32 a44, 0
    v_accvgpr_write_b32 a45, 0
    v_accvgpr_write_b32 a46, 0
    v_accvgpr_write_b32 a47, 0
    v_accvgpr_write_b32 a48, 0
    v_accvgpr_write_b32 a49, 0
    v_accvgpr_write_b32 a50, 0
    v_accvgpr_write_b32 a51, 0
    v_accvgpr_write_b32 a52, 0
    v_accvgpr_write_b32 a53, 0
    v_accvgpr_write_b32 a54, 0
    v_accvgpr_write_b32 a55, 0
    v_accvgpr_write_b32 a56, 0
    v_accvgpr_write_b32 a57, 0
    v_accvgpr_write_b32 a58, 0
    v_accvgpr_write_b32 a59, 0
    v_accvgpr_write_b32 a60, 0
    v_accvgpr_write_b32 a61, 0
    v_accvgpr_write_b32 a62, 0
    v_accvgpr_write_b32 a63, 0
    s_waitcnt vmcnt(12)
    s_barrier
    ds_read_b128 v[32:35], v28 offset:0
    ds_read_b128 v[36:39], v28 offset:1024
    ds_read_b64_tr_b16 v[48:49], v12 offset:0
    ds_read_b64_tr_b16 v[50:51], v12 offset:1024
    ds_read_b64_tr_b16 v[52:53], v13 offset:0
    ds_read_b64_tr_b16 v[54:55], v13 offset:1024
    s_mov_b32 s43, 0
Lpg_89:
    ds_read_b64_tr_b16 v[56:57], v14 offset:0
    ds_read_b64_tr_b16 v[58:59], v14 offset:1024
    s_waitcnt lgkmcnt(6)
    s_waitcnt lgkmcnt(4)
    v_mfma_f32_16x16x32_bf16 a[0:3], v[48:51], v[32:35], a[0:3]
    v_mfma_f32_16x16x32_bf16 a[4:7], v[48:51], v[36:39], a[4:7]
    ds_read_b64_tr_b16 v[60:61], v15 offset:0
    ds_read_b64_tr_b16 v[62:63], v15 offset:1024
    s_waitcnt lgkmcnt(4)
    v_mfma_f32_16x16x32_bf16 a[8:11], v[52:55], v[32:35], a[8:11]
    v_mfma_f32_16x16x32_bf16 a[12:15], v[52:55], v[36:39], a[12:15]
    ds_read_b64_tr_b16 v[48:49], v16 offset:0
    ds_read_b64_tr_b16 v[50:51], v16 offset:1024
    s_waitcnt lgkmcnt(4)
    v_mfma_f32_16x16x32_bf16 a[16:19], v[56:59], v[32:35], a[16:19]
    v_mfma_f32_16x16x32_bf16 a[20:23], v[56:59], v[36:39], a[20:23]
    ds_read_b64_tr_b16 v[52:53], v17 offset:0
    ds_read_b64_tr_b16 v[54:55], v17 offset:1024
    s_waitcnt lgkmcnt(4)
    v_mfma_f32_16x16x32_bf16 a[24:27], v[60:63], v[32:35], a[24:27]
    v_mfma_f32_16x16x32_bf16 a[28:31], v[60:63], v[36:39], a[28:31]
    s_waitcnt vmcnt(8)
    s_barrier
    ds_read_b64_tr_b16 v[56:57], v18 offset:0
    ds_read_b64_tr_b16 v[58:59], v18 offset:1024
    s_waitcnt lgkmcnt(4)
    v_mfma_f32_16x16x32_bf16 a[32:35], v[48:51], v[32:35], a[32:35]
    v_mfma_f32_16x16x32_bf16 a[36:39], v[48:51], v[36:39], a[36:39]
    s_add_u32 m0, s50, 65536
    s_add_u32 s52, s46, 0x0
    buffer_load_dwordx4 v9, s[16:19], s52 offen lds
    ds_read_b64_tr_b16 v[60:61], v19 offset:0
    ds_read_b64_tr_b16 v[62:63], v19 offset:1024
    s_waitcnt lgkmcnt(4)
    v_mfma_f32_16x16x32_bf16 a[40:43], v[52:55], v[32:35], a[40:43]
    v_mfma_f32_16x16x32_bf16 a[44:47], v[52:55], v[36:39], a[44:47]
    s_add_u32 m0, s50, 66560
    s_add_u32 s52, s46, 0x8000
    buffer_load_dwordx4 v9, s[16:19], s52 offen lds
    ds_read_b128 v[40:43], v28 offset:16384
    ds_read_b128 v[44:47], v28 offset:17408
    ds_read_b64_tr_b16 v[48:49], v12 offset:16384
    ds_read_b64_tr_b16 v[50:51], v12 offset:17408
    s_waitcnt lgkmcnt(6)
    v_mfma_f32_16x16x32_bf16 a[48:51], v[56:59], v[32:35], a[48:51]
    v_mfma_f32_16x16x32_bf16 a[52:55], v[56:59], v[36:39], a[52:55]
    s_add_u32 m0, s51, 65536
    s_add_u32 s52, s47, 0
    buffer_load_dwordx4 v10, s[8:11], s52 offen lds
    ds_read_b64_tr_b16 v[52:53], v13 offset:16384
    ds_read_b64_tr_b16 v[54:55], v13 offset:17408
    s_waitcnt lgkmcnt(6)
    v_mfma_f32_16x16x32_bf16 a[56:59], v[60:63], v[32:35], a[56:59]
    v_mfma_f32_16x16x32_bf16 a[60:63], v[60:63], v[36:39], a[60:63]
    s_add_u32 m0, s51, 66560
    s_add_u32 s52, s47, 20480
    buffer_load_dwordx4 v10, s[8:11], s52 offen lds
    s_add_u32 s46, s46, 262144
    s_add_u32 s47, s47, 64
    ds_read_b64_tr_b16 v[56:57], v14 offset:16384
    ds_read_b64_tr_b16 v[58:59], v14 offset:17408
    s_waitcnt lgkmcnt(6)
    s_waitcnt lgkmcnt(4)
    v_mfma_f32_16x16x32_bf16 a[0:3], v[48:51], v[40:43], a[0:3]
    v_mfma_f32_16x16x32_bf16 a[4:7], v[48:51], v[44:47], a[4:7]
    ds_read_b64_tr_b16 v[60:61], v15 offset:16384
    ds_read_b64_tr_b16 v[62:63], v15 offset:17408
    s_waitcnt lgkmcnt(4)
    v_mfma_f32_16x16x32_bf16 a[8:11], v[52:55], v[40:43], a[8:11]
    v_mfma_f32_16x16x32_bf16 a[12:15], v[52:55], v[44:47], a[12:15]
    ds_read_b64_tr_b16 v[48:49], v16 offset:16384
    ds_read_b64_tr_b16 v[50:51], v16 offset:17408
    s_waitcnt lgkmcnt(4)
    v_mfma_f32_16x16x32_bf16 a[16:19], v[56:59], v[40:43], a[16:19]
    v_mfma_f32_16x16x32_bf16 a[20:23], v[56:59], v[44:47], a[20:23]
    ds_read_b64_tr_b16 v[52:53], v17 offset:16384
    ds_read_b64_tr_b16 v[54:55], v17 offset:17408
    s_waitcnt lgkmcnt(4)
    v_mfma_f32_16x16x32_bf16 a[24:27], v[60:63], v[40:43], a[24:27]
    v_mfma_f32_16x16x32_bf16 a[28:31], v[60:63], v[44:47], a[28:31]
    s_waitcnt vmcnt(8)
    s_barrier
    ds_read_b64_tr_b16 v[56:57], v18 offset:16384
    ds_read_b64_tr_b16 v[58:59], v18 offset:17408
    s_waitcnt lgkmcnt(4)
    v_mfma_f32_16x16x32_bf16 a[32:35], v[48:51], v[40:43], a[32:35]
    v_mfma_f32_16x16x32_bf16 a[36:39], v[48:51], v[44:47], a[36:39]
    s_add_u32 m0, s50, 0
    s_add_u32 s52, s46, 0x0
    buffer_load_dwordx4 v9, s[16:19], s52 offen lds
    ds_read_b64_tr_b16 v[60:61], v19 offset:16384
    ds_read_b64_tr_b16 v[62:63], v19 offset:17408
    s_waitcnt lgkmcnt(4)
    v_mfma_f32_16x16x32_bf16 a[40:43], v[52:55], v[40:43], a[40:43]
    v_mfma_f32_16x16x32_bf16 a[44:47], v[52:55], v[44:47], a[44:47]
    s_add_u32 m0, s50, 1024
    s_add_u32 s52, s46, 0x8000
    buffer_load_dwordx4 v9, s[16:19], s52 offen lds
    ds_read_b128 v[32:35], v28 offset:32768
    ds_read_b128 v[36:39], v28 offset:33792
    ds_read_b64_tr_b16 v[48:49], v12 offset:32768
    ds_read_b64_tr_b16 v[50:51], v12 offset:33792
    s_waitcnt lgkmcnt(6)
    v_mfma_f32_16x16x32_bf16 a[48:51], v[56:59], v[40:43], a[48:51]
    v_mfma_f32_16x16x32_bf16 a[52:55], v[56:59], v[44:47], a[52:55]
    s_add_u32 m0, s51, 0
    s_add_u32 s52, s47, 0
    buffer_load_dwordx4 v10, s[8:11], s52 offen lds
    ds_read_b64_tr_b16 v[52:53], v13 offset:32768
    ds_read_b64_tr_b16 v[54:55], v13 offset:33792
    s_waitcnt lgkmcnt(6)
    v_mfma_f32_16x16x32_bf16 a[56:59], v[60:63], v[40:43], a[56:59]
    v_mfma_f32_16x16x32_bf16 a[60:63], v[60:63], v[44:47], a[60:63]
    s_add_u32 m0, s51, 1024
    s_add_u32 s52, s47, 20480
    buffer_load_dwordx4 v10, s[8:11], s52 offen lds
    s_add_u32 s46, s46, 262144
    s_add_u32 s47, s47, 64
    ds_read_b64_tr_b16 v[56:57], v14 offset:32768
    ds_read_b64_tr_b16 v[58:59], v14 offset:33792
    s_waitcnt lgkmcnt(6)
    s_waitcnt lgkmcnt(4)
    v_mfma_f32_16x16x32_bf16 a[0:3], v[48:51], v[32:35], a[0:3]
    v_mfma_f32_16x16x32_bf16 a[4:7], v[48:51], v[36:39], a[4:7]
    ds_read_b64_tr_b16 v[60:61], v15 offset:32768
    ds_read_b64_tr_b16 v[62:63], v15 offset:33792
    s_waitcnt lgkmcnt(4)
    v_mfma_f32_16x16x32_bf16 a[8:11], v[52:55], v[32:35], a[8:11]
    v_mfma_f32_16x16x32_bf16 a[12:15], v[52:55], v[36:39], a[12:15]
    ds_read_b64_tr_b16 v[48:49], v16 offset:32768
    ds_read_b64_tr_b16 v[50:51], v16 offset:33792
    s_waitcnt lgkmcnt(4)
    v_mfma_f32_16x16x32_bf16 a[16:19], v[56:59], v[32:35], a[16:19]
    v_mfma_f32_16x16x32_bf16 a[20:23], v[56:59], v[36:39], a[20:23]
    ds_read_b64_tr_b16 v[52:53], v17 offset:32768
    ds_read_b64_tr_b16 v[54:55], v17 offset:33792
    s_waitcnt lgkmcnt(4)
    v_mfma_f32_16x16x32_bf16 a[24:27], v[60:63], v[32:35], a[24:27]
    v_mfma_f32_16x16x32_bf16 a[28:31], v[60:63], v[36:39], a[28:31]
    s_waitcnt vmcnt(8)
    s_barrier
    ds_read_b64_tr_b16 v[56:57], v18 offset:32768
    ds_read_b64_tr_b16 v[58:59], v18 offset:33792
    s_waitcnt lgkmcnt(4)
    v_mfma_f32_16x16x32_bf16 a[32:35], v[48:51], v[32:35], a[32:35]
    v_mfma_f32_16x16x32_bf16 a[36:39], v[48:51], v[36:39], a[36:39]
    s_add_u32 m0, s50, 16384
    s_add_u32 s52, s46, 0x0
    buffer_load_dwordx4 v9, s[16:19], s52 offen lds
    ds_read_b64_tr_b16 v[60:61], v19 offset:32768
    ds_read_b64_tr_b16 v[62:63], v19 offset:33792
    s_waitcnt lgkmcnt(4)
    v_mfma_f32_16x16x32_bf16 a[40:43], v[52:55], v[32:35], a[40:43]
    v_mfma_f32_16x16x32_bf16 a[44:47], v[52:55], v[36:39], a[44:47]
    s_add_u32 m0, s50, 17408
    s_add_u32 s52, s46, 0x8000
    buffer_load_dwordx4 v9, s[16:19], s52 offen lds
    ds_read_b128 v[40:43], v28 offset:49152
    ds_read_b128 v[44:47], v28 offset:50176
    ds_read_b64_tr_b16 v[48:49], v12 offset:49152
    ds_read_b64_tr_b16 v[50:51], v12 offset:50176
    s_waitcnt lgkmcnt(6)
    v_mfma_f32_16x16x32_bf16 a[48:51], v[56:59], v[32:35], a[48:51]
    v_mfma_f32_16x16x32_bf16 a[52:55], v[56:59], v[36:39], a[52:55]
    s_add_u32 m0, s51, 16384
    s_add_u32 s52, s47, 0
    buffer_load_dwordx4 v10, s[8:11], s52 offen lds
    ds_read_b64_tr_b16 v[52:53], v13 offset:49152
    ds_read_b64_tr_b16 v[54:55], v13 offset:50176
    s_waitcnt lgkmcnt(6)
    v_mfma_f32_16x16x32_bf16 a[56:59], v[60:63], v[32:35], a[56:59]
    v_mfma_f32_16x16x32_bf16 a[60:63], v[60:63], v[36:39], a[60:63]
    s_add_u32 m0, s51, 17408
    s_add_u32 s52, s47, 20480
    buffer_load_dwordx4 v10, s[8:11], s52 offen lds
    s_add_u32 s46, s46, 262144
    s_add_u32 s47, s47, 64
    ds_read_b64_tr_b16 v[56:57], v14 offset:49152
    ds_read_b64_tr_b16 v[58:59], v14 offset:50176
    s_waitcnt lgkmcnt(6)
    s_waitcnt lgkmcnt(4)
    v_mfma_f32_16x16x32_bf16 a[0:3], v[48:51], v[40:43], a[0:3]
    v_mfma_f32_16x16x32_bf16 a[4:7], v[48:51], v[44:47], a[4:7]
    ds_read_b64_tr_b16 v[60:61], v15 offset:49152
    ds_read_b64_tr_b16 v[62:63], v15 offset:50176
    s_waitcnt lgkmcnt(4)
    v_mfma_f32_16x16x32_bf16 a[8:11], v[52:55], v[40:43], a[8:11]
    v_mfma_f32_16x16x32_bf16 a[12:15], v[52:55], v[44:47], a[12:15]
    ds_read_b64_tr_b16 v[48:49], v16 offset:49152
    ds_read_b64_tr_b16 v[50:51], v16 offset:50176
    s_waitcnt lgkmcnt(4)
    v_mfma_f32_16x16x32_bf16 a[16:19], v[56:59], v[40:43], a[16:19]
    v_mfma_f32_16x16x32_bf16 a[20:23], v[56:59], v[44:47], a[20:23]
    ds_read_b64_tr_b16 v[52:53], v17 offset:49152
    ds_read_b64_tr_b16 v[54:55], v17 offset:50176
    s_waitcnt lgkmcnt(4)
    v_mfma_f32_16x16x32_bf16 a[24:27], v[60:63], v[40:43], a[24:27]
    v_mfma_f32_16x16x32_bf16 a[28:31], v[60:63], v[44:47], a[28:31]
    s_waitcnt vmcnt(8)
    s_barrier
    ds_read_b64_tr_b16 v[56:57], v18 offset:49152
    ds_read_b64_tr_b16 v[58:59], v18 offset:50176
    s_waitcnt lgkmcnt(4)
    v_mfma_f32_16x16x32_bf16 a[32:35], v[48:51], v[40:43], a[32:35]
    v_mfma_f32_16x16x32_bf16 a[36:39], v[48:51], v[44:47], a[36:39]
    s_add_u32 m0, s50, 32768
    s_add_u32 s52, s46, 0x0
    buffer_load_dwordx4 v9, s[16:19], s52 offen lds
    ds_read_b64_tr_b16 v[60:61], v19 offset:49152
    ds_read_b64_tr_b16 v[62:63], v19 offset:50176
    s_waitcnt lgkmcnt(4)
    v_mfma_f32_16x16x32_bf16 a[40:43], v[52:55], v[40:43], a[40:43]
    v_mfma_f32_16x16x32_bf16 a[44:47], v[52:55], v[44:47], a[44:47]
    s_add_u32 m0, s50, 33792
    s_add_u32 s52, s46, 0x8000
    buffer_load_dwordx4 v9, s[16:19], s52 offen lds
    ds_read_b128 v[32:35], v29 offset:0
    ds_read_b128 v[36:39], v29 offset:1024
    ds_read_b64_tr_b16 v[48:49], v20 offset:0
    ds_read_b64_tr_b16 v[50:51], v20 offset:1024
    s_waitcnt lgkmcnt(6)
    v_mfma_f32_16x16x32_bf16 a[48:51], v[56:59], v[40:43], a[48:51]
    v_mfma_f32_16x16x32_bf16 a[52:55], v[56:59], v[44:47], a[52:55]
    s_add_u32 m0, s51, 32768
    s_add_u32 s52, s47, 0
    buffer_load_dwordx4 v10, s[8:11], s52 offen lds
    ds_read_b64_tr_b16 v[52:53], v21 offset:0
    ds_read_b64_tr_b16 v[54:55], v21 offset:1024
    s_waitcnt lgkmcnt(6)
    v_mfma_f32_16x16x32_bf16 a[56:59], v[60:63], v[40:43], a[56:59]
    v_mfma_f32_16x16x32_bf16 a[60:63], v[60:63], v[44:47], a[60:63]
    s_add_u32 m0, s51, 33792
    s_add_u32 s52, s47, 20480
    buffer_load_dwordx4 v10, s[8:11], s52 offen lds
    s_add_u32 s46, s46, 262144
    s_add_u32 s47, s47, 64
    ds_read_b64_tr_b16 v[56:57], v22 offset:0
    ds_read_b64_tr_b16 v[58:59], v22 offset:1024
    s_waitcnt lgkmcnt(6)
    s_waitcnt lgkmcnt(4)
    v_mfma_f32_16x16x32_bf16 a[0:3], v[48:51], v[32:35], a[0:3]
    v_mfma_f32_16x16x32_bf16 a[4:7], v[48:51], v[36:39], a[4:7]
    ds_read_b64_tr_b16 v[60:61], v23 offset:0
    ds_read_b64_tr_b16 v[62:63], v23 offset:1024
    s_waitcnt lgkmcnt(4)
    v_mfma_f32_16x16x32_bf16 a[8:11], v[52:55], v[32:35], a[8:11]
    v_mfma_f32_16x16x32_bf16 a[12:15], v[52:55], v[36:39], a[12:15]
    ds_read_b64_tr_b16 v[48:49], v24 offset:0
    ds_read_b64_tr_b16 v[50:51], v24 offset:1024
    s_waitcnt lgkmcnt(4)
    v_mfma_f32_16x16x32_bf16 a[16:19], v[56:59], v[32:35], a[16:19]
    v_mfma_f32_16x16x32_bf16 a[20:23], v[56:59], v[36:39], a[20:23]
    ds_read_b64_tr_b16 v[52:53], v25 offset:0
    ds_read_b64_tr_b16 v[54:55], v25 offset:1024
    s_waitcnt lgkmcnt(4)
    v_mfma_f32_16x16x32_bf16 a[24:27], v[60:63], v[32:35], a[24:27]
    v_mfma_f32_16x16x32_bf16 a[28:31], v[60:63], v[36:39], a[28:31]
    s_waitcnt vmcnt(8)
    s_barrier
    ds_read_b64_tr_b16 v[56:57], v26 offset:0
    ds_read_b64_tr_b16 v[58:59], v26 offset:1024
    s_waitcnt lgkmcnt(4)
    v_mfma_f32_16x16x32_bf16 a[32:35], v[48:51], v[32:35], a[32:35]
    v_mfma_f32_16x16x32_bf16 a[36:39], v[48:51], v[36:39], a[36:39]
    s_add_u32 m0, s50, 49152
    s_add_u32 s52, s46, 0x0
    buffer_load_dwordx4 v9, s[16:19], s52 offen lds
    ds_read_b64_tr_b16 v[60:61], v27 offset:0
    ds_read_b64_tr_b16 v[62:63], v27 offset:1024
    s_waitcnt lgkmcnt(4)
    v_mfma_f32_16x16x32_bf16 a[40:43], v[52:55], v[32:35], a[40:43]
    v_mfma_f32_16x16x32_bf16 a[44:47], v[52:55], v[36:39], a[44:47]
    s_add_u32 m0, s50, 50176
    s_add_u32 s52, s46, 0x8000
    buffer_load_dwordx4 v9, s[16:19], s52 offen lds
    ds_read_b128 v[40:43], v28 offset:0
    ds_read_b128 v[44:47], v28 offset:1024
    ds_read_b64_tr_b16 v[48:49], v12 offset:0
    ds_read_b64_tr_b16 v[50:51], v12 offset:1024
    s_waitcnt lgkmcnt(6)
    v_mfma_f32_16x16x32_bf16 a[48:51], v[56:59], v[32:35], a[48:51]
    v_mfma_f32_16x16x32_bf16 a[52:55], v[56:59], v[36:39], a[52:55]
    s_add_u32 m0, s51, 49152
    s_add_u32 s52, s47, 0
    buffer_load_dwordx4 v10, s[8:11], s52 offen lds
    ds_read_b64_tr_b16 v[52:53], v13 offset:0
    ds_read_b64_tr_b16 v[54:55], v13 offset:1024
    s_waitcnt lgkmcnt(6)
    v_mfma_f32_16x16x32_bf16 a[56:59], v[60:63], v[32:35], a[56:59]
    v_mfma_f32_16x16x32_bf16 a[60:63], v[60:63], v[36:39], a[60:63]
    s_add_u32 m0, s51, 50176
    s_add_u32 s52, s47, 20480
    buffer_load_dwordx4 v10, s[8:11], s52 offen lds
    s_add_u32 s46, s46, 262144
    s_add_u32 s47, s47, 64
    ds_read_b64_tr_b16 v[56:57], v14 offset:0
    ds_read_b64_tr_b16 v[58:59], v14 offset:1024
    s_waitcnt lgkmcnt(6)
    s_waitcnt lgkmcnt(4)
    v_mfma_f32_16x16x32_bf16 a[0:3], v[48:51], v[40:43], a[0:3]
    v_mfma_f32_16x16x32_bf16 a[4:7], v[48:51], v[44:47], a[4:7]
    ds_read_b64_tr_b16 v[60:61], v15 offset:0
    ds_read_b64_tr_b16 v[62:63], v15 offset:1024
    s_waitcnt lgkmcnt(4)
    v_mfma_f32_16x16x32_bf16 a[8:11], v[52:55], v[40:43], a[8:11]
    v_mfma_f32_16x16x32_bf16 a[12:15], v[52:55], v[44:47], a[12:15]
    ds_read_b64_tr_b16 v[48:49], v16 offset:0
    ds_read_b64_tr_b16 v[50:51], v16 offset:1024
    s_waitcnt lgkmcnt(4)
    v_mfma_f32_16x16x32_bf16 a[16:19], v[56:59], v[40:43], a[16:19]
    v_mfma_f32_16x16x32_bf16 a[20:23], v[56:59], v[44:47], a[20:23]
    ds_read_b64_tr_b16 v[52:53], v17 offset:0
    ds_read_b64_tr_b16 v[54:55], v17 offset:1024
    s_waitcnt lgkmcnt(4)
    v_mfma_f32_16x16x32_bf16 a[24:27], v[60:63], v[40:43], a[24:27]
    v_mfma_f32_16x16x32_bf16 a[28:31], v[60:63], v[44:47], a[28:31]
    s_waitcnt vmcnt(8)
    s_barrier
    ds_read_b64_tr_b16 v[56:57], v18 offset:0
    ds_read_b64_tr_b16 v[58:59], v18 offset:1024
    s_waitcnt lgkmcnt(4)
    v_mfma_f32_16x16x32_bf16 a[32:35], v[48:51], v[40:43], a[32:35]
    v_mfma_f32_16x16x32_bf16 a[36:39], v[48:51], v[44:47], a[36:39]
    s_add_u32 m0, s50, 65536
    s_add_u32 s52, s46, 0x0
    buffer_load_dwordx4 v9, s[16:19], s52 offen lds
    ds_read_b64_tr_b16 v[60:61], v19 offset:0
    ds_read_b64_tr_b16 v[62:63], v19 offset:1024
    s_waitcnt lgkmcnt(4)
    v_mfma_f32_16x16x32_bf16 a[40:43], v[52:55], v[40:43], a[40:43]
    v_mfma_f32_16x16x32_bf16 a[44:47], v[52:55], v[44:47], a[44:47]
    s_add_u32 m0, s50, 66560
    s_add_u32 s52, s46, 0x8000
    buffer_load_dwordx4 v9, s[16:19], s52 offen lds
    ds_read_b128 v[32:35], v28 offset:16384
    ds_read_b128 v[36:39], v28 offset:17408
    ds_read_b64_tr_b16 v[48:49], v12 offset:16384
    ds_read_b64_tr_b16 v[50:51], v12 offset:17408
    s_waitcnt lgkmcnt(6)
    v_mfma_f32_16x16x32_bf16 a[48:51], v[56:59], v[40:43], a[48:51]
    v_mfma_f32_16x16x32_bf16 a[52:55], v[56:59], v[44:47], a[52:55]
    s_add_u32 m0, s51, 65536
    s_add_u32 s52, s47, 0
    buffer_load_dwordx4 v10, s[8:11], s52 offen lds
    ds_read_b64_tr_b16 v[52:53], v13 offset:16384
    ds_read_b64_tr_b16 v[54:55], v13 offset:17408
    s_waitcnt lgkmcnt(6)
    v_mfma_f32_16x16x32_bf16 a[56:59], v[60:63], v[40:43], a[56:59]
    v_mfma_f32_16x16x32_bf16 a[60:63], v[60:63], v[44:47], a[60:63]
    s_add_u32 m0, s51, 66560
    s_add_u32 s52, s47, 20480
    buffer_load_dwordx4 v10, s[8:11], s52 offen lds
    s_add_u32 s46, s46, 262144
    s_add_u32 s47, s47, 64
    ds_read_b64_tr_b16 v[56:57], v14 offset:16384
    ds_read_b64_tr_b16 v[58:59], v14 offset:17408
    s_waitcnt lgkmcnt(6)
    s_waitcnt lgkmcnt(4)
    v_mfma_f32_16x16x32_bf16 a[0:3], v[48:51], v[32:35], a[0:3]
    v_mfma_f32_16x16x32_bf16 a[4:7], v[48:51], v[36:39], a[4:7]
    ds_read_b64_tr_b16 v[60:61], v15 offset:16384
    ds_read_b64_tr_b16 v[62:63], v15 offset:17408
    s_waitcnt lgkmcnt(4)
    v_mfma_f32_16x16x32_bf16 a[8:11], v[52:55], v[32:35], a[8:11]
    v_mfma_f32_16x16x32_bf16 a[12:15], v[52:55], v[36:39], a[12:15]
    ds_read_b64_tr_b16 v[48:49], v16 offset:16384
    ds_read_b64_tr_b16 v[50:51], v16 offset:17408
    s_waitcnt lgkmcnt(4)
    v_mfma_f32_16x16x32_bf16 a[16:19], v[56:59], v[32:35], a[16:19]
    v_mfma_f32_16x16x32_bf16 a[20:23], v[56:59], v[36:39], a[20:23]
    ds_read_b64_tr_b16 v[52:53], v17 offset:16384
    ds_read_b64_tr_b16 v[54:55], v17 offset:17408
    s_waitcnt lgkmcnt(4)
    v_mfma_f32_16x16x32_bf16 a[24:27], v[60:63], v[32:35], a[24:27]
    v_mfma_f32_16x16x32_bf16 a[28:31], v[60:63], v[36:39], a[28:31]
    s_waitcnt vmcnt(8)
    s_barrier
    ds_read_b64_tr_b16 v[56:57], v18 offset:16384
    ds_read_b64_tr_b16 v[58:59], v18 offset:17408
    s_waitcnt lgkmcnt(4)
    v_mfma_f32_16x16x32_bf16 a[32:35], v[48:51], v[32:35], a[32:35]
    v_mfma_f32_16x16x32_bf16 a[36:39], v[48:51], v[36:39], a[36:39]
    s_add_u32 m0, s50, 0
    s_add_u32 s52, s46, 0x0
    buffer_load_dwordx4 v9, s[16:19], s52 offen lds
    ds_read_b64_tr_b16 v[60:61], v19 offset:16384
    ds_read_b64_tr_b16 v[62:63], v19 offset:17408
    s_waitcnt lgkmcnt(4)
    v_mfma_f32_16x16x32_bf16 a[40:43], v[52:55], v[32:35], a[40:43]
    v_mfma_f32_16x16x32_bf16 a[44:47], v[52:55], v[36:39], a[44:47]
    s_add_u32 m0, s50, 1024
    s_add_u32 s52, s46, 0x8000
    buffer_load_dwordx4 v9, s[16:19], s52 offen lds
    ds_read_b128 v[40:43], v28 offset:32768
    ds_read_b128 v[44:47], v28 offset:33792
    ds_read_b64_tr_b16 v[48:49], v12 offset:32768
    ds_read_b64_tr_b16 v[50:51], v12 offset:33792
    s_waitcnt lgkmcnt(6)
    v_mfma_f32_16x16x32_bf16 a[48:51], v[56:59], v[32:35], a[48:51]
    v_mfma_f32_16x16x32_bf16 a[52:55], v[56:59], v[36:39], a[52:55]
    s_add_u32 m0, s51, 0
    s_add_u32 s52, s47, 0
    buffer_load_dwordx4 v10, s[8:11], s52 offen lds
    ds_read_b64_tr_b16 v[52:53], v13 offset:32768
    ds_read_b64_tr_b16 v[54:55], v13 offset:33792
    s_waitcnt lgkmcnt(6)
    v_mfma_f32_16x16x32_bf16 a[56:59], v[60:63], v[32:35], a[56:59]
    v_mfma_f32_16x16x32_bf16 a[60:63], v[60:63], v[36:39], a[60:63]
    s_add_u32 m0, s51, 1024
    s_add_u32 s52, s47, 20480
    buffer_load_dwordx4 v10, s[8:11], s52 offen lds
    s_add_u32 s46, s46, 262144
    s_add_u32 s47, s47, 64
    ds_read_b64_tr_b16 v[56:57], v14 offset:32768
    ds_read_b64_tr_b16 v[58:59], v14 offset:33792
    s_waitcnt lgkmcnt(6)
    s_waitcnt lgkmcnt(4)
    v_mfma_f32_16x16x32_bf16 a[0:3], v[48:51], v[40:43], a[0:3]
    v_mfma_f32_16x16x32_bf16 a[4:7], v[48:51], v[44:47], a[4:7]
    ds_read_b64_tr_b16 v[60:61], v15 offset:32768
    ds_read_b64_tr_b16 v[62:63], v15 offset:33792
    s_waitcnt lgkmcnt(4)
    v_mfma_f32_16x16x32_bf16 a[8:11], v[52:55], v[40:43], a[8:11]
    v_mfma_f32_16x16x32_bf16 a[12:15], v[52:55], v[44:47], a[12:15]
    ds_read_b64_tr_b16 v[48:49], v16 offset:32768
    ds_read_b64_tr_b16 v[50:51], v16 offset:33792
    s_waitcnt lgkmcnt(4)
    v_mfma_f32_16x16x32_bf16 a[16:19], v[56:59], v[40:43], a[16:19]
    v_mfma_f32_16x16x32_bf16 a[20:23], v[56:59], v[44:47], a[20:23]
    ds_read_b64_tr_b16 v[52:53], v17 offset:32768
    ds_read_b64_tr_b16 v[54:55], v17 offset:33792
    s_waitcnt lgkmcnt(4)
    v_mfma_f32_16x16x32_bf16 a[24:27], v[60:63], v[40:43], a[24:27]
    v_mfma_f32_16x16x32_bf16 a[28:31], v[60:63], v[44:47], a[28:31]
    s_waitcnt vmcnt(8)
    s_barrier
    ds_read_b64_tr_b16 v[56:57], v18 offset:32768
    ds_read_b64_tr_b16 v[58:59], v18 offset:33792
    s_waitcnt lgkmcnt(4)
    v_mfma_f32_16x16x32_bf16 a[32:35], v[48:51], v[40:43], a[32:35]
    v_mfma_f32_16x16x32_bf16 a[36:39], v[48:51], v[44:47], a[36:39]
    s_add_u32 m0, s50, 16384
    s_add_u32 s52, s46, 0x0
    buffer_load_dwordx4 v9, s[16:19], s52 offen lds
    ds_read_b64_tr_b16 v[60:61], v19 offset:32768
    ds_read_b64_tr_b16 v[62:63], v19 offset:33792
    s_waitcnt lgkmcnt(4)
    v_mfma_f32_16x16x32_bf16 a[40:43], v[52:55], v[40:43], a[40:43]
    v_mfma_f32_16x16x32_bf16 a[44:47], v[52:55], v[44:47], a[44:47]
    s_add_u32 m0, s50, 17408
    s_add_u32 s52, s46, 0x8000
    buffer_load_dwordx4 v9, s[16:19], s52 offen lds
    ds_read_b128 v[32:35], v28 offset:49152
    ds_read_b128 v[36:39], v28 offset:50176
    ds_read_b64_tr_b16 v[48:49], v12 offset:49152
    ds_read_b64_tr_b16 v[50:51], v12 offset:50176
    s_waitcnt lgkmcnt(6)
    v_mfma_f32_16x16x32_bf16 a[48:51], v[56:59], v[40:43], a[48:51]
    v_mfma_f32_16x16x32_bf16 a[52:55], v[56:59], v[44:47], a[52:55]
    s_add_u32 m0, s51, 16384
    s_add_u32 s52, s47, 0
    buffer_load_dwordx4 v10, s[8:11], s52 offen lds
    ds_read_b64_tr_b16 v[52:53], v13 offset:49152
    ds_read_b64_tr_b16 v[54:55], v13 offset:50176
    s_waitcnt lgkmcnt(6)
    v_mfma_f32_16x16x32_bf16 a[56:59], v[60:63], v[40:43], a[56:59]
    v_mfma_f32_16x16x32_bf16 a[60:63], v[60:63], v[44:47], a[60:63]
    s_add_u32 m0, s51, 17408
    s_add_u32 s52, s47, 20480
    buffer_load_dwordx4 v10, s[8:11], s52 offen lds
    s_add_u32 s46, s46, 262144
    s_add_u32 s47, s47, 64
    ds_read_b64_tr_b16 v[56:57], v14 offset:49152
    ds_read_b64_tr_b16 v[58:59], v14 offset:50176
    s_waitcnt lgkmcnt(6)
    s_waitcnt lgkmcnt(4)
    v_mfma_f32_16x16x32_bf16 a[0:3], v[48:51], v[32:35], a[0:3]
    v_mfma_f32_16x16x32_bf16 a[4:7], v[48:51], v[36:39], a[4:7]
    ds_read_b64_tr_b16 v[60:61], v15 offset:49152
    ds_read_b64_tr_b16 v[62:63], v15 offset:50176
    s_waitcnt lgkmcnt(4)
    v_mfma_f32_16x16x32_bf16 a[8:11], v[52:55], v[32:35], a[8:11]
    v_mfma_f32_16x16x32_bf16 a[12:15], v[52:55], v[36:39], a[12:15]
    ds_read_b64_tr_b16 v[48:49], v16 offset:49152
    ds_read_b64_tr_b16 v[50:51], v16 offset:50176
    s_waitcnt lgkmcnt(4)
    v_mfma_f32_16x16x32_bf16 a[16:19], v[56:59], v[32:35], a[16:19]
    v_mfma_f32_16x16x32_bf16 a[20:23], v[56:59], v[36:39], a[20:23]
    ds_read_b64_tr_b16 v[52:53], v17 offset:49152
    ds_read_b64_tr_b16 v[54:55], v17 offset:50176
    s_waitcnt lgkmcnt(4)
    v_mfma_f32_16x16x32_bf16 a[24:27], v[60:63], v[32:35], a[24:27]
    v_mfma_f32_16x16x32_bf16 a[28:31], v[60:63], v[36:39], a[28:31]
    s_waitcnt vmcnt(8)
    s_barrier
    ds_read_b64_tr_b16 v[56:57], v18 offset:49152
    ds_read_b64_tr_b16 v[58:59], v18 offset:50176
    s_waitcnt lgkmcnt(4)
    v_mfma_f32_16x16x32_bf16 a[32:35], v[48:51], v[32:35], a[32:35]
    v_mfma_f32_16x16x32_bf16 a[36:39], v[48:51], v[36:39], a[36:39]
    s_add_u32 m0, s50, 32768
    s_add_u32 s52, s46, 0x0
    buffer_load_dwordx4 v9, s[16:19], s52 offen lds
    ds_read_b64_tr_b16 v[60:61], v19 offset:49152
    ds_read_b64_tr_b16 v[62:63], v19 offset:50176
    s_waitcnt lgkmcnt(4)
    v_mfma_f32_16x16x32_bf16 a[40:43], v[52:55], v[32:35], a[40:43]
    v_mfma_f32_16x16x32_bf16 a[44:47], v[52:55], v[36:39], a[44:47]
    s_add_u32 m0, s50, 33792
    s_add_u32 s52, s46, 0x8000
    buffer_load_dwordx4 v9, s[16:19], s52 offen lds
    ds_read_b128 v[40:43], v29 offset:0
    ds_read_b128 v[44:47], v29 offset:1024
    ds_read_b64_tr_b16 v[48:49], v20 offset:0
    ds_read_b64_tr_b16 v[50:51], v20 offset:1024
    s_waitcnt lgkmcnt(6)
    v_mfma_f32_16x16x32_bf16 a[48:51], v[56:59], v[32:35], a[48:51]
    v_mfma_f32_16x16x32_bf16 a[52:55], v[56:59], v[36:39], a[52:55]
    s_add_u32 m0, s51, 32768
    s_add_u32 s52, s47, 0
    buffer_load_dwordx4 v10, s[8:11], s52 offen lds
    ds_read_b64_tr_b16 v[52:53], v21 offset:0
    ds_read_b64_tr_b16 v[54:55], v21 offset:1024
    s_waitcnt lgkmcnt(6)
    v_mfma_f32_16x16x32_bf16 a[56:59], v[60:63], v[32:35], a[56:59]
    v_mfma_f32_16x16x32_bf16 a[60:63], v[60:63], v[36:39], a[60:63]
    s_add_u32 m0, s51, 33792
    s_add_u32 s52, s47, 20480
    buffer_load_dwordx4 v10, s[8:11], s52 offen lds
    s_add_u32 s46, s46, 262144
    s_add_u32 s47, s47, 64
    ds_read_b64_tr_b16 v[56:57], v22 offset:0
    ds_read_b64_tr_b16 v[58:59], v22 offset:1024
    s_waitcnt lgkmcnt(6)
    s_waitcnt lgkmcnt(4)
    v_mfma_f32_16x16x32_bf16 a[0:3], v[48:51], v[40:43], a[0:3]
    v_mfma_f32_16x16x32_bf16 a[4:7], v[48:51], v[44:47], a[4:7]
    ds_read_b64_tr_b16 v[60:61], v23 offset:0
    ds_read_b64_tr_b16 v[62:63], v23 offset:1024
    s_waitcnt lgkmcnt(4)
    v_mfma_f32_16x16x32_bf16 a[8:11], v[52:55], v[40:43], a[8:11]
    v_mfma_f32_16x16x32_bf16 a[12:15], v[52:55], v[44:47], a[12:15]
    ds_read_b64_tr_b16 v[48:49], v24 offset:0
    ds_read_b64_tr_b16 v[50:51], v24 offset:1024
    s_waitcnt lgkmcnt(4)
    v_mfma_f32_16x16x32_bf16 a[16:19], v[56:59], v[40:43], a[16:19]
    v_mfma_f32_16x16x32_bf16 a[20:23], v[56:59], v[44:47], a[20:23]
    ds_read_b64_tr_b16 v[52:53], v25 offset:0
    ds_read_b64_tr_b16 v[54:55], v25 offset:1024
    s_waitcnt lgkmcnt(4)
    v_mfma_f32_16x16x32_bf16 a[24:27], v[60:63], v[40:43], a[24:27]
    v_mfma_f32_16x16x32_bf16 a[28:31], v[60:63], v[44:47], a[28:31]
    s_waitcnt vmcnt(8)
    s_barrier
    ds_read_b64_tr_b16 v[56:57], v26 offset:0
    ds_read_b64_tr_b16 v[58:59], v26 offset:1024
    s_waitcnt lgkmcnt(4)
    v_mfma_f32_16x16x32_bf16 a[32:35], v[48:51], v[40:43], a[32:35]
    v_mfma_f32_16x16x32_bf16 a[36:39], v[48:51], v[44:47], a[36:39]
    s_add_u32 m0, s50, 49152
    s_add_u32 s52, s46, 0x0
    buffer_load_dwordx4 v9, s[16:19], s52 offen lds
    ds_read_b64_tr_b16 v[60:61], v27 offset:0
    ds_read_b64_tr_b16 v[62:63], v27 offset:1024
    s_waitcnt lgkmcnt(4)
    v_mfma_f32_16x16x32_bf16 a[40:43], v[52:55], v[40:43], a[40:43]
    v_mfma_f32_16x16x32_bf16 a[44:47], v[52:55], v[44:47], a[44:47]
    s_add_u32 m0, s50, 50176
    s_add_u32 s52, s46, 0x8000
    buffer_load_dwordx4 v9, s[16:19], s52 offen lds
    ds_read_b128 v[32:35], v28 offset:0
    ds_read_b128 v[36:39], v28 offset:1024
    ds_read_b64_tr_b16 v[48:49], v12 offset:0
    ds_read_b64_tr_b16 v[50:51], v12 offset:1024
    s_waitcnt lgkmcnt(6)
    v_mfma_f32_16x16x32_bf16 a[48:51], v[56:59], v[40:43], a[48:51]
    v_mfma_f32_16x16x32_bf16 a[52:55], v[56:59], v[44:47], a[52:55]
    s_add_u32 m0, s51, 49152
    s_add_u32 s52, s47, 0
    buffer_load_dwordx4 v10, s[8:11], s52 offen lds
    ds_read_b64_tr_b16 v[52:53], v13 offset:0
    ds_read_b64_tr_b16 v[54:55], v13 offset:1024
    s_waitcnt lgkmcnt(6)
    v_mfma_f32_16x16x32_bf16 a[56:59], v[60:63], v[40:43], a[56:59]
    v_mfma_f32_16x16x32_bf16 a[60:63], v[60:63], v[44:47], a[60:63]
    s_add_u32 m0, s51, 50176
    s_add_u32 s52, s47, 20480
    buffer_load_dwordx4 v10, s[8:11], s52 offen lds
    s_add_u32 s46, s46, 262144
    s_add_u32 s47, s47, 64
    s_add_u32 s43, s43, 1
    s_cmp_lt_u32 s43, 2
    s_cbranch_scc1 Lpg_89
    s_waitcnt vmcnt(0) lgkmcnt(0)
    s_barrier
    s_nop 3
    v_or_b32 v6, 0, v3
    v_lshrrev_b32 v7, 1, v2
    v_xor_b32 v7, v7, v6
    v_and_b32 v8, 1, v2
    v_lshl_add_u32 v7, v7, 1, v8
    v_lshlrev_b32 v7, 4, v7
    v_mul_u32_u24 v8, 1280, v3
    v_add_u32 v7, v7, v8
    s_lshl_b32 s44, s41, 7
    s_lshl_b32 s45, s42, 5
    s_add_u32 s44, s44, s45
    s_mul_i32 s44, s44, 1280
    v_add_u32 v9, s44, v7
    v_or_b32 v6, 4, v3
    v_lshrrev_b32 v7, 1, v2
    v_xor_b32 v7, v7, v6
    v_and_b32 v8, 1, v2
    v_lshl_add_u32 v7, v7, 1, v8
    v_lshlrev_b32 v7, 4, v7
    v_mul_u32_u24 v8, 1280, v3
    v_add_u32 v7, v7, v8
    s_lshl_b32 s44, s41, 7
    s_lshl_b32 s45, s42, 5
    s_add_u32 s44, s44, s45
    s_mul_i32 s44, s44, 1280
    v_add_u32 v10, s44, v7
    s_lshl_b32 s50, s42, 13
    s_add_u32 m0, s50, 0
    s_mov_b32 s52, 0
    buffer_load_dwordx4 v9, s[20:23], s52 offen lds
    s_add_u32 m0, s50, 1024
    s_mov_b32 s52, 5120
    buffer_load_dwordx4 v10, s[20:23], s52 offen lds
    s_add_u32 m0, s50, 2048
    s_mov_b32 s52, 10240
    buffer_load_dwordx4 v9, s[20:23], s52 offen lds
    s_add_u32 m0, s50, 3072
    s_mov_b32 s52, 15360
    buffer_load_dwordx4 v10, s[20:23], s52 offen lds
    s_add_u32 m0, s50, 4096
    s_mov_b32 s52, 20480
    buffer_load_dwordx4 v9, s[20:23], s52 offen lds
    s_add_u32 m0, s50, 5120
    s_mov_b32 s52, 25600
    buffer_load_dwordx4 v10, s[20:23], s52 offen lds
    s_add_u32 m0, s50, 6144
    s_mov_b32 s52, 30720
    buffer_load_dwordx4 v9, s[20:23], s52 offen lds
    s_add_u32 m0, s50, 7168
    s_mov_b32 s52, 35840
    buffer_load_dwordx4 v10, s[20:23], s52 offen lds
    s_add_u32 m0, s50, 32768
    s_mov_b32 s52, 256
    buffer_load_dwordx4 v9, s[20:23], s52 offen lds
    s_add_u32 m0, s50, 33792
    s_mov_b32 s52, 5376
    buffer_load_dwordx4 v10, s[20:23], s52 offen lds
    s_add_u32 m0, s50, 34816
    s_mov_b32 s52, 10496
    buffer_load_dwordx4 v9, s[20:23], s52 offen lds
    s_add_u32 m0, s50, 35840
    s_mov_b32 s52, 15616
    buffer_load_dwordx4 v10, s[20:23], s52 offen lds
    s_add_u32 m0, s50, 36864
    s_mov_b32 s52, 20736
    buffer_load_dwordx4 v9, s[20:23], s52 offen lds
    s_add_u32 m0, s50, 37888
    s_mov_b32 s52, 25856
    buffer_load_dwordx4 v10, s[20:23], s52 offen lds
    s_add_u32 m0, s50, 38912
    s_mov_b32 s52, 30976
    buffer_load_dwordx4 v9, s[20:23], s52 offen lds
    s_add_u32 m0, s50, 39936
    s_mov_b32 s52, 36096
    buffer_load_dwordx4 v10, s[20:23], s52 offen lds
    s_add_u32 m0, s50, 65536
    s_mov_b32 s52, 512
    buffer_load_dwordx4 v9, s[20:23], s52 offen lds
    s_add_u32 m0, s50, 66560
    s_mov_b32 s52, 5632
    buffer_load_dwordx4 v10, s[20:23], s52 offen lds
    s_add_u32 m0, s50, 67584
    s_mov_b32 s52, 10752
    buffer_load_dwordx4 v9, s[20:23], s52 offen lds
    s_add_u32 m0, s50, 68608
    s_mov_b32 s52, 15872
    buffer_load_dwordx4 v10, s[20:23], s52 offen lds
    s_add_u32 m0, s50, 69632
    s_mov_b32 s52, 20992
    buffer_load_dwordx4 v9, s[20:23], s52 offen lds
    s_add_u32 m0, s50, 70656
    s_mov_b32 s52, 26112
    buffer_load_dwordx4 v10, s[20:23], s52 offen lds
    s_add_u32 m0, s50, 71680
    s_mov_b32 s52, 31232
    buffer_load_dwordx4 v9, s[20:23], s52 offen lds
    s_add_u32 m0, s50, 72704
    s_mov_b32 s52, 36352
    buffer_load_dwordx4 v10, s[20:23], s52 offen lds
    s_add_u32 m0, s50, 98304
    s_mov_b32 s52, 768
    buffer_load_dwordx4 v9, s[20:23], s52 offen lds
    s_add_u32 m0, s50, 99328
    s_mov_b32 s52, 5888
    buffer_load_dwordx4 v10, s[20:23], s52 offen lds
    s_add_u32 m0, s50, 100352
    s_mov_b32 s52, 11008
    buffer_load_dwordx4 v9, s[20:23], s52 offen lds
    s_add_u32 m0, s50, 101376
    s_mov_b32 s52, 16128
    buffer_load_dwordx4 v10, s[20:23], s52 offen lds
    s_add_u32 m0, s50, 102400
    s_mov_b32 s52, 21248
    buffer_load_dwordx4 v9, s[20:23], s52 offen lds
    s_add_u32 m0, s50, 103424
    s_mov_b32 s52, 26368
    buffer_load_dwordx4 v10, s[20:23], s52 offen lds
    s_add_u32 m0, s50, 104448
    s_mov_b32 s52, 31488
    buffer_load_dwordx4 v9, s[20:23], s52 offen lds
    s_add_u32 m0, s50, 105472
    s_mov_b32 s52, 36608
    buffer_load_dwordx4 v10, s[20:23], s52 offen lds
    v_lshrrev_b32 v6, 2, v2
    v_lshl_add_u32 v6, v3, 2, v6
    v_and_b32 v7, 7, v6
    v_lshlrev_b32 v6, 8, v6
    v_and_b32 v8, 3, v2
    v_lshl_add_u32 v6, v8, 3, v6
    v_xor_b32 v8, 0, v7
    v_lshl_add_u32 v12, v8, 5, v6
    v_add_u32 v20, 0x10000, v12
    v_xor_b32 v8, 1, v7
    v_lshl_add_u32 v13, v8, 5, v6
    v_add_u32 v21, 0x10000, v13
    v_xor_b32 v8, 2, v7
    v_lshl_add_u32 v14, v8, 5, v6
    v_add_u32 v22, 0x10000, v14
    v_xor_b32 v8, 3, v7
    v_lshl_add_u32 v15, v8, 5, v6
    v_add_u32 v23, 0x10000, v15
    v_xor_b32 v8, 4, v7
    v_lshl_add_u32 v16, v8, 5, v6
    v_add_u32 v24, 0x10000, v16
    v_xor_b32 v8, 5, v7
    v_lshl_add_u32 v17, v8, 5, v6
    v_add_u32 v25, 0x10000, v17
    v_xor_b32 v8, 6, v7
    v_lshl_add_u32 v18, v8, 5, v6
    v_add_u32 v26, 0x10000, v18
    v_xor_b32 v8, 7, v7
    v_lshl_add_u32 v19, v8, 5, v6
    v_add_u32 v27, 0x10000, v19
    s_lshl_b32 s44, s40, 2
    s_add_u32 s44, s44, s42
    s_mul_i32 s44, s44, 32
    s_add_u32 s44, s44, s41
    s_lshl_b32 s48, s44, 13
    v_lshlrev_b32 v28, 4, v1
    v_add_u32 v28, s48, v28
    s_mul_i32 s48, s44, 40960
    v_and_b32 v6, 7, v2
    v_lshl_add_u32 v6, v3, 3, v6
    v_lshlrev_b32 v6, 4, v6
    v_lshrrev_b32 v7, 3, v2
    v_lshl_add_u32 v6, v7, 9, v6
    v_add_u32 v29, s48, v6
    v_accvgpr_read_b32 v32, a0
    v_accvgpr_read_b32 v33, a1
    v_accvgpr_read_b32 v34, a2
    v_accvgpr_read_b32 v35, a3
    v_cvt_pk_bf16_f32 v72, v32, v33
    v_cvt_pk_bf16_f32 v73, v34, v35
    v_accvgpr_read_b32 v36, a8
    v_accvgpr_read_b32 v37, a9
    v_accvgpr_read_b32 v38, a10
    v_accvgpr_read_b32 v39, a11
    v_cvt_pk_bf16_f32 v74, v36, v37
    v_cvt_pk_bf16_f32 v75, v38, v39
    s_mov_b32 s45, 0x1000000
    buffer_store_dwordx4 v[72:75], v28, s[4:7], s45 offen sc1
    v_accvgpr_read_b32 v32, a16
    v_accvgpr_read_b32 v33, a17
    v_accvgpr_read_b32 v34, a18
    v_accvgpr_read_b32 v35, a19
    v_cvt_pk_bf16_f32 v76, v32, v33
    v_cvt_pk_bf16_f32 v77, v34, v35
    v_accvgpr_read_b32 v36, a24
    v_accvgpr_read_b32 v37, a25
    v_accvgpr_read_b32 v38, a26
    v_accvgpr_read_b32 v39, a27
    v_cvt_pk_bf16_f32 v78, v36, v37
    v_cvt_pk_bf16_f32 v79, v38, v39
    s_mov_b32 s45, 0x1000400
    buffer_store_dwordx4 v[76:79], v28, s[4:7], s45 offen sc1
    v_accvgpr_read_b32 v32, a32
    v_accvgpr_read_b32 v33, a33
    v_accvgpr_read_b32 v34, a34
    v_accvgpr_read_b32 v35, a35
    v_cvt_pk_bf16_f32 v80, v32, v33
    v_cvt_pk_bf16_f32 v81, v34, v35
    v_accvgpr_read_b32 v36, a40
    v_accvgpr_read_b32 v37, a41
    v_accvgpr_read_b32 v38, a42
    v_accvgpr_read_b32 v39, a43
    v_cvt_pk_bf16_f32 v82, v36, v37
    v_cvt_pk_bf16_f32 v83, v38, v39
    s_mov_b32 s45, 0x1000800
    buffer_store_dwordx4 v[80:83], v28, s[4:7], s45 offen sc1
    v_accvgpr_read_b32 v32, a48
    v_accvgpr_read_b32 v33, a49
    v_accvgpr_read_b32 v34, a50
    v_accvgpr_read_b32 v35, a51
    v_cvt_pk_bf16_f32 v84, v32, v33
    v_cvt_pk_bf16_f32 v85, v34, v35
    v_accvgpr_read_b32 v36, a56
    v_accvgpr_read_b32 v37, a57
    v_accvgpr_read_b32 v38, a58
    v_accvgpr_read_b32 v39, a59
    v_cvt_pk_bf16_f32 v86, v36, v37
    v_cvt_pk_bf16_f32 v87, v38, v39
    s_mov_b32 s45, 0x1000c00
    buffer_store_dwordx4 v[84:87], v28, s[4:7], s45 offen sc1
    v_accvgpr_read_b32 v32, a4
    v_accvgpr_read_b32 v33, a5
    v_accvgpr_read_b32 v34, a6
    v_accvgpr_read_b32 v35, a7
    v_cvt_pk_bf16_f32 v88, v32, v33
    v_cvt_pk_bf16_f32 v89, v34, v35
    v_accvgpr_read_b32 v36, a12
    v_accvgpr_read_b32 v37, a13
    v_accvgpr_read_b32 v38, a14
    v_accvgpr_read_b32 v39, a15
    v_cvt_pk_bf16_f32 v90, v36, v37
    v_cvt_pk_bf16_f32 v91, v38, v39
    s_mov_b32 s45, 0x1001000
    buffer_store_dwordx4 v[88:91], v28, s[4:7], s45 offen sc1
    v_accvgpr_read_b32 v32, a20
    v_accvgpr_read_b32 v33, a21
    v_accvgpr_read_b32 v34, a22
    v_accvgpr_read_b32 v35, a23
    v_cvt_pk_bf16_f32 v92, v32, v33
    v_cvt_pk_bf16_f32 v93, v34, v35
    v_accvgpr_read_b32 v36, a28
    v_accvgpr_read_b32 v37, a29
    v_accvgpr_read_b32 v38, a30
    v_accvgpr_read_b32 v39, a31
    v_cvt_pk_bf16_f32 v94, v36, v37
    v_cvt_pk_bf16_f32 v95, v38, v39
    s_mov_b32 s45, 0x1001400
    buffer_store_dwordx4 v[92:95], v28, s[4:7], s45 offen sc1
    v_accvgpr_read_b32 v32, a36
    v_accvgpr_read_b32 v33, a37
    v_accvgpr_read_b32 v34, a38
    v_accvgpr_read_b32 v35, a39
    v_cvt_pk_bf16_f32 v96, v32, v33
    v_cvt_pk_bf16_f32 v97, v34, v35
    v_accvgpr_read_b32 v36, a44
    v_accvgpr_read_b32 v37, a45
    v_accvgpr_read_b32 v38, a46
    v_accvgpr_read_b32 v39, a47
    v_cvt_pk_bf16_f32 v98, v36, v37
    v_cvt_pk_bf16_f32 v99, v38, v39
    s_mov_b32 s45, 0x1001800
    buffer_store_dwordx4 v[96:99], v28, s[4:7], s45 offen sc1
    v_accvgpr_read_b32 v32, a52
    v_accvgpr_read_b32 v33, a53
    v_accvgpr_read_b32 v34, a54
    v_accvgpr_read_b32 v35, a55
    v_cvt_pk_bf16_f32 v100, v32, v33
    v_cvt_pk_bf16_f32 v101, v34, v35
    v_accvgpr_read_b32 v36, a60
    v_accvgpr_read_b32 v37, a61
    v_accvgpr_read_b32 v38, a62
    v_accvgpr_read_b32 v39, a63
    v_cvt_pk_bf16_f32 v102, v36, v37
    v_cvt_pk_bf16_f32 v103, v38, v39
    s_mov_b32 s45, 0x1001c00
    buffer_store_dwordx4 v[100:103], v28, s[4:7], s45 offen sc1
    s_waitcnt vmcnt(32)
    s_barrier
    s_mov_b64 s[92:93], s[72:73]
    s_mov_b64 s[72:73], s[92:93]
    s_cmp_lg_u32 s97, 0
    s_cbranch_scc1 Lcf_90
    s_cmp_lg_u32 s42, 0
    s_cbranch_scc1 Lcf0_91
    s_load_dwordx2 s[88:89], s[0:1], 88
    v_and_b32 v4, 7, v0
    v_lshlrev_b32 v4, 5, v4
    v_bfe_u32 v5, v0, 3, 1
    v_lshl_add_u32 v4, v5, 2, v4
    v_add_u32 v4, 16, v4
    s_mov_b64 exec, 0xffff
    s_mov_b32 s43, 0
    s_waitcnt lgkmcnt(0)
    s_and_b32 s89, s89, 0xffff
    s_mov_b32 s90, 256
    s_mov_b32 s91, 0x00020000
Lcfp_92:
    buffer_load_dword v5, v4, s[88:91], 0 offen sc1
    s_waitcnt vmcnt(0)
    v_readlane_b32 s60, v5, 0
    v_readlane_b32 s61, v5, 1
    v_readlane_b32 s62, v5, 2
    v_readlane_b32 s63, v5, 3
    v_readlane_b32 s64, v5, 4
    v_readlane_b32 s65, v5, 5
    v_readlane_b32 s66, v5, 6
    v_readlane_b32 s67, v5, 7
    v_readlane_b32 s48, v5, 8
    v_readlane_b32 s49, v5, 9
    s_nop 3
    s_add_u32 s48, s48, s49
    v_readlane_b32 s49, v5, 10
    s_nop 3
    s_add_u32 s48, s48, s49
    v_readlane_b32 s49, v5, 11
    s_nop 3
    s_add_u32 s48, s48, s49
    v_readlane_b32 s49, v5, 12
    s_nop 3
    s_add_u32 s48, s48, s49
    v_readlane_b32 s49, v5, 13
    s_nop 3
    s_add_u32 s48, s48, s49
    v_readlane_b32 s49, v5, 14
    s_nop 3
    s_add_u32 s48, s48, s49
    v_readlane_b32 s49, v5, 15
    s_nop 3
    s_add_u32 s48, s48, s49
    s_add_u32 s43, s43, 1
    s_cmp_gt_u32 s43, 400000
    s_cbranch_scc0 Lcfo_93
    s_endpgm
Lcfo_93:
    s_cmp_lt_u32 s48, 256
    s_cbranch_scc1 Lcfp_92
    s_min_u32 s48, s60, s61
    s_min_u32 s48, s48, s62
    s_min_u32 s48, s48, s63
    s_min_u32 s48, s48, s64
    s_min_u32 s48, s48, s65
    s_min_u32 s48, s48, s66
    s_min_u32 s48, s48, s67
    s_mov_b32 s49, s99
    s_cmp_gt_u32 s98, 0
    s_cselect_b32 s43, s60, 0
    s_add_u32 s49, s49, s43
    s_cmp_gt_u32 s98, 1
    s_cselect_b32 s43, s61, 0
    s_add_u32 s49, s49, s43
    s_cmp_gt_u32 s98, 2
    s_cselect_b32 s43, s62, 0
    s_add_u32 s49, s49, s43
    s_cmp_gt_u32 s98, 3
    s_cselect_b32 s43, s63, 0
    s_add_u32 s49, s49, s43
    s_cmp_gt_u32 s98, 4
    s_cselect_b32 s43, s64, 0
    s_add_u32 s49, s49, s43
    s_cmp_gt_u32 s98, 5
    s_cselect_b32 s43, s65, 0
    s_add_u32 s49, s49, s43
    s_cmp_gt_u32 s98, 6
    s_cselect_b32 s43, s66, 0
    s_add_u32 s49, s49, s43
    s_or_b32 s49, s49, 0x300
    s_lshl_b32 s43, s98, 5
    s_add_u32 s43, s43, s99
    s_or_b32 s43, s43, 0x200
    s_cmp_ge_u32 s48, 32
    s_cselect_b32 s43, s43, s49
    s_mov_b64 exec, 1
    v_mov_b32 v4, 163824
    v_mov_b32 v5, s43
    ds_write_b32 v4, v5
    s_waitcnt lgkmcnt(0)
    s_mov_b64 exec, -1
Lcf0_91:
    s_barrier
    v_mov_b32 v4, 163824
    ds_read_b32 v5, v4
    s_waitcnt lgkmcnt(0)
    v_readfirstlane_b32 s97, v5
    s_nop 3
    s_barrier
    s_bitcmp1_b32 s97, 8
    s_cbranch_scc0 Lcf_90
    s_branch Lentry_3
Lcf_90:
    s_mov_b64 s[92:93], s[72:73]
    s_mov_b64 s[72:73], s[92:93]
    s_mov_b32 s53, 0x2000000
    s_mov_b32 s54, 0
    ds_read_b64_tr_b16 v[40:41], v12 offset:0
    ds_read_b64_tr_b16 v[42:43], v12 offset:4096
    ds_read_b64_tr_b16 v[44:45], v12 offset:8192
    ds_read_b64_tr_b16 v[46:47], v12 offset:12288
    ds_read_b64_tr_b16 v[48:49], v12 offset:16384
    ds_read_b64_tr_b16 v[50:51], v12 offset:20480
    ds_read_b64_tr_b16 v[52:53], v12 offset:24576
    ds_read_b64_tr_b16 v[54:55], v12 offset:28672
    v_add_u32 v12, 0x8000, v12
    v_and_b32 v12, 0x1ffff, v12
Lu_94:
    ds_read_b64_tr_b16 v[56:57], v13 offset:0
    ds_read_b64_tr_b16 v[58:59], v13 offset:4096
    ds_read_b64_tr_b16 v[60:61], v13 offset:8192
    ds_read_b64_tr_b16 v[62:63], v13 offset:12288
    ds_read_b64_tr_b16 v[64:65], v13 offset:16384
    ds_read_b64_tr_b16 v[66:67], v13 offset:20480
    ds_read_b64_tr_b16 v[68:69], v13 offset:24576
    ds_read_b64_tr_b16 v[70:71], v13 offset:28672
    v_add_u32 v13, 0x8000, v13
    v_and_b32 v13, 0x1ffff, v13
    s_waitcnt lgkmcnt(8)
    v_mfma_f32_16x16x32_bf16 v[104:107], v[72:75], v[40:43], 0
    v_mfma_f32_16x16x32_bf16 v[108:111], v[88:91], v[40:43], 0
    v_mfma_f32_16x16x32_bf16 v[104:107], v[76:79], v[44:47], v[104:107]
    v_mfma_f32_16x16x32_bf16 v[108:111], v[92:95], v[44:47], v[108:111]
    v_mfma_f32_16x16x32_bf16 v[104:107], v[80:83], v[48:51], v[104:107]
    v_mfma_f32_16x16x32_bf16 v[108:111], v[96:99], v[48:51], v[108:111]
    v_mfma_f32_16x16x32_bf16 v[104:107], v[84:87], v[52:55], v[104:107]
    v_mfma_f32_16x16x32_bf16 v[108:111], v[100:103], v[52:55], v[108:111]
    s_cmp_eq_u32 s54, 0
    s_cbranch_scc1 Lsk_95
    v_cvt_pk_bf16_f32 v124, v112, v113
    v_cvt_pk_bf16_f32 v125, v114, v115
    v_cvt_pk_bf16_f32 v126, v116, v117
    v_cvt_pk_bf16_f32 v127, v118, v119
    s_add_u32 s45, s53, 0x0
    buffer_store_dwordx4 v[124:127], v29, s[4:7], s45 offen sc1
    s_add_u32 s53, s53, 1024
Lsk_95:
    ds_read_b64_tr_b16 v[40:41], v14 offset:0
    ds_read_b64_tr_b16 v[42:43], v14 offset:4096
    ds_read_b64_tr_b16 v[44:45], v14 offset:8192
    ds_read_b64_tr_b16 v[46:47], v14 offset:12288
    ds_read_b64_tr_b16 v[48:49], v14 offset:16384
    ds_read_b64_tr_b16 v[50:51], v14 offset:20480
    ds_read_b64_tr_b16 v[52:53], v14 offset:24576
    ds_read_b64_tr_b16 v[54:55], v14 offset:28672
    v_add_u32 v14, 0x8000, v14
    v_and_b32 v14, 0x1ffff, v14
    s_waitcnt lgkmcnt(8)
    v_mfma_f32_16x16x32_bf16 v[112:115], v[72:75], v[56:59], 0
    v_mfma_f32_16x16x32_bf16 v[116:119], v[88:91], v[56:59], 0
    v_mfma_f32_16x16x32_bf16 v[112:115], v[76:79], v[60:63], v[112:115]
    v_mfma_f32_16x16x32_bf16 v[116:119], v[92:95], v[60:63], v[116:119]
    v_mfma_f32_16x16x32_bf16 v[112:115], v[80:83], v[64:67], v[112:115]
    v_mfma_f32_16x16x32_bf16 v[116:119], v[96:99], v[64:67], v[116:119]
    v_mfma_f32_16x16x32_bf16 v[112:115], v[84:87], v[68:71], v[112:115]
    v_mfma_f32_16x16x32_bf16 v[116:119], v[100:103], v[68:71], v[116:119]
    v_cvt_pk_bf16_f32 v120, v104, v105
    v_cvt_pk_bf16_f32 v121, v106, v107
    v_cvt_pk_bf16_f32 v122, v108, v109
    v_cvt_pk_bf16_f32 v123, v110, v111
    s_add_u32 s45, s53, 0x0
    buffer_store_dwordx4 v[120:123], v29, s[4:7], s45 offen sc1
    s_add_u32 s53, s53, 1024
    ds_read_b64_tr_b16 v[56:57], v15 offset:0
    ds_read_b64_tr_b16 v[58:59], v15 offset:4096
    ds_read_b64_tr_b16 v[60:61], v15 offset:8192
    ds_read_b64_tr_b16 v[62:63], v15 offset:12288
    ds_read_b64_tr_b16 v[64:65], v15 offset:16384
    ds_read_b64_tr_b16 v[66:67], v15 offset:20480
    ds_read_b64_tr_b16 v[68:69], v15 offset:24576
    ds_read_b64_tr_b16 v[70:71], v15 offset:28672
    v_add_u32 v15, 0x8000, v15
    v_and_b32 v15, 0x1ffff, v15
    s_waitcnt lgkmcnt(8)
    v_mfma_f32_16x16x32_bf16 v[104:107], v[72:75], v[40:43], 0
    v_mfma_f32_16x16x32_bf16 v[108:111], v[88:91], v[40:43], 0
    v_mfma_f32_16x16x32_bf16 v[104:107], v[76:79], v[44:47], v[104:107]
    v_mfma_f32_16x16x32_bf16 v[108:111], v[92:95], v[44:47], v[108:111]
    v_mfma_f32_16x16x32_bf16 v[104:107], v[80:83], v[48:51], v[104:107]
    v_mfma_f32_16x16x32_bf16 v[108:111], v[96:99], v[48:51], v[108:111]
    v_mfma_f32_16x16x32_bf16 v[104:107], v[84:87], v[52:55], v[104:107]
    v_mfma_f32_16x16x32_bf16 v[108:111], v[100:103], v[52:55], v[108:111]
    v_cvt_pk_bf16_f32 v124, v112, v113
    v_cvt_pk_bf16_f32 v125, v114, v115
    v_cvt_pk_bf16_f32 v126, v116, v117
    v_cvt_pk_bf16_f32 v127, v118, v119
    s_add_u32 s45, s53, 0x0
    buffer_store_dwordx4 v[124:127], v29, s[4:7], s45 offen sc1
    s_add_u32 s53, s53, 1024
    ds_read_b64_tr_b16 v[40:41], v16 offset:0
    ds_read_b64_tr_b16 v[42:43], v16 offset:4096
    ds_read_b64_tr_b16 v[44:45], v16 offset:8192
    ds_read_b64_tr_b16 v[46:47], v16 offset:12288
    ds_read_b64_tr_b16 v[48:49], v16 offset:16384
    ds_read_b64_tr_b16 v[50:51], v16 offset:20480
    ds_read_b64_tr_b16 v[52:53], v16 offset:24576
    ds_read_b64_tr_b16 v[54:55], v16 offset:28672
    v_add_u32 v16, 0x8000, v16
    v_and_b32 v16, 0x1ffff, v16
    s_waitcnt lgkmcnt(8)
    v_mfma_f32_16x16x32_bf16 v[112:115], v[72:75], v[56:59], 0
    v_mfma_f32_16x16x32_bf16 v[116:119], v[88:91], v[56:59], 0
    v_mfma_f32_16x16x32_bf16 v[112:115], v[76:79], v[60:63], v[112:115]
    v_mfma_f32_16x16x32_bf16 v[116:119], v[92:95], v[60:63], v[116:119]
    v_mfma_f32_16x16x32_bf16 v[112:115], v[80:83], v[64:67], v[112:115]
    v_mfma_f32_16x16x32_bf16 v[116:119], v[96:99], v[64:67], v[116:119]
    v_mfma_f32_16x16x32_bf16 v[112:115], v[84:87], v[68:71], v[112:115]
    v_mfma_f32_16x16x32_bf16 v[116:119], v[100:103], v[68:71], v[116:119]
    v_cvt_pk_bf16_f32 v120, v104, v105
    v_cvt_pk_bf16_f32 v121, v106, v107
    v_cvt_pk_bf16_f32 v122, v108, v109
    v_cvt_pk_bf16_f32 v123, v110, v111
    s_add_u32 s45, s53, 0x0
    buffer_store_dwordx4 v[120:123], v29, s[4:7], s45 offen sc1
    s_add_u32 s53, s53, 1024
    ds_read_b64_tr_b16 v[56:57], v17 offset:0
    ds_read_b64_tr_b16 v[58:59], v17 offset:4096
    ds_read_b64_tr_b16 v[60:61], v17 offset:8192
    ds_read_b64_tr_b16 v[62:63], v17 offset:12288
    ds_read_b64_tr_b16 v[64:65], v17 offset:16384
    ds_read_b64_tr_b16 v[66:67], v17 offset:20480
    ds_read_b64_tr_b16 v[68:69], v17 offset:24576
    ds_read_b64_tr_b16 v[70:71], v17 offset:28672
    v_add_u32 v17, 0x8000, v17
    v_and_b32 v17, 0x1ffff, v17
    s_waitcnt lgkmcnt(8)
    v_mfma_f32_16x16x32_bf16 v[104:107], v[72:75], v[40:43], 0
    v_mfma_f32_16x16x32_bf16 v[108:111], v[88:91], v[40:43], 0
    v_mfma_f32_16x16x32_bf16 v[104:107], v[76:79], v[44:47], v[104:107]
    v_mfma_f32_16x16x32_bf16 v[108:111], v[92:95], v[44:47], v[108:111]
    v_mfma_f32_16x16x32_bf16 v[104:107], v[80:83], v[48:51], v[104:107]
    v_mfma_f32_16x16x32_bf16 v[108:111], v[96:99], v[48:51], v[108:111]
    v_mfma_f32_16x16x32_bf16 v[104:107], v[84:87], v[52:55], v[104:107]
    v_mfma_f32_16x16x32_bf16 v[108:111], v[100:103], v[52:55], v[108:111]
    v_cvt_pk_bf16_f32 v124, v112, v113
    v_cvt_pk_bf16_f32 v125, v114, v115
    v_cvt_pk_bf16_f32 v126, v116, v117
    v_cvt_pk_bf16_f32 v127, v118, v119
    s_add_u32 s45, s53, 0x0
    buffer_store_dwordx4 v[124:127], v29, s[4:7], s45 offen sc1
    s_add_u32 s53, s53, 1024
    ds_read_b64_tr_b16 v[40:41], v18 offset:0
    ds_read_b64_tr_b16 v[42:43], v18 offset:4096
    ds_read_b64_tr_b16 v[44:45], v18 offset:8192
    ds_read_b64_tr_b16 v[46:47], v18 offset:12288
    ds_read_b64_tr_b16 v[48:49], v18 offset:16384
    ds_read_b64_tr_b16 v[50:51], v18 offset:20480
    ds_read_b64_tr_b16 v[52:53], v18 offset:24576
    ds_read_b64_tr_b16 v[54:55], v18 offset:28672
    v_add_u32 v18, 0x8000, v18
    v_and_b32 v18, 0x1ffff, v18
    s_waitcnt lgkmcnt(8)
    v_mfma_f32_16x16x32_bf16 v[112:115], v[72:75], v[56:59], 0
    v_mfma_f32_16x16x32_bf16 v[116:119], v[88:91], v[56:59], 0
    v_mfma_f32_16x16x32_bf16 v[112:115], v[76:79], v[60:63], v[112:115]
    v_mfma_f32_16x16x32_bf16 v[116:119], v[92:95], v[60:63], v[116:119]
    v_mfma_f32_16x16x32_bf16 v[112:115], v[80:83], v[64:67], v[112:115]
    v_mfma_f32_16x16x32_bf16 v[116:119], v[96:99], v[64:67], v[116:119]
    v_mfma_f32_16x16x32_bf16 v[112:115], v[84:87], v[68:71], v[112:115]
    v_mfma_f32_16x16x32_bf16 v[116:119], v[100:103], v[68:71], v[116:119]
    v_cvt_pk_bf16_f32 v120, v104, v105
    v_cvt_pk_bf16_f32 v121, v106, v107
    v_cvt_pk_bf16_f32 v122, v108, v109
    v_cvt_pk_bf16_f32 v123, v110, v111
    s_add_u32 s45, s53, 0x0
    buffer_store_dwordx4 v[120:123], v29, s[4:7], s45 offen sc1
    s_add_u32 s53, s53, 1024
    ds_read_b64_tr_b16 v[56:57], v19 offset:0
    ds_read_b64_tr_b16 v[58:59], v19 offset:4096
    ds_read_b64_tr_b16 v[60:61], v19 offset:8192
    ds_read_b64_tr_b16 v[62:63], v19 offset:12288
    ds_read_b64_tr_b16 v[64:65], v19 offset:16384
    ds_read_b64_tr_b16 v[66:67], v19 offset:20480
    ds_read_b64_tr_b16 v[68:69], v19 offset:24576
    ds_read_b64_tr_b16 v[70:71], v19 offset:28672
    v_add_u32 v19, 0x8000, v19
    v_and_b32 v19, 0x1ffff, v19
    s_waitcnt lgkmcnt(8)
    v_mfma_f32_16x16x32_bf16 v[104:107], v[72:75], v[40:43], 0
    v_mfma_f32_16x16x32_bf16 v[108:111], v[88:91], v[40:43], 0
    v_mfma_f32_16x16x32_bf16 v[104:107], v[76:79], v[44:47], v[104:107]
    v_mfma_f32_16x16x32_bf16 v[108:111], v[92:95], v[44:47], v[108:111]
    v_mfma_f32_16x16x32_bf16 v[104:107], v[80:83], v[48:51], v[104:107]
    v_mfma_f32_16x16x32_bf16 v[108:111], v[96:99], v[48:51], v[108:111]
    v_mfma_f32_16x16x32_bf16 v[104:107], v[84:87], v[52:55], v[104:107]
    v_mfma_f32_16x16x32_bf16 v[108:111], v[100:103], v[52:55], v[108:111]
    v_cvt_pk_bf16_f32 v124, v112, v113
    v_cvt_pk_bf16_f32 v125, v114, v115
    v_cvt_pk_bf16_f32 v126, v116, v117
    v_cvt_pk_bf16_f32 v127, v118, v119
    s_add_u32 s45, s53, 0x0
    buffer_store_dwordx4 v[124:127], v29, s[4:7], s45 offen sc1
    s_add_u32 s53, s53, 1024
    s_waitcnt vmcnt(6)
    s_barrier
    s_cmp_lg_u32 s54, 1
    s_cbranch_scc1 Lnd_96
    s_add_u32 m0, s50, 0
    s_mov_b32 s52, 1024
    buffer_load_dwordx4 v9, s[20:23], s52 offen lds
    s_add_u32 m0, s50, 1024
    s_mov_b32 s52, 6144
    buffer_load_dwordx4 v10, s[20:23], s52 offen lds
    s_add_u32 m0, s50, 2048
    s_mov_b32 s52, 11264
    buffer_load_dwordx4 v9, s[20:23], s52 offen lds
    s_add_u32 m0, s50, 3072
    s_mov_b32 s52, 16384
    buffer_load_dwordx4 v10, s[20:23], s52 offen lds
    s_add_u32 m0, s50, 4096
    s_mov_b32 s52, 21504
    buffer_load_dwordx4 v9, s[20:23], s52 offen lds
    s_add_u32 m0, s50, 5120
    s_mov_b32 s52, 26624
    buffer_load_dwordx4 v10, s[20:23], s52 offen lds
    s_add_u32 m0, s50, 6144
    s_mov_b32 s52, 31744
    buffer_load_dwordx4 v9, s[20:23], s52 offen lds
    s_add_u32 m0, s50, 7168
    s_mov_b32 s52, 36864
    buffer_load_dwordx4 v10, s[20:23], s52 offen lds
Lnd_96:
    ds_read_b64_tr_b16 v[40:41], v12 offset:0
    ds_read_b64_tr_b16 v[42:43], v12 offset:4096
    ds_read_b64_tr_b16 v[44:45], v12 offset:8192
    ds_read_b64_tr_b16 v[46:47], v12 offset:12288
    ds_read_b64_tr_b16 v[48:49], v12 offset:16384
    ds_read_b64_tr_b16 v[50:51], v12 offset:20480
    ds_read_b64_tr_b16 v[52:53], v12 offset:24576
    ds_read_b64_tr_b16 v[54:55], v12 offset:28672
    v_add_u32 v12, 0x8000, v12
    v_and_b32 v12, 0x1ffff, v12
    s_waitcnt lgkmcnt(8)
    v_mfma_f32_16x16x32_bf16 v[112:115], v[72:75], v[56:59], 0
    v_mfma_f32_16x16x32_bf16 v[116:119], v[88:91], v[56:59], 0
    v_mfma_f32_16x16x32_bf16 v[112:115], v[76:79], v[60:63], v[112:115]
    v_mfma_f32_16x16x32_bf16 v[116:119], v[92:95], v[60:63], v[116:119]
    v_mfma_f32_16x16x32_bf16 v[112:115], v[80:83], v[64:67], v[112:115]
    v_mfma_f32_16x16x32_bf16 v[116:119], v[96:99], v[64:67], v[116:119]
    v_mfma_f32_16x16x32_bf16 v[112:115], v[84:87], v[68:71], v[112:115]
    v_mfma_f32_16x16x32_bf16 v[116:119], v[100:103], v[68:71], v[116:119]
    v_cvt_pk_bf16_f32 v120, v104, v105
    v_cvt_pk_bf16_f32 v121, v106, v107
    v_cvt_pk_bf16_f32 v122, v108, v109
    v_cvt_pk_bf16_f32 v123, v110, v111
    s_add_u32 s45, s53, 0x0
    buffer_store_dwordx4 v[120:123], v29, s[4:7], s45 offen sc1
    s_add_u32 s53, s53, 1024
    s_add_u32 s54, s54, 1
    s_cmp_lt_u32 s54, 5
    s_cbranch_scc1 Lu_94
    s_nop 7
    v_cvt_pk_bf16_f32 v124, v112, v113
    v_cvt_pk_bf16_f32 v125, v114, v115
    v_cvt_pk_bf16_f32 v126, v116, v117
    v_cvt_pk_bf16_f32 v127, v118, v119
    s_add_u32 s45, s53, 0x0
    buffer_store_dwordx4 v[124:127], v29, s[4:7], s45 offen sc1
    s_add_u32 s53, s53, 1024
    s_waitcnt lgkmcnt(0)
    s_lshl_b32 s75, s40, 12
    s_lshl_b32 s44, s41, 7
    s_add_u32 s75, s75, s44
    s_add_u32 s75, s75, 0x8c27180
    s_waitcnt vmcnt(0)
    s_barrier
    s_cmp_lg_u32 s42, 0
    s_cbranch_scc1 Lsig_97
    s_mov_b64 exec, 1
    v_mov_b32 v4, 1
    v_mov_b32 v5, 0
    buffer_atomic_add v4, v5, s[4:7], s75 offen
    s_mov_b64 exec, -1
Lsig_97:
    s_mov_b64 s[92:93], s[72:73]
    s_mov_b64 s[72:73], s[92:93]
Lcs_87:
    s_cmp_eq_u32 s71, 2
    s_cbranch_scc1 Lcg_99
    s_branch Lcs_98
Lcg_99:
    s_mov_b32 s40, 0
    s_mov_b32 s41, s72
    s_mov_b32 s8, s24
    s_and_b32 s9, s25, 0xffff
    s_mov_b32 s10, 0x280000
    s_mov_b32 s11, 0x00020000
    s_mov_b32 s12, s30
    s_and_b32 s13, s31, 0xffff
    s_mov_b32 s14, 0x500000
    s_mov_b32 s15, 0x00020000
    s_mov_b32 s16, s32
    s_and_b32 s17, s33, 0xffff
    s_mov_b32 s18, 0x500000
    s_mov_b32 s19, 0x00020000
    s_mov_b32 s20, s34
    s_and_b32 s21, s35, 0xffff
    s_mov_b32 s22, 0x500000
    s_mov_b32 s23, 0x00020000
    s_and_b32 s44, s42, 1
    s_lshl_b32 s44, s44, 2
    v_or_b32 v6, s44, v3
    v_lshrrev_b32 v7, 1, v2
    v_xor_b32 v7, v7, v6
    v_and_b32 v8, 1, v2
    v_lshl_add_u32 v7, v7, 1, v8
    v_lshlrev_b32 v7, 4, v7
    v_mul_u32_u24 v8, 8192, v3
    v_add_u32 v7, v7, v8
    s_mul_i32 s44, s42, 65536
    s_lshl_b32 s45, s41, 8
    s_add_u32 s44, s44, s45
    v_add_u32 v9, s44, v7
    v_lshrrev_b32 v6, 2, v1
    v_mul_u32_u24 v6, 1280, v6
    v_and_b32 v7, 3, v1
    v_xor_b32 v7, v7, v3
    v_lshl_add_u32 v6, v7, 4, v6
    s_lshl_b32 s44, s40, 2
    s_add_u32 s44, s44, s42
    s_mul_i32 s44, s44, 81920
    v_add_u32 v10, s44, v6
    v_lshrrev_b32 v6, 2, v2
    v_and_b32 v7, 1, v3
    v_lshl_or_b32 v7, v7, 2, v6
    v_lshl_add_u32 v6, v3, 3, v6
    v_lshlrev_b32 v6, 8, v6
    v_and_b32 v8, 3, v2
    v_lshl_add_u32 v6, v8, 3, v6
    v_xor_b32 v8, 0, v7
    v_lshl_add_u32 v12, v8, 5, v6
    v_add_u32 v20, 0x10000, v12
    v_xor_b32 v8, 1, v7
    v_lshl_add_u32 v13, v8, 5, v6
    v_add_u32 v21, 0x10000, v13
    v_xor_b32 v8, 2, v7
    v_lshl_add_u32 v14, v8, 5, v6
    v_add_u32 v22, 0x10000, v14
    v_xor_b32 v8, 3, v7
    v_lshl_add_u32 v15, v8, 5, v6
    v_add_u32 v23, 0x10000, v15
    v_xor_b32 v8, 4, v7
    v_lshl_add_u32 v16, v8, 5, v6
    v_add_u32 v24, 0x10000, v16
    v_xor_b32 v8, 5, v7
    v_lshl_add_u32 v17, v8, 5, v6
    v_add_u32 v25, 0x10000, v17
    v_xor_b32 v8, 6, v7
    v_lshl_add_u32 v18, v8, 5, v6
    v_add_u32 v26, 0x10000, v18
    v_xor_b32 v8, 7, v7
    v_lshl_add_u32 v19, v8, 5, v6
    v_add_u32 v27, 0x10000, v19
    v_lshrrev_b32 v6, 2, v2
    v_xor_b32 v6, v6, v3
    v_lshlrev_b32 v6, 4, v6
    v_lshl_add_u32 v6, v2, 6, v6
    s_mul_i32 s44, s42, 4096
    s_add_u32 s44, s44, 8192
    v_add_u32 v28, s44, v6
    v_add_u32 v29, 0x10000, v28
    s_lshl_b32 s50, s42, 11
    s_mov_b32 s51, s44
    s_mov_b32 s46, 0
    s_mov_b32 s47, 0x0
    s_mov_b32 s53, 0
    s_add_u32 m0, s50, 0
    s_add_u32 s52, s46, 0x0
    buffer_load_dwordx4 v9, s[12:15], s52 offen lds
    s_add_u32 m0, s50, 1024
    s_add_u32 s52, s46, 0x8000
    buffer_load_dwordx4 v9, s[12:15], s52 offen lds
    s_add_u32 m0, s51, 0
    s_add_u32 s52, s47, 0
    buffer_load_dwordx4 v10, s[8:11], s52 offen lds
    s_add_u32 m0, s51, 1024
    s_add_u32 s52, s47, 20480
    buffer_load_dwordx4 v10, s[8:11], s52 offen lds
    s_add_u32 m0, s51, 2048
    s_add_u32 s52, s47, 40960
    buffer_load_dwordx4 v10, s[8:11], s52 offen lds
    s_add_u32 m0, s51, 3072
    s_add_u32 s52, s47, 61440
    buffer_load_dwordx4 v10, s[8:11], s52 offen lds
    s_add_u32 s46, s46, 262144
    s_add_u32 s47, s47, 64
    s_add_u32 m0, s50, 24576
    s_add_u32 s52, s46, 0x0
    buffer_load_dwordx4 v9, s[12:15], s52 offen lds
    s_add_u32 m0, s50, 25600
    s_add_u32 s52, s46, 0x8000
    buffer_load_dwordx4 v9, s[12:15], s52 offen lds
    s_add_u32 m0, s51, 24576
    s_add_u32 s52, s47, 0
    buffer_load_dwordx4 v10, s[8:11], s52 offen lds
    s_add_u32 m0, s51, 25600
    s_add_u32 s52, s47, 20480
    buffer_load_dwordx4 v10, s[8:11], s52 offen lds
    s_add_u32 m0, s51, 26624
    s_add_u32 s52, s47, 40960
    buffer_load_dwordx4 v10, s[8:11], s52 offen lds
    s_add_u32 m0, s51, 27648
    s_add_u32 s52, s47, 61440
    buffer_load_dwordx4 v10, s[8:11], s52 offen lds
    s_add_u32 s46, s46, 262144
    s_add_u32 s47, s47, 64
    s_add_u32 m0, s50, 49152
    s_add_u32 s52, s46, 0x0
    buffer_load_dwordx4 v9, s[12:15], s52 offen lds
    s_add_u32 m0, s50, 50176
    s_add_u32 s52, s46, 0x8000
    buffer_load_dwordx4 v9, s[12:15], s52 offen lds
    s_add_u32 m0, s51, 49152
    s_add_u32 s52, s47, 0
    buffer_load_dwordx4 v10, s[8:11], s52 offen lds
    s_add_u32 m0, s51, 50176
    s_add_u32 s52, s47, 20480
    buffer_load_dwordx4 v10, s[8:11], s52 offen lds
    s_add_u32 m0, s51, 51200
    s_add_u32 s52, s47, 40960
    buffer_load_dwordx4 v10, s[8:11], s52 offen lds
    s_add_u32 m0, s51, 52224
    s_add_u32 s52, s47, 61440
    buffer_load_dwordx4 v10, s[8:11], s52 offen lds
    s_add_u32 s46, s46, 262144
    s_add_u32 s47, s47, 64
    s_add_u32 m0, s50, 73728
    s_add_u32 s52, s46, 0x0
    buffer_load_dwordx4 v9, s[12:15], s52 offen lds
    s_add_u32 m0, s50, 74752
    s_add_u32 s52, s46, 0x8000
    buffer_load_dwordx4 v9, s[12:15], s52 offen lds
    s_add_u32 m0, s51, 73728
    s_add_u32 s52, s47, 0
    buffer_load_dwordx4 v10, s[8:11], s52 offen lds
    s_add_u32 m0, s51, 74752
    s_add_u32 s52, s47, 20480
    buffer_load_dwordx4 v10, s[8:11], s52 offen lds
    s_add_u32 m0, s51, 75776
    s_add_u32 s52, s47, 40960
    buffer_load_dwordx4 v10, s[8:11], s52 offen lds
    s_add_u32 m0, s51, 76800
    s_add_u32 s52, s47, 61440
    buffer_load_dwordx4 v10, s[8:11], s52 offen lds
    s_add_u32 s46, s46, 262144
    s_add_u32 s47, s47, 64
    v_accvgpr_write_b32 a128, 0
    v_accvgpr_write_b32 a129, 0
    v_accvgpr_write_b32 a130, 0
    v_accvgpr_write_b32 a131, 0
    v_accvgpr_write_b32 a132, 0
    v_accvgpr_write_b32 a133, 0
    v_accvgpr_write_b32 a134, 0
    v_accvgpr_write_b32 a135, 0
    v_accvgpr_write_b32 a136, 0
    v_accvgpr_write_b32 a137, 0
    v_accvgpr_write_b32 a138, 0
    v_accvgpr_write_b32 a139, 0
    v_accvgpr_write_b32 a140, 0
    v_accvgpr_write_b32 a141, 0
    v_accvgpr_write_b32 a142, 0
    v_accvgpr_write_b32 a143, 0
    v_accvgpr_write_b32 a144, 0
    v_accvgpr_write_b32 a145, 0
    v_accvgpr_write_b32 a146, 0
    v_accvgpr_write_b32 a147, 0
    v_accvgpr_write_b32 a148, 0
    v_accvgpr_write_b32 a149, 0
    v_accvgpr_write_b32 a150, 0
    v_accvgpr_write_b32 a151, 0
    v_accvgpr_write_b32 a152, 0
    v_accvgpr_write_b32 a153, 0
    v_accvgpr_write_b32 a154, 0
    v_accvgpr_write_b32 a155, 0
    v_accvgpr_write_b32 a156, 0
    v_accvgpr_write_b32 a157, 0
    v_accvgpr_write_b32 a158, 0
    v_accvgpr_write_b32 a159, 0
    v_accvgpr_write_b32 a160, 0
    v_accvgpr_write_b32 a161, 0
    v_accvgpr_write_b32 a162, 0
    v_accvgpr_write_b32 a163, 0
    v_accvgpr_write_b32 a164, 0
    v_accvgpr_write_b32 a165, 0
    v_accvgpr_write_b32 a166, 0
    v_accvgpr_write_b32 a167, 0
    v_accvgpr_write_b32 a168, 0
    v_accvgpr_write_b32 a169, 0
    v_accvgpr_write_b32 a170, 0
    v_accvgpr_write_b32 a171, 0
    v_accvgpr_write_b32 a172, 0
    v_accvgpr_write_b32 a173, 0
    v_accvgpr_write_b32 a174, 0
    v_accvgpr_write_b32 a175, 0
    v_accvgpr_write_b32 a176, 0
    v_accvgpr_write_b32 a177, 0
    v_accvgpr_write_b32 a178, 0
    v_accvgpr_write_b32 a179, 0
    v_accvgpr_write_b32 a180, 0
    v_accvgpr_write_b32 a181, 0
    v_accvgpr_write_b32 a182, 0
    v_accvgpr_write_b32 a183, 0
    v_accvgpr_write_b32 a184, 0
    v_accvgpr_write_b32 a185, 0
    v_accvgpr_write_b32 a186, 0
    v_accvgpr_write_b32 a187, 0
    v_accvgpr_write_b32 a188, 0
    v_accvgpr_write_b32 a189, 0
    v_accvgpr_write_b32 a190, 0
    v_accvgpr_write_b32 a191, 0
    v_accvgpr_write_b32 a192, 0
    v_accvgpr_write_b32 a193, 0
    v_accvgpr_write_b32 a194, 0
    v_accvgpr_write_b32 a195, 0
    v_accvgpr_write_b32 a196, 0
    v_accvgpr_write_b32 a197, 0
    v_accvgpr_write_b32 a198, 0
    v_accvgpr_write_b32 a199, 0
    v_accvgpr_write_b32 a200, 0
    v_accvgpr_write_b32 a201, 0
    v_accvgpr_write_b32 a202, 0
    v_accvgpr_write_b32 a203, 0
    v_accvgpr_write_b32 a204, 0
    v_accvgpr_write_b32 a205, 0
    v_accvgpr_write_b32 a206, 0
    v_accvgpr_write_b32 a207, 0
    v_accvgpr_write_b32 a208, 0
    v_accvgpr_write_b32 a209, 0
    v_accvgpr_write_b32 a210, 0
    v_accvgpr_write_b32 a211, 0
    v_accvgpr_write_b32 a212, 0
    v_accvgpr_write_b32 a213, 0
    v_accvgpr_write_b32 a214, 0
    v_accvgpr_write_b32 a215, 0
    v_accvgpr_write_b32 a216, 0
    v_accvgpr_write_b32 a217, 0
    v_accvgpr_write_b32 a218, 0
    v_accvgpr_write_b32 a219, 0
    v_accvgpr_write_b32 a220, 0
    v_accvgpr_write_b32 a221, 0
    v_accvgpr_write_b32 a222, 0
    v_accvgpr_write_b32 a223, 0
    v_accvgpr_write_b32 a224, 0
    v_accvgpr_write_b32 a225, 0
    v_accvgpr_write_b32 a226, 0
    v_accvgpr_write_b32 a227, 0
    v_accvgpr_write_b32 a228, 0
    v_accvgpr_write_b32 a229, 0
    v_accvgpr_write_b32 a230, 0
    v_accvgpr_write_b32 a231, 0
    v_accvgpr_write_b32 a232, 0
    v_accvgpr_write_b32 a233, 0
    v_accvgpr_write_b32 a234, 0
    v_accvgpr_write_b32 a235, 0
    v_accvgpr_write_b32 a236, 0
    v_accvgpr_write_b32 a237, 0
    v_accvgpr_write_b32 a238, 0
    v_accvgpr_write_b32 a239, 0
    v_accvgpr_write_b32 a240, 0
    v_accvgpr_write_b32 a241, 0
    v_accvgpr_write_b32 a242, 0
    v_accvgpr_write_b32 a243, 0
    v_accvgpr_write_b32 a244, 0
    v_accvgpr_write_b32 a245, 0
    v_accvgpr_write_b32 a246, 0
    v_accvgpr_write_b32 a247, 0
    v_accvgpr_write_b32 a248, 0
    v_accvgpr_write_b32 a249, 0
    v_accvgpr_write_b32 a250, 0
    v_accvgpr_write_b32 a251, 0
    v_accvgpr_write_b32 a252, 0
    v_accvgpr_write_b32 a253, 0
    v_accvgpr_write_b32 a254, 0
    v_accvgpr_write_b32 a255, 0
    s_waitcnt vmcnt(18)
    s_barrier
    ds_read_b128 v[32:35], v28 offset:0
    ds_read_b128 v[36:39], v28 offset:1024
    ds_read_b128 v[40:43], v28 offset:2048
    ds_read_b128 v[44:47], v28 offset:3072
    ds_read_b64_tr_b16 v[64:65], v12 offset:0
    ds_read_b64_tr_b16 v[66:67], v12 offset:1024
    ds_read_b64_tr_b16 v[68:69], v13 offset:0
    ds_read_b64_tr_b16 v[70:71], v13 offset:1024
    s_mov_b32 s43, 0
Lpg_100:
    ds_read_b64_tr_b16 v[72:73], v14 offset:0
    ds_read_b64_tr_b16 v[74:75], v14 offset:1024
    s_waitcnt lgkmcnt(6)
    s_waitcnt lgkmcnt(4)
    v_mfma_f32_16x16x32_bf16 a[128:131], v[64:67], v[32:35], a[128:131]
    v_mfma_f32_16x16x32_bf16 a[132:135], v[64:67], v[36:39], a[132:135]
    v_mfma_f32_16x16x32_bf16 a[136:139], v[64:67], v[40:43], a[136:139]
    v_mfma_f32_16x16x32_bf16 a[140:143], v[64:67], v[44:47], a[140:143]
    ds_read_b64_tr_b16 v[76:77], v15 offset:0
    ds_read_b64_tr_b16 v[78:79], v15 offset:1024
    s_waitcnt lgkmcnt(4)
    v_mfma_f32_16x16x32_bf16 a[144:147], v[68:71], v[32:35], a[144:147]
    v_mfma_f32_16x16x32_bf16 a[148:151], v[68:71], v[36:39], a[148:151]
    v_mfma_f32_16x16x32_bf16 a[152:155], v[68:71], v[40:43], a[152:155]
    v_mfma_f32_16x16x32_bf16 a[156:159], v[68:71], v[44:47], a[156:159]
    ds_read_b64_tr_b16 v[64:65], v16 offset:0
    ds_read_b64_tr_b16 v[66:67], v16 offset:1024
    s_waitcnt lgkmcnt(4)
    v_mfma_f32_16x16x32_bf16 a[160:163], v[72:75], v[32:35], a[160:163]
    v_mfma_f32_16x16x32_bf16 a[164:167], v[72:75], v[36:39], a[164:167]
    v_mfma_f32_16x16x32_bf16 a[168:171], v[72:75], v[40:43], a[168:171]
    v_mfma_f32_16x16x32_bf16 a[172:175], v[72:75], v[44:47], a[172:175]
    ds_read_b64_tr_b16 v[68:69], v17 offset:0
    ds_read_b64_tr_b16 v[70:71], v17 offset:1024
    s_waitcnt lgkmcnt(4)
    v_mfma_f32_16x16x32_bf16 a[176:179], v[76:79], v[32:35], a[176:179]
    v_mfma_f32_16x16x32_bf16 a[180:183], v[76:79], v[36:39], a[180:183]
    v_mfma_f32_16x16x32_bf16 a[184:187], v[76:79], v[40:43], a[184:187]
    v_mfma_f32_16x16x32_bf16 a[188:191], v[76:79], v[44:47], a[188:191]
    s_waitcnt vmcnt(12)
    s_barrier
    ds_read_b64_tr_b16 v[72:73], v18 offset:0
    ds_read_b64_tr_b16 v[74:75], v18 offset:1024
    s_waitcnt lgkmcnt(4)
    v_mfma_f32_16x16x32_bf16 a[192:195], v[64:67], v[32:35], a[192:195]
    v_mfma_f32_16x16x32_bf16 a[196:199], v[64:67], v[36:39], a[196:199]
    s_add_u32 m0, s50, 98304
    s_add_u32 s52, s46, 0x0
    buffer_load_dwordx4 v9, s[12:15], s52 offen lds
    v_mfma_f32_16x16x32_bf16 a[200:203], v[64:67], v[40:43], a[200:203]
    v_mfma_f32_16x16x32_bf16 a[204:207], v[64:67], v[44:47], a[204:207]
    s_add_u32 m0, s50, 99328
    s_add_u32 s52, s46, 0x8000
    buffer_load_dwordx4 v9, s[12:15], s52 offen lds
    ds_read_b64_tr_b16 v[76:77], v19 offset:0
    ds_read_b64_tr_b16 v[78:79], v19 offset:1024
    s_waitcnt lgkmcnt(4)
    v_mfma_f32_16x16x32_bf16 a[208:211], v[68:71], v[32:35], a[208:211]
    v_mfma_f32_16x16x32_bf16 a[212:215], v[68:71], v[36:39], a[212:215]
    s_add_u32 m0, s51, 98304
    s_add_u32 s52, s47, 0
    buffer_load_dwordx4 v10, s[8:11], s52 offen lds
    v_mfma_f32_16x16x32_bf16 a[216:219], v[68:71], v[40:43], a[216:219]
    v_mfma_f32_16x16x32_bf16 a[220:223], v[68:71], v[44:47], a[220:223]
    s_add_u32 m0, s51, 99328
    s_add_u32 s52, s47, 20480
    buffer_load_dwordx4 v10, s[8:11], s52 offen lds
    ds_read_b128 v[48:51], v28 offset:24576
    ds_read_b128 v[52:55], v28 offset:25600
    ds_read_b128 v[56:59], v28 offset:26624
    ds_read_b128 v[60:63], v28 offset:27648
    ds_read_b64_tr_b16 v[64:65], v12 offset:24576
    ds_read_b64_tr_b16 v[66:67], v12 offset:25600
    s_waitcnt lgkmcnt(8)
    v_mfma_f32_16x16x32_bf16 a[224:227], v[72:75], v[32:35], a[224:227]
    v_mfma_f32_16x16x32_bf16 a[228:231], v[72:75], v[36:39], a[228:231]
    s_add_u32 m0, s51, 100352
    s_add_u32 s52, s47, 40960
    buffer_load_dwordx4 v10, s[8:11], s52 offen lds
    v_mfma_f32_16x16x32_bf16 a[232:235], v[72:75], v[40:43], a[232:235]
    v_mfma_f32_16x16x32_bf16 a[236:239], v[72:75], v[44:47], a[236:239]
    s_add_u32 m0, s51, 101376
    s_add_u32 s52, s47, 61440
    buffer_load_dwordx4 v10, s[8:11], s52 offen lds
    ds_read_b64_tr_b16 v[68:69], v13 offset:24576
    ds_read_b64_tr_b16 v[70:71], v13 offset:25600
    s_waitcnt lgkmcnt(8)
    v_mfma_f32_16x16x32_bf16 a[240:243], v[76:79], v[32:35], a[240:243]
    v_mfma_f32_16x16x32_bf16 a[244:247], v[76:79], v[36:39], a[244:247]
    s_add_u32 s46, s46, 262144
    s_add_u32 s47, s47, 64
    v_mfma_f32_16x16x32_bf16 a[248:251], v[76:79], v[40:43], a[248:251]
    v_mfma_f32_16x16x32_bf16 a[252:255], v[76:79], v[44:47], a[252:255]
    ds_read_b64_tr_b16 v[72:73], v14 offset:24576
    ds_read_b64_tr_b16 v[74:75], v14 offset:25600
    s_waitcnt lgkmcnt(6)
    s_waitcnt lgkmcnt(4)
    v_mfma_f32_16x16x32_bf16 a[128:131], v[64:67], v[48:51], a[128:131]
    v_mfma_f32_16x16x32_bf16 a[132:135], v[64:67], v[52:55], a[132:135]
    v_mfma_f32_16x16x32_bf16 a[136:139], v[64:67], v[56:59], a[136:139]
    v_mfma_f32_16x16x32_bf16 a[140:143], v[64:67], v[60:63], a[140:143]
    ds_read_b64_tr_b16 v[76:77], v15 offset:24576
    ds_read_b64_tr_b16 v[78:79], v15 offset:25600
    s_waitcnt lgkmcnt(4)
    v_mfma_f32_16x16x32_bf16 a[144:147], v[68:71], v[48:51], a[144:147]
    v_mfma_f32_16x16x32_bf16 a[148:151], v[68:71], v[52:55], a[148:151]
    v_mfma_f32_16x16x32_bf16 a[152:155], v[68:71], v[56:59], a[152:155]
    v_mfma_f32_16x16x32_bf16 a[156:159], v[68:71], v[60:63], a[156:159]
    ds_read_b64_tr_b16 v[64:65], v16 offset:24576
    ds_read_b64_tr_b16 v[66:67], v16 offset:25600
    s_waitcnt lgkmcnt(4)
    v_mfma_f32_16x16x32_bf16 a[160:163], v[72:75], v[48:51], a[160:163]
    v_mfma_f32_16x16x32_bf16 a[164:167], v[72:75], v[52:55], a[164:167]
    v_mfma_f32_16x16x32_bf16 a[168:171], v[72:75], v[56:59], a[168:171]
    v_mfma_f32_16x16x32_bf16 a[172:175], v[72:75], v[60:63], a[172:175]
    ds_read_b64_tr_b16 v[68:69], v17 offset:24576
    ds_read_b64_tr_b16 v[70:71], v17 offset:25600
    s_waitcnt lgkmcnt(4)
    v_mfma_f32_16x16x32_bf16 a[176:179], v[76:79], v[48:51], a[176:179]
    v_mfma_f32_16x16x32_bf16 a[180:183], v[76:79], v[52:55], a[180:183]
    v_mfma_f32_16x16x32_bf16 a[184:187], v[76:79], v[56:59], a[184:187]
    v_mfma_f32_16x16x32_bf16 a[188:191], v[76:79], v[60:63], a[188:191]
    s_waitcnt vmcnt(12)
    s_barrier
    ds_read_b64_tr_b16 v[72:73], v18 offset:24576
    ds_read_b64_tr_b16 v[74:75], v18 offset:25600
    s_waitcnt lgkmcnt(4)
    v_mfma_f32_16x16x32_bf16 a[192:195], v[64:67], v[48:51], a[192:195]
    v_mfma_f32_16x16x32_bf16 a[196:199], v[64:67], v[52:55], a[196:199]
    s_add_u32 m0, s50, 0
    s_add_u32 s52, s46, 0x0
    buffer_load_dwordx4 v9, s[12:15], s52 offen lds
    v_mfma_f32_16x16x32_bf16 a[200:203], v[64:67], v[56:59], a[200:203]
    v_mfma_f32_16x16x32_bf16 a[204:207], v[64:67], v[60:63], a[204:207]
    s_add_u32 m0, s50, 1024
    s_add_u32 s52, s46, 0x8000
    buffer_load_dwordx4 v9, s[12:15], s52 offen lds
    ds_read_b64_tr_b16 v[76:77], v19 offset:24576
    ds_read_b64_tr_b16 v[78:79], v19 offset:25600
    s_waitcnt lgkmcnt(4)
    v_mfma_f32_16x16x32_bf16 a[208:211], v[68:71], v[48:51], a[208:211]
    v_mfma_f32_16x16x32_bf16 a[212:215], v[68:71], v[52:55], a[212:215]
    s_add_u32 m0, s51, 0
    s_add_u32 s52, s47, 0
    buffer_load_dwordx4 v10, s[8:11], s52 offen lds
    v_mfma_f32_16x16x32_bf16 a[216:219], v[68:71], v[56:59], a[216:219]
    v_mfma_f32_16x16x32_bf16 a[220:223], v[68:71], v[60:63], a[220:223]
    s_add_u32 m0, s51, 1024
    s_add_u32 s52, s47, 20480
    buffer_load_dwordx4 v10, s[8:11], s52 offen lds
    ds_read_b128 v[32:35], v28 offset:49152
    ds_read_b128 v[36:39], v28 offset:50176
    ds_read_b128 v[40:43], v28 offset:51200
    ds_read_b128 v[44:47], v28 offset:52224
    ds_read_b64_tr_b16 v[64:65], v12 offset:49152
    ds_read_b64_tr_b16 v[66:67], v12 offset:50176
    s_waitcnt lgkmcnt(8)
    v_mfma_f32_16x16x32_bf16 a[224:227], v[72:75], v[48:51], a[224:227]
    v_mfma_f32_16x16x32_bf16 a[228:231], v[72:75], v[52:55], a[228:231]
    s_add_u32 m0, s51, 2048
    s_add_u32 s52, s47, 40960
    buffer_load_dwordx4 v10, s[8:11], s52 offen lds
    v_mfma_f32_16x16x32_bf16 a[232:235], v[72:75], v[56:59], a[232:235]
    v_mfma_f32_16x16x32_bf16 a[236:239], v[72:75], v[60:63], a[236:239]
    s_add_u32 m0, s51, 3072
    s_add_u32 s52, s47, 61440
    buffer_load_dwordx4 v10, s[8:11], s52 offen lds
    ds_read_b64_tr_b16 v[68:69], v13 offset:49152
    ds_read_b64_tr_b16 v[70:71], v13 offset:50176
    s_waitcnt lgkmcnt(8)
    v_mfma_f32_16x16x32_bf16 a[240:243], v[76:79], v[48:51], a[240:243]
    v_mfma_f32_16x16x32_bf16 a[244:247], v[76:79], v[52:55], a[244:247]
    s_add_u32 s46, s46, 262144
    s_add_u32 s47, s47, 64
    v_mfma_f32_16x16x32_bf16 a[248:251], v[76:79], v[56:59], a[248:251]
    v_mfma_f32_16x16x32_bf16 a[252:255], v[76:79], v[60:63], a[252:255]
    ds_read_b64_tr_b16 v[72:73], v14 offset:49152
    ds_read_b64_tr_b16 v[74:75], v14 offset:50176
    s_waitcnt lgkmcnt(6)
    s_waitcnt lgkmcnt(4)
    v_mfma_f32_16x16x32_bf16 a[128:131], v[64:67], v[32:35], a[128:131]
    v_mfma_f32_16x16x32_bf16 a[132:135], v[64:67], v[36:39], a[132:135]
    v_mfma_f32_16x16x32_bf16 a[136:139], v[64:67], v[40:43], a[136:139]
    v_mfma_f32_16x16x32_bf16 a[140:143], v[64:67], v[44:47], a[140:143]
    ds_read_b64_tr_b16 v[76:77], v15 offset:49152
    ds_read_b64_tr_b16 v[78:79], v15 offset:50176
    s_waitcnt lgkmcnt(4)
    v_mfma_f32_16x16x32_bf16 a[144:147], v[68:71], v[32:35], a[144:147]
    v_mfma_f32_16x16x32_bf16 a[148:151], v[68:71], v[36:39], a[148:151]
    v_mfma_f32_16x16x32_bf16 a[152:155], v[68:71], v[40:43], a[152:155]
    v_mfma_f32_16x16x32_bf16 a[156:159], v[68:71], v[44:47], a[156:159]
    ds_read_b64_tr_b16 v[64:65], v16 offset:49152
    ds_read_b64_tr_b16 v[66:67], v16 offset:50176
    s_waitcnt lgkmcnt(4)
    v_mfma_f32_16x16x32_bf16 a[160:163], v[72:75], v[32:35], a[160:163]
    v_mfma_f32_16x16x32_bf16 a[164:167], v[72:75], v[36:39], a[164:167]
    v_mfma_f32_16x16x32_bf16 a[168:171], v[72:75], v[40:43], a[168:171]
    v_mfma_f32_16x16x32_bf16 a[172:175], v[72:75], v[44:47], a[172:175]
    ds_read_b64_tr_b16 v[68:69], v17 offset:49152
    ds_read_b64_tr_b16 v[70:71], v17 offset:50176
    s_waitcnt lgkmcnt(4)
    v_mfma_f32_16x16x32_bf16 a[176:179], v[76:79], v[32:35], a[176:179]
    v_mfma_f32_16x16x32_bf16 a[180:183], v[76:79], v[36:39], a[180:183]
    v_mfma_f32_16x16x32_bf16 a[184:187], v[76:79], v[40:43], a[184:187]
    v_mfma_f32_16x16x32_bf16 a[188:191], v[76:79], v[44:47], a[188:191]
    s_waitcnt vmcnt(12)
    s_barrier
    ds_read_b64_tr_b16 v[72:73], v18 offset:49152
    ds_read_b64_tr_b16 v[74:75], v18 offset:50176
    s_waitcnt lgkmcnt(4)
    v_mfma_f32_16x16x32_bf16 a[192:195], v[64:67], v[32:35], a[192:195]
    v_mfma_f32_16x16x32_bf16 a[196:199], v[64:67], v[36:39], a[196:199]
    s_add_u32 m0, s50, 24576
    s_add_u32 s52, s46, 0x0
    buffer_load_dwordx4 v9, s[12:15], s52 offen lds
    v_mfma_f32_16x16x32_bf16 a[200:203], v[64:67], v[40:43], a[200:203]
    v_mfma_f32_16x16x32_bf16 a[204:207], v[64:67], v[44:47], a[204:207]
    s_add_u32 m0, s50, 25600
    s_add_u32 s52, s46, 0x8000
    buffer_load_dwordx4 v9, s[12:15], s52 offen lds
    ds_read_b64_tr_b16 v[76:77], v19 offset:49152
    ds_read_b64_tr_b16 v[78:79], v19 offset:50176
    s_waitcnt lgkmcnt(4)
    v_mfma_f32_16x16x32_bf16 a[208:211], v[68:71], v[32:35], a[208:211]
    v_mfma_f32_16x16x32_bf16 a[212:215], v[68:71], v[36:39], a[212:215]
    s_add_u32 m0, s51, 24576
    s_add_u32 s52, s47, 0
    buffer_load_dwordx4 v10, s[8:11], s52 offen lds
    v_mfma_f32_16x16x32_bf16 a[216:219], v[68:71], v[40:43], a[216:219]
    v_mfma_f32_16x16x32_bf16 a[220:223], v[68:71], v[44:47], a[220:223]
    s_add_u32 m0, s51, 25600
    s_add_u32 s52, s47, 20480
    buffer_load_dwordx4 v10, s[8:11], s52 offen lds
    ds_read_b128 v[48:51], v29 offset:8192
    ds_read_b128 v[52:55], v29 offset:9216
    ds_read_b128 v[56:59], v29 offset:10240
    ds_read_b128 v[60:63], v29 offset:11264
    ds_read_b64_tr_b16 v[64:65], v20 offset:8192
    ds_read_b64_tr_b16 v[66:67], v20 offset:9216
    s_waitcnt lgkmcnt(8)
    v_mfma_f32_16x16x32_bf16 a[224:227], v[72:75], v[32:35], a[224:227]
    v_mfma_f32_16x16x32_bf16 a[228:231], v[72:75], v[36:39], a[228:231]
    s_add_u32 m0, s51, 26624
    s_add_u32 s52, s47, 40960
    buffer_load_dwordx4 v10, s[8:11], s52 offen lds
    v_mfma_f32_16x16x32_bf16 a[232:235], v[72:75], v[40:43], a[232:235]
    v_mfma_f32_16x16x32_bf16 a[236:239], v[72:75], v[44:47], a[236:239]
    s_add_u32 m0, s51, 27648
    s_add_u32 s52, s47, 61440
    buffer_load_dwordx4 v10, s[8:11], s52 offen lds
    ds_read_b64_tr_b16 v[68:69], v21 offset:8192
    ds_read_b64_tr_b16 v[70:71], v21 offset:9216
    s_waitcnt lgkmcnt(8)
    v_mfma_f32_16x16x32_bf16 a[240:243], v[76:79], v[32:35], a[240:243]
    v_mfma_f32_16x16x32_bf16 a[244:247], v[76:79], v[36:39], a[244:247]
    s_add_u32 s46, s46, 262144
    s_add_u32 s47, s47, 64
    v_mfma_f32_16x16x32_bf16 a[248:251], v[76:79], v[40:43], a[248:251]
    v_mfma_f32_16x16x32_bf16 a[252:255], v[76:79], v[44:47], a[252:255]
    ds_read_b64_tr_b16 v[72:73], v22 offset:8192
    ds_read_b64_tr_b16 v[74:75], v22 offset:9216
    s_waitcnt lgkmcnt(6)
    s_waitcnt lgkmcnt(4)
    v_mfma_f32_16x16x32_bf16 a[128:131], v[64:67], v[48:51], a[128:131]
    v_mfma_f32_16x16x32_bf16 a[132:135], v[64:67], v[52:55], a[132:135]
    v_mfma_f32_16x16x32_bf16 a[136:139], v[64:67], v[56:59], a[136:139]
    v_mfma_f32_16x16x32_bf16 a[140:143], v[64:67], v[60:63], a[140:143]
    ds_read_b64_tr_b16 v[76:77], v23 offset:8192
    ds_read_b64_tr_b16 v[78:79], v23 offset:9216
    s_waitcnt lgkmcnt(4)
    v_mfma_f32_16x16x32_bf16 a[144:147], v[68:71], v[48:51], a[144:147]
    v_mfma_f32_16x16x32_bf16 a[148:151], v[68:71], v[52:55], a[148:151]
    v_mfma_f32_16x16x32_bf16 a[152:155], v[68:71], v[56:59], a[152:155]
    v_mfma_f32_16x16x32_bf16 a[156:159], v[68:71], v[60:63], a[156:159]
    ds_read_b64_tr_b16 v[64:65], v24 offset:8192
    ds_read_b64_tr_b16 v[66:67], v24 offset:9216
    s_waitcnt lgkmcnt(4)
    v_mfma_f32_16x16x32_bf16 a[160:163], v[72:75], v[48:51], a[160:163]
    v_mfma_f32_16x16x32_bf16 a[164:167], v[72:75], v[52:55], a[164:167]
    v_mfma_f32_16x16x32_bf16 a[168:171], v[72:75], v[56:59], a[168:171]
    v_mfma_f32_16x16x32_bf16 a[172:175], v[72:75], v[60:63], a[172:175]
    ds_read_b64_tr_b16 v[68:69], v25 offset:8192
    ds_read_b64_tr_b16 v[70:71], v25 offset:9216
    s_waitcnt lgkmcnt(4)
    v_mfma_f32_16x16x32_bf16 a[176:179], v[76:79], v[48:51], a[176:179]
    v_mfma_f32_16x16x32_bf16 a[180:183], v[76:79], v[52:55], a[180:183]
    v_mfma_f32_16x16x32_bf16 a[184:187], v[76:79], v[56:59], a[184:187]
    v_mfma_f32_16x16x32_bf16 a[188:191], v[76:79], v[60:63], a[188:191]
    s_waitcnt vmcnt(12)
    s_barrier
    ds_read_b64_tr_b16 v[72:73], v26 offset:8192
    ds_read_b64_tr_b16 v[74:75], v26 offset:9216
    s_waitcnt lgkmcnt(4)
    v_mfma_f32_16x16x32_bf16 a[192:195], v[64:67], v[48:51], a[192:195]
    v_mfma_f32_16x16x32_bf16 a[196:199], v[64:67], v[52:55], a[196:199]
    s_add_u32 m0, s50, 49152
    s_add_u32 s52, s46, 0x0
    buffer_load_dwordx4 v9, s[12:15], s52 offen lds
    v_mfma_f32_16x16x32_bf16 a[200:203], v[64:67], v[56:59], a[200:203]
    v_mfma_f32_16x16x32_bf16 a[204:207], v[64:67], v[60:63], a[204:207]
    s_add_u32 m0, s50, 50176
    s_add_u32 s52, s46, 0x8000
    buffer_load_dwordx4 v9, s[12:15], s52 offen lds
    ds_read_b64_tr_b16 v[76:77], v27 offset:8192
    ds_read_b64_tr_b16 v[78:79], v27 offset:9216
    s_waitcnt lgkmcnt(4)
    v_mfma_f32_16x16x32_bf16 a[208:211], v[68:71], v[48:51], a[208:211]
    v_mfma_f32_16x16x32_bf16 a[212:215], v[68:71], v[52:55], a[212:215]
    s_add_u32 m0, s51, 49152
    s_add_u32 s52, s47, 0
    buffer_load_dwordx4 v10, s[8:11], s52 offen lds
    v_mfma_f32_16x16x32_bf16 a[216:219], v[68:71], v[56:59], a[216:219]
    v_mfma_f32_16x16x32_bf16 a[220:223], v[68:71], v[60:63], a[220:223]
    s_add_u32 m0, s51, 50176
    s_add_u32 s52, s47, 20480
    buffer_load_dwordx4 v10, s[8:11], s52 offen lds
    ds_read_b128 v[32:35], v29 offset:32768
    ds_read_b128 v[36:39], v29 offset:33792
    ds_read_b128 v[40:43], v29 offset:34816
    ds_read_b128 v[44:47], v29 offset:35840
    ds_read_b64_tr_b16 v[64:65], v20 offset:32768
    ds_read_b64_tr_b16 v[66:67], v20 offset:33792
    s_waitcnt lgkmcnt(8)
    v_mfma_f32_16x16x32_bf16 a[224:227], v[72:75], v[48:51], a[224:227]
    v_mfma_f32_16x16x32_bf16 a[228:231], v[72:75], v[52:55], a[228:231]
    s_add_u32 m0, s51, 51200
    s_add_u32 s52, s47, 40960
    buffer_load_dwordx4 v10, s[8:11], s52 offen lds
    v_mfma_f32_16x16x32_bf16 a[232:235], v[72:75], v[56:59], a[232:235]
    v_mfma_f32_16x16x32_bf16 a[236:239], v[72:75], v[60:63], a[236:239]
    s_add_u32 m0, s51, 52224
    s_add_u32 s52, s47, 61440
    buffer_load_dwordx4 v10, s[8:11], s52 offen lds
    ds_read_b64_tr_b16 v[68:69], v21 offset:32768
    ds_read_b64_tr_b16 v[70:71], v21 offset:33792
    s_waitcnt lgkmcnt(8)
    v_mfma_f32_16x16x32_bf16 a[240:243], v[76:79], v[48:51], a[240:243]
    v_mfma_f32_16x16x32_bf16 a[244:247], v[76:79], v[52:55], a[244:247]
    s_add_u32 s46, s46, 262144
    s_add_u32 s47, s47, 64
    v_mfma_f32_16x16x32_bf16 a[248:251], v[76:79], v[56:59], a[248:251]
    v_mfma_f32_16x16x32_bf16 a[252:255], v[76:79], v[60:63], a[252:255]
    ds_read_b64_tr_b16 v[72:73], v22 offset:32768
    ds_read_b64_tr_b16 v[74:75], v22 offset:33792
    s_waitcnt lgkmcnt(6)
    s_waitcnt lgkmcnt(4)
    v_mfma_f32_16x16x32_bf16 a[128:131], v[64:67], v[32:35], a[128:131]
    v_mfma_f32_16x16x32_bf16 a[132:135], v[64:67], v[36:39], a[132:135]
    v_mfma_f32_16x16x32_bf16 a[136:139], v[64:67], v[40:43], a[136:139]
    v_mfma_f32_16x16x32_bf16 a[140:143], v[64:67], v[44:47], a[140:143]
    ds_read_b64_tr_b16 v[76:77], v23 offset:32768
    ds_read_b64_tr_b16 v[78:79], v23 offset:33792
    s_waitcnt lgkmcnt(4)
    v_mfma_f32_16x16x32_bf16 a[144:147], v[68:71], v[32:35], a[144:147]
    v_mfma_f32_16x16x32_bf16 a[148:151], v[68:71], v[36:39], a[148:151]
    v_mfma_f32_16x16x32_bf16 a[152:155], v[68:71], v[40:43], a[152:155]
    v_mfma_f32_16x16x32_bf16 a[156:159], v[68:71], v[44:47], a[156:159]
    ds_read_b64_tr_b16 v[64:65], v24 offset:32768
    ds_read_b64_tr_b16 v[66:67], v24 offset:33792
    s_waitcnt lgkmcnt(4)
    v_mfma_f32_16x16x32_bf16 a[160:163], v[72:75], v[32:35], a[160:163]
    v_mfma_f32_16x16x32_bf16 a[164:167], v[72:75], v[36:39], a[164:167]
    v_mfma_f32_16x16x32_bf16 a[168:171], v[72:75], v[40:43], a[168:171]
    v_mfma_f32_16x16x32_bf16 a[172:175], v[72:75], v[44:47], a[172:175]
    ds_read_b64_tr_b16 v[68:69], v25 offset:32768
    ds_read_b64_tr_b16 v[70:71], v25 offset:33792
    s_waitcnt lgkmcnt(4)
    v_mfma_f32_16x16x32_bf16 a[176:179], v[76:79], v[32:35], a[176:179]
    v_mfma_f32_16x16x32_bf16 a[180:183], v[76:79], v[36:39], a[180:183]
    v_mfma_f32_16x16x32_bf16 a[184:187], v[76:79], v[40:43], a[184:187]
    v_mfma_f32_16x16x32_bf16 a[188:191], v[76:79], v[44:47], a[188:191]
    s_waitcnt vmcnt(12)
    s_barrier
    ds_read_b64_tr_b16 v[72:73], v26 offset:32768
    ds_read_b64_tr_b16 v[74:75], v26 offset:33792
    s_waitcnt lgkmcnt(4)
    v_mfma_f32_16x16x32_bf16 a[192:195], v[64:67], v[32:35], a[192:195]
    v_mfma_f32_16x16x32_bf16 a[196:199], v[64:67], v[36:39], a[196:199]
    s_add_u32 m0, s50, 73728
    s_add_u32 s52, s46, 0x0
    buffer_load_dwordx4 v9, s[12:15], s52 offen lds
    v_mfma_f32_16x16x32_bf16 a[200:203], v[64:67], v[40:43], a[200:203]
    v_mfma_f32_16x16x32_bf16 a[204:207], v[64:67], v[44:47], a[204:207]
    s_add_u32 m0, s50, 74752
    s_add_u32 s52, s46, 0x8000
    buffer_load_dwordx4 v9, s[12:15], s52 offen lds
    ds_read_b64_tr_b16 v[76:77], v27 offset:32768
    ds_read_b64_tr_b16 v[78:79], v27 offset:33792
    s_waitcnt lgkmcnt(4)
    v_mfma_f32_16x16x32_bf16 a[208:211], v[68:71], v[32:35], a[208:211]
    v_mfma_f32_16x16x32_bf16 a[212:215], v[68:71], v[36:39], a[212:215]
    s_add_u32 m0, s51, 73728
    s_add_u32 s52, s47, 0
    buffer_load_dwordx4 v10, s[8:11], s52 offen lds
    v_mfma_f32_16x16x32_bf16 a[216:219], v[68:71], v[40:43], a[216:219]
    v_mfma_f32_16x16x32_bf16 a[220:223], v[68:71], v[44:47], a[220:223]
    s_add_u32 m0, s51, 74752
    s_add_u32 s52, s47, 20480
    buffer_load_dwordx4 v10, s[8:11], s52 offen lds
    ds_read_b128 v[48:51], v28 offset:0
    ds_read_b128 v[52:55], v28 offset:1024
    ds_read_b128 v[56:59], v28 offset:2048
    ds_read_b128 v[60:63], v28 offset:3072
    ds_read_b64_tr_b16 v[64:65], v12 offset:0
    ds_read_b64_tr_b16 v[66:67], v12 offset:1024
    s_waitcnt lgkmcnt(8)
    v_mfma_f32_16x16x32_bf16 a[224:227], v[72:75], v[32:35], a[224:227]
    v_mfma_f32_16x16x32_bf16 a[228:231], v[72:75], v[36:39], a[228:231]
    s_add_u32 m0, s51, 75776
    s_add_u32 s52, s47, 40960
    buffer_load_dwordx4 v10, s[8:11], s52 offen lds
    v_mfma_f32_16x16x32_bf16 a[232:235], v[72:75], v[40:43], a[232:235]
    v_mfma_f32_16x16x32_bf16 a[236:239], v[72:75], v[44:47], a[236:239]
    s_add_u32 m0, s51, 76800
    s_add_u32 s52, s47, 61440
    buffer_load_dwordx4 v10, s[8:11], s52 offen lds
    ds_read_b64_tr_b16 v[68:69], v13 offset:0
    ds_read_b64_tr_b16 v[70:71], v13 offset:1024
    s_waitcnt lgkmcnt(8)
    v_mfma_f32_16x16x32_bf16 a[240:243], v[76:79], v[32:35], a[240:243]
    v_mfma_f32_16x16x32_bf16 a[244:247], v[76:79], v[36:39], a[244:247]
    s_add_u32 s46, s46, 262144
    s_add_u32 s47, s47, 64
    v_mfma_f32_16x16x32_bf16 a[248:251], v[76:79], v[40:43], a[248:251]
    v_mfma_f32_16x16x32_bf16 a[252:255], v[76:79], v[44:47], a[252:255]
    ds_read_b64_tr_b16 v[72:73], v14 offset:0
    ds_read_b64_tr_b16 v[74:75], v14 offset:1024
    s_waitcnt lgkmcnt(6)
    s_waitcnt lgkmcnt(4)
    v_mfma_f32_16x16x32_bf16 a[128:131], v[64:67], v[48:51], a[128:131]
    v_mfma_f32_16x16x32_bf16 a[132:135], v[64:67], v[52:55], a[132:135]
    v_mfma_f32_16x16x32_bf16 a[136:139], v[64:67], v[56:59], a[136:139]
    v_mfma_f32_16x16x32_bf16 a[140:143], v[64:67], v[60:63], a[140:143]
    ds_read_b64_tr_b16 v[76:77], v15 offset:0
    ds_read_b64_tr_b16 v[78:79], v15 offset:1024
    s_waitcnt lgkmcnt(4)
    v_mfma_f32_16x16x32_bf16 a[144:147], v[68:71], v[48:51], a[144:147]
    v_mfma_f32_16x16x32_bf16 a[148:151], v[68:71], v[52:55], a[148:151]
    v_mfma_f32_16x16x32_bf16 a[152:155], v[68:71], v[56:59], a[152:155]
    v_mfma_f32_16x16x32_bf16 a[156:159], v[68:71], v[60:63], a[156:159]
    ds_read_b64_tr_b16 v[64:65], v16 offset:0
    ds_read_b64_tr_b16 v[66:67], v16 offset:1024
    s_waitcnt lgkmcnt(4)
    v_mfma_f32_16x16x32_bf16 a[160:163], v[72:75], v[48:51], a[160:163]
    v_mfma_f32_16x16x32_bf16 a[164:167], v[72:75], v[52:55], a[164:167]
    v_mfma_f32_16x16x32_bf16 a[168:171], v[72:75], v[56:59], a[168:171]
    v_mfma_f32_16x16x32_bf16 a[172:175], v[72:75], v[60:63], a[172:175]
    ds_read_b64_tr_b16 v[68:69], v17 offset:0
    ds_read_b64_tr_b16 v[70:71], v17 offset:1024
    s_waitcnt lgkmcnt(4)
    v_mfma_f32_16x16x32_bf16 a[176:179], v[76:79], v[48:51], a[176:179]
    v_mfma_f32_16x16x32_bf16 a[180:183], v[76:79], v[52:55], a[180:183]
    v_mfma_f32_16x16x32_bf16 a[184:187], v[76:79], v[56:59], a[184:187]
    v_mfma_f32_16x16x32_bf16 a[188:191], v[76:79], v[60:63], a[188:191]
    s_waitcnt vmcnt(12)
    s_barrier
    ds_read_b64_tr_b16 v[72:73], v18 offset:0
    ds_read_b64_tr_b16 v[74:75], v18 offset:1024
    s_waitcnt lgkmcnt(4)
    v_mfma_f32_16x16x32_bf16 a[192:195], v[64:67], v[48:51], a[192:195]
    v_mfma_f32_16x16x32_bf16 a[196:199], v[64:67], v[52:55], a[196:199]
    s_add_u32 m0, s50, 98304
    s_add_u32 s52, s46, 0x0
    buffer_load_dwordx4 v9, s[12:15], s52 offen lds
    v_mfma_f32_16x16x32_bf16 a[200:203], v[64:67], v[56:59], a[200:203]
    v_mfma_f32_16x16x32_bf16 a[204:207], v[64:67], v[60:63], a[204:207]
    s_add_u32 m0, s50, 99328
    s_add_u32 s52, s46, 0x8000
    buffer_load_dwordx4 v9, s[12:15], s52 offen lds
    ds_read_b64_tr_b16 v[76:77], v19 offset:0
    ds_read_b64_tr_b16 v[78:79], v19 offset:1024
    s_waitcnt lgkmcnt(4)
    v_mfma_f32_16x16x32_bf16 a[208:211], v[68:71], v[48:51], a[208:211]
    v_mfma_f32_16x16x32_bf16 a[212:215], v[68:71], v[52:55], a[212:215]
    s_add_u32 m0, s51, 98304
    s_add_u32 s52, s47, 0
    buffer_load_dwordx4 v10, s[8:11], s52 offen lds
    v_mfma_f32_16x16x32_bf16 a[216:219], v[68:71], v[56:59], a[216:219]
    v_mfma_f32_16x16x32_bf16 a[220:223], v[68:71], v[60:63], a[220:223]
    s_add_u32 m0, s51, 99328
    s_add_u32 s52, s47, 20480
    buffer_load_dwordx4 v10, s[8:11], s52 offen lds
    ds_read_b128 v[32:35], v28 offset:24576
    ds_read_b128 v[36:39], v28 offset:25600
    ds_read_b128 v[40:43], v28 offset:26624
    ds_read_b128 v[44:47], v28 offset:27648
    ds_read_b64_tr_b16 v[64:65], v12 offset:24576
    ds_read_b64_tr_b16 v[66:67], v12 offset:25600
    s_waitcnt lgkmcnt(8)
    v_mfma_f32_16x16x32_bf16 a[224:227], v[72:75], v[48:51], a[224:227]
    v_mfma_f32_16x16x32_bf16 a[228:231], v[72:75], v[52:55], a[228:231]
    s_add_u32 m0, s51, 100352
    s_add_u32 s52, s47, 40960
    buffer_load_dwordx4 v10, s[8:11], s52 offen lds
    v_mfma_f32_16x16x32_bf16 a[232:235], v[72:75], v[56:59], a[232:235]
    v_mfma_f32_16x16x32_bf16 a[236:239], v[72:75], v[60:63], a[236:239]
    s_add_u32 m0, s51, 101376
    s_add_u32 s52, s47, 61440
    buffer_load_dwordx4 v10, s[8:11], s52 offen lds
    ds_read_b64_tr_b16 v[68:69], v13 offset:24576
    ds_read_b64_tr_b16 v[70:71], v13 offset:25600
    s_waitcnt lgkmcnt(8)
    v_mfma_f32_16x16x32_bf16 a[240:243], v[76:79], v[48:51], a[240:243]
    v_mfma_f32_16x16x32_bf16 a[244:247], v[76:79], v[52:55], a[244:247]
    s_add_u32 s46, s46, 262144
    s_add_u32 s47, s47, 64
    v_mfma_f32_16x16x32_bf16 a[248:251], v[76:79], v[56:59], a[248:251]
    v_mfma_f32_16x16x32_bf16 a[252:255], v[76:79], v[60:63], a[252:255]
    ds_read_b64_tr_b16 v[72:73], v14 offset:24576
    ds_read_b64_tr_b16 v[74:75], v14 offset:25600
    s_waitcnt lgkmcnt(6)
    s_waitcnt lgkmcnt(4)
    v_mfma_f32_16x16x32_bf16 a[128:131], v[64:67], v[32:35], a[128:131]
    v_mfma_f32_16x16x32_bf16 a[132:135], v[64:67], v[36:39], a[132:135]
    v_mfma_f32_16x16x32_bf16 a[136:139], v[64:67], v[40:43], a[136:139]
    v_mfma_f32_16x16x32_bf16 a[140:143], v[64:67], v[44:47], a[140:143]
    ds_read_b64_tr_b16 v[76:77], v15 offset:24576
    ds_read_b64_tr_b16 v[78:79], v15 offset:25600
    s_waitcnt lgkmcnt(4)
    v_mfma_f32_16x16x32_bf16 a[144:147], v[68:71], v[32:35], a[144:147]
    v_mfma_f32_16x16x32_bf16 a[148:151], v[68:71], v[36:39], a[148:151]
    v_mfma_f32_16x16x32_bf16 a[152:155], v[68:71], v[40:43], a[152:155]
    v_mfma_f32_16x16x32_bf16 a[156:159], v[68:71], v[44:47], a[156:159]
    ds_read_b64_tr_b16 v[64:65], v16 offset:24576
    ds_read_b64_tr_b16 v[66:67], v16 offset:25600
    s_waitcnt lgkmcnt(4)
    v_mfma_f32_16x16x32_bf16 a[160:163], v[72:75], v[32:35], a[160:163]
    v_mfma_f32_16x16x32_bf16 a[164:167], v[72:75], v[36:39], a[164:167]
    v_mfma_f32_16x16x32_bf16 a[168:171], v[72:75], v[40:43], a[168:171]
    v_mfma_f32_16x16x32_bf16 a[172:175], v[72:75], v[44:47], a[172:175]
    ds_read_b64_tr_b16 v[68:69], v17 offset:24576
    ds_read_b64_tr_b16 v[70:71], v17 offset:25600
    s_waitcnt lgkmcnt(4)
    v_mfma_f32_16x16x32_bf16 a[176:179], v[76:79], v[32:35], a[176:179]
    v_mfma_f32_16x16x32_bf16 a[180:183], v[76:79], v[36:39], a[180:183]
    v_mfma_f32_16x16x32_bf16 a[184:187], v[76:79], v[40:43], a[184:187]
    v_mfma_f32_16x16x32_bf16 a[188:191], v[76:79], v[44:47], a[188:191]
    s_waitcnt vmcnt(12)
    s_barrier
    ds_read_b64_tr_b16 v[72:73], v18 offset:24576
    ds_read_b64_tr_b16 v[74:75], v18 offset:25600
    s_waitcnt lgkmcnt(4)
    v_mfma_f32_16x16x32_bf16 a[192:195], v[64:67], v[32:35], a[192:195]
    v_mfma_f32_16x16x32_bf16 a[196:199], v[64:67], v[36:39], a[196:199]
    s_add_u32 m0, s50, 0
    s_add_u32 s52, s46, 0x0
    buffer_load_dwordx4 v9, s[12:15], s52 offen lds
    v_mfma_f32_16x16x32_bf16 a[200:203], v[64:67], v[40:43], a[200:203]
    v_mfma_f32_16x16x32_bf16 a[204:207], v[64:67], v[44:47], a[204:207]
    s_add_u32 m0, s50, 1024
    s_add_u32 s52, s46, 0x8000
    buffer_load_dwordx4 v9, s[12:15], s52 offen lds
    ds_read_b64_tr_b16 v[76:77], v19 offset:24576
    ds_read_b64_tr_b16 v[78:79], v19 offset:25600
    s_waitcnt lgkmcnt(4)
    v_mfma_f32_16x16x32_bf16 a[208:211], v[68:71], v[32:35], a[208:211]
    v_mfma_f32_16x16x32_bf16 a[212:215], v[68:71], v[36:39], a[212:215]
    s_add_u32 m0, s51, 0
    s_add_u32 s52, s47, 0
    buffer_load_dwordx4 v10, s[8:11], s52 offen lds
    v_mfma_f32_16x16x32_bf16 a[216:219], v[68:71], v[40:43], a[216:219]
    v_mfma_f32_16x16x32_bf16 a[220:223], v[68:71], v[44:47], a[220:223]
    s_add_u32 m0, s51, 1024
    s_add_u32 s52, s47, 20480
    buffer_load_dwordx4 v10, s[8:11], s52 offen lds
    ds_read_b128 v[48:51], v28 offset:49152
    ds_read_b128 v[52:55], v28 offset:50176
    ds_read_b128 v[56:59], v28 offset:51200
    ds_read_b128 v[60:63], v28 offset:52224
    ds_read_b64_tr_b16 v[64:65], v12 offset:49152
    ds_read_b64_tr_b16 v[66:67], v12 offset:50176
    s_waitcnt lgkmcnt(8)
    v_mfma_f32_16x16x32_bf16 a[224:227], v[72:75], v[32:35], a[224:227]
    v_mfma_f32_16x16x32_bf16 a[228:231], v[72:75], v[36:39], a[228:231]
    s_add_u32 m0, s51, 2048
    s_add_u32 s52, s47, 40960
    buffer_load_dwordx4 v10, s[8:11], s52 offen lds
    v_mfma_f32_16x16x32_bf16 a[232:235], v[72:75], v[40:43], a[232:235]
    v_mfma_f32_16x16x32_bf16 a[236:239], v[72:75], v[44:47], a[236:239]
    s_add_u32 m0, s51, 3072
    s_add_u32 s52, s47, 61440
    buffer_load_dwordx4 v10, s[8:11], s52 offen lds
    ds_read_b64_tr_b16 v[68:69], v13 offset:49152
    ds_read_b64_tr_b16 v[70:71], v13 offset:50176
    s_waitcnt lgkmcnt(8)
    v_mfma_f32_16x16x32_bf16 a[240:243], v[76:79], v[32:35], a[240:243]
    v_mfma_f32_16x16x32_bf16 a[244:247], v[76:79], v[36:39], a[244:247]
    s_add_u32 s46, s46, 262144
    s_add_u32 s47, s47, 64
    v_mfma_f32_16x16x32_bf16 a[248:251], v[76:79], v[40:43], a[248:251]
    v_mfma_f32_16x16x32_bf16 a[252:255], v[76:79], v[44:47], a[252:255]
    ds_read_b64_tr_b16 v[72:73], v14 offset:49152
    ds_read_b64_tr_b16 v[74:75], v14 offset:50176
    s_waitcnt lgkmcnt(6)
    s_waitcnt lgkmcnt(4)
    v_mfma_f32_16x16x32_bf16 a[128:131], v[64:67], v[48:51], a[128:131]
    v_mfma_f32_16x16x32_bf16 a[132:135], v[64:67], v[52:55], a[132:135]
    v_mfma_f32_16x16x32_bf16 a[136:139], v[64:67], v[56:59], a[136:139]
    v_mfma_f32_16x16x32_bf16 a[140:143], v[64:67], v[60:63], a[140:143]
    ds_read_b64_tr_b16 v[76:77], v15 offset:49152
    ds_read_b64_tr_b16 v[78:79], v15 offset:50176
    s_waitcnt lgkmcnt(4)
    v_mfma_f32_16x16x32_bf16 a[144:147], v[68:71], v[48:51], a[144:147]
    v_mfma_f32_16x16x32_bf16 a[148:151], v[68:71], v[52:55], a[148:151]
    v_mfma_f32_16x16x32_bf16 a[152:155], v[68:71], v[56:59], a[152:155]
    v_mfma_f32_16x16x32_bf16 a[156:159], v[68:71], v[60:63], a[156:159]
    ds_read_b64_tr_b16 v[64:65], v16 offset:49152
    ds_read_b64_tr_b16 v[66:67], v16 offset:50176
    s_waitcnt lgkmcnt(4)
    v_mfma_f32_16x16x32_bf16 a[160:163], v[72:75], v[48:51], a[160:163]
    v_mfma_f32_16x16x32_bf16 a[164:167], v[72:75], v[52:55], a[164:167]
    v_mfma_f32_16x16x32_bf16 a[168:171], v[72:75], v[56:59], a[168:171]
    v_mfma_f32_16x16x32_bf16 a[172:175], v[72:75], v[60:63], a[172:175]
    ds_read_b64_tr_b16 v[68:69], v17 offset:49152
    ds_read_b64_tr_b16 v[70:71], v17 offset:50176
    s_waitcnt lgkmcnt(4)
    v_mfma_f32_16x16x32_bf16 a[176:179], v[76:79], v[48:51], a[176:179]
    v_mfma_f32_16x16x32_bf16 a[180:183], v[76:79], v[52:55], a[180:183]
    v_mfma_f32_16x16x32_bf16 a[184:187], v[76:79], v[56:59], a[184:187]
    v_mfma_f32_16x16x32_bf16 a[188:191], v[76:79], v[60:63], a[188:191]
    s_waitcnt vmcnt(12)
    s_barrier
    ds_read_b64_tr_b16 v[72:73], v18 offset:49152
    ds_read_b64_tr_b16 v[74:75], v18 offset:50176
    s_waitcnt lgkmcnt(4)
    v_mfma_f32_16x16x32_bf16 a[192:195], v[64:67], v[48:51], a[192:195]
    v_mfma_f32_16x16x32_bf16 a[196:199], v[64:67], v[52:55], a[196:199]
    s_add_u32 m0, s50, 24576
    s_add_u32 s52, s46, 0x0
    buffer_load_dwordx4 v9, s[12:15], s52 offen lds
    v_mfma_f32_16x16x32_bf16 a[200:203], v[64:67], v[56:59], a[200:203]
    v_mfma_f32_16x16x32_bf16 a[204:207], v[64:67], v[60:63], a[204:207]
    s_add_u32 m0, s50, 25600
    s_add_u32 s52, s46, 0x8000
    buffer_load_dwordx4 v9, s[12:15], s52 offen lds
    ds_read_b64_tr_b16 v[76:77], v19 offset:49152
    ds_read_b64_tr_b16 v[78:79], v19 offset:50176
    s_waitcnt lgkmcnt(4)
    v_mfma_f32_16x16x32_bf16 a[208:211], v[68:71], v[48:51], a[208:211]
    v_mfma_f32_16x16x32_bf16 a[212:215], v[68:71], v[52:55], a[212:215]
    s_add_u32 m0, s51, 24576
    s_add_u32 s52, s47, 0
    buffer_load_dwordx4 v10, s[8:11], s52 offen lds
    v_mfma_f32_16x16x32_bf16 a[216:219], v[68:71], v[56:59], a[216:219]
    v_mfma_f32_16x16x32_bf16 a[220:223], v[68:71], v[60:63], a[220:223]
    s_add_u32 m0, s51, 25600
    s_add_u32 s52, s47, 20480
    buffer_load_dwordx4 v10, s[8:11], s52 offen lds
    ds_read_b128 v[32:35], v29 offset:8192
    ds_read_b128 v[36:39], v29 offset:9216
    ds_read_b128 v[40:43], v29 offset:10240
    ds_read_b128 v[44:47], v29 offset:11264
    ds_read_b64_tr_b16 v[64:65], v20 offset:8192
    ds_read_b64_tr_b16 v[66:67], v20 offset:9216
    s_waitcnt lgkmcnt(8)
    v_mfma_f32_16x16x32_bf16 a[224:227], v[72:75], v[48:51], a[224:227]
    v_mfma_f32_16x16x32_bf16 a[228:231], v[72:75], v[52:55], a[228:231]
    s_add_u32 m0, s51, 26624
    s_add_u32 s52, s47, 40960
    buffer_load_dwordx4 v10, s[8:11], s52 offen lds
    v_mfma_f32_16x16x32_bf16 a[232:235], v[72:75], v[56:59], a[232:235]
    v_mfma_f32_16x16x32_bf16 a[236:239], v[72:75], v[60:63], a[236:239]
    s_add_u32 m0, s51, 27648
    s_add_u32 s52, s47, 61440
    buffer_load_dwordx4 v10, s[8:11], s52 offen lds
    ds_read_b64_tr_b16 v[68:69], v21 offset:8192
    ds_read_b64_tr_b16 v[70:71], v21 offset:9216
    s_waitcnt lgkmcnt(8)
    v_mfma_f32_16x16x32_bf16 a[240:243], v[76:79], v[48:51], a[240:243]
    v_mfma_f32_16x16x32_bf16 a[244:247], v[76:79], v[52:55], a[244:247]
    s_add_u32 s46, s46, 262144
    s_add_u32 s47, s47, 64
    v_mfma_f32_16x16x32_bf16 a[248:251], v[76:79], v[56:59], a[248:251]
    v_mfma_f32_16x16x32_bf16 a[252:255], v[76:79], v[60:63], a[252:255]
    ds_read_b64_tr_b16 v[72:73], v22 offset:8192
    ds_read_b64_tr_b16 v[74:75], v22 offset:9216
    s_waitcnt lgkmcnt(6)
    s_waitcnt lgkmcnt(4)
    v_mfma_f32_16x16x32_bf16 a[128:131], v[64:67], v[32:35], a[128:131]
    v_mfma_f32_16x16x32_bf16 a[132:135], v[64:67], v[36:39], a[132:135]
    v_mfma_f32_16x16x32_bf16 a[136:139], v[64:67], v[40:43], a[136:139]
    v_mfma_f32_16x16x32_bf16 a[140:143], v[64:67], v[44:47], a[140:143]
    ds_read_b64_tr_b16 v[76:77], v23 offset:8192
    ds_read_b64_tr_b16 v[78:79], v23 offset:9216
    s_waitcnt lgkmcnt(4)
    v_mfma_f32_16x16x32_bf16 a[144:147], v[68:71], v[32:35], a[144:147]
    v_mfma_f32_16x16x32_bf16 a[148:151], v[68:71], v[36:39], a[148:151]
    v_mfma_f32_16x16x32_bf16 a[152:155], v[68:71], v[40:43], a[152:155]
    v_mfma_f32_16x16x32_bf16 a[156:159], v[68:71], v[44:47], a[156:159]
    ds_read_b64_tr_b16 v[64:65], v24 offset:8192
    ds_read_b64_tr_b16 v[66:67], v24 offset:9216
    s_waitcnt lgkmcnt(4)
    v_mfma_f32_16x16x32_bf16 a[160:163], v[72:75], v[32:35], a[160:163]
    v_mfma_f32_16x16x32_bf16 a[164:167], v[72:75], v[36:39], a[164:167]
    v_mfma_f32_16x16x32_bf16 a[168:171], v[72:75], v[40:43], a[168:171]
    v_mfma_f32_16x16x32_bf16 a[172:175], v[72:75], v[44:47], a[172:175]
    ds_read_b64_tr_b16 v[68:69], v25 offset:8192
    ds_read_b64_tr_b16 v[70:71], v25 offset:9216
    s_waitcnt lgkmcnt(4)
    v_mfma_f32_16x16x32_bf16 a[176:179], v[76:79], v[32:35], a[176:179]
    v_mfma_f32_16x16x32_bf16 a[180:183], v[76:79], v[36:39], a[180:183]
    v_mfma_f32_16x16x32_bf16 a[184:187], v[76:79], v[40:43], a[184:187]
    v_mfma_f32_16x16x32_bf16 a[188:191], v[76:79], v[44:47], a[188:191]
    s_waitcnt vmcnt(12)
    s_barrier
    ds_read_b64_tr_b16 v[72:73], v26 offset:8192
    ds_read_b64_tr_b16 v[74:75], v26 offset:9216
    s_waitcnt lgkmcnt(4)
    v_mfma_f32_16x16x32_bf16 a[192:195], v[64:67], v[32:35], a[192:195]
    v_mfma_f32_16x16x32_bf16 a[196:199], v[64:67], v[36:39], a[196:199]
    s_add_u32 m0, s50, 49152
    s_add_u32 s52, s46, 0x0
    buffer_load_dwordx4 v9, s[12:15], s52 offen lds
    v_mfma_f32_16x16x32_bf16 a[200:203], v[64:67], v[40:43], a[200:203]
    v_mfma_f32_16x16x32_bf16 a[204:207], v[64:67], v[44:47], a[204:207]
    s_add_u32 m0, s50, 50176
    s_add_u32 s52, s46, 0x8000
    buffer_load_dwordx4 v9, s[12:15], s52 offen lds
    ds_read_b64_tr_b16 v[76:77], v27 offset:8192
    ds_read_b64_tr_b16 v[78:79], v27 offset:9216
    s_waitcnt lgkmcnt(4)
    v_mfma_f32_16x16x32_bf16 a[208:211], v[68:71], v[32:35], a[208:211]
    v_mfma_f32_16x16x32_bf16 a[212:215], v[68:71], v[36:39], a[212:215]
    s_add_u32 m0, s51, 49152
    s_add_u32 s52, s47, 0
    buffer_load_dwordx4 v10, s[8:11], s52 offen lds
    v_mfma_f32_16x16x32_bf16 a[216:219], v[68:71], v[40:43], a[216:219]
    v_mfma_f32_16x16x32_bf16 a[220:223], v[68:71], v[44:47], a[220:223]
    s_add_u32 m0, s51, 50176
    s_add_u32 s52, s47, 20480
    buffer_load_dwordx4 v10, s[8:11], s52 offen lds
    ds_read_b128 v[48:51], v29 offset:32768
    ds_read_b128 v[52:55], v29 offset:33792
    ds_read_b128 v[56:59], v29 offset:34816
    ds_read_b128 v[60:63], v29 offset:35840
    ds_read_b64_tr_b16 v[64:65], v20 offset:32768
    ds_read_b64_tr_b16 v[66:67], v20 offset:33792
    s_waitcnt lgkmcnt(8)
    v_mfma_f32_16x16x32_bf16 a[224:227], v[72:75], v[32:35], a[224:227]
    v_mfma_f32_16x16x32_bf16 a[228:231], v[72:75], v[36:39], a[228:231]
    s_add_u32 m0, s51, 51200
    s_add_u32 s52, s47, 40960
    buffer_load_dwordx4 v10, s[8:11], s52 offen lds
    v_mfma_f32_16x16x32_bf16 a[232:235], v[72:75], v[40:43], a[232:235]
    v_mfma_f32_16x16x32_bf16 a[236:239], v[72:75], v[44:47], a[236:239]
    s_add_u32 m0, s51, 52224
    s_add_u32 s52, s47, 61440
    buffer_load_dwordx4 v10, s[8:11], s52 offen lds
    ds_read_b64_tr_b16 v[68:69], v21 offset:32768
    ds_read_b64_tr_b16 v[70:71], v21 offset:33792
    s_waitcnt lgkmcnt(8)
    v_mfma_f32_16x16x32_bf16 a[240:243], v[76:79], v[32:35], a[240:243]
    v_mfma_f32_16x16x32_bf16 a[244:247], v[76:79], v[36:39], a[244:247]
    s_add_u32 s46, s46, 262144
    s_add_u32 s47, s47, 64
    v_mfma_f32_16x16x32_bf16 a[248:251], v[76:79], v[40:43], a[248:251]
    v_mfma_f32_16x16x32_bf16 a[252:255], v[76:79], v[44:47], a[252:255]
    ds_read_b64_tr_b16 v[72:73], v22 offset:32768
    ds_read_b64_tr_b16 v[74:75], v22 offset:33792
    s_waitcnt lgkmcnt(6)
    s_waitcnt lgkmcnt(4)
    v_mfma_f32_16x16x32_bf16 a[128:131], v[64:67], v[48:51], a[128:131]
    v_mfma_f32_16x16x32_bf16 a[132:135], v[64:67], v[52:55], a[132:135]
    v_mfma_f32_16x16x32_bf16 a[136:139], v[64:67], v[56:59], a[136:139]
    v_mfma_f32_16x16x32_bf16 a[140:143], v[64:67], v[60:63], a[140:143]
    ds_read_b64_tr_b16 v[76:77], v23 offset:32768
    ds_read_b64_tr_b16 v[78:79], v23 offset:33792
    s_waitcnt lgkmcnt(4)
    v_mfma_f32_16x16x32_bf16 a[144:147], v[68:71], v[48:51], a[144:147]
    v_mfma_f32_16x16x32_bf16 a[148:151], v[68:71], v[52:55], a[148:151]
    v_mfma_f32_16x16x32_bf16 a[152:155], v[68:71], v[56:59], a[152:155]
    v_mfma_f32_16x16x32_bf16 a[156:159], v[68:71], v[60:63], a[156:159]
    ds_read_b64_tr_b16 v[64:65], v24 offset:32768
    ds_read_b64_tr_b16 v[66:67], v24 offset:33792
    s_waitcnt lgkmcnt(4)
    v_mfma_f32_16x16x32_bf16 a[160:163], v[72:75], v[48:51], a[160:163]
    v_mfma_f32_16x16x32_bf16 a[164:167], v[72:75], v[52:55], a[164:167]
    v_mfma_f32_16x16x32_bf16 a[168:171], v[72:75], v[56:59], a[168:171]
    v_mfma_f32_16x16x32_bf16 a[172:175], v[72:75], v[60:63], a[172:175]
    ds_read_b64_tr_b16 v[68:69], v25 offset:32768
    ds_read_b64_tr_b16 v[70:71], v25 offset:33792
    s_waitcnt lgkmcnt(4)
    v_mfma_f32_16x16x32_bf16 a[176:179], v[76:79], v[48:51], a[176:179]
    v_mfma_f32_16x16x32_bf16 a[180:183], v[76:79], v[52:55], a[180:183]
    v_mfma_f32_16x16x32_bf16 a[184:187], v[76:79], v[56:59], a[184:187]
    v_mfma_f32_16x16x32_bf16 a[188:191], v[76:79], v[60:63], a[188:191]
    s_waitcnt vmcnt(12)
    s_barrier
    ds_read_b64_tr_b16 v[72:73], v26 offset:32768
    ds_read_b64_tr_b16 v[74:75], v26 offset:33792
    s_waitcnt lgkmcnt(4)
    v_mfma_f32_16x16x32_bf16 a[192:195], v[64:67], v[48:51], a[192:195]
    v_mfma_f32_16x16x32_bf16 a[196:199], v[64:67], v[52:55], a[196:199]
    s_add_u32 m0, s50, 73728
    s_add_u32 s52, s46, 0x0
    buffer_load_dwordx4 v9, s[12:15], s52 offen lds
    v_mfma_f32_16x16x32_bf16 a[200:203], v[64:67], v[56:59], a[200:203]
    v_mfma_f32_16x16x32_bf16 a[204:207], v[64:67], v[60:63], a[204:207]
    s_add_u32 m0, s50, 74752
    s_add_u32 s52, s46, 0x8000
    buffer_load_dwordx4 v9, s[12:15], s52 offen lds
    ds_read_b64_tr_b16 v[76:77], v27 offset:32768
    ds_read_b64_tr_b16 v[78:79], v27 offset:33792
    s_waitcnt lgkmcnt(4)
    v_mfma_f32_16x16x32_bf16 a[208:211], v[68:71], v[48:51], a[208:211]
    v_mfma_f32_16x16x32_bf16 a[212:215], v[68:71], v[52:55], a[212:215]
    s_add_u32 m0, s51, 73728
    s_add_u32 s52, s47, 0
    buffer_load_dwordx4 v10, s[8:11], s52 offen lds
    v_mfma_f32_16x16x32_bf16 a[216:219], v[68:71], v[56:59], a[216:219]
    v_mfma_f32_16x16x32_bf16 a[220:223], v[68:71], v[60:63], a[220:223]
    s_add_u32 m0, s51, 74752
    s_add_u32 s52, s47, 20480
    buffer_load_dwordx4 v10, s[8:11], s52 offen lds
    ds_read_b128 v[32:35], v28 offset:0
    ds_read_b128 v[36:39], v28 offset:1024
    ds_read_b128 v[40:43], v28 offset:2048
    ds_read_b128 v[44:47], v28 offset:3072
    ds_read_b64_tr_b16 v[64:65], v12 offset:0
    ds_read_b64_tr_b16 v[66:67], v12 offset:1024
    s_waitcnt lgkmcnt(8)
    v_mfma_f32_16x16x32_bf16 a[224:227], v[72:75], v[48:51], a[224:227]
    v_mfma_f32_16x16x32_bf16 a[228:231], v[72:75], v[52:55], a[228:231]
    s_add_u32 m0, s51, 75776
    s_add_u32 s52, s47, 40960
    buffer_load_dwordx4 v10, s[8:11], s52 offen lds
    v_mfma_f32_16x16x32_bf16 a[232:235], v[72:75], v[56:59], a[232:235]
    v_mfma_f32_16x16x32_bf16 a[236:239], v[72:75], v[60:63], a[236:239]
    s_add_u32 m0, s51, 76800
    s_add_u32 s52, s47, 61440
    buffer_load_dwordx4 v10, s[8:11], s52 offen lds
    ds_read_b64_tr_b16 v[68:69], v13 offset:0
    ds_read_b64_tr_b16 v[70:71], v13 offset:1024
    s_waitcnt lgkmcnt(8)
    v_mfma_f32_16x16x32_bf16 a[240:243], v[76:79], v[48:51], a[240:243]
    v_mfma_f32_16x16x32_bf16 a[244:247], v[76:79], v[52:55], a[244:247]
    s_add_u32 s46, s46, 262144
    s_add_u32 s47, s47, 64
    v_mfma_f32_16x16x32_bf16 a[248:251], v[76:79], v[56:59], a[248:251]
    v_mfma_f32_16x16x32_bf16 a[252:255], v[76:79], v[60:63], a[252:255]
    s_add_u32 s43, s43, 1
    s_cmp_lt_u32 s43, 2
    s_cbranch_scc1 Lpg_100
    s_waitcnt vmcnt(0) lgkmcnt(0)
    s_barrier
    s_nop 3
    v_or_b32 v6, 0, v3
    v_lshrrev_b32 v7, 1, v2
    v_xor_b32 v7, v7, v6
    v_and_b32 v8, 1, v2
    v_lshl_add_u32 v7, v7, 1, v8
    v_lshlrev_b32 v7, 4, v7
    v_mul_u32_u24 v8, 1280, v3
    v_add_u32 v7, v7, v8
    s_lshl_b32 s44, s41, 7
    s_lshl_b32 s45, s42, 5
    s_add_u32 s44, s44, s45
    s_mul_i32 s44, s44, 1280
    v_add_u32 v9, s44, v7
    v_or_b32 v6, 4, v3
    v_lshrrev_b32 v7, 1, v2
    v_xor_b32 v7, v7, v6
    v_and_b32 v8, 1, v2
    v_lshl_add_u32 v7, v7, 1, v8
    v_lshlrev_b32 v7, 4, v7
    v_mul_u32_u24 v8, 1280, v3
    v_add_u32 v7, v7, v8
    s_lshl_b32 s44, s41, 7
    s_lshl_b32 s45, s42, 5
    s_add_u32 s44, s44, s45
    s_mul_i32 s44, s44, 1280
    v_add_u32 v10, s44, v7
    s_lshl_b32 s50, s42, 13
    v_lshrrev_b32 v6, 2, v2
    v_lshl_add_u32 v6, v3, 2, v6
    v_and_b32 v7, 7, v6
    v_lshlrev_b32 v6, 8, v6
    v_and_b32 v8, 3, v2
    v_lshl_add_u32 v6, v8, 3, v6
    v_xor_b32 v8, 0, v7
    v_lshl_add_u32 v12, v8, 5, v6
    v_add_u32 v20, 0x10000, v12
    v_xor_b32 v8, 1, v7
    v_lshl_add_u32 v13, v8, 5, v6
    v_add_u32 v21, 0x10000, v13
    v_xor_b32 v8, 2, v7
    v_lshl_add_u32 v14, v8, 5, v6
    v_add_u32 v22, 0x10000, v14
    v_xor_b32 v8, 3, v7
    v_lshl_add_u32 v15, v8, 5, v6
    v_add_u32 v23, 0x10000, v15
    v_xor_b32 v8, 4, v7
    v_lshl_add_u32 v16, v8, 5, v6
    v_add_u32 v24, 0x10000, v16
    v_xor_b32 v8, 5, v7
    v_lshl_add_u32 v17, v8, 5, v6
    v_add_u32 v25, 0x10000, v17
    v_xor_b32 v8, 6, v7
    v_lshl_add_u32 v18, v8, 5, v6
    v_add_u32 v26, 0x10000, v18
    v_xor_b32 v8, 7, v7
    v_lshl_add_u32 v19, v8, 5, v6
    v_add_u32 v27, 0x10000, v19
    s_lshl_b32 s44, s40, 2
    s_add_u32 s44, s44, s42
    s_mul_i32 s44, s44, 64
    s_add_u32 s44, s44, s41
    s_lshl_b32 s48, s44, 13
    v_lshlrev_b32 v28, 4, v1
    v_add_u32 v28, s48, v28
    s_mul_i32 s48, s44, 40960
    v_and_b32 v6, 7, v2
    v_lshl_add_u32 v6, v3, 3, v6
    v_lshlrev_b32 v6, 4, v6
    v_lshrrev_b32 v7, 3, v2
    v_lshl_add_u32 v6, v7, 9, v6
    v_add_u32 v29, s48, v6
    v_accvgpr_read_b32 v32, a128
    v_accvgpr_read_b32 v33, a129
    v_accvgpr_read_b32 v34, a130
    v_accvgpr_read_b32 v35, a131
    v_cvt_pk_bf16_f32 v40, v32, v33
    v_cvt_pk_bf16_f32 v41, v34, v35
    v_accvgpr_read_b32 v36, a144
    v_accvgpr_read_b32 v37, a145
    v_accvgpr_read_b32 v38, a146
    v_accvgpr_read_b32 v39, a147
    v_cvt_pk_bf16_f32 v42, v36, v37
    v_cvt_pk_bf16_f32 v43, v38, v39
    s_mov_b32 s45, 0x0
    buffer_store_dwordx4 v[40:43], v28, s[4:7], s45 offen sc1
    v_accvgpr_read_b32 v32, a160
    v_accvgpr_read_b32 v33, a161
    v_accvgpr_read_b32 v34, a162
    v_accvgpr_read_b32 v35, a163
    v_cvt_pk_bf16_f32 v44, v32, v33
    v_cvt_pk_bf16_f32 v45, v34, v35
    v_accvgpr_read_b32 v36, a176
    v_accvgpr_read_b32 v37, a177
    v_accvgpr_read_b32 v38, a178
    v_accvgpr_read_b32 v39, a179
    v_cvt_pk_bf16_f32 v46, v36, v37
    v_cvt_pk_bf16_f32 v47, v38, v39
    s_mov_b32 s45, 0x400
    buffer_store_dwordx4 v[44:47], v28, s[4:7], s45 offen sc1
    v_accvgpr_read_b32 v32, a192
    v_accvgpr_read_b32 v33, a193
    v_accvgpr_read_b32 v34, a194
    v_accvgpr_read_b32 v35, a195
    v_cvt_pk_bf16_f32 v48, v32, v33
    v_cvt_pk_bf16_f32 v49, v34, v35
    v_accvgpr_read_b32 v36, a208
    v_accvgpr_read_b32 v37, a209
    v_accvgpr_read_b32 v38, a210
    v_accvgpr_read_b32 v39, a211
    v_cvt_pk_bf16_f32 v50, v36, v37
    v_cvt_pk_bf16_f32 v51, v38, v39
    s_mov_b32 s45, 0x800
    buffer_store_dwordx4 v[48:51], v28, s[4:7], s45 offen sc1
    v_accvgpr_read_b32 v32, a224
    v_accvgpr_read_b32 v33, a225
    v_accvgpr_read_b32 v34, a226
    v_accvgpr_read_b32 v35, a227
    v_cvt_pk_bf16_f32 v52, v32, v33
    v_cvt_pk_bf16_f32 v53, v34, v35
    v_accvgpr_read_b32 v36, a240
    v_accvgpr_read_b32 v37, a241
    v_accvgpr_read_b32 v38, a242
    v_accvgpr_read_b32 v39, a243
    v_cvt_pk_bf16_f32 v54, v36, v37
    v_cvt_pk_bf16_f32 v55, v38, v39
    s_mov_b32 s45, 0xc00
    buffer_store_dwordx4 v[52:55], v28, s[4:7], s45 offen sc1
    v_accvgpr_read_b32 v32, a132
    v_accvgpr_read_b32 v33, a133
    v_accvgpr_read_b32 v34, a134
    v_accvgpr_read_b32 v35, a135
    v_cvt_pk_bf16_f32 v56, v32, v33
    v_cvt_pk_bf16_f32 v57, v34, v35
    v_accvgpr_read_b32 v36, a148
    v_accvgpr_read_b32 v37, a149
    v_accvgpr_read_b32 v38, a150
    v_accvgpr_read_b32 v39, a151
    v_cvt_pk_bf16_f32 v58, v36, v37
    v_cvt_pk_bf16_f32 v59, v38, v39
    s_mov_b32 s45, 0x1000
    buffer_store_dwordx4 v[56:59], v28, s[4:7], s45 offen sc1
    v_accvgpr_read_b32 v32, a164
    v_accvgpr_read_b32 v33, a165
    v_accvgpr_read_b32 v34, a166
    v_accvgpr_read_b32 v35, a167
    v_cvt_pk_bf16_f32 v60, v32, v33
    v_cvt_pk_bf16_f32 v61, v34, v35
    v_accvgpr_read_b32 v36, a180
    v_accvgpr_read_b32 v37, a181
    v_accvgpr_read_b32 v38, a182
    v_accvgpr_read_b32 v39, a183
    v_cvt_pk_bf16_f32 v62, v36, v37
    v_cvt_pk_bf16_f32 v63, v38, v39
    s_mov_b32 s45, 0x1400
    buffer_store_dwordx4 v[60:63], v28, s[4:7], s45 offen sc1
    v_accvgpr_read_b32 v32, a196
    v_accvgpr_read_b32 v33, a197
    v_accvgpr_read_b32 v34, a198
    v_accvgpr_read_b32 v35, a199
    v_cvt_pk_bf16_f32 v64, v32, v33
    v_cvt_pk_bf16_f32 v65, v34, v35
    v_accvgpr_read_b32 v36, a212
    v_accvgpr_read_b32 v37, a213
    v_accvgpr_read_b32 v38, a214
    v_accvgpr_read_b32 v39, a215
    v_cvt_pk_bf16_f32 v66, v36, v37
    v_cvt_pk_bf16_f32 v67, v38, v39
    s_mov_b32 s45, 0x1800
    buffer_store_dwordx4 v[64:67], v28, s[4:7], s45 offen sc1
    v_accvgpr_read_b32 v32, a228
    v_accvgpr_read_b32 v33, a229
    v_accvgpr_read_b32 v34, a230
    v_accvgpr_read_b32 v35, a231
    v_cvt_pk_bf16_f32 v68, v32, v33
    v_cvt_pk_bf16_f32 v69, v34, v35
    v_accvgpr_read_b32 v36, a244
    v_accvgpr_read_b32 v37, a245
    v_accvgpr_read_b32 v38, a246
    v_accvgpr_read_b32 v39, a247
    v_cvt_pk_bf16_f32 v70, v36, v37
    v_cvt_pk_bf16_f32 v71, v38, v39
    s_mov_b32 s45, 0x1c00
    buffer_store_dwordx4 v[68:71], v28, s[4:7], s45 offen sc1
    v_accvgpr_read_b32 v32, a136
    v_accvgpr_read_b32 v33, a137
    v_accvgpr_read_b32 v34, a138
    v_accvgpr_read_b32 v35, a139
    v_cvt_pk_bf16_f32 v40, v32, v33
    v_cvt_pk_bf16_f32 v41, v34, v35
    v_accvgpr_read_b32 v36, a152
    v_accvgpr_read_b32 v37, a153
    v_accvgpr_read_b32 v38, a154
    v_accvgpr_read_b32 v39, a155
    v_cvt_pk_bf16_f32 v42, v36, v37
    v_cvt_pk_bf16_f32 v43, v38, v39
    s_mov_b32 s45, 0x40000
    buffer_store_dwordx4 v[40:43], v28, s[4:7], s45 offen sc1
    v_accvgpr_read_b32 v32, a168
    v_accvgpr_read_b32 v33, a169
    v_accvgpr_read_b32 v34, a170
    v_accvgpr_read_b32 v35, a171
    v_cvt_pk_bf16_f32 v44, v32, v33
    v_cvt_pk_bf16_f32 v45, v34, v35
    v_accvgpr_read_b32 v36, a184
    v_accvgpr_read_b32 v37, a185
    v_accvgpr_read_b32 v38, a186
    v_accvgpr_read_b32 v39, a187
    v_cvt_pk_bf16_f32 v46, v36, v37
    v_cvt_pk_bf16_f32 v47, v38, v39
    s_mov_b32 s45, 0x40400
    buffer_store_dwordx4 v[44:47], v28, s[4:7], s45 offen sc1
    v_accvgpr_read_b32 v32, a200
    v_accvgpr_read_b32 v33, a201
    v_accvgpr_read_b32 v34, a202
    v_accvgpr_read_b32 v35, a203
    v_cvt_pk_bf16_f32 v48, v32, v33
    v_cvt_pk_bf16_f32 v49, v34, v35
    v_accvgpr_read_b32 v36, a216
    v_accvgpr_read_b32 v37, a217
    v_accvgpr_read_b32 v38, a218
    v_accvgpr_read_b32 v39, a219
    v_cvt_pk_bf16_f32 v50, v36, v37
    v_cvt_pk_bf16_f32 v51, v38, v39
    s_mov_b32 s45, 0x40800
    buffer_store_dwordx4 v[48:51], v28, s[4:7], s45 offen sc1
    v_accvgpr_read_b32 v32, a232
    v_accvgpr_read_b32 v33, a233
    v_accvgpr_read_b32 v34, a234
    v_accvgpr_read_b32 v35, a235
    v_cvt_pk_bf16_f32 v52, v32, v33
    v_cvt_pk_bf16_f32 v53, v34, v35
    v_accvgpr_read_b32 v36, a248
    v_accvgpr_read_b32 v37, a249
    v_accvgpr_read_b32 v38, a250
    v_accvgpr_read_b32 v39, a251
    v_cvt_pk_bf16_f32 v54, v36, v37
    v_cvt_pk_bf16_f32 v55, v38, v39
    s_mov_b32 s45, 0x40c00
    buffer_store_dwordx4 v[52:55], v28, s[4:7], s45 offen sc1
    v_accvgpr_read_b32 v32, a140
    v_accvgpr_read_b32 v33, a141
    v_accvgpr_read_b32 v34, a142
    v_accvgpr_read_b32 v35, a143
    v_cvt_pk_bf16_f32 v56, v32, v33
    v_cvt_pk_bf16_f32 v57, v34, v35
    v_accvgpr_read_b32 v36, a156
    v_accvgpr_read_b32 v37, a157
    v_accvgpr_read_b32 v38, a158
    v_accvgpr_read_b32 v39, a159
    v_cvt_pk_bf16_f32 v58, v36, v37
    v_cvt_pk_bf16_f32 v59, v38, v39
    s_mov_b32 s45, 0x41000
    buffer_store_dwordx4 v[56:59], v28, s[4:7], s45 offen sc1
    v_accvgpr_read_b32 v32, a172
    v_accvgpr_read_b32 v33, a173
    v_accvgpr_read_b32 v34, a174
    v_accvgpr_read_b32 v35, a175
    v_cvt_pk_bf16_f32 v60, v32, v33
    v_cvt_pk_bf16_f32 v61, v34, v35
    v_accvgpr_read_b32 v36, a188
    v_accvgpr_read_b32 v37, a189
    v_accvgpr_read_b32 v38, a190
    v_accvgpr_read_b32 v39, a191
    v_cvt_pk_bf16_f32 v62, v36, v37
    v_cvt_pk_bf16_f32 v63, v38, v39
    s_mov_b32 s45, 0x41400
    buffer_store_dwordx4 v[60:63], v28, s[4:7], s45 offen sc1
    v_accvgpr_read_b32 v32, a204
    v_accvgpr_read_b32 v33, a205
    v_accvgpr_read_b32 v34, a206
    v_accvgpr_read_b32 v35, a207
    v_cvt_pk_bf16_f32 v64, v32, v33
    v_cvt_pk_bf16_f32 v65, v34, v35
    v_accvgpr_read_b32 v36, a220
    v_accvgpr_read_b32 v37, a221
    v_accvgpr_read_b32 v38, a222
    v_accvgpr_read_b32 v39, a223
    v_cvt_pk_bf16_f32 v66, v36, v37
    v_cvt_pk_bf16_f32 v67, v38, v39
    s_mov_b32 s45, 0x41800
    buffer_store_dwordx4 v[64:67], v28, s[4:7], s45 offen sc1
    v_accvgpr_read_b32 v32, a236
    v_accvgpr_read_b32 v33, a237
    v_accvgpr_read_b32 v34, a238
    v_accvgpr_read_b32 v35, a239
    v_cvt_pk_bf16_f32 v68, v32, v33
    v_cvt_pk_bf16_f32 v69, v34, v35
    v_accvgpr_read_b32 v36, a252
    v_accvgpr_read_b32 v37, a253
    v_accvgpr_read_b32 v38, a254
    v_accvgpr_read_b32 v39, a255
    v_cvt_pk_bf16_f32 v70, v36, v37
    v_cvt_pk_bf16_f32 v71, v38, v39
    s_mov_b32 s45, 0x41c00
    buffer_store_dwordx4 v[68:71], v28, s[4:7], s45 offen sc1
    s_cmp_lg_u32 s97, 0
    s_cbranch_scc1 Lcf_101
    s_cmp_lg_u32 s42, 0
    s_cbranch_scc1 Lcf0_102
    s_load_dwordx2 s[88:89], s[0:1], 88
    v_and_b32 v4, 7, v0
    v_lshlrev_b32 v4, 5, v4
    v_bfe_u32 v5, v0, 3, 1
    v_lshl_add_u32 v4, v5, 2, v4
    v_add_u32 v4, 16, v4
    s_mov_b64 exec, 0xffff
    s_mov_b32 s43, 0
    s_waitcnt lgkmcnt(0)
    s_and_b32 s89, s89, 0xffff
    s_mov_b32 s90, 256
    s_mov_b32 s91, 0x00020000
Lcfp_103:
    buffer_load_dword v5, v4, s[88:91], 0 offen sc1
    s_waitcnt vmcnt(0)
    v_readlane_b32 s60, v5, 0
    v_readlane_b32 s61, v5, 1
    v_readlane_b32 s62, v5, 2
    v_readlane_b32 s63, v5, 3
    v_readlane_b32 s64, v5, 4
    v_readlane_b32 s65, v5, 5
    v_readlane_b32 s66, v5, 6
    v_readlane_b32 s67, v5, 7
    v_readlane_b32 s48, v5, 8
    v_readlane_b32 s49, v5, 9
    s_nop 3
    s_add_u32 s48, s48, s49
    v_readlane_b32 s49, v5, 10
    s_nop 3
    s_add_u32 s48, s48, s49
    v_readlane_b32 s49, v5, 11
    s_nop 3
    s_add_u32 s48, s48, s49
    v_readlane_b32 s49, v5, 12
    s_nop 3
    s_add_u32 s48, s48, s49
    v_readlane_b32 s49, v5, 13
    s_nop 3
    s_add_u32 s48, s48, s49
    v_readlane_b32 s49, v5, 14
    s_nop 3
    s_add_u32 s48, s48, s49
    v_readlane_b32 s49, v5, 15
    s_nop 3
    s_add_u32 s48, s48, s49
    s_add_u32 s43, s43, 1
    s_cmp_gt_u32 s43, 400000
    s_cbranch_scc0 Lcfo_104
    s_endpgm
Lcfo_104:
    s_cmp_lt_u32 s48, 256
    s_cbranch_scc1 Lcfp_103
    s_min_u32 s48, s60, s61
    s_min_u32 s48, s48, s62
    s_min_u32 s48, s48, s63
    s_min_u32 s48, s48, s64
    s_min_u32 s48, s48, s65
    s_min_u32 s48, s48, s66
    s_min_u32 s48, s48, s67
    s_mov_b32 s49, s99
    s_cmp_gt_u32 s98, 0
    s_cselect_b32 s43, s60, 0
    s_add_u32 s49, s49, s43
    s_cmp_gt_u32 s98, 1
    s_cselect_b32 s43, s61, 0
    s_add_u32 s49, s49, s43
    s_cmp_gt_u32 s98, 2
    s_cselect_b32 s43, s62, 0
    s_add_u32 s49, s49, s43
    s_cmp_gt_u32 s98, 3
    s_cselect_b32 s43, s63, 0
    s_add_u32 s49, s49, s43
    s_cmp_gt_u32 s98, 4
    s_cselect_b32 s43, s64, 0
    s_add_u32 s49, s49, s43
    s_cmp_gt_u32 s98, 5
    s_cselect_b32 s43, s65, 0
    s_add_u32 s49, s49, s43
    s_cmp_gt_u32 s98, 6
    s_cselect_b32 s43, s66, 0
    s_add_u32 s49, s49, s43
    s_or_b32 s49, s49, 0x300
    s_lshl_b32 s43, s98, 5
    s_add_u32 s43, s43, s99
    s_or_b32 s43, s43, 0x200
    s_cmp_ge_u32 s48, 32
    s_cselect_b32 s43, s43, s49
    s_mov_b64 exec, 1
    v_mov_b32 v4, 163824
    v_mov_b32 v5, s43
    ds_write_b32 v4, v5
    s_waitcnt lgkmcnt(0)
    s_mov_b64 exec, -1
Lcf0_102:
    s_barrier
    v_mov_b32 v4, 163824
    ds_read_b32 v5, v4
    s_waitcnt lgkmcnt(0)
    v_readfirstlane_b32 s97, v5
    s_nop 3
    s_barrier
    s_bitcmp1_b32 s97, 8
    s_cbranch_scc0 Lcf_101
    s_branch Lentry_3
Lcf_101:
    s_lshl_b32 s75, s40, 12
    s_lshl_b32 s44, s41, 7
    s_add_u32 s75, s75, s44
    s_add_u32 s75, s75, 0x8c01000
    s_waitcnt vmcnt(0)
    s_barrier
    s_cmp_lg_u32 s42, 0
    s_cbranch_scc1 Lsig_105
    s_mov_b64 exec, 1
    v_mov_b32 v4, 1
    v_mov_b32 v5, 0
    buffer_atomic_add v4, v5, s[4:7], s75 offen
    s_add_u32 s75, s75, 4096
    buffer_atomic_add v4, v5, s[4:7], s75 offen
    s_mov_b64 exec, -1
Lsig_105:
Lcs_98:
    s_add_u32 s73, s71, 4
    s_sub_u32 s86, 5, s71
    s_cmp_lt_u32 s71, 2
    s_cselect_b32 s73, s73, s86
Lkvu_106:
    s_mov_b32 s40, s73
    s_mov_b32 s41, s72
    s_mov_b32 s8, s24
    s_and_b32 s9, s25, 0xffff
    s_mov_b32 s10, 0x280000
    s_mov_b32 s11, 0x00020000
    s_mov_b32 s12, s30
    s_and_b32 s13, s31, 0xffff
    s_mov_b32 s14, 0x500000
    s_mov_b32 s15, 0x00020000
    s_mov_b32 s16, s32
    s_and_b32 s17, s33, 0xffff
    s_mov_b32 s18, 0x500000
    s_mov_b32 s19, 0x00020000
    s_mov_b32 s20, s34
    s_and_b32 s21, s35, 0xffff
    s_mov_b32 s22, 0x500000
    s_mov_b32 s23, 0x00020000
    s_and_b32 s44, s42, 1
    s_lshl_b32 s44, s44, 2
    v_or_b32 v6, s44, v3
    v_lshrrev_b32 v7, 1, v2
    v_xor_b32 v7, v7, v6
    v_and_b32 v8, 1, v2
    v_lshl_add_u32 v7, v7, 1, v8
    v_lshlrev_b32 v7, 4, v7
    v_mul_u32_u24 v8, 8192, v3
    v_add_u32 v7, v7, v8
    s_mul_i32 s44, s42, 65536
    s_lshl_b32 s45, s41, 8
    s_add_u32 s44, s44, s45
    v_add_u32 v9, s44, v7
    v_lshrrev_b32 v6, 2, v1
    v_mul_u32_u24 v6, 1280, v6
    v_and_b32 v7, 3, v1
    v_xor_b32 v7, v7, v3
    v_lshl_add_u32 v6, v7, 4, v6
    s_lshl_b32 s44, s40, 2
    s_add_u32 s44, s44, s42
    s_mul_i32 s44, s44, 40960
    v_add_u32 v10, s44, v6
    v_lshrrev_b32 v6, 2, v2
    v_and_b32 v7, 1, v3
    v_lshl_or_b32 v7, v7, 2, v6
    v_lshl_add_u32 v6, v3, 3, v6
    v_lshlrev_b32 v6, 8, v6
    v_and_b32 v8, 3, v2
    v_lshl_add_u32 v6, v8, 3, v6
    v_xor_b32 v8, 0, v7
    v_lshl_add_u32 v12, v8, 5, v6
    v_add_u32 v20, 0x10000, v12
    v_xor_b32 v8, 1, v7
    v_lshl_add_u32 v13, v8, 5, v6
    v_add_u32 v21, 0x10000, v13
    v_xor_b32 v8, 2, v7
    v_lshl_add_u32 v14, v8, 5, v6
    v_add_u32 v22, 0x10000, v14
    v_xor_b32 v8, 3, v7
    v_lshl_add_u32 v15, v8, 5, v6
    v_add_u32 v23, 0x10000, v15
    v_xor_b32 v8, 4, v7
    v_lshl_add_u32 v16, v8, 5, v6
    v_add_u32 v24, 0x10000, v16
    v_xor_b32 v8, 5, v7
    v_lshl_add_u32 v17, v8, 5, v6
    v_add_u32 v25, 0x10000, v17
    v_xor_b32 v8, 6, v7
    v_lshl_add_u32 v18, v8, 5, v6
    v_add_u32 v26, 0x10000, v18
    v_xor_b32 v8, 7, v7
    v_lshl_add_u32 v19, v8, 5, v6
    v_add_u32 v27, 0x10000, v19
    v_lshrrev_b32 v6, 2, v2
    v_xor_b32 v6, v6, v3
    v_lshlrev_b32 v6, 4, v6
    v_lshl_add_u32 v6, v2, 6, v6
    s_mul_i32 s44, s42, 2048
    s_add_u32 s44, s44, 16384
    v_add_u32 v28, s44, v6
    v_add_u32 v29, 0x10000, v28
    s_lshl_b32 s50, s42, 11
    s_mov_b32 s51, s44
    s_mov_b32 s46, 0
    s_mov_b32 s47, 0x0
    s_mov_b32 s53, 0
    s_add_u32 m0, s50, 0
    s_add_u32 s52, s46, 0x0
    buffer_load_dwordx4 v9, s[12:15], s52 offen lds
    s_add_u32 m0, s50, 1024
    s_add_u32 s52, s46, 0x8000
    buffer_load_dwordx4 v9, s[12:15], s52 offen lds
    s_add_u32 m0, s50, 8192
    s_add_u32 s52, s46, 0x0
    buffer_load_dwordx4 v9, s[16:19], s52 offen lds
    s_add_u32 m0, s50, 9216
    s_add_u32 s52, s46, 0x8000
    buffer_load_dwordx4 v9, s[16:19], s52 offen lds
    s_add_u32 m0, s51, 0
    s_add_u32 s52, s47, 0
    buffer_load_dwordx4 v10, s[8:11], s52 offen lds
    s_add_u32 m0, s51, 1024
    s_add_u32 s52, s47, 20480
    buffer_load_dwordx4 v10, s[8:11], s52 offen lds
    s_add_u32 s46, s46, 262144
    s_add_u32 s47, s47, 64
    s_add_u32 m0, s50, 24576
    s_add_u32 s52, s46, 0x0
    buffer_load_dwordx4 v9, s[12:15], s52 offen lds
    s_add_u32 m0, s50, 25600
    s_add_u32 s52, s46, 0x8000
    buffer_load_dwordx4 v9, s[12:15], s52 offen lds
    s_add_u32 m0, s50, 32768
    s_add_u32 s52, s46, 0x0
    buffer_load_dwordx4 v9, s[16:19], s52 offen lds
    s_add_u32 m0, s50, 33792
    s_add_u32 s52, s46, 0x8000
    buffer_load_dwordx4 v9, s[16:19], s52 offen lds
    s_add_u32 m0, s51, 24576
    s_add_u32 s52, s47, 0
    buffer_load_dwordx4 v10, s[8:11], s52 offen lds
    s_add_u32 m0, s51, 25600
    s_add_u32 s52, s47, 20480
    buffer_load_dwordx4 v10, s[8:11], s52 offen lds
    s_add_u32 s46, s46, 262144
    s_add_u32 s47, s47, 64
    s_add_u32 m0, s50, 49152
    s_add_u32 s52, s46, 0x0
    buffer_load_dwordx4 v9, s[12:15], s52 offen lds
    s_add_u32 m0, s50, 50176
    s_add_u32 s52, s46, 0x8000
    buffer_load_dwordx4 v9, s[12:15], s52 offen lds
    s_add_u32 m0, s50, 57344
    s_add_u32 s52, s46, 0x0
    buffer_load_dwordx4 v9, s[16:19], s52 offen lds
    s_add_u32 m0, s50, 58368
    s_add_u32 s52, s46, 0x8000
    buffer_load_dwordx4 v9, s[16:19], s52 offen lds
    s_add_u32 m0, s51, 49152
    s_add_u32 s52, s47, 0
    buffer_load_dwordx4 v10, s[8:11], s52 offen lds
    s_add_u32 m0, s51, 50176
    s_add_u32 s52, s47, 20480
    buffer_load_dwordx4 v10, s[8:11], s52 offen lds
    s_add_u32 s46, s46, 262144
    s_add_u32 s47, s47, 64
    s_add_u32 m0, s50, 73728
    s_add_u32 s52, s46, 0x0
    buffer_load_dwordx4 v9, s[12:15], s52 offen lds
    s_add_u32 m0, s50, 74752
    s_add_u32 s52, s46, 0x8000
    buffer_load_dwordx4 v9, s[12:15], s52 offen lds
    s_add_u32 m0, s50, 81920
    s_add_u32 s52, s46, 0x0
    buffer_load_dwordx4 v9, s[16:19], s52 offen lds
    s_add_u32 m0, s50, 82944
    s_add_u32 s52, s46, 0x8000
    buffer_load_dwordx4 v9, s[16:19], s52 offen lds
    s_add_u32 m0, s51, 73728
    s_add_u32 s52, s47, 0
    buffer_load_dwordx4 v10, s[8:11], s52 offen lds
    s_add_u32 m0, s51, 74752
    s_add_u32 s52, s47, 20480
    buffer_load_dwordx4 v10, s[8:11], s52 offen lds
    s_add_u32 s46, s46, 262144
    s_add_u32 s47, s47, 64
    v_accvgpr_write_b32 a64, 0
    v_accvgpr_write_b32 a65, 0
    v_accvgpr_write_b32 a66, 0
    v_accvgpr_write_b32 a67, 0
    v_accvgpr_write_b32 a68, 0
    v_accvgpr_write_b32 a69, 0
    v_accvgpr_write_b32 a70, 0
    v_accvgpr_write_b32 a71, 0
    v_accvgpr_write_b32 a72, 0
    v_accvgpr_write_b32 a73, 0
    v_accvgpr_write_b32 a74, 0
    v_accvgpr_write_b32 a75, 0
    v_accvgpr_write_b32 a76, 0
    v_accvgpr_write_b32 a77, 0
    v_accvgpr_write_b32 a78, 0
    v_accvgpr_write_b32 a79, 0
    v_accvgpr_write_b32 a80, 0
    v_accvgpr_write_b32 a81, 0
    v_accvgpr_write_b32 a82, 0
    v_accvgpr_write_b32 a83, 0
    v_accvgpr_write_b32 a84, 0
    v_accvgpr_write_b32 a85, 0
    v_accvgpr_write_b32 a86, 0
    v_accvgpr_write_b32 a87, 0
    v_accvgpr_write_b32 a88, 0
    v_accvgpr_write_b32 a89, 0
    v_accvgpr_write_b32 a90, 0
    v_accvgpr_write_b32 a91, 0
    v_accvgpr_write_b32 a92, 0
    v_accvgpr_write_b32 a93, 0
    v_accvgpr_write_b32 a94, 0
    v_accvgpr_write_b32 a95, 0
    v_accvgpr_write_b32 a96, 0
    v_accvgpr_write_b32 a97, 0
    v_accvgpr_write_b32 a98, 0
    v_accvgpr_write_b32 a99, 0
    v_accvgpr_write_b32 a100, 0
    v_accvgpr_write_b32 a101, 0
    v_accvgpr_write_b32 a102, 0
    v_accvgpr_write_b32 a103, 0
    v_accvgpr_write_b32 a104, 0
    v_accvgpr_write_b32 a105, 0
    v_accvgpr_write_b32 a106, 0
    v_accvgpr_write_b32 a107, 0
    v_accvgpr_write_b32 a108, 0
    v_accvgpr_write_b32 a109, 0
    v_accvgpr_write_b32 a110, 0
    v_accvgpr_write_b32 a111, 0
    v_accvgpr_write_b32 a112, 0
    v_accvgpr_write_b32 a113, 0
    v_accvgpr_write_b32 a114, 0
    v_accvgpr_write_b32 a115, 0
    v_accvgpr_write_b32 a116, 0
    v_accvgpr_write_b32 a117, 0
    v_accvgpr_write_b32 a118, 0
    v_accvgpr_write_b32 a119, 0
    v_accvgpr_write_b32 a120, 0
    v_accvgpr_write_b32 a121, 0
    v_accvgpr_write_b32 a122, 0
    v_accvgpr_write_b32 a123, 0
    v_accvgpr_write_b32 a124, 0
    v_accvgpr_write_b32 a125, 0
    v_accvgpr_write_b32 a126, 0
    v_accvgpr_write_b32 a127, 0
    v_accvgpr_write_b32 a0, 0
    v_accvgpr_write_b32 a1, 0
    v_accvgpr_write_b32 a2, 0
    v_accvgpr_write_b32 a3, 0
    v_accvgpr_write_b32 a4, 0
    v_accvgpr_write_b32 a5, 0
    v_accvgpr_write_b32 a6, 0
    v_accvgpr_write_b32 a7, 0
    v_accvgpr_write_b32 a8, 0
    v_accvgpr_write_b32 a9, 0
    v_accvgpr_write_b32 a10, 0
    v_accvgpr_write_b32 a11, 0
    v_accvgpr_write_b32 a12, 0
    v_accvgpr_write_b32 a13, 0
    v_accvgpr_write_b32 a14, 0
    v_accvgpr_write_b32 a15, 0
    v_accvgpr_write_b32 a16, 0
    v_accvgpr_write_b32 a17, 0
    v_accvgpr_write_b32 a18, 0
    v_accvgpr_write_b32 a19, 0
    v_accvgpr_write_b32 a20, 0
    v_accvgpr_write_b32 a21, 0
    v_accvgpr_write_b32 a22, 0
    v_accvgpr_write_b32 a23, 0
    v_accvgpr_write_b32 a24, 0
    v_accvgpr_write_b32 a25, 0
    v_accvgpr_write_b32 a26, 0
    v_accvgpr_write_b32 a27, 0
    v_accvgpr_write_b32 a28, 0
    v_accvgpr_write_b32 a29, 0
    v_accvgpr_write_b32 a30, 0
    v_accvgpr_write_b32 a31, 0
    v_accvgpr_write_b32 a32, 0
    v_accvgpr_write_b32 a33, 0
    v_accvgpr_write_b32 a34, 0
    v_accvgpr_write_b32 a35, 0
    v_accvgpr_write_b32 a36, 0
    v_accvgpr_write_b32 a37, 0
    v_accvgpr_write_b32 a38, 0
    v_accvgpr_write_b32 a39, 0
    v_accvgpr_write_b32 a40, 0
    v_accvgpr_write_b32 a41, 0
    v_accvgpr_write_b32 a42, 0
    v_accvgpr_write_b32 a43, 0
    v_accvgpr_write_b32 a44, 0
    v_accvgpr_write_b32 a45, 0
    v_accvgpr_write_b32 a46, 0
    v_accvgpr_write_b32 a47, 0
    v_accvgpr_write_b32 a48, 0
    v_accvgpr_write_b32 a49, 0
    v_accvgpr_write_b32 a50, 0
    v_accvgpr_write_b32 a51, 0
    v_accvgpr_write_b32 a52, 0
    v_accvgpr_write_b32 a53, 0
    v_accvgpr_write_b32 a54, 0
    v_accvgpr_write_b32 a55, 0
    v_accvgpr_write_b32 a56, 0
    v_accvgpr_write_b32 a57, 0
    v_accvgpr_write_b32 a58, 0
    v_accvgpr_write_b32 a59, 0
    v_accvgpr_write_b32 a60, 0
    v_accvgpr_write_b32 a61, 0
    v_accvgpr_write_b32 a62, 0
    v_accvgpr_write_b32 a63, 0
    s_waitcnt vmcnt(18)
    s_barrier
    ds_read_b128 v[32:35], v28 offset:0
    ds_read_b128 v[36:39], v28 offset:1024
    ds_read_b64_tr_b16 v[48:49], v12 offset:0
    ds_read_b64_tr_b16 v[50:51], v12 offset:1024
    ds_read_b64_tr_b16 v[52:53], v13 offset:0
    ds_read_b64_tr_b16 v[54:55], v13 offset:1024
    s_mov_b32 s43, 0
Lpg_107:
    ds_read_b64_tr_b16 v[56:57], v14 offset:0
    ds_read_b64_tr_b16 v[58:59], v14 offset:1024
    s_waitcnt lgkmcnt(6)
    s_waitcnt lgkmcnt(4)
    v_mfma_f32_16x16x32_bf16 a[64:67], v[48:51], v[32:35], a[64:67]
    v_mfma_f32_16x16x32_bf16 a[68:71], v[48:51], v[36:39], a[68:71]
    ds_read_b64_tr_b16 v[60:61], v15 offset:0
    ds_read_b64_tr_b16 v[62:63], v15 offset:1024
    s_waitcnt lgkmcnt(4)
    v_mfma_f32_16x16x32_bf16 a[72:75], v[52:55], v[32:35], a[72:75]
    v_mfma_f32_16x16x32_bf16 a[76:79], v[52:55], v[36:39], a[76:79]
    ds_read_b64_tr_b16 v[48:49], v16 offset:0
    ds_read_b64_tr_b16 v[50:51], v16 offset:1024
    s_waitcnt lgkmcnt(4)
    v_mfma_f32_16x16x32_bf16 a[80:83], v[56:59], v[32:35], a[80:83]
    v_mfma_f32_16x16x32_bf16 a[84:87], v[56:59], v[36:39], a[84:87]
    ds_read_b64_tr_b16 v[52:53], v17 offset:0
    ds_read_b64_tr_b16 v[54:55], v17 offset:1024
    s_waitcnt lgkmcnt(4)
    v_mfma_f32_16x16x32_bf16 a[88:91], v[60:63], v[32:35], a[88:91]
    v_mfma_f32_16x16x32_bf16 a[92:95], v[60:63], v[36:39], a[92:95]
    ds_read_b64_tr_b16 v[56:57], v18 offset:0
    ds_read_b64_tr_b16 v[58:59], v18 offset:1024
    s_waitcnt lgkmcnt(4)
    v_mfma_f32_16x16x32_bf16 a[96:99], v[48:51], v[32:35], a[96:99]
    v_mfma_f32_16x16x32_bf16 a[100:103], v[48:51], v[36:39], a[100:103]
    ds_read_b64_tr_b16 v[60:61], v19 offset:0
    ds_read_b64_tr_b16 v[62:63], v19 offset:1024
    s_waitcnt lgkmcnt(4)
    v_mfma_f32_16x16x32_bf16 a[104:107], v[52:55], v[32:35], a[104:107]
    v_mfma_f32_16x16x32_bf16 a[108:111], v[52:55], v[36:39], a[108:111]
    ds_read_b64_tr_b16 v[48:49], v12 offset:8192
    ds_read_b64_tr_b16 v[50:51], v12 offset:9216
    s_waitcnt lgkmcnt(4)
    v_mfma_f32_16x16x32_bf16 a[112:115], v[56:59], v[32:35], a[112:115]
    v_mfma_f32_16x16x32_bf16 a[116:119], v[56:59], v[36:39], a[116:119]
    ds_read_b64_tr_b16 v[52:53], v13 offset:8192
    ds_read_b64_tr_b16 v[54:55], v13 offset:9216
    s_waitcnt lgkmcnt(4)
    v_mfma_f32_16x16x32_bf16 a[120:123], v[60:63], v[32:35], a[120:123]
    v_mfma_f32_16x16x32_bf16 a[124:127], v[60:63], v[36:39], a[124:127]
    s_waitcnt vmcnt(12)
    s_barrier
    ds_read_b64_tr_b16 v[56:57], v14 offset:8192
    ds_read_b64_tr_b16 v[58:59], v14 offset:9216
    s_waitcnt lgkmcnt(4)
    v_mfma_f32_16x16x32_bf16 a[0:3], v[48:51], v[32:35], a[0:3]
    v_mfma_f32_16x16x32_bf16 a[4:7], v[48:51], v[36:39], a[4:7]
    s_add_u32 m0, s50, 98304
    s_add_u32 s52, s46, 0x0
    buffer_load_dwordx4 v9, s[12:15], s52 offen lds
    ds_read_b64_tr_b16 v[60:61], v15 offset:8192
    ds_read_b64_tr_b16 v[62:63], v15 offset:9216
    s_waitcnt lgkmcnt(4)
    v_mfma_f32_16x16x32_bf16 a[8:11], v[52:55], v[32:35], a[8:11]
    v_mfma_f32_16x16x32_bf16 a[12:15], v[52:55], v[36:39], a[12:15]
    s_add_u32 m0, s50, 99328
    s_add_u32 s52, s46, 0x8000
    buffer_load_dwordx4 v9, s[12:15], s52 offen lds
    ds_read_b64_tr_b16 v[48:49], v16 offset:8192
    ds_read_b64_tr_b16 v[50:51], v16 offset:9216
    s_waitcnt lgkmcnt(4)
    v_mfma_f32_16x16x32_bf16 a[16:19], v[56:59], v[32:35], a[16:19]
    v_mfma_f32_16x16x32_bf16 a[20:23], v[56:59], v[36:39], a[20:23]
    s_add_u32 m0, s50, 106496
    s_add_u32 s52, s46, 0x0
    buffer_load_dwordx4 v9, s[16:19], s52 offen lds
    ds_read_b64_tr_b16 v[52:53], v17 offset:8192
    ds_read_b64_tr_b16 v[54:55], v17 offset:9216
    s_waitcnt lgkmcnt(4)
    v_mfma_f32_16x16x32_bf16 a[24:27], v[60:63], v[32:35], a[24:27]
    v_mfma_f32_16x16x32_bf16 a[28:31], v[60:63], v[36:39], a[28:31]
    s_add_u32 m0, s50, 107520
    s_add_u32 s52, s46, 0x8000
    buffer_load_dwordx4 v9, s[16:19], s52 offen lds
    ds_read_b64_tr_b16 v[56:57], v18 offset:8192
    ds_read_b64_tr_b16 v[58:59], v18 offset:9216
    s_waitcnt lgkmcnt(4)
    v_mfma_f32_16x16x32_bf16 a[32:35], v[48:51], v[32:35], a[32:35]
    v_mfma_f32_16x16x32_bf16 a[36:39], v[48:51], v[36:39], a[36:39]
    s_add_u32 m0, s51, 98304
    s_add_u32 s52, s47, 0
    buffer_load_dwordx4 v10, s[8:11], s52 offen lds
    ds_read_b64_tr_b16 v[60:61], v19 offset:8192
    ds_read_b64_tr_b16 v[62:63], v19 offset:9216
    s_waitcnt lgkmcnt(4)
    v_mfma_f32_16x16x32_bf16 a[40:43], v[52:55], v[32:35], a[40:43]
    v_mfma_f32_16x16x32_bf16 a[44:47], v[52:55], v[36:39], a[44:47]
    s_add_u32 m0, s51, 99328
    s_add_u32 s52, s47, 20480
    buffer_load_dwordx4 v10, s[8:11], s52 offen lds
    ds_read_b128 v[40:43], v28 offset:24576
    ds_read_b128 v[44:47], v28 offset:25600
    ds_read_b64_tr_b16 v[48:49], v12 offset:24576
    ds_read_b64_tr_b16 v[50:51], v12 offset:25600
    s_waitcnt lgkmcnt(6)
    v_mfma_f32_16x16x32_bf16 a[48:51], v[56:59], v[32:35], a[48:51]
    v_mfma_f32_16x16x32_bf16 a[52:55], v[56:59], v[36:39], a[52:55]
    s_add_u32 s46, s46, 262144
    s_add_u32 s47, s47, 64
    ds_read_b64_tr_b16 v[52:53], v13 offset:24576
    ds_read_b64_tr_b16 v[54:55], v13 offset:25600
    s_waitcnt lgkmcnt(6)
    v_mfma_f32_16x16x32_bf16 a[56:59], v[60:63], v[32:35], a[56:59]
    v_mfma_f32_16x16x32_bf16 a[60:63], v[60:63], v[36:39], a[60:63]
    ds_read_b64_tr_b16 v[56:57], v14 offset:24576
    ds_read_b64_tr_b16 v[58:59], v14 offset:25600
    s_waitcnt lgkmcnt(6)
    s_waitcnt lgkmcnt(4)
    v_mfma_f32_16x16x32_bf16 a[64:67], v[48:51], v[40:43], a[64:67]
    v_mfma_f32_16x16x32_bf16 a[68:71], v[48:51], v[44:47], a[68:71]
    ds_read_b64_tr_b16 v[60:61], v15 offset:24576
    ds_read_b64_tr_b16 v[62:63], v15 offset:25600
    s_waitcnt lgkmcnt(4)
    v_mfma_f32_16x16x32_bf16 a[72:75], v[52:55], v[40:43], a[72:75]
    v_mfma_f32_16x16x32_bf16 a[76:79], v[52:55], v[44:47], a[76:79]
    ds_read_b64_tr_b16 v[48:49], v16 offset:24576
    ds_read_b64_tr_b16 v[50:51], v16 offset:25600
    s_waitcnt lgkmcnt(4)
    v_mfma_f32_16x16x32_bf16 a[80:83], v[56:59], v[40:43], a[80:83]
    v_mfma_f32_16x16x32_bf16 a[84:87], v[56:59], v[44:47], a[84:87]
    ds_read_b64_tr_b16 v[52:53], v17 offset:24576
    ds_read_b64_tr_b16 v[54:55], v17 offset:25600
    s_waitcnt lgkmcnt(4)
    v_mfma_f32_16x16x32_bf16 a[88:91], v[60:63], v[40:43], a[88:91]
    v_mfma_f32_16x16x32_bf16 a[92:95], v[60:63], v[44:47], a[92:95]
    ds_read_b64_tr_b16 v[56:57], v18 offset:24576
    ds_read_b64_tr_b16 v[58:59], v18 offset:25600
    s_waitcnt lgkmcnt(4)
    v_mfma_f32_16x16x32_bf16 a[96:99], v[48:51], v[40:43], a[96:99]
    v_mfma_f32_16x16x32_bf16 a[100:103], v[48:51], v[44:47], a[100:103]
    ds_read_b64_tr_b16 v[60:61], v19 offset:24576
    ds_read_b64_tr_b16 v[62:63], v19 offset:25600
    s_waitcnt lgkmcnt(4)
    v_mfma_f32_16x16x32_bf16 a[104:107], v[52:55], v[40:43], a[104:107]
    v_mfma_f32_16x16x32_bf16 a[108:111], v[52:55], v[44:47], a[108:111]
    ds_read_b64_tr_b16 v[48:49], v12 offset:32768
    ds_read_b64_tr_b16 v[50:51], v12 offset:33792
    s_waitcnt lgkmcnt(4)
    v_mfma_f32_16x16x32_bf16 a[112:115], v[56:59], v[40:43], a[112:115]
    v_mfma_f32_16x16x32_bf16 a[116:119], v[56:59], v[44:47], a[116:119]
    ds_read_b64_tr_b16 v[52:53], v13 offset:32768
    ds_read_b64_tr_b16 v[54:55], v13 offset:33792
    s_waitcnt lgkmcnt(4)
    v_mfma_f32_16x16x32_bf16 a[120:123], v[60:63], v[40:43], a[120:123]
    v_mfma_f32_16x16x32_bf16 a[124:127], v[60:63], v[44:47], a[124:127]
    s_waitcnt vmcnt(12)
    s_barrier
    ds_read_b64_tr_b16 v[56:57], v14 offset:32768
    ds_read_b64_tr_b16 v[58:59], v14 offset:33792
    s_waitcnt lgkmcnt(4)
    v_mfma_f32_16x16x32_bf16 a[0:3], v[48:51], v[40:43], a[0:3]
    v_mfma_f32_16x16x32_bf16 a[4:7], v[48:51], v[44:47], a[4:7]
    s_add_u32 m0, s50, 0
    s_add_u32 s52, s46, 0x0
    buffer_load_dwordx4 v9, s[12:15], s52 offen lds
    ds_read_b64_tr_b16 v[60:61], v15 offset:32768
    ds_read_b64_tr_b16 v[62:63], v15 offset:33792
    s_waitcnt lgkmcnt(4)
    v_mfma_f32_16x16x32_bf16 a[8:11], v[52:55], v[40:43], a[8:11]
    v_mfma_f32_16x16x32_bf16 a[12:15], v[52:55], v[44:47], a[12:15]
    s_add_u32 m0, s50, 1024
    s_add_u32 s52, s46, 0x8000
    buffer_load_dwordx4 v9, s[12:15], s52 offen lds
    ds_read_b64_tr_b16 v[48:49], v16 offset:32768
    ds_read_b64_tr_b16 v[50:51], v16 offset:33792
    s_waitcnt lgkmcnt(4)
    v_mfma_f32_16x16x32_bf16 a[16:19], v[56:59], v[40:43], a[16:19]
    v_mfma_f32_16x16x32_bf16 a[20:23], v[56:59], v[44:47], a[20:23]
    s_add_u32 m0, s50, 8192
    s_add_u32 s52, s46, 0x0
    buffer_load_dwordx4 v9, s[16:19], s52 offen lds
    ds_read_b64_tr_b16 v[52:53], v17 offset:32768
    ds_read_b64_tr_b16 v[54:55], v17 offset:33792
    s_waitcnt lgkmcnt(4)
    v_mfma_f32_16x16x32_bf16 a[24:27], v[60:63], v[40:43], a[24:27]
    v_mfma_f32_16x16x32_bf16 a[28:31], v[60:63], v[44:47], a[28:31]
    s_add_u32 m0, s50, 9216
    s_add_u32 s52, s46, 0x8000
    buffer_load_dwordx4 v9, s[16:19], s52 offen lds
    ds_read_b64_tr_b16 v[56:57], v18 offset:32768
    ds_read_b64_tr_b16 v[58:59], v18 offset:33792
    s_waitcnt lgkmcnt(4)
    v_mfma_f32_16x16x32_bf16 a[32:35], v[48:51], v[40:43], a[32:35]
    v_mfma_f32_16x16x32_bf16 a[36:39], v[48:51], v[44:47], a[36:39]
    s_add_u32 m0, s51, 0
    s_add_u32 s52, s47, 0
    buffer_load_dwordx4 v10, s[8:11], s52 offen lds
    ds_read_b64_tr_b16 v[60:61], v19 offset:32768
    ds_read_b64_tr_b16 v[62:63], v19 offset:33792
    s_waitcnt lgkmcnt(4)
    v_mfma_f32_16x16x32_bf16 a[40:43], v[52:55], v[40:43], a[40:43]
    v_mfma_f32_16x16x32_bf16 a[44:47], v[52:55], v[44:47], a[44:47]
    s_add_u32 m0, s51, 1024
    s_add_u32 s52, s47, 20480
    buffer_load_dwordx4 v10, s[8:11], s52 offen lds
    ds_read_b128 v[32:35], v28 offset:49152
    ds_read_b128 v[36:39], v28 offset:50176
    ds_read_b64_tr_b16 v[48:49], v12 offset:49152
    ds_read_b64_tr_b16 v[50:51], v12 offset:50176
    s_waitcnt lgkmcnt(6)
    v_mfma_f32_16x16x32_bf16 a[48:51], v[56:59], v[40:43], a[48:51]
    v_mfma_f32_16x16x32_bf16 a[52:55], v[56:59], v[44:47], a[52:55]
    s_add_u32 s46, s46, 262144
    s_add_u32 s47, s47, 64
    ds_read_b64_tr_b16 v[52:53], v13 offset:49152
    ds_read_b64_tr_b16 v[54:55], v13 offset:50176
    s_waitcnt lgkmcnt(6)
    v_mfma_f32_16x16x32_bf16 a[56:59], v[60:63], v[40:43], a[56:59]
    v_mfma_f32_16x16x32_bf16 a[60:63], v[60:63], v[44:47], a[60:63]
    ds_read_b64_tr_b16 v[56:57], v14 offset:49152
    ds_read_b64_tr_b16 v[58:59], v14 offset:50176
    s_waitcnt lgkmcnt(6)
    s_waitcnt lgkmcnt(4)
    v_mfma_f32_16x16x32_bf16 a[64:67], v[48:51], v[32:35], a[64:67]
    v_mfma_f32_16x16x32_bf16 a[68:71], v[48:51], v[36:39], a[68:71]
    ds_read_b64_tr_b16 v[60:61], v15 offset:49152
    ds_read_b64_tr_b16 v[62:63], v15 offset:50176
    s_waitcnt lgkmcnt(4)
    v_mfma_f32_16x16x32_bf16 a[72:75], v[52:55], v[32:35], a[72:75]
    v_mfma_f32_16x16x32_bf16 a[76:79], v[52:55], v[36:39], a[76:79]
    ds_read_b64_tr_b16 v[48:49], v16 offset:49152
    ds_read_b64_tr_b16 v[50:51], v16 offset:50176
    s_waitcnt lgkmcnt(4)
    v_mfma_f32_16x16x32_bf16 a[80:83], v[56:59], v[32:35], a[80:83]
    v_mfma_f32_16x16x32_bf16 a[84:87], v[56:59], v[36:39], a[84:87]
    ds_read_b64_tr_b16 v[52:53], v17 offset:49152
    ds_read_b64_tr_b16 v[54:55], v17 offset:50176
    s_waitcnt lgkmcnt(4)
    v_mfma_f32_16x16x32_bf16 a[88:91], v[60:63], v[32:35], a[88:91]
    v_mfma_f32_16x16x32_bf16 a[92:95], v[60:63], v[36:39], a[92:95]
    ds_read_b64_tr_b16 v[56:57], v18 offset:49152
    ds_read_b64_tr_b16 v[58:59], v18 offset:50176
    s_waitcnt lgkmcnt(4)
    v_mfma_f32_16x16x32_bf16 a[96:99], v[48:51], v[32:35], a[96:99]
    v_mfma_f32_16x16x32_bf16 a[100:103], v[48:51], v[36:39], a[100:103]
    ds_read_b64_tr_b16 v[60:61], v19 offset:49152
    ds_read_b64_tr_b16 v[62:63], v19 offset:50176
    s_waitcnt lgkmcnt(4)
    v_mfma_f32_16x16x32_bf16 a[104:107], v[52:55], v[32:35], a[104:107]
    v_mfma_f32_16x16x32_bf16 a[108:111], v[52:55], v[36:39], a[108:111]
    ds_read_b64_tr_b16 v[48:49], v12 offset:57344
    ds_read_b64_tr_b16 v[50:51], v12 offset:58368
    s_waitcnt lgkmcnt(4)
    v_mfma_f32_16x16x32_bf16 a[112:115], v[56:59], v[32:35], a[112:115]
    v_mfma_f32_16x16x32_bf16 a[116:119], v[56:59], v[36:39], a[116:119]
    ds_read_b64_tr_b16 v[52:53], v13 offset:57344
    ds_read_b64_tr_b16 v[54:55], v13 offset:58368
    s_waitcnt lgkmcnt(4)
    v_mfma_f32_16x16x32_bf16 a[120:123], v[60:63], v[32:35], a[120:123]
    v_mfma_f32_16x16x32_bf16 a[124:127], v[60:63], v[36:39], a[124:127]
    s_waitcnt vmcnt(12)
    s_barrier
    ds_read_b64_tr_b16 v[56:57], v14 offset:57344
    ds_read_b64_tr_b16 v[58:59], v14 offset:58368
    s_waitcnt lgkmcnt(4)
    v_mfma_f32_16x16x32_bf16 a[0:3], v[48:51], v[32:35], a[0:3]
    v_mfma_f32_16x16x32_bf16 a[4:7], v[48:51], v[36:39], a[4:7]
    s_add_u32 m0, s50, 24576
    s_add_u32 s52, s46, 0x0
    buffer_load_dwordx4 v9, s[12:15], s52 offen lds
    ds_read_b64_tr_b16 v[60:61], v15 offset:57344
    ds_read_b64_tr_b16 v[62:63], v15 offset:58368
    s_waitcnt lgkmcnt(4)
    v_mfma_f32_16x16x32_bf16 a[8:11], v[52:55], v[32:35], a[8:11]
    v_mfma_f32_16x16x32_bf16 a[12:15], v[52:55], v[36:39], a[12:15]
    s_add_u32 m0, s50, 25600
    s_add_u32 s52, s46, 0x8000
    buffer_load_dwordx4 v9, s[12:15], s52 offen lds
    ds_read_b64_tr_b16 v[48:49], v16 offset:57344
    ds_read_b64_tr_b16 v[50:51], v16 offset:58368
    s_waitcnt lgkmcnt(4)
    v_mfma_f32_16x16x32_bf16 a[16:19], v[56:59], v[32:35], a[16:19]
    v_mfma_f32_16x16x32_bf16 a[20:23], v[56:59], v[36:39], a[20:23]
    s_add_u32 m0, s50, 32768
    s_add_u32 s52, s46, 0x0
    buffer_load_dwordx4 v9, s[16:19], s52 offen lds
    ds_read_b64_tr_b16 v[52:53], v17 offset:57344
    ds_read_b64_tr_b16 v[54:55], v17 offset:58368
    s_waitcnt lgkmcnt(4)
    v_mfma_f32_16x16x32_bf16 a[24:27], v[60:63], v[32:35], a[24:27]
    v_mfma_f32_16x16x32_bf16 a[28:31], v[60:63], v[36:39], a[28:31]
    s_add_u32 m0, s50, 33792
    s_add_u32 s52, s46, 0x8000
    buffer_load_dwordx4 v9, s[16:19], s52 offen lds
    ds_read_b64_tr_b16 v[56:57], v18 offset:57344
    ds_read_b64_tr_b16 v[58:59], v18 offset:58368
    s_waitcnt lgkmcnt(4)
    v_mfma_f32_16x16x32_bf16 a[32:35], v[48:51], v[32:35], a[32:35]
    v_mfma_f32_16x16x32_bf16 a[36:39], v[48:51], v[36:39], a[36:39]
    s_add_u32 m0, s51, 24576
    s_add_u32 s52, s47, 0
    buffer_load_dwordx4 v10, s[8:11], s52 offen lds
    ds_read_b64_tr_b16 v[60:61], v19 offset:57344
    ds_read_b64_tr_b16 v[62:63], v19 offset:58368
    s_waitcnt lgkmcnt(4)
    v_mfma_f32_16x16x32_bf16 a[40:43], v[52:55], v[32:35], a[40:43]
    v_mfma_f32_16x16x32_bf16 a[44:47], v[52:55], v[36:39], a[44:47]
    s_add_u32 m0, s51, 25600
    s_add_u32 s52, s47, 20480
    buffer_load_dwordx4 v10, s[8:11], s52 offen lds
    ds_read_b128 v[40:43], v29 offset:8192
    ds_read_b128 v[44:47], v29 offset:9216
    ds_read_b64_tr_b16 v[48:49], v20 offset:8192
    ds_read_b64_tr_b16 v[50:51], v20 offset:9216
    s_waitcnt lgkmcnt(6)
    v_mfma_f32_16x16x32_bf16 a[48:51], v[56:59], v[32:35], a[48:51]
    v_mfma_f32_16x16x32_bf16 a[52:55], v[56:59], v[36:39], a[52:55]
    s_add_u32 s46, s46, 262144
    s_add_u32 s47, s47, 64
    ds_read_b64_tr_b16 v[52:53], v21 offset:8192
    ds_read_b64_tr_b16 v[54:55], v21 offset:9216
    s_waitcnt lgkmcnt(6)
    v_mfma_f32_16x16x32_bf16 a[56:59], v[60:63], v[32:35], a[56:59]
    v_mfma_f32_16x16x32_bf16 a[60:63], v[60:63], v[36:39], a[60:63]
    ds_read_b64_tr_b16 v[56:57], v22 offset:8192
    ds_read_b64_tr_b16 v[58:59], v22 offset:9216
    s_waitcnt lgkmcnt(6)
    s_waitcnt lgkmcnt(4)
    v_mfma_f32_16x16x32_bf16 a[64:67], v[48:51], v[40:43], a[64:67]
    v_mfma_f32_16x16x32_bf16 a[68:71], v[48:51], v[44:47], a[68:71]
    ds_read_b64_tr_b16 v[60:61], v23 offset:8192
    ds_read_b64_tr_b16 v[62:63], v23 offset:9216
    s_waitcnt lgkmcnt(4)
    v_mfma_f32_16x16x32_bf16 a[72:75], v[52:55], v[40:43], a[72:75]
    v_mfma_f32_16x16x32_bf16 a[76:79], v[52:55], v[44:47], a[76:79]
    ds_read_b64_tr_b16 v[48:49], v24 offset:8192
    ds_read_b64_tr_b16 v[50:51], v24 offset:9216
    s_waitcnt lgkmcnt(4)
    v_mfma_f32_16x16x32_bf16 a[80:83], v[56:59], v[40:43], a[80:83]
    v_mfma_f32_16x16x32_bf16 a[84:87], v[56:59], v[44:47], a[84:87]
    ds_read_b64_tr_b16 v[52:53], v25 offset:8192
    ds_read_b64_tr_b16 v[54:55], v25 offset:9216
    s_waitcnt lgkmcnt(4)
    v_mfma_f32_16x16x32_bf16 a[88:91], v[60:63], v[40:43], a[88:91]
    v_mfma_f32_16x16x32_bf16 a[92:95], v[60:63], v[44:47], a[92:95]
    ds_read_b64_tr_b16 v[56:57], v26 offset:8192
    ds_read_b64_tr_b16 v[58:59], v26 offset:9216
    s_waitcnt lgkmcnt(4)
    v_mfma_f32_16x16x32_bf16 a[96:99], v[48:51], v[40:43], a[96:99]
    v_mfma_f32_16x16x32_bf16 a[100:103], v[48:51], v[44:47], a[100:103]
    ds_read_b64_tr_b16 v[60:61], v27 offset:8192
    ds_read_b64_tr_b16 v[62:63], v27 offset:9216
    s_waitcnt lgkmcnt(4)
    v_mfma_f32_16x16x32_bf16 a[104:107], v[52:55], v[40:43], a[104:107]
    v_mfma_f32_16x16x32_bf16 a[108:111], v[52:55], v[44:47], a[108:111]
    ds_read_b64_tr_b16 v[48:49], v20 offset:16384
    ds_read_b64_tr_b16 v[50:51], v20 offset:17408
    s_waitcnt lgkmcnt(4)
    v_mfma_f32_16x16x32_bf16 a[112:115], v[56:59], v[40:43], a[112:115]
    v_mfma_f32_16x16x32_bf16 a[116:119], v[56:59], v[44:47], a[116:119]
    ds_read_b64_tr_b16 v[52:53], v21 offset:16384
    ds_read_b64_tr_b16 v[54:55], v21 offset:17408
    s_waitcnt lgkmcnt(4)
    v_mfma_f32_16x16x32_bf16 a[120:123], v[60:63], v[40:43], a[120:123]
    v_mfma_f32_16x16x32_bf16 a[124:127], v[60:63], v[44:47], a[124:127]
    s_waitcnt vmcnt(12)
    s_barrier
    ds_read_b64_tr_b16 v[56:57], v22 offset:16384
    ds_read_b64_tr_b16 v[58:59], v22 offset:17408
    s_waitcnt lgkmcnt(4)
    v_mfma_f32_16x16x32_bf16 a[0:3], v[48:51], v[40:43], a[0:3]
    v_mfma_f32_16x16x32_bf16 a[4:7], v[48:51], v[44:47], a[4:7]
    s_add_u32 m0, s50, 49152
    s_add_u32 s52, s46, 0x0
    buffer_load_dwordx4 v9, s[12:15], s52 offen lds
    ds_read_b64_tr_b16 v[60:61], v23 offset:16384
    ds_read_b64_tr_b16 v[62:63], v23 offset:17408
    s_waitcnt lgkmcnt(4)
    v_mfma_f32_16x16x32_bf16 a[8:11], v[52:55], v[40:43], a[8:11]
    v_mfma_f32_16x16x32_bf16 a[12:15], v[52:55], v[44:47], a[12:15]
    s_add_u32 m0, s50, 50176
    s_add_u32 s52, s46, 0x8000
    buffer_load_dwordx4 v9, s[12:15], s52 offen lds
    ds_read_b64_tr_b16 v[48:49], v24 offset:16384
    ds_read_b64_tr_b16 v[50:51], v24 offset:17408
    s_waitcnt lgkmcnt(4)
    v_mfma_f32_16x16x32_bf16 a[16:19], v[56:59], v[40:43], a[16:19]
    v_mfma_f32_16x16x32_bf16 a[20:23], v[56:59], v[44:47], a[20:23]
    s_add_u32 m0, s50, 57344
    s_add_u32 s52, s46, 0x0
    buffer_load_dwordx4 v9, s[16:19], s52 offen lds
    ds_read_b64_tr_b16 v[52:53], v25 offset:16384
    ds_read_b64_tr_b16 v[54:55], v25 offset:17408
    s_waitcnt lgkmcnt(4)
    v_mfma_f32_16x16x32_bf16 a[24:27], v[60:63], v[40:43], a[24:27]
    v_mfma_f32_16x16x32_bf16 a[28:31], v[60:63], v[44:47], a[28:31]
    s_add_u32 m0, s50, 58368
    s_add_u32 s52, s46, 0x8000
    buffer_load_dwordx4 v9, s[16:19], s52 offen lds
    ds_read_b64_tr_b16 v[56:57], v26 offset:16384
    ds_read_b64_tr_b16 v[58:59], v26 offset:17408
    s_waitcnt lgkmcnt(4)
    v_mfma_f32_16x16x32_bf16 a[32:35], v[48:51], v[40:43], a[32:35]
    v_mfma_f32_16x16x32_bf16 a[36:39], v[48:51], v[44:47], a[36:39]
    s_add_u32 m0, s51, 49152
    s_add_u32 s52, s47, 0
    buffer_load_dwordx4 v10, s[8:11], s52 offen lds
    ds_read_b64_tr_b16 v[60:61], v27 offset:16384
    ds_read_b64_tr_b16 v[62:63], v27 offset:17408
    s_waitcnt lgkmcnt(4)
    v_mfma_f32_16x16x32_bf16 a[40:43], v[52:55], v[40:43], a[40:43]
    v_mfma_f32_16x16x32_bf16 a[44:47], v[52:55], v[44:47], a[44:47]
    s_add_u32 m0, s51, 50176
    s_add_u32 s52, s47, 20480
    buffer_load_dwordx4 v10, s[8:11], s52 offen lds
    ds_read_b128 v[32:35], v29 offset:32768
    ds_read_b128 v[36:39], v29 offset:33792
    ds_read_b64_tr_b16 v[48:49], v20 offset:32768
    ds_read_b64_tr_b16 v[50:51], v20 offset:33792
    s_waitcnt lgkmcnt(6)
    v_mfma_f32_16x16x32_bf16 a[48:51], v[56:59], v[40:43], a[48:51]
    v_mfma_f32_16x16x32_bf16 a[52:55], v[56:59], v[44:47], a[52:55]
    s_add_u32 s46, s46, 262144
    s_add_u32 s47, s47, 64
    ds_read_b64_tr_b16 v[52:53], v21 offset:32768
    ds_read_b64_tr_b16 v[54:55], v21 offset:33792
    s_waitcnt lgkmcnt(6)
    v_mfma_f32_16x16x32_bf16 a[56:59], v[60:63], v[40:43], a[56:59]
    v_mfma_f32_16x16x32_bf16 a[60:63], v[60:63], v[44:47], a[60:63]
    ds_read_b64_tr_b16 v[56:57], v22 offset:32768
    ds_read_b64_tr_b16 v[58:59], v22 offset:33792
    s_waitcnt lgkmcnt(6)
    s_waitcnt lgkmcnt(4)
    v_mfma_f32_16x16x32_bf16 a[64:67], v[48:51], v[32:35], a[64:67]
    v_mfma_f32_16x16x32_bf16 a[68:71], v[48:51], v[36:39], a[68:71]
    ds_read_b64_tr_b16 v[60:61], v23 offset:32768
    ds_read_b64_tr_b16 v[62:63], v23 offset:33792
    s_waitcnt lgkmcnt(4)
    v_mfma_f32_16x16x32_bf16 a[72:75], v[52:55], v[32:35], a[72:75]
    v_mfma_f32_16x16x32_bf16 a[76:79], v[52:55], v[36:39], a[76:79]
    ds_read_b64_tr_b16 v[48:49], v24 offset:32768
    ds_read_b64_tr_b16 v[50:51], v24 offset:33792
    s_waitcnt lgkmcnt(4)
    v_mfma_f32_16x16x32_bf16 a[80:83], v[56:59], v[32:35], a[80:83]
    v_mfma_f32_16x16x32_bf16 a[84:87], v[56:59], v[36:39], a[84:87]
    ds_read_b64_tr_b16 v[52:53], v25 offset:32768
    ds_read_b64_tr_b16 v[54:55], v25 offset:33792
    s_waitcnt lgkmcnt(4)
    v_mfma_f32_16x16x32_bf16 a[88:91], v[60:63], v[32:35], a[88:91]
    v_mfma_f32_16x16x32_bf16 a[92:95], v[60:63], v[36:39], a[92:95]
    ds_read_b64_tr_b16 v[56:57], v26 offset:32768
    ds_read_b64_tr_b16 v[58:59], v26 offset:33792
    s_waitcnt lgkmcnt(4)
    v_mfma_f32_16x16x32_bf16 a[96:99], v[48:51], v[32:35], a[96:99]
    v_mfma_f32_16x16x32_bf16 a[100:103], v[48:51], v[36:39], a[100:103]
    ds_read_b64_tr_b16 v[60:61], v27 offset:32768
    ds_read_b64_tr_b16 v[62:63], v27 offset:33792
    s_waitcnt lgkmcnt(4)
    v_mfma_f32_16x16x32_bf16 a[104:107], v[52:55], v[32:35], a[104:107]
    v_mfma_f32_16x16x32_bf16 a[108:111], v[52:55], v[36:39], a[108:111]
    ds_read_b64_tr_b16 v[48:49], v20 offset:40960
    ds_read_b64_tr_b16 v[50:51], v20 offset:41984
    s_waitcnt lgkmcnt(4)
    v_mfma_f32_16x16x32_bf16 a[112:115], v[56:59], v[32:35], a[112:115]
    v_mfma_f32_16x16x32_bf16 a[116:119], v[56:59], v[36:39], a[116:119]
    ds_read_b64_tr_b16 v[52:53], v21 offset:40960
    ds_read_b64_tr_b16 v[54:55], v21 offset:41984
    s_waitcnt lgkmcnt(4)
    v_mfma_f32_16x16x32_bf16 a[120:123], v[60:63], v[32:35], a[120:123]
    v_mfma_f32_16x16x32_bf16 a[124:127], v[60:63], v[36:39], a[124:127]
    s_waitcnt vmcnt(12)
    s_barrier
    ds_read_b64_tr_b16 v[56:57], v22 offset:40960
    ds_read_b64_tr_b16 v[58:59], v22 offset:41984
    s_waitcnt lgkmcnt(4)
    v_mfma_f32_16x16x32_bf16 a[0:3], v[48:51], v[32:35], a[0:3]
    v_mfma_f32_16x16x32_bf16 a[4:7], v[48:51], v[36:39], a[4:7]
    s_add_u32 m0, s50, 73728
    s_add_u32 s52, s46, 0x0
    buffer_load_dwordx4 v9, s[12:15], s52 offen lds
    ds_read_b64_tr_b16 v[60:61], v23 offset:40960
    ds_read_b64_tr_b16 v[62:63], v23 offset:41984
    s_waitcnt lgkmcnt(4)
    v_mfma_f32_16x16x32_bf16 a[8:11], v[52:55], v[32:35], a[8:11]
    v_mfma_f32_16x16x32_bf16 a[12:15], v[52:55], v[36:39], a[12:15]
    s_add_u32 m0, s50, 74752
    s_add_u32 s52, s46, 0x8000
    buffer_load_dwordx4 v9, s[12:15], s52 offen lds
    ds_read_b64_tr_b16 v[48:49], v24 offset:40960
    ds_read_b64_tr_b16 v[50:51], v24 offset:41984
    s_waitcnt lgkmcnt(4)
    v_mfma_f32_16x16x32_bf16 a[16:19], v[56:59], v[32:35], a[16:19]
    v_mfma_f32_16x16x32_bf16 a[20:23], v[56:59], v[36:39], a[20:23]
    s_add_u32 m0, s50, 81920
    s_add_u32 s52, s46, 0x0
    buffer_load_dwordx4 v9, s[16:19], s52 offen lds
    ds_read_b64_tr_b16 v[52:53], v25 offset:40960
    ds_read_b64_tr_b16 v[54:55], v25 offset:41984
    s_waitcnt lgkmcnt(4)
    v_mfma_f32_16x16x32_bf16 a[24:27], v[60:63], v[32:35], a[24:27]
    v_mfma_f32_16x16x32_bf16 a[28:31], v[60:63], v[36:39], a[28:31]
    s_add_u32 m0, s50, 82944
    s_add_u32 s52, s46, 0x8000
    buffer_load_dwordx4 v9, s[16:19], s52 offen lds
    ds_read_b64_tr_b16 v[56:57], v26 offset:40960
    ds_read_b64_tr_b16 v[58:59], v26 offset:41984
    s_waitcnt lgkmcnt(4)
    v_mfma_f32_16x16x32_bf16 a[32:35], v[48:51], v[32:35], a[32:35]
    v_mfma_f32_16x16x32_bf16 a[36:39], v[48:51], v[36:39], a[36:39]
    s_add_u32 m0, s51, 73728
    s_add_u32 s52, s47, 0
    buffer_load_dwordx4 v10, s[8:11], s52 offen lds
    ds_read_b64_tr_b16 v[60:61], v27 offset:40960
    ds_read_b64_tr_b16 v[62:63], v27 offset:41984
    s_waitcnt lgkmcnt(4)
    v_mfma_f32_16x16x32_bf16 a[40:43], v[52:55], v[32:35], a[40:43]
    v_mfma_f32_16x16x32_bf16 a[44:47], v[52:55], v[36:39], a[44:47]
    s_add_u32 m0, s51, 74752
    s_add_u32 s52, s47, 20480
    buffer_load_dwordx4 v10, s[8:11], s52 offen lds
    ds_read_b128 v[40:43], v28 offset:0
    ds_read_b128 v[44:47], v28 offset:1024
    ds_read_b64_tr_b16 v[48:49], v12 offset:0
    ds_read_b64_tr_b16 v[50:51], v12 offset:1024
    s_waitcnt lgkmcnt(6)
    v_mfma_f32_16x16x32_bf16 a[48:51], v[56:59], v[32:35], a[48:51]
    v_mfma_f32_16x16x32_bf16 a[52:55], v[56:59], v[36:39], a[52:55]
    s_add_u32 s46, s46, 262144
    s_add_u32 s47, s47, 64
    ds_read_b64_tr_b16 v[52:53], v13 offset:0
    ds_read_b64_tr_b16 v[54:55], v13 offset:1024
    s_waitcnt lgkmcnt(6)
    v_mfma_f32_16x16x32_bf16 a[56:59], v[60:63], v[32:35], a[56:59]
    v_mfma_f32_16x16x32_bf16 a[60:63], v[60:63], v[36:39], a[60:63]
    ds_read_b64_tr_b16 v[56:57], v14 offset:0
    ds_read_b64_tr_b16 v[58:59], v14 offset:1024
    s_waitcnt lgkmcnt(6)
    s_waitcnt lgkmcnt(4)
    v_mfma_f32_16x16x32_bf16 a[64:67], v[48:51], v[40:43], a[64:67]
    v_mfma_f32_16x16x32_bf16 a[68:71], v[48:51], v[44:47], a[68:71]
    ds_read_b64_tr_b16 v[60:61], v15 offset:0
    ds_read_b64_tr_b16 v[62:63], v15 offset:1024
    s_waitcnt lgkmcnt(4)
    v_mfma_f32_16x16x32_bf16 a[72:75], v[52:55], v[40:43], a[72:75]
    v_mfma_f32_16x16x32_bf16 a[76:79], v[52:55], v[44:47], a[76:79]
    ds_read_b64_tr_b16 v[48:49], v16 offset:0
    ds_read_b64_tr_b16 v[50:51], v16 offset:1024
    s_waitcnt lgkmcnt(4)
    v_mfma_f32_16x16x32_bf16 a[80:83], v[56:59], v[40:43], a[80:83]
    v_mfma_f32_16x16x32_bf16 a[84:87], v[56:59], v[44:47], a[84:87]
    ds_read_b64_tr_b16 v[52:53], v17 offset:0
    ds_read_b64_tr_b16 v[54:55], v17 offset:1024
    s_waitcnt lgkmcnt(4)
    v_mfma_f32_16x16x32_bf16 a[88:91], v[60:63], v[40:43], a[88:91]
    v_mfma_f32_16x16x32_bf16 a[92:95], v[60:63], v[44:47], a[92:95]
    ds_read_b64_tr_b16 v[56:57], v18 offset:0
    ds_read_b64_tr_b16 v[58:59], v18 offset:1024
    s_waitcnt lgkmcnt(4)
    v_mfma_f32_16x16x32_bf16 a[96:99], v[48:51], v[40:43], a[96:99]
    v_mfma_f32_16x16x32_bf16 a[100:103], v[48:51], v[44:47], a[100:103]
    ds_read_b64_tr_b16 v[60:61], v19 offset:0
    ds_read_b64_tr_b16 v[62:63], v19 offset:1024
    s_waitcnt lgkmcnt(4)
    v_mfma_f32_16x16x32_bf16 a[104:107], v[52:55], v[40:43], a[104:107]
    v_mfma_f32_16x16x32_bf16 a[108:111], v[52:55], v[44:47], a[108:111]
    ds_read_b64_tr_b16 v[48:49], v12 offset:8192
    ds_read_b64_tr_b16 v[50:51], v12 offset:9216
    s_waitcnt lgkmcnt(4)
    v_mfma_f32_16x16x32_bf16 a[112:115], v[56:59], v[40:43], a[112:115]
    v_mfma_f32_16x16x32_bf16 a[116:119], v[56:59], v[44:47], a[116:119]
    ds_read_b64_tr_b16 v[52:53], v13 offset:8192
    ds_read_b64_tr_b16 v[54:55], v13 offset:9216
    s_waitcnt lgkmcnt(4)
    v_mfma_f32_16x16x32_bf16 a[120:123], v[60:63], v[40:43], a[120:123]
    v_mfma_f32_16x16x32_bf16 a[124:127], v[60:63], v[44:47], a[124:127]
    s_waitcnt vmcnt(12)
    s_barrier
    ds_read_b64_tr_b16 v[56:57], v14 offset:8192
    ds_read_b64_tr_b16 v[58:59], v14 offset:9216
    s_waitcnt lgkmcnt(4)
    v_mfma_f32_16x16x32_bf16 a[0:3], v[48:51], v[40:43], a[0:3]
    v_mfma_f32_16x16x32_bf16 a[4:7], v[48:51], v[44:47], a[4:7]
    s_add_u32 m0, s50, 98304
    s_add_u32 s52, s46, 0x0
    buffer_load_dwordx4 v9, s[12:15], s52 offen lds
    ds_read_b64_tr_b16 v[60:61], v15 offset:8192
    ds_read_b64_tr_b16 v[62:63], v15 offset:9216
    s_waitcnt lgkmcnt(4)
    v_mfma_f32_16x16x32_bf16 a[8:11], v[52:55], v[40:43], a[8:11]
    v_mfma_f32_16x16x32_bf16 a[12:15], v[52:55], v[44:47], a[12:15]
    s_add_u32 m0, s50, 99328
    s_add_u32 s52, s46, 0x8000
    buffer_load_dwordx4 v9, s[12:15], s52 offen lds
    ds_read_b64_tr_b16 v[48:49], v16 offset:8192
    ds_read_b64_tr_b16 v[50:51], v16 offset:9216
    s_waitcnt lgkmcnt(4)
    v_mfma_f32_16x16x32_bf16 a[16:19], v[56:59], v[40:43], a[16:19]
    v_mfma_f32_16x16x32_bf16 a[20:23], v[56:59], v[44:47], a[20:23]
    s_add_u32 m0, s50, 106496
    s_add_u32 s52, s46, 0x0
    buffer_load_dwordx4 v9, s[16:19], s52 offen lds
    ds_read_b64_tr_b16 v[52:53], v17 offset:8192
    ds_read_b64_tr_b16 v[54:55], v17 offset:9216
    s_waitcnt lgkmcnt(4)
    v_mfma_f32_16x16x32_bf16 a[24:27], v[60:63], v[40:43], a[24:27]
    v_mfma_f32_16x16x32_bf16 a[28:31], v[60:63], v[44:47], a[28:31]
    s_add_u32 m0, s50, 107520
    s_add_u32 s52, s46, 0x8000
    buffer_load_dwordx4 v9, s[16:19], s52 offen lds
    ds_read_b64_tr_b16 v[56:57], v18 offset:8192
    ds_read_b64_tr_b16 v[58:59], v18 offset:9216
    s_waitcnt lgkmcnt(4)
    v_mfma_f32_16x16x32_bf16 a[32:35], v[48:51], v[40:43], a[32:35]
    v_mfma_f32_16x16x32_bf16 a[36:39], v[48:51], v[44:47], a[36:39]
    s_add_u32 m0, s51, 98304
    s_add_u32 s52, s47, 0
    buffer_load_dwordx4 v10, s[8:11], s52 offen lds
    ds_read_b64_tr_b16 v[60:61], v19 offset:8192
    ds_read_b64_tr_b16 v[62:63], v19 offset:9216
    s_waitcnt lgkmcnt(4)
    v_mfma_f32_16x16x32_bf16 a[40:43], v[52:55], v[40:43], a[40:43]
    v_mfma_f32_16x16x32_bf16 a[44:47], v[52:55], v[44:47], a[44:47]
    s_add_u32 m0, s51, 99328
    s_add_u32 s52, s47, 20480
    buffer_load_dwordx4 v10, s[8:11], s52 offen lds
    ds_read_b128 v[32:35], v28 offset:24576
    ds_read_b128 v[36:39], v28 offset:25600
    ds_read_b64_tr_b16 v[48:49], v12 offset:24576
    ds_read_b64_tr_b16 v[50:51], v12 offset:25600
    s_waitcnt lgkmcnt(6)
    v_mfma_f32_16x16x32_bf16 a[48:51], v[56:59], v[40:43], a[48:51]
    v_mfma_f32_16x16x32_bf16 a[52:55], v[56:59], v[44:47], a[52:55]
    s_add_u32 s46, s46, 262144
    s_add_u32 s47, s47, 64
    ds_read_b64_tr_b16 v[52:53], v13 offset:24576
    ds_read_b64_tr_b16 v[54:55], v13 offset:25600
    s_waitcnt lgkmcnt(6)
    v_mfma_f32_16x16x32_bf16 a[56:59], v[60:63], v[40:43], a[56:59]
    v_mfma_f32_16x16x32_bf16 a[60:63], v[60:63], v[44:47], a[60:63]
    ds_read_b64_tr_b16 v[56:57], v14 offset:24576
    ds_read_b64_tr_b16 v[58:59], v14 offset:25600
    s_waitcnt lgkmcnt(6)
    s_waitcnt lgkmcnt(4)
    v_mfma_f32_16x16x32_bf16 a[64:67], v[48:51], v[32:35], a[64:67]
    v_mfma_f32_16x16x32_bf16 a[68:71], v[48:51], v[36:39], a[68:71]
    ds_read_b64_tr_b16 v[60:61], v15 offset:24576
    ds_read_b64_tr_b16 v[62:63], v15 offset:25600
    s_waitcnt lgkmcnt(4)
    v_mfma_f32_16x16x32_bf16 a[72:75], v[52:55], v[32:35], a[72:75]
    v_mfma_f32_16x16x32_bf16 a[76:79], v[52:55], v[36:39], a[76:79]
    ds_read_b64_tr_b16 v[48:49], v16 offset:24576
    ds_read_b64_tr_b16 v[50:51], v16 offset:25600
    s_waitcnt lgkmcnt(4)
    v_mfma_f32_16x16x32_bf16 a[80:83], v[56:59], v[32:35], a[80:83]
    v_mfma_f32_16x16x32_bf16 a[84:87], v[56:59], v[36:39], a[84:87]
    ds_read_b64_tr_b16 v[52:53], v17 offset:24576
    ds_read_b64_tr_b16 v[54:55], v17 offset:25600
    s_waitcnt lgkmcnt(4)
    v_mfma_f32_16x16x32_bf16 a[88:91], v[60:63], v[32:35], a[88:91]
    v_mfma_f32_16x16x32_bf16 a[92:95], v[60:63], v[36:39], a[92:95]
    ds_read_b64_tr_b16 v[56:57], v18 offset:24576
    ds_read_b64_tr_b16 v[58:59], v18 offset:25600
    s_waitcnt lgkmcnt(4)
    v_mfma_f32_16x16x32_bf16 a[96:99], v[48:51], v[32:35], a[96:99]
    v_mfma_f32_16x16x32_bf16 a[100:103], v[48:51], v[36:39], a[100:103]
    ds_read_b64_tr_b16 v[60:61], v19 offset:24576
    ds_read_b64_tr_b16 v[62:63], v19 offset:25600
    s_waitcnt lgkmcnt(4)
    v_mfma_f32_16x16x32_bf16 a[104:107], v[52:55], v[32:35], a[104:107]
    v_mfma_f32_16x16x32_bf16 a[108:111], v[52:55], v[36:39], a[108:111]
    ds_read_b64_tr_b16 v[48:49], v12 offset:32768
    ds_read_b64_tr_b16 v[50:51], v12 offset:33792
    s_waitcnt lgkmcnt(4)
    v_mfma_f32_16x16x32_bf16 a[112:115], v[56:59], v[32:35], a[112:115]
    v_mfma_f32_16x16x32_bf16 a[116:119], v[56:59], v[36:39], a[116:119]
    ds_read_b64_tr_b16 v[52:53], v13 offset:32768
    ds_read_b64_tr_b16 v[54:55], v13 offset:33792
    s_waitcnt lgkmcnt(4)
    v_mfma_f32_16x16x32_bf16 a[120:123], v[60:63], v[32:35], a[120:123]
    v_mfma_f32_16x16x32_bf16 a[124:127], v[60:63], v[36:39], a[124:127]
    s_waitcnt vmcnt(12)
    s_barrier
    ds_read_b64_tr_b16 v[56:57], v14 offset:32768
    ds_read_b64_tr_b16 v[58:59], v14 offset:33792
    s_waitcnt lgkmcnt(4)
    v_mfma_f32_16x16x32_bf16 a[0:3], v[48:51], v[32:35], a[0:3]
    v_mfma_f32_16x16x32_bf16 a[4:7], v[48:51], v[36:39], a[4:7]
    s_add_u32 m0, s50, 0
    s_add_u32 s52, s46, 0x0
    buffer_load_dwordx4 v9, s[12:15], s52 offen lds
    ds_read_b64_tr_b16 v[60:61], v15 offset:32768
    ds_read_b64_tr_b16 v[62:63], v15 offset:33792
    s_waitcnt lgkmcnt(4)
    v_mfma_f32_16x16x32_bf16 a[8:11], v[52:55], v[32:35], a[8:11]
    v_mfma_f32_16x16x32_bf16 a[12:15], v[52:55], v[36:39], a[12:15]
    s_add_u32 m0, s50, 1024
    s_add_u32 s52, s46, 0x8000
    buffer_load_dwordx4 v9, s[12:15], s52 offen lds
    ds_read_b64_tr_b16 v[48:49], v16 offset:32768
    ds_read_b64_tr_b16 v[50:51], v16 offset:33792
    s_waitcnt lgkmcnt(4)
    v_mfma_f32_16x16x32_bf16 a[16:19], v[56:59], v[32:35], a[16:19]
    v_mfma_f32_16x16x32_bf16 a[20:23], v[56:59], v[36:39], a[20:23]
    s_add_u32 m0, s50, 8192
    s_add_u32 s52, s46, 0x0
    buffer_load_dwordx4 v9, s[16:19], s52 offen lds
    ds_read_b64_tr_b16 v[52:53], v17 offset:32768
    ds_read_b64_tr_b16 v[54:55], v17 offset:33792
    s_waitcnt lgkmcnt(4)
    v_mfma_f32_16x16x32_bf16 a[24:27], v[60:63], v[32:35], a[24:27]
    v_mfma_f32_16x16x32_bf16 a[28:31], v[60:63], v[36:39], a[28:31]
    s_add_u32 m0, s50, 9216
    s_add_u32 s52, s46, 0x8000
    buffer_load_dwordx4 v9, s[16:19], s52 offen lds
    ds_read_b64_tr_b16 v[56:57], v18 offset:32768
    ds_read_b64_tr_b16 v[58:59], v18 offset:33792
    s_waitcnt lgkmcnt(4)
    v_mfma_f32_16x16x32_bf16 a[32:35], v[48:51], v[32:35], a[32:35]
    v_mfma_f32_16x16x32_bf16 a[36:39], v[48:51], v[36:39], a[36:39]
    s_add_u32 m0, s51, 0
    s_add_u32 s52, s47, 0
    buffer_load_dwordx4 v10, s[8:11], s52 offen lds
    ds_read_b64_tr_b16 v[60:61], v19 offset:32768
    ds_read_b64_tr_b16 v[62:63], v19 offset:33792
    s_waitcnt lgkmcnt(4)
    v_mfma_f32_16x16x32_bf16 a[40:43], v[52:55], v[32:35], a[40:43]
    v_mfma_f32_16x16x32_bf16 a[44:47], v[52:55], v[36:39], a[44:47]
    s_add_u32 m0, s51, 1024
    s_add_u32 s52, s47, 20480
    buffer_load_dwordx4 v10, s[8:11], s52 offen lds
    ds_read_b128 v[40:43], v28 offset:49152
    ds_read_b128 v[44:47], v28 offset:50176
    ds_read_b64_tr_b16 v[48:49], v12 offset:49152
    ds_read_b64_tr_b16 v[50:51], v12 offset:50176
    s_waitcnt lgkmcnt(6)
    v_mfma_f32_16x16x32_bf16 a[48:51], v[56:59], v[32:35], a[48:51]
    v_mfma_f32_16x16x32_bf16 a[52:55], v[56:59], v[36:39], a[52:55]
    s_add_u32 s46, s46, 262144
    s_add_u32 s47, s47, 64
    ds_read_b64_tr_b16 v[52:53], v13 offset:49152
    ds_read_b64_tr_b16 v[54:55], v13 offset:50176
    s_waitcnt lgkmcnt(6)
    v_mfma_f32_16x16x32_bf16 a[56:59], v[60:63], v[32:35], a[56:59]
    v_mfma_f32_16x16x32_bf16 a[60:63], v[60:63], v[36:39], a[60:63]
    ds_read_b64_tr_b16 v[56:57], v14 offset:49152
    ds_read_b64_tr_b16 v[58:59], v14 offset:50176
    s_waitcnt lgkmcnt(6)
    s_waitcnt lgkmcnt(4)
    v_mfma_f32_16x16x32_bf16 a[64:67], v[48:51], v[40:43], a[64:67]
    v_mfma_f32_16x16x32_bf16 a[68:71], v[48:51], v[44:47], a[68:71]
    ds_read_b64_tr_b16 v[60:61], v15 offset:49152
    ds_read_b64_tr_b16 v[62:63], v15 offset:50176
    s_waitcnt lgkmcnt(4)
    v_mfma_f32_16x16x32_bf16 a[72:75], v[52:55], v[40:43], a[72:75]
    v_mfma_f32_16x16x32_bf16 a[76:79], v[52:55], v[44:47], a[76:79]
    ds_read_b64_tr_b16 v[48:49], v16 offset:49152
    ds_read_b64_tr_b16 v[50:51], v16 offset:50176
    s_waitcnt lgkmcnt(4)
    v_mfma_f32_16x16x32_bf16 a[80:83], v[56:59], v[40:43], a[80:83]
    v_mfma_f32_16x16x32_bf16 a[84:87], v[56:59], v[44:47], a[84:87]
    ds_read_b64_tr_b16 v[52:53], v17 offset:49152
    ds_read_b64_tr_b16 v[54:55], v17 offset:50176
    s_waitcnt lgkmcnt(4)
    v_mfma_f32_16x16x32_bf16 a[88:91], v[60:63], v[40:43], a[88:91]
    v_mfma_f32_16x16x32_bf16 a[92:95], v[60:63], v[44:47], a[92:95]
    ds_read_b64_tr_b16 v[56:57], v18 offset:49152
    ds_read_b64_tr_b16 v[58:59], v18 offset:50176
    s_waitcnt lgkmcnt(4)
    v_mfma_f32_16x16x32_bf16 a[96:99], v[48:51], v[40:43], a[96:99]
    v_mfma_f32_16x16x32_bf16 a[100:103], v[48:51], v[44:47], a[100:103]
    ds_read_b64_tr_b16 v[60:61], v19 offset:49152
    ds_read_b64_tr_b16 v[62:63], v19 offset:50176
    s_waitcnt lgkmcnt(4)
    v_mfma_f32_16x16x32_bf16 a[104:107], v[52:55], v[40:43], a[104:107]
    v_mfma_f32_16x16x32_bf16 a[108:111], v[52:55], v[44:47], a[108:111]
    ds_read_b64_tr_b16 v[48:49], v12 offset:57344
    ds_read_b64_tr_b16 v[50:51], v12 offset:58368
    s_waitcnt lgkmcnt(4)
    v_mfma_f32_16x16x32_bf16 a[112:115], v[56:59], v[40:43], a[112:115]
    v_mfma_f32_16x16x32_bf16 a[116:119], v[56:59], v[44:47], a[116:119]
    ds_read_b64_tr_b16 v[52:53], v13 offset:57344
    ds_read_b64_tr_b16 v[54:55], v13 offset:58368
    s_waitcnt lgkmcnt(4)
    v_mfma_f32_16x16x32_bf16 a[120:123], v[60:63], v[40:43], a[120:123]
    v_mfma_f32_16x16x32_bf16 a[124:127], v[60:63], v[44:47], a[124:127]
    s_waitcnt vmcnt(12)
    s_barrier
    ds_read_b64_tr_b16 v[56:57], v14 offset:57344
    ds_read_b64_tr_b16 v[58:59], v14 offset:58368
    s_waitcnt lgkmcnt(4)
    v_mfma_f32_16x16x32_bf16 a[0:3], v[48:51], v[40:43], a[0:3]
    v_mfma_f32_16x16x32_bf16 a[4:7], v[48:51], v[44:47], a[4:7]
    s_add_u32 m0, s50, 24576
    s_add_u32 s52, s46, 0x0
    buffer_load_dwordx4 v9, s[12:15], s52 offen lds
    ds_read_b64_tr_b16 v[60:61], v15 offset:57344
    ds_read_b64_tr_b16 v[62:63], v15 offset:58368
    s_waitcnt lgkmcnt(4)
    v_mfma_f32_16x16x32_bf16 a[8:11], v[52:55], v[40:43], a[8:11]
    v_mfma_f32_16x16x32_bf16 a[12:15], v[52:55], v[44:47], a[12:15]
    s_add_u32 m0, s50, 25600
    s_add_u32 s52, s46, 0x8000
    buffer_load_dwordx4 v9, s[12:15], s52 offen lds
    ds_read_b64_tr_b16 v[48:49], v16 offset:57344
    ds_read_b64_tr_b16 v[50:51], v16 offset:58368
    s_waitcnt lgkmcnt(4)
    v_mfma_f32_16x16x32_bf16 a[16:19], v[56:59], v[40:43], a[16:19]
    v_mfma_f32_16x16x32_bf16 a[20:23], v[56:59], v[44:47], a[20:23]
    s_add_u32 m0, s50, 32768
    s_add_u32 s52, s46, 0x0
    buffer_load_dwordx4 v9, s[16:19], s52 offen lds
    ds_read_b64_tr_b16 v[52:53], v17 offset:57344
    ds_read_b64_tr_b16 v[54:55], v17 offset:58368
    s_waitcnt lgkmcnt(4)
    v_mfma_f32_16x16x32_bf16 a[24:27], v[60:63], v[40:43], a[24:27]
    v_mfma_f32_16x16x32_bf16 a[28:31], v[60:63], v[44:47], a[28:31]
    s_add_u32 m0, s50, 33792
    s_add_u32 s52, s46, 0x8000
    buffer_load_dwordx4 v9, s[16:19], s52 offen lds
    ds_read_b64_tr_b16 v[56:57], v18 offset:57344
    ds_read_b64_tr_b16 v[58:59], v18 offset:58368
    s_waitcnt lgkmcnt(4)
    v_mfma_f32_16x16x32_bf16 a[32:35], v[48:51], v[40:43], a[32:35]
    v_mfma_f32_16x16x32_bf16 a[36:39], v[48:51], v[44:47], a[36:39]
    s_add_u32 m0, s51, 24576
    s_add_u32 s52, s47, 0
    buffer_load_dwordx4 v10, s[8:11], s52 offen lds
    ds_read_b64_tr_b16 v[60:61], v19 offset:57344
    ds_read_b64_tr_b16 v[62:63], v19 offset:58368
    s_waitcnt lgkmcnt(4)
    v_mfma_f32_16x16x32_bf16 a[40:43], v[52:55], v[40:43], a[40:43]
    v_mfma_f32_16x16x32_bf16 a[44:47], v[52:55], v[44:47], a[44:47]
    s_add_u32 m0, s51, 25600
    s_add_u32 s52, s47, 20480
    buffer_load_dwordx4 v10, s[8:11], s52 offen lds
    ds_read_b128 v[32:35], v29 offset:8192
    ds_read_b128 v[36:39], v29 offset:9216
    ds_read_b64_tr_b16 v[48:49], v20 offset:8192
    ds_read_b64_tr_b16 v[50:51], v20 offset:9216
    s_waitcnt lgkmcnt(6)
    v_mfma_f32_16x16x32_bf16 a[48:51], v[56:59], v[40:43], a[48:51]
    v_mfma_f32_16x16x32_bf16 a[52:55], v[56:59], v[44:47], a[52:55]
    s_add_u32 s46, s46, 262144
    s_add_u32 s47, s47, 64
    ds_read_b64_tr_b16 v[52:53], v21 offset:8192
    ds_read_b64_tr_b16 v[54:55], v21 offset:9216
    s_waitcnt lgkmcnt(6)
    v_mfma_f32_16x16x32_bf16 a[56:59], v[60:63], v[40:43], a[56:59]
    v_mfma_f32_16x16x32_bf16 a[60:63], v[60:63], v[44:47], a[60:63]
    ds_read_b64_tr_b16 v[56:57], v22 offset:8192
    ds_read_b64_tr_b16 v[58:59], v22 offset:9216
    s_waitcnt lgkmcnt(6)
    s_waitcnt lgkmcnt(4)
    v_mfma_f32_16x16x32_bf16 a[64:67], v[48:51], v[32:35], a[64:67]
    v_mfma_f32_16x16x32_bf16 a[68:71], v[48:51], v[36:39], a[68:71]
    ds_read_b64_tr_b16 v[60:61], v23 offset:8192
    ds_read_b64_tr_b16 v[62:63], v23 offset:9216
    s_waitcnt lgkmcnt(4)
    v_mfma_f32_16x16x32_bf16 a[72:75], v[52:55], v[32:35], a[72:75]
    v_mfma_f32_16x16x32_bf16 a[76:79], v[52:55], v[36:39], a[76:79]
    ds_read_b64_tr_b16 v[48:49], v24 offset:8192
    ds_read_b64_tr_b16 v[50:51], v24 offset:9216
    s_waitcnt lgkmcnt(4)
    v_mfma_f32_16x16x32_bf16 a[80:83], v[56:59], v[32:35], a[80:83]
    v_mfma_f32_16x16x32_bf16 a[84:87], v[56:59], v[36:39], a[84:87]
    ds_read_b64_tr_b16 v[52:53], v25 offset:8192
    ds_read_b64_tr_b16 v[54:55], v25 offset:9216
    s_waitcnt lgkmcnt(4)
    v_mfma_f32_16x16x32_bf16 a[88:91], v[60:63], v[32:35], a[88:91]
    v_mfma_f32_16x16x32_bf16 a[92:95], v[60:63], v[36:39], a[92:95]
    ds_read_b64_tr_b16 v[56:57], v26 offset:8192
    ds_read_b64_tr_b16 v[58:59], v26 offset:9216
    s_waitcnt lgkmcnt(4)
    v_mfma_f32_16x16x32_bf16 a[96:99], v[48:51], v[32:35], a[96:99]
    v_mfma_f32_16x16x32_bf16 a[100:103], v[48:51], v[36:39], a[100:103]
    ds_read_b64_tr_b16 v[60:61], v27 offset:8192
    ds_read_b64_tr_b16 v[62:63], v27 offset:9216
    s_waitcnt lgkmcnt(4)
    v_mfma_f32_16x16x32_bf16 a[104:107], v[52:55], v[32:35], a[104:107]
    v_mfma_f32_16x16x32_bf16 a[108:111], v[52:55], v[36:39], a[108:111]
    ds_read_b64_tr_b16 v[48:49], v20 offset:16384
    ds_read_b64_tr_b16 v[50:51], v20 offset:17408
    s_waitcnt lgkmcnt(4)
    v_mfma_f32_16x16x32_bf16 a[112:115], v[56:59], v[32:35], a[112:115]
    v_mfma_f32_16x16x32_bf16 a[116:119], v[56:59], v[36:39], a[116:119]
    ds_read_b64_tr_b16 v[52:53], v21 offset:16384
    ds_read_b64_tr_b16 v[54:55], v21 offset:17408
    s_waitcnt lgkmcnt(4)
    v_mfma_f32_16x16x32_bf16 a[120:123], v[60:63], v[32:35], a[120:123]
    v_mfma_f32_16x16x32_bf16 a[124:127], v[60:63], v[36:39], a[124:127]
    s_waitcnt vmcnt(12)
    s_barrier
    ds_read_b64_tr_b16 v[56:57], v22 offset:16384
    ds_read_b64_tr_b16 v[58:59], v22 offset:17408
    s_waitcnt lgkmcnt(4)
    v_mfma_f32_16x16x32_bf16 a[0:3], v[48:51], v[32:35], a[0:3]
    v_mfma_f32_16x16x32_bf16 a[4:7], v[48:51], v[36:39], a[4:7]
    s_add_u32 m0, s50, 49152
    s_add_u32 s52, s46, 0x0
    buffer_load_dwordx4 v9, s[12:15], s52 offen lds
    ds_read_b64_tr_b16 v[60:61], v23 offset:16384
    ds_read_b64_tr_b16 v[62:63], v23 offset:17408
    s_waitcnt lgkmcnt(4)
    v_mfma_f32_16x16x32_bf16 a[8:11], v[52:55], v[32:35], a[8:11]
    v_mfma_f32_16x16x32_bf16 a[12:15], v[52:55], v[36:39], a[12:15]
    s_add_u32 m0, s50, 50176
    s_add_u32 s52, s46, 0x8000
    buffer_load_dwordx4 v9, s[12:15], s52 offen lds
    ds_read_b64_tr_b16 v[48:49], v24 offset:16384
    ds_read_b64_tr_b16 v[50:51], v24 offset:17408
    s_waitcnt lgkmcnt(4)
    v_mfma_f32_16x16x32_bf16 a[16:19], v[56:59], v[32:35], a[16:19]
    v_mfma_f32_16x16x32_bf16 a[20:23], v[56:59], v[36:39], a[20:23]
    s_add_u32 m0, s50, 57344
    s_add_u32 s52, s46, 0x0
    buffer_load_dwordx4 v9, s[16:19], s52 offen lds
    ds_read_b64_tr_b16 v[52:53], v25 offset:16384
    ds_read_b64_tr_b16 v[54:55], v25 offset:17408
    s_waitcnt lgkmcnt(4)
    v_mfma_f32_16x16x32_bf16 a[24:27], v[60:63], v[32:35], a[24:27]
    v_mfma_f32_16x16x32_bf16 a[28:31], v[60:63], v[36:39], a[28:31]
    s_add_u32 m0, s50, 58368
    s_add_u32 s52, s46, 0x8000
    buffer_load_dwordx4 v9, s[16:19], s52 offen lds
    ds_read_b64_tr_b16 v[56:57], v26 offset:16384
    ds_read_b64_tr_b16 v[58:59], v26 offset:17408
    s_waitcnt lgkmcnt(4)
    v_mfma_f32_16x16x32_bf16 a[32:35], v[48:51], v[32:35], a[32:35]
    v_mfma_f32_16x16x32_bf16 a[36:39], v[48:51], v[36:39], a[36:39]
    s_add_u32 m0, s51, 49152
    s_add_u32 s52, s47, 0
    buffer_load_dwordx4 v10, s[8:11], s52 offen lds
    ds_read_b64_tr_b16 v[60:61], v27 offset:16384
    ds_read_b64_tr_b16 v[62:63], v27 offset:17408
    s_waitcnt lgkmcnt(4)
    v_mfma_f32_16x16x32_bf16 a[40:43], v[52:55], v[32:35], a[40:43]
    v_mfma_f32_16x16x32_bf16 a[44:47], v[52:55], v[36:39], a[44:47]
    s_add_u32 m0, s51, 50176
    s_add_u32 s52, s47, 20480
    buffer_load_dwordx4 v10, s[8:11], s52 offen lds
    ds_read_b128 v[40:43], v29 offset:32768
    ds_read_b128 v[44:47], v29 offset:33792
    ds_read_b64_tr_b16 v[48:49], v20 offset:32768
    ds_read_b64_tr_b16 v[50:51], v20 offset:33792
    s_waitcnt lgkmcnt(6)
    v_mfma_f32_16x16x32_bf16 a[48:51], v[56:59], v[32:35], a[48:51]
    v_mfma_f32_16x16x32_bf16 a[52:55], v[56:59], v[36:39], a[52:55]
    s_add_u32 s46, s46, 262144
    s_add_u32 s47, s47, 64
    ds_read_b64_tr_b16 v[52:53], v21 offset:32768
    ds_read_b64_tr_b16 v[54:55], v21 offset:33792
    s_waitcnt lgkmcnt(6)
    v_mfma_f32_16x16x32_bf16 a[56:59], v[60:63], v[32:35], a[56:59]
    v_mfma_f32_16x16x32_bf16 a[60:63], v[60:63], v[36:39], a[60:63]
    ds_read_b64_tr_b16 v[56:57], v22 offset:32768
    ds_read_b64_tr_b16 v[58:59], v22 offset:33792
    s_waitcnt lgkmcnt(6)
    s_waitcnt lgkmcnt(4)
    v_mfma_f32_16x16x32_bf16 a[64:67], v[48:51], v[40:43], a[64:67]
    v_mfma_f32_16x16x32_bf16 a[68:71], v[48:51], v[44:47], a[68:71]
    ds_read_b64_tr_b16 v[60:61], v23 offset:32768
    ds_read_b64_tr_b16 v[62:63], v23 offset:33792
    s_waitcnt lgkmcnt(4)
    v_mfma_f32_16x16x32_bf16 a[72:75], v[52:55], v[40:43], a[72:75]
    v_mfma_f32_16x16x32_bf16 a[76:79], v[52:55], v[44:47], a[76:79]
    ds_read_b64_tr_b16 v[48:49], v24 offset:32768
    ds_read_b64_tr_b16 v[50:51], v24 offset:33792
    s_waitcnt lgkmcnt(4)
    v_mfma_f32_16x16x32_bf16 a[80:83], v[56:59], v[40:43], a[80:83]
    v_mfma_f32_16x16x32_bf16 a[84:87], v[56:59], v[44:47], a[84:87]
    ds_read_b64_tr_b16 v[52:53], v25 offset:32768
    ds_read_b64_tr_b16 v[54:55], v25 offset:33792
    s_waitcnt lgkmcnt(4)
    v_mfma_f32_16x16x32_bf16 a[88:91], v[60:63], v[40:43], a[88:91]
    v_mfma_f32_16x16x32_bf16 a[92:95], v[60:63], v[44:47], a[92:95]
    ds_read_b64_tr_b16 v[56:57], v26 offset:32768
    ds_read_b64_tr_b16 v[58:59], v26 offset:33792
    s_waitcnt lgkmcnt(4)
    v_mfma_f32_16x16x32_bf16 a[96:99], v[48:51], v[40:43], a[96:99]
    v_mfma_f32_16x16x32_bf16 a[100:103], v[48:51], v[44:47], a[100:103]
    ds_read_b64_tr_b16 v[60:61], v27 offset:32768
    ds_read_b64_tr_b16 v[62:63], v27 offset:33792
    s_waitcnt lgkmcnt(4)
    v_mfma_f32_16x16x32_bf16 a[104:107], v[52:55], v[40:43], a[104:107]
    v_mfma_f32_16x16x32_bf16 a[108:111], v[52:55], v[44:47], a[108:111]
    ds_read_b64_tr_b16 v[48:49], v20 offset:40960
    ds_read_b64_tr_b16 v[50:51], v20 offset:41984
    s_waitcnt lgkmcnt(4)
    v_mfma_f32_16x16x32_bf16 a[112:115], v[56:59], v[40:43], a[112:115]
    v_mfma_f32_16x16x32_bf16 a[116:119], v[56:59], v[44:47], a[116:119]
    ds_read_b64_tr_b16 v[52:53], v21 offset:40960
    ds_read_b64_tr_b16 v[54:55], v21 offset:41984
    s_waitcnt lgkmcnt(4)
    v_mfma_f32_16x16x32_bf16 a[120:123], v[60:63], v[40:43], a[120:123]
    v_mfma_f32_16x16x32_bf16 a[124:127], v[60:63], v[44:47], a[124:127]
    s_waitcnt vmcnt(12)
    s_barrier
    ds_read_b64_tr_b16 v[56:57], v22 offset:40960
    ds_read_b64_tr_b16 v[58:59], v22 offset:41984
    s_waitcnt lgkmcnt(4)
    v_mfma_f32_16x16x32_bf16 a[0:3], v[48:51], v[40:43], a[0:3]
    v_mfma_f32_16x16x32_bf16 a[4:7], v[48:51], v[44:47], a[4:7]
    s_add_u32 m0, s50, 73728
    s_add_u32 s52, s46, 0x0
    buffer_load_dwordx4 v9, s[12:15], s52 offen lds
    ds_read_b64_tr_b16 v[60:61], v23 offset:40960
    ds_read_b64_tr_b16 v[62:63], v23 offset:41984
    s_waitcnt lgkmcnt(4)
    v_mfma_f32_16x16x32_bf16 a[8:11], v[52:55], v[40:43], a[8:11]
    v_mfma_f32_16x16x32_bf16 a[12:15], v[52:55], v[44:47], a[12:15]
    s_add_u32 m0, s50, 74752
    s_add_u32 s52, s46, 0x8000
    buffer_load_dwordx4 v9, s[12:15], s52 offen lds
    ds_read_b64_tr_b16 v[48:49], v24 offset:40960
    ds_read_b64_tr_b16 v[50:51], v24 offset:41984
    s_waitcnt lgkmcnt(4)
    v_mfma_f32_16x16x32_bf16 a[16:19], v[56:59], v[40:43], a[16:19]
    v_mfma_f32_16x16x32_bf16 a[20:23], v[56:59], v[44:47], a[20:23]
    s_add_u32 m0, s50, 81920
    s_add_u32 s52, s46, 0x0
    buffer_load_dwordx4 v9, s[16:19], s52 offen lds
    ds_read_b64_tr_b16 v[52:53], v25 offset:40960
    ds_read_b64_tr_b16 v[54:55], v25 offset:41984
    s_waitcnt lgkmcnt(4)
    v_mfma_f32_16x16x32_bf16 a[24:27], v[60:63], v[40:43], a[24:27]
    v_mfma_f32_16x16x32_bf16 a[28:31], v[60:63], v[44:47], a[28:31]
    s_add_u32 m0, s50, 82944
    s_add_u32 s52, s46, 0x8000
    buffer_load_dwordx4 v9, s[16:19], s52 offen lds
    ds_read_b64_tr_b16 v[56:57], v26 offset:40960
    ds_read_b64_tr_b16 v[58:59], v26 offset:41984
    s_waitcnt lgkmcnt(4)
    v_mfma_f32_16x16x32_bf16 a[32:35], v[48:51], v[40:43], a[32:35]
    v_mfma_f32_16x16x32_bf16 a[36:39], v[48:51], v[44:47], a[36:39]
    s_add_u32 m0, s51, 73728
    s_add_u32 s52, s47, 0
    buffer_load_dwordx4 v10, s[8:11], s52 offen lds
    ds_read_b64_tr_b16 v[60:61], v27 offset:40960
    ds_read_b64_tr_b16 v[62:63], v27 offset:41984
    s_waitcnt lgkmcnt(4)
    v_mfma_f32_16x16x32_bf16 a[40:43], v[52:55], v[40:43], a[40:43]
    v_mfma_f32_16x16x32_bf16 a[44:47], v[52:55], v[44:47], a[44:47]
    s_add_u32 m0, s51, 74752
    s_add_u32 s52, s47, 20480
    buffer_load_dwordx4 v10, s[8:11], s52 offen lds
    ds_read_b128 v[32:35], v28 offset:0
    ds_read_b128 v[36:39], v28 offset:1024
    ds_read_b64_tr_b16 v[48:49], v12 offset:0
    ds_read_b64_tr_b16 v[50:51], v12 offset:1024
    s_waitcnt lgkmcnt(6)
    v_mfma_f32_16x16x32_bf16 a[48:51], v[56:59], v[40:43], a[48:51]
    v_mfma_f32_16x16x32_bf16 a[52:55], v[56:59], v[44:47], a[52:55]
    s_add_u32 s46, s46, 262144
    s_add_u32 s47, s47, 64
    ds_read_b64_tr_b16 v[52:53], v13 offset:0
    ds_read_b64_tr_b16 v[54:55], v13 offset:1024
    s_waitcnt lgkmcnt(6)
    v_mfma_f32_16x16x32_bf16 a[56:59], v[60:63], v[40:43], a[56:59]
    v_mfma_f32_16x16x32_bf16 a[60:63], v[60:63], v[44:47], a[60:63]
    s_add_u32 s43, s43, 1
    s_cmp_lt_u32 s43, 2
    s_cbranch_scc1 Lpg_107
    s_waitcnt vmcnt(0) lgkmcnt(0)
    s_barrier
    s_nop 3
    v_or_b32 v6, 0, v3
    v_lshrrev_b32 v7, 1, v2
    v_xor_b32 v7, v7, v6
    v_and_b32 v8, 1, v2
    v_lshl_add_u32 v7, v7, 1, v8
    v_lshlrev_b32 v7, 4, v7
    v_mul_u32_u24 v8, 1280, v3
    v_add_u32 v7, v7, v8
    s_lshl_b32 s44, s41, 7
    s_lshl_b32 s45, s42, 5
    s_add_u32 s44, s44, s45
    s_mul_i32 s44, s44, 1280
    v_add_u32 v9, s44, v7
    v_or_b32 v6, 4, v3
    v_lshrrev_b32 v7, 1, v2
    v_xor_b32 v7, v7, v6
    v_and_b32 v8, 1, v2
    v_lshl_add_u32 v7, v7, 1, v8
    v_lshlrev_b32 v7, 4, v7
    v_mul_u32_u24 v8, 1280, v3
    v_add_u32 v7, v7, v8
    s_lshl_b32 s44, s41, 7
    s_lshl_b32 s45, s42, 5
    s_add_u32 s44, s44, s45
    s_mul_i32 s44, s44, 1280
    v_add_u32 v10, s44, v7
    s_lshl_b32 s50, s42, 13
    s_add_u32 m0, s50, 0
    s_mov_b32 s52, 0
    buffer_load_dwordx4 v9, s[20:23], s52 offen lds
    s_add_u32 m0, s50, 1024
    s_mov_b32 s52, 5120
    buffer_load_dwordx4 v10, s[20:23], s52 offen lds
    s_add_u32 m0, s50, 2048
    s_mov_b32 s52, 10240
    buffer_load_dwordx4 v9, s[20:23], s52 offen lds
    s_add_u32 m0, s50, 3072
    s_mov_b32 s52, 15360
    buffer_load_dwordx4 v10, s[20:23], s52 offen lds
    s_add_u32 m0, s50, 4096
    s_mov_b32 s52, 20480
    buffer_load_dwordx4 v9, s[20:23], s52 offen lds
    s_add_u32 m0, s50, 5120
    s_mov_b32 s52, 25600
    buffer_load_dwordx4 v10, s[20:23], s52 offen lds
    s_add_u32 m0, s50, 6144
    s_mov_b32 s52, 30720
    buffer_load_dwordx4 v9, s[20:23], s52 offen lds
    s_add_u32 m0, s50, 7168
    s_mov_b32 s52, 35840
    buffer_load_dwordx4 v10, s[20:23], s52 offen lds
    s_add_u32 m0, s50, 32768
    s_mov_b32 s52, 256
    buffer_load_dwordx4 v9, s[20:23], s52 offen lds
    s_add_u32 m0, s50, 33792
    s_mov_b32 s52, 5376
    buffer_load_dwordx4 v10, s[20:23], s52 offen lds
    s_add_u32 m0, s50, 34816
    s_mov_b32 s52, 10496
    buffer_load_dwordx4 v9, s[20:23], s52 offen lds
    s_add_u32 m0, s50, 35840
    s_mov_b32 s52, 15616
    buffer_load_dwordx4 v10, s[20:23], s52 offen lds
    s_add_u32 m0, s50, 36864
    s_mov_b32 s52, 20736
    buffer_load_dwordx4 v9, s[20:23], s52 offen lds
    s_add_u32 m0, s50, 37888
    s_mov_b32 s52, 25856
    buffer_load_dwordx4 v10, s[20:23], s52 offen lds
    s_add_u32 m0, s50, 38912
    s_mov_b32 s52, 30976
    buffer_load_dwordx4 v9, s[20:23], s52 offen lds
    s_add_u32 m0, s50, 39936
    s_mov_b32 s52, 36096
    buffer_load_dwordx4 v10, s[20:23], s52 offen lds
    s_add_u32 m0, s50, 65536
    s_mov_b32 s52, 512
    buffer_load_dwordx4 v9, s[20:23], s52 offen lds
    s_add_u32 m0, s50, 66560
    s_mov_b32 s52, 5632
    buffer_load_dwordx4 v10, s[20:23], s52 offen lds
    s_add_u32 m0, s50, 67584
    s_mov_b32 s52, 10752
    buffer_load_dwordx4 v9, s[20:23], s52 offen lds
    s_add_u32 m0, s50, 68608
    s_mov_b32 s52, 15872
    buffer_load_dwordx4 v10, s[20:23], s52 offen lds
    s_add_u32 m0, s50, 69632
    s_mov_b32 s52, 20992
    buffer_load_dwordx4 v9, s[20:23], s52 offen lds
    s_add_u32 m0, s50, 70656
    s_mov_b32 s52, 26112
    buffer_load_dwordx4 v10, s[20:23], s52 offen lds
    s_add_u32 m0, s50, 71680
    s_mov_b32 s52, 31232
    buffer_load_dwordx4 v9, s[20:23], s52 offen lds
    s_add_u32 m0, s50, 72704
    s_mov_b32 s52, 36352
    buffer_load_dwordx4 v10, s[20:23], s52 offen lds
    s_add_u32 m0, s50, 98304
    s_mov_b32 s52, 768
    buffer_load_dwordx4 v9, s[20:23], s52 offen lds
    s_add_u32 m0, s50, 99328
    s_mov_b32 s52, 5888
    buffer_load_dwordx4 v10, s[20:23], s52 offen lds
    s_add_u32 m0, s50, 100352
    s_mov_b32 s52, 11008
    buffer_load_dwordx4 v9, s[20:23], s52 offen lds
    s_add_u32 m0, s50, 101376
    s_mov_b32 s52, 16128
    buffer_load_dwordx4 v10, s[20:23], s52 offen lds
    s_add_u32 m0, s50, 102400
    s_mov_b32 s52, 21248
    buffer_load_dwordx4 v9, s[20:23], s52 offen lds
    s_add_u32 m0, s50, 103424
    s_mov_b32 s52, 26368
    buffer_load_dwordx4 v10, s[20:23], s52 offen lds
    s_add_u32 m0, s50, 104448
    s_mov_b32 s52, 31488
    buffer_load_dwordx4 v9, s[20:23], s52 offen lds
    s_add_u32 m0, s50, 105472
    s_mov_b32 s52, 36608
    buffer_load_dwordx4 v10, s[20:23], s52 offen lds
    v_lshrrev_b32 v6, 2, v2
    v_lshl_add_u32 v6, v3, 2, v6
    v_and_b32 v7, 7, v6
    v_lshlrev_b32 v6, 8, v6
    v_and_b32 v8, 3, v2
    v_lshl_add_u32 v6, v8, 3, v6
    v_xor_b32 v8, 0, v7
    v_lshl_add_u32 v12, v8, 5, v6
    v_add_u32 v20, 0x10000, v12
    v_xor_b32 v8, 1, v7
    v_lshl_add_u32 v13, v8, 5, v6
    v_add_u32 v21, 0x10000, v13
    v_xor_b32 v8, 2, v7
    v_lshl_add_u32 v14, v8, 5, v6
    v_add_u32 v22, 0x10000, v14
    v_xor_b32 v8, 3, v7
    v_lshl_add_u32 v15, v8, 5, v6
    v_add_u32 v23, 0x10000, v15
    v_xor_b32 v8, 4, v7
    v_lshl_add_u32 v16, v8, 5, v6
    v_add_u32 v24, 0x10000, v16
    v_xor_b32 v8, 5, v7
    v_lshl_add_u32 v17, v8, 5, v6
    v_add_u32 v25, 0x10000, v17
    v_xor_b32 v8, 6, v7
    v_lshl_add_u32 v18, v8, 5, v6
    v_add_u32 v26, 0x10000, v18
    v_xor_b32 v8, 7, v7
    v_lshl_add_u32 v19, v8, 5, v6
    v_add_u32 v27, 0x10000, v19
    s_lshl_b32 s44, s40, 2
    s_add_u32 s44, s44, s42
    s_mul_i32 s44, s44, 32
    s_add_u32 s44, s44, s41
    s_lshl_b32 s48, s44, 13
    v_lshlrev_b32 v28, 4, v1
    v_add_u32 v28, s48, v28
    s_mul_i32 s48, s44, 40960
    v_and_b32 v6, 7, v2
    v_lshl_add_u32 v6, v3, 3, v6
    v_lshlrev_b32 v6, 4, v6
    v_lshrrev_b32 v7, 3, v2
    v_lshl_add_u32 v6, v7, 9, v6
    v_add_u32 v29, s48, v6
    v_accvgpr_read_b32 v32, a64
    v_accvgpr_read_b32 v33, a65
    v_accvgpr_read_b32 v34, a66
    v_accvgpr_read_b32 v35, a67
    v_cvt_pk_bf16_f32 v40, v32, v33
    v_cvt_pk_bf16_f32 v41, v34, v35
    v_accvgpr_read_b32 v36, a72
    v_accvgpr_read_b32 v37, a73
    v_accvgpr_read_b32 v38, a74
    v_accvgpr_read_b32 v39, a75
    v_cvt_pk_bf16_f32 v42, v36, v37
    v_cvt_pk_bf16_f32 v43, v38, v39
    s_mov_b32 s45, 0x0
    buffer_store_dwordx4 v[40:43], v28, s[4:7], s45 offen sc1
    v_accvgpr_read_b32 v32, a80
    v_accvgpr_read_b32 v33, a81
    v_accvgpr_read_b32 v34, a82
    v_accvgpr_read_b32 v35, a83
    v_cvt_pk_bf16_f32 v44, v32, v33
    v_cvt_pk_bf16_f32 v45, v34, v35
    v_accvgpr_read_b32 v36, a88
    v_accvgpr_read_b32 v37, a89
    v_accvgpr_read_b32 v38, a90
    v_accvgpr_read_b32 v39, a91
    v_cvt_pk_bf16_f32 v46, v36, v37
    v_cvt_pk_bf16_f32 v47, v38, v39
    s_mov_b32 s45, 0x400
    buffer_store_dwordx4 v[44:47], v28, s[4:7], s45 offen sc1
    v_accvgpr_read_b32 v32, a96
    v_accvgpr_read_b32 v33, a97
    v_accvgpr_read_b32 v34, a98
    v_accvgpr_read_b32 v35, a99
    v_cvt_pk_bf16_f32 v48, v32, v33
    v_cvt_pk_bf16_f32 v49, v34, v35
    v_accvgpr_read_b32 v36, a104
    v_accvgpr_read_b32 v37, a105
    v_accvgpr_read_b32 v38, a106
    v_accvgpr_read_b32 v39, a107
    v_cvt_pk_bf16_f32 v50, v36, v37
    v_cvt_pk_bf16_f32 v51, v38, v39
    s_mov_b32 s45, 0x800
    buffer_store_dwordx4 v[48:51], v28, s[4:7], s45 offen sc1
    v_accvgpr_read_b32 v32, a112
    v_accvgpr_read_b32 v33, a113
    v_accvgpr_read_b32 v34, a114
    v_accvgpr_read_b32 v35, a115
    v_cvt_pk_bf16_f32 v52, v32, v33
    v_cvt_pk_bf16_f32 v53, v34, v35
    v_accvgpr_read_b32 v36, a120
    v_accvgpr_read_b32 v37, a121
    v_accvgpr_read_b32 v38, a122
    v_accvgpr_read_b32 v39, a123
    v_cvt_pk_bf16_f32 v54, v36, v37
    v_cvt_pk_bf16_f32 v55, v38, v39
    s_mov_b32 s45, 0xc00
    buffer_store_dwordx4 v[52:55], v28, s[4:7], s45 offen sc1
    v_accvgpr_read_b32 v32, a68
    v_accvgpr_read_b32 v33, a69
    v_accvgpr_read_b32 v34, a70
    v_accvgpr_read_b32 v35, a71
    v_cvt_pk_bf16_f32 v56, v32, v33
    v_cvt_pk_bf16_f32 v57, v34, v35
    v_accvgpr_read_b32 v36, a76
    v_accvgpr_read_b32 v37, a77
    v_accvgpr_read_b32 v38, a78
    v_accvgpr_read_b32 v39, a79
    v_cvt_pk_bf16_f32 v58, v36, v37
    v_cvt_pk_bf16_f32 v59, v38, v39
    s_mov_b32 s45, 0x1000
    buffer_store_dwordx4 v[56:59], v28, s[4:7], s45 offen sc1
    v_accvgpr_read_b32 v32, a84
    v_accvgpr_read_b32 v33, a85
    v_accvgpr_read_b32 v34, a86
    v_accvgpr_read_b32 v35, a87
    v_cvt_pk_bf16_f32 v60, v32, v33
    v_cvt_pk_bf16_f32 v61, v34, v35
    v_accvgpr_read_b32 v36, a92
    v_accvgpr_read_b32 v37, a93
    v_accvgpr_read_b32 v38, a94
    v_accvgpr_read_b32 v39, a95
    v_cvt_pk_bf16_f32 v62, v36, v37
    v_cvt_pk_bf16_f32 v63, v38, v39
    s_mov_b32 s45, 0x1400
    buffer_store_dwordx4 v[60:63], v28, s[4:7], s45 offen sc1
    v_accvgpr_read_b32 v32, a100
    v_accvgpr_read_b32 v33, a101
    v_accvgpr_read_b32 v34, a102
    v_accvgpr_read_b32 v35, a103
    v_cvt_pk_bf16_f32 v64, v32, v33
    v_cvt_pk_bf16_f32 v65, v34, v35
    v_accvgpr_read_b32 v36, a108
    v_accvgpr_read_b32 v37, a109
    v_accvgpr_read_b32 v38, a110
    v_accvgpr_read_b32 v39, a111
    v_cvt_pk_bf16_f32 v66, v36, v37
    v_cvt_pk_bf16_f32 v67, v38, v39
    s_mov_b32 s45, 0x1800
    buffer_store_dwordx4 v[64:67], v28, s[4:7], s45 offen sc1
    v_accvgpr_read_b32 v32, a116
    v_accvgpr_read_b32 v33, a117
    v_accvgpr_read_b32 v34, a118
    v_accvgpr_read_b32 v35, a119
    v_cvt_pk_bf16_f32 v68, v32, v33
    v_cvt_pk_bf16_f32 v69, v34, v35
    v_accvgpr_read_b32 v36, a124
    v_accvgpr_read_b32 v37, a125
    v_accvgpr_read_b32 v38, a126
    v_accvgpr_read_b32 v39, a127
    v_cvt_pk_bf16_f32 v70, v36, v37
    v_cvt_pk_bf16_f32 v71, v38, v39
    s_mov_b32 s45, 0x1c00
    buffer_store_dwordx4 v[68:71], v28, s[4:7], s45 offen sc1
    v_accvgpr_read_b32 v32, a0
    v_accvgpr_read_b32 v33, a1
    v_accvgpr_read_b32 v34, a2
    v_accvgpr_read_b32 v35, a3
    v_cvt_pk_bf16_f32 v72, v32, v33
    v_cvt_pk_bf16_f32 v73, v34, v35
    v_accvgpr_read_b32 v36, a8
    v_accvgpr_read_b32 v37, a9
    v_accvgpr_read_b32 v38, a10
    v_accvgpr_read_b32 v39, a11
    v_cvt_pk_bf16_f32 v74, v36, v37
    v_cvt_pk_bf16_f32 v75, v38, v39
    s_mov_b32 s45, 0x1000000
    buffer_store_dwordx4 v[72:75], v28, s[4:7], s45 offen sc1
    v_accvgpr_read_b32 v32, a16
    v_accvgpr_read_b32 v33, a17
    v_accvgpr_read_b32 v34, a18
    v_accvgpr_read_b32 v35, a19
    v_cvt_pk_bf16_f32 v76, v32, v33
    v_cvt_pk_bf16_f32 v77, v34, v35
    v_accvgpr_read_b32 v36, a24
    v_accvgpr_read_b32 v37, a25
    v_accvgpr_read_b32 v38, a26
    v_accvgpr_read_b32 v39, a27
    v_cvt_pk_bf16_f32 v78, v36, v37
    v_cvt_pk_bf16_f32 v79, v38, v39
    s_mov_b32 s45, 0x1000400
    buffer_store_dwordx4 v[76:79], v28, s[4:7], s45 offen sc1
    v_accvgpr_read_b32 v32, a32
    v_accvgpr_read_b32 v33, a33
    v_accvgpr_read_b32 v34, a34
    v_accvgpr_read_b32 v35, a35
    v_cvt_pk_bf16_f32 v80, v32, v33
    v_cvt_pk_bf16_f32 v81, v34, v35
    v_accvgpr_read_b32 v36, a40
    v_accvgpr_read_b32 v37, a41
    v_accvgpr_read_b32 v38, a42
    v_accvgpr_read_b32 v39, a43
    v_cvt_pk_bf16_f32 v82, v36, v37
    v_cvt_pk_bf16_f32 v83, v38, v39
    s_mov_b32 s45, 0x1000800
    buffer_store_dwordx4 v[80:83], v28, s[4:7], s45 offen sc1
    v_accvgpr_read_b32 v32, a48
    v_accvgpr_read_b32 v33, a49
    v_accvgpr_read_b32 v34, a50
    v_accvgpr_read_b32 v35, a51
    v_cvt_pk_bf16_f32 v84, v32, v33
    v_cvt_pk_bf16_f32 v85, v34, v35
    v_accvgpr_read_b32 v36, a56
    v_accvgpr_read_b32 v37, a57
    v_accvgpr_read_b32 v38, a58
    v_accvgpr_read_b32 v39, a59
    v_cvt_pk_bf16_f32 v86, v36, v37
    v_cvt_pk_bf16_f32 v87, v38, v39
    s_mov_b32 s45, 0x1000c00
    buffer_store_dwordx4 v[84:87], v28, s[4:7], s45 offen sc1
    v_accvgpr_read_b32 v32, a4
    v_accvgpr_read_b32 v33, a5
    v_accvgpr_read_b32 v34, a6
    v_accvgpr_read_b32 v35, a7
    v_cvt_pk_bf16_f32 v88, v32, v33
    v_cvt_pk_bf16_f32 v89, v34, v35
    v_accvgpr_read_b32 v36, a12
    v_accvgpr_read_b32 v37, a13
    v_accvgpr_read_b32 v38, a14
    v_accvgpr_read_b32 v39, a15
    v_cvt_pk_bf16_f32 v90, v36, v37
    v_cvt_pk_bf16_f32 v91, v38, v39
    s_mov_b32 s45, 0x1001000
    buffer_store_dwordx4 v[88:91], v28, s[4:7], s45 offen sc1
    v_accvgpr_read_b32 v32, a20
    v_accvgpr_read_b32 v33, a21
    v_accvgpr_read_b32 v34, a22
    v_accvgpr_read_b32 v35, a23
    v_cvt_pk_bf16_f32 v92, v32, v33
    v_cvt_pk_bf16_f32 v93, v34, v35
    v_accvgpr_read_b32 v36, a28
    v_accvgpr_read_b32 v37, a29
    v_accvgpr_read_b32 v38, a30
    v_accvgpr_read_b32 v39, a31
    v_cvt_pk_bf16_f32 v94, v36, v37
    v_cvt_pk_bf16_f32 v95, v38, v39
    s_mov_b32 s45, 0x1001400
    buffer_store_dwordx4 v[92:95], v28, s[4:7], s45 offen sc1
    v_accvgpr_read_b32 v32, a36
    v_accvgpr_read_b32 v33, a37
    v_accvgpr_read_b32 v34, a38
    v_accvgpr_read_b32 v35, a39
    v_cvt_pk_bf16_f32 v96, v32, v33
    v_cvt_pk_bf16_f32 v97, v34, v35
    v_accvgpr_read_b32 v36, a44
    v_accvgpr_read_b32 v37, a45
    v_accvgpr_read_b32 v38, a46
    v_accvgpr_read_b32 v39, a47
    v_cvt_pk_bf16_f32 v98, v36, v37
    v_cvt_pk_bf16_f32 v99, v38, v39
    s_mov_b32 s45, 0x1001800
    buffer_store_dwordx4 v[96:99], v28, s[4:7], s45 offen sc1
    v_accvgpr_read_b32 v32, a52
    v_accvgpr_read_b32 v33, a53
    v_accvgpr_read_b32 v34, a54
    v_accvgpr_read_b32 v35, a55
    v_cvt_pk_bf16_f32 v100, v32, v33
    v_cvt_pk_bf16_f32 v101, v34, v35
    v_accvgpr_read_b32 v36, a60
    v_accvgpr_read_b32 v37, a61
    v_accvgpr_read_b32 v38, a62
    v_accvgpr_read_b32 v39, a63
    v_cvt_pk_bf16_f32 v102, v36, v37
    v_cvt_pk_bf16_f32 v103, v38, v39
    s_mov_b32 s45, 0x1001c00
    buffer_store_dwordx4 v[100:103], v28, s[4:7], s45 offen sc1
    s_waitcnt vmcnt(40)
    s_barrier
    s_cmp_lg_u32 s97, 0
    s_cbranch_scc1 Lcf_108
    s_cmp_lg_u32 s42, 0
    s_cbranch_scc1 Lcf0_109
    s_load_dwordx2 s[88:89], s[0:1], 88
    v_and_b32 v4, 7, v0
    v_lshlrev_b32 v4, 5, v4
    v_bfe_u32 v5, v0, 3, 1
    v_lshl_add_u32 v4, v5, 2, v4
    v_add_u32 v4, 16, v4
    s_mov_b64 exec, 0xffff
    s_mov_b32 s43, 0
    s_waitcnt lgkmcnt(0)
    s_and_b32 s89, s89, 0xffff
    s_mov_b32 s90, 256
    s_mov_b32 s91, 0x00020000
Lcfp_110:
    buffer_load_dword v5, v4, s[88:91], 0 offen sc1
    s_waitcnt vmcnt(0)
    v_readlane_b32 s60, v5, 0
    v_readlane_b32 s61, v5, 1
    v_readlane_b32 s62, v5, 2
    v_readlane_b32 s63, v5, 3
    v_readlane_b32 s64, v5, 4
    v_readlane_b32 s65, v5, 5
    v_readlane_b32 s66, v5, 6
    v_readlane_b32 s67, v5, 7
    v_readlane_b32 s48, v5, 8
    v_readlane_b32 s49, v5, 9
    s_nop 3
    s_add_u32 s48, s48, s49
    v_readlane_b32 s49, v5, 10
    s_nop 3
    s_add_u32 s48, s48, s49
    v_readlane_b32 s49, v5, 11
    s_nop 3
    s_add_u32 s48, s48, s49
    v_readlane_b32 s49, v5, 12
    s_nop 3
    s_add_u32 s48, s48, s49
    v_readlane_b32 s49, v5, 13
    s_nop 3
    s_add_u32 s48, s48, s49
    v_readlane_b32 s49, v5, 14
    s_nop 3
    s_add_u32 s48, s48, s49
    v_readlane_b32 s49, v5, 15
    s_nop 3
    s_add_u32 s48, s48, s49
    s_add_u32 s43, s43, 1
    s_cmp_gt_u32 s43, 400000
    s_cbranch_scc0 Lcfo_111
    s_endpgm
Lcfo_111:
    s_cmp_lt_u32 s48, 256
    s_cbranch_scc1 Lcfp_110
    s_min_u32 s48, s60, s61
    s_min_u32 s48, s48, s62
    s_min_u32 s48, s48, s63
    s_min_u32 s48, s48, s64
    s_min_u32 s48, s48, s65
    s_min_u32 s48, s48, s66
    s_min_u32 s48, s48, s67
    s_mov_b32 s49, s99
    s_cmp_gt_u32 s98, 0
    s_cselect_b32 s43, s60, 0
    s_add_u32 s49, s49, s43
    s_cmp_gt_u32 s98, 1
    s_cselect_b32 s43, s61, 0
    s_add_u32 s49, s49, s43
    s_cmp_gt_u32 s98, 2
    s_cselect_b32 s43, s62, 0
    s_add_u32 s49, s49, s43
    s_cmp_gt_u32 s98, 3
    s_cselect_b32 s43, s63, 0
    s_add_u32 s49, s49, s43
    s_cmp_gt_u32 s98, 4
    s_cselect_b32 s43, s64, 0
    s_add_u32 s49, s49, s43
    s_cmp_gt_u32 s98, 5
    s_cselect_b32 s43, s65, 0
    s_add_u32 s49, s49, s43
    s_cmp_gt_u32 s98, 6
    s_cselect_b32 s43, s66, 0
    s_add_u32 s49, s49, s43
    s_or_b32 s49, s49, 0x300
    s_lshl_b32 s43, s98, 5
    s_add_u32 s43, s43, s99
    s_or_b32 s43, s43, 0x200
    s_cmp_ge_u32 s48, 32
    s_cselect_b32 s43, s43, s49
    s_mov_b64 exec, 1
    v_mov_b32 v4, 163824
    v_mov_b32 v5, s43
    ds_write_b32 v4, v5
    s_waitcnt lgkmcnt(0)
    s_mov_b64 exec, -1
Lcf0_109:
    s_barrier
    v_mov_b32 v4, 163824
    ds_read_b32 v5, v4
    s_waitcnt lgkmcnt(0)
    v_readfirstlane_b32 s97, v5
    s_nop 3
    s_barrier
    s_bitcmp1_b32 s97, 8
    s_cbranch_scc0 Lcf_108
    s_branch Lentry_3
Lcf_108:
    s_mov_b32 s53, 0x2000000
    s_mov_b32 s54, 0
    ds_read_b64_tr_b16 v[40:41], v12 offset:0
    ds_read_b64_tr_b16 v[42:43], v12 offset:4096
    ds_read_b64_tr_b16 v[44:45], v12 offset:8192
    ds_read_b64_tr_b16 v[46:47], v12 offset:12288
    ds_read_b64_tr_b16 v[48:49], v12 offset:16384
    ds_read_b64_tr_b16 v[50:51], v12 offset:20480
    ds_read_b64_tr_b16 v[52:53], v12 offset:24576
    ds_read_b64_tr_b16 v[54:55], v12 offset:28672
    v_add_u32 v12, 0x8000, v12
    v_and_b32 v12, 0x1ffff, v12
Lu_112:
    ds_read_b64_tr_b16 v[56:57], v13 offset:0
    ds_read_b64_tr_b16 v[58:59], v13 offset:4096
    ds_read_b64_tr_b16 v[60:61], v13 offset:8192
    ds_read_b64_tr_b16 v[62:63], v13 offset:12288
    ds_read_b64_tr_b16 v[64:65], v13 offset:16384
    ds_read_b64_tr_b16 v[66:67], v13 offset:20480
    ds_read_b64_tr_b16 v[68:69], v13 offset:24576
    ds_read_b64_tr_b16 v[70:71], v13 offset:28672
    v_add_u32 v13, 0x8000, v13
    v_and_b32 v13, 0x1ffff, v13
    s_waitcnt lgkmcnt(8)
    v_mfma_f32_16x16x32_bf16 v[104:107], v[72:75], v[40:43], 0
    v_mfma_f32_16x16x32_bf16 v[108:111], v[88:91], v[40:43], 0
    v_mfma_f32_16x16x32_bf16 v[104:107], v[76:79], v[44:47], v[104:107]
    v_mfma_f32_16x16x32_bf16 v[108:111], v[92:95], v[44:47], v[108:111]
    v_mfma_f32_16x16x32_bf16 v[104:107], v[80:83], v[48:51], v[104:107]
    v_mfma_f32_16x16x32_bf16 v[108:111], v[96:99], v[48:51], v[108:111]
    v_mfma_f32_16x16x32_bf16 v[104:107], v[84:87], v[52:55], v[104:107]
    v_mfma_f32_16x16x32_bf16 v[108:111], v[100:103], v[52:55], v[108:111]
    s_cmp_eq_u32 s54, 0
    s_cbranch_scc1 Lsk_113
    v_cvt_pk_bf16_f32 v124, v112, v113
    v_cvt_pk_bf16_f32 v125, v114, v115
    v_cvt_pk_bf16_f32 v126, v116, v117
    v_cvt_pk_bf16_f32 v127, v118, v119
    s_add_u32 s45, s53, 0x0
    buffer_store_dwordx4 v[124:127], v29, s[4:7], s45 offen sc1
    s_add_u32 s53, s53, 1024
Lsk_113:
    ds_read_b64_tr_b16 v[40:41], v14 offset:0
    ds_read_b64_tr_b16 v[42:43], v14 offset:4096
    ds_read_b64_tr_b16 v[44:45], v14 offset:8192
    ds_read_b64_tr_b16 v[46:47], v14 offset:12288
    ds_read_b64_tr_b16 v[48:49], v14 offset:16384
    ds_read_b64_tr_b16 v[50:51], v14 offset:20480
    ds_read_b64_tr_b16 v[52:53], v14 offset:24576
    ds_read_b64_tr_b16 v[54:55], v14 offset:28672
    v_add_u32 v14, 0x8000, v14
    v_and_b32 v14, 0x1ffff, v14
    s_waitcnt lgkmcnt(8)
    v_mfma_f32_16x16x32_bf16 v[112:115], v[72:75], v[56:59], 0
    v_mfma_f32_16x16x32_bf16 v[116:119], v[88:91], v[56:59], 0
    v_mfma_f32_16x16x32_bf16 v[112:115], v[76:79], v[60:63], v[112:115]
    v_mfma_f32_16x16x32_bf16 v[116:119], v[92:95], v[60:63], v[116:119]
    v_mfma_f32_16x16x32_bf16 v[112:115], v[80:83], v[64:67], v[112:115]
    v_mfma_f32_16x16x32_bf16 v[116:119], v[96:99], v[64:67], v[116:119]
    v_mfma_f32_16x16x32_bf16 v[112:115], v[84:87], v[68:71], v[112:115]
    v_mfma_f32_16x16x32_bf16 v[116:119], v[100:103], v[68:71], v[116:119]
    v_cvt_pk_bf16_f32 v120, v104, v105
    v_cvt_pk_bf16_f32 v121, v106, v107
    v_cvt_pk_bf16_f32 v122, v108, v109
    v_cvt_pk_bf16_f32 v123, v110, v111
    s_add_u32 s45, s53, 0x0
    buffer_store_dwordx4 v[120:123], v29, s[4:7], s45 offen sc1
    s_add_u32 s53, s53, 1024
    ds_read_b64_tr_b16 v[56:57], v15 offset:0
    ds_read_b64_tr_b16 v[58:59], v15 offset:4096
    ds_read_b64_tr_b16 v[60:61], v15 offset:8192
    ds_read_b64_tr_b16 v[62:63], v15 offset:12288
    ds_read_b64_tr_b16 v[64:65], v15 offset:16384
    ds_read_b64_tr_b16 v[66:67], v15 offset:20480
    ds_read_b64_tr_b16 v[68:69], v15 offset:24576
    ds_read_b64_tr_b16 v[70:71], v15 offset:28672
    v_add_u32 v15, 0x8000, v15
    v_and_b32 v15, 0x1ffff, v15
    s_waitcnt lgkmcnt(8)
    v_mfma_f32_16x16x32_bf16 v[104:107], v[72:75], v[40:43], 0
    v_mfma_f32_16x16x32_bf16 v[108:111], v[88:91], v[40:43], 0
    v_mfma_f32_16x16x32_bf16 v[104:107], v[76:79], v[44:47], v[104:107]
    v_mfma_f32_16x16x32_bf16 v[108:111], v[92:95], v[44:47], v[108:111]
    v_mfma_f32_16x16x32_bf16 v[104:107], v[80:83], v[48:51], v[104:107]
    v_mfma_f32_16x16x32_bf16 v[108:111], v[96:99], v[48:51], v[108:111]
    v_mfma_f32_16x16x32_bf16 v[104:107], v[84:87], v[52:55], v[104:107]
    v_mfma_f32_16x16x32_bf16 v[108:111], v[100:103], v[52:55], v[108:111]
    v_cvt_pk_bf16_f32 v124, v112, v113
    v_cvt_pk_bf16_f32 v125, v114, v115
    v_cvt_pk_bf16_f32 v126, v116, v117
    v_cvt_pk_bf16_f32 v127, v118, v119
    s_add_u32 s45, s53, 0x0
    buffer_store_dwordx4 v[124:127], v29, s[4:7], s45 offen sc1
    s_add_u32 s53, s53, 1024
    ds_read_b64_tr_b16 v[40:41], v16 offset:0
    ds_read_b64_tr_b16 v[42:43], v16 offset:4096
    ds_read_b64_tr_b16 v[44:45], v16 offset:8192
    ds_read_b64_tr_b16 v[46:47], v16 offset:12288
    ds_read_b64_tr_b16 v[48:49], v16 offset:16384
    ds_read_b64_tr_b16 v[50:51], v16 offset:20480
    ds_read_b64_tr_b16 v[52:53], v16 offset:24576
    ds_read_b64_tr_b16 v[54:55], v16 offset:28672
    v_add_u32 v16, 0x8000, v16
    v_and_b32 v16, 0x1ffff, v16
    s_waitcnt lgkmcnt(8)
    v_mfma_f32_16x16x32_bf16 v[112:115], v[72:75], v[56:59], 0
    v_mfma_f32_16x16x32_bf16 v[116:119], v[88:91], v[56:59], 0
    v_mfma_f32_16x16x32_bf16 v[112:115], v[76:79], v[60:63], v[112:115]
    v_mfma_f32_16x16x32_bf16 v[116:119], v[92:95], v[60:63], v[116:119]
    v_mfma_f32_16x16x32_bf16 v[112:115], v[80:83], v[64:67], v[112:115]
    v_mfma_f32_16x16x32_bf16 v[116:119], v[96:99], v[64:67], v[116:119]
    v_mfma_f32_16x16x32_bf16 v[112:115], v[84:87], v[68:71], v[112:115]
    v_mfma_f32_16x16x32_bf16 v[116:119], v[100:103], v[68:71], v[116:119]
    v_cvt_pk_bf16_f32 v120, v104, v105
    v_cvt_pk_bf16_f32 v121, v106, v107
    v_cvt_pk_bf16_f32 v122, v108, v109
    v_cvt_pk_bf16_f32 v123, v110, v111
    s_add_u32 s45, s53, 0x0
    buffer_store_dwordx4 v[120:123], v29, s[4:7], s45 offen sc1
    s_add_u32 s53, s53, 1024
    ds_read_b64_tr_b16 v[56:57], v17 offset:0
    ds_read_b64_tr_b16 v[58:59], v17 offset:4096
    ds_read_b64_tr_b16 v[60:61], v17 offset:8192
    ds_read_b64_tr_b16 v[62:63], v17 offset:12288
    ds_read_b64_tr_b16 v[64:65], v17 offset:16384
    ds_read_b64_tr_b16 v[66:67], v17 offset:20480
    ds_read_b64_tr_b16 v[68:69], v17 offset:24576
    ds_read_b64_tr_b16 v[70:71], v17 offset:28672
    v_add_u32 v17, 0x8000, v17
    v_and_b32 v17, 0x1ffff, v17
    s_waitcnt lgkmcnt(8)
    v_mfma_f32_16x16x32_bf16 v[104:107], v[72:75], v[40:43], 0
    v_mfma_f32_16x16x32_bf16 v[108:111], v[88:91], v[40:43], 0
    v_mfma_f32_16x16x32_bf16 v[104:107], v[76:79], v[44:47], v[104:107]
    v_mfma_f32_16x16x32_bf16 v[108:111], v[92:95], v[44:47], v[108:111]
    v_mfma_f32_16x16x32_bf16 v[104:107], v[80:83], v[48:51], v[104:107]
    v_mfma_f32_16x16x32_bf16 v[108:111], v[96:99], v[48:51], v[108:111]
    v_mfma_f32_16x16x32_bf16 v[104:107], v[84:87], v[52:55], v[104:107]
    v_mfma_f32_16x16x32_bf16 v[108:111], v[100:103], v[52:55], v[108:111]
    v_cvt_pk_bf16_f32 v124, v112, v113
    v_cvt_pk_bf16_f32 v125, v114, v115
    v_cvt_pk_bf16_f32 v126, v116, v117
    v_cvt_pk_bf16_f32 v127, v118, v119
    s_add_u32 s45, s53, 0x0
    buffer_store_dwordx4 v[124:127], v29, s[4:7], s45 offen sc1
    s_add_u32 s53, s53, 1024
    ds_read_b64_tr_b16 v[40:41], v18 offset:0
    ds_read_b64_tr_b16 v[42:43], v18 offset:4096
    ds_read_b64_tr_b16 v[44:45], v18 offset:8192
    ds_read_b64_tr_b16 v[46:47], v18 offset:12288
    ds_read_b64_tr_b16 v[48:49], v18 offset:16384
    ds_read_b64_tr_b16 v[50:51], v18 offset:20480
    ds_read_b64_tr_b16 v[52:53], v18 offset:24576
    ds_read_b64_tr_b16 v[54:55], v18 offset:28672
    v_add_u32 v18, 0x8000, v18
    v_and_b32 v18, 0x1ffff, v18
    s_waitcnt lgkmcnt(8)
    v_mfma_f32_16x16x32_bf16 v[112:115], v[72:75], v[56:59], 0
    v_mfma_f32_16x16x32_bf16 v[116:119], v[88:91], v[56:59], 0
    v_mfma_f32_16x16x32_bf16 v[112:115], v[76:79], v[60:63], v[112:115]
    v_mfma_f32_16x16x32_bf16 v[116:119], v[92:95], v[60:63], v[116:119]
    v_mfma_f32_16x16x32_bf16 v[112:115], v[80:83], v[64:67], v[112:115]
    v_mfma_f32_16x16x32_bf16 v[116:119], v[96:99], v[64:67], v[116:119]
    v_mfma_f32_16x16x32_bf16 v[112:115], v[84:87], v[68:71], v[112:115]
    v_mfma_f32_16x16x32_bf16 v[116:119], v[100:103], v[68:71], v[116:119]
    v_cvt_pk_bf16_f32 v120, v104, v105
    v_cvt_pk_bf16_f32 v121, v106, v107
    v_cvt_pk_bf16_f32 v122, v108, v109
    v_cvt_pk_bf16_f32 v123, v110, v111
    s_add_u32 s45, s53, 0x0
    buffer_store_dwordx4 v[120:123], v29, s[4:7], s45 offen sc1
    s_add_u32 s53, s53, 1024
    ds_read_b64_tr_b16 v[56:57], v19 offset:0
    ds_read_b64_tr_b16 v[58:59], v19 offset:4096
    ds_read_b64_tr_b16 v[60:61], v19 offset:8192
    ds_read_b64_tr_b16 v[62:63], v19 offset:12288
    ds_read_b64_tr_b16 v[64:65], v19 offset:16384
    ds_read_b64_tr_b16 v[66:67], v19 offset:20480
    ds_read_b64_tr_b16 v[68:69], v19 offset:24576
    ds_read_b64_tr_b16 v[70:71], v19 offset:28672
    v_add_u32 v19, 0x8000, v19
    v_and_b32 v19, 0x1ffff, v19
    s_waitcnt lgkmcnt(8)
    v_mfma_f32_16x16x32_bf16 v[104:107], v[72:75], v[40:43], 0
    v_mfma_f32_16x16x32_bf16 v[108:111], v[88:91], v[40:43], 0
    v_mfma_f32_16x16x32_bf16 v[104:107], v[76:79], v[44:47], v[104:107]
    v_mfma_f32_16x16x32_bf16 v[108:111], v[92:95], v[44:47], v[108:111]
    v_mfma_f32_16x16x32_bf16 v[104:107], v[80:83], v[48:51], v[104:107]
    v_mfma_f32_16x16x32_bf16 v[108:111], v[96:99], v[48:51], v[108:111]
    v_mfma_f32_16x16x32_bf16 v[104:107], v[84:87], v[52:55], v[104:107]
    v_mfma_f32_16x16x32_bf16 v[108:111], v[100:103], v[52:55], v[108:111]
    v_cvt_pk_bf16_f32 v124, v112, v113
    v_cvt_pk_bf16_f32 v125, v114, v115
    v_cvt_pk_bf16_f32 v126, v116, v117
    v_cvt_pk_bf16_f32 v127, v118, v119
    s_add_u32 s45, s53, 0x0
    buffer_store_dwordx4 v[124:127], v29, s[4:7], s45 offen sc1
    s_add_u32 s53, s53, 1024
    s_waitcnt vmcnt(6)
    s_barrier
    s_cmp_lg_u32 s54, 1
    s_cbranch_scc1 Lnd_114
    s_add_u32 m0, s50, 0
    s_mov_b32 s52, 1024
    buffer_load_dwordx4 v9, s[20:23], s52 offen lds
    s_add_u32 m0, s50, 1024
    s_mov_b32 s52, 6144
    buffer_load_dwordx4 v10, s[20:23], s52 offen lds
    s_add_u32 m0, s50, 2048
    s_mov_b32 s52, 11264
    buffer_load_dwordx4 v9, s[20:23], s52 offen lds
    s_add_u32 m0, s50, 3072
    s_mov_b32 s52, 16384
    buffer_load_dwordx4 v10, s[20:23], s52 offen lds
    s_add_u32 m0, s50, 4096
    s_mov_b32 s52, 21504
    buffer_load_dwordx4 v9, s[20:23], s52 offen lds
    s_add_u32 m0, s50, 5120
    s_mov_b32 s52, 26624
    buffer_load_dwordx4 v10, s[20:23], s52 offen lds
    s_add_u32 m0, s50, 6144
    s_mov_b32 s52, 31744
    buffer_load_dwordx4 v9, s[20:23], s52 offen lds
    s_add_u32 m0, s50, 7168
    s_mov_b32 s52, 36864
    buffer_load_dwordx4 v10, s[20:23], s52 offen lds
Lnd_114:
    ds_read_b64_tr_b16 v[40:41], v12 offset:0
    ds_read_b64_tr_b16 v[42:43], v12 offset:4096
    ds_read_b64_tr_b16 v[44:45], v12 offset:8192
    ds_read_b64_tr_b16 v[46:47], v12 offset:12288
    ds_read_b64_tr_b16 v[48:49], v12 offset:16384
    ds_read_b64_tr_b16 v[50:51], v12 offset:20480
    ds_read_b64_tr_b16 v[52:53], v12 offset:24576
    ds_read_b64_tr_b16 v[54:55], v12 offset:28672
    v_add_u32 v12, 0x8000, v12
    v_and_b32 v12, 0x1ffff, v12
    s_waitcnt lgkmcnt(8)
    v_mfma_f32_16x16x32_bf16 v[112:115], v[72:75], v[56:59], 0
    v_mfma_f32_16x16x32_bf16 v[116:119], v[88:91], v[56:59], 0
    v_mfma_f32_16x16x32_bf16 v[112:115], v[76:79], v[60:63], v[112:115]
    v_mfma_f32_16x16x32_bf16 v[116:119], v[92:95], v[60:63], v[116:119]
    v_mfma_f32_16x16x32_bf16 v[112:115], v[80:83], v[64:67], v[112:115]
    v_mfma_f32_16x16x32_bf16 v[116:119], v[96:99], v[64:67], v[116:119]
    v_mfma_f32_16x16x32_bf16 v[112:115], v[84:87], v[68:71], v[112:115]
    v_mfma_f32_16x16x32_bf16 v[116:119], v[100:103], v[68:71], v[116:119]
    v_cvt_pk_bf16_f32 v120, v104, v105
    v_cvt_pk_bf16_f32 v121, v106, v107
    v_cvt_pk_bf16_f32 v122, v108, v109
    v_cvt_pk_bf16_f32 v123, v110, v111
    s_add_u32 s45, s53, 0x0
    buffer_store_dwordx4 v[120:123], v29, s[4:7], s45 offen sc1
    s_add_u32 s53, s53, 1024
    s_add_u32 s54, s54, 1
    s_cmp_lt_u32 s54, 5
    s_cbranch_scc1 Lu_112
    s_nop 7
    v_cvt_pk_bf16_f32 v124, v112, v113
    v_cvt_pk_bf16_f32 v125, v114, v115
    v_cvt_pk_bf16_f32 v126, v116, v117
    v_cvt_pk_bf16_f32 v127, v118, v119
    s_add_u32 s45, s53, 0x0
    buffer_store_dwordx4 v[124:127], v29, s[4:7], s45 offen sc1
    s_add_u32 s53, s53, 1024
    s_waitcnt lgkmcnt(0)
    s_lshl_b32 s75, s40, 12
    s_lshl_b32 s44, s41, 7
    s_add_u32 s75, s75, s44
    s_add_u32 s75, s75, 0x8c01000
    s_waitcnt vmcnt(0)
    s_barrier
    s_cmp_lg_u32 s42, 0
    s_cbranch_scc1 Lsig_115
    s_mov_b64 exec, 1
    v_mov_b32 v4, 1
    v_mov_b32 v5, 0
    buffer_atomic_add v4, v5, s[4:7], s75 offen
    s_add_u32 s75, s75, 156032
    buffer_atomic_add v4, v5, s[4:7], s75 offen
    s_mov_b64 exec, -1
Lsig_115:
    s_add_u32 s73, s73, 4
    s_cmp_lt_u32 s73, 8
    s_cbranch_scc0 Lkvu2_116
    s_branch Lkvu_106
Lkvu2_116:
    s_add_u32 s85, s72, 32
    s_cmp_eq_u32 s71, 2
    s_cselect_b32 s85, s85, 99
    s_cmp_eq_u32 s71, 1
    s_cselect_b32 s85, s72, s85
    s_cmp_lt_u32 s85, 40
    s_cbranch_scc1 Lcg_118
    s_branch Lcs_117
Lcg_118:
    s_mov_b32 s75, 0x8c27100
    s_cmp_lg_u32 s42, 0
    s_cbranch_scc1 Lwtd_120
    v_mov_b32 v5, 0
    s_mov_b32 s74, 0
Lwt_119:
    buffer_load_dword v4, v5, s[4:7], s75 offen sc1
    s_waitcnt vmcnt(0)
    v_cmp_gt_u32 vcc, 0x200, v4
    s_cbranch_vccz Lwtd_120
    s_sleep 8
    s_add_u32 s74, s74, 1
    s_cmp_lt_u32 s74, 4000000
    s_cbranch_scc1 Lwt_119
Lwtd_120:
    s_barrier
    s_and_b32 s40, s85, 7
    s_lshr_b32 s41, s85, 3
    s_mov_b32 s8, s76
    s_and_b32 s9, s77, 0xffff
    s_mov_b32 s10, 0x280000
    s_mov_b32 s11, 0x00020000
    s_and_b32 s44, s42, 1
    s_lshl_b32 s44, s44, 2
    v_or_b32 v6, s44, v3
    v_lshrrev_b32 v7, 1, v2
    v_xor_b32 v7, v7, v6
    v_and_b32 v8, 1, v2
    v_lshl_add_u32 v7, v7, 1, v8
    v_lshlrev_b32 v7, 4, v7
    v_mul_u32_u24 v8, 1280, v3
    v_add_u32 v7, v7, v8
    s_mul_i32 s44, s42, 10240
    s_lshl_b32 s45, s41, 8
    s_add_u32 s44, s44, s45
    v_add_u32 v9, s44, v7
    v_lshrrev_b32 v6, 2, v1
    v_mul_u32_u24 v6, 81920, v6
    v_and_b32 v7, 3, v1
    v_xor_b32 v7, v7, v3
    v_lshl_add_u32 v6, v7, 4, v6
    s_lshl_b32 s44, s40, 2
    s_add_u32 s44, s44, s42
    s_mul_i32 s44, s44, 2560
    v_add_u32 v10, s44, v6
    v_lshrrev_b32 v6, 2, v2
    v_and_b32 v7, 1, v3
    v_lshl_or_b32 v7, v7, 2, v6
    v_lshl_add_u32 v6, v3, 3, v6
    v_lshlrev_b32 v6, 8, v6
    v_and_b32 v8, 3, v2
    v_lshl_add_u32 v6, v8, 3, v6
    v_xor_b32 v8, 0, v7
    v_lshl_add_u32 v12, v8, 5, v6
    v_add_u32 v20, 0x10000, v12
    v_xor_b32 v8, 1, v7
    v_lshl_add_u32 v13, v8, 5, v6
    v_add_u32 v21, 0x10000, v13
    v_xor_b32 v8, 2, v7
    v_lshl_add_u32 v14, v8, 5, v6
    v_add_u32 v22, 0x10000, v14
    v_xor_b32 v8, 3, v7
    v_lshl_add_u32 v15, v8, 5, v6
    v_add_u32 v23, 0x10000, v15
    v_xor_b32 v8, 4, v7
    v_lshl_add_u32 v16, v8, 5, v6
    v_add_u32 v24, 0x10000, v16
    v_xor_b32 v8, 5, v7
    v_lshl_add_u32 v17, v8, 5, v6
    v_add_u32 v25, 0x10000, v17
    v_xor_b32 v8, 6, v7
    v_lshl_add_u32 v18, v8, 5, v6
    v_add_u32 v26, 0x10000, v18
    v_xor_b32 v8, 7, v7
    v_lshl_add_u32 v19, v8, 5, v6
    v_add_u32 v27, 0x10000, v19
    v_lshrrev_b32 v6, 2, v2
    v_xor_b32 v6, v6, v3
    v_lshlrev_b32 v6, 4, v6
    v_lshl_add_u32 v6, v2, 6, v6
    s_mul_i32 s44, s42, 4096
    s_add_u32 s44, s44, 16384
    v_add_u32 v28, s44, v6
    v_add_u32 v29, 0x10000, v28
    s_lshl_b32 s50, s42, 11
    s_mov_b32 s51, s44
    s_mov_b32 s46, 0
    s_mov_b32 s47, 0x0
    s_mov_b32 s53, 0
    s_add_u32 m0, s50, 0
    s_add_u32 s52, s46, 0x9800000
    buffer_load_dwordx4 v9, s[4:7], s52 offen lds
    s_add_u32 m0, s50, 1024
    s_add_u32 s52, s46, 0x9801400
    buffer_load_dwordx4 v9, s[4:7], s52 offen lds
    s_add_u32 m0, s50, 8192
    s_add_u32 s52, s46, 0x9900000
    buffer_load_dwordx4 v9, s[4:7], s52 offen lds
    s_add_u32 m0, s50, 9216
    s_add_u32 s52, s46, 0x9901400
    buffer_load_dwordx4 v9, s[4:7], s52 offen lds
    s_add_u32 m0, s51, 0
    s_add_u32 s52, s47, 0
    buffer_load_dwordx4 v10, s[8:11], s52 offen lds
    s_add_u32 m0, s51, 1024
    s_add_u32 s52, s47, 1310720
    buffer_load_dwordx4 v10, s[8:11], s52 offen lds
    s_add_u32 m0, s51, 2048
    s_add_u32 s52, s47, 1280
    buffer_load_dwordx4 v10, s[8:11], s52 offen lds
    s_add_u32 m0, s51, 3072
    s_add_u32 s52, s47, 1312000
    buffer_load_dwordx4 v10, s[8:11], s52 offen lds
    s_add_u32 s46, s46, 40960
    s_add_u32 s47, s47, 64
    s_add_u32 m0, s50, 32768
    s_add_u32 s52, s46, 0x9800000
    buffer_load_dwordx4 v9, s[4:7], s52 offen lds
    s_add_u32 m0, s50, 33792
    s_add_u32 s52, s46, 0x9801400
    buffer_load_dwordx4 v9, s[4:7], s52 offen lds
    s_add_u32 m0, s50, 40960
    s_add_u32 s52, s46, 0x9900000
    buffer_load_dwordx4 v9, s[4:7], s52 offen lds
    s_add_u32 m0, s50, 41984
    s_add_u32 s52, s46, 0x9901400
    buffer_load_dwordx4 v9, s[4:7], s52 offen lds
    s_add_u32 m0, s51, 32768
    s_add_u32 s52, s47, 0
    buffer_load_dwordx4 v10, s[8:11], s52 offen lds
    s_add_u32 m0, s51, 33792
    s_add_u32 s52, s47, 1310720
    buffer_load_dwordx4 v10, s[8:11], s52 offen lds
    s_add_u32 m0, s51, 34816
    s_add_u32 s52, s47, 1280
    buffer_load_dwordx4 v10, s[8:11], s52 offen lds
    s_add_u32 m0, s51, 35840
    s_add_u32 s52, s47, 1312000
    buffer_load_dwordx4 v10, s[8:11], s52 offen lds
    s_add_u32 s46, s46, 40960
    s_add_u32 s47, s47, 64
    s_add_u32 m0, s50, 65536
    s_add_u32 s52, s46, 0x9800000
    buffer_load_dwordx4 v9, s[4:7], s52 offen lds
    s_add_u32 m0, s50, 66560
    s_add_u32 s52, s46, 0x9801400
    buffer_load_dwordx4 v9, s[4:7], s52 offen lds
    s_add_u32 m0, s50, 73728
    s_add_u32 s52, s46, 0x9900000
    buffer_load_dwordx4 v9, s[4:7], s52 offen lds
    s_add_u32 m0, s50, 74752
    s_add_u32 s52, s46, 0x9901400
    buffer_load_dwordx4 v9, s[4:7], s52 offen lds
    s_add_u32 m0, s51, 65536
    s_add_u32 s52, s47, 0
    buffer_load_dwordx4 v10, s[8:11], s52 offen lds
    s_add_u32 m0, s51, 66560
    s_add_u32 s52, s47, 1310720
    buffer_load_dwordx4 v10, s[8:11], s52 offen lds
    s_add_u32 m0, s51, 67584
    s_add_u32 s52, s47, 1280
    buffer_load_dwordx4 v10, s[8:11], s52 offen lds
    s_add_u32 m0, s51, 68608
    s_add_u32 s52, s47, 1312000
    buffer_load_dwordx4 v10, s[8:11], s52 offen lds
    s_add_u32 s46, s46, 40960
    s_add_u32 s47, s47, 64
    v_accvgpr_write_b32 a0, 0
    v_accvgpr_write_b32 a1, 0
    v_accvgpr_write_b32 a2, 0
    v_accvgpr_write_b32 a3, 0
    v_accvgpr_write_b32 a4, 0
    v_accvgpr_write_b32 a5, 0
    v_accvgpr_write_b32 a6, 0
    v_accvgpr_write_b32 a7, 0
    v_accvgpr_write_b32 a8, 0
    v_accvgpr_write_b32 a9, 0
    v_accvgpr_write_b32 a10, 0
    v_accvgpr_write_b32 a11, 0
    v_accvgpr_write_b32 a12, 0
    v_accvgpr_write_b32 a13, 0
    v_accvgpr_write_b32 a14, 0
    v_accvgpr_write_b32 a15, 0
    v_accvgpr_write_b32 a16, 0
    v_accvgpr_write_b32 a17, 0
    v_accvgpr_write_b32 a18, 0
    v_accvgpr_write_b32 a19, 0
    v_accvgpr_write_b32 a20, 0
    v_accvgpr_write_b32 a21, 0
    v_accvgpr_write_b32 a22, 0
    v_accvgpr_write_b32 a23, 0
    v_accvgpr_write_b32 a24, 0
    v_accvgpr_write_b32 a25, 0
    v_accvgpr_write_b32 a26, 0
    v_accvgpr_write_b32 a27, 0
    v_accvgpr_write_b32 a28, 0
    v_accvgpr_write_b32 a29, 0
    v_accvgpr_write_b32 a30, 0
    v_accvgpr_write_b32 a31, 0
    v_accvgpr_write_b32 a32, 0
    v_accvgpr_write_b32 a33, 0
    v_accvgpr_write_b32 a34, 0
    v_accvgpr_write_b32 a35, 0
    v_accvgpr_write_b32 a36, 0
    v_accvgpr_write_b32 a37, 0
    v_accvgpr_write_b32 a38, 0
    v_accvgpr_write_b32 a39, 0
    v_accvgpr_write_b32 a40, 0
    v_accvgpr_write_b32 a41, 0
    v_accvgpr_write_b32 a42, 0
    v_accvgpr_write_b32 a43, 0
    v_accvgpr_write_b32 a44, 0
    v_accvgpr_write_b32 a45, 0
    v_accvgpr_write_b32 a46, 0
    v_accvgpr_write_b32 a47, 0
    v_accvgpr_write_b32 a48, 0
    v_accvgpr_write_b32 a49, 0
    v_accvgpr_write_b32 a50, 0
    v_accvgpr_write_b32 a51, 0
    v_accvgpr_write_b32 a52, 0
    v_accvgpr_write_b32 a53, 0
    v_accvgpr_write_b32 a54, 0
    v_accvgpr_write_b32 a55, 0
    v_accvgpr_write_b32 a56, 0
    v_accvgpr_write_b32 a57, 0
    v_accvgpr_write_b32 a58, 0
    v_accvgpr_write_b32 a59, 0
    v_accvgpr_write_b32 a60, 0
    v_accvgpr_write_b32 a61, 0
    v_accvgpr_write_b32 a62, 0
    v_accvgpr_write_b32 a63, 0
    v_accvgpr_write_b32 a64, 0
    v_accvgpr_write_b32 a65, 0
    v_accvgpr_write_b32 a66, 0
    v_accvgpr_write_b32 a67, 0
    v_accvgpr_write_b32 a68, 0
    v_accvgpr_write_b32 a69, 0
    v_accvgpr_write_b32 a70, 0
    v_accvgpr_write_b32 a71, 0
    v_accvgpr_write_b32 a72, 0
    v_accvgpr_write_b32 a73, 0
    v_accvgpr_write_b32 a74, 0
    v_accvgpr_write_b32 a75, 0
    v_accvgpr_write_b32 a76, 0
    v_accvgpr_write_b32 a77, 0
    v_accvgpr_write_b32 a78, 0
    v_accvgpr_write_b32 a79, 0
    v_accvgpr_write_b32 a80, 0
    v_accvgpr_write_b32 a81, 0
    v_accvgpr_write_b32 a82, 0
    v_accvgpr_write_b32 a83, 0
    v_accvgpr_write_b32 a84, 0
    v_accvgpr_write_b32 a85, 0
    v_accvgpr_write_b32 a86, 0
    v_accvgpr_write_b32 a87, 0
    v_accvgpr_write_b32 a88, 0
    v_accvgpr_write_b32 a89, 0
    v_accvgpr_write_b32 a90, 0
    v_accvgpr_write_b32 a91, 0
    v_accvgpr_write_b32 a92, 0
    v_accvgpr_write_b32 a93, 0
    v_accvgpr_write_b32 a94, 0
    v_accvgpr_write_b32 a95, 0
    v_accvgpr_write_b32 a96, 0
    v_accvgpr_write_b32 a97, 0
    v_accvgpr_write_b32 a98, 0
    v_accvgpr_write_b32 a99, 0
    v_accvgpr_write_b32 a100, 0
    v_accvgpr_write_b32 a101, 0
    v_accvgpr_write_b32 a102, 0
    v_accvgpr_write_b32 a103, 0
    v_accvgpr_write_b32 a104, 0
    v_accvgpr_write_b32 a105, 0
    v_accvgpr_write_b32 a106, 0
    v_accvgpr_write_b32 a107, 0
    v_accvgpr_write_b32 a108, 0
    v_accvgpr_write_b32 a109, 0
    v_accvgpr_write_b32 a110, 0
    v_accvgpr_write_b32 a111, 0
    v_accvgpr_write_b32 a112, 0
    v_accvgpr_write_b32 a113, 0
    v_accvgpr_write_b32 a114, 0
    v_accvgpr_write_b32 a115, 0
    v_accvgpr_write_b32 a116, 0
    v_accvgpr_write_b32 a117, 0
    v_accvgpr_write_b32 a118, 0
    v_accvgpr_write_b32 a119, 0
    v_accvgpr_write_b32 a120, 0
    v_accvgpr_write_b32 a121, 0
    v_accvgpr_write_b32 a122, 0
    v_accvgpr_write_b32 a123, 0
    v_accvgpr_write_b32 a124, 0
    v_accvgpr_write_b32 a125, 0
    v_accvgpr_write_b32 a126, 0
    v_accvgpr_write_b32 a127, 0
    s_waitcnt vmcnt(16)
    s_barrier
    ds_read_b128 v[32:35], v28 offset:0
    ds_read_b128 v[36:39], v28 offset:1024
    ds_read_b128 v[40:43], v28 offset:2048
    ds_read_b128 v[44:47], v28 offset:3072
    ds_read_b64_tr_b16 v[64:65], v12 offset:0
    ds_read_b64_tr_b16 v[66:67], v12 offset:1024
    ds_read_b64_tr_b16 v[68:69], v13 offset:0
    ds_read_b64_tr_b16 v[70:71], v13 offset:1024
    s_mov_b32 s43, 0
Lpg_121:
    ds_read_b64_tr_b16 v[72:73], v14 offset:0
    ds_read_b64_tr_b16 v[74:75], v14 offset:1024
    s_waitcnt lgkmcnt(6)
    s_waitcnt lgkmcnt(4)
    v_mfma_f32_16x16x32_bf16 a[0:3], v[32:35], v[64:67], a[0:3]
    v_mfma_f32_16x16x32_bf16 a[4:7], v[36:39], v[64:67], a[4:7]
    v_mfma_f32_16x16x32_bf16 a[8:11], v[40:43], v[64:67], a[8:11]
    v_mfma_f32_16x16x32_bf16 a[12:15], v[44:47], v[64:67], a[12:15]
    ds_read_b64_tr_b16 v[76:77], v15 offset:0
    ds_read_b64_tr_b16 v[78:79], v15 offset:1024
    s_waitcnt lgkmcnt(4)
    v_mfma_f32_16x16x32_bf16 a[16:19], v[32:35], v[68:71], a[16:19]
    v_mfma_f32_16x16x32_bf16 a[20:23], v[36:39], v[68:71], a[20:23]
    v_mfma_f32_16x16x32_bf16 a[24:27], v[40:43], v[68:71], a[24:27]
    v_mfma_f32_16x16x32_bf16 a[28:31], v[44:47], v[68:71], a[28:31]
    ds_read_b64_tr_b16 v[64:65], v16 offset:0
    ds_read_b64_tr_b16 v[66:67], v16 offset:1024
    s_waitcnt lgkmcnt(4)
    v_mfma_f32_16x16x32_bf16 a[32:35], v[32:35], v[72:75], a[32:35]
    v_mfma_f32_16x16x32_bf16 a[36:39], v[36:39], v[72:75], a[36:39]
    v_mfma_f32_16x16x32_bf16 a[40:43], v[40:43], v[72:75], a[40:43]
    v_mfma_f32_16x16x32_bf16 a[44:47], v[44:47], v[72:75], a[44:47]
    ds_read_b64_tr_b16 v[68:69], v17 offset:0
    ds_read_b64_tr_b16 v[70:71], v17 offset:1024
    s_waitcnt lgkmcnt(4)
    v_mfma_f32_16x16x32_bf16 a[48:51], v[32:35], v[76:79], a[48:51]
    v_mfma_f32_16x16x32_bf16 a[52:55], v[36:39], v[76:79], a[52:55]
    v_mfma_f32_16x16x32_bf16 a[56:59], v[40:43], v[76:79], a[56:59]
    v_mfma_f32_16x16x32_bf16 a[60:63], v[44:47], v[76:79], a[60:63]
    ds_read_b64_tr_b16 v[72:73], v18 offset:0
    ds_read_b64_tr_b16 v[74:75], v18 offset:1024
    s_waitcnt lgkmcnt(4)
    v_mfma_f32_16x16x32_bf16 a[64:67], v[32:35], v[64:67], a[64:67]
    v_mfma_f32_16x16x32_bf16 a[68:71], v[36:39], v[64:67], a[68:71]
    v_mfma_f32_16x16x32_bf16 a[72:75], v[40:43], v[64:67], a[72:75]
    v_mfma_f32_16x16x32_bf16 a[76:79], v[44:47], v[64:67], a[76:79]
    ds_read_b64_tr_b16 v[76:77], v19 offset:0
    ds_read_b64_tr_b16 v[78:79], v19 offset:1024
    s_waitcnt lgkmcnt(4)
    v_mfma_f32_16x16x32_bf16 a[80:83], v[32:35], v[68:71], a[80:83]
    v_mfma_f32_16x16x32_bf16 a[84:87], v[36:39], v[68:71], a[84:87]
    v_mfma_f32_16x16x32_bf16 a[88:91], v[40:43], v[68:71], a[88:91]
    v_mfma_f32_16x16x32_bf16 a[92:95], v[44:47], v[68:71], a[92:95]
    ds_read_b64_tr_b16 v[64:65], v12 offset:8192
    ds_read_b64_tr_b16 v[66:67], v12 offset:9216
    s_waitcnt lgkmcnt(4)
    v_mfma_f32_16x16x32_bf16 a[96:99], v[32:35], v[72:75], a[96:99]
    v_mfma_f32_16x16x32_bf16 a[100:103], v[36:39], v[72:75], a[100:103]
    v_mfma_f32_16x16x32_bf16 a[104:107], v[40:43], v[72:75], a[104:107]
    v_mfma_f32_16x16x32_bf16 a[108:111], v[44:47], v[72:75], a[108:111]
    ds_read_b64_tr_b16 v[68:69], v13 offset:8192
    ds_read_b64_tr_b16 v[70:71], v13 offset:9216
    s_waitcnt lgkmcnt(4)
    v_mfma_f32_16x16x32_bf16 a[112:115], v[32:35], v[76:79], a[112:115]
    v_mfma_f32_16x16x32_bf16 a[116:119], v[36:39], v[76:79], a[116:119]
    v_mfma_f32_16x16x32_bf16 a[120:123], v[40:43], v[76:79], a[120:123]
    v_mfma_f32_16x16x32_bf16 a[124:127], v[44:47], v[76:79], a[124:127]
    s_waitcnt vmcnt(8)
    s_barrier
    ds_read_b64_tr_b16 v[72:73], v14 offset:8192
    ds_read_b64_tr_b16 v[74:75], v14 offset:9216
    s_waitcnt lgkmcnt(4)
    v_mfma_f32_16x16x32_bf16 a[0:3], v[32:35], v[64:67], a[0:3]
    v_mfma_f32_16x16x32_bf16 a[4:7], v[36:39], v[64:67], a[4:7]
    s_add_u32 m0, s50, 98304
    s_add_u32 s52, s46, 0x9800000
    buffer_load_dwordx4 v9, s[4:7], s52 offen lds
    v_mfma_f32_16x16x32_bf16 a[8:11], v[40:43], v[64:67], a[8:11]
    v_mfma_f32_16x16x32_bf16 a[12:15], v[44:47], v[64:67], a[12:15]
    ds_read_b64_tr_b16 v[76:77], v15 offset:8192
    ds_read_b64_tr_b16 v[78:79], v15 offset:9216
    s_waitcnt lgkmcnt(4)
    v_mfma_f32_16x16x32_bf16 a[16:19], v[32:35], v[68:71], a[16:19]
    v_mfma_f32_16x16x32_bf16 a[20:23], v[36:39], v[68:71], a[20:23]
    s_add_u32 m0, s50, 99328
    s_add_u32 s52, s46, 0x9801400
    buffer_load_dwordx4 v9, s[4:7], s52 offen lds
    v_mfma_f32_16x16x32_bf16 a[24:27], v[40:43], v[68:71], a[24:27]
    v_mfma_f32_16x16x32_bf16 a[28:31], v[44:47], v[68:71], a[28:31]
    ds_read_b64_tr_b16 v[64:65], v16 offset:8192
    ds_read_b64_tr_b16 v[66:67], v16 offset:9216
    s_waitcnt lgkmcnt(4)
    v_mfma_f32_16x16x32_bf16 a[32:35], v[32:35], v[72:75], a[32:35]
    v_mfma_f32_16x16x32_bf16 a[36:39], v[36:39], v[72:75], a[36:39]
    s_add_u32 m0, s50, 106496
    s_add_u32 s52, s46, 0x9900000
    buffer_load_dwordx4 v9, s[4:7], s52 offen lds
    v_mfma_f32_16x16x32_bf16 a[40:43], v[40:43], v[72:75], a[40:43]
    v_mfma_f32_16x16x32_bf16 a[44:47], v[44:47], v[72:75], a[44:47]
    ds_read_b64_tr_b16 v[68:69], v17 offset:8192
    ds_read_b64_tr_b16 v[70:71], v17 offset:9216
    s_waitcnt lgkmcnt(4)
    v_mfma_f32_16x16x32_bf16 a[48:51], v[32:35], v[76:79], a[48:51]
    v_mfma_f32_16x16x32_bf16 a[52:55], v[36:39], v[76:79], a[52:55]
    s_add_u32 m0, s50, 107520
    s_add_u32 s52, s46, 0x9901400
    buffer_load_dwordx4 v9, s[4:7], s52 offen lds
    v_mfma_f32_16x16x32_bf16 a[56:59], v[40:43], v[76:79], a[56:59]
    v_mfma_f32_16x16x32_bf16 a[60:63], v[44:47], v[76:79], a[60:63]
    ds_read_b64_tr_b16 v[72:73], v18 offset:8192
    ds_read_b64_tr_b16 v[74:75], v18 offset:9216
    s_waitcnt lgkmcnt(4)
    v_mfma_f32_16x16x32_bf16 a[64:67], v[32:35], v[64:67], a[64:67]
    v_mfma_f32_16x16x32_bf16 a[68:71], v[36:39], v[64:67], a[68:71]
    s_add_u32 m0, s51, 98304
    s_add_u32 s52, s47, 0
    buffer_load_dwordx4 v10, s[8:11], s52 offen lds
    v_mfma_f32_16x16x32_bf16 a[72:75], v[40:43], v[64:67], a[72:75]
    v_mfma_f32_16x16x32_bf16 a[76:79], v[44:47], v[64:67], a[76:79]
    ds_read_b64_tr_b16 v[76:77], v19 offset:8192
    ds_read_b64_tr_b16 v[78:79], v19 offset:9216
    s_waitcnt lgkmcnt(4)
    v_mfma_f32_16x16x32_bf16 a[80:83], v[32:35], v[68:71], a[80:83]
    v_mfma_f32_16x16x32_bf16 a[84:87], v[36:39], v[68:71], a[84:87]
    s_add_u32 m0, s51, 99328
    s_add_u32 s52, s47, 1310720
    buffer_load_dwordx4 v10, s[8:11], s52 offen lds
    v_mfma_f32_16x16x32_bf16 a[88:91], v[40:43], v[68:71], a[88:91]
    v_mfma_f32_16x16x32_bf16 a[92:95], v[44:47], v[68:71], a[92:95]
    ds_read_b128 v[48:51], v28 offset:32768
    ds_read_b128 v[52:55], v28 offset:33792
    ds_read_b128 v[56:59], v28 offset:34816
    ds_read_b128 v[60:63], v28 offset:35840
    ds_read_b64_tr_b16 v[64:65], v12 offset:32768
    ds_read_b64_tr_b16 v[66:67], v12 offset:33792
    s_waitcnt lgkmcnt(8)
    v_mfma_f32_16x16x32_bf16 a[96:99], v[32:35], v[72:75], a[96:99]
    v_mfma_f32_16x16x32_bf16 a[100:103], v[36:39], v[72:75], a[100:103]
    s_add_u32 m0, s51, 100352
    s_add_u32 s52, s47, 1280
    buffer_load_dwordx4 v10, s[8:11], s52 offen lds
    v_mfma_f32_16x16x32_bf16 a[104:107], v[40:43], v[72:75], a[104:107]
    v_mfma_f32_16x16x32_bf16 a[108:111], v[44:47], v[72:75], a[108:111]
    ds_read_b64_tr_b16 v[68:69], v13 offset:32768
    ds_read_b64_tr_b16 v[70:71], v13 offset:33792
    s_waitcnt lgkmcnt(8)
    v_mfma_f32_16x16x32_bf16 a[112:115], v[32:35], v[76:79], a[112:115]
    v_mfma_f32_16x16x32_bf16 a[116:119], v[36:39], v[76:79], a[116:119]
    s_add_u32 m0, s51, 101376
    s_add_u32 s52, s47, 1312000
    buffer_load_dwordx4 v10, s[8:11], s52 offen lds
    v_mfma_f32_16x16x32_bf16 a[120:123], v[40:43], v[76:79], a[120:123]
    v_mfma_f32_16x16x32_bf16 a[124:127], v[44:47], v[76:79], a[124:127]
    s_add_u32 s46, s46, 40960
    s_add_u32 s47, s47, 64
    ds_read_b64_tr_b16 v[72:73], v14 offset:32768
    ds_read_b64_tr_b16 v[74:75], v14 offset:33792
    s_waitcnt lgkmcnt(6)
    s_waitcnt lgkmcnt(4)
    v_mfma_f32_16x16x32_bf16 a[0:3], v[48:51], v[64:67], a[0:3]
    v_mfma_f32_16x16x32_bf16 a[4:7], v[52:55], v[64:67], a[4:7]
    v_mfma_f32_16x16x32_bf16 a[8:11], v[56:59], v[64:67], a[8:11]
    v_mfma_f32_16x16x32_bf16 a[12:15], v[60:63], v[64:67], a[12:15]
    ds_read_b64_tr_b16 v[76:77], v15 offset:32768
    ds_read_b64_tr_b16 v[78:79], v15 offset:33792
    s_waitcnt lgkmcnt(4)
    v_mfma_f32_16x16x32_bf16 a[16:19], v[48:51], v[68:71], a[16:19]
    v_mfma_f32_16x16x32_bf16 a[20:23], v[52:55], v[68:71], a[20:23]
    v_mfma_f32_16x16x32_bf16 a[24:27], v[56:59], v[68:71], a[24:27]
    v_mfma_f32_16x16x32_bf16 a[28:31], v[60:63], v[68:71], a[28:31]
    ds_read_b64_tr_b16 v[64:65], v16 offset:32768
    ds_read_b64_tr_b16 v[66:67], v16 offset:33792
    s_waitcnt lgkmcnt(4)
    v_mfma_f32_16x16x32_bf16 a[32:35], v[48:51], v[72:75], a[32:35]
    v_mfma_f32_16x16x32_bf16 a[36:39], v[52:55], v[72:75], a[36:39]
    v_mfma_f32_16x16x32_bf16 a[40:43], v[56:59], v[72:75], a[40:43]
    v_mfma_f32_16x16x32_bf16 a[44:47], v[60:63], v[72:75], a[44:47]
    ds_read_b64_tr_b16 v[68:69], v17 offset:32768
    ds_read_b64_tr_b16 v[70:71], v17 offset:33792
    s_waitcnt lgkmcnt(4)
    v_mfma_f32_16x16x32_bf16 a[48:51], v[48:51], v[76:79], a[48:51]
    v_mfma_f32_16x16x32_bf16 a[52:55], v[52:55], v[76:79], a[52:55]
    v_mfma_f32_16x16x32_bf16 a[56:59], v[56:59], v[76:79], a[56:59]
    v_mfma_f32_16x16x32_bf16 a[60:63], v[60:63], v[76:79], a[60:63]
    ds_read_b64_tr_b16 v[72:73], v18 offset:32768
    ds_read_b64_tr_b16 v[74:75], v18 offset:33792
    s_waitcnt lgkmcnt(4)
    v_mfma_f32_16x16x32_bf16 a[64:67], v[48:51], v[64:67], a[64:67]
    v_mfma_f32_16x16x32_bf16 a[68:71], v[52:55], v[64:67], a[68:71]
    v_mfma_f32_16x16x32_bf16 a[72:75], v[56:59], v[64:67], a[72:75]
    v_mfma_f32_16x16x32_bf16 a[76:79], v[60:63], v[64:67], a[76:79]
    ds_read_b64_tr_b16 v[76:77], v19 offset:32768
    ds_read_b64_tr_b16 v[78:79], v19 offset:33792
    s_waitcnt lgkmcnt(4)
    v_mfma_f32_16x16x32_bf16 a[80:83], v[48:51], v[68:71], a[80:83]
    v_mfma_f32_16x16x32_bf16 a[84:87], v[52:55], v[68:71], a[84:87]
    v_mfma_f32_16x16x32_bf16 a[88:91], v[56:59], v[68:71], a[88:91]
    v_mfma_f32_16x16x32_bf16 a[92:95], v[60:63], v[68:71], a[92:95]
    ds_read_b64_tr_b16 v[64:65], v12 offset:40960
    ds_read_b64_tr_b16 v[66:67], v12 offset:41984
    s_waitcnt lgkmcnt(4)
    v_mfma_f32_16x16x32_bf16 a[96:99], v[48:51], v[72:75], a[96:99]
    v_mfma_f32_16x16x32_bf16 a[100:103], v[52:55], v[72:75], a[100:103]
    v_mfma_f32_16x16x32_bf16 a[104:107], v[56:59], v[72:75], a[104:107]
    v_mfma_f32_16x16x32_bf16 a[108:111], v[60:63], v[72:75], a[108:111]
    ds_read_b64_tr_b16 v[68:69], v13 offset:40960
    ds_read_b64_tr_b16 v[70:71], v13 offset:41984
    s_waitcnt lgkmcnt(4)
    v_mfma_f32_16x16x32_bf16 a[112:115], v[48:51], v[76:79], a[112:115]
    v_mfma_f32_16x16x32_bf16 a[116:119], v[52:55], v[76:79], a[116:119]
    v_mfma_f32_16x16x32_bf16 a[120:123], v[56:59], v[76:79], a[120:123]
    v_mfma_f32_16x16x32_bf16 a[124:127], v[60:63], v[76:79], a[124:127]
    s_waitcnt vmcnt(8)
    s_barrier
    ds_read_b64_tr_b16 v[72:73], v14 offset:40960
    ds_read_b64_tr_b16 v[74:75], v14 offset:41984
    s_waitcnt lgkmcnt(4)
    v_mfma_f32_16x16x32_bf16 a[0:3], v[48:51], v[64:67], a[0:3]
    v_mfma_f32_16x16x32_bf16 a[4:7], v[52:55], v[64:67], a[4:7]
    s_add_u32 m0, s50, 0
    s_add_u32 s52, s46, 0x9800000
    buffer_load_dwordx4 v9, s[4:7], s52 offen lds
    v_mfma_f32_16x16x32_bf16 a[8:11], v[56:59], v[64:67], a[8:11]
    v_mfma_f32_16x16x32_bf16 a[12:15], v[60:63], v[64:67], a[12:15]
    ds_read_b64_tr_b16 v[76:77], v15 offset:40960
    ds_read_b64_tr_b16 v[78:79], v15 offset:41984
    s_waitcnt lgkmcnt(4)
    v_mfma_f32_16x16x32_bf16 a[16:19], v[48:51], v[68:71], a[16:19]
    v_mfma_f32_16x16x32_bf16 a[20:23], v[52:55], v[68:71], a[20:23]
    s_add_u32 m0, s50, 1024
    s_add_u32 s52, s46, 0x9801400
    buffer_load_dwordx4 v9, s[4:7], s52 offen lds
    v_mfma_f32_16x16x32_bf16 a[24:27], v[56:59], v[68:71], a[24:27]
    v_mfma_f32_16x16x32_bf16 a[28:31], v[60:63], v[68:71], a[28:31]
    ds_read_b64_tr_b16 v[64:65], v16 offset:40960
    ds_read_b64_tr_b16 v[66:67], v16 offset:41984
    s_waitcnt lgkmcnt(4)
    v_mfma_f32_16x16x32_bf16 a[32:35], v[48:51], v[72:75], a[32:35]
    v_mfma_f32_16x16x32_bf16 a[36:39], v[52:55], v[72:75], a[36:39]
    s_add_u32 m0, s50, 8192
    s_add_u32 s52, s46, 0x9900000
    buffer_load_dwordx4 v9, s[4:7], s52 offen lds
    v_mfma_f32_16x16x32_bf16 a[40:43], v[56:59], v[72:75], a[40:43]
    v_mfma_f32_16x16x32_bf16 a[44:47], v[60:63], v[72:75], a[44:47]
    ds_read_b64_tr_b16 v[68:69], v17 offset:40960
    ds_read_b64_tr_b16 v[70:71], v17 offset:41984
    s_waitcnt lgkmcnt(4)
    v_mfma_f32_16x16x32_bf16 a[48:51], v[48:51], v[76:79], a[48:51]
    v_mfma_f32_16x16x32_bf16 a[52:55], v[52:55], v[76:79], a[52:55]
    s_add_u32 m0, s50, 9216
    s_add_u32 s52, s46, 0x9901400
    buffer_load_dwordx4 v9, s[4:7], s52 offen lds
    v_mfma_f32_16x16x32_bf16 a[56:59], v[56:59], v[76:79], a[56:59]
    v_mfma_f32_16x16x32_bf16 a[60:63], v[60:63], v[76:79], a[60:63]
    ds_read_b64_tr_b16 v[72:73], v18 offset:40960
    ds_read_b64_tr_b16 v[74:75], v18 offset:41984
    s_waitcnt lgkmcnt(4)
    v_mfma_f32_16x16x32_bf16 a[64:67], v[48:51], v[64:67], a[64:67]
    v_mfma_f32_16x16x32_bf16 a[68:71], v[52:55], v[64:67], a[68:71]
    s_add_u32 m0, s51, 0
    s_add_u32 s52, s47, 0
    buffer_load_dwordx4 v10, s[8:11], s52 offen lds
    v_mfma_f32_16x16x32_bf16 a[72:75], v[56:59], v[64:67], a[72:75]
    v_mfma_f32_16x16x32_bf16 a[76:79], v[60:63], v[64:67], a[76:79]
    ds_read_b64_tr_b16 v[76:77], v19 offset:40960
    ds_read_b64_tr_b16 v[78:79], v19 offset:41984
    s_waitcnt lgkmcnt(4)
    v_mfma_f32_16x16x32_bf16 a[80:83], v[48:51], v[68:71], a[80:83]
    v_mfma_f32_16x16x32_bf16 a[84:87], v[52:55], v[68:71], a[84:87]
    s_add_u32 m0, s51, 1024
    s_add_u32 s52, s47, 1310720
    buffer_load_dwordx4 v10, s[8:11], s52 offen lds
    v_mfma_f32_16x16x32_bf16 a[88:91], v[56:59], v[68:71], a[88:91]
    v_mfma_f32_16x16x32_bf16 a[92:95], v[60:63], v[68:71], a[92:95]
    ds_read_b128 v[32:35], v29 offset:0
    ds_read_b128 v[36:39], v29 offset:1024
    ds_read_b128 v[40:43], v29 offset:2048
    ds_read_b128 v[44:47], v29 offset:3072
    ds_read_b64_tr_b16 v[64:65], v20 offset:0
    ds_read_b64_tr_b16 v[66:67], v20 offset:1024
    s_waitcnt lgkmcnt(8)
    v_mfma_f32_16x16x32_bf16 a[96:99], v[48:51], v[72:75], a[96:99]
    v_mfma_f32_16x16x32_bf16 a[100:103], v[52:55], v[72:75], a[100:103]
    s_add_u32 m0, s51, 2048
    s_add_u32 s52, s47, 1280
    buffer_load_dwordx4 v10, s[8:11], s52 offen lds
    v_mfma_f32_16x16x32_bf16 a[104:107], v[56:59], v[72:75], a[104:107]
    v_mfma_f32_16x16x32_bf16 a[108:111], v[60:63], v[72:75], a[108:111]
    ds_read_b64_tr_b16 v[68:69], v21 offset:0
    ds_read_b64_tr_b16 v[70:71], v21 offset:1024
    s_waitcnt lgkmcnt(8)
    v_mfma_f32_16x16x32_bf16 a[112:115], v[48:51], v[76:79], a[112:115]
    v_mfma_f32_16x16x32_bf16 a[116:119], v[52:55], v[76:79], a[116:119]
    s_add_u32 m0, s51, 3072
    s_add_u32 s52, s47, 1312000
    buffer_load_dwordx4 v10, s[8:11], s52 offen lds
    v_mfma_f32_16x16x32_bf16 a[120:123], v[56:59], v[76:79], a[120:123]
    v_mfma_f32_16x16x32_bf16 a[124:127], v[60:63], v[76:79], a[124:127]
    s_add_u32 s46, s46, 40960
    s_add_u32 s47, s47, 64
    ds_read_b64_tr_b16 v[72:73], v22 offset:0
    ds_read_b64_tr_b16 v[74:75], v22 offset:1024
    s_waitcnt lgkmcnt(6)
    s_waitcnt lgkmcnt(4)
    v_mfma_f32_16x16x32_bf16 a[0:3], v[32:35], v[64:67], a[0:3]
    v_mfma_f32_16x16x32_bf16 a[4:7], v[36:39], v[64:67], a[4:7]
    v_mfma_f32_16x16x32_bf16 a[8:11], v[40:43], v[64:67], a[8:11]
    v_mfma_f32_16x16x32_bf16 a[12:15], v[44:47], v[64:67], a[12:15]
    ds_read_b64_tr_b16 v[76:77], v23 offset:0
    ds_read_b64_tr_b16 v[78:79], v23 offset:1024
    s_waitcnt lgkmcnt(4)
    v_mfma_f32_16x16x32_bf16 a[16:19], v[32:35], v[68:71], a[16:19]
    v_mfma_f32_16x16x32_bf16 a[20:23], v[36:39], v[68:71], a[20:23]
    v_mfma_f32_16x16x32_bf16 a[24:27], v[40:43], v[68:71], a[24:27]
    v_mfma_f32_16x16x32_bf16 a[28:31], v[44:47], v[68:71], a[28:31]
    ds_read_b64_tr_b16 v[64:65], v24 offset:0
    ds_read_b64_tr_b16 v[66:67], v24 offset:1024
    s_waitcnt lgkmcnt(4)
    v_mfma_f32_16x16x32_bf16 a[32:35], v[32:35], v[72:75], a[32:35]
    v_mfma_f32_16x16x32_bf16 a[36:39], v[36:39], v[72:75], a[36:39]
    v_mfma_f32_16x16x32_bf16 a[40:43], v[40:43], v[72:75], a[40:43]
    v_mfma_f32_16x16x32_bf16 a[44:47], v[44:47], v[72:75], a[44:47]
    ds_read_b64_tr_b16 v[68:69], v25 offset:0
    ds_read_b64_tr_b16 v[70:71], v25 offset:1024
    s_waitcnt lgkmcnt(4)
    v_mfma_f32_16x16x32_bf16 a[48:51], v[32:35], v[76:79], a[48:51]
    v_mfma_f32_16x16x32_bf16 a[52:55], v[36:39], v[76:79], a[52:55]
    v_mfma_f32_16x16x32_bf16 a[56:59], v[40:43], v[76:79], a[56:59]
    v_mfma_f32_16x16x32_bf16 a[60:63], v[44:47], v[76:79], a[60:63]
    ds_read_b64_tr_b16 v[72:73], v26 offset:0
    ds_read_b64_tr_b16 v[74:75], v26 offset:1024
    s_waitcnt lgkmcnt(4)
    v_mfma_f32_16x16x32_bf16 a[64:67], v[32:35], v[64:67], a[64:67]
    v_mfma_f32_16x16x32_bf16 a[68:71], v[36:39], v[64:67], a[68:71]
    v_mfma_f32_16x16x32_bf16 a[72:75], v[40:43], v[64:67], a[72:75]
    v_mfma_f32_16x16x32_bf16 a[76:79], v[44:47], v[64:67], a[76:79]
    ds_read_b64_tr_b16 v[76:77], v27 offset:0
    ds_read_b64_tr_b16 v[78:79], v27 offset:1024
    s_waitcnt lgkmcnt(4)
    v_mfma_f32_16x16x32_bf16 a[80:83], v[32:35], v[68:71], a[80:83]
    v_mfma_f32_16x16x32_bf16 a[84:87], v[36:39], v[68:71], a[84:87]
    v_mfma_f32_16x16x32_bf16 a[88:91], v[40:43], v[68:71], a[88:91]
    v_mfma_f32_16x16x32_bf16 a[92:95], v[44:47], v[68:71], a[92:95]
    ds_read_b64_tr_b16 v[64:65], v20 offset:8192
    ds_read_b64_tr_b16 v[66:67], v20 offset:9216
    s_waitcnt lgkmcnt(4)
    v_mfma_f32_16x16x32_bf16 a[96:99], v[32:35], v[72:75], a[96:99]
    v_mfma_f32_16x16x32_bf16 a[100:103], v[36:39], v[72:75], a[100:103]
    v_mfma_f32_16x16x32_bf16 a[104:107], v[40:43], v[72:75], a[104:107]
    v_mfma_f32_16x16x32_bf16 a[108:111], v[44:47], v[72:75], a[108:111]
    ds_read_b64_tr_b16 v[68:69], v21 offset:8192
    ds_read_b64_tr_b16 v[70:71], v21 offset:9216
    s_waitcnt lgkmcnt(4)
    v_mfma_f32_16x16x32_bf16 a[112:115], v[32:35], v[76:79], a[112:115]
    v_mfma_f32_16x16x32_bf16 a[116:119], v[36:39], v[76:79], a[116:119]
    v_mfma_f32_16x16x32_bf16 a[120:123], v[40:43], v[76:79], a[120:123]
    v_mfma_f32_16x16x32_bf16 a[124:127], v[44:47], v[76:79], a[124:127]
    s_waitcnt vmcnt(8)
    s_barrier
    ds_read_b64_tr_b16 v[72:73], v22 offset:8192
    ds_read_b64_tr_b16 v[74:75], v22 offset:9216
    s_waitcnt lgkmcnt(4)
    v_mfma_f32_16x16x32_bf16 a[0:3], v[32:35], v[64:67], a[0:3]
    v_mfma_f32_16x16x32_bf16 a[4:7], v[36:39], v[64:67], a[4:7]
    s_add_u32 m0, s50, 32768
    s_add_u32 s52, s46, 0x9800000
    buffer_load_dwordx4 v9, s[4:7], s52 offen lds
    v_mfma_f32_16x16x32_bf16 a[8:11], v[40:43], v[64:67], a[8:11]
    v_mfma_f32_16x16x32_bf16 a[12:15], v[44:47], v[64:67], a[12:15]
    ds_read_b64_tr_b16 v[76:77], v23 offset:8192
    ds_read_b64_tr_b16 v[78:79], v23 offset:9216
    s_waitcnt lgkmcnt(4)
    v_mfma_f32_16x16x32_bf16 a[16:19], v[32:35], v[68:71], a[16:19]
    v_mfma_f32_16x16x32_bf16 a[20:23], v[36:39], v[68:71], a[20:23]
    s_add_u32 m0, s50, 33792
    s_add_u32 s52, s46, 0x9801400
    buffer_load_dwordx4 v9, s[4:7], s52 offen lds
    v_mfma_f32_16x16x32_bf16 a[24:27], v[40:43], v[68:71], a[24:27]
    v_mfma_f32_16x16x32_bf16 a[28:31], v[44:47], v[68:71], a[28:31]
    ds_read_b64_tr_b16 v[64:65], v24 offset:8192
    ds_read_b64_tr_b16 v[66:67], v24 offset:9216
    s_waitcnt lgkmcnt(4)
    v_mfma_f32_16x16x32_bf16 a[32:35], v[32:35], v[72:75], a[32:35]
    v_mfma_f32_16x16x32_bf16 a[36:39], v[36:39], v[72:75], a[36:39]
    s_add_u32 m0, s50, 40960
    s_add_u32 s52, s46, 0x9900000
    buffer_load_dwordx4 v9, s[4:7], s52 offen lds
    v_mfma_f32_16x16x32_bf16 a[40:43], v[40:43], v[72:75], a[40:43]
    v_mfma_f32_16x16x32_bf16 a[44:47], v[44:47], v[72:75], a[44:47]
    ds_read_b64_tr_b16 v[68:69], v25 offset:8192
    ds_read_b64_tr_b16 v[70:71], v25 offset:9216
    s_waitcnt lgkmcnt(4)
    v_mfma_f32_16x16x32_bf16 a[48:51], v[32:35], v[76:79], a[48:51]
    v_mfma_f32_16x16x32_bf16 a[52:55], v[36:39], v[76:79], a[52:55]
    s_add_u32 m0, s50, 41984
    s_add_u32 s52, s46, 0x9901400
    buffer_load_dwordx4 v9, s[4:7], s52 offen lds
    v_mfma_f32_16x16x32_bf16 a[56:59], v[40:43], v[76:79], a[56:59]
    v_mfma_f32_16x16x32_bf16 a[60:63], v[44:47], v[76:79], a[60:63]
    ds_read_b64_tr_b16 v[72:73], v26 offset:8192
    ds_read_b64_tr_b16 v[74:75], v26 offset:9216
    s_waitcnt lgkmcnt(4)
    v_mfma_f32_16x16x32_bf16 a[64:67], v[32:35], v[64:67], a[64:67]
    v_mfma_f32_16x16x32_bf16 a[68:71], v[36:39], v[64:67], a[68:71]
    s_add_u32 m0, s51, 32768
    s_add_u32 s52, s47, 0
    buffer_load_dwordx4 v10, s[8:11], s52 offen lds
    v_mfma_f32_16x16x32_bf16 a[72:75], v[40:43], v[64:67], a[72:75]
    v_mfma_f32_16x16x32_bf16 a[76:79], v[44:47], v[64:67], a[76:79]
    ds_read_b64_tr_b16 v[76:77], v27 offset:8192
    ds_read_b64_tr_b16 v[78:79], v27 offset:9216
    s_waitcnt lgkmcnt(4)
    v_mfma_f32_16x16x32_bf16 a[80:83], v[32:35], v[68:71], a[80:83]
    v_mfma_f32_16x16x32_bf16 a[84:87], v[36:39], v[68:71], a[84:87]
    s_add_u32 m0, s51, 33792
    s_add_u32 s52, s47, 1310720
    buffer_load_dwordx4 v10, s[8:11], s52 offen lds
    v_mfma_f32_16x16x32_bf16 a[88:91], v[40:43], v[68:71], a[88:91]
    v_mfma_f32_16x16x32_bf16 a[92:95], v[44:47], v[68:71], a[92:95]
    ds_read_b128 v[48:51], v29 offset:32768
    ds_read_b128 v[52:55], v29 offset:33792
    ds_read_b128 v[56:59], v29 offset:34816
    ds_read_b128 v[60:63], v29 offset:35840
    ds_read_b64_tr_b16 v[64:65], v20 offset:32768
    ds_read_b64_tr_b16 v[66:67], v20 offset:33792
    s_waitcnt lgkmcnt(8)
    v_mfma_f32_16x16x32_bf16 a[96:99], v[32:35], v[72:75], a[96:99]
    v_mfma_f32_16x16x32_bf16 a[100:103], v[36:39], v[72:75], a[100:103]
    s_add_u32 m0, s51, 34816
    s_add_u32 s52, s47, 1280
    buffer_load_dwordx4 v10, s[8:11], s52 offen lds
    v_mfma_f32_16x16x32_bf16 a[104:107], v[40:43], v[72:75], a[104:107]
    v_mfma_f32_16x16x32_bf16 a[108:111], v[44:47], v[72:75], a[108:111]
    ds_read_b64_tr_b16 v[68:69], v21 offset:32768
    ds_read_b64_tr_b16 v[70:71], v21 offset:33792
    s_waitcnt lgkmcnt(8)
    v_mfma_f32_16x16x32_bf16 a[112:115], v[32:35], v[76:79], a[112:115]
    v_mfma_f32_16x16x32_bf16 a[116:119], v[36:39], v[76:79], a[116:119]
    s_add_u32 m0, s51, 35840
    s_add_u32 s52, s47, 1312000
    buffer_load_dwordx4 v10, s[8:11], s52 offen lds
    v_mfma_f32_16x16x32_bf16 a[120:123], v[40:43], v[76:79], a[120:123]
    v_mfma_f32_16x16x32_bf16 a[124:127], v[44:47], v[76:79], a[124:127]
    s_add_u32 s46, s46, 40960
    s_add_u32 s47, s47, 64
    ds_read_b64_tr_b16 v[72:73], v22 offset:32768
    ds_read_b64_tr_b16 v[74:75], v22 offset:33792
    s_waitcnt lgkmcnt(6)
    s_waitcnt lgkmcnt(4)
    v_mfma_f32_16x16x32_bf16 a[0:3], v[48:51], v[64:67], a[0:3]
    v_mfma_f32_16x16x32_bf16 a[4:7], v[52:55], v[64:67], a[4:7]
    v_mfma_f32_16x16x32_bf16 a[8:11], v[56:59], v[64:67], a[8:11]
    v_mfma_f32_16x16x32_bf16 a[12:15], v[60:63], v[64:67], a[12:15]
    ds_read_b64_tr_b16 v[76:77], v23 offset:32768
    ds_read_b64_tr_b16 v[78:79], v23 offset:33792
    s_waitcnt lgkmcnt(4)
    v_mfma_f32_16x16x32_bf16 a[16:19], v[48:51], v[68:71], a[16:19]
    v_mfma_f32_16x16x32_bf16 a[20:23], v[52:55], v[68:71], a[20:23]
    v_mfma_f32_16x16x32_bf16 a[24:27], v[56:59], v[68:71], a[24:27]
    v_mfma_f32_16x16x32_bf16 a[28:31], v[60:63], v[68:71], a[28:31]
    ds_read_b64_tr_b16 v[64:65], v24 offset:32768
    ds_read_b64_tr_b16 v[66:67], v24 offset:33792
    s_waitcnt lgkmcnt(4)
    v_mfma_f32_16x16x32_bf16 a[32:35], v[48:51], v[72:75], a[32:35]
    v_mfma_f32_16x16x32_bf16 a[36:39], v[52:55], v[72:75], a[36:39]
    v_mfma_f32_16x16x32_bf16 a[40:43], v[56:59], v[72:75], a[40:43]
    v_mfma_f32_16x16x32_bf16 a[44:47], v[60:63], v[72:75], a[44:47]
    ds_read_b64_tr_b16 v[68:69], v25 offset:32768
    ds_read_b64_tr_b16 v[70:71], v25 offset:33792
    s_waitcnt lgkmcnt(4)
    v_mfma_f32_16x16x32_bf16 a[48:51], v[48:51], v[76:79], a[48:51]
    v_mfma_f32_16x16x32_bf16 a[52:55], v[52:55], v[76:79], a[52:55]
    v_mfma_f32_16x16x32_bf16 a[56:59], v[56:59], v[76:79], a[56:59]
    v_mfma_f32_16x16x32_bf16 a[60:63], v[60:63], v[76:79], a[60:63]
    ds_read_b64_tr_b16 v[72:73], v26 offset:32768
    ds_read_b64_tr_b16 v[74:75], v26 offset:33792
    s_waitcnt lgkmcnt(4)
    v_mfma_f32_16x16x32_bf16 a[64:67], v[48:51], v[64:67], a[64:67]
    v_mfma_f32_16x16x32_bf16 a[68:71], v[52:55], v[64:67], a[68:71]
    v_mfma_f32_16x16x32_bf16 a[72:75], v[56:59], v[64:67], a[72:75]
    v_mfma_f32_16x16x32_bf16 a[76:79], v[60:63], v[64:67], a[76:79]
    ds_read_b64_tr_b16 v[76:77], v27 offset:32768
    ds_read_b64_tr_b16 v[78:79], v27 offset:33792
    s_waitcnt lgkmcnt(4)
    v_mfma_f32_16x16x32_bf16 a[80:83], v[48:51], v[68:71], a[80:83]
    v_mfma_f32_16x16x32_bf16 a[84:87], v[52:55], v[68:71], a[84:87]
    v_mfma_f32_16x16x32_bf16 a[88:91], v[56:59], v[68:71], a[88:91]
    v_mfma_f32_16x16x32_bf16 a[92:95], v[60:63], v[68:71], a[92:95]
    ds_read_b64_tr_b16 v[64:65], v20 offset:40960
    ds_read_b64_tr_b16 v[66:67], v20 offset:41984
    s_waitcnt lgkmcnt(4)
    v_mfma_f32_16x16x32_bf16 a[96:99], v[48:51], v[72:75], a[96:99]
    v_mfma_f32_16x16x32_bf16 a[100:103], v[52:55], v[72:75], a[100:103]
    v_mfma_f32_16x16x32_bf16 a[104:107], v[56:59], v[72:75], a[104:107]
    v_mfma_f32_16x16x32_bf16 a[108:111], v[60:63], v[72:75], a[108:111]
    ds_read_b64_tr_b16 v[68:69], v21 offset:40960
    ds_read_b64_tr_b16 v[70:71], v21 offset:41984
    s_waitcnt lgkmcnt(4)
    v_mfma_f32_16x16x32_bf16 a[112:115], v[48:51], v[76:79], a[112:115]
    v_mfma_f32_16x16x32_bf16 a[116:119], v[52:55], v[76:79], a[116:119]
    v_mfma_f32_16x16x32_bf16 a[120:123], v[56:59], v[76:79], a[120:123]
    v_mfma_f32_16x16x32_bf16 a[124:127], v[60:63], v[76:79], a[124:127]
    s_waitcnt vmcnt(8)
    s_barrier
    ds_read_b64_tr_b16 v[72:73], v22 offset:40960
    ds_read_b64_tr_b16 v[74:75], v22 offset:41984
    s_waitcnt lgkmcnt(4)
    v_mfma_f32_16x16x32_bf16 a[0:3], v[48:51], v[64:67], a[0:3]
    v_mfma_f32_16x16x32_bf16 a[4:7], v[52:55], v[64:67], a[4:7]
    s_add_u32 m0, s50, 65536
    s_add_u32 s52, s46, 0x9800000
    buffer_load_dwordx4 v9, s[4:7], s52 offen lds
    v_mfma_f32_16x16x32_bf16 a[8:11], v[56:59], v[64:67], a[8:11]
    v_mfma_f32_16x16x32_bf16 a[12:15], v[60:63], v[64:67], a[12:15]
    ds_read_b64_tr_b16 v[76:77], v23 offset:40960
    ds_read_b64_tr_b16 v[78:79], v23 offset:41984
    s_waitcnt lgkmcnt(4)
    v_mfma_f32_16x16x32_bf16 a[16:19], v[48:51], v[68:71], a[16:19]
    v_mfma_f32_16x16x32_bf16 a[20:23], v[52:55], v[68:71], a[20:23]
    s_add_u32 m0, s50, 66560
    s_add_u32 s52, s46, 0x9801400
    buffer_load_dwordx4 v9, s[4:7], s52 offen lds
    v_mfma_f32_16x16x32_bf16 a[24:27], v[56:59], v[68:71], a[24:27]
    v_mfma_f32_16x16x32_bf16 a[28:31], v[60:63], v[68:71], a[28:31]
    ds_read_b64_tr_b16 v[64:65], v24 offset:40960
    ds_read_b64_tr_b16 v[66:67], v24 offset:41984
    s_waitcnt lgkmcnt(4)
    v_mfma_f32_16x16x32_bf16 a[32:35], v[48:51], v[72:75], a[32:35]
    v_mfma_f32_16x16x32_bf16 a[36:39], v[52:55], v[72:75], a[36:39]
    s_add_u32 m0, s50, 73728
    s_add_u32 s52, s46, 0x9900000
    buffer_load_dwordx4 v9, s[4:7], s52 offen lds
    v_mfma_f32_16x16x32_bf16 a[40:43], v[56:59], v[72:75], a[40:43]
    v_mfma_f32_16x16x32_bf16 a[44:47], v[60:63], v[72:75], a[44:47]
    ds_read_b64_tr_b16 v[68:69], v25 offset:40960
    ds_read_b64_tr_b16 v[70:71], v25 offset:41984
    s_waitcnt lgkmcnt(4)
    v_mfma_f32_16x16x32_bf16 a[48:51], v[48:51], v[76:79], a[48:51]
    v_mfma_f32_16x16x32_bf16 a[52:55], v[52:55], v[76:79], a[52:55]
    s_add_u32 m0, s50, 74752
    s_add_u32 s52, s46, 0x9901400
    buffer_load_dwordx4 v9, s[4:7], s52 offen lds
    v_mfma_f32_16x16x32_bf16 a[56:59], v[56:59], v[76:79], a[56:59]
    v_mfma_f32_16x16x32_bf16 a[60:63], v[60:63], v[76:79], a[60:63]
    ds_read_b64_tr_b16 v[72:73], v26 offset:40960
    ds_read_b64_tr_b16 v[74:75], v26 offset:41984
    s_waitcnt lgkmcnt(4)
    v_mfma_f32_16x16x32_bf16 a[64:67], v[48:51], v[64:67], a[64:67]
    v_mfma_f32_16x16x32_bf16 a[68:71], v[52:55], v[64:67], a[68:71]
    s_add_u32 m0, s51, 65536
    s_add_u32 s52, s47, 0
    buffer_load_dwordx4 v10, s[8:11], s52 offen lds
    v_mfma_f32_16x16x32_bf16 a[72:75], v[56:59], v[64:67], a[72:75]
    v_mfma_f32_16x16x32_bf16 a[76:79], v[60:63], v[64:67], a[76:79]
    ds_read_b64_tr_b16 v[76:77], v27 offset:40960
    ds_read_b64_tr_b16 v[78:79], v27 offset:41984
    s_waitcnt lgkmcnt(4)
    v_mfma_f32_16x16x32_bf16 a[80:83], v[48:51], v[68:71], a[80:83]
    v_mfma_f32_16x16x32_bf16 a[84:87], v[52:55], v[68:71], a[84:87]
    s_add_u32 m0, s51, 66560
    s_add_u32 s52, s47, 1310720
    buffer_load_dwordx4 v10, s[8:11], s52 offen lds
    v_mfma_f32_16x16x32_bf16 a[88:91], v[56:59], v[68:71], a[88:91]
    v_mfma_f32_16x16x32_bf16 a[92:95], v[60:63], v[68:71], a[92:95]
    ds_read_b128 v[32:35], v28 offset:0
    ds_read_b128 v[36:39], v28 offset:1024
    ds_read_b128 v[40:43], v28 offset:2048
    ds_read_b128 v[44:47], v28 offset:3072
    ds_read_b64_tr_b16 v[64:65], v12 offset:0
    ds_read_b64_tr_b16 v[66:67], v12 offset:1024
    s_waitcnt lgkmcnt(8)
    v_mfma_f32_16x16x32_bf16 a[96:99], v[48:51], v[72:75], a[96:99]
    v_mfma_f32_16x16x32_bf16 a[100:103], v[52:55], v[72:75], a[100:103]
    s_add_u32 m0, s51, 67584
    s_add_u32 s52, s47, 1280
    buffer_load_dwordx4 v10, s[8:11], s52 offen lds
    v_mfma_f32_16x16x32_bf16 a[104:107], v[56:59], v[72:75], a[104:107]
    v_mfma_f32_16x16x32_bf16 a[108:111], v[60:63], v[72:75], a[108:111]
    ds_read_b64_tr_b16 v[68:69], v13 offset:0
    ds_read_b64_tr_b16 v[70:71], v13 offset:1024
    s_waitcnt lgkmcnt(8)
    v_mfma_f32_16x16x32_bf16 a[112:115], v[48:51], v[76:79], a[112:115]
    v_mfma_f32_16x16x32_bf16 a[116:119], v[52:55], v[76:79], a[116:119]
    s_add_u32 m0, s51, 68608
    s_add_u32 s52, s47, 1312000
    buffer_load_dwordx4 v10, s[8:11], s52 offen lds
    v_mfma_f32_16x16x32_bf16 a[120:123], v[56:59], v[76:79], a[120:123]
    v_mfma_f32_16x16x32_bf16 a[124:127], v[60:63], v[76:79], a[124:127]
    s_add_u32 s46, s46, 40960
    s_add_u32 s47, s47, 64
    s_add_u32 s43, s43, 1
    s_cmp_lt_u32 s43, 5
    s_cbranch_scc1 Lpg_121
    s_waitcnt vmcnt(0) lgkmcnt(0)
    s_barrier
    s_nop 3
    v_lshlrev_b32 v6, 9, v2
    v_lshl_add_u32 v6, v3, 7, v6
    s_lshl_b32 s44, s42, 5
    v_add_u32 v9, s44, v6
    v_add_u32 v11, 0x10000, v9
    v_accvgpr_read_b32 v12, a0
    v_accvgpr_read_b32 v13, a1
    v_accvgpr_read_b32 v14, a2
    v_accvgpr_read_b32 v15, a3
    v_accvgpr_read_b32 v16, a4
    v_accvgpr_read_b32 v17, a5
    v_accvgpr_read_b32 v18, a6
    v_accvgpr_read_b32 v19, a7
    v_cvt_pk_bf16_f32 v20, v12, v13
    v_lshlrev_b32 v6, 16, v20
    v_and_b32 v7, 0xffff0000, v20
    v_sub_f32 v6, v12, v6
    v_sub_f32 v7, v13, v7
    v_cvt_pk_bf16_f32 v28, v6, v7
    v_cvt_pk_bf16_f32 v21, v14, v15
    v_lshlrev_b32 v6, 16, v21
    v_and_b32 v7, 0xffff0000, v21
    v_sub_f32 v6, v14, v6
    v_sub_f32 v7, v15, v7
    v_cvt_pk_bf16_f32 v29, v6, v7
    v_cvt_pk_bf16_f32 v22, v16, v17
    v_lshlrev_b32 v6, 16, v22
    v_and_b32 v7, 0xffff0000, v22
    v_sub_f32 v6, v16, v6
    v_sub_f32 v7, v17, v7
    v_cvt_pk_bf16_f32 v30, v6, v7
    v_cvt_pk_bf16_f32 v23, v18, v19
    v_lshlrev_b32 v6, 16, v23
    v_and_b32 v7, 0xffff0000, v23
    v_sub_f32 v6, v18, v6
    v_sub_f32 v7, v19, v7
    v_cvt_pk_bf16_f32 v31, v6, v7
    ds_write_b128 v9, v[20:23] offset:0
    ds_write_b128 v11, v[28:31] offset:0
    v_accvgpr_read_b32 v12, a8
    v_accvgpr_read_b32 v13, a9
    v_accvgpr_read_b32 v14, a10
    v_accvgpr_read_b32 v15, a11
    v_accvgpr_read_b32 v16, a12
    v_accvgpr_read_b32 v17, a13
    v_accvgpr_read_b32 v18, a14
    v_accvgpr_read_b32 v19, a15
    v_cvt_pk_bf16_f32 v24, v12, v13
    v_lshlrev_b32 v6, 16, v24
    v_and_b32 v7, 0xffff0000, v24
    v_sub_f32 v6, v12, v6
    v_sub_f32 v7, v13, v7
    v_cvt_pk_bf16_f32 v32, v6, v7
    v_cvt_pk_bf16_f32 v25, v14, v15
    v_lshlrev_b32 v6, 16, v25
    v_and_b32 v7, 0xffff0000, v25
    v_sub_f32 v6, v14, v6
    v_sub_f32 v7, v15, v7
    v_cvt_pk_bf16_f32 v33, v6, v7
    v_cvt_pk_bf16_f32 v26, v16, v17
    v_lshlrev_b32 v6, 16, v26
    v_and_b32 v7, 0xffff0000, v26
    v_sub_f32 v6, v16, v6
    v_sub_f32 v7, v17, v7
    v_cvt_pk_bf16_f32 v34, v6, v7
    v_cvt_pk_bf16_f32 v27, v18, v19
    v_lshlrev_b32 v6, 16, v27
    v_and_b32 v7, 0xffff0000, v27
    v_sub_f32 v6, v18, v6
    v_sub_f32 v7, v19, v7
    v_cvt_pk_bf16_f32 v35, v6, v7
    ds_write_b128 v9, v[24:27] offset:16
    ds_write_b128 v11, v[32:35] offset:16
    v_accvgpr_read_b32 v12, a16
    v_accvgpr_read_b32 v13, a17
    v_accvgpr_read_b32 v14, a18
    v_accvgpr_read_b32 v15, a19
    v_accvgpr_read_b32 v16, a20
    v_accvgpr_read_b32 v17, a21
    v_accvgpr_read_b32 v18, a22
    v_accvgpr_read_b32 v19, a23
    v_cvt_pk_bf16_f32 v20, v12, v13
    v_lshlrev_b32 v6, 16, v20
    v_and_b32 v7, 0xffff0000, v20
    v_sub_f32 v6, v12, v6
    v_sub_f32 v7, v13, v7
    v_cvt_pk_bf16_f32 v28, v6, v7
    v_cvt_pk_bf16_f32 v21, v14, v15
    v_lshlrev_b32 v6, 16, v21
    v_and_b32 v7, 0xffff0000, v21
    v_sub_f32 v6, v14, v6
    v_sub_f32 v7, v15, v7
    v_cvt_pk_bf16_f32 v29, v6, v7
    v_cvt_pk_bf16_f32 v22, v16, v17
    v_lshlrev_b32 v6, 16, v22
    v_and_b32 v7, 0xffff0000, v22
    v_sub_f32 v6, v16, v6
    v_sub_f32 v7, v17, v7
    v_cvt_pk_bf16_f32 v30, v6, v7
    v_cvt_pk_bf16_f32 v23, v18, v19
    v_lshlrev_b32 v6, 16, v23
    v_and_b32 v7, 0xffff0000, v23
    v_sub_f32 v6, v18, v6
    v_sub_f32 v7, v19, v7
    v_cvt_pk_bf16_f32 v31, v6, v7
    ds_write_b128 v9, v[20:23] offset:8192
    ds_write_b128 v11, v[28:31] offset:8192
    v_accvgpr_read_b32 v12, a24
    v_accvgpr_read_b32 v13, a25
    v_accvgpr_read_b32 v14, a26
    v_accvgpr_read_b32 v15, a27
    v_accvgpr_read_b32 v16, a28
    v_accvgpr_read_b32 v17, a29
    v_accvgpr_read_b32 v18, a30
    v_accvgpr_read_b32 v19, a31
    v_cvt_pk_bf16_f32 v24, v12, v13
    v_lshlrev_b32 v6, 16, v24
    v_and_b32 v7, 0xffff0000, v24
    v_sub_f32 v6, v12, v6
    v_sub_f32 v7, v13, v7
    v_cvt_pk_bf16_f32 v32, v6, v7
    v_cvt_pk_bf16_f32 v25, v14, v15
    v_lshlrev_b32 v6, 16, v25
    v_and_b32 v7, 0xffff0000, v25
    v_sub_f32 v6, v14, v6
    v_sub_f32 v7, v15, v7
    v_cvt_pk_bf16_f32 v33, v6, v7
    v_cvt_pk_bf16_f32 v26, v16, v17
    v_lshlrev_b32 v6, 16, v26
    v_and_b32 v7, 0xffff0000, v26
    v_sub_f32 v6, v16, v6
    v_sub_f32 v7, v17, v7
    v_cvt_pk_bf16_f32 v34, v6, v7
    v_cvt_pk_bf16_f32 v27, v18, v19
    v_lshlrev_b32 v6, 16, v27
    v_and_b32 v7, 0xffff0000, v27
    v_sub_f32 v6, v18, v6
    v_sub_f32 v7, v19, v7
    v_cvt_pk_bf16_f32 v35, v6, v7
    ds_write_b128 v9, v[24:27] offset:8208
    ds_write_b128 v11, v[32:35] offset:8208
    v_accvgpr_read_b32 v12, a32
    v_accvgpr_read_b32 v13, a33
    v_accvgpr_read_b32 v14, a34
    v_accvgpr_read_b32 v15, a35
    v_accvgpr_read_b32 v16, a36
    v_accvgpr_read_b32 v17, a37
    v_accvgpr_read_b32 v18, a38
    v_accvgpr_read_b32 v19, a39
    v_cvt_pk_bf16_f32 v20, v12, v13
    v_lshlrev_b32 v6, 16, v20
    v_and_b32 v7, 0xffff0000, v20
    v_sub_f32 v6, v12, v6
    v_sub_f32 v7, v13, v7
    v_cvt_pk_bf16_f32 v28, v6, v7
    v_cvt_pk_bf16_f32 v21, v14, v15
    v_lshlrev_b32 v6, 16, v21
    v_and_b32 v7, 0xffff0000, v21
    v_sub_f32 v6, v14, v6
    v_sub_f32 v7, v15, v7
    v_cvt_pk_bf16_f32 v29, v6, v7
    v_cvt_pk_bf16_f32 v22, v16, v17
    v_lshlrev_b32 v6, 16, v22
    v_and_b32 v7, 0xffff0000, v22
    v_sub_f32 v6, v16, v6
    v_sub_f32 v7, v17, v7
    v_cvt_pk_bf16_f32 v30, v6, v7
    v_cvt_pk_bf16_f32 v23, v18, v19
    v_lshlrev_b32 v6, 16, v23
    v_and_b32 v7, 0xffff0000, v23
    v_sub_f32 v6, v18, v6
    v_sub_f32 v7, v19, v7
    v_cvt_pk_bf16_f32 v31, v6, v7
    ds_write_b128 v9, v[20:23] offset:16384
    ds_write_b128 v11, v[28:31] offset:16384
    v_accvgpr_read_b32 v12, a40
    v_accvgpr_read_b32 v13, a41
    v_accvgpr_read_b32 v14, a42
    v_accvgpr_read_b32 v15, a43
    v_accvgpr_read_b32 v16, a44
    v_accvgpr_read_b32 v17, a45
    v_accvgpr_read_b32 v18, a46
    v_accvgpr_read_b32 v19, a47
    v_cvt_pk_bf16_f32 v24, v12, v13
    v_lshlrev_b32 v6, 16, v24
    v_and_b32 v7, 0xffff0000, v24
    v_sub_f32 v6, v12, v6
    v_sub_f32 v7, v13, v7
    v_cvt_pk_bf16_f32 v32, v6, v7
    v_cvt_pk_bf16_f32 v25, v14, v15
    v_lshlrev_b32 v6, 16, v25
    v_and_b32 v7, 0xffff0000, v25
    v_sub_f32 v6, v14, v6
    v_sub_f32 v7, v15, v7
    v_cvt_pk_bf16_f32 v33, v6, v7
    v_cvt_pk_bf16_f32 v26, v16, v17
    v_lshlrev_b32 v6, 16, v26
    v_and_b32 v7, 0xffff0000, v26
    v_sub_f32 v6, v16, v6
    v_sub_f32 v7, v17, v7
    v_cvt_pk_bf16_f32 v34, v6, v7
    v_cvt_pk_bf16_f32 v27, v18, v19
    v_lshlrev_b32 v6, 16, v27
    v_and_b32 v7, 0xffff0000, v27
    v_sub_f32 v6, v18, v6
    v_sub_f32 v7, v19, v7
    v_cvt_pk_bf16_f32 v35, v6, v7
    ds_write_b128 v9, v[24:27] offset:16400
    ds_write_b128 v11, v[32:35] offset:16400
    v_accvgpr_read_b32 v12, a48
    v_accvgpr_read_b32 v13, a49
    v_accvgpr_read_b32 v14, a50
    v_accvgpr_read_b32 v15, a51
    v_accvgpr_read_b32 v16, a52
    v_accvgpr_read_b32 v17, a53
    v_accvgpr_read_b32 v18, a54
    v_accvgpr_read_b32 v19, a55
    v_cvt_pk_bf16_f32 v20, v12, v13
    v_lshlrev_b32 v6, 16, v20
    v_and_b32 v7, 0xffff0000, v20
    v_sub_f32 v6, v12, v6
    v_sub_f32 v7, v13, v7
    v_cvt_pk_bf16_f32 v28, v6, v7
    v_cvt_pk_bf16_f32 v21, v14, v15
    v_lshlrev_b32 v6, 16, v21
    v_and_b32 v7, 0xffff0000, v21
    v_sub_f32 v6, v14, v6
    v_sub_f32 v7, v15, v7
    v_cvt_pk_bf16_f32 v29, v6, v7
    v_cvt_pk_bf16_f32 v22, v16, v17
    v_lshlrev_b32 v6, 16, v22
    v_and_b32 v7, 0xffff0000, v22
    v_sub_f32 v6, v16, v6
    v_sub_f32 v7, v17, v7
    v_cvt_pk_bf16_f32 v30, v6, v7
    v_cvt_pk_bf16_f32 v23, v18, v19
    v_lshlrev_b32 v6, 16, v23
    v_and_b32 v7, 0xffff0000, v23
    v_sub_f32 v6, v18, v6
    v_sub_f32 v7, v19, v7
    v_cvt_pk_bf16_f32 v31, v6, v7
    ds_write_b128 v9, v[20:23] offset:24576
    ds_write_b128 v11, v[28:31] offset:24576
    v_accvgpr_read_b32 v12, a56
    v_accvgpr_read_b32 v13, a57
    v_accvgpr_read_b32 v14, a58
    v_accvgpr_read_b32 v15, a59
    v_accvgpr_read_b32 v16, a60
    v_accvgpr_read_b32 v17, a61
    v_accvgpr_read_b32 v18, a62
    v_accvgpr_read_b32 v19, a63
    v_cvt_pk_bf16_f32 v24, v12, v13
    v_lshlrev_b32 v6, 16, v24
    v_and_b32 v7, 0xffff0000, v24
    v_sub_f32 v6, v12, v6
    v_sub_f32 v7, v13, v7
    v_cvt_pk_bf16_f32 v32, v6, v7
    v_cvt_pk_bf16_f32 v25, v14, v15
    v_lshlrev_b32 v6, 16, v25
    v_and_b32 v7, 0xffff0000, v25
    v_sub_f32 v6, v14, v6
    v_sub_f32 v7, v15, v7
    v_cvt_pk_bf16_f32 v33, v6, v7
    v_cvt_pk_bf16_f32 v26, v16, v17
    v_lshlrev_b32 v6, 16, v26
    v_and_b32 v7, 0xffff0000, v26
    v_sub_f32 v6, v16, v6
    v_sub_f32 v7, v17, v7
    v_cvt_pk_bf16_f32 v34, v6, v7
    v_cvt_pk_bf16_f32 v27, v18, v19
    v_lshlrev_b32 v6, 16, v27
    v_and_b32 v7, 0xffff0000, v27
    v_sub_f32 v6, v18, v6
    v_sub_f32 v7, v19, v7
    v_cvt_pk_bf16_f32 v35, v6, v7
    ds_write_b128 v9, v[24:27] offset:24592
    ds_write_b128 v11, v[32:35] offset:24592
    v_accvgpr_read_b32 v12, a64
    v_accvgpr_read_b32 v13, a65
    v_accvgpr_read_b32 v14, a66
    v_accvgpr_read_b32 v15, a67
    v_accvgpr_read_b32 v16, a68
    v_accvgpr_read_b32 v17, a69
    v_accvgpr_read_b32 v18, a70
    v_accvgpr_read_b32 v19, a71
    v_cvt_pk_bf16_f32 v20, v12, v13
    v_lshlrev_b32 v6, 16, v20
    v_and_b32 v7, 0xffff0000, v20
    v_sub_f32 v6, v12, v6
    v_sub_f32 v7, v13, v7
    v_cvt_pk_bf16_f32 v28, v6, v7
    v_cvt_pk_bf16_f32 v21, v14, v15
    v_lshlrev_b32 v6, 16, v21
    v_and_b32 v7, 0xffff0000, v21
    v_sub_f32 v6, v14, v6
    v_sub_f32 v7, v15, v7
    v_cvt_pk_bf16_f32 v29, v6, v7
    v_cvt_pk_bf16_f32 v22, v16, v17
    v_lshlrev_b32 v6, 16, v22
    v_and_b32 v7, 0xffff0000, v22
    v_sub_f32 v6, v16, v6
    v_sub_f32 v7, v17, v7
    v_cvt_pk_bf16_f32 v30, v6, v7
    v_cvt_pk_bf16_f32 v23, v18, v19
    v_lshlrev_b32 v6, 16, v23
    v_and_b32 v7, 0xffff0000, v23
    v_sub_f32 v6, v18, v6
    v_sub_f32 v7, v19, v7
    v_cvt_pk_bf16_f32 v31, v6, v7
    ds_write_b128 v9, v[20:23] offset:32768
    ds_write_b128 v11, v[28:31] offset:32768
    v_accvgpr_read_b32 v12, a72
    v_accvgpr_read_b32 v13, a73
    v_accvgpr_read_b32 v14, a74
    v_accvgpr_read_b32 v15, a75
    v_accvgpr_read_b32 v16, a76
    v_accvgpr_read_b32 v17, a77
    v_accvgpr_read_b32 v18, a78
    v_accvgpr_read_b32 v19, a79
    v_cvt_pk_bf16_f32 v24, v12, v13
    v_lshlrev_b32 v6, 16, v24
    v_and_b32 v7, 0xffff0000, v24
    v_sub_f32 v6, v12, v6
    v_sub_f32 v7, v13, v7
    v_cvt_pk_bf16_f32 v32, v6, v7
    v_cvt_pk_bf16_f32 v25, v14, v15
    v_lshlrev_b32 v6, 16, v25
    v_and_b32 v7, 0xffff0000, v25
    v_sub_f32 v6, v14, v6
    v_sub_f32 v7, v15, v7
    v_cvt_pk_bf16_f32 v33, v6, v7
    v_cvt_pk_bf16_f32 v26, v16, v17
    v_lshlrev_b32 v6, 16, v26
    v_and_b32 v7, 0xffff0000, v26
    v_sub_f32 v6, v16, v6
    v_sub_f32 v7, v17, v7
    v_cvt_pk_bf16_f32 v34, v6, v7
    v_cvt_pk_bf16_f32 v27, v18, v19
    v_lshlrev_b32 v6, 16, v27
    v_and_b32 v7, 0xffff0000, v27
    v_sub_f32 v6, v18, v6
    v_sub_f32 v7, v19, v7
    v_cvt_pk_bf16_f32 v35, v6, v7
    ds_write_b128 v9, v[24:27] offset:32784
    ds_write_b128 v11, v[32:35] offset:32784
    v_accvgpr_read_b32 v12, a80
    v_accvgpr_read_b32 v13, a81
    v_accvgpr_read_b32 v14, a82
    v_accvgpr_read_b32 v15, a83
    v_accvgpr_read_b32 v16, a84
    v_accvgpr_read_b32 v17, a85
    v_accvgpr_read_b32 v18, a86
    v_accvgpr_read_b32 v19, a87
    v_cvt_pk_bf16_f32 v20, v12, v13
    v_lshlrev_b32 v6, 16, v20
    v_and_b32 v7, 0xffff0000, v20
    v_sub_f32 v6, v12, v6
    v_sub_f32 v7, v13, v7
    v_cvt_pk_bf16_f32 v28, v6, v7
    v_cvt_pk_bf16_f32 v21, v14, v15
    v_lshlrev_b32 v6, 16, v21
    v_and_b32 v7, 0xffff0000, v21
    v_sub_f32 v6, v14, v6
    v_sub_f32 v7, v15, v7
    v_cvt_pk_bf16_f32 v29, v6, v7
    v_cvt_pk_bf16_f32 v22, v16, v17
    v_lshlrev_b32 v6, 16, v22
    v_and_b32 v7, 0xffff0000, v22
    v_sub_f32 v6, v16, v6
    v_sub_f32 v7, v17, v7
    v_cvt_pk_bf16_f32 v30, v6, v7
    v_cvt_pk_bf16_f32 v23, v18, v19
    v_lshlrev_b32 v6, 16, v23
    v_and_b32 v7, 0xffff0000, v23
    v_sub_f32 v6, v18, v6
    v_sub_f32 v7, v19, v7
    v_cvt_pk_bf16_f32 v31, v6, v7
    ds_write_b128 v9, v[20:23] offset:40960
    ds_write_b128 v11, v[28:31] offset:40960
    v_accvgpr_read_b32 v12, a88
    v_accvgpr_read_b32 v13, a89
    v_accvgpr_read_b32 v14, a90
    v_accvgpr_read_b32 v15, a91
    v_accvgpr_read_b32 v16, a92
    v_accvgpr_read_b32 v17, a93
    v_accvgpr_read_b32 v18, a94
    v_accvgpr_read_b32 v19, a95
    v_cvt_pk_bf16_f32 v24, v12, v13
    v_lshlrev_b32 v6, 16, v24
    v_and_b32 v7, 0xffff0000, v24
    v_sub_f32 v6, v12, v6
    v_sub_f32 v7, v13, v7
    v_cvt_pk_bf16_f32 v32, v6, v7
    v_cvt_pk_bf16_f32 v25, v14, v15
    v_lshlrev_b32 v6, 16, v25
    v_and_b32 v7, 0xffff0000, v25
    v_sub_f32 v6, v14, v6
    v_sub_f32 v7, v15, v7
    v_cvt_pk_bf16_f32 v33, v6, v7
    v_cvt_pk_bf16_f32 v26, v16, v17
    v_lshlrev_b32 v6, 16, v26
    v_and_b32 v7, 0xffff0000, v26
    v_sub_f32 v6, v16, v6
    v_sub_f32 v7, v17, v7
    v_cvt_pk_bf16_f32 v34, v6, v7
    v_cvt_pk_bf16_f32 v27, v18, v19
    v_lshlrev_b32 v6, 16, v27
    v_and_b32 v7, 0xffff0000, v27
    v_sub_f32 v6, v18, v6
    v_sub_f32 v7, v19, v7
    v_cvt_pk_bf16_f32 v35, v6, v7
    ds_write_b128 v9, v[24:27] offset:40976
    ds_write_b128 v11, v[32:35] offset:40976
    v_accvgpr_read_b32 v12, a96
    v_accvgpr_read_b32 v13, a97
    v_accvgpr_read_b32 v14, a98
    v_accvgpr_read_b32 v15, a99
    v_accvgpr_read_b32 v16, a100
    v_accvgpr_read_b32 v17, a101
    v_accvgpr_read_b32 v18, a102
    v_accvgpr_read_b32 v19, a103
    v_cvt_pk_bf16_f32 v20, v12, v13
    v_lshlrev_b32 v6, 16, v20
    v_and_b32 v7, 0xffff0000, v20
    v_sub_f32 v6, v12, v6
    v_sub_f32 v7, v13, v7
    v_cvt_pk_bf16_f32 v28, v6, v7
    v_cvt_pk_bf16_f32 v21, v14, v15
    v_lshlrev_b32 v6, 16, v21
    v_and_b32 v7, 0xffff0000, v21
    v_sub_f32 v6, v14, v6
    v_sub_f32 v7, v15, v7
    v_cvt_pk_bf16_f32 v29, v6, v7
    v_cvt_pk_bf16_f32 v22, v16, v17
    v_lshlrev_b32 v6, 16, v22
    v_and_b32 v7, 0xffff0000, v22
    v_sub_f32 v6, v16, v6
    v_sub_f32 v7, v17, v7
    v_cvt_pk_bf16_f32 v30, v6, v7
    v_cvt_pk_bf16_f32 v23, v18, v19
    v_lshlrev_b32 v6, 16, v23
    v_and_b32 v7, 0xffff0000, v23
    v_sub_f32 v6, v18, v6
    v_sub_f32 v7, v19, v7
    v_cvt_pk_bf16_f32 v31, v6, v7
    ds_write_b128 v9, v[20:23] offset:49152
    ds_write_b128 v11, v[28:31] offset:49152
    v_accvgpr_read_b32 v12, a104
    v_accvgpr_read_b32 v13, a105
    v_accvgpr_read_b32 v14, a106
    v_accvgpr_read_b32 v15, a107
    v_accvgpr_read_b32 v16, a108
    v_accvgpr_read_b32 v17, a109
    v_accvgpr_read_b32 v18, a110
    v_accvgpr_read_b32 v19, a111
    v_cvt_pk_bf16_f32 v24, v12, v13
    v_lshlrev_b32 v6, 16, v24
    v_and_b32 v7, 0xffff0000, v24
    v_sub_f32 v6, v12, v6
    v_sub_f32 v7, v13, v7
    v_cvt_pk_bf16_f32 v32, v6, v7
    v_cvt_pk_bf16_f32 v25, v14, v15
    v_lshlrev_b32 v6, 16, v25
    v_and_b32 v7, 0xffff0000, v25
    v_sub_f32 v6, v14, v6
    v_sub_f32 v7, v15, v7
    v_cvt_pk_bf16_f32 v33, v6, v7
    v_cvt_pk_bf16_f32 v26, v16, v17
    v_lshlrev_b32 v6, 16, v26
    v_and_b32 v7, 0xffff0000, v26
    v_sub_f32 v6, v16, v6
    v_sub_f32 v7, v17, v7
    v_cvt_pk_bf16_f32 v34, v6, v7
    v_cvt_pk_bf16_f32 v27, v18, v19
    v_lshlrev_b32 v6, 16, v27
    v_and_b32 v7, 0xffff0000, v27
    v_sub_f32 v6, v18, v6
    v_sub_f32 v7, v19, v7
    v_cvt_pk_bf16_f32 v35, v6, v7
    ds_write_b128 v9, v[24:27] offset:49168
    ds_write_b128 v11, v[32:35] offset:49168
    v_accvgpr_read_b32 v12, a112
    v_accvgpr_read_b32 v13, a113
    v_accvgpr_read_b32 v14, a114
    v_accvgpr_read_b32 v15, a115
    v_accvgpr_read_b32 v16, a116
    v_accvgpr_read_b32 v17, a117
    v_accvgpr_read_b32 v18, a118
    v_accvgpr_read_b32 v19, a119
    v_cvt_pk_bf16_f32 v20, v12, v13
    v_lshlrev_b32 v6, 16, v20
    v_and_b32 v7, 0xffff0000, v20
    v_sub_f32 v6, v12, v6
    v_sub_f32 v7, v13, v7
    v_cvt_pk_bf16_f32 v28, v6, v7
    v_cvt_pk_bf16_f32 v21, v14, v15
    v_lshlrev_b32 v6, 16, v21
    v_and_b32 v7, 0xffff0000, v21
    v_sub_f32 v6, v14, v6
    v_sub_f32 v7, v15, v7
    v_cvt_pk_bf16_f32 v29, v6, v7
    v_cvt_pk_bf16_f32 v22, v16, v17
    v_lshlrev_b32 v6, 16, v22
    v_and_b32 v7, 0xffff0000, v22
    v_sub_f32 v6, v16, v6
    v_sub_f32 v7, v17, v7
    v_cvt_pk_bf16_f32 v30, v6, v7
    v_cvt_pk_bf16_f32 v23, v18, v19
    v_lshlrev_b32 v6, 16, v23
    v_and_b32 v7, 0xffff0000, v23
    v_sub_f32 v6, v18, v6
    v_sub_f32 v7, v19, v7
    v_cvt_pk_bf16_f32 v31, v6, v7
    ds_write_b128 v9, v[20:23] offset:57344
    ds_write_b128 v11, v[28:31] offset:57344
    v_accvgpr_read_b32 v12, a120
    v_accvgpr_read_b32 v13, a121
    v_accvgpr_read_b32 v14, a122
    v_accvgpr_read_b32 v15, a123
    v_accvgpr_read_b32 v16, a124
    v_accvgpr_read_b32 v17, a125
    v_accvgpr_read_b32 v18, a126
    v_accvgpr_read_b32 v19, a127
    v_cvt_pk_bf16_f32 v24, v12, v13
    v_lshlrev_b32 v6, 16, v24
    v_and_b32 v7, 0xffff0000, v24
    v_sub_f32 v6, v12, v6
    v_sub_f32 v7, v13, v7
    v_cvt_pk_bf16_f32 v32, v6, v7
    v_cvt_pk_bf16_f32 v25, v14, v15
    v_lshlrev_b32 v6, 16, v25
    v_and_b32 v7, 0xffff0000, v25
    v_sub_f32 v6, v14, v6
    v_sub_f32 v7, v15, v7
    v_cvt_pk_bf16_f32 v33, v6, v7
    v_cvt_pk_bf16_f32 v26, v16, v17
    v_lshlrev_b32 v6, 16, v26
    v_and_b32 v7, 0xffff0000, v26
    v_sub_f32 v6, v16, v6
    v_sub_f32 v7, v17, v7
    v_cvt_pk_bf16_f32 v34, v6, v7
    v_cvt_pk_bf16_f32 v27, v18, v19
    v_lshlrev_b32 v6, 16, v27
    v_and_b32 v7, 0xffff0000, v27
    v_sub_f32 v6, v18, v6
    v_sub_f32 v7, v19, v7
    v_cvt_pk_bf16_f32 v35, v6, v7
    ds_write_b128 v9, v[24:27] offset:57360
    ds_write_b128 v11, v[32:35] offset:57360
    s_waitcnt lgkmcnt(0)
    s_barrier
    v_lshlrev_b32 v6, 4, v1
    s_lshl_b32 s44, s42, 14
    v_add_u32 v10, s44, v6
    v_add_u32 v11, 0x10000, v10
    s_lshr_b32 s45, s40, 1
    s_lshl_b32 s45, s45, 10
    s_and_b32 s44, s40, 1
    s_lshl_b32 s44, s44, 7
    s_add_u32 s44, s44, s45
    s_lshl_b32 s45, s41, 20
    s_add_u32 s44, s44, s45
    s_lshl_b32 s45, s42, 18
    s_add_u32 s44, s44, s45
    v_lshrrev_b32 v6, 5, v1
    v_lshlrev_b32 v6, 13, v6
    v_bfe_u32 v7, v1, 3, 2
    v_lshl_add_u32 v6, v7, 8, v6
    v_and_b32 v7, 7, v1
    v_lshl_add_u32 v6, v7, 4, v6
    v_add_u32 v8, s44, v6
    ds_read_b128 v[36:39], v10 offset:0
    ds_read_b128 v[40:43], v10 offset:1024
    ds_read_b128 v[44:47], v10 offset:2048
    ds_read_b128 v[48:51], v10 offset:3072
    ds_read_b128 v[52:55], v10 offset:4096
    ds_read_b128 v[56:59], v10 offset:5120
    ds_read_b128 v[60:63], v10 offset:6144
    ds_read_b128 v[64:67], v10 offset:7168
    s_waitcnt lgkmcnt(7)
    s_mov_b32 s44, 0xa200000
    buffer_store_dwordx4 v[36:39], v8, s[4:7], s44 offen sc1
    s_waitcnt lgkmcnt(6)
    s_mov_b32 s44, 0xa204000
    buffer_store_dwordx4 v[40:43], v8, s[4:7], s44 offen sc1
    s_waitcnt lgkmcnt(5)
    s_mov_b32 s44, 0xa208000
    buffer_store_dwordx4 v[44:47], v8, s[4:7], s44 offen sc1
    s_waitcnt lgkmcnt(4)
    s_mov_b32 s44, 0xa20c000
    buffer_store_dwordx4 v[48:51], v8, s[4:7], s44 offen sc1
    s_waitcnt lgkmcnt(3)
    s_mov_b32 s44, 0xa210000
    buffer_store_dwordx4 v[52:55], v8, s[4:7], s44 offen sc1
    s_waitcnt lgkmcnt(2)
    s_mov_b32 s44, 0xa214000
    buffer_store_dwordx4 v[56:59], v8, s[4:7], s44 offen sc1
    s_waitcnt lgkmcnt(1)
    s_mov_b32 s44, 0xa218000
    buffer_store_dwordx4 v[60:63], v8, s[4:7], s44 offen sc1
    s_waitcnt lgkmcnt(0)
    s_mov_b32 s44, 0xa21c000
    buffer_store_dwordx4 v[64:67], v8, s[4:7], s44 offen sc1
    s_nop 1
    ds_read_b128 v[36:39], v10 offset:8192
    ds_read_b128 v[40:43], v10 offset:9216
    ds_read_b128 v[44:47], v10 offset:10240
    ds_read_b128 v[48:51], v10 offset:11264
    ds_read_b128 v[52:55], v10 offset:12288
    ds_read_b128 v[56:59], v10 offset:13312
    ds_read_b128 v[60:63], v10 offset:14336
    ds_read_b128 v[64:67], v10 offset:15360
    s_waitcnt lgkmcnt(7)
    s_mov_b32 s44, 0xa220000
    buffer_store_dwordx4 v[36:39], v8, s[4:7], s44 offen sc1
    s_waitcnt lgkmcnt(6)
    s_mov_b32 s44, 0xa224000
    buffer_store_dwordx4 v[40:43], v8, s[4:7], s44 offen sc1
    s_waitcnt lgkmcnt(5)
    s_mov_b32 s44, 0xa228000
    buffer_store_dwordx4 v[44:47], v8, s[4:7], s44 offen sc1
    s_waitcnt lgkmcnt(4)
    s_mov_b32 s44, 0xa22c000
    buffer_store_dwordx4 v[48:51], v8, s[4:7], s44 offen sc1
    s_waitcnt lgkmcnt(3)
    s_mov_b32 s44, 0xa230000
    buffer_store_dwordx4 v[52:55], v8, s[4:7], s44 offen sc1
    s_waitcnt lgkmcnt(2)
    s_mov_b32 s44, 0xa234000
    buffer_store_dwordx4 v[56:59], v8, s[4:7], s44 offen sc1
    s_waitcnt lgkmcnt(1)
    s_mov_b32 s44, 0xa238000
    buffer_store_dwordx4 v[60:63], v8, s[4:7], s44 offen sc1
    s_waitcnt lgkmcnt(0)
    s_mov_b32 s44, 0xa23c000
    buffer_store_dwordx4 v[64:67], v8, s[4:7], s44 offen sc1
    s_nop 1
    ds_read_b128 v[36:39], v11 offset:0
    ds_read_b128 v[40:43], v11 offset:1024
    ds_read_b128 v[44:47], v11 offset:2048
    ds_read_b128 v[48:51], v11 offset:3072
    ds_read_b128 v[52:55], v11 offset:4096
    ds_read_b128 v[56:59], v11 offset:5120
    ds_read_b128 v[60:63], v11 offset:6144
    ds_read_b128 v[64:67], v11 offset:7168
    s_waitcnt lgkmcnt(7)
    s_mov_b32 s44, 0xa201000
    buffer_store_dwordx4 v[36:39], v8, s[4:7], s44 offen sc1
    s_waitcnt lgkmcnt(6)
    s_mov_b32 s44, 0xa205000
    buffer_store_dwordx4 v[40:43], v8, s[4:7], s44 offen sc1
    s_waitcnt lgkmcnt(5)
    s_mov_b32 s44, 0xa209000
    buffer_store_dwordx4 v[44:47], v8, s[4:7], s44 offen sc1
    s_waitcnt lgkmcnt(4)
    s_mov_b32 s44, 0xa20d000
    buffer_store_dwordx4 v[48:51], v8, s[4:7], s44 offen sc1
    s_waitcnt lgkmcnt(3)
    s_mov_b32 s44, 0xa211000
    buffer_store_dwordx4 v[52:55], v8, s[4:7], s44 offen sc1
    s_waitcnt lgkmcnt(2)
    s_mov_b32 s44, 0xa215000
    buffer_store_dwordx4 v[56:59], v8, s[4:7], s44 offen sc1
    s_waitcnt lgkmcnt(1)
    s_mov_b32 s44, 0xa219000
    buffer_store_dwordx4 v[60:63], v8, s[4:7], s44 offen sc1
    s_waitcnt lgkmcnt(0)
    s_mov_b32 s44, 0xa21d000
    buffer_store_dwordx4 v[64:67], v8, s[4:7], s44 offen sc1
    s_nop 1
    ds_read_b128 v[36:39], v11 offset:8192
    ds_read_b128 v[40:43], v11 offset:9216
    ds_read_b128 v[44:47], v11 offset:10240
    ds_read_b128 v[48:51], v11 offset:11264
    ds_read_b128 v[52:55], v11 offset:12288
    ds_read_b128 v[56:59], v11 offset:13312
    ds_read_b128 v[60:63], v11 offset:14336
    ds_read_b128 v[64:67], v11 offset:15360
    s_waitcnt lgkmcnt(7)
    s_mov_b32 s44, 0xa221000
    buffer_store_dwordx4 v[36:39], v8, s[4:7], s44 offen sc1
    s_waitcnt lgkmcnt(6)
    s_mov_b32 s44, 0xa225000
    buffer_store_dwordx4 v[40:43], v8, s[4:7], s44 offen sc1
    s_waitcnt lgkmcnt(5)
    s_mov_b32 s44, 0xa229000
    buffer_store_dwordx4 v[44:47], v8, s[4:7], s44 offen sc1
    s_waitcnt lgkmcnt(4)
    s_mov_b32 s44, 0xa22d000
    buffer_store_dwordx4 v[48:51], v8, s[4:7], s44 offen sc1
    s_waitcnt lgkmcnt(3)
    s_mov_b32 s44, 0xa231000
    buffer_store_dwordx4 v[52:55], v8, s[4:7], s44 offen sc1
    s_waitcnt lgkmcnt(2)
    s_mov_b32 s44, 0xa235000
    buffer_store_dwordx4 v[56:59], v8, s[4:7], s44 offen sc1
    s_waitcnt lgkmcnt(1)
    s_mov_b32 s44, 0xa239000
    buffer_store_dwordx4 v[60:63], v8, s[4:7], s44 offen sc1
    s_waitcnt lgkmcnt(0)
    s_mov_b32 s44, 0xa23d000
    buffer_store_dwordx4 v[64:67], v8, s[4:7], s44 offen sc1
    s_nop 1
    s_mov_b32 s75, 0x8c23000
    s_waitcnt vmcnt(0)
    s_barrier
    s_cmp_lg_u32 s42, 0
    s_cbranch_scc1 Lsig_122
    s_mov_b64 exec, 1
    v_mov_b32 v4, 1
    v_mov_b32 v5, 0
    buffer_atomic_add v4, v5, s[4:7], s75 offen
    s_mov_b64 exec, -1
Lsig_122:
Lcs_117:
    s_mov_b32 s40, s71
    s_mov_b32 s41, s72
    s_mov_b32 s8, s24
    s_and_b32 s9, s25, 0xffff
    s_mov_b32 s10, 0x280000
    s_mov_b32 s11, 0x00020000
    s_mov_b32 s12, s30
    s_and_b32 s13, s31, 0xffff
    s_mov_b32 s14, 0x500000
    s_mov_b32 s15, 0x00020000
    s_mov_b32 s16, s32
    s_and_b32 s17, s33, 0xffff
    s_mov_b32 s18, 0x500000
    s_mov_b32 s19, 0x00020000
    s_mov_b32 s20, s34
    s_and_b32 s21, s35, 0xffff
    s_mov_b32 s22, 0x500000
    s_mov_b32 s23, 0x00020000
    s_and_b32 s44, s42, 1
    s_lshl_b32 s44, s44, 2
    v_or_b32 v6, s44, v3
    v_lshrrev_b32 v7, 1, v2
    v_xor_b32 v7, v7, v6
    v_and_b32 v8, 1, v2
    v_lshl_add_u32 v7, v7, 1, v8
    v_lshlrev_b32 v7, 4, v7
    v_mul_u32_u24 v8, 8192, v3
    v_add_u32 v7, v7, v8
    s_mul_i32 s44, s42, 65536
    s_lshl_b32 s45, s41, 8
    s_add_u32 s44, s44, s45
    v_add_u32 v9, s44, v7
    v_lshrrev_b32 v6, 2, v1
    v_mul_u32_u24 v6, 1280, v6
    v_and_b32 v7, 3, v1
    v_xor_b32 v7, v7, v3
    v_lshl_add_u32 v6, v7, 4, v6
    s_lshl_b32 s44, s40, 2
    s_add_u32 s44, s44, s42
    s_mul_i32 s44, s44, 81920
    v_add_u32 v10, s44, v6
    v_lshrrev_b32 v6, 2, v2
    v_and_b32 v7, 1, v3
    v_lshl_or_b32 v7, v7, 2, v6
    v_lshl_add_u32 v6, v3, 3, v6
    v_lshlrev_b32 v6, 8, v6
    v_and_b32 v8, 3, v2
    v_lshl_add_u32 v6, v8, 3, v6
    v_xor_b32 v8, 0, v7
    v_lshl_add_u32 v12, v8, 5, v6
    v_add_u32 v20, 0x10000, v12
    v_xor_b32 v8, 1, v7
    v_lshl_add_u32 v13, v8, 5, v6
    v_add_u32 v21, 0x10000, v13
    v_xor_b32 v8, 2, v7
    v_lshl_add_u32 v14, v8, 5, v6
    v_add_u32 v22, 0x10000, v14
    v_xor_b32 v8, 3, v7
    v_lshl_add_u32 v15, v8, 5, v6
    v_add_u32 v23, 0x10000, v15
    v_xor_b32 v8, 4, v7
    v_lshl_add_u32 v16, v8, 5, v6
    v_add_u32 v24, 0x10000, v16
    v_xor_b32 v8, 5, v7
    v_lshl_add_u32 v17, v8, 5, v6
    v_add_u32 v25, 0x10000, v17
    v_xor_b32 v8, 6, v7
    v_lshl_add_u32 v18, v8, 5, v6
    v_add_u32 v26, 0x10000, v18
    v_xor_b32 v8, 7, v7
    v_lshl_add_u32 v19, v8, 5, v6
    v_add_u32 v27, 0x10000, v19
    v_lshrrev_b32 v6, 2, v2
    v_xor_b32 v6, v6, v3
    v_lshlrev_b32 v6, 4, v6
    v_lshl_add_u32 v6, v2, 6, v6
    s_mul_i32 s44, s42, 4096
    s_add_u32 s44, s44, 16384
    v_add_u32 v28, s44, v6
    v_add_u32 v29, 0x10000, v28
    s_lshl_b32 s50, s42, 11
    s_mov_b32 s51, s44
    s_mov_b32 s46, 0
    s_mov_b32 s47, 0x140000
    s_mov_b32 s53, 0
    s_add_u32 m0, s50, 0
    s_add_u32 s52, s46, 0x0
    buffer_load_dwordx4 v9, s[12:15], s52 offen lds
    s_add_u32 m0, s50, 1024
    s_add_u32 s52, s46, 0x8000
    buffer_load_dwordx4 v9, s[12:15], s52 offen lds
    s_add_u32 m0, s50, 8192
    s_add_u32 s52, s46, 0x0
    buffer_load_dwordx4 v9, s[16:19], s52 offen lds
    s_add_u32 m0, s50, 9216
    s_add_u32 s52, s46, 0x8000
    buffer_load_dwordx4 v9, s[16:19], s52 offen lds
    s_add_u32 m0, s51, 0
    s_add_u32 s52, s47, 0
    buffer_load_dwordx4 v10, s[8:11], s52 offen lds
    s_add_u32 m0, s51, 1024
    s_add_u32 s52, s47, 20480
    buffer_load_dwordx4 v10, s[8:11], s52 offen lds
    s_add_u32 m0, s51, 2048
    s_add_u32 s52, s47, 40960
    buffer_load_dwordx4 v10, s[8:11], s52 offen lds
    s_add_u32 m0, s51, 3072
    s_add_u32 s52, s47, 61440
    buffer_load_dwordx4 v10, s[8:11], s52 offen lds
    s_add_u32 s46, s46, 262144
    s_add_u32 s47, s47, 64
    s_add_u32 m0, s50, 32768
    s_add_u32 s52, s46, 0x0
    buffer_load_dwordx4 v9, s[12:15], s52 offen lds
    s_add_u32 m0, s50, 33792
    s_add_u32 s52, s46, 0x8000
    buffer_load_dwordx4 v9, s[12:15], s52 offen lds
    s_add_u32 m0, s50, 40960
    s_add_u32 s52, s46, 0x0
    buffer_load_dwordx4 v9, s[16:19], s52 offen lds
    s_add_u32 m0, s50, 41984
    s_add_u32 s52, s46, 0x8000
    buffer_load_dwordx4 v9, s[16:19], s52 offen lds
    s_add_u32 m0, s51, 32768
    s_add_u32 s52, s47, 0
    buffer_load_dwordx4 v10, s[8:11], s52 offen lds
    s_add_u32 m0, s51, 33792
    s_add_u32 s52, s47, 20480
    buffer_load_dwordx4 v10, s[8:11], s52 offen lds
    s_add_u32 m0, s51, 34816
    s_add_u32 s52, s47, 40960
    buffer_load_dwordx4 v10, s[8:11], s52 offen lds
    s_add_u32 m0, s51, 35840
    s_add_u32 s52, s47, 61440
    buffer_load_dwordx4 v10, s[8:11], s52 offen lds
    s_add_u32 s46, s46, 262144
    s_add_u32 s47, s47, 64
    s_add_u32 m0, s50, 65536
    s_add_u32 s52, s46, 0x0
    buffer_load_dwordx4 v9, s[12:15], s52 offen lds
    s_add_u32 m0, s50, 66560
    s_add_u32 s52, s46, 0x8000
    buffer_load_dwordx4 v9, s[12:15], s52 offen lds
    s_add_u32 m0, s50, 73728
    s_add_u32 s52, s46, 0x0
    buffer_load_dwordx4 v9, s[16:19], s52 offen lds
    s_add_u32 m0, s50, 74752
    s_add_u32 s52, s46, 0x8000
    buffer_load_dwordx4 v9, s[16:19], s52 offen lds
    s_add_u32 m0, s51, 65536
    s_add_u32 s52, s47, 0
    buffer_load_dwordx4 v10, s[8:11], s52 offen lds
    s_add_u32 m0, s51, 66560
    s_add_u32 s52, s47, 20480
    buffer_load_dwordx4 v10, s[8:11], s52 offen lds
    s_add_u32 m0, s51, 67584
    s_add_u32 s52, s47, 40960
    buffer_load_dwordx4 v10, s[8:11], s52 offen lds
    s_add_u32 m0, s51, 68608
    s_add_u32 s52, s47, 61440
    buffer_load_dwordx4 v10, s[8:11], s52 offen lds
    s_add_u32 s46, s46, 262144
    s_add_u32 s47, s47, 64
    v_accvgpr_write_b32 a128, 0
    v_accvgpr_write_b32 a129, 0
    v_accvgpr_write_b32 a130, 0
    v_accvgpr_write_b32 a131, 0
    v_accvgpr_write_b32 a132, 0
    v_accvgpr_write_b32 a133, 0
    v_accvgpr_write_b32 a134, 0
    v_accvgpr_write_b32 a135, 0
    v_accvgpr_write_b32 a136, 0
    v_accvgpr_write_b32 a137, 0
    v_accvgpr_write_b32 a138, 0
    v_accvgpr_write_b32 a139, 0
    v_accvgpr_write_b32 a140, 0
    v_accvgpr_write_b32 a141, 0
    v_accvgpr_write_b32 a142, 0
    v_accvgpr_write_b32 a143, 0
    v_accvgpr_write_b32 a144, 0
    v_accvgpr_write_b32 a145, 0
    v_accvgpr_write_b32 a146, 0
    v_accvgpr_write_b32 a147, 0
    v_accvgpr_write_b32 a148, 0
    v_accvgpr_write_b32 a149, 0
    v_accvgpr_write_b32 a150, 0
    v_accvgpr_write_b32 a151, 0
    v_accvgpr_write_b32 a152, 0
    v_accvgpr_write_b32 a153, 0
    v_accvgpr_write_b32 a154, 0
    v_accvgpr_write_b32 a155, 0
    v_accvgpr_write_b32 a156, 0
    v_accvgpr_write_b32 a157, 0
    v_accvgpr_write_b32 a158, 0
    v_accvgpr_write_b32 a159, 0
    v_accvgpr_write_b32 a160, 0
    v_accvgpr_write_b32 a161, 0
    v_accvgpr_write_b32 a162, 0
    v_accvgpr_write_b32 a163, 0
    v_accvgpr_write_b32 a164, 0
    v_accvgpr_write_b32 a165, 0
    v_accvgpr_write_b32 a166, 0
    v_accvgpr_write_b32 a167, 0
    v_accvgpr_write_b32 a168, 0
    v_accvgpr_write_b32 a169, 0
    v_accvgpr_write_b32 a170, 0
    v_accvgpr_write_b32 a171, 0
    v_accvgpr_write_b32 a172, 0
    v_accvgpr_write_b32 a173, 0
    v_accvgpr_write_b32 a174, 0
    v_accvgpr_write_b32 a175, 0
    v_accvgpr_write_b32 a176, 0
    v_accvgpr_write_b32 a177, 0
    v_accvgpr_write_b32 a178, 0
    v_accvgpr_write_b32 a179, 0
    v_accvgpr_write_b32 a180, 0
    v_accvgpr_write_b32 a181, 0
    v_accvgpr_write_b32 a182, 0
    v_accvgpr_write_b32 a183, 0
    v_accvgpr_write_b32 a184, 0
    v_accvgpr_write_b32 a185, 0
    v_accvgpr_write_b32 a186, 0
    v_accvgpr_write_b32 a187, 0
    v_accvgpr_write_b32 a188, 0
    v_accvgpr_write_b32 a189, 0
    v_accvgpr_write_b32 a190, 0
    v_accvgpr_write_b32 a191, 0
    v_accvgpr_write_b32 a192, 0
    v_accvgpr_write_b32 a193, 0
    v_accvgpr_write_b32 a194, 0
    v_accvgpr_write_b32 a195, 0
    v_accvgpr_write_b32 a196, 0
    v_accvgpr_write_b32 a197, 0
    v_accvgpr_write_b32 a198, 0
    v_accvgpr_write_b32 a199, 0
    v_accvgpr_write_b32 a200, 0
    v_accvgpr_write_b32 a201, 0
    v_accvgpr_write_b32 a202, 0
    v_accvgpr_write_b32 a203, 0
    v_accvgpr_write_b32 a204, 0
    v_accvgpr_write_b32 a205, 0
    v_accvgpr_write_b32 a206, 0
    v_accvgpr_write_b32 a207, 0
    v_accvgpr_write_b32 a208, 0
    v_accvgpr_write_b32 a209, 0
    v_accvgpr_write_b32 a210, 0
    v_accvgpr_write_b32 a211, 0
    v_accvgpr_write_b32 a212, 0
    v_accvgpr_write_b32 a213, 0
    v_accvgpr_write_b32 a214, 0
    v_accvgpr_write_b32 a215, 0
    v_accvgpr_write_b32 a216, 0
    v_accvgpr_write_b32 a217, 0
    v_accvgpr_write_b32 a218, 0
    v_accvgpr_write_b32 a219, 0
    v_accvgpr_write_b32 a220, 0
    v_accvgpr_write_b32 a221, 0
    v_accvgpr_write_b32 a222, 0
    v_accvgpr_write_b32 a223, 0
    v_accvgpr_write_b32 a224, 0
    v_accvgpr_write_b32 a225, 0
    v_accvgpr_write_b32 a226, 0
    v_accvgpr_write_b32 a227, 0
    v_accvgpr_write_b32 a228, 0
    v_accvgpr_write_b32 a229, 0
    v_accvgpr_write_b32 a230, 0
    v_accvgpr_write_b32 a231, 0
    v_accvgpr_write_b32 a232, 0
    v_accvgpr_write_b32 a233, 0
    v_accvgpr_write_b32 a234, 0
    v_accvgpr_write_b32 a235, 0
    v_accvgpr_write_b32 a236, 0
    v_accvgpr_write_b32 a237, 0
    v_accvgpr_write_b32 a238, 0
    v_accvgpr_write_b32 a239, 0
    v_accvgpr_write_b32 a240, 0
    v_accvgpr_write_b32 a241, 0
    v_accvgpr_write_b32 a242, 0
    v_accvgpr_write_b32 a243, 0
    v_accvgpr_write_b32 a244, 0
    v_accvgpr_write_b32 a245, 0
    v_accvgpr_write_b32 a246, 0
    v_accvgpr_write_b32 a247, 0
    v_accvgpr_write_b32 a248, 0
    v_accvgpr_write_b32 a249, 0
    v_accvgpr_write_b32 a250, 0
    v_accvgpr_write_b32 a251, 0
    v_accvgpr_write_b32 a252, 0
    v_accvgpr_write_b32 a253, 0
    v_accvgpr_write_b32 a254, 0
    v_accvgpr_write_b32 a255, 0
    v_accvgpr_write_b32 a0, 0
    v_accvgpr_write_b32 a1, 0
    v_accvgpr_write_b32 a2, 0
    v_accvgpr_write_b32 a3, 0
    v_accvgpr_write_b32 a4, 0
    v_accvgpr_write_b32 a5, 0
    v_accvgpr_write_b32 a6, 0
    v_accvgpr_write_b32 a7, 0
    v_accvgpr_write_b32 a8, 0
    v_accvgpr_write_b32 a9, 0
    v_accvgpr_write_b32 a10, 0
    v_accvgpr_write_b32 a11, 0
    v_accvgpr_write_b32 a12, 0
    v_accvgpr_write_b32 a13, 0
    v_accvgpr_write_b32 a14, 0
    v_accvgpr_write_b32 a15, 0
    v_accvgpr_write_b32 a16, 0
    v_accvgpr_write_b32 a17, 0
    v_accvgpr_write_b32 a18, 0
    v_accvgpr_write_b32 a19, 0
    v_accvgpr_write_b32 a20, 0
    v_accvgpr_write_b32 a21, 0
    v_accvgpr_write_b32 a22, 0
    v_accvgpr_write_b32 a23, 0
    v_accvgpr_write_b32 a24, 0
    v_accvgpr_write_b32 a25, 0
    v_accvgpr_write_b32 a26, 0
    v_accvgpr_write_b32 a27, 0
    v_accvgpr_write_b32 a28, 0
    v_accvgpr_write_b32 a29, 0
    v_accvgpr_write_b32 a30, 0
    v_accvgpr_write_b32 a31, 0
    v_accvgpr_write_b32 a32, 0
    v_accvgpr_write_b32 a33, 0
    v_accvgpr_write_b32 a34, 0
    v_accvgpr_write_b32 a35, 0
    v_accvgpr_write_b32 a36, 0
    v_accvgpr_write_b32 a37, 0
    v_accvgpr_write_b32 a38, 0
    v_accvgpr_write_b32 a39, 0
    v_accvgpr_write_b32 a40, 0
    v_accvgpr_write_b32 a41, 0
    v_accvgpr_write_b32 a42, 0
    v_accvgpr_write_b32 a43, 0
    v_accvgpr_write_b32 a44, 0
    v_accvgpr_write_b32 a45, 0
    v_accvgpr_write_b32 a46, 0
    v_accvgpr_write_b32 a47, 0
    v_accvgpr_write_b32 a48, 0
    v_accvgpr_write_b32 a49, 0
    v_accvgpr_write_b32 a50, 0
    v_accvgpr_write_b32 a51, 0
    v_accvgpr_write_b32 a52, 0
    v_accvgpr_write_b32 a53, 0
    v_accvgpr_write_b32 a54, 0
    v_accvgpr_write_b32 a55, 0
    v_accvgpr_write_b32 a56, 0
    v_accvgpr_write_b32 a57, 0
    v_accvgpr_write_b32 a58, 0
    v_accvgpr_write_b32 a59, 0
    v_accvgpr_write_b32 a60, 0
    v_accvgpr_write_b32 a61, 0
    v_accvgpr_write_b32 a62, 0
    v_accvgpr_write_b32 a63, 0
    v_accvgpr_write_b32 a64, 0
    v_accvgpr_write_b32 a65, 0
    v_accvgpr_write_b32 a66, 0
    v_accvgpr_write_b32 a67, 0
    v_accvgpr_write_b32 a68, 0
    v_accvgpr_write_b32 a69, 0
    v_accvgpr_write_b32 a70, 0
    v_accvgpr_write_b32 a71, 0
    v_accvgpr_write_b32 a72, 0
    v_accvgpr_write_b32 a73, 0
    v_accvgpr_write_b32 a74, 0
    v_accvgpr_write_b32 a75, 0
    v_accvgpr_write_b32 a76, 0
    v_accvgpr_write_b32 a77, 0
    v_accvgpr_write_b32 a78, 0
    v_accvgpr_write_b32 a79, 0
    v_accvgpr_write_b32 a80, 0
    v_accvgpr_write_b32 a81, 0
    v_accvgpr_write_b32 a82, 0
    v_accvgpr_write_b32 a83, 0
    v_accvgpr_write_b32 a84, 0
    v_accvgpr_write_b32 a85, 0
    v_accvgpr_write_b32 a86, 0
    v_accvgpr_write_b32 a87, 0
    v_accvgpr_write_b32 a88, 0
    v_accvgpr_write_b32 a89, 0
    v_accvgpr_write_b32 a90, 0
    v_accvgpr_write_b32 a91, 0
    v_accvgpr_write_b32 a92, 0
    v_accvgpr_write_b32 a93, 0
    v_accvgpr_write_b32 a94, 0
    v_accvgpr_write_b32 a95, 0
    v_accvgpr_write_b32 a96, 0
    v_accvgpr_write_b32 a97, 0
    v_accvgpr_write_b32 a98, 0
    v_accvgpr_write_b32 a99, 0
    v_accvgpr_write_b32 a100, 0
    v_accvgpr_write_b32 a101, 0
    v_accvgpr_write_b32 a102, 0
    v_accvgpr_write_b32 a103, 0
    v_accvgpr_write_b32 a104, 0
    v_accvgpr_write_b32 a105, 0
    v_accvgpr_write_b32 a106, 0
    v_accvgpr_write_b32 a107, 0
    v_accvgpr_write_b32 a108, 0
    v_accvgpr_write_b32 a109, 0
    v_accvgpr_write_b32 a110, 0
    v_accvgpr_write_b32 a111, 0
    v_accvgpr_write_b32 a112, 0
    v_accvgpr_write_b32 a113, 0
    v_accvgpr_write_b32 a114, 0
    v_accvgpr_write_b32 a115, 0
    v_accvgpr_write_b32 a116, 0
    v_accvgpr_write_b32 a117, 0
    v_accvgpr_write_b32 a118, 0
    v_accvgpr_write_b32 a119, 0
    v_accvgpr_write_b32 a120, 0
    v_accvgpr_write_b32 a121, 0
    v_accvgpr_write_b32 a122, 0
    v_accvgpr_write_b32 a123, 0
    v_accvgpr_write_b32 a124, 0
    v_accvgpr_write_b32 a125, 0
    v_accvgpr_write_b32 a126, 0
    v_accvgpr_write_b32 a127, 0
    s_waitcnt vmcnt(16)
    s_barrier
    ds_read_b128 v[32:35], v28 offset:0
    ds_read_b128 v[36:39], v28 offset:1024
    ds_read_b128 v[40:43], v28 offset:2048
    ds_read_b128 v[44:47], v28 offset:3072
    ds_read_b64_tr_b16 v[64:65], v12 offset:0
    ds_read_b64_tr_b16 v[66:67], v12 offset:1024
    ds_read_b64_tr_b16 v[68:69], v13 offset:0
    ds_read_b64_tr_b16 v[70:71], v13 offset:1024
    s_mov_b32 s43, 0
Lpg_123:
    ds_read_b64_tr_b16 v[72:73], v14 offset:0
    ds_read_b64_tr_b16 v[74:75], v14 offset:1024
    s_waitcnt lgkmcnt(6)
    s_waitcnt lgkmcnt(4)
    v_mfma_f32_16x16x32_bf16 a[128:131], v[64:67], v[32:35], a[128:131]
    v_mfma_f32_16x16x32_bf16 a[132:135], v[64:67], v[36:39], a[132:135]
    v_mfma_f32_16x16x32_bf16 a[136:139], v[64:67], v[40:43], a[136:139]
    v_mfma_f32_16x16x32_bf16 a[140:143], v[64:67], v[44:47], a[140:143]
    ds_read_b64_tr_b16 v[76:77], v15 offset:0
    ds_read_b64_tr_b16 v[78:79], v15 offset:1024
    s_waitcnt lgkmcnt(4)
    v_mfma_f32_16x16x32_bf16 a[144:147], v[68:71], v[32:35], a[144:147]
    v_mfma_f32_16x16x32_bf16 a[148:151], v[68:71], v[36:39], a[148:151]
    v_mfma_f32_16x16x32_bf16 a[152:155], v[68:71], v[40:43], a[152:155]
    v_mfma_f32_16x16x32_bf16 a[156:159], v[68:71], v[44:47], a[156:159]
    ds_read_b64_tr_b16 v[64:65], v16 offset:0
    ds_read_b64_tr_b16 v[66:67], v16 offset:1024
    s_waitcnt lgkmcnt(4)
    v_mfma_f32_16x16x32_bf16 a[160:163], v[72:75], v[32:35], a[160:163]
    v_mfma_f32_16x16x32_bf16 a[164:167], v[72:75], v[36:39], a[164:167]
    v_mfma_f32_16x16x32_bf16 a[168:171], v[72:75], v[40:43], a[168:171]
    v_mfma_f32_16x16x32_bf16 a[172:175], v[72:75], v[44:47], a[172:175]
    ds_read_b64_tr_b16 v[68:69], v17 offset:0
    ds_read_b64_tr_b16 v[70:71], v17 offset:1024
    s_waitcnt lgkmcnt(4)
    v_mfma_f32_16x16x32_bf16 a[176:179], v[76:79], v[32:35], a[176:179]
    v_mfma_f32_16x16x32_bf16 a[180:183], v[76:79], v[36:39], a[180:183]
    v_mfma_f32_16x16x32_bf16 a[184:187], v[76:79], v[40:43], a[184:187]
    v_mfma_f32_16x16x32_bf16 a[188:191], v[76:79], v[44:47], a[188:191]
    ds_read_b64_tr_b16 v[72:73], v18 offset:0
    ds_read_b64_tr_b16 v[74:75], v18 offset:1024
    s_waitcnt lgkmcnt(4)
    v_mfma_f32_16x16x32_bf16 a[192:195], v[64:67], v[32:35], a[192:195]
    v_mfma_f32_16x16x32_bf16 a[196:199], v[64:67], v[36:39], a[196:199]
    v_mfma_f32_16x16x32_bf16 a[200:203], v[64:67], v[40:43], a[200:203]
    v_mfma_f32_16x16x32_bf16 a[204:207], v[64:67], v[44:47], a[204:207]
    ds_read_b64_tr_b16 v[76:77], v19 offset:0
    ds_read_b64_tr_b16 v[78:79], v19 offset:1024
    s_waitcnt lgkmcnt(4)
    v_mfma_f32_16x16x32_bf16 a[208:211], v[68:71], v[32:35], a[208:211]
    v_mfma_f32_16x16x32_bf16 a[212:215], v[68:71], v[36:39], a[212:215]
    v_mfma_f32_16x16x32_bf16 a[216:219], v[68:71], v[40:43], a[216:219]
    v_mfma_f32_16x16x32_bf16 a[220:223], v[68:71], v[44:47], a[220:223]
    ds_read_b64_tr_b16 v[64:65], v12 offset:8192
    ds_read_b64_tr_b16 v[66:67], v12 offset:9216
    s_waitcnt lgkmcnt(4)
    v_mfma_f32_16x16x32_bf16 a[224:227], v[72:75], v[32:35], a[224:227]
    v_mfma_f32_16x16x32_bf16 a[228:231], v[72:75], v[36:39], a[228:231]
    v_mfma_f32_16x16x32_bf16 a[232:235], v[72:75], v[40:43], a[232:235]
    v_mfma_f32_16x16x32_bf16 a[236:239], v[72:75], v[44:47], a[236:239]
    ds_read_b64_tr_b16 v[68:69], v13 offset:8192
    ds_read_b64_tr_b16 v[70:71], v13 offset:9216
    s_waitcnt lgkmcnt(4)
    v_mfma_f32_16x16x32_bf16 a[240:243], v[76:79], v[32:35], a[240:243]
    v_mfma_f32_16x16x32_bf16 a[244:247], v[76:79], v[36:39], a[244:247]
    v_mfma_f32_16x16x32_bf16 a[248:251], v[76:79], v[40:43], a[248:251]
    v_mfma_f32_16x16x32_bf16 a[252:255], v[76:79], v[44:47], a[252:255]
    s_waitcnt vmcnt(8)
    s_barrier
    ds_read_b64_tr_b16 v[72:73], v14 offset:8192
    ds_read_b64_tr_b16 v[74:75], v14 offset:9216
    s_waitcnt lgkmcnt(4)
    v_mfma_f32_16x16x32_bf16 a[0:3], v[64:67], v[32:35], a[0:3]
    v_mfma_f32_16x16x32_bf16 a[4:7], v[64:67], v[36:39], a[4:7]
    s_add_u32 m0, s50, 98304
    s_add_u32 s52, s46, 0x0
    buffer_load_dwordx4 v9, s[12:15], s52 offen lds
    v_mfma_f32_16x16x32_bf16 a[8:11], v[64:67], v[40:43], a[8:11]
    v_mfma_f32_16x16x32_bf16 a[12:15], v[64:67], v[44:47], a[12:15]
    ds_read_b64_tr_b16 v[76:77], v15 offset:8192
    ds_read_b64_tr_b16 v[78:79], v15 offset:9216
    s_waitcnt lgkmcnt(4)
    v_mfma_f32_16x16x32_bf16 a[16:19], v[68:71], v[32:35], a[16:19]
    v_mfma_f32_16x16x32_bf16 a[20:23], v[68:71], v[36:39], a[20:23]
    s_add_u32 m0, s50, 99328
    s_add_u32 s52, s46, 0x8000
    buffer_load_dwordx4 v9, s[12:15], s52 offen lds
    v_mfma_f32_16x16x32_bf16 a[24:27], v[68:71], v[40:43], a[24:27]
    v_mfma_f32_16x16x32_bf16 a[28:31], v[68:71], v[44:47], a[28:31]
    ds_read_b64_tr_b16 v[64:65], v16 offset:8192
    ds_read_b64_tr_b16 v[66:67], v16 offset:9216
    s_waitcnt lgkmcnt(4)
    v_mfma_f32_16x16x32_bf16 a[32:35], v[72:75], v[32:35], a[32:35]
    v_mfma_f32_16x16x32_bf16 a[36:39], v[72:75], v[36:39], a[36:39]
    s_add_u32 m0, s50, 106496
    s_add_u32 s52, s46, 0x0
    buffer_load_dwordx4 v9, s[16:19], s52 offen lds
    v_mfma_f32_16x16x32_bf16 a[40:43], v[72:75], v[40:43], a[40:43]
    v_mfma_f32_16x16x32_bf16 a[44:47], v[72:75], v[44:47], a[44:47]
    ds_read_b64_tr_b16 v[68:69], v17 offset:8192
    ds_read_b64_tr_b16 v[70:71], v17 offset:9216
    s_waitcnt lgkmcnt(4)
    v_mfma_f32_16x16x32_bf16 a[48:51], v[76:79], v[32:35], a[48:51]
    v_mfma_f32_16x16x32_bf16 a[52:55], v[76:79], v[36:39], a[52:55]
    s_add_u32 m0, s50, 107520
    s_add_u32 s52, s46, 0x8000
    buffer_load_dwordx4 v9, s[16:19], s52 offen lds
    v_mfma_f32_16x16x32_bf16 a[56:59], v[76:79], v[40:43], a[56:59]
    v_mfma_f32_16x16x32_bf16 a[60:63], v[76:79], v[44:47], a[60:63]
    ds_read_b64_tr_b16 v[72:73], v18 offset:8192
    ds_read_b64_tr_b16 v[74:75], v18 offset:9216
    s_waitcnt lgkmcnt(4)
    v_mfma_f32_16x16x32_bf16 a[64:67], v[64:67], v[32:35], a[64:67]
    v_mfma_f32_16x16x32_bf16 a[68:71], v[64:67], v[36:39], a[68:71]
    s_add_u32 m0, s51, 98304
    s_add_u32 s52, s47, 0
    buffer_load_dwordx4 v10, s[8:11], s52 offen lds
    v_mfma_f32_16x16x32_bf16 a[72:75], v[64:67], v[40:43], a[72:75]
    v_mfma_f32_16x16x32_bf16 a[76:79], v[64:67], v[44:47], a[76:79]
    ds_read_b64_tr_b16 v[76:77], v19 offset:8192
    ds_read_b64_tr_b16 v[78:79], v19 offset:9216
    s_waitcnt lgkmcnt(4)
    v_mfma_f32_16x16x32_bf16 a[80:83], v[68:71], v[32:35], a[80:83]
    v_mfma_f32_16x16x32_bf16 a[84:87], v[68:71], v[36:39], a[84:87]
    s_add_u32 m0, s51, 99328
    s_add_u32 s52, s47, 20480
    buffer_load_dwordx4 v10, s[8:11], s52 offen lds
    v_mfma_f32_16x16x32_bf16 a[88:91], v[68:71], v[40:43], a[88:91]
    v_mfma_f32_16x16x32_bf16 a[92:95], v[68:71], v[44:47], a[92:95]
    ds_read_b128 v[48:51], v28 offset:32768
    ds_read_b128 v[52:55], v28 offset:33792
    ds_read_b128 v[56:59], v28 offset:34816
    ds_read_b128 v[60:63], v28 offset:35840
    ds_read_b64_tr_b16 v[64:65], v12 offset:32768
    ds_read_b64_tr_b16 v[66:67], v12 offset:33792
    s_waitcnt lgkmcnt(8)
    v_mfma_f32_16x16x32_bf16 a[96:99], v[72:75], v[32:35], a[96:99]
    v_mfma_f32_16x16x32_bf16 a[100:103], v[72:75], v[36:39], a[100:103]
    s_add_u32 m0, s51, 100352
    s_add_u32 s52, s47, 40960
    buffer_load_dwordx4 v10, s[8:11], s52 offen lds
    v_mfma_f32_16x16x32_bf16 a[104:107], v[72:75], v[40:43], a[104:107]
    v_mfma_f32_16x16x32_bf16 a[108:111], v[72:75], v[44:47], a[108:111]
    ds_read_b64_tr_b16 v[68:69], v13 offset:32768
    ds_read_b64_tr_b16 v[70:71], v13 offset:33792
    s_waitcnt lgkmcnt(8)
    v_mfma_f32_16x16x32_bf16 a[112:115], v[76:79], v[32:35], a[112:115]
    v_mfma_f32_16x16x32_bf16 a[116:119], v[76:79], v[36:39], a[116:119]
    s_add_u32 m0, s51, 101376
    s_add_u32 s52, s47, 61440
    buffer_load_dwordx4 v10, s[8:11], s52 offen lds
    v_mfma_f32_16x16x32_bf16 a[120:123], v[76:79], v[40:43], a[120:123]
    v_mfma_f32_16x16x32_bf16 a[124:127], v[76:79], v[44:47], a[124:127]
    s_add_u32 s46, s46, 262144
    s_add_u32 s47, s47, 64
    ds_read_b64_tr_b16 v[72:73], v14 offset:32768
    ds_read_b64_tr_b16 v[74:75], v14 offset:33792
    s_waitcnt lgkmcnt(6)
    s_waitcnt lgkmcnt(4)
    v_mfma_f32_16x16x32_bf16 a[128:131], v[64:67], v[48:51], a[128:131]
    v_mfma_f32_16x16x32_bf16 a[132:135], v[64:67], v[52:55], a[132:135]
    v_mfma_f32_16x16x32_bf16 a[136:139], v[64:67], v[56:59], a[136:139]
    v_mfma_f32_16x16x32_bf16 a[140:143], v[64:67], v[60:63], a[140:143]
    ds_read_b64_tr_b16 v[76:77], v15 offset:32768
    ds_read_b64_tr_b16 v[78:79], v15 offset:33792
    s_waitcnt lgkmcnt(4)
    v_mfma_f32_16x16x32_bf16 a[144:147], v[68:71], v[48:51], a[144:147]
    v_mfma_f32_16x16x32_bf16 a[148:151], v[68:71], v[52:55], a[148:151]
    v_mfma_f32_16x16x32_bf16 a[152:155], v[68:71], v[56:59], a[152:155]
    v_mfma_f32_16x16x32_bf16 a[156:159], v[68:71], v[60:63], a[156:159]
    ds_read_b64_tr_b16 v[64:65], v16 offset:32768
    ds_read_b64_tr_b16 v[66:67], v16 offset:33792
    s_waitcnt lgkmcnt(4)
    v_mfma_f32_16x16x32_bf16 a[160:163], v[72:75], v[48:51], a[160:163]
    v_mfma_f32_16x16x32_bf16 a[164:167], v[72:75], v[52:55], a[164:167]
    v_mfma_f32_16x16x32_bf16 a[168:171], v[72:75], v[56:59], a[168:171]
    v_mfma_f32_16x16x32_bf16 a[172:175], v[72:75], v[60:63], a[172:175]
    ds_read_b64_tr_b16 v[68:69], v17 offset:32768
    ds_read_b64_tr_b16 v[70:71], v17 offset:33792
    s_waitcnt lgkmcnt(4)
    v_mfma_f32_16x16x32_bf16 a[176:179], v[76:79], v[48:51], a[176:179]
    v_mfma_f32_16x16x32_bf16 a[180:183], v[76:79], v[52:55], a[180:183]
    v_mfma_f32_16x16x32_bf16 a[184:187], v[76:79], v[56:59], a[184:187]
    v_mfma_f32_16x16x32_bf16 a[188:191], v[76:79], v[60:63], a[188:191]
    ds_read_b64_tr_b16 v[72:73], v18 offset:32768
    ds_read_b64_tr_b16 v[74:75], v18 offset:33792
    s_waitcnt lgkmcnt(4)
    v_mfma_f32_16x16x32_bf16 a[192:195], v[64:67], v[48:51], a[192:195]
    v_mfma_f32_16x16x32_bf16 a[196:199], v[64:67], v[52:55], a[196:199]
    v_mfma_f32_16x16x32_bf16 a[200:203], v[64:67], v[56:59], a[200:203]
    v_mfma_f32_16x16x32_bf16 a[204:207], v[64:67], v[60:63], a[204:207]
    ds_read_b64_tr_b16 v[76:77], v19 offset:32768
    ds_read_b64_tr_b16 v[78:79], v19 offset:33792
    s_waitcnt lgkmcnt(4)
    v_mfma_f32_16x16x32_bf16 a[208:211], v[68:71], v[48:51], a[208:211]
    v_mfma_f32_16x16x32_bf16 a[212:215], v[68:71], v[52:55], a[212:215]
    v_mfma_f32_16x16x32_bf16 a[216:219], v[68:71], v[56:59], a[216:219]
    v_mfma_f32_16x16x32_bf16 a[220:223], v[68:71], v[60:63], a[220:223]
    ds_read_b64_tr_b16 v[64:65], v12 offset:40960
    ds_read_b64_tr_b16 v[66:67], v12 offset:41984
    s_waitcnt lgkmcnt(4)
    v_mfma_f32_16x16x32_bf16 a[224:227], v[72:75], v[48:51], a[224:227]
    v_mfma_f32_16x16x32_bf16 a[228:231], v[72:75], v[52:55], a[228:231]
    v_mfma_f32_16x16x32_bf16 a[232:235], v[72:75], v[56:59], a[232:235]
    v_mfma_f32_16x16x32_bf16 a[236:239], v[72:75], v[60:63], a[236:239]
    ds_read_b64_tr_b16 v[68:69], v13 offset:40960
    ds_read_b64_tr_b16 v[70:71], v13 offset:41984
    s_waitcnt lgkmcnt(4)
    v_mfma_f32_16x16x32_bf16 a[240:243], v[76:79], v[48:51], a[240:243]
    v_mfma_f32_16x16x32_bf16 a[244:247], v[76:79], v[52:55], a[244:247]
    v_mfma_f32_16x16x32_bf16 a[248:251], v[76:79], v[56:59], a[248:251]
    v_mfma_f32_16x16x32_bf16 a[252:255], v[76:79], v[60:63], a[252:255]
    s_waitcnt vmcnt(8)
    s_barrier
    ds_read_b64_tr_b16 v[72:73], v14 offset:40960
    ds_read_b64_tr_b16 v[74:75], v14 offset:41984
    s_waitcnt lgkmcnt(4)
    v_mfma_f32_16x16x32_bf16 a[0:3], v[64:67], v[48:51], a[0:3]
    v_mfma_f32_16x16x32_bf16 a[4:7], v[64:67], v[52:55], a[4:7]
    s_add_u32 m0, s50, 0
    s_add_u32 s52, s46, 0x0
    buffer_load_dwordx4 v9, s[12:15], s52 offen lds
    v_mfma_f32_16x16x32_bf16 a[8:11], v[64:67], v[56:59], a[8:11]
    v_mfma_f32_16x16x32_bf16 a[12:15], v[64:67], v[60:63], a[12:15]
    ds_read_b64_tr_b16 v[76:77], v15 offset:40960
    ds_read_b64_tr_b16 v[78:79], v15 offset:41984
    s_waitcnt lgkmcnt(4)
    v_mfma_f32_16x16x32_bf16 a[16:19], v[68:71], v[48:51], a[16:19]
    v_mfma_f32_16x16x32_bf16 a[20:23], v[68:71], v[52:55], a[20:23]
    s_add_u32 m0, s50, 1024
    s_add_u32 s52, s46, 0x8000
    buffer_load_dwordx4 v9, s[12:15], s52 offen lds
    v_mfma_f32_16x16x32_bf16 a[24:27], v[68:71], v[56:59], a[24:27]
    v_mfma_f32_16x16x32_bf16 a[28:31], v[68:71], v[60:63], a[28:31]
    ds_read_b64_tr_b16 v[64:65], v16 offset:40960
    ds_read_b64_tr_b16 v[66:67], v16 offset:41984
    s_waitcnt lgkmcnt(4)
    v_mfma_f32_16x16x32_bf16 a[32:35], v[72:75], v[48:51], a[32:35]
    v_mfma_f32_16x16x32_bf16 a[36:39], v[72:75], v[52:55], a[36:39]
    s_add_u32 m0, s50, 8192
    s_add_u32 s52, s46, 0x0
    buffer_load_dwordx4 v9, s[16:19], s52 offen lds
    v_mfma_f32_16x16x32_bf16 a[40:43], v[72:75], v[56:59], a[40:43]
    v_mfma_f32_16x16x32_bf16 a[44:47], v[72:75], v[60:63], a[44:47]
    ds_read_b64_tr_b16 v[68:69], v17 offset:40960
    ds_read_b64_tr_b16 v[70:71], v17 offset:41984
    s_waitcnt lgkmcnt(4)
    v_mfma_f32_16x16x32_bf16 a[48:51], v[76:79], v[48:51], a[48:51]
    v_mfma_f32_16x16x32_bf16 a[52:55], v[76:79], v[52:55], a[52:55]
    s_add_u32 m0, s50, 9216
    s_add_u32 s52, s46, 0x8000
    buffer_load_dwordx4 v9, s[16:19], s52 offen lds
    v_mfma_f32_16x16x32_bf16 a[56:59], v[76:79], v[56:59], a[56:59]
    v_mfma_f32_16x16x32_bf16 a[60:63], v[76:79], v[60:63], a[60:63]
    ds_read_b64_tr_b16 v[72:73], v18 offset:40960
    ds_read_b64_tr_b16 v[74:75], v18 offset:41984
    s_waitcnt lgkmcnt(4)
    v_mfma_f32_16x16x32_bf16 a[64:67], v[64:67], v[48:51], a[64:67]
    v_mfma_f32_16x16x32_bf16 a[68:71], v[64:67], v[52:55], a[68:71]
    s_add_u32 m0, s51, 0
    s_add_u32 s52, s47, 0
    buffer_load_dwordx4 v10, s[8:11], s52 offen lds
    v_mfma_f32_16x16x32_bf16 a[72:75], v[64:67], v[56:59], a[72:75]
    v_mfma_f32_16x16x32_bf16 a[76:79], v[64:67], v[60:63], a[76:79]
    ds_read_b64_tr_b16 v[76:77], v19 offset:40960
    ds_read_b64_tr_b16 v[78:79], v19 offset:41984
    s_waitcnt lgkmcnt(4)
    v_mfma_f32_16x16x32_bf16 a[80:83], v[68:71], v[48:51], a[80:83]
    v_mfma_f32_16x16x32_bf16 a[84:87], v[68:71], v[52:55], a[84:87]
    s_add_u32 m0, s51, 1024
    s_add_u32 s52, s47, 20480
    buffer_load_dwordx4 v10, s[8:11], s52 offen lds
    v_mfma_f32_16x16x32_bf16 a[88:91], v[68:71], v[56:59], a[88:91]
    v_mfma_f32_16x16x32_bf16 a[92:95], v[68:71], v[60:63], a[92:95]
    ds_read_b128 v[32:35], v29 offset:0
    ds_read_b128 v[36:39], v29 offset:1024
    ds_read_b128 v[40:43], v29 offset:2048
    ds_read_b128 v[44:47], v29 offset:3072
    ds_read_b64_tr_b16 v[64:65], v20 offset:0
    ds_read_b64_tr_b16 v[66:67], v20 offset:1024
    s_waitcnt lgkmcnt(8)
    v_mfma_f32_16x16x32_bf16 a[96:99], v[72:75], v[48:51], a[96:99]
    v_mfma_f32_16x16x32_bf16 a[100:103], v[72:75], v[52:55], a[100:103]
    s_add_u32 m0, s51, 2048
    s_add_u32 s52, s47, 40960
    buffer_load_dwordx4 v10, s[8:11], s52 offen lds
    v_mfma_f32_16x16x32_bf16 a[104:107], v[72:75], v[56:59], a[104:107]
    v_mfma_f32_16x16x32_bf16 a[108:111], v[72:75], v[60:63], a[108:111]
    ds_read_b64_tr_b16 v[68:69], v21 offset:0
    ds_read_b64_tr_b16 v[70:71], v21 offset:1024
    s_waitcnt lgkmcnt(8)
    v_mfma_f32_16x16x32_bf16 a[112:115], v[76:79], v[48:51], a[112:115]
    v_mfma_f32_16x16x32_bf16 a[116:119], v[76:79], v[52:55], a[116:119]
    s_add_u32 m0, s51, 3072
    s_add_u32 s52, s47, 61440
    buffer_load_dwordx4 v10, s[8:11], s52 offen lds
    v_mfma_f32_16x16x32_bf16 a[120:123], v[76:79], v[56:59], a[120:123]
    v_mfma_f32_16x16x32_bf16 a[124:127], v[76:79], v[60:63], a[124:127]
    s_add_u32 s46, s46, 262144
    s_add_u32 s47, s47, 64
    ds_read_b64_tr_b16 v[72:73], v22 offset:0
    ds_read_b64_tr_b16 v[74:75], v22 offset:1024
    s_waitcnt lgkmcnt(6)
    s_waitcnt lgkmcnt(4)
    v_mfma_f32_16x16x32_bf16 a[128:131], v[64:67], v[32:35], a[128:131]
    v_mfma_f32_16x16x32_bf16 a[132:135], v[64:67], v[36:39], a[132:135]
    v_mfma_f32_16x16x32_bf16 a[136:139], v[64:67], v[40:43], a[136:139]
    v_mfma_f32_16x16x32_bf16 a[140:143], v[64:67], v[44:47], a[140:143]
    ds_read_b64_tr_b16 v[76:77], v23 offset:0
    ds_read_b64_tr_b16 v[78:79], v23 offset:1024
    s_waitcnt lgkmcnt(4)
    v_mfma_f32_16x16x32_bf16 a[144:147], v[68:71], v[32:35], a[144:147]
    v_mfma_f32_16x16x32_bf16 a[148:151], v[68:71], v[36:39], a[148:151]
    v_mfma_f32_16x16x32_bf16 a[152:155], v[68:71], v[40:43], a[152:155]
    v_mfma_f32_16x16x32_bf16 a[156:159], v[68:71], v[44:47], a[156:159]
    ds_read_b64_tr_b16 v[64:65], v24 offset:0
    ds_read_b64_tr_b16 v[66:67], v24 offset:1024
    s_waitcnt lgkmcnt(4)
    v_mfma_f32_16x16x32_bf16 a[160:163], v[72:75], v[32:35], a[160:163]
    v_mfma_f32_16x16x32_bf16 a[164:167], v[72:75], v[36:39], a[164:167]
    v_mfma_f32_16x16x32_bf16 a[168:171], v[72:75], v[40:43], a[168:171]
    v_mfma_f32_16x16x32_bf16 a[172:175], v[72:75], v[44:47], a[172:175]
    ds_read_b64_tr_b16 v[68:69], v25 offset:0
    ds_read_b64_tr_b16 v[70:71], v25 offset:1024
    s_waitcnt lgkmcnt(4)
    v_mfma_f32_16x16x32_bf16 a[176:179], v[76:79], v[32:35], a[176:179]
    v_mfma_f32_16x16x32_bf16 a[180:183], v[76:79], v[36:39], a[180:183]
    v_mfma_f32_16x16x32_bf16 a[184:187], v[76:79], v[40:43], a[184:187]
    v_mfma_f32_16x16x32_bf16 a[188:191], v[76:79], v[44:47], a[188:191]
    ds_read_b64_tr_b16 v[72:73], v26 offset:0
    ds_read_b64_tr_b16 v[74:75], v26 offset:1024
    s_waitcnt lgkmcnt(4)
    v_mfma_f32_16x16x32_bf16 a[192:195], v[64:67], v[32:35], a[192:195]
    v_mfma_f32_16x16x32_bf16 a[196:199], v[64:67], v[36:39], a[196:199]
    v_mfma_f32_16x16x32_bf16 a[200:203], v[64:67], v[40:43], a[200:203]
    v_mfma_f32_16x16x32_bf16 a[204:207], v[64:67], v[44:47], a[204:207]
    ds_read_b64_tr_b16 v[76:77], v27 offset:0
    ds_read_b64_tr_b16 v[78:79], v27 offset:1024
    s_waitcnt lgkmcnt(4)
    v_mfma_f32_16x16x32_bf16 a[208:211], v[68:71], v[32:35], a[208:211]
    v_mfma_f32_16x16x32_bf16 a[212:215], v[68:71], v[36:39], a[212:215]
    v_mfma_f32_16x16x32_bf16 a[216:219], v[68:71], v[40:43], a[216:219]
    v_mfma_f32_16x16x32_bf16 a[220:223], v[68:71], v[44:47], a[220:223]
    ds_read_b64_tr_b16 v[64:65], v20 offset:8192
    ds_read_b64_tr_b16 v[66:67], v20 offset:9216
    s_waitcnt lgkmcnt(4)
    v_mfma_f32_16x16x32_bf16 a[224:227], v[72:75], v[32:35], a[224:227]
    v_mfma_f32_16x16x32_bf16 a[228:231], v[72:75], v[36:39], a[228:231]
    v_mfma_f32_16x16x32_bf16 a[232:235], v[72:75], v[40:43], a[232:235]
    v_mfma_f32_16x16x32_bf16 a[236:239], v[72:75], v[44:47], a[236:239]
    ds_read_b64_tr_b16 v[68:69], v21 offset:8192
    ds_read_b64_tr_b16 v[70:71], v21 offset:9216
    s_waitcnt lgkmcnt(4)
    v_mfma_f32_16x16x32_bf16 a[240:243], v[76:79], v[32:35], a[240:243]
    v_mfma_f32_16x16x32_bf16 a[244:247], v[76:79], v[36:39], a[244:247]
    v_mfma_f32_16x16x32_bf16 a[248:251], v[76:79], v[40:43], a[248:251]
    v_mfma_f32_16x16x32_bf16 a[252:255], v[76:79], v[44:47], a[252:255]
    s_waitcnt vmcnt(8)
    s_barrier
    ds_read_b64_tr_b16 v[72:73], v22 offset:8192
    ds_read_b64_tr_b16 v[74:75], v22 offset:9216
    s_waitcnt lgkmcnt(4)
    v_mfma_f32_16x16x32_bf16 a[0:3], v[64:67], v[32:35], a[0:3]
    v_mfma_f32_16x16x32_bf16 a[4:7], v[64:67], v[36:39], a[4:7]
    s_add_u32 m0, s50, 32768
    s_add_u32 s52, s46, 0x0
    buffer_load_dwordx4 v9, s[12:15], s52 offen lds
    v_mfma_f32_16x16x32_bf16 a[8:11], v[64:67], v[40:43], a[8:11]
    v_mfma_f32_16x16x32_bf16 a[12:15], v[64:67], v[44:47], a[12:15]
    ds_read_b64_tr_b16 v[76:77], v23 offset:8192
    ds_read_b64_tr_b16 v[78:79], v23 offset:9216
    s_waitcnt lgkmcnt(4)
    v_mfma_f32_16x16x32_bf16 a[16:19], v[68:71], v[32:35], a[16:19]
    v_mfma_f32_16x16x32_bf16 a[20:23], v[68:71], v[36:39], a[20:23]
    s_add_u32 m0, s50, 33792
    s_add_u32 s52, s46, 0x8000
    buffer_load_dwordx4 v9, s[12:15], s52 offen lds
    v_mfma_f32_16x16x32_bf16 a[24:27], v[68:71], v[40:43], a[24:27]
    v_mfma_f32_16x16x32_bf16 a[28:31], v[68:71], v[44:47], a[28:31]
    ds_read_b64_tr_b16 v[64:65], v24 offset:8192
    ds_read_b64_tr_b16 v[66:67], v24 offset:9216
    s_waitcnt lgkmcnt(4)
    v_mfma_f32_16x16x32_bf16 a[32:35], v[72:75], v[32:35], a[32:35]
    v_mfma_f32_16x16x32_bf16 a[36:39], v[72:75], v[36:39], a[36:39]
    s_add_u32 m0, s50, 40960
    s_add_u32 s52, s46, 0x0
    buffer_load_dwordx4 v9, s[16:19], s52 offen lds
    v_mfma_f32_16x16x32_bf16 a[40:43], v[72:75], v[40:43], a[40:43]
    v_mfma_f32_16x16x32_bf16 a[44:47], v[72:75], v[44:47], a[44:47]
    ds_read_b64_tr_b16 v[68:69], v25 offset:8192
    ds_read_b64_tr_b16 v[70:71], v25 offset:9216
    s_waitcnt lgkmcnt(4)
    v_mfma_f32_16x16x32_bf16 a[48:51], v[76:79], v[32:35], a[48:51]
    v_mfma_f32_16x16x32_bf16 a[52:55], v[76:79], v[36:39], a[52:55]
    s_add_u32 m0, s50, 41984
    s_add_u32 s52, s46, 0x8000
    buffer_load_dwordx4 v9, s[16:19], s52 offen lds
    v_mfma_f32_16x16x32_bf16 a[56:59], v[76:79], v[40:43], a[56:59]
    v_mfma_f32_16x16x32_bf16 a[60:63], v[76:79], v[44:47], a[60:63]
    ds_read_b64_tr_b16 v[72:73], v26 offset:8192
    ds_read_b64_tr_b16 v[74:75], v26 offset:9216
    s_waitcnt lgkmcnt(4)
    v_mfma_f32_16x16x32_bf16 a[64:67], v[64:67], v[32:35], a[64:67]
    v_mfma_f32_16x16x32_bf16 a[68:71], v[64:67], v[36:39], a[68:71]
    s_add_u32 m0, s51, 32768
    s_add_u32 s52, s47, 0
    buffer_load_dwordx4 v10, s[8:11], s52 offen lds
    v_mfma_f32_16x16x32_bf16 a[72:75], v[64:67], v[40:43], a[72:75]
    v_mfma_f32_16x16x32_bf16 a[76:79], v[64:67], v[44:47], a[76:79]
    ds_read_b64_tr_b16 v[76:77], v27 offset:8192
    ds_read_b64_tr_b16 v[78:79], v27 offset:9216
    s_waitcnt lgkmcnt(4)
    v_mfma_f32_16x16x32_bf16 a[80:83], v[68:71], v[32:35], a[80:83]
    v_mfma_f32_16x16x32_bf16 a[84:87], v[68:71], v[36:39], a[84:87]
    s_add_u32 m0, s51, 33792
    s_add_u32 s52, s47, 20480
    buffer_load_dwordx4 v10, s[8:11], s52 offen lds
    v_mfma_f32_16x16x32_bf16 a[88:91], v[68:71], v[40:43], a[88:91]
    v_mfma_f32_16x16x32_bf16 a[92:95], v[68:71], v[44:47], a[92:95]
    ds_read_b128 v[48:51], v29 offset:32768
    ds_read_b128 v[52:55], v29 offset:33792
    ds_read_b128 v[56:59], v29 offset:34816
    ds_read_b128 v[60:63], v29 offset:35840
    ds_read_b64_tr_b16 v[64:65], v20 offset:32768
    ds_read_b64_tr_b16 v[66:67], v20 offset:33792
    s_waitcnt lgkmcnt(8)
    v_mfma_f32_16x16x32_bf16 a[96:99], v[72:75], v[32:35], a[96:99]
    v_mfma_f32_16x16x32_bf16 a[100:103], v[72:75], v[36:39], a[100:103]
    s_add_u32 m0, s51, 34816
    s_add_u32 s52, s47, 40960
    buffer_load_dwordx4 v10, s[8:11], s52 offen lds
    v_mfma_f32_16x16x32_bf16 a[104:107], v[72:75], v[40:43], a[104:107]
    v_mfma_f32_16x16x32_bf16 a[108:111], v[72:75], v[44:47], a[108:111]
    ds_read_b64_tr_b16 v[68:69], v21 offset:32768
    ds_read_b64_tr_b16 v[70:71], v21 offset:33792
    s_waitcnt lgkmcnt(8)
    v_mfma_f32_16x16x32_bf16 a[112:115], v[76:79], v[32:35], a[112:115]
    v_mfma_f32_16x16x32_bf16 a[116:119], v[76:79], v[36:39], a[116:119]
    s_add_u32 m0, s51, 35840
    s_add_u32 s52, s47, 61440
    buffer_load_dwordx4 v10, s[8:11], s52 offen lds
    v_mfma_f32_16x16x32_bf16 a[120:123], v[76:79], v[40:43], a[120:123]
    v_mfma_f32_16x16x32_bf16 a[124:127], v[76:79], v[44:47], a[124:127]
    s_add_u32 s46, s46, 262144
    s_add_u32 s47, s47, 64
    ds_read_b64_tr_b16 v[72:73], v22 offset:32768
    ds_read_b64_tr_b16 v[74:75], v22 offset:33792
    s_waitcnt lgkmcnt(6)
    s_waitcnt lgkmcnt(4)
    v_mfma_f32_16x16x32_bf16 a[128:131], v[64:67], v[48:51], a[128:131]
    v_mfma_f32_16x16x32_bf16 a[132:135], v[64:67], v[52:55], a[132:135]
    v_mfma_f32_16x16x32_bf16 a[136:139], v[64:67], v[56:59], a[136:139]
    v_mfma_f32_16x16x32_bf16 a[140:143], v[64:67], v[60:63], a[140:143]
    ds_read_b64_tr_b16 v[76:77], v23 offset:32768
    ds_read_b64_tr_b16 v[78:79], v23 offset:33792
    s_waitcnt lgkmcnt(4)
    v_mfma_f32_16x16x32_bf16 a[144:147], v[68:71], v[48:51], a[144:147]
    v_mfma_f32_16x16x32_bf16 a[148:151], v[68:71], v[52:55], a[148:151]
    v_mfma_f32_16x16x32_bf16 a[152:155], v[68:71], v[56:59], a[152:155]
    v_mfma_f32_16x16x32_bf16 a[156:159], v[68:71], v[60:63], a[156:159]
    ds_read_b64_tr_b16 v[64:65], v24 offset:32768
    ds_read_b64_tr_b16 v[66:67], v24 offset:33792
    s_waitcnt lgkmcnt(4)
    v_mfma_f32_16x16x32_bf16 a[160:163], v[72:75], v[48:51], a[160:163]
    v_mfma_f32_16x16x32_bf16 a[164:167], v[72:75], v[52:55], a[164:167]
    v_mfma_f32_16x16x32_bf16 a[168:171], v[72:75], v[56:59], a[168:171]
    v_mfma_f32_16x16x32_bf16 a[172:175], v[72:75], v[60:63], a[172:175]
    ds_read_b64_tr_b16 v[68:69], v25 offset:32768
    ds_read_b64_tr_b16 v[70:71], v25 offset:33792
    s_waitcnt lgkmcnt(4)
    v_mfma_f32_16x16x32_bf16 a[176:179], v[76:79], v[48:51], a[176:179]
    v_mfma_f32_16x16x32_bf16 a[180:183], v[76:79], v[52:55], a[180:183]
    v_mfma_f32_16x16x32_bf16 a[184:187], v[76:79], v[56:59], a[184:187]
    v_mfma_f32_16x16x32_bf16 a[188:191], v[76:79], v[60:63], a[188:191]
    ds_read_b64_tr_b16 v[72:73], v26 offset:32768
    ds_read_b64_tr_b16 v[74:75], v26 offset:33792
    s_waitcnt lgkmcnt(4)
    v_mfma_f32_16x16x32_bf16 a[192:195], v[64:67], v[48:51], a[192:195]
    v_mfma_f32_16x16x32_bf16 a[196:199], v[64:67], v[52:55], a[196:199]
    v_mfma_f32_16x16x32_bf16 a[200:203], v[64:67], v[56:59], a[200:203]
    v_mfma_f32_16x16x32_bf16 a[204:207], v[64:67], v[60:63], a[204:207]
    ds_read_b64_tr_b16 v[76:77], v27 offset:32768
    ds_read_b64_tr_b16 v[78:79], v27 offset:33792
    s_waitcnt lgkmcnt(4)
    v_mfma_f32_16x16x32_bf16 a[208:211], v[68:71], v[48:51], a[208:211]
    v_mfma_f32_16x16x32_bf16 a[212:215], v[68:71], v[52:55], a[212:215]
    v_mfma_f32_16x16x32_bf16 a[216:219], v[68:71], v[56:59], a[216:219]
    v_mfma_f32_16x16x32_bf16 a[220:223], v[68:71], v[60:63], a[220:223]
    ds_read_b64_tr_b16 v[64:65], v20 offset:40960
    ds_read_b64_tr_b16 v[66:67], v20 offset:41984
    s_waitcnt lgkmcnt(4)
    v_mfma_f32_16x16x32_bf16 a[224:227], v[72:75], v[48:51], a[224:227]
    v_mfma_f32_16x16x32_bf16 a[228:231], v[72:75], v[52:55], a[228:231]
    v_mfma_f32_16x16x32_bf16 a[232:235], v[72:75], v[56:59], a[232:235]
    v_mfma_f32_16x16x32_bf16 a[236:239], v[72:75], v[60:63], a[236:239]
    ds_read_b64_tr_b16 v[68:69], v21 offset:40960
    ds_read_b64_tr_b16 v[70:71], v21 offset:41984
    s_waitcnt lgkmcnt(4)
    v_mfma_f32_16x16x32_bf16 a[240:243], v[76:79], v[48:51], a[240:243]
    v_mfma_f32_16x16x32_bf16 a[244:247], v[76:79], v[52:55], a[244:247]
    v_mfma_f32_16x16x32_bf16 a[248:251], v[76:79], v[56:59], a[248:251]
    v_mfma_f32_16x16x32_bf16 a[252:255], v[76:79], v[60:63], a[252:255]
    s_waitcnt vmcnt(8)
    s_barrier
    ds_read_b64_tr_b16 v[72:73], v22 offset:40960
    ds_read_b64_tr_b16 v[74:75], v22 offset:41984
    s_waitcnt lgkmcnt(4)
    v_mfma_f32_16x16x32_bf16 a[0:3], v[64:67], v[48:51], a[0:3]
    v_mfma_f32_16x16x32_bf16 a[4:7], v[64:67], v[52:55], a[4:7]
    s_add_u32 m0, s50, 65536
    s_add_u32 s52, s46, 0x0
    buffer_load_dwordx4 v9, s[12:15], s52 offen lds
    v_mfma_f32_16x16x32_bf16 a[8:11], v[64:67], v[56:59], a[8:11]
    v_mfma_f32_16x16x32_bf16 a[12:15], v[64:67], v[60:63], a[12:15]
    ds_read_b64_tr_b16 v[76:77], v23 offset:40960
    ds_read_b64_tr_b16 v[78:79], v23 offset:41984
    s_waitcnt lgkmcnt(4)
    v_mfma_f32_16x16x32_bf16 a[16:19], v[68:71], v[48:51], a[16:19]
    v_mfma_f32_16x16x32_bf16 a[20:23], v[68:71], v[52:55], a[20:23]
    s_add_u32 m0, s50, 66560
    s_add_u32 s52, s46, 0x8000
    buffer_load_dwordx4 v9, s[12:15], s52 offen lds
    v_mfma_f32_16x16x32_bf16 a[24:27], v[68:71], v[56:59], a[24:27]
    v_mfma_f32_16x16x32_bf16 a[28:31], v[68:71], v[60:63], a[28:31]
    ds_read_b64_tr_b16 v[64:65], v24 offset:40960
    ds_read_b64_tr_b16 v[66:67], v24 offset:41984
    s_waitcnt lgkmcnt(4)
    v_mfma_f32_16x16x32_bf16 a[32:35], v[72:75], v[48:51], a[32:35]
    v_mfma_f32_16x16x32_bf16 a[36:39], v[72:75], v[52:55], a[36:39]
    s_add_u32 m0, s50, 73728
    s_add_u32 s52, s46, 0x0
    buffer_load_dwordx4 v9, s[16:19], s52 offen lds
    v_mfma_f32_16x16x32_bf16 a[40:43], v[72:75], v[56:59], a[40:43]
    v_mfma_f32_16x16x32_bf16 a[44:47], v[72:75], v[60:63], a[44:47]
    ds_read_b64_tr_b16 v[68:69], v25 offset:40960
    ds_read_b64_tr_b16 v[70:71], v25 offset:41984
    s_waitcnt lgkmcnt(4)
    v_mfma_f32_16x16x32_bf16 a[48:51], v[76:79], v[48:51], a[48:51]
    v_mfma_f32_16x16x32_bf16 a[52:55], v[76:79], v[52:55], a[52:55]
    s_add_u32 m0, s50, 74752
    s_add_u32 s52, s46, 0x8000
    buffer_load_dwordx4 v9, s[16:19], s52 offen lds
    v_mfma_f32_16x16x32_bf16 a[56:59], v[76:79], v[56:59], a[56:59]
    v_mfma_f32_16x16x32_bf16 a[60:63], v[76:79], v[60:63], a[60:63]
    ds_read_b64_tr_b16 v[72:73], v26 offset:40960
    ds_read_b64_tr_b16 v[74:75], v26 offset:41984
    s_waitcnt lgkmcnt(4)
    v_mfma_f32_16x16x32_bf16 a[64:67], v[64:67], v[48:51], a[64:67]
    v_mfma_f32_16x16x32_bf16 a[68:71], v[64:67], v[52:55], a[68:71]
    s_add_u32 m0, s51, 65536
    s_add_u32 s52, s47, 0
    buffer_load_dwordx4 v10, s[8:11], s52 offen lds
    v_mfma_f32_16x16x32_bf16 a[72:75], v[64:67], v[56:59], a[72:75]
    v_mfma_f32_16x16x32_bf16 a[76:79], v[64:67], v[60:63], a[76:79]
    ds_read_b64_tr_b16 v[76:77], v27 offset:40960
    ds_read_b64_tr_b16 v[78:79], v27 offset:41984
    s_waitcnt lgkmcnt(4)
    v_mfma_f32_16x16x32_bf16 a[80:83], v[68:71], v[48:51], a[80:83]
    v_mfma_f32_16x16x32_bf16 a[84:87], v[68:71], v[52:55], a[84:87]
    s_add_u32 m0, s51, 66560
    s_add_u32 s52, s47, 20480
    buffer_load_dwordx4 v10, s[8:11], s52 offen lds
    v_mfma_f32_16x16x32_bf16 a[88:91], v[68:71], v[56:59], a[88:91]
    v_mfma_f32_16x16x32_bf16 a[92:95], v[68:71], v[60:63], a[92:95]
    ds_read_b128 v[32:35], v28 offset:0
    ds_read_b128 v[36:39], v28 offset:1024
    ds_read_b128 v[40:43], v28 offset:2048
    ds_read_b128 v[44:47], v28 offset:3072
    ds_read_b64_tr_b16 v[64:65], v12 offset:0
    ds_read_b64_tr_b16 v[66:67], v12 offset:1024
    s_waitcnt lgkmcnt(8)
    v_mfma_f32_16x16x32_bf16 a[96:99], v[72:75], v[48:51], a[96:99]
    v_mfma_f32_16x16x32_bf16 a[100:103], v[72:75], v[52:55], a[100:103]
    s_add_u32 m0, s51, 67584
    s_add_u32 s52, s47, 40960
    buffer_load_dwordx4 v10, s[8:11], s52 offen lds
    v_mfma_f32_16x16x32_bf16 a[104:107], v[72:75], v[56:59], a[104:107]
    v_mfma_f32_16x16x32_bf16 a[108:111], v[72:75], v[60:63], a[108:111]
    ds_read_b64_tr_b16 v[68:69], v13 offset:0
    ds_read_b64_tr_b16 v[70:71], v13 offset:1024
    s_waitcnt lgkmcnt(8)
    v_mfma_f32_16x16x32_bf16 a[112:115], v[76:79], v[48:51], a[112:115]
    v_mfma_f32_16x16x32_bf16 a[116:119], v[76:79], v[52:55], a[116:119]
    s_add_u32 m0, s51, 68608
    s_add_u32 s52, s47, 61440
    buffer_load_dwordx4 v10, s[8:11], s52 offen lds
    v_mfma_f32_16x16x32_bf16 a[120:123], v[76:79], v[56:59], a[120:123]
    v_mfma_f32_16x16x32_bf16 a[124:127], v[76:79], v[60:63], a[124:127]
    s_add_u32 s46, s46, 262144
    s_add_u32 s47, s47, 64
    s_add_u32 s43, s43, 1
    s_cmp_lt_u32 s43, 5
    s_cbranch_scc1 Lpg_123
    s_waitcnt vmcnt(0) lgkmcnt(0)
    s_barrier
    s_nop 3
    v_or_b32 v6, 0, v3
    v_lshrrev_b32 v7, 1, v2
    v_xor_b32 v7, v7, v6
    v_and_b32 v8, 1, v2
    v_lshl_add_u32 v7, v7, 1, v8
    v_lshlrev_b32 v7, 4, v7
    v_mul_u32_u24 v8, 1280, v3
    v_add_u32 v7, v7, v8
    s_lshl_b32 s44, s41, 7
    s_lshl_b32 s45, s42, 5
    s_add_u32 s44, s44, s45
    s_mul_i32 s44, s44, 1280
    v_add_u32 v9, s44, v7
    v_or_b32 v6, 4, v3
    v_lshrrev_b32 v7, 1, v2
    v_xor_b32 v7, v7, v6
    v_and_b32 v8, 1, v2
    v_lshl_add_u32 v7, v7, 1, v8
    v_lshlrev_b32 v7, 4, v7
    v_mul_u32_u24 v8, 1280, v3
    v_add_u32 v7, v7, v8
    s_lshl_b32 s44, s41, 7
    s_lshl_b32 s45, s42, 5
    s_add_u32 s44, s44, s45
    s_mul_i32 s44, s44, 1280
    v_add_u32 v10, s44, v7
    s_lshl_b32 s50, s42, 13
    s_add_u32 m0, s50, 0
    s_mov_b32 s52, 0
    buffer_load_dwordx4 v9, s[20:23], s52 offen lds
    s_add_u32 m0, s50, 1024
    s_mov_b32 s52, 5120
    buffer_load_dwordx4 v10, s[20:23], s52 offen lds
    s_add_u32 m0, s50, 2048
    s_mov_b32 s52, 10240
    buffer_load_dwordx4 v9, s[20:23], s52 offen lds
    s_add_u32 m0, s50, 3072
    s_mov_b32 s52, 15360
    buffer_load_dwordx4 v10, s[20:23], s52 offen lds
    s_add_u32 m0, s50, 4096
    s_mov_b32 s52, 20480
    buffer_load_dwordx4 v9, s[20:23], s52 offen lds
    s_add_u32 m0, s50, 5120
    s_mov_b32 s52, 25600
    buffer_load_dwordx4 v10, s[20:23], s52 offen lds
    s_add_u32 m0, s50, 6144
    s_mov_b32 s52, 30720
    buffer_load_dwordx4 v9, s[20:23], s52 offen lds
    s_add_u32 m0, s50, 7168
    s_mov_b32 s52, 35840
    buffer_load_dwordx4 v10, s[20:23], s52 offen lds
    s_add_u32 m0, s50, 32768
    s_mov_b32 s52, 256
    buffer_load_dwordx4 v9, s[20:23], s52 offen lds
    s_add_u32 m0, s50, 33792
    s_mov_b32 s52, 5376
    buffer_load_dwordx4 v10, s[20:23], s52 offen lds
    s_add_u32 m0, s50, 34816
    s_mov_b32 s52, 10496
    buffer_load_dwordx4 v9, s[20:23], s52 offen lds
    s_add_u32 m0, s50, 35840
    s_mov_b32 s52, 15616
    buffer_load_dwordx4 v10, s[20:23], s52 offen lds
    s_add_u32 m0, s50, 36864
    s_mov_b32 s52, 20736
    buffer_load_dwordx4 v9, s[20:23], s52 offen lds
    s_add_u32 m0, s50, 37888
    s_mov_b32 s52, 25856
    buffer_load_dwordx4 v10, s[20:23], s52 offen lds
    s_add_u32 m0, s50, 38912
    s_mov_b32 s52, 30976
    buffer_load_dwordx4 v9, s[20:23], s52 offen lds
    s_add_u32 m0, s50, 39936
    s_mov_b32 s52, 36096
    buffer_load_dwordx4 v10, s[20:23], s52 offen lds
    s_add_u32 m0, s50, 65536
    s_mov_b32 s52, 512
    buffer_load_dwordx4 v9, s[20:23], s52 offen lds
    s_add_u32 m0, s50, 66560
    s_mov_b32 s52, 5632
    buffer_load_dwordx4 v10, s[20:23], s52 offen lds
    s_add_u32 m0, s50, 67584
    s_mov_b32 s52, 10752
    buffer_load_dwordx4 v9, s[20:23], s52 offen lds
    s_add_u32 m0, s50, 68608
    s_mov_b32 s52, 15872
    buffer_load_dwordx4 v10, s[20:23], s52 offen lds
    s_add_u32 m0, s50, 69632
    s_mov_b32 s52, 20992
    buffer_load_dwordx4 v9, s[20:23], s52 offen lds
    s_add_u32 m0, s50, 70656
    s_mov_b32 s52, 26112
    buffer_load_dwordx4 v10, s[20:23], s52 offen lds
    s_add_u32 m0, s50, 71680
    s_mov_b32 s52, 31232
    buffer_load_dwordx4 v9, s[20:23], s52 offen lds
    s_add_u32 m0, s50, 72704
    s_mov_b32 s52, 36352
    buffer_load_dwordx4 v10, s[20:23], s52 offen lds
    s_add_u32 m0, s50, 98304
    s_mov_b32 s52, 768
    buffer_load_dwordx4 v9, s[20:23], s52 offen lds
    s_add_u32 m0, s50, 99328
    s_mov_b32 s52, 5888
    buffer_load_dwordx4 v10, s[20:23], s52 offen lds
    s_add_u32 m0, s50, 100352
    s_mov_b32 s52, 11008
    buffer_load_dwordx4 v9, s[20:23], s52 offen lds
    s_add_u32 m0, s50, 101376
    s_mov_b32 s52, 16128
    buffer_load_dwordx4 v10, s[20:23], s52 offen lds
    s_add_u32 m0, s50, 102400
    s_mov_b32 s52, 21248
    buffer_load_dwordx4 v9, s[20:23], s52 offen lds
    s_add_u32 m0, s50, 103424
    s_mov_b32 s52, 26368
    buffer_load_dwordx4 v10, s[20:23], s52 offen lds
    s_add_u32 m0, s50, 104448
    s_mov_b32 s52, 31488
    buffer_load_dwordx4 v9, s[20:23], s52 offen lds
    s_add_u32 m0, s50, 105472
    s_mov_b32 s52, 36608
    buffer_load_dwordx4 v10, s[20:23], s52 offen lds
    v_lshrrev_b32 v6, 2, v2
    v_lshl_add_u32 v6, v3, 2, v6
    v_and_b32 v7, 7, v6
    v_lshlrev_b32 v6, 8, v6
    v_and_b32 v8, 3, v2
    v_lshl_add_u32 v6, v8, 3, v6
    v_xor_b32 v8, 0, v7
    v_lshl_add_u32 v12, v8, 5, v6
    v_add_u32 v20, 0x10000, v12
    v_xor_b32 v8, 1, v7
    v_lshl_add_u32 v13, v8, 5, v6
    v_add_u32 v21, 0x10000, v13
    v_xor_b32 v8, 2, v7
    v_lshl_add_u32 v14, v8, 5, v6
    v_add_u32 v22, 0x10000, v14
    v_xor_b32 v8, 3, v7
    v_lshl_add_u32 v15, v8, 5, v6
    v_add_u32 v23, 0x10000, v15
    v_xor_b32 v8, 4, v7
    v_lshl_add_u32 v16, v8, 5, v6
    v_add_u32 v24, 0x10000, v16
    v_xor_b32 v8, 5, v7
    v_lshl_add_u32 v17, v8, 5, v6
    v_add_u32 v25, 0x10000, v17
    v_xor_b32 v8, 6, v7
    v_lshl_add_u32 v18, v8, 5, v6
    v_add_u32 v26, 0x10000, v18
    v_xor_b32 v8, 7, v7
    v_lshl_add_u32 v19, v8, 5, v6
    v_add_u32 v27, 0x10000, v19
    s_lshl_b32 s44, s40, 2
    s_add_u32 s44, s44, s42
    s_mul_i32 s44, s44, 64
    s_add_u32 s44, s44, s41
    s_add_u32 s44, s44, 1024
    s_lshl_b32 s48, s44, 13
    v_lshlrev_b32 v28, 4, v1
    v_add_u32 v28, s48, v28
    s_mul_i32 s48, s44, 40960
    v_and_b32 v6, 7, v2
    v_lshl_add_u32 v6, v3, 3, v6
    v_lshlrev_b32 v6, 4, v6
    v_lshrrev_b32 v7, 3, v2
    v_lshl_add_u32 v6, v7, 9, v6
    v_add_u32 v29, s48, v6
    v_accvgpr_read_b32 v32, a128
    v_accvgpr_read_b32 v33, a129
    v_accvgpr_read_b32 v34, a130
    v_accvgpr_read_b32 v35, a131
    v_cvt_pk_bf16_f32 v40, v32, v33
    v_cvt_pk_bf16_f32 v41, v34, v35
    v_accvgpr_read_b32 v36, a144
    v_accvgpr_read_b32 v37, a145
    v_accvgpr_read_b32 v38, a146
    v_accvgpr_read_b32 v39, a147
    v_cvt_pk_bf16_f32 v42, v36, v37
    v_cvt_pk_bf16_f32 v43, v38, v39
    s_mov_b32 s45, 0x0
    buffer_store_dwordx4 v[40:43], v28, s[4:7], s45 offen sc1
    v_accvgpr_read_b32 v32, a160
    v_accvgpr_read_b32 v33, a161
    v_accvgpr_read_b32 v34, a162
    v_accvgpr_read_b32 v35, a163
    v_cvt_pk_bf16_f32 v44, v32, v33
    v_cvt_pk_bf16_f32 v45, v34, v35
    v_accvgpr_read_b32 v36, a176
    v_accvgpr_read_b32 v37, a177
    v_accvgpr_read_b32 v38, a178
    v_accvgpr_read_b32 v39, a179
    v_cvt_pk_bf16_f32 v46, v36, v37
    v_cvt_pk_bf16_f32 v47, v38, v39
    s_mov_b32 s45, 0x400
    buffer_store_dwordx4 v[44:47], v28, s[4:7], s45 offen sc1
    v_accvgpr_read_b32 v32, a192
    v_accvgpr_read_b32 v33, a193
    v_accvgpr_read_b32 v34, a194
    v_accvgpr_read_b32 v35, a195
    v_cvt_pk_bf16_f32 v48, v32, v33
    v_cvt_pk_bf16_f32 v49, v34, v35
    v_accvgpr_read_b32 v36, a208
    v_accvgpr_read_b32 v37, a209
    v_accvgpr_read_b32 v38, a210
    v_accvgpr_read_b32 v39, a211
    v_cvt_pk_bf16_f32 v50, v36, v37
    v_cvt_pk_bf16_f32 v51, v38, v39
    s_mov_b32 s45, 0x800
    buffer_store_dwordx4 v[48:51], v28, s[4:7], s45 offen sc1
    v_accvgpr_read_b32 v32, a224
    v_accvgpr_read_b32 v33, a225
    v_accvgpr_read_b32 v34, a226
    v_accvgpr_read_b32 v35, a227
    v_cvt_pk_bf16_f32 v52, v32, v33
    v_cvt_pk_bf16_f32 v53, v34, v35
    v_accvgpr_read_b32 v36, a240
    v_accvgpr_read_b32 v37, a241
    v_accvgpr_read_b32 v38, a242
    v_accvgpr_read_b32 v39, a243
    v_cvt_pk_bf16_f32 v54, v36, v37
    v_cvt_pk_bf16_f32 v55, v38, v39
    s_mov_b32 s45, 0xc00
    buffer_store_dwordx4 v[52:55], v28, s[4:7], s45 offen sc1
    v_accvgpr_read_b32 v32, a132
    v_accvgpr_read_b32 v33, a133
    v_accvgpr_read_b32 v34, a134
    v_accvgpr_read_b32 v35, a135
    v_cvt_pk_bf16_f32 v56, v32, v33
    v_cvt_pk_bf16_f32 v57, v34, v35
    v_accvgpr_read_b32 v36, a148
    v_accvgpr_read_b32 v37, a149
    v_accvgpr_read_b32 v38, a150
    v_accvgpr_read_b32 v39, a151
    v_cvt_pk_bf16_f32 v58, v36, v37
    v_cvt_pk_bf16_f32 v59, v38, v39
    s_mov_b32 s45, 0x1000
    buffer_store_dwordx4 v[56:59], v28, s[4:7], s45 offen sc1
    v_accvgpr_read_b32 v32, a164
    v_accvgpr_read_b32 v33, a165
    v_accvgpr_read_b32 v34, a166
    v_accvgpr_read_b32 v35, a167
    v_cvt_pk_bf16_f32 v60, v32, v33
    v_cvt_pk_bf16_f32 v61, v34, v35
    v_accvgpr_read_b32 v36, a180
    v_accvgpr_read_b32 v37, a181
    v_accvgpr_read_b32 v38, a182
    v_accvgpr_read_b32 v39, a183
    v_cvt_pk_bf16_f32 v62, v36, v37
    v_cvt_pk_bf16_f32 v63, v38, v39
    s_mov_b32 s45, 0x1400
    buffer_store_dwordx4 v[60:63], v28, s[4:7], s45 offen sc1
    v_accvgpr_read_b32 v32, a196
    v_accvgpr_read_b32 v33, a197
    v_accvgpr_read_b32 v34, a198
    v_accvgpr_read_b32 v35, a199
    v_cvt_pk_bf16_f32 v64, v32, v33
    v_cvt_pk_bf16_f32 v65, v34, v35
    v_accvgpr_read_b32 v36, a212
    v_accvgpr_read_b32 v37, a213
    v_accvgpr_read_b32 v38, a214
    v_accvgpr_read_b32 v39, a215
    v_cvt_pk_bf16_f32 v66, v36, v37
    v_cvt_pk_bf16_f32 v67, v38, v39
    s_mov_b32 s45, 0x1800
    buffer_store_dwordx4 v[64:67], v28, s[4:7], s45 offen sc1
    v_accvgpr_read_b32 v32, a228
    v_accvgpr_read_b32 v33, a229
    v_accvgpr_read_b32 v34, a230
    v_accvgpr_read_b32 v35, a231
    v_cvt_pk_bf16_f32 v68, v32, v33
    v_cvt_pk_bf16_f32 v69, v34, v35
    v_accvgpr_read_b32 v36, a244
    v_accvgpr_read_b32 v37, a245
    v_accvgpr_read_b32 v38, a246
    v_accvgpr_read_b32 v39, a247
    v_cvt_pk_bf16_f32 v70, v36, v37
    v_cvt_pk_bf16_f32 v71, v38, v39
    s_mov_b32 s45, 0x1c00
    buffer_store_dwordx4 v[68:71], v28, s[4:7], s45 offen sc1
    v_accvgpr_read_b32 v32, a136
    v_accvgpr_read_b32 v33, a137
    v_accvgpr_read_b32 v34, a138
    v_accvgpr_read_b32 v35, a139
    v_cvt_pk_bf16_f32 v40, v32, v33
    v_cvt_pk_bf16_f32 v41, v34, v35
    v_accvgpr_read_b32 v36, a152
    v_accvgpr_read_b32 v37, a153
    v_accvgpr_read_b32 v38, a154
    v_accvgpr_read_b32 v39, a155
    v_cvt_pk_bf16_f32 v42, v36, v37
    v_cvt_pk_bf16_f32 v43, v38, v39
    s_mov_b32 s45, 0x40000
    buffer_store_dwordx4 v[40:43], v28, s[4:7], s45 offen sc1
    v_accvgpr_read_b32 v32, a168
    v_accvgpr_read_b32 v33, a169
    v_accvgpr_read_b32 v34, a170
    v_accvgpr_read_b32 v35, a171
    v_cvt_pk_bf16_f32 v44, v32, v33
    v_cvt_pk_bf16_f32 v45, v34, v35
    v_accvgpr_read_b32 v36, a184
    v_accvgpr_read_b32 v37, a185
    v_accvgpr_read_b32 v38, a186
    v_accvgpr_read_b32 v39, a187
    v_cvt_pk_bf16_f32 v46, v36, v37
    v_cvt_pk_bf16_f32 v47, v38, v39
    s_mov_b32 s45, 0x40400
    buffer_store_dwordx4 v[44:47], v28, s[4:7], s45 offen sc1
    v_accvgpr_read_b32 v32, a200
    v_accvgpr_read_b32 v33, a201
    v_accvgpr_read_b32 v34, a202
    v_accvgpr_read_b32 v35, a203
    v_cvt_pk_bf16_f32 v48, v32, v33
    v_cvt_pk_bf16_f32 v49, v34, v35
    v_accvgpr_read_b32 v36, a216
    v_accvgpr_read_b32 v37, a217
    v_accvgpr_read_b32 v38, a218
    v_accvgpr_read_b32 v39, a219
    v_cvt_pk_bf16_f32 v50, v36, v37
    v_cvt_pk_bf16_f32 v51, v38, v39
    s_mov_b32 s45, 0x40800
    buffer_store_dwordx4 v[48:51], v28, s[4:7], s45 offen sc1
    v_accvgpr_read_b32 v32, a232
    v_accvgpr_read_b32 v33, a233
    v_accvgpr_read_b32 v34, a234
    v_accvgpr_read_b32 v35, a235
    v_cvt_pk_bf16_f32 v52, v32, v33
    v_cvt_pk_bf16_f32 v53, v34, v35
    v_accvgpr_read_b32 v36, a248
    v_accvgpr_read_b32 v37, a249
    v_accvgpr_read_b32 v38, a250
    v_accvgpr_read_b32 v39, a251
    v_cvt_pk_bf16_f32 v54, v36, v37
    v_cvt_pk_bf16_f32 v55, v38, v39
    s_mov_b32 s45, 0x40c00
    buffer_store_dwordx4 v[52:55], v28, s[4:7], s45 offen sc1
    v_accvgpr_read_b32 v32, a140
    v_accvgpr_read_b32 v33, a141
    v_accvgpr_read_b32 v34, a142
    v_accvgpr_read_b32 v35, a143
    v_cvt_pk_bf16_f32 v56, v32, v33
    v_cvt_pk_bf16_f32 v57, v34, v35
    v_accvgpr_read_b32 v36, a156
    v_accvgpr_read_b32 v37, a157
    v_accvgpr_read_b32 v38, a158
    v_accvgpr_read_b32 v39, a159
    v_cvt_pk_bf16_f32 v58, v36, v37
    v_cvt_pk_bf16_f32 v59, v38, v39
    s_mov_b32 s45, 0x41000
    buffer_store_dwordx4 v[56:59], v28, s[4:7], s45 offen sc1
    v_accvgpr_read_b32 v32, a172
    v_accvgpr_read_b32 v33, a173
    v_accvgpr_read_b32 v34, a174
    v_accvgpr_read_b32 v35, a175
    v_cvt_pk_bf16_f32 v60, v32, v33
    v_cvt_pk_bf16_f32 v61, v34, v35
    v_accvgpr_read_b32 v36, a188
    v_accvgpr_read_b32 v37, a189
    v_accvgpr_read_b32 v38, a190
    v_accvgpr_read_b32 v39, a191
    v_cvt_pk_bf16_f32 v62, v36, v37
    v_cvt_pk_bf16_f32 v63, v38, v39
    s_mov_b32 s45, 0x41400
    buffer_store_dwordx4 v[60:63], v28, s[4:7], s45 offen sc1
    v_accvgpr_read_b32 v32, a204
    v_accvgpr_read_b32 v33, a205
    v_accvgpr_read_b32 v34, a206
    v_accvgpr_read_b32 v35, a207
    v_cvt_pk_bf16_f32 v64, v32, v33
    v_cvt_pk_bf16_f32 v65, v34, v35
    v_accvgpr_read_b32 v36, a220
    v_accvgpr_read_b32 v37, a221
    v_accvgpr_read_b32 v38, a222
    v_accvgpr_read_b32 v39, a223
    v_cvt_pk_bf16_f32 v66, v36, v37
    v_cvt_pk_bf16_f32 v67, v38, v39
    s_mov_b32 s45, 0x41800
    buffer_store_dwordx4 v[64:67], v28, s[4:7], s45 offen sc1
    v_accvgpr_read_b32 v32, a236
    v_accvgpr_read_b32 v33, a237
    v_accvgpr_read_b32 v34, a238
    v_accvgpr_read_b32 v35, a239
    v_cvt_pk_bf16_f32 v68, v32, v33
    v_cvt_pk_bf16_f32 v69, v34, v35
    v_accvgpr_read_b32 v36, a252
    v_accvgpr_read_b32 v37, a253
    v_accvgpr_read_b32 v38, a254
    v_accvgpr_read_b32 v39, a255
    v_cvt_pk_bf16_f32 v70, v36, v37
    v_cvt_pk_bf16_f32 v71, v38, v39
    s_mov_b32 s45, 0x41c00
    buffer_store_dwordx4 v[68:71], v28, s[4:7], s45 offen sc1
    v_accvgpr_read_b32 v32, a0
    v_accvgpr_read_b32 v33, a1
    v_accvgpr_read_b32 v34, a2
    v_accvgpr_read_b32 v35, a3
    v_cvt_pk_bf16_f32 v72, v32, v33
    v_cvt_pk_bf16_f32 v73, v34, v35
    v_accvgpr_read_b32 v36, a16
    v_accvgpr_read_b32 v37, a17
    v_accvgpr_read_b32 v38, a18
    v_accvgpr_read_b32 v39, a19
    v_cvt_pk_bf16_f32 v74, v36, v37
    v_cvt_pk_bf16_f32 v75, v38, v39
    s_mov_b32 s45, 0x1000000
    buffer_store_dwordx4 v[72:75], v28, s[4:7], s45 offen sc1
    v_accvgpr_read_b32 v32, a32
    v_accvgpr_read_b32 v33, a33
    v_accvgpr_read_b32 v34, a34
    v_accvgpr_read_b32 v35, a35
    v_cvt_pk_bf16_f32 v76, v32, v33
    v_cvt_pk_bf16_f32 v77, v34, v35
    v_accvgpr_read_b32 v36, a48
    v_accvgpr_read_b32 v37, a49
    v_accvgpr_read_b32 v38, a50
    v_accvgpr_read_b32 v39, a51
    v_cvt_pk_bf16_f32 v78, v36, v37
    v_cvt_pk_bf16_f32 v79, v38, v39
    s_mov_b32 s45, 0x1000400
    buffer_store_dwordx4 v[76:79], v28, s[4:7], s45 offen sc1
    v_accvgpr_read_b32 v32, a64
    v_accvgpr_read_b32 v33, a65
    v_accvgpr_read_b32 v34, a66
    v_accvgpr_read_b32 v35, a67
    v_cvt_pk_bf16_f32 v80, v32, v33
    v_cvt_pk_bf16_f32 v81, v34, v35
    v_accvgpr_read_b32 v36, a80
    v_accvgpr_read_b32 v37, a81
    v_accvgpr_read_b32 v38, a82
    v_accvgpr_read_b32 v39, a83
    v_cvt_pk_bf16_f32 v82, v36, v37
    v_cvt_pk_bf16_f32 v83, v38, v39
    s_mov_b32 s45, 0x1000800
    buffer_store_dwordx4 v[80:83], v28, s[4:7], s45 offen sc1
    v_accvgpr_read_b32 v32, a96
    v_accvgpr_read_b32 v33, a97
    v_accvgpr_read_b32 v34, a98
    v_accvgpr_read_b32 v35, a99
    v_cvt_pk_bf16_f32 v84, v32, v33
    v_cvt_pk_bf16_f32 v85, v34, v35
    v_accvgpr_read_b32 v36, a112
    v_accvgpr_read_b32 v37, a113
    v_accvgpr_read_b32 v38, a114
    v_accvgpr_read_b32 v39, a115
    v_cvt_pk_bf16_f32 v86, v36, v37
    v_cvt_pk_bf16_f32 v87, v38, v39
    s_mov_b32 s45, 0x1000c00
    buffer_store_dwordx4 v[84:87], v28, s[4:7], s45 offen sc1
    v_accvgpr_read_b32 v32, a4
    v_accvgpr_read_b32 v33, a5
    v_accvgpr_read_b32 v34, a6
    v_accvgpr_read_b32 v35, a7
    v_cvt_pk_bf16_f32 v88, v32, v33
    v_cvt_pk_bf16_f32 v89, v34, v35
    v_accvgpr_read_b32 v36, a20
    v_accvgpr_read_b32 v37, a21
    v_accvgpr_read_b32 v38, a22
    v_accvgpr_read_b32 v39, a23
    v_cvt_pk_bf16_f32 v90, v36, v37
    v_cvt_pk_bf16_f32 v91, v38, v39
    s_mov_b32 s45, 0x1001000
    buffer_store_dwordx4 v[88:91], v28, s[4:7], s45 offen sc1
    v_accvgpr_read_b32 v32, a36
    v_accvgpr_read_b32 v33, a37
    v_accvgpr_read_b32 v34, a38
    v_accvgpr_read_b32 v35, a39
    v_cvt_pk_bf16_f32 v92, v32, v33
    v_cvt_pk_bf16_f32 v93, v34, v35
    v_accvgpr_read_b32 v36, a52
    v_accvgpr_read_b32 v37, a53
    v_accvgpr_read_b32 v38, a54
    v_accvgpr_read_b32 v39, a55
    v_cvt_pk_bf16_f32 v94, v36, v37
    v_cvt_pk_bf16_f32 v95, v38, v39
    s_mov_b32 s45, 0x1001400
    buffer_store_dwordx4 v[92:95], v28, s[4:7], s45 offen sc1
    v_accvgpr_read_b32 v32, a68
    v_accvgpr_read_b32 v33, a69
    v_accvgpr_read_b32 v34, a70
    v_accvgpr_read_b32 v35, a71
    v_cvt_pk_bf16_f32 v96, v32, v33
    v_cvt_pk_bf16_f32 v97, v34, v35
    v_accvgpr_read_b32 v36, a84
    v_accvgpr_read_b32 v37, a85
    v_accvgpr_read_b32 v38, a86
    v_accvgpr_read_b32 v39, a87
    v_cvt_pk_bf16_f32 v98, v36, v37
    v_cvt_pk_bf16_f32 v99, v38, v39
    s_mov_b32 s45, 0x1001800
    buffer_store_dwordx4 v[96:99], v28, s[4:7], s45 offen sc1
    v_accvgpr_read_b32 v32, a100
    v_accvgpr_read_b32 v33, a101
    v_accvgpr_read_b32 v34, a102
    v_accvgpr_read_b32 v35, a103
    v_cvt_pk_bf16_f32 v100, v32, v33
    v_cvt_pk_bf16_f32 v101, v34, v35
    v_accvgpr_read_b32 v36, a116
    v_accvgpr_read_b32 v37, a117
    v_accvgpr_read_b32 v38, a118
    v_accvgpr_read_b32 v39, a119
    v_cvt_pk_bf16_f32 v102, v36, v37
    v_cvt_pk_bf16_f32 v103, v38, v39
    s_mov_b32 s45, 0x1001c00
    buffer_store_dwordx4 v[100:103], v28, s[4:7], s45 offen sc1
    v_accvgpr_read_b32 v32, a8
    v_accvgpr_read_b32 v33, a9
    v_accvgpr_read_b32 v34, a10
    v_accvgpr_read_b32 v35, a11
    v_cvt_pk_bf16_f32 v104, v32, v33
    v_cvt_pk_bf16_f32 v105, v34, v35
    v_accvgpr_read_b32 v36, a24
    v_accvgpr_read_b32 v37, a25
    v_accvgpr_read_b32 v38, a26
    v_accvgpr_read_b32 v39, a27
    v_cvt_pk_bf16_f32 v106, v36, v37
    v_cvt_pk_bf16_f32 v107, v38, v39
    s_mov_b32 s45, 0x1040000
    buffer_store_dwordx4 v[104:107], v28, s[4:7], s45 offen sc1
    v_accvgpr_read_b32 v32, a40
    v_accvgpr_read_b32 v33, a41
    v_accvgpr_read_b32 v34, a42
    v_accvgpr_read_b32 v35, a43
    v_cvt_pk_bf16_f32 v108, v32, v33
    v_cvt_pk_bf16_f32 v109, v34, v35
    v_accvgpr_read_b32 v36, a56
    v_accvgpr_read_b32 v37, a57
    v_accvgpr_read_b32 v38, a58
    v_accvgpr_read_b32 v39, a59
    v_cvt_pk_bf16_f32 v110, v36, v37
    v_cvt_pk_bf16_f32 v111, v38, v39
    s_mov_b32 s45, 0x1040400
    buffer_store_dwordx4 v[108:111], v28, s[4:7], s45 offen sc1
    v_accvgpr_read_b32 v32, a72
    v_accvgpr_read_b32 v33, a73
    v_accvgpr_read_b32 v34, a74
    v_accvgpr_read_b32 v35, a75
    v_cvt_pk_bf16_f32 v112, v32, v33
    v_cvt_pk_bf16_f32 v113, v34, v35
    v_accvgpr_read_b32 v36, a88
    v_accvgpr_read_b32 v37, a89
    v_accvgpr_read_b32 v38, a90
    v_accvgpr_read_b32 v39, a91
    v_cvt_pk_bf16_f32 v114, v36, v37
    v_cvt_pk_bf16_f32 v115, v38, v39
    s_mov_b32 s45, 0x1040800
    buffer_store_dwordx4 v[112:115], v28, s[4:7], s45 offen sc1
    v_accvgpr_read_b32 v32, a104
    v_accvgpr_read_b32 v33, a105
    v_accvgpr_read_b32 v34, a106
    v_accvgpr_read_b32 v35, a107
    v_cvt_pk_bf16_f32 v116, v32, v33
    v_cvt_pk_bf16_f32 v117, v34, v35
    v_accvgpr_read_b32 v36, a120
    v_accvgpr_read_b32 v37, a121
    v_accvgpr_read_b32 v38, a122
    v_accvgpr_read_b32 v39, a123
    v_cvt_pk_bf16_f32 v118, v36, v37
    v_cvt_pk_bf16_f32 v119, v38, v39
    s_mov_b32 s45, 0x1040c00
    buffer_store_dwordx4 v[116:119], v28, s[4:7], s45 offen sc1
    v_accvgpr_read_b32 v32, a12
    v_accvgpr_read_b32 v33, a13
    v_accvgpr_read_b32 v34, a14
    v_accvgpr_read_b32 v35, a15
    v_cvt_pk_bf16_f32 v120, v32, v33
    v_cvt_pk_bf16_f32 v121, v34, v35
    v_accvgpr_read_b32 v36, a28
    v_accvgpr_read_b32 v37, a29
    v_accvgpr_read_b32 v38, a30
    v_accvgpr_read_b32 v39, a31
    v_cvt_pk_bf16_f32 v122, v36, v37
    v_cvt_pk_bf16_f32 v123, v38, v39
    s_mov_b32 s45, 0x1041000
    buffer_store_dwordx4 v[120:123], v28, s[4:7], s45 offen sc1
    v_accvgpr_read_b32 v32, a44
    v_accvgpr_read_b32 v33, a45
    v_accvgpr_read_b32 v34, a46
    v_accvgpr_read_b32 v35, a47
    v_cvt_pk_bf16_f32 v124, v32, v33
    v_cvt_pk_bf16_f32 v125, v34, v35
    v_accvgpr_read_b32 v36, a60
    v_accvgpr_read_b32 v37, a61
    v_accvgpr_read_b32 v38, a62
    v_accvgpr_read_b32 v39, a63
    v_cvt_pk_bf16_f32 v126, v36, v37
    v_cvt_pk_bf16_f32 v127, v38, v39
    s_mov_b32 s45, 0x1041400
    buffer_store_dwordx4 v[124:127], v28, s[4:7], s45 offen sc1
    v_accvgpr_read_b32 v32, a76
    v_accvgpr_read_b32 v33, a77
    v_accvgpr_read_b32 v34, a78
    v_accvgpr_read_b32 v35, a79
    v_cvt_pk_bf16_f32 v128, v32, v33
    v_cvt_pk_bf16_f32 v129, v34, v35
    v_accvgpr_read_b32 v36, a92
    v_accvgpr_read_b32 v37, a93
    v_accvgpr_read_b32 v38, a94
    v_accvgpr_read_b32 v39, a95
    v_cvt_pk_bf16_f32 v130, v36, v37
    v_cvt_pk_bf16_f32 v131, v38, v39
    s_mov_b32 s45, 0x1041800
    buffer_store_dwordx4 v[128:131], v28, s[4:7], s45 offen sc1
    v_accvgpr_read_b32 v32, a108
    v_accvgpr_read_b32 v33, a109
    v_accvgpr_read_b32 v34, a110
    v_accvgpr_read_b32 v35, a111
    v_cvt_pk_bf16_f32 v132, v32, v33
    v_cvt_pk_bf16_f32 v133, v34, v35
    v_accvgpr_read_b32 v36, a124
    v_accvgpr_read_b32 v37, a125
    v_accvgpr_read_b32 v38, a126
    v_accvgpr_read_b32 v39, a127
    v_cvt_pk_bf16_f32 v134, v36, v37
    v_cvt_pk_bf16_f32 v135, v38, v39
    s_mov_b32 s45, 0x1041c00
    buffer_store_dwordx4 v[132:135], v28, s[4:7], s45 offen sc1
    s_waitcnt vmcnt(56)
    s_barrier
    s_mov_b32 s53, 0x2000000
    s_mov_b32 s54, 0
    ds_read_b64_tr_b16 v[40:41], v12 offset:0
    ds_read_b64_tr_b16 v[42:43], v12 offset:4096
    ds_read_b64_tr_b16 v[44:45], v12 offset:8192
    ds_read_b64_tr_b16 v[46:47], v12 offset:12288
    ds_read_b64_tr_b16 v[48:49], v12 offset:16384
    ds_read_b64_tr_b16 v[50:51], v12 offset:20480
    ds_read_b64_tr_b16 v[52:53], v12 offset:24576
    ds_read_b64_tr_b16 v[54:55], v12 offset:28672
    v_add_u32 v12, 0x8000, v12
    v_and_b32 v12, 0x1ffff, v12
Lu_124:
    ds_read_b64_tr_b16 v[56:57], v13 offset:0
    ds_read_b64_tr_b16 v[58:59], v13 offset:4096
    ds_read_b64_tr_b16 v[60:61], v13 offset:8192
    ds_read_b64_tr_b16 v[62:63], v13 offset:12288
    ds_read_b64_tr_b16 v[64:65], v13 offset:16384
    ds_read_b64_tr_b16 v[66:67], v13 offset:20480
    ds_read_b64_tr_b16 v[68:69], v13 offset:24576
    ds_read_b64_tr_b16 v[70:71], v13 offset:28672
    v_add_u32 v13, 0x8000, v13
    v_and_b32 v13, 0x1ffff, v13
    s_waitcnt lgkmcnt(8)
    v_mfma_f32_16x16x32_bf16 v[136:139], v[72:75], v[40:43], 0
    v_mfma_f32_16x16x32_bf16 v[140:143], v[88:91], v[40:43], 0
    v_mfma_f32_16x16x32_bf16 v[144:147], v[104:107], v[40:43], 0
    v_mfma_f32_16x16x32_bf16 v[148:151], v[120:123], v[40:43], 0
    v_mfma_f32_16x16x32_bf16 v[136:139], v[76:79], v[44:47], v[136:139]
    v_mfma_f32_16x16x32_bf16 v[140:143], v[92:95], v[44:47], v[140:143]
    v_mfma_f32_16x16x32_bf16 v[144:147], v[108:111], v[44:47], v[144:147]
    v_mfma_f32_16x16x32_bf16 v[148:151], v[124:127], v[44:47], v[148:151]
    v_mfma_f32_16x16x32_bf16 v[136:139], v[80:83], v[48:51], v[136:139]
    v_mfma_f32_16x16x32_bf16 v[140:143], v[96:99], v[48:51], v[140:143]
    v_mfma_f32_16x16x32_bf16 v[144:147], v[112:115], v[48:51], v[144:147]
    v_mfma_f32_16x16x32_bf16 v[148:151], v[128:131], v[48:51], v[148:151]
    s_cmp_eq_u32 s54, 0
    s_cbranch_scc1 Lsk_125
    v_cvt_pk_bf16_f32 v176, v152, v153
    v_cvt_pk_bf16_f32 v177, v154, v155
    v_cvt_pk_bf16_f32 v178, v156, v157
    v_cvt_pk_bf16_f32 v179, v158, v159
    s_add_u32 s45, s53, 0x0
    buffer_store_dwordx4 v[176:179], v29, s[4:7], s45 offen sc1
    v_cvt_pk_bf16_f32 v180, v160, v161
    v_cvt_pk_bf16_f32 v181, v162, v163
    v_cvt_pk_bf16_f32 v182, v164, v165
    v_cvt_pk_bf16_f32 v183, v166, v167
    s_add_u32 s45, s53, 0x140000
    buffer_store_dwordx4 v[180:183], v29, s[4:7], s45 offen sc1
    s_add_u32 s53, s53, 1024
Lsk_125:
    v_mfma_f32_16x16x32_bf16 v[136:139], v[84:87], v[52:55], v[136:139]
    v_mfma_f32_16x16x32_bf16 v[140:143], v[100:103], v[52:55], v[140:143]
    v_mfma_f32_16x16x32_bf16 v[144:147], v[116:119], v[52:55], v[144:147]
    v_mfma_f32_16x16x32_bf16 v[148:151], v[132:135], v[52:55], v[148:151]
    ds_read_b64_tr_b16 v[40:41], v14 offset:0
    ds_read_b64_tr_b16 v[42:43], v14 offset:4096
    ds_read_b64_tr_b16 v[44:45], v14 offset:8192
    ds_read_b64_tr_b16 v[46:47], v14 offset:12288
    ds_read_b64_tr_b16 v[48:49], v14 offset:16384
    ds_read_b64_tr_b16 v[50:51], v14 offset:20480
    ds_read_b64_tr_b16 v[52:53], v14 offset:24576
    ds_read_b64_tr_b16 v[54:55], v14 offset:28672
    v_add_u32 v14, 0x8000, v14
    v_and_b32 v14, 0x1ffff, v14
    s_waitcnt lgkmcnt(8)
    v_mfma_f32_16x16x32_bf16 v[152:155], v[72:75], v[56:59], 0
    v_mfma_f32_16x16x32_bf16 v[156:159], v[88:91], v[56:59], 0
    v_mfma_f32_16x16x32_bf16 v[160:163], v[104:107], v[56:59], 0
    v_mfma_f32_16x16x32_bf16 v[164:167], v[120:123], v[56:59], 0
    v_mfma_f32_16x16x32_bf16 v[152:155], v[76:79], v[60:63], v[152:155]
    v_mfma_f32_16x16x32_bf16 v[156:159], v[92:95], v[60:63], v[156:159]
    v_mfma_f32_16x16x32_bf16 v[160:163], v[108:111], v[60:63], v[160:163]
    v_mfma_f32_16x16x32_bf16 v[164:167], v[124:127], v[60:63], v[164:167]
    v_mfma_f32_16x16x32_bf16 v[152:155], v[80:83], v[64:67], v[152:155]
    v_mfma_f32_16x16x32_bf16 v[156:159], v[96:99], v[64:67], v[156:159]
    v_mfma_f32_16x16x32_bf16 v[160:163], v[112:115], v[64:67], v[160:163]
    v_mfma_f32_16x16x32_bf16 v[164:167], v[128:131], v[64:67], v[164:167]
    v_cvt_pk_bf16_f32 v168, v136, v137
    v_cvt_pk_bf16_f32 v169, v138, v139
    v_cvt_pk_bf16_f32 v170, v140, v141
    v_cvt_pk_bf16_f32 v171, v142, v143
    s_add_u32 s45, s53, 0x0
    buffer_store_dwordx4 v[168:171], v29, s[4:7], s45 offen sc1
    v_cvt_pk_bf16_f32 v172, v144, v145
    v_cvt_pk_bf16_f32 v173, v146, v147
    v_cvt_pk_bf16_f32 v174, v148, v149
    v_cvt_pk_bf16_f32 v175, v150, v151
    s_add_u32 s45, s53, 0x140000
    buffer_store_dwordx4 v[172:175], v29, s[4:7], s45 offen sc1
    s_add_u32 s53, s53, 1024
    v_mfma_f32_16x16x32_bf16 v[152:155], v[84:87], v[68:71], v[152:155]
    v_mfma_f32_16x16x32_bf16 v[156:159], v[100:103], v[68:71], v[156:159]
    v_mfma_f32_16x16x32_bf16 v[160:163], v[116:119], v[68:71], v[160:163]
    v_mfma_f32_16x16x32_bf16 v[164:167], v[132:135], v[68:71], v[164:167]
    ds_read_b64_tr_b16 v[56:57], v15 offset:0
    ds_read_b64_tr_b16 v[58:59], v15 offset:4096
    ds_read_b64_tr_b16 v[60:61], v15 offset:8192
    ds_read_b64_tr_b16 v[62:63], v15 offset:12288
    ds_read_b64_tr_b16 v[64:65], v15 offset:16384
    ds_read_b64_tr_b16 v[66:67], v15 offset:20480
    ds_read_b64_tr_b16 v[68:69], v15 offset:24576
    ds_read_b64_tr_b16 v[70:71], v15 offset:28672
    v_add_u32 v15, 0x8000, v15
    v_and_b32 v15, 0x1ffff, v15
    s_waitcnt lgkmcnt(8)
    v_mfma_f32_16x16x32_bf16 v[136:139], v[72:75], v[40:43], 0
    v_mfma_f32_16x16x32_bf16 v[140:143], v[88:91], v[40:43], 0
    v_mfma_f32_16x16x32_bf16 v[144:147], v[104:107], v[40:43], 0
    v_mfma_f32_16x16x32_bf16 v[148:151], v[120:123], v[40:43], 0
    v_mfma_f32_16x16x32_bf16 v[136:139], v[76:79], v[44:47], v[136:139]
    v_mfma_f32_16x16x32_bf16 v[140:143], v[92:95], v[44:47], v[140:143]
    v_mfma_f32_16x16x32_bf16 v[144:147], v[108:111], v[44:47], v[144:147]
    v_mfma_f32_16x16x32_bf16 v[148:151], v[124:127], v[44:47], v[148:151]
    v_mfma_f32_16x16x32_bf16 v[136:139], v[80:83], v[48:51], v[136:139]
    v_mfma_f32_16x16x32_bf16 v[140:143], v[96:99], v[48:51], v[140:143]
    v_mfma_f32_16x16x32_bf16 v[144:147], v[112:115], v[48:51], v[144:147]
    v_mfma_f32_16x16x32_bf16 v[148:151], v[128:131], v[48:51], v[148:151]
    v_cvt_pk_bf16_f32 v176, v152, v153
    v_cvt_pk_bf16_f32 v177, v154, v155
    v_cvt_pk_bf16_f32 v178, v156, v157
    v_cvt_pk_bf16_f32 v179, v158, v159
    s_add_u32 s45, s53, 0x0
    buffer_store_dwordx4 v[176:179], v29, s[4:7], s45 offen sc1
    v_cvt_pk_bf16_f32 v180, v160, v161
    v_cvt_pk_bf16_f32 v181, v162, v163
    v_cvt_pk_bf16_f32 v182, v164, v165
    v_cvt_pk_bf16_f32 v183, v166, v167
    s_add_u32 s45, s53, 0x140000
    buffer_store_dwordx4 v[180:183], v29, s[4:7], s45 offen sc1
    s_add_u32 s53, s53, 1024
    v_mfma_f32_16x16x32_bf16 v[136:139], v[84:87], v[52:55], v[136:139]
    v_mfma_f32_16x16x32_bf16 v[140:143], v[100:103], v[52:55], v[140:143]
    v_mfma_f32_16x16x32_bf16 v[144:147], v[116:119], v[52:55], v[144:147]
    v_mfma_f32_16x16x32_bf16 v[148:151], v[132:135], v[52:55], v[148:151]
    ds_read_b64_tr_b16 v[40:41], v16 offset:0
    ds_read_b64_tr_b16 v[42:43], v16 offset:4096
    ds_read_b64_tr_b16 v[44:45], v16 offset:8192
    ds_read_b64_tr_b16 v[46:47], v16 offset:12288
    ds_read_b64_tr_b16 v[48:49], v16 offset:16384
    ds_read_b64_tr_b16 v[50:51], v16 offset:20480
    ds_read_b64_tr_b16 v[52:53], v16 offset:24576
    ds_read_b64_tr_b16 v[54:55], v16 offset:28672
    v_add_u32 v16, 0x8000, v16
    v_and_b32 v16, 0x1ffff, v16
    s_waitcnt lgkmcnt(8)
    v_mfma_f32_16x16x32_bf16 v[152:155], v[72:75], v[56:59], 0
    v_mfma_f32_16x16x32_bf16 v[156:159], v[88:91], v[56:59], 0
    v_mfma_f32_16x16x32_bf16 v[160:163], v[104:107], v[56:59], 0
    v_mfma_f32_16x16x32_bf16 v[164:167], v[120:123], v[56:59], 0
    v_mfma_f32_16x16x32_bf16 v[152:155], v[76:79], v[60:63], v[152:155]
    v_mfma_f32_16x16x32_bf16 v[156:159], v[92:95], v[60:63], v[156:159]
    v_mfma_f32_16x16x32_bf16 v[160:163], v[108:111], v[60:63], v[160:163]
    v_mfma_f32_16x16x32_bf16 v[164:167], v[124:127], v[60:63], v[164:167]
    v_mfma_f32_16x16x32_bf16 v[152:155], v[80:83], v[64:67], v[152:155]
    v_mfma_f32_16x16x32_bf16 v[156:159], v[96:99], v[64:67], v[156:159]
    v_mfma_f32_16x16x32_bf16 v[160:163], v[112:115], v[64:67], v[160:163]
    v_mfma_f32_16x16x32_bf16 v[164:167], v[128:131], v[64:67], v[164:167]
    v_cvt_pk_bf16_f32 v168, v136, v137
    v_cvt_pk_bf16_f32 v169, v138, v139
    v_cvt_pk_bf16_f32 v170, v140, v141
    v_cvt_pk_bf16_f32 v171, v142, v143
    s_add_u32 s45, s53, 0x0
    buffer_store_dwordx4 v[168:171], v29, s[4:7], s45 offen sc1
    v_cvt_pk_bf16_f32 v172, v144, v145
    v_cvt_pk_bf16_f32 v173, v146, v147
    v_cvt_pk_bf16_f32 v174, v148, v149
    v_cvt_pk_bf16_f32 v175, v150, v151
    s_add_u32 s45, s53, 0x140000
    buffer_store_dwordx4 v[172:175], v29, s[4:7], s45 offen sc1
    s_add_u32 s53, s53, 1024
    v_mfma_f32_16x16x32_bf16 v[152:155], v[84:87], v[68:71], v[152:155]
    v_mfma_f32_16x16x32_bf16 v[156:159], v[100:103], v[68:71], v[156:159]
    v_mfma_f32_16x16x32_bf16 v[160:163], v[116:119], v[68:71], v[160:163]
    v_mfma_f32_16x16x32_bf16 v[164:167], v[132:135], v[68:71], v[164:167]
    ds_read_b64_tr_b16 v[56:57], v17 offset:0
    ds_read_b64_tr_b16 v[58:59], v17 offset:4096
    ds_read_b64_tr_b16 v[60:61], v17 offset:8192
    ds_read_b64_tr_b16 v[62:63], v17 offset:12288
    ds_read_b64_tr_b16 v[64:65], v17 offset:16384
    ds_read_b64_tr_b16 v[66:67], v17 offset:20480
    ds_read_b64_tr_b16 v[68:69], v17 offset:24576
    ds_read_b64_tr_b16 v[70:71], v17 offset:28672
    v_add_u32 v17, 0x8000, v17
    v_and_b32 v17, 0x1ffff, v17
    s_waitcnt lgkmcnt(8)
    v_mfma_f32_16x16x32_bf16 v[136:139], v[72:75], v[40:43], 0
    v_mfma_f32_16x16x32_bf16 v[140:143], v[88:91], v[40:43], 0
    v_mfma_f32_16x16x32_bf16 v[144:147], v[104:107], v[40:43], 0
    v_mfma_f32_16x16x32_bf16 v[148:151], v[120:123], v[40:43], 0
    v_mfma_f32_16x16x32_bf16 v[136:139], v[76:79], v[44:47], v[136:139]
    v_mfma_f32_16x16x32_bf16 v[140:143], v[92:95], v[44:47], v[140:143]
    v_mfma_f32_16x16x32_bf16 v[144:147], v[108:111], v[44:47], v[144:147]
    v_mfma_f32_16x16x32_bf16 v[148:151], v[124:127], v[44:47], v[148:151]
    v_mfma_f32_16x16x32_bf16 v[136:139], v[80:83], v[48:51], v[136:139]
    v_mfma_f32_16x16x32_bf16 v[140:143], v[96:99], v[48:51], v[140:143]
    v_mfma_f32_16x16x32_bf16 v[144:147], v[112:115], v[48:51], v[144:147]
    v_mfma_f32_16x16x32_bf16 v[148:151], v[128:131], v[48:51], v[148:151]
    v_cvt_pk_bf16_f32 v176, v152, v153
    v_cvt_pk_bf16_f32 v177, v154, v155
    v_cvt_pk_bf16_f32 v178, v156, v157
    v_cvt_pk_bf16_f32 v179, v158, v159
    s_add_u32 s45, s53, 0x0
    buffer_store_dwordx4 v[176:179], v29, s[4:7], s45 offen sc1
    v_cvt_pk_bf16_f32 v180, v160, v161
    v_cvt_pk_bf16_f32 v181, v162, v163
    v_cvt_pk_bf16_f32 v182, v164, v165
    v_cvt_pk_bf16_f32 v183, v166, v167
    s_add_u32 s45, s53, 0x140000
    buffer_store_dwordx4 v[180:183], v29, s[4:7], s45 offen sc1
    s_add_u32 s53, s53, 1024
    v_mfma_f32_16x16x32_bf16 v[136:139], v[84:87], v[52:55], v[136:139]
    v_mfma_f32_16x16x32_bf16 v[140:143], v[100:103], v[52:55], v[140:143]
    v_mfma_f32_16x16x32_bf16 v[144:147], v[116:119], v[52:55], v[144:147]
    v_mfma_f32_16x16x32_bf16 v[148:151], v[132:135], v[52:55], v[148:151]
    ds_read_b64_tr_b16 v[40:41], v18 offset:0
    ds_read_b64_tr_b16 v[42:43], v18 offset:4096
    ds_read_b64_tr_b16 v[44:45], v18 offset:8192
    ds_read_b64_tr_b16 v[46:47], v18 offset:12288
    ds_read_b64_tr_b16 v[48:49], v18 offset:16384
    ds_read_b64_tr_b16 v[50:51], v18 offset:20480
    ds_read_b64_tr_b16 v[52:53], v18 offset:24576
    ds_read_b64_tr_b16 v[54:55], v18 offset:28672
    v_add_u32 v18, 0x8000, v18
    v_and_b32 v18, 0x1ffff, v18
    s_waitcnt lgkmcnt(8)
    v_mfma_f32_16x16x32_bf16 v[152:155], v[72:75], v[56:59], 0
    v_mfma_f32_16x16x32_bf16 v[156:159], v[88:91], v[56:59], 0
    v_mfma_f32_16x16x32_bf16 v[160:163], v[104:107], v[56:59], 0
    v_mfma_f32_16x16x32_bf16 v[164:167], v[120:123], v[56:59], 0
    v_mfma_f32_16x16x32_bf16 v[152:155], v[76:79], v[60:63], v[152:155]
    v_mfma_f32_16x16x32_bf16 v[156:159], v[92:95], v[60:63], v[156:159]
    v_mfma_f32_16x16x32_bf16 v[160:163], v[108:111], v[60:63], v[160:163]
    v_mfma_f32_16x16x32_bf16 v[164:167], v[124:127], v[60:63], v[164:167]
    v_mfma_f32_16x16x32_bf16 v[152:155], v[80:83], v[64:67], v[152:155]
    v_mfma_f32_16x16x32_bf16 v[156:159], v[96:99], v[64:67], v[156:159]
    v_mfma_f32_16x16x32_bf16 v[160:163], v[112:115], v[64:67], v[160:163]
    v_mfma_f32_16x16x32_bf16 v[164:167], v[128:131], v[64:67], v[164:167]
    v_cvt_pk_bf16_f32 v168, v136, v137
    v_cvt_pk_bf16_f32 v169, v138, v139
    v_cvt_pk_bf16_f32 v170, v140, v141
    v_cvt_pk_bf16_f32 v171, v142, v143
    s_add_u32 s45, s53, 0x0
    buffer_store_dwordx4 v[168:171], v29, s[4:7], s45 offen sc1
    v_cvt_pk_bf16_f32 v172, v144, v145
    v_cvt_pk_bf16_f32 v173, v146, v147
    v_cvt_pk_bf16_f32 v174, v148, v149
    v_cvt_pk_bf16_f32 v175, v150, v151
    s_add_u32 s45, s53, 0x140000
    buffer_store_dwordx4 v[172:175], v29, s[4:7], s45 offen sc1
    s_add_u32 s53, s53, 1024
    v_mfma_f32_16x16x32_bf16 v[152:155], v[84:87], v[68:71], v[152:155]
    v_mfma_f32_16x16x32_bf16 v[156:159], v[100:103], v[68:71], v[156:159]
    v_mfma_f32_16x16x32_bf16 v[160:163], v[116:119], v[68:71], v[160:163]
    v_mfma_f32_16x16x32_bf16 v[164:167], v[132:135], v[68:71], v[164:167]
    ds_read_b64_tr_b16 v[56:57], v19 offset:0
    ds_read_b64_tr_b16 v[58:59], v19 offset:4096
    ds_read_b64_tr_b16 v[60:61], v19 offset:8192
    ds_read_b64_tr_b16 v[62:63], v19 offset:12288
    ds_read_b64_tr_b16 v[64:65], v19 offset:16384
    ds_read_b64_tr_b16 v[66:67], v19 offset:20480
    ds_read_b64_tr_b16 v[68:69], v19 offset:24576
    ds_read_b64_tr_b16 v[70:71], v19 offset:28672
    v_add_u32 v19, 0x8000, v19
    v_and_b32 v19, 0x1ffff, v19
    s_waitcnt lgkmcnt(8)
    v_mfma_f32_16x16x32_bf16 v[136:139], v[72:75], v[40:43], 0
    v_mfma_f32_16x16x32_bf16 v[140:143], v[88:91], v[40:43], 0
    v_mfma_f32_16x16x32_bf16 v[144:147], v[104:107], v[40:43], 0
    v_mfma_f32_16x16x32_bf16 v[148:151], v[120:123], v[40:43], 0
    v_mfma_f32_16x16x32_bf16 v[136:139], v[76:79], v[44:47], v[136:139]
    v_mfma_f32_16x16x32_bf16 v[140:143], v[92:95], v[44:47], v[140:143]
    v_mfma_f32_16x16x32_bf16 v[144:147], v[108:111], v[44:47], v[144:147]
    v_mfma_f32_16x16x32_bf16 v[148:151], v[124:127], v[44:47], v[148:151]
    v_mfma_f32_16x16x32_bf16 v[136:139], v[80:83], v[48:51], v[136:139]
    v_mfma_f32_16x16x32_bf16 v[140:143], v[96:99], v[48:51], v[140:143]
    v_mfma_f32_16x16x32_bf16 v[144:147], v[112:115], v[48:51], v[144:147]
    v_mfma_f32_16x16x32_bf16 v[148:151], v[128:131], v[48:51], v[148:151]
    v_cvt_pk_bf16_f32 v176, v152, v153
    v_cvt_pk_bf16_f32 v177, v154, v155
    v_cvt_pk_bf16_f32 v178, v156, v157
    v_cvt_pk_bf16_f32 v179, v158, v159
    s_add_u32 s45, s53, 0x0
    buffer_store_dwordx4 v[176:179], v29, s[4:7], s45 offen sc1
    v_cvt_pk_bf16_f32 v180, v160, v161
    v_cvt_pk_bf16_f32 v181, v162, v163
    v_cvt_pk_bf16_f32 v182, v164, v165
    v_cvt_pk_bf16_f32 v183, v166, v167
    s_add_u32 s45, s53, 0x140000
    buffer_store_dwordx4 v[180:183], v29, s[4:7], s45 offen sc1
    s_add_u32 s53, s53, 1024
    v_mfma_f32_16x16x32_bf16 v[136:139], v[84:87], v[52:55], v[136:139]
    v_mfma_f32_16x16x32_bf16 v[140:143], v[100:103], v[52:55], v[140:143]
    v_mfma_f32_16x16x32_bf16 v[144:147], v[116:119], v[52:55], v[144:147]
    v_mfma_f32_16x16x32_bf16 v[148:151], v[132:135], v[52:55], v[148:151]
    s_waitcnt vmcnt(12)
    s_barrier
    s_cmp_lg_u32 s54, 1
    s_cbranch_scc1 Lnd_126
    s_add_u32 m0, s50, 0
    s_mov_b32 s52, 1024
    buffer_load_dwordx4 v9, s[20:23], s52 offen lds
    s_add_u32 m0, s50, 1024
    s_mov_b32 s52, 6144
    buffer_load_dwordx4 v10, s[20:23], s52 offen lds
    s_add_u32 m0, s50, 2048
    s_mov_b32 s52, 11264
    buffer_load_dwordx4 v9, s[20:23], s52 offen lds
    s_add_u32 m0, s50, 3072
    s_mov_b32 s52, 16384
    buffer_load_dwordx4 v10, s[20:23], s52 offen lds
    s_add_u32 m0, s50, 4096
    s_mov_b32 s52, 21504
    buffer_load_dwordx4 v9, s[20:23], s52 offen lds
    s_add_u32 m0, s50, 5120
    s_mov_b32 s52, 26624
    buffer_load_dwordx4 v10, s[20:23], s52 offen lds
    s_add_u32 m0, s50, 6144
    s_mov_b32 s52, 31744
    buffer_load_dwordx4 v9, s[20:23], s52 offen lds
    s_add_u32 m0, s50, 7168
    s_mov_b32 s52, 36864
    buffer_load_dwordx4 v10, s[20:23], s52 offen lds
Lnd_126:
    ds_read_b64_tr_b16 v[40:41], v12 offset:0
    ds_read_b64_tr_b16 v[42:43], v12 offset:4096
    ds_read_b64_tr_b16 v[44:45], v12 offset:8192
    ds_read_b64_tr_b16 v[46:47], v12 offset:12288
    ds_read_b64_tr_b16 v[48:49], v12 offset:16384
    ds_read_b64_tr_b16 v[50:51], v12 offset:20480
    ds_read_b64_tr_b16 v[52:53], v12 offset:24576
    ds_read_b64_tr_b16 v[54:55], v12 offset:28672
    v_add_u32 v12, 0x8000, v12
    v_and_b32 v12, 0x1ffff, v12
    s_waitcnt lgkmcnt(8)
    v_mfma_f32_16x16x32_bf16 v[152:155], v[72:75], v[56:59], 0
    v_mfma_f32_16x16x32_bf16 v[156:159], v[88:91], v[56:59], 0
    v_mfma_f32_16x16x32_bf16 v[160:163], v[104:107], v[56:59], 0
    v_mfma_f32_16x16x32_bf16 v[164:167], v[120:123], v[56:59], 0
    v_mfma_f32_16x16x32_bf16 v[152:155], v[76:79], v[60:63], v[152:155]
    v_mfma_f32_16x16x32_bf16 v[156:159], v[92:95], v[60:63], v[156:159]
    v_mfma_f32_16x16x32_bf16 v[160:163], v[108:111], v[60:63], v[160:163]
    v_mfma_f32_16x16x32_bf16 v[164:167], v[124:127], v[60:63], v[164:167]
    v_mfma_f32_16x16x32_bf16 v[152:155], v[80:83], v[64:67], v[152:155]
    v_mfma_f32_16x16x32_bf16 v[156:159], v[96:99], v[64:67], v[156:159]
    v_mfma_f32_16x16x32_bf16 v[160:163], v[112:115], v[64:67], v[160:163]
    v_mfma_f32_16x16x32_bf16 v[164:167], v[128:131], v[64:67], v[164:167]
    v_cvt_pk_bf16_f32 v168, v136, v137
    v_cvt_pk_bf16_f32 v169, v138, v139
    v_cvt_pk_bf16_f32 v170, v140, v141
    v_cvt_pk_bf16_f32 v171, v142, v143
    s_add_u32 s45, s53, 0x0
    buffer_store_dwordx4 v[168:171], v29, s[4:7], s45 offen sc1
    v_cvt_pk_bf16_f32 v172, v144, v145
    v_cvt_pk_bf16_f32 v173, v146, v147
    v_cvt_pk_bf16_f32 v174, v148, v149
    v_cvt_pk_bf16_f32 v175, v150, v151
    s_add_u32 s45, s53, 0x140000
    buffer_store_dwordx4 v[172:175], v29, s[4:7], s45 offen sc1
    s_add_u32 s53, s53, 1024
    v_mfma_f32_16x16x32_bf16 v[152:155], v[84:87], v[68:71], v[152:155]
    v_mfma_f32_16x16x32_bf16 v[156:159], v[100:103], v[68:71], v[156:159]
    v_mfma_f32_16x16x32_bf16 v[160:163], v[116:119], v[68:71], v[160:163]
    v_mfma_f32_16x16x32_bf16 v[164:167], v[132:135], v[68:71], v[164:167]
    s_add_u32 s54, s54, 1
    s_cmp_lt_u32 s54, 5
    s_cbranch_scc1 Lu_124
    s_nop 7
    v_cvt_pk_bf16_f32 v176, v152, v153
    v_cvt_pk_bf16_f32 v177, v154, v155
    v_cvt_pk_bf16_f32 v178, v156, v157
    v_cvt_pk_bf16_f32 v179, v158, v159
    s_add_u32 s45, s53, 0x0
    buffer_store_dwordx4 v[176:179], v29, s[4:7], s45 offen sc1
    v_cvt_pk_bf16_f32 v180, v160, v161
    v_cvt_pk_bf16_f32 v181, v162, v163
    v_cvt_pk_bf16_f32 v182, v164, v165
    v_cvt_pk_bf16_f32 v183, v166, v167
    s_add_u32 s45, s53, 0x140000
    buffer_store_dwordx4 v[180:183], v29, s[4:7], s45 offen sc1
    s_add_u32 s53, s53, 1024
    s_waitcnt lgkmcnt(0)
    s_lshl_b32 s40, s71, 1
    s_add_u32 s40, s40, 8
    s_lshl_b32 s75, s40, 12
    s_lshl_b32 s44, s41, 7
    s_add_u32 s75, s75, s44
    s_add_u32 s75, s75, 0x8c01000
    s_waitcnt vmcnt(0)
    s_barrier
    s_cmp_lg_u32 s42, 0
    s_cbranch_scc1 Lsig_127
    s_mov_b64 exec, 1
    v_mov_b32 v4, 1
    v_mov_b32 v5, 0
    buffer_atomic_add v4, v5, s[4:7], s75 offen
    s_add_u32 s75, s75, 4096
    buffer_atomic_add v4, v5, s[4:7], s75 offen
    s_mov_b64 exec, -1
Lsig_127:
    s_lshl_b32 s75, s40, 12
    s_lshl_b32 s44, s41, 7
    s_add_u32 s75, s75, s44
    s_add_u32 s75, s75, 0x8c27180
    s_waitcnt vmcnt(0)
    s_barrier
    s_cmp_lg_u32 s42, 0
    s_cbranch_scc1 Lsig_128
    s_mov_b64 exec, 1
    v_mov_b32 v4, 1
    v_mov_b32 v5, 0
    buffer_atomic_add v4, v5, s[4:7], s75 offen
    s_add_u32 s75, s75, 4096
    buffer_atomic_add v4, v5, s[4:7], s75 offen
    s_mov_b64 exec, -1
Lsig_128:
    s_add_u32 s85, s72, 56
    s_cmp_lt_u32 s72, 8
    s_cselect_b32 s85, 99, s85
    s_cmp_lt_u32 s71, 2
    s_cselect_b32 s85, 99, s85
    s_cmp_eq_u32 s71, 3
    s_cselect_b32 s85, s72, s85
    s_cmp_lt_u32 s85, 81
    s_cbranch_scc1 Lcg_130
    s_branch Lcs_129
Lcg_130:
    s_mov_b32 s75, 0x8c23000
    s_cmp_lg_u32 s42, 0
    s_cbranch_scc1 Lwtd_132
    v_mov_b32 v5, 0
    s_mov_b32 s74, 0
Lwt_131:
    buffer_load_dword v4, v5, s[4:7], s75 offen sc1
    s_waitcnt vmcnt(0)
    v_cmp_gt_u32 vcc, 0x28, v4
    s_cbranch_vccz Lwtd_132
    s_sleep 8
    s_add_u32 s74, s74, 1
    s_cmp_lt_u32 s74, 4000000
    s_cbranch_scc1 Lwt_131
Lwtd_132:
    s_barrier
La2l_133:
    s_lshl_b32 s41, s85, 2
    s_add_u32 s41, s41, s42
    s_cmp_le_u32 s41, 320
    s_cbranch_scc1 Lcg_135
    s_branch Lcs_134
Lcg_135:
    v_lshlrev_b32 v8, 4, v1
    s_sub_u32 s44, s41, 1
    s_cmp_lt_u32 s44, 319
    s_cselect_b32 s50, 0, 0x7ff00000
    v_add_u32 v9, s50, v8
    s_lshl_b32 s44, s41, 13
    s_add_u32 s44, s44, 0xa200000
    s_add_u32 s45, s44, 2621440
    s_add_u32 s51, s44, 0
    buffer_load_dwordx4 v[12:15], v8, s[4:7], s51 offen offset:0
    s_add_u32 s51, s45, 0
    buffer_load_dwordx4 v[44:47], v9, s[4:7], s51 offen offset:0
    s_add_u32 s51, s44, 0
    buffer_load_dwordx4 v[16:19], v8, s[4:7], s51 offen offset:1024
    s_add_u32 s51, s45, 0
    buffer_load_dwordx4 v[48:51], v9, s[4:7], s51 offen offset:1024
    s_add_u32 s51, s44, 0
    buffer_load_dwordx4 v[20:23], v8, s[4:7], s51 offen offset:2048
    s_add_u32 s51, s45, 0
    buffer_load_dwordx4 v[52:55], v9, s[4:7], s51 offen offset:2048
    s_add_u32 s51, s44, 0
    buffer_load_dwordx4 v[24:27], v8, s[4:7], s51 offen offset:3072
    s_add_u32 s51, s45, 0
    buffer_load_dwordx4 v[56:59], v9, s[4:7], s51 offen offset:3072
    s_add_u32 s51, s44, 4096
    buffer_load_dwordx4 v[28:31], v8, s[4:7], s51 offen offset:0
    s_add_u32 s51, s45, 4096
    buffer_load_dwordx4 v[60:63], v9, s[4:7], s51 offen offset:0
    s_add_u32 s51, s44, 4096
    buffer_load_dwordx4 v[32:35], v8, s[4:7], s51 offen offset:1024
    s_add_u32 s51, s45, 4096
    buffer_load_dwordx4 v[64:67], v9, s[4:7], s51 offen offset:1024
    s_add_u32 s51, s44, 4096
    buffer_load_dwordx4 v[36:39], v8, s[4:7], s51 offen offset:2048
    s_add_u32 s51, s45, 4096
    buffer_load_dwordx4 v[68:71], v9, s[4:7], s51 offen offset:2048
    s_add_u32 s51, s44, 4096
    buffer_load_dwordx4 v[40:43], v8, s[4:7], s51 offen offset:3072
    s_add_u32 s51, s45, 4096
    buffer_load_dwordx4 v[72:75], v9, s[4:7], s51 offen offset:3072
    s_mov_b32 s51, 0x9d00000
    buffer_load_dwordx4 a[128:131], v8, s[4:7], s51 offen
    s_mov_b32 s51, 0x9d00400
    buffer_load_dwordx4 a[132:135], v8, s[4:7], s51 offen
    s_mov_b32 s51, 0x9d00800
    buffer_load_dwordx4 a[136:139], v8, s[4:7], s51 offen
    s_mov_b32 s51, 0x9d00c00
    buffer_load_dwordx4 a[140:143], v8, s[4:7], s51 offen
    s_mov_b32 s51, 0x9d01000
    buffer_load_dwordx4 a[144:147], v8, s[4:7], s51 offen
    s_mov_b32 s51, 0x9d01400
    buffer_load_dwordx4 a[148:151], v8, s[4:7], s51 offen
    s_mov_b32 s51, 0x9d01800
    buffer_load_dwordx4 a[152:155], v8, s[4:7], s51 offen
    s_mov_b32 s51, 0x9d01c00
    buffer_load_dwordx4 a[156:159], v8, s[4:7], s51 offen
    s_mov_b32 s51, 0x9d0a000
    buffer_load_dwordx4 v[172:175], v8, s[4:7], s51 offen
    s_mov_b32 s51, 0x9d0a400
    buffer_load_dwordx4 v[176:179], v8, s[4:7], s51 offen
    s_mov_b32 s51, 0x9d0a800
    buffer_load_dwordx4 v[180:183], v8, s[4:7], s51 offen
    s_mov_b32 s51, 0x9d0ac00
    buffer_load_dwordx4 v[184:187], v8, s[4:7], s51 offen
    s_mov_b32 s51, 0x9d0b000
    buffer_load_dwordx4 v[188:191], v8, s[4:7], s51 offen
    s_mov_b32 s51, 0x9d0b400
    buffer_load_dwordx4 v[192:195], v8, s[4:7], s51 offen
    s_mov_b32 s51, 0x9d0b800
    buffer_load_dwordx4 v[196:199], v8, s[4:7], s51 offen
    s_mov_b32 s51, 0x9d0bc00
    buffer_load_dwordx4 v[200:203], v8, s[4:7], s51 offen
    s_mov_b32 s51, 0x9d0c000
    buffer_load_dwordx4 v[204:207], v8, s[4:7], s51 offen
    s_mov_b32 s51, 0x9d0c400
    buffer_load_dwordx4 v[208:211], v8, s[4:7], s51 offen
    s_mov_b32 s51, 0x9d0c800
    buffer_load_dwordx4 v[212:215], v8, s[4:7], s51 offen
    s_mov_b32 s51, 0x9d0cc00
    buffer_load_dwordx4 v[216:219], v8, s[4:7], s51 offen
    s_mov_b32 s51, 0x9d0d000
    buffer_load_dwordx4 v[220:223], v8, s[4:7], s51 offen
    s_mov_b32 s51, 0x9d0d400
    buffer_load_dwordx4 v[224:227], v8, s[4:7], s51 offen
    s_mov_b32 s51, 0x9d0d800
    buffer_load_dwordx4 v[228:231], v8, s[4:7], s51 offen
    s_mov_b32 s51, 0x9d0dc00
    buffer_load_dwordx4 v[232:235], v8, s[4:7], s51 offen
    s_mov_b32 s51, 0x9d02000
    buffer_load_dwordx4 a[0:3], v8, s[4:7], s51 offen
    s_mov_b32 s51, 0x9d02400
    buffer_load_dwordx4 a[4:7], v8, s[4:7], s51 offen
    s_mov_b32 s51, 0x9d02800
    buffer_load_dwordx4 a[8:11], v8, s[4:7], s51 offen
    s_mov_b32 s51, 0x9d02c00
    buffer_load_dwordx4 a[12:15], v8, s[4:7], s51 offen
    s_mov_b32 s51, 0x9d03000
    buffer_load_dwordx4 a[16:19], v8, s[4:7], s51 offen
    s_mov_b32 s51, 0x9d03400
    buffer_load_dwordx4 a[20:23], v8, s[4:7], s51 offen
    s_mov_b32 s51, 0x9d03800
    buffer_load_dwordx4 a[24:27], v8, s[4:7], s51 offen
    s_mov_b32 s51, 0x9d03c00
    buffer_load_dwordx4 a[28:31], v8, s[4:7], s51 offen
    s_mov_b32 s51, 0x9d04000
    buffer_load_dwordx4 a[32:35], v8, s[4:7], s51 offen
    s_mov_b32 s51, 0x9d04400
    buffer_load_dwordx4 a[36:39], v8, s[4:7], s51 offen
    s_mov_b32 s51, 0x9d04800
    buffer_load_dwordx4 a[40:43], v8, s[4:7], s51 offen
    s_mov_b32 s51, 0x9d04c00
    buffer_load_dwordx4 a[44:47], v8, s[4:7], s51 offen
    s_mov_b32 s51, 0x9d05000
    buffer_load_dwordx4 a[48:51], v8, s[4:7], s51 offen
    s_mov_b32 s51, 0x9d05400
    buffer_load_dwordx4 a[52:55], v8, s[4:7], s51 offen
    s_mov_b32 s51, 0x9d05800
    buffer_load_dwordx4 a[56:59], v8, s[4:7], s51 offen
    s_mov_b32 s51, 0x9d05c00
    buffer_load_dwordx4 a[60:63], v8, s[4:7], s51 offen
    s_mov_b32 s51, 0x9d06000
    buffer_load_dwordx4 a[64:67], v8, s[4:7], s51 offen
    s_mov_b32 s51, 0x9d06400
    buffer_load_dwordx4 a[68:71], v8, s[4:7], s51 offen
    s_mov_b32 s51, 0x9d06800
    buffer_load_dwordx4 a[72:75], v8, s[4:7], s51 offen
    s_mov_b32 s51, 0x9d06c00
    buffer_load_dwordx4 a[76:79], v8, s[4:7], s51 offen
    s_mov_b32 s51, 0x9d07000
    buffer_load_dwordx4 a[80:83], v8, s[4:7], s51 offen
    s_mov_b32 s51, 0x9d07400
    buffer_load_dwordx4 a[84:87], v8, s[4:7], s51 offen
    s_mov_b32 s51, 0x9d07800
    buffer_load_dwordx4 a[88:91], v8, s[4:7], s51 offen
    s_mov_b32 s51, 0x9d07c00
    buffer_load_dwordx4 a[92:95], v8, s[4:7], s51 offen
    s_mov_b32 s51, 0x9d08000
    buffer_load_dwordx4 a[96:99], v8, s[4:7], s51 offen
    s_mov_b32 s51, 0x9d08400
    buffer_load_dwordx4 a[100:103], v8, s[4:7], s51 offen
    s_mov_b32 s51, 0x9d08800
    buffer_load_dwordx4 a[104:107], v8, s[4:7], s51 offen
    s_mov_b32 s51, 0x9d08c00
    buffer_load_dwordx4 a[108:111], v8, s[4:7], s51 offen
    s_mov_b32 s51, 0x9d09000
    buffer_load_dwordx4 a[112:115], v8, s[4:7], s51 offen
    s_mov_b32 s51, 0x9d09400
    buffer_load_dwordx4 a[116:119], v8, s[4:7], s51 offen
    s_mov_b32 s51, 0x9d09800
    buffer_load_dwordx4 a[120:123], v8, s[4:7], s51 offen
    s_mov_b32 s51, 0x9d09c00
    buffer_load_dwordx4 a[124:127], v8, s[4:7], s51 offen
    s_waitcnt vmcnt(48)
    v_xor_b32 v76, 0x80008000, v12
    v_xor_b32 v77, 0x80008000, v13
    v_xor_b32 v78, 0x80008000, v14
    v_xor_b32 v79, 0x80008000, v15
    v_xor_b32 v80, 0x80008000, v16
    v_xor_b32 v81, 0x80008000, v17
    v_xor_b32 v82, 0x80008000, v18
    v_xor_b32 v83, 0x80008000, v19
    v_xor_b32 v84, 0x80008000, v20
    v_xor_b32 v85, 0x80008000, v21
    v_xor_b32 v86, 0x80008000, v22
    v_xor_b32 v87, 0x80008000, v23
    v_xor_b32 v88, 0x80008000, v24
    v_xor_b32 v89, 0x80008000, v25
    v_xor_b32 v90, 0x80008000, v26
    v_xor_b32 v91, 0x80008000, v27
    v_xor_b32 v92, 0x80008000, v28
    v_xor_b32 v93, 0x80008000, v29
    v_xor_b32 v94, 0x80008000, v30
    v_xor_b32 v95, 0x80008000, v31
    v_xor_b32 v96, 0x80008000, v32
    v_xor_b32 v97, 0x80008000, v33
    v_xor_b32 v98, 0x80008000, v34
    v_xor_b32 v99, 0x80008000, v35
    v_xor_b32 v100, 0x80008000, v36
    v_xor_b32 v101, 0x80008000, v37
    v_xor_b32 v102, 0x80008000, v38
    v_xor_b32 v103, 0x80008000, v39
    v_xor_b32 v104, 0x80008000, v40
    v_xor_b32 v105, 0x80008000, v41
    v_xor_b32 v106, 0x80008000, v42
    v_xor_b32 v107, 0x80008000, v43
    s_nop 1
    v_mfma_f32_16x16x32_bf16 v[108:111], v[12:15], a[128:131], 0
    v_mfma_f32_16x16x32_bf16 v[140:143], v[44:47], a[128:131], 0
    v_mfma_f32_16x16x32_bf16 v[112:115], v[12:15], a[132:135], 0
    v_mfma_f32_16x16x32_bf16 v[144:147], v[44:47], a[132:135], 0
    v_mfma_f32_16x16x32_bf16 v[116:119], v[16:19], a[128:131], 0
    v_mfma_f32_16x16x32_bf16 v[148:151], v[48:51], a[128:131], 0
    v_mfma_f32_16x16x32_bf16 v[120:123], v[16:19], a[132:135], 0
    v_mfma_f32_16x16x32_bf16 v[152:155], v[48:51], a[132:135], 0
    v_mfma_f32_16x16x32_bf16 v[124:127], v[20:23], a[128:131], 0
    v_mfma_f32_16x16x32_bf16 v[156:159], v[52:55], a[128:131], 0
    v_mfma_f32_16x16x32_bf16 v[128:131], v[20:23], a[132:135], 0
    v_mfma_f32_16x16x32_bf16 v[160:163], v[52:55], a[132:135], 0
    v_mfma_f32_16x16x32_bf16 v[132:135], v[24:27], a[128:131], 0
    v_mfma_f32_16x16x32_bf16 v[164:167], v[56:59], a[128:131], 0
    v_mfma_f32_16x16x32_bf16 v[136:139], v[24:27], a[132:135], 0
    v_mfma_f32_16x16x32_bf16 v[168:171], v[56:59], a[132:135], 0
    v_mfma_f32_16x16x32_bf16 v[108:111], v[28:31], a[128:131], v[108:111]
    v_mfma_f32_16x16x32_bf16 v[140:143], v[60:63], a[128:131], v[140:143]
    v_mfma_f32_16x16x32_bf16 v[112:115], v[28:31], a[132:135], v[112:115]
    v_mfma_f32_16x16x32_bf16 v[144:147], v[60:63], a[132:135], v[144:147]
    v_mfma_f32_16x16x32_bf16 v[116:119], v[32:35], a[128:131], v[116:119]
    v_mfma_f32_16x16x32_bf16 v[148:151], v[64:67], a[128:131], v[148:151]
    v_mfma_f32_16x16x32_bf16 v[120:123], v[32:35], a[132:135], v[120:123]
    v_mfma_f32_16x16x32_bf16 v[152:155], v[64:67], a[132:135], v[152:155]
    v_mfma_f32_16x16x32_bf16 v[124:127], v[36:39], a[128:131], v[124:127]
    v_mfma_f32_16x16x32_bf16 v[156:159], v[68:71], a[128:131], v[156:159]
    v_mfma_f32_16x16x32_bf16 v[128:131], v[36:39], a[132:135], v[128:131]
    v_mfma_f32_16x16x32_bf16 v[160:163], v[68:71], a[132:135], v[160:163]
    v_mfma_f32_16x16x32_bf16 v[132:135], v[40:43], a[128:131], v[132:135]
    v_mfma_f32_16x16x32_bf16 v[164:167], v[72:75], a[128:131], v[164:167]
    v_mfma_f32_16x16x32_bf16 v[136:139], v[40:43], a[132:135], v[136:139]
    v_mfma_f32_16x16x32_bf16 v[168:171], v[72:75], a[132:135], v[168:171]
    v_mfma_f32_16x16x32_bf16 v[108:111], v[12:15], a[136:139], v[108:111]
    v_mfma_f32_16x16x32_bf16 v[140:143], v[44:47], a[136:139], v[140:143]
    v_mfma_f32_16x16x32_bf16 v[112:115], v[12:15], a[140:143], v[112:115]
    v_mfma_f32_16x16x32_bf16 v[144:147], v[44:47], a[140:143], v[144:147]
    v_mfma_f32_16x16x32_bf16 v[116:119], v[16:19], a[136:139], v[116:119]
    v_mfma_f32_16x16x32_bf16 v[148:151], v[48:51], a[136:139], v[148:151]
    v_mfma_f32_16x16x32_bf16 v[120:123], v[16:19], a[140:143], v[120:123]
    v_mfma_f32_16x16x32_bf16 v[152:155], v[48:51], a[140:143], v[152:155]
    v_mfma_f32_16x16x32_bf16 v[124:127], v[20:23], a[136:139], v[124:127]
    v_mfma_f32_16x16x32_bf16 v[156:159], v[52:55], a[136:139], v[156:159]
    v_mfma_f32_16x16x32_bf16 v[128:131], v[20:23], a[140:143], v[128:131]
    v_mfma_f32_16x16x32_bf16 v[160:163], v[52:55], a[140:143], v[160:163]
    v_mfma_f32_16x16x32_bf16 v[132:135], v[24:27], a[136:139], v[132:135]
    v_mfma_f32_16x16x32_bf16 v[164:167], v[56:59], a[136:139], v[164:167]
    v_mfma_f32_16x16x32_bf16 v[136:139], v[24:27], a[140:143], v[136:139]
    v_mfma_f32_16x16x32_bf16 v[168:171], v[56:59], a[140:143], v[168:171]
    v_mfma_f32_16x16x32_bf16 v[108:111], v[44:47], a[144:147], v[108:111]
    v_mfma_f32_16x16x32_bf16 v[140:143], v[76:79], a[144:147], v[140:143]
    v_mfma_f32_16x16x32_bf16 v[112:115], v[44:47], a[148:151], v[112:115]
    v_mfma_f32_16x16x32_bf16 v[144:147], v[76:79], a[148:151], v[144:147]
    v_mfma_f32_16x16x32_bf16 v[116:119], v[48:51], a[144:147], v[116:119]
    v_mfma_f32_16x16x32_bf16 v[148:151], v[80:83], a[144:147], v[148:151]
    v_mfma_f32_16x16x32_bf16 v[120:123], v[48:51], a[148:151], v[120:123]
    v_mfma_f32_16x16x32_bf16 v[152:155], v[80:83], a[148:151], v[152:155]
    v_mfma_f32_16x16x32_bf16 v[124:127], v[52:55], a[144:147], v[124:127]
    v_mfma_f32_16x16x32_bf16 v[156:159], v[84:87], a[144:147], v[156:159]
    v_mfma_f32_16x16x32_bf16 v[128:131], v[52:55], a[148:151], v[128:131]
    v_mfma_f32_16x16x32_bf16 v[160:163], v[84:87], a[148:151], v[160:163]
    v_mfma_f32_16x16x32_bf16 v[132:135], v[56:59], a[144:147], v[132:135]
    v_mfma_f32_16x16x32_bf16 v[164:167], v[88:91], a[144:147], v[164:167]
    v_mfma_f32_16x16x32_bf16 v[136:139], v[56:59], a[148:151], v[136:139]
    v_mfma_f32_16x16x32_bf16 v[168:171], v[88:91], a[148:151], v[168:171]
    v_mfma_f32_16x16x32_bf16 v[108:111], v[60:63], a[144:147], v[108:111]
    v_mfma_f32_16x16x32_bf16 v[140:143], v[92:95], a[144:147], v[140:143]
    v_mfma_f32_16x16x32_bf16 v[112:115], v[60:63], a[148:151], v[112:115]
    v_mfma_f32_16x16x32_bf16 v[144:147], v[92:95], a[148:151], v[144:147]
    v_mfma_f32_16x16x32_bf16 v[116:119], v[64:67], a[144:147], v[116:119]
    v_mfma_f32_16x16x32_bf16 v[148:151], v[96:99], a[144:147], v[148:151]
    v_mfma_f32_16x16x32_bf16 v[120:123], v[64:67], a[148:151], v[120:123]
    v_mfma_f32_16x16x32_bf16 v[152:155], v[96:99], a[148:151], v[152:155]
    v_mfma_f32_16x16x32_bf16 v[124:127], v[68:71], a[144:147], v[124:127]
    v_mfma_f32_16x16x32_bf16 v[156:159], v[100:103], a[144:147], v[156:159]
    v_mfma_f32_16x16x32_bf16 v[128:131], v[68:71], a[148:151], v[128:131]
    v_mfma_f32_16x16x32_bf16 v[160:163], v[100:103], a[148:151], v[160:163]
    v_mfma_f32_16x16x32_bf16 v[132:135], v[72:75], a[144:147], v[132:135]
    v_mfma_f32_16x16x32_bf16 v[164:167], v[104:107], a[144:147], v[164:167]
    v_mfma_f32_16x16x32_bf16 v[136:139], v[72:75], a[148:151], v[136:139]
    v_mfma_f32_16x16x32_bf16 v[168:171], v[104:107], a[148:151], v[168:171]
    v_mfma_f32_16x16x32_bf16 v[108:111], v[44:47], a[152:155], v[108:111]
    v_mfma_f32_16x16x32_bf16 v[140:143], v[76:79], a[152:155], v[140:143]
    v_mfma_f32_16x16x32_bf16 v[112:115], v[44:47], a[156:159], v[112:115]
    v_mfma_f32_16x16x32_bf16 v[144:147], v[76:79], a[156:159], v[144:147]
    v_mfma_f32_16x16x32_bf16 v[116:119], v[48:51], a[152:155], v[116:119]
    v_mfma_f32_16x16x32_bf16 v[148:151], v[80:83], a[152:155], v[148:151]
    v_mfma_f32_16x16x32_bf16 v[120:123], v[48:51], a[156:159], v[120:123]
    v_mfma_f32_16x16x32_bf16 v[152:155], v[80:83], a[156:159], v[152:155]
    v_mfma_f32_16x16x32_bf16 v[124:127], v[52:55], a[152:155], v[124:127]
    v_mfma_f32_16x16x32_bf16 v[156:159], v[84:87], a[152:155], v[156:159]
    v_mfma_f32_16x16x32_bf16 v[128:131], v[52:55], a[156:159], v[128:131]
    v_mfma_f32_16x16x32_bf16 v[160:163], v[84:87], a[156:159], v[160:163]
    v_mfma_f32_16x16x32_bf16 v[132:135], v[56:59], a[152:155], v[132:135]
    v_mfma_f32_16x16x32_bf16 v[164:167], v[88:91], a[152:155], v[164:167]
    v_mfma_f32_16x16x32_bf16 v[136:139], v[56:59], a[156:159], v[136:139]
    v_mfma_f32_16x16x32_bf16 v[168:171], v[88:91], a[156:159], v[168:171]
    s_nop 7
    s_waitcnt vmcnt(32)
    v_mul_f32 v6, v108, v172
    v_mul_f32 v7, v140, v172
    v_fma_f32 v6, v140, v204, v6
    v_fma_f32 v140, -v108, v204, v7
    v_mov_b32 v108, v6
    v_mul_f32 v6, v109, v173
    v_mul_f32 v7, v141, v173
    v_fma_f32 v6, v141, v205, v6
    v_fma_f32 v141, -v109, v205, v7
    v_mov_b32 v109, v6
    v_mul_f32 v6, v110, v174
    v_mul_f32 v7, v142, v174
    v_fma_f32 v6, v142, v206, v6
    v_fma_f32 v142, -v110, v206, v7
    v_mov_b32 v110, v6
    v_mul_f32 v6, v111, v175
    v_mul_f32 v7, v143, v175
    v_fma_f32 v6, v143, v207, v6
    v_fma_f32 v143, -v111, v207, v7
    v_mov_b32 v111, v6
    v_mul_f32 v6, v112, v176
    v_mul_f32 v7, v144, v176
    v_fma_f32 v6, v144, v208, v6
    v_fma_f32 v144, -v112, v208, v7
    v_mov_b32 v112, v6
    v_mul_f32 v6, v113, v177
    v_mul_f32 v7, v145, v177
    v_fma_f32 v6, v145, v209, v6
    v_fma_f32 v145, -v113, v209, v7
    v_mov_b32 v113, v6
    v_mul_f32 v6, v114, v178
    v_mul_f32 v7, v146, v178
    v_fma_f32 v6, v146, v210, v6
    v_fma_f32 v146, -v114, v210, v7
    v_mov_b32 v114, v6
    v_mul_f32 v6, v115, v179
    v_mul_f32 v7, v147, v179
    v_fma_f32 v6, v147, v211, v6
    v_fma_f32 v147, -v115, v211, v7
    v_mov_b32 v115, v6
    v_mul_f32 v6, v116, v180
    v_mul_f32 v7, v148, v180
    v_fma_f32 v6, v148, v212, v6
    v_fma_f32 v148, -v116, v212, v7
    v_mov_b32 v116, v6
    v_mul_f32 v6, v117, v181
    v_mul_f32 v7, v149, v181
    v_fma_f32 v6, v149, v213, v6
    v_fma_f32 v149, -v117, v213, v7
    v_mov_b32 v117, v6
    v_mul_f32 v6, v118, v182
    v_mul_f32 v7, v150, v182
    v_fma_f32 v6, v150, v214, v6
    v_fma_f32 v150, -v118, v214, v7
    v_mov_b32 v118, v6
    v_mul_f32 v6, v119, v183
    v_mul_f32 v7, v151, v183
    v_fma_f32 v6, v151, v215, v6
    v_fma_f32 v151, -v119, v215, v7
    v_mov_b32 v119, v6
    v_mul_f32 v6, v120, v184
    v_mul_f32 v7, v152, v184
    v_fma_f32 v6, v152, v216, v6
    v_fma_f32 v152, -v120, v216, v7
    v_mov_b32 v120, v6
    v_mul_f32 v6, v121, v185
    v_mul_f32 v7, v153, v185
    v_fma_f32 v6, v153, v217, v6
    v_fma_f32 v153, -v121, v217, v7
    v_mov_b32 v121, v6
    v_mul_f32 v6, v122, v186
    v_mul_f32 v7, v154, v186
    v_fma_f32 v6, v154, v218, v6
    v_fma_f32 v154, -v122, v218, v7
    v_mov_b32 v122, v6
    v_mul_f32 v6, v123, v187
    v_mul_f32 v7, v155, v187
    v_fma_f32 v6, v155, v219, v6
    v_fma_f32 v155, -v123, v219, v7
    v_mov_b32 v123, v6
    v_mul_f32 v6, v124, v188
    v_mul_f32 v7, v156, v188
    v_fma_f32 v6, v156, v220, v6
    v_fma_f32 v156, -v124, v220, v7
    v_mov_b32 v124, v6
    v_mul_f32 v6, v125, v189
    v_mul_f32 v7, v157, v189
    v_fma_f32 v6, v157, v221, v6
    v_fma_f32 v157, -v125, v221, v7
    v_mov_b32 v125, v6
    v_mul_f32 v6, v126, v190
    v_mul_f32 v7, v158, v190
    v_fma_f32 v6, v158, v222, v6
    v_fma_f32 v158, -v126, v222, v7
    v_mov_b32 v126, v6
    v_mul_f32 v6, v127, v191
    v_mul_f32 v7, v159, v191
    v_fma_f32 v6, v159, v223, v6
    v_fma_f32 v159, -v127, v223, v7
    v_mov_b32 v127, v6
    v_mul_f32 v6, v128, v192
    v_mul_f32 v7, v160, v192
    v_fma_f32 v6, v160, v224, v6
    v_fma_f32 v160, -v128, v224, v7
    v_mov_b32 v128, v6
    v_mul_f32 v6, v129, v193
    v_mul_f32 v7, v161, v193
    v_fma_f32 v6, v161, v225, v6
    v_fma_f32 v161, -v129, v225, v7
    v_mov_b32 v129, v6
    v_mul_f32 v6, v130, v194
    v_mul_f32 v7, v162, v194
    v_fma_f32 v6, v162, v226, v6
    v_fma_f32 v162, -v130, v226, v7
    v_mov_b32 v130, v6
    v_mul_f32 v6, v131, v195
    v_mul_f32 v7, v163, v195
    v_fma_f32 v6, v163, v227, v6
    v_fma_f32 v163, -v131, v227, v7
    v_mov_b32 v131, v6
    v_mul_f32 v6, v132, v196
    v_mul_f32 v7, v164, v196
    v_fma_f32 v6, v164, v228, v6
    v_fma_f32 v164, -v132, v228, v7
    v_mov_b32 v132, v6
    v_mul_f32 v6, v133, v197
    v_mul_f32 v7, v165, v197
    v_fma_f32 v6, v165, v229, v6
    v_fma_f32 v165, -v133, v229, v7
    v_mov_b32 v133, v6
    v_mul_f32 v6, v134, v198
    v_mul_f32 v7, v166, v198
    v_fma_f32 v6, v166, v230, v6
    v_fma_f32 v166, -v134, v230, v7
    v_mov_b32 v134, v6
    v_mul_f32 v6, v135, v199
    v_mul_f32 v7, v167, v199
    v_fma_f32 v6, v167, v231, v6
    v_fma_f32 v167, -v135, v231, v7
    v_mov_b32 v135, v6
    v_mul_f32 v6, v136, v200
    v_mul_f32 v7, v168, v200
    v_fma_f32 v6, v168, v232, v6
    v_fma_f32 v168, -v136, v232, v7
    v_mov_b32 v136, v6
    v_mul_f32 v6, v137, v201
    v_mul_f32 v7, v169, v201
    v_fma_f32 v6, v169, v233, v6
    v_fma_f32 v169, -v137, v233, v7
    v_mov_b32 v137, v6
    v_mul_f32 v6, v138, v202
    v_mul_f32 v7, v170, v202
    v_fma_f32 v6, v170, v234, v6
    v_fma_f32 v170, -v138, v234, v7
    v_mov_b32 v138, v6
    v_mul_f32 v6, v139, v203
    v_mul_f32 v7, v171, v203
    v_fma_f32 v6, v171, v235, v6
    v_fma_f32 v171, -v139, v235, v7
    v_mov_b32 v139, v6
    s_lshl_b32 s44, s41, 13
    s_add_u32 s44, s44, 0x9e00000
    s_add_u32 s45, s44, 4096
    buffer_load_dwordx4 v[172:175], v8, s[4:7], s44 offen offset:0
    buffer_load_dwordx4 v[176:179], v8, s[4:7], s44 offen offset:1024
    buffer_load_dwordx4 v[180:183], v8, s[4:7], s44 offen offset:2048
    buffer_load_dwordx4 v[184:187], v8, s[4:7], s44 offen offset:3072
    buffer_load_dwordx4 v[188:191], v8, s[4:7], s45 offen offset:0
    buffer_load_dwordx4 v[192:195], v8, s[4:7], s45 offen offset:1024
    buffer_load_dwordx4 v[196:199], v8, s[4:7], s45 offen offset:2048
    buffer_load_dwordx4 v[200:203], v8, s[4:7], s45 offen offset:3072
    v_cvt_pk_bf16_f32 v12, v108, v109
    v_lshlrev_b32 v6, 16, v12
    v_and_b32 v7, 0xffff0000, v12
    v_sub_f32 v6, v108, v6
    v_sub_f32 v7, v109, v7
    v_cvt_pk_bf16_f32 v28, v6, v7
    v_cvt_pk_bf16_f32 v13, v110, v111
    v_lshlrev_b32 v6, 16, v13
    v_and_b32 v7, 0xffff0000, v13
    v_sub_f32 v6, v110, v6
    v_sub_f32 v7, v111, v7
    v_cvt_pk_bf16_f32 v29, v6, v7
    v_cvt_pk_bf16_f32 v14, v116, v117
    v_lshlrev_b32 v6, 16, v14
    v_and_b32 v7, 0xffff0000, v14
    v_sub_f32 v6, v116, v6
    v_sub_f32 v7, v117, v7
    v_cvt_pk_bf16_f32 v30, v6, v7
    v_cvt_pk_bf16_f32 v15, v118, v119
    v_lshlrev_b32 v6, 16, v15
    v_and_b32 v7, 0xffff0000, v15
    v_sub_f32 v6, v118, v6
    v_sub_f32 v7, v119, v7
    v_cvt_pk_bf16_f32 v31, v6, v7
    v_cvt_pk_bf16_f32 v16, v124, v125
    v_lshlrev_b32 v6, 16, v16
    v_and_b32 v7, 0xffff0000, v16
    v_sub_f32 v6, v124, v6
    v_sub_f32 v7, v125, v7
    v_cvt_pk_bf16_f32 v32, v6, v7
    v_cvt_pk_bf16_f32 v17, v126, v127
    v_lshlrev_b32 v6, 16, v17
    v_and_b32 v7, 0xffff0000, v17
    v_sub_f32 v6, v126, v6
    v_sub_f32 v7, v127, v7
    v_cvt_pk_bf16_f32 v33, v6, v7
    v_cvt_pk_bf16_f32 v18, v132, v133
    v_lshlrev_b32 v6, 16, v18
    v_and_b32 v7, 0xffff0000, v18
    v_sub_f32 v6, v132, v6
    v_sub_f32 v7, v133, v7
    v_cvt_pk_bf16_f32 v34, v6, v7
    v_cvt_pk_bf16_f32 v19, v134, v135
    v_lshlrev_b32 v6, 16, v19
    v_and_b32 v7, 0xffff0000, v19
    v_sub_f32 v6, v134, v6
    v_sub_f32 v7, v135, v7
    v_cvt_pk_bf16_f32 v35, v6, v7
    v_cvt_pk_bf16_f32 v20, v112, v113
    v_lshlrev_b32 v6, 16, v20
    v_and_b32 v7, 0xffff0000, v20
    v_sub_f32 v6, v112, v6
    v_sub_f32 v7, v113, v7
    v_cvt_pk_bf16_f32 v36, v6, v7
    v_cvt_pk_bf16_f32 v21, v114, v115
    v_lshlrev_b32 v6, 16, v21
    v_and_b32 v7, 0xffff0000, v21
    v_sub_f32 v6, v114, v6
    v_sub_f32 v7, v115, v7
    v_cvt_pk_bf16_f32 v37, v6, v7
    v_cvt_pk_bf16_f32 v22, v120, v121
    v_lshlrev_b32 v6, 16, v22
    v_and_b32 v7, 0xffff0000, v22
    v_sub_f32 v6, v120, v6
    v_sub_f32 v7, v121, v7
    v_cvt_pk_bf16_f32 v38, v6, v7
    v_cvt_pk_bf16_f32 v23, v122, v123
    v_lshlrev_b32 v6, 16, v23
    v_and_b32 v7, 0xffff0000, v23
    v_sub_f32 v6, v122, v6
    v_sub_f32 v7, v123, v7
    v_cvt_pk_bf16_f32 v39, v6, v7
    v_cvt_pk_bf16_f32 v24, v128, v129
    v_lshlrev_b32 v6, 16, v24
    v_and_b32 v7, 0xffff0000, v24
    v_sub_f32 v6, v128, v6
    v_sub_f32 v7, v129, v7
    v_cvt_pk_bf16_f32 v40, v6, v7
    v_cvt_pk_bf16_f32 v25, v130, v131
    v_lshlrev_b32 v6, 16, v25
    v_and_b32 v7, 0xffff0000, v25
    v_sub_f32 v6, v130, v6
    v_sub_f32 v7, v131, v7
    v_cvt_pk_bf16_f32 v41, v6, v7
    v_cvt_pk_bf16_f32 v26, v136, v137
    v_lshlrev_b32 v6, 16, v26
    v_and_b32 v7, 0xffff0000, v26
    v_sub_f32 v6, v136, v6
    v_sub_f32 v7, v137, v7
    v_cvt_pk_bf16_f32 v42, v6, v7
    v_cvt_pk_bf16_f32 v27, v138, v139
    v_lshlrev_b32 v6, 16, v27
    v_and_b32 v7, 0xffff0000, v27
    v_sub_f32 v6, v138, v6
    v_sub_f32 v7, v139, v7
    v_cvt_pk_bf16_f32 v43, v6, v7
    v_cvt_pk_bf16_f32 v44, v140, v141
    v_lshlrev_b32 v6, 16, v44
    v_and_b32 v7, 0xffff0000, v44
    v_sub_f32 v6, v140, v6
    v_sub_f32 v7, v141, v7
    v_cvt_pk_bf16_f32 v60, v6, v7
    v_cvt_pk_bf16_f32 v45, v142, v143
    v_lshlrev_b32 v6, 16, v45
    v_and_b32 v7, 0xffff0000, v45
    v_sub_f32 v6, v142, v6
    v_sub_f32 v7, v143, v7
    v_cvt_pk_bf16_f32 v61, v6, v7
    v_cvt_pk_bf16_f32 v46, v148, v149
    v_lshlrev_b32 v6, 16, v46
    v_and_b32 v7, 0xffff0000, v46
    v_sub_f32 v6, v148, v6
    v_sub_f32 v7, v149, v7
    v_cvt_pk_bf16_f32 v62, v6, v7
    v_cvt_pk_bf16_f32 v47, v150, v151
    v_lshlrev_b32 v6, 16, v47
    v_and_b32 v7, 0xffff0000, v47
    v_sub_f32 v6, v150, v6
    v_sub_f32 v7, v151, v7
    v_cvt_pk_bf16_f32 v63, v6, v7
    v_cvt_pk_bf16_f32 v48, v156, v157
    v_lshlrev_b32 v6, 16, v48
    v_and_b32 v7, 0xffff0000, v48
    v_sub_f32 v6, v156, v6
    v_sub_f32 v7, v157, v7
    v_cvt_pk_bf16_f32 v64, v6, v7
    v_cvt_pk_bf16_f32 v49, v158, v159
    v_lshlrev_b32 v6, 16, v49
    v_and_b32 v7, 0xffff0000, v49
    v_sub_f32 v6, v158, v6
    v_sub_f32 v7, v159, v7
    v_cvt_pk_bf16_f32 v65, v6, v7
    v_cvt_pk_bf16_f32 v50, v164, v165
    v_lshlrev_b32 v6, 16, v50
    v_and_b32 v7, 0xffff0000, v50
    v_sub_f32 v6, v164, v6
    v_sub_f32 v7, v165, v7
    v_cvt_pk_bf16_f32 v66, v6, v7
    v_cvt_pk_bf16_f32 v51, v166, v167
    v_lshlrev_b32 v6, 16, v51
    v_and_b32 v7, 0xffff0000, v51
    v_sub_f32 v6, v166, v6
    v_sub_f32 v7, v167, v7
    v_cvt_pk_bf16_f32 v67, v6, v7
    v_cvt_pk_bf16_f32 v52, v144, v145
    v_lshlrev_b32 v6, 16, v52
    v_and_b32 v7, 0xffff0000, v52
    v_sub_f32 v6, v144, v6
    v_sub_f32 v7, v145, v7
    v_cvt_pk_bf16_f32 v68, v6, v7
    v_cvt_pk_bf16_f32 v53, v146, v147
    v_lshlrev_b32 v6, 16, v53
    v_and_b32 v7, 0xffff0000, v53
    v_sub_f32 v6, v146, v6
    v_sub_f32 v7, v147, v7
    v_cvt_pk_bf16_f32 v69, v6, v7
    v_cvt_pk_bf16_f32 v54, v152, v153
    v_lshlrev_b32 v6, 16, v54
    v_and_b32 v7, 0xffff0000, v54
    v_sub_f32 v6, v152, v6
    v_sub_f32 v7, v153, v7
    v_cvt_pk_bf16_f32 v70, v6, v7
    v_cvt_pk_bf16_f32 v55, v154, v155
    v_lshlrev_b32 v6, 16, v55
    v_and_b32 v7, 0xffff0000, v55
    v_sub_f32 v6, v154, v6
    v_sub_f32 v7, v155, v7
    v_cvt_pk_bf16_f32 v71, v6, v7
    v_cvt_pk_bf16_f32 v56, v160, v161
    v_lshlrev_b32 v6, 16, v56
    v_and_b32 v7, 0xffff0000, v56
    v_sub_f32 v6, v160, v6
    v_sub_f32 v7, v161, v7
    v_cvt_pk_bf16_f32 v72, v6, v7
    v_cvt_pk_bf16_f32 v57, v162, v163
    v_lshlrev_b32 v6, 16, v57
    v_and_b32 v7, 0xffff0000, v57
    v_sub_f32 v6, v162, v6
    v_sub_f32 v7, v163, v7
    v_cvt_pk_bf16_f32 v73, v6, v7
    v_cvt_pk_bf16_f32 v58, v168, v169
    v_lshlrev_b32 v6, 16, v58
    v_and_b32 v7, 0xffff0000, v58
    v_sub_f32 v6, v168, v6
    v_sub_f32 v7, v169, v7
    v_cvt_pk_bf16_f32 v74, v6, v7
    v_cvt_pk_bf16_f32 v59, v170, v171
    v_lshlrev_b32 v6, 16, v59
    v_and_b32 v7, 0xffff0000, v59
    v_sub_f32 v6, v170, v6
    v_sub_f32 v7, v171, v7
    v_cvt_pk_bf16_f32 v75, v6, v7
    v_xor_b32 v76, 0x80008000, v12
    v_xor_b32 v77, 0x80008000, v13
    v_xor_b32 v78, 0x80008000, v14
    v_xor_b32 v79, 0x80008000, v15
    v_xor_b32 v80, 0x80008000, v16
    v_xor_b32 v81, 0x80008000, v17
    v_xor_b32 v82, 0x80008000, v18
    v_xor_b32 v83, 0x80008000, v19
    v_xor_b32 v84, 0x80008000, v20
    v_xor_b32 v85, 0x80008000, v21
    v_xor_b32 v86, 0x80008000, v22
    v_xor_b32 v87, 0x80008000, v23
    v_xor_b32 v88, 0x80008000, v24
    v_xor_b32 v89, 0x80008000, v25
    v_xor_b32 v90, 0x80008000, v26
    v_xor_b32 v91, 0x80008000, v27
    v_xor_b32 v92, 0x80008000, v28
    v_xor_b32 v93, 0x80008000, v29
    v_xor_b32 v94, 0x80008000, v30
    v_xor_b32 v95, 0x80008000, v31
    v_xor_b32 v96, 0x80008000, v32
    v_xor_b32 v97, 0x80008000, v33
    v_xor_b32 v98, 0x80008000, v34
    v_xor_b32 v99, 0x80008000, v35
    v_xor_b32 v100, 0x80008000, v36
    v_xor_b32 v101, 0x80008000, v37
    v_xor_b32 v102, 0x80008000, v38
    v_xor_b32 v103, 0x80008000, v39
    v_xor_b32 v104, 0x80008000, v40
    v_xor_b32 v105, 0x80008000, v41
    v_xor_b32 v106, 0x80008000, v42
    v_xor_b32 v107, 0x80008000, v43
    s_waitcnt vmcnt(8)
    s_nop 1
    v_mfma_f32_16x16x32_bf16 v[108:111], a[0:3], v[12:15], 0
    v_mfma_f32_16x16x32_bf16 v[140:143], a[0:3], v[44:47], 0
    v_mfma_f32_16x16x32_bf16 v[112:115], a[0:3], v[20:23], 0
    v_mfma_f32_16x16x32_bf16 v[144:147], a[0:3], v[52:55], 0
    v_mfma_f32_16x16x32_bf16 v[116:119], a[8:11], v[12:15], 0
    v_mfma_f32_16x16x32_bf16 v[148:151], a[8:11], v[44:47], 0
    v_mfma_f32_16x16x32_bf16 v[120:123], a[8:11], v[20:23], 0
    v_mfma_f32_16x16x32_bf16 v[152:155], a[8:11], v[52:55], 0
    v_mfma_f32_16x16x32_bf16 v[124:127], a[16:19], v[12:15], 0
    v_mfma_f32_16x16x32_bf16 v[156:159], a[16:19], v[44:47], 0
    v_mfma_f32_16x16x32_bf16 v[128:131], a[16:19], v[20:23], 0
    v_mfma_f32_16x16x32_bf16 v[160:163], a[16:19], v[52:55], 0
    v_mfma_f32_16x16x32_bf16 v[132:135], a[24:27], v[12:15], 0
    v_mfma_f32_16x16x32_bf16 v[164:167], a[24:27], v[44:47], 0
    v_mfma_f32_16x16x32_bf16 v[136:139], a[24:27], v[20:23], 0
    v_mfma_f32_16x16x32_bf16 v[168:171], a[24:27], v[52:55], 0
    v_mfma_f32_16x16x32_bf16 v[108:111], a[0:3], v[28:31], v[108:111]
    v_mfma_f32_16x16x32_bf16 v[140:143], a[0:3], v[60:63], v[140:143]
    v_mfma_f32_16x16x32_bf16 v[112:115], a[0:3], v[36:39], v[112:115]
    v_mfma_f32_16x16x32_bf16 v[144:147], a[0:3], v[68:71], v[144:147]
    v_mfma_f32_16x16x32_bf16 v[116:119], a[8:11], v[28:31], v[116:119]
    v_mfma_f32_16x16x32_bf16 v[148:151], a[8:11], v[60:63], v[148:151]
    v_mfma_f32_16x16x32_bf16 v[120:123], a[8:11], v[36:39], v[120:123]
    v_mfma_f32_16x16x32_bf16 v[152:155], a[8:11], v[68:71], v[152:155]
    v_mfma_f32_16x16x32_bf16 v[124:127], a[16:19], v[28:31], v[124:127]
    v_mfma_f32_16x16x32_bf16 v[156:159], a[16:19], v[60:63], v[156:159]
    v_mfma_f32_16x16x32_bf16 v[128:131], a[16:19], v[36:39], v[128:131]
    v_mfma_f32_16x16x32_bf16 v[160:163], a[16:19], v[68:71], v[160:163]
    v_mfma_f32_16x16x32_bf16 v[132:135], a[24:27], v[28:31], v[132:135]
    v_mfma_f32_16x16x32_bf16 v[164:167], a[24:27], v[60:63], v[164:167]
    v_mfma_f32_16x16x32_bf16 v[136:139], a[24:27], v[36:39], v[136:139]
    v_mfma_f32_16x16x32_bf16 v[168:171], a[24:27], v[68:71], v[168:171]
    v_mfma_f32_16x16x32_bf16 v[108:111], a[32:35], v[12:15], v[108:111]
    v_mfma_f32_16x16x32_bf16 v[140:143], a[32:35], v[44:47], v[140:143]
    v_mfma_f32_16x16x32_bf16 v[112:115], a[32:35], v[20:23], v[112:115]
    v_mfma_f32_16x16x32_bf16 v[144:147], a[32:35], v[52:55], v[144:147]
    v_mfma_f32_16x16x32_bf16 v[116:119], a[40:43], v[12:15], v[116:119]
    v_mfma_f32_16x16x32_bf16 v[148:151], a[40:43], v[44:47], v[148:151]
    v_mfma_f32_16x16x32_bf16 v[120:123], a[40:43], v[20:23], v[120:123]
    v_mfma_f32_16x16x32_bf16 v[152:155], a[40:43], v[52:55], v[152:155]
    v_mfma_f32_16x16x32_bf16 v[124:127], a[48:51], v[12:15], v[124:127]
    v_mfma_f32_16x16x32_bf16 v[156:159], a[48:51], v[44:47], v[156:159]
    v_mfma_f32_16x16x32_bf16 v[128:131], a[48:51], v[20:23], v[128:131]
    v_mfma_f32_16x16x32_bf16 v[160:163], a[48:51], v[52:55], v[160:163]
    v_mfma_f32_16x16x32_bf16 v[132:135], a[56:59], v[12:15], v[132:135]
    v_mfma_f32_16x16x32_bf16 v[164:167], a[56:59], v[44:47], v[164:167]
    v_mfma_f32_16x16x32_bf16 v[136:139], a[56:59], v[20:23], v[136:139]
    v_mfma_f32_16x16x32_bf16 v[168:171], a[56:59], v[52:55], v[168:171]
    v_mfma_f32_16x16x32_bf16 v[108:111], a[64:67], v[44:47], v[108:111]
    v_mfma_f32_16x16x32_bf16 v[140:143], a[64:67], v[76:79], v[140:143]
    v_mfma_f32_16x16x32_bf16 v[112:115], a[64:67], v[52:55], v[112:115]
    v_mfma_f32_16x16x32_bf16 v[144:147], a[64:67], v[84:87], v[144:147]
    v_mfma_f32_16x16x32_bf16 v[116:119], a[72:75], v[44:47], v[116:119]
    v_mfma_f32_16x16x32_bf16 v[148:151], a[72:75], v[76:79], v[148:151]
    v_mfma_f32_16x16x32_bf16 v[120:123], a[72:75], v[52:55], v[120:123]
    v_mfma_f32_16x16x32_bf16 v[152:155], a[72:75], v[84:87], v[152:155]
    v_mfma_f32_16x16x32_bf16 v[124:127], a[80:83], v[44:47], v[124:127]
    v_mfma_f32_16x16x32_bf16 v[156:159], a[80:83], v[76:79], v[156:159]
    v_mfma_f32_16x16x32_bf16 v[128:131], a[80:83], v[52:55], v[128:131]
    v_mfma_f32_16x16x32_bf16 v[160:163], a[80:83], v[84:87], v[160:163]
    v_mfma_f32_16x16x32_bf16 v[132:135], a[88:91], v[44:47], v[132:135]
    v_mfma_f32_16x16x32_bf16 v[164:167], a[88:91], v[76:79], v[164:167]
    v_mfma_f32_16x16x32_bf16 v[136:139], a[88:91], v[52:55], v[136:139]
    v_mfma_f32_16x16x32_bf16 v[168:171], a[88:91], v[84:87], v[168:171]
    v_mfma_f32_16x16x32_bf16 v[108:111], a[64:67], v[60:63], v[108:111]
    v_mfma_f32_16x16x32_bf16 v[140:143], a[64:67], v[92:95], v[140:143]
    v_mfma_f32_16x16x32_bf16 v[112:115], a[64:67], v[68:71], v[112:115]
    v_mfma_f32_16x16x32_bf16 v[144:147], a[64:67], v[100:103], v[144:147]
    v_mfma_f32_16x16x32_bf16 v[116:119], a[72:75], v[60:63], v[116:119]
    v_mfma_f32_16x16x32_bf16 v[148:151], a[72:75], v[92:95], v[148:151]
    v_mfma_f32_16x16x32_bf16 v[120:123], a[72:75], v[68:71], v[120:123]
    v_mfma_f32_16x16x32_bf16 v[152:155], a[72:75], v[100:103], v[152:155]
    v_mfma_f32_16x16x32_bf16 v[124:127], a[80:83], v[60:63], v[124:127]
    v_mfma_f32_16x16x32_bf16 v[156:159], a[80:83], v[92:95], v[156:159]
    v_mfma_f32_16x16x32_bf16 v[128:131], a[80:83], v[68:71], v[128:131]
    v_mfma_f32_16x16x32_bf16 v[160:163], a[80:83], v[100:103], v[160:163]
    v_mfma_f32_16x16x32_bf16 v[132:135], a[88:91], v[60:63], v[132:135]
    v_mfma_f32_16x16x32_bf16 v[164:167], a[88:91], v[92:95], v[164:167]
    v_mfma_f32_16x16x32_bf16 v[136:139], a[88:91], v[68:71], v[136:139]
    v_mfma_f32_16x16x32_bf16 v[168:171], a[88:91], v[100:103], v[168:171]
    v_mfma_f32_16x16x32_bf16 v[108:111], a[96:99], v[44:47], v[108:111]
    v_mfma_f32_16x16x32_bf16 v[140:143], a[96:99], v[76:79], v[140:143]
    v_mfma_f32_16x16x32_bf16 v[112:115], a[96:99], v[52:55], v[112:115]
    v_mfma_f32_16x16x32_bf16 v[144:147], a[96:99], v[84:87], v[144:147]
    v_mfma_f32_16x16x32_bf16 v[116:119], a[104:107], v[44:47], v[116:119]
    v_mfma_f32_16x16x32_bf16 v[148:151], a[104:107], v[76:79], v[148:151]
    v_mfma_f32_16x16x32_bf16 v[120:123], a[104:107], v[52:55], v[120:123]
    v_mfma_f32_16x16x32_bf16 v[152:155], a[104:107], v[84:87], v[152:155]
    v_mfma_f32_16x16x32_bf16 v[124:127], a[112:115], v[44:47], v[124:127]
    v_mfma_f32_16x16x32_bf16 v[156:159], a[112:115], v[76:79], v[156:159]
    v_mfma_f32_16x16x32_bf16 v[128:131], a[112:115], v[52:55], v[128:131]
    v_mfma_f32_16x16x32_bf16 v[160:163], a[112:115], v[84:87], v[160:163]
    v_mfma_f32_16x16x32_bf16 v[132:135], a[120:123], v[44:47], v[132:135]
    v_mfma_f32_16x16x32_bf16 v[164:167], a[120:123], v[76:79], v[164:167]
    v_mfma_f32_16x16x32_bf16 v[136:139], a[120:123], v[52:55], v[136:139]
    v_mfma_f32_16x16x32_bf16 v[168:171], a[120:123], v[84:87], v[168:171]
    v_mfma_f32_16x16x32_bf16 v[108:111], a[4:7], v[16:19], v[108:111]
    v_mfma_f32_16x16x32_bf16 v[140:143], a[4:7], v[48:51], v[140:143]
    v_mfma_f32_16x16x32_bf16 v[112:115], a[4:7], v[24:27], v[112:115]
    v_mfma_f32_16x16x32_bf16 v[144:147], a[4:7], v[56:59], v[144:147]
    v_mfma_f32_16x16x32_bf16 v[116:119], a[12:15], v[16:19], v[116:119]
    v_mfma_f32_16x16x32_bf16 v[148:151], a[12:15], v[48:51], v[148:151]
    v_mfma_f32_16x16x32_bf16 v[120:123], a[12:15], v[24:27], v[120:123]
    v_mfma_f32_16x16x32_bf16 v[152:155], a[12:15], v[56:59], v[152:155]
    v_mfma_f32_16x16x32_bf16 v[124:127], a[20:23], v[16:19], v[124:127]
    v_mfma_f32_16x16x32_bf16 v[156:159], a[20:23], v[48:51], v[156:159]
    v_mfma_f32_16x16x32_bf16 v[128:131], a[20:23], v[24:27], v[128:131]
    v_mfma_f32_16x16x32_bf16 v[160:163], a[20:23], v[56:59], v[160:163]
    v_mfma_f32_16x16x32_bf16 v[132:135], a[28:31], v[16:19], v[132:135]
    v_mfma_f32_16x16x32_bf16 v[164:167], a[28:31], v[48:51], v[164:167]
    v_mfma_f32_16x16x32_bf16 v[136:139], a[28:31], v[24:27], v[136:139]
    v_mfma_f32_16x16x32_bf16 v[168:171], a[28:31], v[56:59], v[168:171]
    v_mfma_f32_16x16x32_bf16 v[108:111], a[4:7], v[32:35], v[108:111]
    v_mfma_f32_16x16x32_bf16 v[140:143], a[4:7], v[64:67], v[140:143]
    v_mfma_f32_16x16x32_bf16 v[112:115], a[4:7], v[40:43], v[112:115]
    v_mfma_f32_16x16x32_bf16 v[144:147], a[4:7], v[72:75], v[144:147]
    v_mfma_f32_16x16x32_bf16 v[116:119], a[12:15], v[32:35], v[116:119]
    v_mfma_f32_16x16x32_bf16 v[148:151], a[12:15], v[64:67], v[148:151]
    v_mfma_f32_16x16x32_bf16 v[120:123], a[12:15], v[40:43], v[120:123]
    v_mfma_f32_16x16x32_bf16 v[152:155], a[12:15], v[72:75], v[152:155]
    v_mfma_f32_16x16x32_bf16 v[124:127], a[20:23], v[32:35], v[124:127]
    v_mfma_f32_16x16x32_bf16 v[156:159], a[20:23], v[64:67], v[156:159]
    v_mfma_f32_16x16x32_bf16 v[128:131], a[20:23], v[40:43], v[128:131]
    v_mfma_f32_16x16x32_bf16 v[160:163], a[20:23], v[72:75], v[160:163]
    v_mfma_f32_16x16x32_bf16 v[132:135], a[28:31], v[32:35], v[132:135]
    v_mfma_f32_16x16x32_bf16 v[164:167], a[28:31], v[64:67], v[164:167]
    v_mfma_f32_16x16x32_bf16 v[136:139], a[28:31], v[40:43], v[136:139]
    v_mfma_f32_16x16x32_bf16 v[168:171], a[28:31], v[72:75], v[168:171]
    v_mfma_f32_16x16x32_bf16 v[108:111], a[36:39], v[16:19], v[108:111]
    v_mfma_f32_16x16x32_bf16 v[140:143], a[36:39], v[48:51], v[140:143]
    v_mfma_f32_16x16x32_bf16 v[112:115], a[36:39], v[24:27], v[112:115]
    v_mfma_f32_16x16x32_bf16 v[144:147], a[36:39], v[56:59], v[144:147]
    v_mfma_f32_16x16x32_bf16 v[116:119], a[44:47], v[16:19], v[116:119]
    v_mfma_f32_16x16x32_bf16 v[148:151], a[44:47], v[48:51], v[148:151]
    v_mfma_f32_16x16x32_bf16 v[120:123], a[44:47], v[24:27], v[120:123]
    v_mfma_f32_16x16x32_bf16 v[152:155], a[44:47], v[56:59], v[152:155]
    v_mfma_f32_16x16x32_bf16 v[124:127], a[52:55], v[16:19], v[124:127]
    v_mfma_f32_16x16x32_bf16 v[156:159], a[52:55], v[48:51], v[156:159]
    v_mfma_f32_16x16x32_bf16 v[128:131], a[52:55], v[24:27], v[128:131]
    v_mfma_f32_16x16x32_bf16 v[160:163], a[52:55], v[56:59], v[160:163]
    v_mfma_f32_16x16x32_bf16 v[132:135], a[60:63], v[16:19], v[132:135]
    v_mfma_f32_16x16x32_bf16 v[164:167], a[60:63], v[48:51], v[164:167]
    v_mfma_f32_16x16x32_bf16 v[136:139], a[60:63], v[24:27], v[136:139]
    v_mfma_f32_16x16x32_bf16 v[168:171], a[60:63], v[56:59], v[168:171]
    v_mfma_f32_16x16x32_bf16 v[108:111], a[68:71], v[48:51], v[108:111]
    v_mfma_f32_16x16x32_bf16 v[140:143], a[68:71], v[80:83], v[140:143]
    v_mfma_f32_16x16x32_bf16 v[112:115], a[68:71], v[56:59], v[112:115]
    v_mfma_f32_16x16x32_bf16 v[144:147], a[68:71], v[88:91], v[144:147]
    v_mfma_f32_16x16x32_bf16 v[116:119], a[76:79], v[48:51], v[116:119]
    v_mfma_f32_16x16x32_bf16 v[148:151], a[76:79], v[80:83], v[148:151]
    v_mfma_f32_16x16x32_bf16 v[120:123], a[76:79], v[56:59], v[120:123]
    v_mfma_f32_16x16x32_bf16 v[152:155], a[76:79], v[88:91], v[152:155]
    v_mfma_f32_16x16x32_bf16 v[124:127], a[84:87], v[48:51], v[124:127]
    v_mfma_f32_16x16x32_bf16 v[156:159], a[84:87], v[80:83], v[156:159]
    v_mfma_f32_16x16x32_bf16 v[128:131], a[84:87], v[56:59], v[128:131]
    v_mfma_f32_16x16x32_bf16 v[160:163], a[84:87], v[88:91], v[160:163]
    v_mfma_f32_16x16x32_bf16 v[132:135], a[92:95], v[48:51], v[132:135]
    v_mfma_f32_16x16x32_bf16 v[164:167], a[92:95], v[80:83], v[164:167]
    v_mfma_f32_16x16x32_bf16 v[136:139], a[92:95], v[56:59], v[136:139]
    v_mfma_f32_16x16x32_bf16 v[168:171], a[92:95], v[88:91], v[168:171]
    v_mfma_f32_16x16x32_bf16 v[108:111], a[68:71], v[64:67], v[108:111]
    v_mfma_f32_16x16x32_bf16 v[140:143], a[68:71], v[96:99], v[140:143]
    v_mfma_f32_16x16x32_bf16 v[112:115], a[68:71], v[72:75], v[112:115]
    v_mfma_f32_16x16x32_bf16 v[144:147], a[68:71], v[104:107], v[144:147]
    v_mfma_f32_16x16x32_bf16 v[116:119], a[76:79], v[64:67], v[116:119]
    v_mfma_f32_16x16x32_bf16 v[148:151], a[76:79], v[96:99], v[148:151]
    v_mfma_f32_16x16x32_bf16 v[120:123], a[76:79], v[72:75], v[120:123]
    v_mfma_f32_16x16x32_bf16 v[152:155], a[76:79], v[104:107], v[152:155]
    v_mfma_f32_16x16x32_bf16 v[124:127], a[84:87], v[64:67], v[124:127]
    v_mfma_f32_16x16x32_bf16 v[156:159], a[84:87], v[96:99], v[156:159]
    v_mfma_f32_16x16x32_bf16 v[128:131], a[84:87], v[72:75], v[128:131]
    v_mfma_f32_16x16x32_bf16 v[160:163], a[84:87], v[104:107], v[160:163]
    v_mfma_f32_16x16x32_bf16 v[132:135], a[92:95], v[64:67], v[132:135]
    v_mfma_f32_16x16x32_bf16 v[164:167], a[92:95], v[96:99], v[164:167]
    v_mfma_f32_16x16x32_bf16 v[136:139], a[92:95], v[72:75], v[136:139]
    v_mfma_f32_16x16x32_bf16 v[168:171], a[92:95], v[104:107], v[168:171]
    v_mfma_f32_16x16x32_bf16 v[108:111], a[100:103], v[48:51], v[108:111]
    v_mfma_f32_16x16x32_bf16 v[140:143], a[100:103], v[80:83], v[140:143]
    v_mfma_f32_16x16x32_bf16 v[112:115], a[100:103], v[56:59], v[112:115]
    v_mfma_f32_16x16x32_bf16 v[144:147], a[100:103], v[88:91], v[144:147]
    v_mfma_f32_16x16x32_bf16 v[116:119], a[108:111], v[48:51], v[116:119]
    v_mfma_f32_16x16x32_bf16 v[148:151], a[108:111], v[80:83], v[148:151]
    v_mfma_f32_16x16x32_bf16 v[120:123], a[108:111], v[56:59], v[120:123]
    v_mfma_f32_16x16x32_bf16 v[152:155], a[108:111], v[88:91], v[152:155]
    v_mfma_f32_16x16x32_bf16 v[124:127], a[116:119], v[48:51], v[124:127]
    v_mfma_f32_16x16x32_bf16 v[156:159], a[116:119], v[80:83], v[156:159]
    v_mfma_f32_16x16x32_bf16 v[128:131], a[116:119], v[56:59], v[128:131]
    v_mfma_f32_16x16x32_bf16 v[160:163], a[116:119], v[88:91], v[160:163]
    v_mfma_f32_16x16x32_bf16 v[132:135], a[124:127], v[48:51], v[132:135]
    v_mfma_f32_16x16x32_bf16 v[164:167], a[124:127], v[80:83], v[164:167]
    v_mfma_f32_16x16x32_bf16 v[136:139], a[124:127], v[56:59], v[136:139]
    v_mfma_f32_16x16x32_bf16 v[168:171], a[124:127], v[88:91], v[168:171]
    s_nop 7
    s_waitcnt vmcnt(0)
    v_lshlrev_b32 v236, 16, v172
    v_lshlrev_b32 v237, 16, v188
    v_mul_f32 v6, v108, v236
    v_mul_f32 v7, v108, v237
    v_fma_f32 v108, -v140, v237, v6
    v_fma_f32 v140, v140, v236, v7
    v_and_b32 v236, 0xffff0000, v172
    v_and_b32 v237, 0xffff0000, v188
    v_mul_f32 v6, v109, v236
    v_mul_f32 v7, v109, v237
    v_fma_f32 v109, -v141, v237, v6
    v_fma_f32 v141, v141, v236, v7
    v_lshlrev_b32 v236, 16, v173
    v_lshlrev_b32 v237, 16, v189
    v_mul_f32 v6, v110, v236
    v_mul_f32 v7, v110, v237
    v_fma_f32 v110, -v142, v237, v6
    v_fma_f32 v142, v142, v236, v7
    v_and_b32 v236, 0xffff0000, v173
    v_and_b32 v237, 0xffff0000, v189
    v_mul_f32 v6, v111, v236
    v_mul_f32 v7, v111, v237
    v_fma_f32 v111, -v143, v237, v6
    v_fma_f32 v143, v143, v236, v7
    v_lshlrev_b32 v236, 16, v174
    v_lshlrev_b32 v237, 16, v190
    v_mul_f32 v6, v112, v236
    v_mul_f32 v7, v112, v237
    v_fma_f32 v112, -v144, v237, v6
    v_fma_f32 v144, v144, v236, v7
    v_and_b32 v236, 0xffff0000, v174
    v_and_b32 v237, 0xffff0000, v190
    v_mul_f32 v6, v113, v236
    v_mul_f32 v7, v113, v237
    v_fma_f32 v113, -v145, v237, v6
    v_fma_f32 v145, v145, v236, v7
    v_lshlrev_b32 v236, 16, v175
    v_lshlrev_b32 v237, 16, v191
    v_mul_f32 v6, v114, v236
    v_mul_f32 v7, v114, v237
    v_fma_f32 v114, -v146, v237, v6
    v_fma_f32 v146, v146, v236, v7
    v_and_b32 v236, 0xffff0000, v175
    v_and_b32 v237, 0xffff0000, v191
    v_mul_f32 v6, v115, v236
    v_mul_f32 v7, v115, v237
    v_fma_f32 v115, -v147, v237, v6
    v_fma_f32 v147, v147, v236, v7
    v_lshlrev_b32 v236, 16, v176
    v_lshlrev_b32 v237, 16, v192
    v_mul_f32 v6, v116, v236
    v_mul_f32 v7, v116, v237
    v_fma_f32 v116, -v148, v237, v6
    v_fma_f32 v148, v148, v236, v7
    v_and_b32 v236, 0xffff0000, v176
    v_and_b32 v237, 0xffff0000, v192
    v_mul_f32 v6, v117, v236
    v_mul_f32 v7, v117, v237
    v_fma_f32 v117, -v149, v237, v6
    v_fma_f32 v149, v149, v236, v7
    v_lshlrev_b32 v236, 16, v177
    v_lshlrev_b32 v237, 16, v193
    v_mul_f32 v6, v118, v236
    v_mul_f32 v7, v118, v237
    v_fma_f32 v118, -v150, v237, v6
    v_fma_f32 v150, v150, v236, v7
    v_and_b32 v236, 0xffff0000, v177
    v_and_b32 v237, 0xffff0000, v193
    v_mul_f32 v6, v119, v236
    v_mul_f32 v7, v119, v237
    v_fma_f32 v119, -v151, v237, v6
    v_fma_f32 v151, v151, v236, v7
    v_lshlrev_b32 v236, 16, v178
    v_lshlrev_b32 v237, 16, v194
    v_mul_f32 v6, v120, v236
    v_mul_f32 v7, v120, v237
    v_fma_f32 v120, -v152, v237, v6
    v_fma_f32 v152, v152, v236, v7
    v_and_b32 v236, 0xffff0000, v178
    v_and_b32 v237, 0xffff0000, v194
    v_mul_f32 v6, v121, v236
    v_mul_f32 v7, v121, v237
    v_fma_f32 v121, -v153, v237, v6
    v_fma_f32 v153, v153, v236, v7
    v_lshlrev_b32 v236, 16, v179
    v_lshlrev_b32 v237, 16, v195
    v_mul_f32 v6, v122, v236
    v_mul_f32 v7, v122, v237
    v_fma_f32 v122, -v154, v237, v6
    v_fma_f32 v154, v154, v236, v7
    v_and_b32 v236, 0xffff0000, v179
    v_and_b32 v237, 0xffff0000, v195
    v_mul_f32 v6, v123, v236
    v_mul_f32 v7, v123, v237
    v_fma_f32 v123, -v155, v237, v6
    v_fma_f32 v155, v155, v236, v7
    v_lshlrev_b32 v236, 16, v180
    v_lshlrev_b32 v237, 16, v196
    v_mul_f32 v6, v124, v236
    v_mul_f32 v7, v124, v237
    v_fma_f32 v124, -v156, v237, v6
    v_fma_f32 v156, v156, v236, v7
    v_and_b32 v236, 0xffff0000, v180
    v_and_b32 v237, 0xffff0000, v196
    v_mul_f32 v6, v125, v236
    v_mul_f32 v7, v125, v237
    v_fma_f32 v125, -v157, v237, v6
    v_fma_f32 v157, v157, v236, v7
    v_lshlrev_b32 v236, 16, v181
    v_lshlrev_b32 v237, 16, v197
    v_mul_f32 v6, v126, v236
    v_mul_f32 v7, v126, v237
    v_fma_f32 v126, -v158, v237, v6
    v_fma_f32 v158, v158, v236, v7
    v_and_b32 v236, 0xffff0000, v181
    v_and_b32 v237, 0xffff0000, v197
    v_mul_f32 v6, v127, v236
    v_mul_f32 v7, v127, v237
    v_fma_f32 v127, -v159, v237, v6
    v_fma_f32 v159, v159, v236, v7
    v_lshlrev_b32 v236, 16, v182
    v_lshlrev_b32 v237, 16, v198
    v_mul_f32 v6, v128, v236
    v_mul_f32 v7, v128, v237
    v_fma_f32 v128, -v160, v237, v6
    v_fma_f32 v160, v160, v236, v7
    v_and_b32 v236, 0xffff0000, v182
    v_and_b32 v237, 0xffff0000, v198
    v_mul_f32 v6, v129, v236
    v_mul_f32 v7, v129, v237
    v_fma_f32 v129, -v161, v237, v6
    v_fma_f32 v161, v161, v236, v7
    v_lshlrev_b32 v236, 16, v183
    v_lshlrev_b32 v237, 16, v199
    v_mul_f32 v6, v130, v236
    v_mul_f32 v7, v130, v237
    v_fma_f32 v130, -v162, v237, v6
    v_fma_f32 v162, v162, v236, v7
    v_and_b32 v236, 0xffff0000, v183
    v_and_b32 v237, 0xffff0000, v199
    v_mul_f32 v6, v131, v236
    v_mul_f32 v7, v131, v237
    v_fma_f32 v131, -v163, v237, v6
    v_fma_f32 v163, v163, v236, v7
    v_lshlrev_b32 v236, 16, v184
    v_lshlrev_b32 v237, 16, v200
    v_mul_f32 v6, v132, v236
    v_mul_f32 v7, v132, v237
    v_fma_f32 v132, -v164, v237, v6
    v_fma_f32 v164, v164, v236, v7
    v_and_b32 v236, 0xffff0000, v184
    v_and_b32 v237, 0xffff0000, v200
    v_mul_f32 v6, v133, v236
    v_mul_f32 v7, v133, v237
    v_fma_f32 v133, -v165, v237, v6
    v_fma_f32 v165, v165, v236, v7
    v_lshlrev_b32 v236, 16, v185
    v_lshlrev_b32 v237, 16, v201
    v_mul_f32 v6, v134, v236
    v_mul_f32 v7, v134, v237
    v_fma_f32 v134, -v166, v237, v6
    v_fma_f32 v166, v166, v236, v7
    v_and_b32 v236, 0xffff0000, v185
    v_and_b32 v237, 0xffff0000, v201
    v_mul_f32 v6, v135, v236
    v_mul_f32 v7, v135, v237
    v_fma_f32 v135, -v167, v237, v6
    v_fma_f32 v167, v167, v236, v7
    v_lshlrev_b32 v236, 16, v186
    v_lshlrev_b32 v237, 16, v202
    v_mul_f32 v6, v136, v236
    v_mul_f32 v7, v136, v237
    v_fma_f32 v136, -v168, v237, v6
    v_fma_f32 v168, v168, v236, v7
    v_and_b32 v236, 0xffff0000, v186
    v_and_b32 v237, 0xffff0000, v202
    v_mul_f32 v6, v137, v236
    v_mul_f32 v7, v137, v237
    v_fma_f32 v137, -v169, v237, v6
    v_fma_f32 v169, v169, v236, v7
    v_lshlrev_b32 v236, 16, v187
    v_lshlrev_b32 v237, 16, v203
    v_mul_f32 v6, v138, v236
    v_mul_f32 v7, v138, v237
    v_fma_f32 v138, -v170, v237, v6
    v_fma_f32 v170, v170, v236, v7
    v_and_b32 v236, 0xffff0000, v187
    v_and_b32 v237, 0xffff0000, v203
    v_mul_f32 v6, v139, v236
    v_mul_f32 v7, v139, v237
    v_fma_f32 v139, -v171, v237, v6
    v_fma_f32 v171, v171, v236, v7
    s_mov_b32 s51, 0x9d0e000
    buffer_load_dwordx4 v[172:175], v8, s[4:7], s51 offen
    s_mov_b32 s51, 0x9d0e400
    buffer_load_dwordx4 v[176:179], v8, s[4:7], s51 offen
    s_mov_b32 s51, 0x9d0e800
    buffer_load_dwordx4 v[180:183], v8, s[4:7], s51 offen
    s_mov_b32 s51, 0x9d0ec00
    buffer_load_dwordx4 v[184:187], v8, s[4:7], s51 offen
    s_mov_b32 s51, 0x9d0f000
    buffer_load_dwordx4 v[188:191], v8, s[4:7], s51 offen
    s_mov_b32 s51, 0x9d0f400
    buffer_load_dwordx4 v[192:195], v8, s[4:7], s51 offen
    s_mov_b32 s51, 0x9d0f800
    buffer_load_dwordx4 v[196:199], v8, s[4:7], s51 offen
    s_mov_b32 s51, 0x9d0fc00
    buffer_load_dwordx4 v[200:203], v8, s[4:7], s51 offen
    s_mov_b32 s51, 0x9d10000
    buffer_load_dwordx4 v[204:207], v8, s[4:7], s51 offen
    s_mov_b32 s51, 0x9d10400
    buffer_load_dwordx4 v[208:211], v8, s[4:7], s51 offen
    s_mov_b32 s51, 0x9d10800
    buffer_load_dwordx4 v[212:215], v8, s[4:7], s51 offen
    s_mov_b32 s51, 0x9d10c00
    buffer_load_dwordx4 v[216:219], v8, s[4:7], s51 offen
    s_mov_b32 s51, 0x9d11000
    buffer_load_dwordx4 v[220:223], v8, s[4:7], s51 offen
    s_mov_b32 s51, 0x9d11400
    buffer_load_dwordx4 v[224:227], v8, s[4:7], s51 offen
    s_mov_b32 s51, 0x9d11800
    buffer_load_dwordx4 v[228:231], v8, s[4:7], s51 offen
    s_mov_b32 s51, 0x9d11c00
    buffer_load_dwordx4 v[232:235], v8, s[4:7], s51 offen
    v_cvt_pk_bf16_f32 v12, v108, v109
    v_lshlrev_b32 v6, 16, v12
    v_and_b32 v7, 0xffff0000, v12
    v_sub_f32 v6, v108, v6
    v_sub_f32 v7, v109, v7
    v_cvt_pk_bf16_f32 v28, v6, v7
    v_cvt_pk_bf16_f32 v13, v110, v111
    v_lshlrev_b32 v6, 16, v13
    v_and_b32 v7, 0xffff0000, v13
    v_sub_f32 v6, v110, v6
    v_sub_f32 v7, v111, v7
    v_cvt_pk_bf16_f32 v29, v6, v7
    v_cvt_pk_bf16_f32 v14, v116, v117
    v_lshlrev_b32 v6, 16, v14
    v_and_b32 v7, 0xffff0000, v14
    v_sub_f32 v6, v116, v6
    v_sub_f32 v7, v117, v7
    v_cvt_pk_bf16_f32 v30, v6, v7
    v_cvt_pk_bf16_f32 v15, v118, v119
    v_lshlrev_b32 v6, 16, v15
    v_and_b32 v7, 0xffff0000, v15
    v_sub_f32 v6, v118, v6
    v_sub_f32 v7, v119, v7
    v_cvt_pk_bf16_f32 v31, v6, v7
    v_cvt_pk_bf16_f32 v16, v124, v125
    v_lshlrev_b32 v6, 16, v16
    v_and_b32 v7, 0xffff0000, v16
    v_sub_f32 v6, v124, v6
    v_sub_f32 v7, v125, v7
    v_cvt_pk_bf16_f32 v32, v6, v7
    v_cvt_pk_bf16_f32 v17, v126, v127
    v_lshlrev_b32 v6, 16, v17
    v_and_b32 v7, 0xffff0000, v17
    v_sub_f32 v6, v126, v6
    v_sub_f32 v7, v127, v7
    v_cvt_pk_bf16_f32 v33, v6, v7
    v_cvt_pk_bf16_f32 v18, v132, v133
    v_lshlrev_b32 v6, 16, v18
    v_and_b32 v7, 0xffff0000, v18
    v_sub_f32 v6, v132, v6
    v_sub_f32 v7, v133, v7
    v_cvt_pk_bf16_f32 v34, v6, v7
    v_cvt_pk_bf16_f32 v19, v134, v135
    v_lshlrev_b32 v6, 16, v19
    v_and_b32 v7, 0xffff0000, v19
    v_sub_f32 v6, v134, v6
    v_sub_f32 v7, v135, v7
    v_cvt_pk_bf16_f32 v35, v6, v7
    v_cvt_pk_bf16_f32 v20, v112, v113
    v_lshlrev_b32 v6, 16, v20
    v_and_b32 v7, 0xffff0000, v20
    v_sub_f32 v6, v112, v6
    v_sub_f32 v7, v113, v7
    v_cvt_pk_bf16_f32 v36, v6, v7
    v_cvt_pk_bf16_f32 v21, v114, v115
    v_lshlrev_b32 v6, 16, v21
    v_and_b32 v7, 0xffff0000, v21
    v_sub_f32 v6, v114, v6
    v_sub_f32 v7, v115, v7
    v_cvt_pk_bf16_f32 v37, v6, v7
    v_cvt_pk_bf16_f32 v22, v120, v121
    v_lshlrev_b32 v6, 16, v22
    v_and_b32 v7, 0xffff0000, v22
    v_sub_f32 v6, v120, v6
    v_sub_f32 v7, v121, v7
    v_cvt_pk_bf16_f32 v38, v6, v7
    v_cvt_pk_bf16_f32 v23, v122, v123
    v_lshlrev_b32 v6, 16, v23
    v_and_b32 v7, 0xffff0000, v23
    v_sub_f32 v6, v122, v6
    v_sub_f32 v7, v123, v7
    v_cvt_pk_bf16_f32 v39, v6, v7
    v_cvt_pk_bf16_f32 v24, v128, v129
    v_lshlrev_b32 v6, 16, v24
    v_and_b32 v7, 0xffff0000, v24
    v_sub_f32 v6, v128, v6
    v_sub_f32 v7, v129, v7
    v_cvt_pk_bf16_f32 v40, v6, v7
    v_cvt_pk_bf16_f32 v25, v130, v131
    v_lshlrev_b32 v6, 16, v25
    v_and_b32 v7, 0xffff0000, v25
    v_sub_f32 v6, v130, v6
    v_sub_f32 v7, v131, v7
    v_cvt_pk_bf16_f32 v41, v6, v7
    v_cvt_pk_bf16_f32 v26, v136, v137
    v_lshlrev_b32 v6, 16, v26
    v_and_b32 v7, 0xffff0000, v26
    v_sub_f32 v6, v136, v6
    v_sub_f32 v7, v137, v7
    v_cvt_pk_bf16_f32 v42, v6, v7
    v_cvt_pk_bf16_f32 v27, v138, v139
    v_lshlrev_b32 v6, 16, v27
    v_and_b32 v7, 0xffff0000, v27
    v_sub_f32 v6, v138, v6
    v_sub_f32 v7, v139, v7
    v_cvt_pk_bf16_f32 v43, v6, v7
    v_cvt_pk_bf16_f32 v44, v140, v141
    v_lshlrev_b32 v6, 16, v44
    v_and_b32 v7, 0xffff0000, v44
    v_sub_f32 v6, v140, v6
    v_sub_f32 v7, v141, v7
    v_cvt_pk_bf16_f32 v60, v6, v7
    v_cvt_pk_bf16_f32 v45, v142, v143
    v_lshlrev_b32 v6, 16, v45
    v_and_b32 v7, 0xffff0000, v45
    v_sub_f32 v6, v142, v6
    v_sub_f32 v7, v143, v7
    v_cvt_pk_bf16_f32 v61, v6, v7
    v_cvt_pk_bf16_f32 v46, v148, v149
    v_lshlrev_b32 v6, 16, v46
    v_and_b32 v7, 0xffff0000, v46
    v_sub_f32 v6, v148, v6
    v_sub_f32 v7, v149, v7
    v_cvt_pk_bf16_f32 v62, v6, v7
    v_cvt_pk_bf16_f32 v47, v150, v151
    v_lshlrev_b32 v6, 16, v47
    v_and_b32 v7, 0xffff0000, v47
    v_sub_f32 v6, v150, v6
    v_sub_f32 v7, v151, v7
    v_cvt_pk_bf16_f32 v63, v6, v7
    v_cvt_pk_bf16_f32 v48, v156, v157
    v_lshlrev_b32 v6, 16, v48
    v_and_b32 v7, 0xffff0000, v48
    v_sub_f32 v6, v156, v6
    v_sub_f32 v7, v157, v7
    v_cvt_pk_bf16_f32 v64, v6, v7
    v_cvt_pk_bf16_f32 v49, v158, v159
    v_lshlrev_b32 v6, 16, v49
    v_and_b32 v7, 0xffff0000, v49
    v_sub_f32 v6, v158, v6
    v_sub_f32 v7, v159, v7
    v_cvt_pk_bf16_f32 v65, v6, v7
    v_cvt_pk_bf16_f32 v50, v164, v165
    v_lshlrev_b32 v6, 16, v50
    v_and_b32 v7, 0xffff0000, v50
    v_sub_f32 v6, v164, v6
    v_sub_f32 v7, v165, v7
    v_cvt_pk_bf16_f32 v66, v6, v7
    v_cvt_pk_bf16_f32 v51, v166, v167
    v_lshlrev_b32 v6, 16, v51
    v_and_b32 v7, 0xffff0000, v51
    v_sub_f32 v6, v166, v6
    v_sub_f32 v7, v167, v7
    v_cvt_pk_bf16_f32 v67, v6, v7
    v_cvt_pk_bf16_f32 v52, v144, v145
    v_lshlrev_b32 v6, 16, v52
    v_and_b32 v7, 0xffff0000, v52
    v_sub_f32 v6, v144, v6
    v_sub_f32 v7, v145, v7
    v_cvt_pk_bf16_f32 v68, v6, v7
    v_cvt_pk_bf16_f32 v53, v146, v147
    v_lshlrev_b32 v6, 16, v53
    v_and_b32 v7, 0xffff0000, v53
    v_sub_f32 v6, v146, v6
    v_sub_f32 v7, v147, v7
    v_cvt_pk_bf16_f32 v69, v6, v7
    v_cvt_pk_bf16_f32 v54, v152, v153
    v_lshlrev_b32 v6, 16, v54
    v_and_b32 v7, 0xffff0000, v54
    v_sub_f32 v6, v152, v6
    v_sub_f32 v7, v153, v7
    v_cvt_pk_bf16_f32 v70, v6, v7
    v_cvt_pk_bf16_f32 v55, v154, v155
    v_lshlrev_b32 v6, 16, v55
    v_and_b32 v7, 0xffff0000, v55
    v_sub_f32 v6, v154, v6
    v_sub_f32 v7, v155, v7
    v_cvt_pk_bf16_f32 v71, v6, v7
    v_cvt_pk_bf16_f32 v56, v160, v161
    v_lshlrev_b32 v6, 16, v56
    v_and_b32 v7, 0xffff0000, v56
    v_sub_f32 v6, v160, v6
    v_sub_f32 v7, v161, v7
    v_cvt_pk_bf16_f32 v72, v6, v7
    v_cvt_pk_bf16_f32 v57, v162, v163
    v_lshlrev_b32 v6, 16, v57
    v_and_b32 v7, 0xffff0000, v57
    v_sub_f32 v6, v162, v6
    v_sub_f32 v7, v163, v7
    v_cvt_pk_bf16_f32 v73, v6, v7
    v_cvt_pk_bf16_f32 v58, v168, v169
    v_lshlrev_b32 v6, 16, v58
    v_and_b32 v7, 0xffff0000, v58
    v_sub_f32 v6, v168, v6
    v_sub_f32 v7, v169, v7
    v_cvt_pk_bf16_f32 v74, v6, v7
    v_cvt_pk_bf16_f32 v59, v170, v171
    v_lshlrev_b32 v6, 16, v59
    v_and_b32 v7, 0xffff0000, v59
    v_sub_f32 v6, v170, v6
    v_sub_f32 v7, v171, v7
    v_cvt_pk_bf16_f32 v75, v6, v7
    v_xor_b32 v76, 0x80008000, v44
    v_xor_b32 v77, 0x80008000, v45
    v_xor_b32 v78, 0x80008000, v46
    v_xor_b32 v79, 0x80008000, v47
    v_xor_b32 v80, 0x80008000, v48
    v_xor_b32 v81, 0x80008000, v49
    v_xor_b32 v82, 0x80008000, v50
    v_xor_b32 v83, 0x80008000, v51
    v_xor_b32 v84, 0x80008000, v52
    v_xor_b32 v85, 0x80008000, v53
    v_xor_b32 v86, 0x80008000, v54
    v_xor_b32 v87, 0x80008000, v55
    v_xor_b32 v88, 0x80008000, v56
    v_xor_b32 v89, 0x80008000, v57
    v_xor_b32 v90, 0x80008000, v58
    v_xor_b32 v91, 0x80008000, v59
    v_xor_b32 v92, 0x80008000, v60
    v_xor_b32 v93, 0x80008000, v61
    v_xor_b32 v94, 0x80008000, v62
    v_xor_b32 v95, 0x80008000, v63
    v_xor_b32 v96, 0x80008000, v64
    v_xor_b32 v97, 0x80008000, v65
    v_xor_b32 v98, 0x80008000, v66
    v_xor_b32 v99, 0x80008000, v67
    v_xor_b32 v100, 0x80008000, v68
    v_xor_b32 v101, 0x80008000, v69
    v_xor_b32 v102, 0x80008000, v70
    v_xor_b32 v103, 0x80008000, v71
    v_xor_b32 v104, 0x80008000, v72
    v_xor_b32 v105, 0x80008000, v73
    v_xor_b32 v106, 0x80008000, v74
    v_xor_b32 v107, 0x80008000, v75
    s_nop 1
    v_mfma_f32_16x16x32_bf16 v[108:111], v[12:15], a[0:3], 0
    v_mfma_f32_16x16x32_bf16 v[140:143], v[44:47], a[0:3], 0
    v_mfma_f32_16x16x32_bf16 v[112:115], v[12:15], a[8:11], 0
    v_mfma_f32_16x16x32_bf16 v[144:147], v[44:47], a[8:11], 0
    v_mfma_f32_16x16x32_bf16 v[116:119], v[12:15], a[16:19], 0
    v_mfma_f32_16x16x32_bf16 v[148:151], v[44:47], a[16:19], 0
    v_mfma_f32_16x16x32_bf16 v[120:123], v[12:15], a[24:27], 0
    v_mfma_f32_16x16x32_bf16 v[152:155], v[44:47], a[24:27], 0
    v_mfma_f32_16x16x32_bf16 v[124:127], v[20:23], a[0:3], 0
    v_mfma_f32_16x16x32_bf16 v[156:159], v[52:55], a[0:3], 0
    v_mfma_f32_16x16x32_bf16 v[128:131], v[20:23], a[8:11], 0
    v_mfma_f32_16x16x32_bf16 v[160:163], v[52:55], a[8:11], 0
    v_mfma_f32_16x16x32_bf16 v[132:135], v[20:23], a[16:19], 0
    v_mfma_f32_16x16x32_bf16 v[164:167], v[52:55], a[16:19], 0
    v_mfma_f32_16x16x32_bf16 v[136:139], v[20:23], a[24:27], 0
    v_mfma_f32_16x16x32_bf16 v[168:171], v[52:55], a[24:27], 0
    v_mfma_f32_16x16x32_bf16 v[108:111], v[28:31], a[0:3], v[108:111]
    v_mfma_f32_16x16x32_bf16 v[140:143], v[60:63], a[0:3], v[140:143]
    v_mfma_f32_16x16x32_bf16 v[112:115], v[28:31], a[8:11], v[112:115]
    v_mfma_f32_16x16x32_bf16 v[144:147], v[60:63], a[8:11], v[144:147]
    v_mfma_f32_16x16x32_bf16 v[116:119], v[28:31], a[16:19], v[116:119]
    v_mfma_f32_16x16x32_bf16 v[148:151], v[60:63], a[16:19], v[148:151]
    v_mfma_f32_16x16x32_bf16 v[120:123], v[28:31], a[24:27], v[120:123]
    v_mfma_f32_16x16x32_bf16 v[152:155], v[60:63], a[24:27], v[152:155]
    v_mfma_f32_16x16x32_bf16 v[124:127], v[36:39], a[0:3], v[124:127]
    v_mfma_f32_16x16x32_bf16 v[156:159], v[68:71], a[0:3], v[156:159]
    v_mfma_f32_16x16x32_bf16 v[128:131], v[36:39], a[8:11], v[128:131]
    v_mfma_f32_16x16x32_bf16 v[160:163], v[68:71], a[8:11], v[160:163]
    v_mfma_f32_16x16x32_bf16 v[132:135], v[36:39], a[16:19], v[132:135]
    v_mfma_f32_16x16x32_bf16 v[164:167], v[68:71], a[16:19], v[164:167]
    v_mfma_f32_16x16x32_bf16 v[136:139], v[36:39], a[24:27], v[136:139]
    v_mfma_f32_16x16x32_bf16 v[168:171], v[68:71], a[24:27], v[168:171]
    v_mfma_f32_16x16x32_bf16 v[108:111], v[12:15], a[32:35], v[108:111]
    v_mfma_f32_16x16x32_bf16 v[140:143], v[44:47], a[32:35], v[140:143]
    v_mfma_f32_16x16x32_bf16 v[112:115], v[12:15], a[40:43], v[112:115]
    v_mfma_f32_16x16x32_bf16 v[144:147], v[44:47], a[40:43], v[144:147]
    v_mfma_f32_16x16x32_bf16 v[116:119], v[12:15], a[48:51], v[116:119]
    v_mfma_f32_16x16x32_bf16 v[148:151], v[44:47], a[48:51], v[148:151]
    v_mfma_f32_16x16x32_bf16 v[120:123], v[12:15], a[56:59], v[120:123]
    v_mfma_f32_16x16x32_bf16 v[152:155], v[44:47], a[56:59], v[152:155]
    v_mfma_f32_16x16x32_bf16 v[124:127], v[20:23], a[32:35], v[124:127]
    v_mfma_f32_16x16x32_bf16 v[156:159], v[52:55], a[32:35], v[156:159]
    v_mfma_f32_16x16x32_bf16 v[128:131], v[20:23], a[40:43], v[128:131]
    v_mfma_f32_16x16x32_bf16 v[160:163], v[52:55], a[40:43], v[160:163]
    v_mfma_f32_16x16x32_bf16 v[132:135], v[20:23], a[48:51], v[132:135]
    v_mfma_f32_16x16x32_bf16 v[164:167], v[52:55], a[48:51], v[164:167]
    v_mfma_f32_16x16x32_bf16 v[136:139], v[20:23], a[56:59], v[136:139]
    v_mfma_f32_16x16x32_bf16 v[168:171], v[52:55], a[56:59], v[168:171]
    v_mfma_f32_16x16x32_bf16 v[108:111], v[76:79], a[64:67], v[108:111]
    v_mfma_f32_16x16x32_bf16 v[140:143], v[12:15], a[64:67], v[140:143]
    v_mfma_f32_16x16x32_bf16 v[112:115], v[76:79], a[72:75], v[112:115]
    v_mfma_f32_16x16x32_bf16 v[144:147], v[12:15], a[72:75], v[144:147]
    v_mfma_f32_16x16x32_bf16 v[116:119], v[76:79], a[80:83], v[116:119]
    v_mfma_f32_16x16x32_bf16 v[148:151], v[12:15], a[80:83], v[148:151]
    v_mfma_f32_16x16x32_bf16 v[120:123], v[76:79], a[88:91], v[120:123]
    v_mfma_f32_16x16x32_bf16 v[152:155], v[12:15], a[88:91], v[152:155]
    v_mfma_f32_16x16x32_bf16 v[124:127], v[84:87], a[64:67], v[124:127]
    v_mfma_f32_16x16x32_bf16 v[156:159], v[20:23], a[64:67], v[156:159]
    v_mfma_f32_16x16x32_bf16 v[128:131], v[84:87], a[72:75], v[128:131]
    v_mfma_f32_16x16x32_bf16 v[160:163], v[20:23], a[72:75], v[160:163]
    v_mfma_f32_16x16x32_bf16 v[132:135], v[84:87], a[80:83], v[132:135]
    v_mfma_f32_16x16x32_bf16 v[164:167], v[20:23], a[80:83], v[164:167]
    v_mfma_f32_16x16x32_bf16 v[136:139], v[84:87], a[88:91], v[136:139]
    v_mfma_f32_16x16x32_bf16 v[168:171], v[20:23], a[88:91], v[168:171]
    v_mfma_f32_16x16x32_bf16 v[108:111], v[92:95], a[64:67], v[108:111]
    v_mfma_f32_16x16x32_bf16 v[140:143], v[28:31], a[64:67], v[140:143]
    v_mfma_f32_16x16x32_bf16 v[112:115], v[92:95], a[72:75], v[112:115]
    v_mfma_f32_16x16x32_bf16 v[144:147], v[28:31], a[72:75], v[144:147]
    v_mfma_f32_16x16x32_bf16 v[116:119], v[92:95], a[80:83], v[116:119]
    v_mfma_f32_16x16x32_bf16 v[148:151], v[28:31], a[80:83], v[148:151]
    v_mfma_f32_16x16x32_bf16 v[120:123], v[92:95], a[88:91], v[120:123]
    v_mfma_f32_16x16x32_bf16 v[152:155], v[28:31], a[88:91], v[152:155]
    v_mfma_f32_16x16x32_bf16 v[124:127], v[100:103], a[64:67], v[124:127]
    v_mfma_f32_16x16x32_bf16 v[156:159], v[36:39], a[64:67], v[156:159]
    v_mfma_f32_16x16x32_bf16 v[128:131], v[100:103], a[72:75], v[128:131]
    v_mfma_f32_16x16x32_bf16 v[160:163], v[36:39], a[72:75], v[160:163]
    v_mfma_f32_16x16x32_bf16 v[132:135], v[100:103], a[80:83], v[132:135]
    v_mfma_f32_16x16x32_bf16 v[164:167], v[36:39], a[80:83], v[164:167]
    v_mfma_f32_16x16x32_bf16 v[136:139], v[100:103], a[88:91], v[136:139]
    v_mfma_f32_16x16x32_bf16 v[168:171], v[36:39], a[88:91], v[168:171]
    v_mfma_f32_16x16x32_bf16 v[108:111], v[76:79], a[96:99], v[108:111]
    v_mfma_f32_16x16x32_bf16 v[140:143], v[12:15], a[96:99], v[140:143]
    v_mfma_f32_16x16x32_bf16 v[112:115], v[76:79], a[104:107], v[112:115]
    v_mfma_f32_16x16x32_bf16 v[144:147], v[12:15], a[104:107], v[144:147]
    v_mfma_f32_16x16x32_bf16 v[116:119], v[76:79], a[112:115], v[116:119]
    v_mfma_f32_16x16x32_bf16 v[148:151], v[12:15], a[112:115], v[148:151]
    v_mfma_f32_16x16x32_bf16 v[120:123], v[76:79], a[120:123], v[120:123]
    v_mfma_f32_16x16x32_bf16 v[152:155], v[12:15], a[120:123], v[152:155]
    v_mfma_f32_16x16x32_bf16 v[124:127], v[84:87], a[96:99], v[124:127]
    v_mfma_f32_16x16x32_bf16 v[156:159], v[20:23], a[96:99], v[156:159]
    v_mfma_f32_16x16x32_bf16 v[128:131], v[84:87], a[104:107], v[128:131]
    v_mfma_f32_16x16x32_bf16 v[160:163], v[20:23], a[104:107], v[160:163]
    v_mfma_f32_16x16x32_bf16 v[132:135], v[84:87], a[112:115], v[132:135]
    v_mfma_f32_16x16x32_bf16 v[164:167], v[20:23], a[112:115], v[164:167]
    v_mfma_f32_16x16x32_bf16 v[136:139], v[84:87], a[120:123], v[136:139]
    v_mfma_f32_16x16x32_bf16 v[168:171], v[20:23], a[120:123], v[168:171]
    v_mfma_f32_16x16x32_bf16 v[108:111], v[16:19], a[4:7], v[108:111]
    v_mfma_f32_16x16x32_bf16 v[140:143], v[48:51], a[4:7], v[140:143]
    v_mfma_f32_16x16x32_bf16 v[112:115], v[16:19], a[12:15], v[112:115]
    v_mfma_f32_16x16x32_bf16 v[144:147], v[48:51], a[12:15], v[144:147]
    v_mfma_f32_16x16x32_bf16 v[116:119], v[16:19], a[20:23], v[116:119]
    v_mfma_f32_16x16x32_bf16 v[148:151], v[48:51], a[20:23], v[148:151]
    v_mfma_f32_16x16x32_bf16 v[120:123], v[16:19], a[28:31], v[120:123]
    v_mfma_f32_16x16x32_bf16 v[152:155], v[48:51], a[28:31], v[152:155]
    v_mfma_f32_16x16x32_bf16 v[124:127], v[24:27], a[4:7], v[124:127]
    v_mfma_f32_16x16x32_bf16 v[156:159], v[56:59], a[4:7], v[156:159]
    v_mfma_f32_16x16x32_bf16 v[128:131], v[24:27], a[12:15], v[128:131]
    v_mfma_f32_16x16x32_bf16 v[160:163], v[56:59], a[12:15], v[160:163]
    v_mfma_f32_16x16x32_bf16 v[132:135], v[24:27], a[20:23], v[132:135]
    v_mfma_f32_16x16x32_bf16 v[164:167], v[56:59], a[20:23], v[164:167]
    v_mfma_f32_16x16x32_bf16 v[136:139], v[24:27], a[28:31], v[136:139]
    v_mfma_f32_16x16x32_bf16 v[168:171], v[56:59], a[28:31], v[168:171]
    v_mfma_f32_16x16x32_bf16 v[108:111], v[32:35], a[4:7], v[108:111]
    v_mfma_f32_16x16x32_bf16 v[140:143], v[64:67], a[4:7], v[140:143]
    v_mfma_f32_16x16x32_bf16 v[112:115], v[32:35], a[12:15], v[112:115]
    v_mfma_f32_16x16x32_bf16 v[144:147], v[64:67], a[12:15], v[144:147]
    v_mfma_f32_16x16x32_bf16 v[116:119], v[32:35], a[20:23], v[116:119]
    v_mfma_f32_16x16x32_bf16 v[148:151], v[64:67], a[20:23], v[148:151]
    v_mfma_f32_16x16x32_bf16 v[120:123], v[32:35], a[28:31], v[120:123]
    v_mfma_f32_16x16x32_bf16 v[152:155], v[64:67], a[28:31], v[152:155]
    v_mfma_f32_16x16x32_bf16 v[124:127], v[40:43], a[4:7], v[124:127]
    v_mfma_f32_16x16x32_bf16 v[156:159], v[72:75], a[4:7], v[156:159]
    v_mfma_f32_16x16x32_bf16 v[128:131], v[40:43], a[12:15], v[128:131]
    v_mfma_f32_16x16x32_bf16 v[160:163], v[72:75], a[12:15], v[160:163]
    v_mfma_f32_16x16x32_bf16 v[132:135], v[40:43], a[20:23], v[132:135]
    v_mfma_f32_16x16x32_bf16 v[164:167], v[72:75], a[20:23], v[164:167]
    v_mfma_f32_16x16x32_bf16 v[136:139], v[40:43], a[28:31], v[136:139]
    v_mfma_f32_16x16x32_bf16 v[168:171], v[72:75], a[28:31], v[168:171]
    v_mfma_f32_16x16x32_bf16 v[108:111], v[16:19], a[36:39], v[108:111]
    v_mfma_f32_16x16x32_bf16 v[140:143], v[48:51], a[36:39], v[140:143]
    v_mfma_f32_16x16x32_bf16 v[112:115], v[16:19], a[44:47], v[112:115]
    v_mfma_f32_16x16x32_bf16 v[144:147], v[48:51], a[44:47], v[144:147]
    v_mfma_f32_16x16x32_bf16 v[116:119], v[16:19], a[52:55], v[116:119]
    v_mfma_f32_16x16x32_bf16 v[148:151], v[48:51], a[52:55], v[148:151]
    v_mfma_f32_16x16x32_bf16 v[120:123], v[16:19], a[60:63], v[120:123]
    v_mfma_f32_16x16x32_bf16 v[152:155], v[48:51], a[60:63], v[152:155]
    v_mfma_f32_16x16x32_bf16 v[124:127], v[24:27], a[36:39], v[124:127]
    v_mfma_f32_16x16x32_bf16 v[156:159], v[56:59], a[36:39], v[156:159]
    v_mfma_f32_16x16x32_bf16 v[128:131], v[24:27], a[44:47], v[128:131]
    v_mfma_f32_16x16x32_bf16 v[160:163], v[56:59], a[44:47], v[160:163]
    v_mfma_f32_16x16x32_bf16 v[132:135], v[24:27], a[52:55], v[132:135]
    v_mfma_f32_16x16x32_bf16 v[164:167], v[56:59], a[52:55], v[164:167]
    v_mfma_f32_16x16x32_bf16 v[136:139], v[24:27], a[60:63], v[136:139]
    v_mfma_f32_16x16x32_bf16 v[168:171], v[56:59], a[60:63], v[168:171]
    v_mfma_f32_16x16x32_bf16 v[108:111], v[80:83], a[68:71], v[108:111]
    v_mfma_f32_16x16x32_bf16 v[140:143], v[16:19], a[68:71], v[140:143]
    v_mfma_f32_16x16x32_bf16 v[112:115], v[80:83], a[76:79], v[112:115]
    v_mfma_f32_16x16x32_bf16 v[144:147], v[16:19], a[76:79], v[144:147]
    v_mfma_f32_16x16x32_bf16 v[116:119], v[80:83], a[84:87], v[116:119]
    v_mfma_f32_16x16x32_bf16 v[148:151], v[16:19], a[84:87], v[148:151]
    v_mfma_f32_16x16x32_bf16 v[120:123], v[80:83], a[92:95], v[120:123]
    v_mfma_f32_16x16x32_bf16 v[152:155], v[16:19], a[92:95], v[152:155]
    v_mfma_f32_16x16x32_bf16 v[124:127], v[88:91], a[68:71], v[124:127]
    v_mfma_f32_16x16x32_bf16 v[156:159], v[24:27], a[68:71], v[156:159]
    v_mfma_f32_16x16x32_bf16 v[128:131], v[88:91], a[76:79], v[128:131]
    v_mfma_f32_16x16x32_bf16 v[160:163], v[24:27], a[76:79], v[160:163]
    v_mfma_f32_16x16x32_bf16 v[132:135], v[88:91], a[84:87], v[132:135]
    v_mfma_f32_16x16x32_bf16 v[164:167], v[24:27], a[84:87], v[164:167]
    v_mfma_f32_16x16x32_bf16 v[136:139], v[88:91], a[92:95], v[136:139]
    v_mfma_f32_16x16x32_bf16 v[168:171], v[24:27], a[92:95], v[168:171]
    v_mfma_f32_16x16x32_bf16 v[108:111], v[96:99], a[68:71], v[108:111]
    v_mfma_f32_16x16x32_bf16 v[140:143], v[32:35], a[68:71], v[140:143]
    v_mfma_f32_16x16x32_bf16 v[112:115], v[96:99], a[76:79], v[112:115]
    v_mfma_f32_16x16x32_bf16 v[144:147], v[32:35], a[76:79], v[144:147]
    v_mfma_f32_16x16x32_bf16 v[116:119], v[96:99], a[84:87], v[116:119]
    v_mfma_f32_16x16x32_bf16 v[148:151], v[32:35], a[84:87], v[148:151]
    v_mfma_f32_16x16x32_bf16 v[120:123], v[96:99], a[92:95], v[120:123]
    v_mfma_f32_16x16x32_bf16 v[152:155], v[32:35], a[92:95], v[152:155]
    v_mfma_f32_16x16x32_bf16 v[124:127], v[104:107], a[68:71], v[124:127]
    v_mfma_f32_16x16x32_bf16 v[156:159], v[40:43], a[68:71], v[156:159]
    v_mfma_f32_16x16x32_bf16 v[128:131], v[104:107], a[76:79], v[128:131]
    v_mfma_f32_16x16x32_bf16 v[160:163], v[40:43], a[76:79], v[160:163]
    v_mfma_f32_16x16x32_bf16 v[132:135], v[104:107], a[84:87], v[132:135]
    v_mfma_f32_16x16x32_bf16 v[164:167], v[40:43], a[84:87], v[164:167]
    v_mfma_f32_16x16x32_bf16 v[136:139], v[104:107], a[92:95], v[136:139]
    v_mfma_f32_16x16x32_bf16 v[168:171], v[40:43], a[92:95], v[168:171]
    v_mfma_f32_16x16x32_bf16 v[108:111], v[80:83], a[100:103], v[108:111]
    v_mfma_f32_16x16x32_bf16 v[140:143], v[16:19], a[100:103], v[140:143]
    v_mfma_f32_16x16x32_bf16 v[112:115], v[80:83], a[108:111], v[112:115]
    v_mfma_f32_16x16x32_bf16 v[144:147], v[16:19], a[108:111], v[144:147]
    v_mfma_f32_16x16x32_bf16 v[116:119], v[80:83], a[116:119], v[116:119]
    v_mfma_f32_16x16x32_bf16 v[148:151], v[16:19], a[116:119], v[148:151]
    v_mfma_f32_16x16x32_bf16 v[120:123], v[80:83], a[124:127], v[120:123]
    v_mfma_f32_16x16x32_bf16 v[152:155], v[16:19], a[124:127], v[152:155]
    v_mfma_f32_16x16x32_bf16 v[124:127], v[88:91], a[100:103], v[124:127]
    v_mfma_f32_16x16x32_bf16 v[156:159], v[24:27], a[100:103], v[156:159]
    v_mfma_f32_16x16x32_bf16 v[128:131], v[88:91], a[108:111], v[128:131]
    v_mfma_f32_16x16x32_bf16 v[160:163], v[24:27], a[108:111], v[160:163]
    v_mfma_f32_16x16x32_bf16 v[132:135], v[88:91], a[116:119], v[132:135]
    v_mfma_f32_16x16x32_bf16 v[164:167], v[24:27], a[116:119], v[164:167]
    v_mfma_f32_16x16x32_bf16 v[136:139], v[88:91], a[124:127], v[136:139]
    v_mfma_f32_16x16x32_bf16 v[168:171], v[24:27], a[124:127], v[168:171]
    s_nop 7
    s_waitcnt vmcnt(0)
    v_mul_f32 v6, v108, v172
    v_mul_f32 v7, v140, v172
    v_fma_f32 v6, -v140, v204, v6
    v_fma_f32 v140, v108, v204, v7
    v_mov_b32 v108, v6
    v_mul_f32 v6, v109, v173
    v_mul_f32 v7, v141, v173
    v_fma_f32 v6, -v141, v205, v6
    v_fma_f32 v141, v109, v205, v7
    v_mov_b32 v109, v6
    v_mul_f32 v6, v110, v174
    v_mul_f32 v7, v142, v174
    v_fma_f32 v6, -v142, v206, v6
    v_fma_f32 v142, v110, v206, v7
    v_mov_b32 v110, v6
    v_mul_f32 v6, v111, v175
    v_mul_f32 v7, v143, v175
    v_fma_f32 v6, -v143, v207, v6
    v_fma_f32 v143, v111, v207, v7
    v_mov_b32 v111, v6
    v_mul_f32 v6, v112, v176
    v_mul_f32 v7, v144, v176
    v_fma_f32 v6, -v144, v208, v6
    v_fma_f32 v144, v112, v208, v7
    v_mov_b32 v112, v6
    v_mul_f32 v6, v113, v177
    v_mul_f32 v7, v145, v177
    v_fma_f32 v6, -v145, v209, v6
    v_fma_f32 v145, v113, v209, v7
    v_mov_b32 v113, v6
    v_mul_f32 v6, v114, v178
    v_mul_f32 v7, v146, v178
    v_fma_f32 v6, -v146, v210, v6
    v_fma_f32 v146, v114, v210, v7
    v_mov_b32 v114, v6
    v_mul_f32 v6, v115, v179
    v_mul_f32 v7, v147, v179
    v_fma_f32 v6, -v147, v211, v6
    v_fma_f32 v147, v115, v211, v7
    v_mov_b32 v115, v6
    v_mul_f32 v6, v116, v180
    v_mul_f32 v7, v148, v180
    v_fma_f32 v6, -v148, v212, v6
    v_fma_f32 v148, v116, v212, v7
    v_mov_b32 v116, v6
    v_mul_f32 v6, v117, v181
    v_mul_f32 v7, v149, v181
    v_fma_f32 v6, -v149, v213, v6
    v_fma_f32 v149, v117, v213, v7
    v_mov_b32 v117, v6
    v_mul_f32 v6, v118, v182
    v_mul_f32 v7, v150, v182
    v_fma_f32 v6, -v150, v214, v6
    v_fma_f32 v150, v118, v214, v7
    v_mov_b32 v118, v6
    v_mul_f32 v6, v119, v183
    v_mul_f32 v7, v151, v183
    v_fma_f32 v6, -v151, v215, v6
    v_fma_f32 v151, v119, v215, v7
    v_mov_b32 v119, v6
    v_mul_f32 v6, v120, v184
    v_mul_f32 v7, v152, v184
    v_fma_f32 v6, -v152, v216, v6
    v_fma_f32 v152, v120, v216, v7
    v_mov_b32 v120, v6
    v_mul_f32 v6, v121, v185
    v_mul_f32 v7, v153, v185
    v_fma_f32 v6, -v153, v217, v6
    v_fma_f32 v153, v121, v217, v7
    v_mov_b32 v121, v6
    v_mul_f32 v6, v122, v186
    v_mul_f32 v7, v154, v186
    v_fma_f32 v6, -v154, v218, v6
    v_fma_f32 v154, v122, v218, v7
    v_mov_b32 v122, v6
    v_mul_f32 v6, v123, v187
    v_mul_f32 v7, v155, v187
    v_fma_f32 v6, -v155, v219, v6
    v_fma_f32 v155, v123, v219, v7
    v_mov_b32 v123, v6
    v_mul_f32 v6, v124, v188
    v_mul_f32 v7, v156, v188
    v_fma_f32 v6, -v156, v220, v6
    v_fma_f32 v156, v124, v220, v7
    v_mov_b32 v124, v6
    v_mul_f32 v6, v125, v189
    v_mul_f32 v7, v157, v189
    v_fma_f32 v6, -v157, v221, v6
    v_fma_f32 v157, v125, v221, v7
    v_mov_b32 v125, v6
    v_mul_f32 v6, v126, v190
    v_mul_f32 v7, v158, v190
    v_fma_f32 v6, -v158, v222, v6
    v_fma_f32 v158, v126, v222, v7
    v_mov_b32 v126, v6
    v_mul_f32 v6, v127, v191
    v_mul_f32 v7, v159, v191
    v_fma_f32 v6, -v159, v223, v6
    v_fma_f32 v159, v127, v223, v7
    v_mov_b32 v127, v6
    v_mul_f32 v6, v128, v192
    v_mul_f32 v7, v160, v192
    v_fma_f32 v6, -v160, v224, v6
    v_fma_f32 v160, v128, v224, v7
    v_mov_b32 v128, v6
    v_mul_f32 v6, v129, v193
    v_mul_f32 v7, v161, v193
    v_fma_f32 v6, -v161, v225, v6
    v_fma_f32 v161, v129, v225, v7
    v_mov_b32 v129, v6
    v_mul_f32 v6, v130, v194
    v_mul_f32 v7, v162, v194
    v_fma_f32 v6, -v162, v226, v6
    v_fma_f32 v162, v130, v226, v7
    v_mov_b32 v130, v6
    v_mul_f32 v6, v131, v195
    v_mul_f32 v7, v163, v195
    v_fma_f32 v6, -v163, v227, v6
    v_fma_f32 v163, v131, v227, v7
    v_mov_b32 v131, v6
    v_mul_f32 v6, v132, v196
    v_mul_f32 v7, v164, v196
    v_fma_f32 v6, -v164, v228, v6
    v_fma_f32 v164, v132, v228, v7
    v_mov_b32 v132, v6
    v_mul_f32 v6, v133, v197
    v_mul_f32 v7, v165, v197
    v_fma_f32 v6, -v165, v229, v6
    v_fma_f32 v165, v133, v229, v7
    v_mov_b32 v133, v6
    v_mul_f32 v6, v134, v198
    v_mul_f32 v7, v166, v198
    v_fma_f32 v6, -v166, v230, v6
    v_fma_f32 v166, v134, v230, v7
    v_mov_b32 v134, v6
    v_mul_f32 v6, v135, v199
    v_mul_f32 v7, v167, v199
    v_fma_f32 v6, -v167, v231, v6
    v_fma_f32 v167, v135, v231, v7
    v_mov_b32 v135, v6
    v_mul_f32 v6, v136, v200
    v_mul_f32 v7, v168, v200
    v_fma_f32 v6, -v168, v232, v6
    v_fma_f32 v168, v136, v232, v7
    v_mov_b32 v136, v6
    v_mul_f32 v6, v137, v201
    v_mul_f32 v7, v169, v201
    v_fma_f32 v6, -v169, v233, v6
    v_fma_f32 v169, v137, v233, v7
    v_mov_b32 v137, v6
    v_mul_f32 v6, v138, v202
    v_mul_f32 v7, v170, v202
    v_fma_f32 v6, -v170, v234, v6
    v_fma_f32 v170, v138, v234, v7
    v_mov_b32 v138, v6
    v_mul_f32 v6, v139, v203
    v_mul_f32 v7, v171, v203
    v_fma_f32 v6, -v171, v235, v6
    v_fma_f32 v171, v139, v235, v7
    v_mov_b32 v139, v6
    v_cvt_pk_bf16_f32 v12, v108, v109
    v_lshlrev_b32 v6, 16, v12
    v_and_b32 v7, 0xffff0000, v12
    v_sub_f32 v6, v108, v6
    v_sub_f32 v7, v109, v7
    v_cvt_pk_bf16_f32 v28, v6, v7
    v_cvt_pk_bf16_f32 v13, v110, v111
    v_lshlrev_b32 v6, 16, v13
    v_and_b32 v7, 0xffff0000, v13
    v_sub_f32 v6, v110, v6
    v_sub_f32 v7, v111, v7
    v_cvt_pk_bf16_f32 v29, v6, v7
    v_cvt_pk_bf16_f32 v14, v124, v125
    v_lshlrev_b32 v6, 16, v14
    v_and_b32 v7, 0xffff0000, v14
    v_sub_f32 v6, v124, v6
    v_sub_f32 v7, v125, v7
    v_cvt_pk_bf16_f32 v30, v6, v7
    v_cvt_pk_bf16_f32 v15, v126, v127
    v_lshlrev_b32 v6, 16, v15
    v_and_b32 v7, 0xffff0000, v15
    v_sub_f32 v6, v126, v6
    v_sub_f32 v7, v127, v7
    v_cvt_pk_bf16_f32 v31, v6, v7
    v_cvt_pk_bf16_f32 v16, v112, v113
    v_lshlrev_b32 v6, 16, v16
    v_and_b32 v7, 0xffff0000, v16
    v_sub_f32 v6, v112, v6
    v_sub_f32 v7, v113, v7
    v_cvt_pk_bf16_f32 v32, v6, v7
    v_cvt_pk_bf16_f32 v17, v114, v115
    v_lshlrev_b32 v6, 16, v17
    v_and_b32 v7, 0xffff0000, v17
    v_sub_f32 v6, v114, v6
    v_sub_f32 v7, v115, v7
    v_cvt_pk_bf16_f32 v33, v6, v7
    v_cvt_pk_bf16_f32 v18, v128, v129
    v_lshlrev_b32 v6, 16, v18
    v_and_b32 v7, 0xffff0000, v18
    v_sub_f32 v6, v128, v6
    v_sub_f32 v7, v129, v7
    v_cvt_pk_bf16_f32 v34, v6, v7
    v_cvt_pk_bf16_f32 v19, v130, v131
    v_lshlrev_b32 v6, 16, v19
    v_and_b32 v7, 0xffff0000, v19
    v_sub_f32 v6, v130, v6
    v_sub_f32 v7, v131, v7
    v_cvt_pk_bf16_f32 v35, v6, v7
    v_cvt_pk_bf16_f32 v20, v116, v117
    v_lshlrev_b32 v6, 16, v20
    v_and_b32 v7, 0xffff0000, v20
    v_sub_f32 v6, v116, v6
    v_sub_f32 v7, v117, v7
    v_cvt_pk_bf16_f32 v36, v6, v7
    v_cvt_pk_bf16_f32 v21, v118, v119
    v_lshlrev_b32 v6, 16, v21
    v_and_b32 v7, 0xffff0000, v21
    v_sub_f32 v6, v118, v6
    v_sub_f32 v7, v119, v7
    v_cvt_pk_bf16_f32 v37, v6, v7
    v_cvt_pk_bf16_f32 v22, v132, v133
    v_lshlrev_b32 v6, 16, v22
    v_and_b32 v7, 0xffff0000, v22
    v_sub_f32 v6, v132, v6
    v_sub_f32 v7, v133, v7
    v_cvt_pk_bf16_f32 v38, v6, v7
    v_cvt_pk_bf16_f32 v23, v134, v135
    v_lshlrev_b32 v6, 16, v23
    v_and_b32 v7, 0xffff0000, v23
    v_sub_f32 v6, v134, v6
    v_sub_f32 v7, v135, v7
    v_cvt_pk_bf16_f32 v39, v6, v7
    v_cvt_pk_bf16_f32 v24, v120, v121
    v_lshlrev_b32 v6, 16, v24
    v_and_b32 v7, 0xffff0000, v24
    v_sub_f32 v6, v120, v6
    v_sub_f32 v7, v121, v7
    v_cvt_pk_bf16_f32 v40, v6, v7
    v_cvt_pk_bf16_f32 v25, v122, v123
    v_lshlrev_b32 v6, 16, v25
    v_and_b32 v7, 0xffff0000, v25
    v_sub_f32 v6, v122, v6
    v_sub_f32 v7, v123, v7
    v_cvt_pk_bf16_f32 v41, v6, v7
    v_cvt_pk_bf16_f32 v26, v136, v137
    v_lshlrev_b32 v6, 16, v26
    v_and_b32 v7, 0xffff0000, v26
    v_sub_f32 v6, v136, v6
    v_sub_f32 v7, v137, v7
    v_cvt_pk_bf16_f32 v42, v6, v7
    v_cvt_pk_bf16_f32 v27, v138, v139
    v_lshlrev_b32 v6, 16, v27
    v_and_b32 v7, 0xffff0000, v27
    v_sub_f32 v6, v138, v6
    v_sub_f32 v7, v139, v7
    v_cvt_pk_bf16_f32 v43, v6, v7
    v_cvt_pk_bf16_f32 v44, v140, v141
    v_lshlrev_b32 v6, 16, v44
    v_and_b32 v7, 0xffff0000, v44
    v_sub_f32 v6, v140, v6
    v_sub_f32 v7, v141, v7
    v_cvt_pk_bf16_f32 v60, v6, v7
    v_cvt_pk_bf16_f32 v45, v142, v143
    v_lshlrev_b32 v6, 16, v45
    v_and_b32 v7, 0xffff0000, v45
    v_sub_f32 v6, v142, v6
    v_sub_f32 v7, v143, v7
    v_cvt_pk_bf16_f32 v61, v6, v7
    v_cvt_pk_bf16_f32 v46, v156, v157
    v_lshlrev_b32 v6, 16, v46
    v_and_b32 v7, 0xffff0000, v46
    v_sub_f32 v6, v156, v6
    v_sub_f32 v7, v157, v7
    v_cvt_pk_bf16_f32 v62, v6, v7
    v_cvt_pk_bf16_f32 v47, v158, v159
    v_lshlrev_b32 v6, 16, v47
    v_and_b32 v7, 0xffff0000, v47
    v_sub_f32 v6, v158, v6
    v_sub_f32 v7, v159, v7
    v_cvt_pk_bf16_f32 v63, v6, v7
    v_cvt_pk_bf16_f32 v48, v144, v145
    v_lshlrev_b32 v6, 16, v48
    v_and_b32 v7, 0xffff0000, v48
    v_sub_f32 v6, v144, v6
    v_sub_f32 v7, v145, v7
    v_cvt_pk_bf16_f32 v64, v6, v7
    v_cvt_pk_bf16_f32 v49, v146, v147
    v_lshlrev_b32 v6, 16, v49
    v_and_b32 v7, 0xffff0000, v49
    v_sub_f32 v6, v146, v6
    v_sub_f32 v7, v147, v7
    v_cvt_pk_bf16_f32 v65, v6, v7
    v_cvt_pk_bf16_f32 v50, v160, v161
    v_lshlrev_b32 v6, 16, v50
    v_and_b32 v7, 0xffff0000, v50
    v_sub_f32 v6, v160, v6
    v_sub_f32 v7, v161, v7
    v_cvt_pk_bf16_f32 v66, v6, v7
    v_cvt_pk_bf16_f32 v51, v162, v163
    v_lshlrev_b32 v6, 16, v51
    v_and_b32 v7, 0xffff0000, v51
    v_sub_f32 v6, v162, v6
    v_sub_f32 v7, v163, v7
    v_cvt_pk_bf16_f32 v67, v6, v7
    v_cvt_pk_bf16_f32 v52, v148, v149
    v_lshlrev_b32 v6, 16, v52
    v_and_b32 v7, 0xffff0000, v52
    v_sub_f32 v6, v148, v6
    v_sub_f32 v7, v149, v7
    v_cvt_pk_bf16_f32 v68, v6, v7
    v_cvt_pk_bf16_f32 v53, v150, v151
    v_lshlrev_b32 v6, 16, v53
    v_and_b32 v7, 0xffff0000, v53
    v_sub_f32 v6, v150, v6
    v_sub_f32 v7, v151, v7
    v_cvt_pk_bf16_f32 v69, v6, v7
    v_cvt_pk_bf16_f32 v54, v164, v165
    v_lshlrev_b32 v6, 16, v54
    v_and_b32 v7, 0xffff0000, v54
    v_sub_f32 v6, v164, v6
    v_sub_f32 v7, v165, v7
    v_cvt_pk_bf16_f32 v70, v6, v7
    v_cvt_pk_bf16_f32 v55, v166, v167
    v_lshlrev_b32 v6, 16, v55
    v_and_b32 v7, 0xffff0000, v55
    v_sub_f32 v6, v166, v6
    v_sub_f32 v7, v167, v7
    v_cvt_pk_bf16_f32 v71, v6, v7
    v_cvt_pk_bf16_f32 v56, v152, v153
    v_lshlrev_b32 v6, 16, v56
    v_and_b32 v7, 0xffff0000, v56
    v_sub_f32 v6, v152, v6
    v_sub_f32 v7, v153, v7
    v_cvt_pk_bf16_f32 v72, v6, v7
    v_cvt_pk_bf16_f32 v57, v154, v155
    v_lshlrev_b32 v6, 16, v57
    v_and_b32 v7, 0xffff0000, v57
    v_sub_f32 v6, v154, v6
    v_sub_f32 v7, v155, v7
    v_cvt_pk_bf16_f32 v73, v6, v7
    v_cvt_pk_bf16_f32 v58, v168, v169
    v_lshlrev_b32 v6, 16, v58
    v_and_b32 v7, 0xffff0000, v58
    v_sub_f32 v6, v168, v6
    v_sub_f32 v7, v169, v7
    v_cvt_pk_bf16_f32 v74, v6, v7
    v_cvt_pk_bf16_f32 v59, v170, v171
    v_lshlrev_b32 v6, 16, v59
    v_and_b32 v7, 0xffff0000, v59
    v_sub_f32 v6, v170, v6
    v_sub_f32 v7, v171, v7
    v_cvt_pk_bf16_f32 v75, v6, v7
    v_xor_b32 v76, 0x80008000, v44
    v_xor_b32 v77, 0x80008000, v45
    v_xor_b32 v78, 0x80008000, v46
    v_xor_b32 v79, 0x80008000, v47
    v_xor_b32 v80, 0x80008000, v48
    v_xor_b32 v81, 0x80008000, v49
    v_xor_b32 v82, 0x80008000, v50
    v_xor_b32 v83, 0x80008000, v51
    v_xor_b32 v84, 0x80008000, v52
    v_xor_b32 v85, 0x80008000, v53
    v_xor_b32 v86, 0x80008000, v54
    v_xor_b32 v87, 0x80008000, v55
    v_xor_b32 v88, 0x80008000, v56
    v_xor_b32 v89, 0x80008000, v57
    v_xor_b32 v90, 0x80008000, v58
    v_xor_b32 v91, 0x80008000, v59
    v_xor_b32 v92, 0x80008000, v60
    v_xor_b32 v93, 0x80008000, v61
    v_xor_b32 v94, 0x80008000, v62
    v_xor_b32 v95, 0x80008000, v63
    v_xor_b32 v96, 0x80008000, v64
    v_xor_b32 v97, 0x80008000, v65
    v_xor_b32 v98, 0x80008000, v66
    v_xor_b32 v99, 0x80008000, v67
    v_xor_b32 v100, 0x80008000, v68
    v_xor_b32 v101, 0x80008000, v69
    v_xor_b32 v102, 0x80008000, v70
    v_xor_b32 v103, 0x80008000, v71
    v_xor_b32 v104, 0x80008000, v72
    v_xor_b32 v105, 0x80008000, v73
    v_xor_b32 v106, 0x80008000, v74
    v_xor_b32 v107, 0x80008000, v75
    s_nop 1
    v_mfma_f32_16x16x32_bf16 v[108:111], v[12:15], a[128:131], 0
    v_mfma_f32_16x16x32_bf16 v[140:143], v[44:47], a[128:131], 0
    v_mfma_f32_16x16x32_bf16 v[112:115], v[12:15], a[132:135], 0
    v_mfma_f32_16x16x32_bf16 v[144:147], v[44:47], a[132:135], 0
    v_mfma_f32_16x16x32_bf16 v[116:119], v[16:19], a[128:131], 0
    v_mfma_f32_16x16x32_bf16 v[148:151], v[48:51], a[128:131], 0
    v_mfma_f32_16x16x32_bf16 v[120:123], v[16:19], a[132:135], 0
    v_mfma_f32_16x16x32_bf16 v[152:155], v[48:51], a[132:135], 0
    v_mfma_f32_16x16x32_bf16 v[124:127], v[20:23], a[128:131], 0
    v_mfma_f32_16x16x32_bf16 v[156:159], v[52:55], a[128:131], 0
    v_mfma_f32_16x16x32_bf16 v[128:131], v[20:23], a[132:135], 0
    v_mfma_f32_16x16x32_bf16 v[160:163], v[52:55], a[132:135], 0
    v_mfma_f32_16x16x32_bf16 v[132:135], v[24:27], a[128:131], 0
    v_mfma_f32_16x16x32_bf16 v[164:167], v[56:59], a[128:131], 0
    v_mfma_f32_16x16x32_bf16 v[136:139], v[24:27], a[132:135], 0
    v_mfma_f32_16x16x32_bf16 v[168:171], v[56:59], a[132:135], 0
    v_mfma_f32_16x16x32_bf16 v[108:111], v[28:31], a[128:131], v[108:111]
    v_mfma_f32_16x16x32_bf16 v[140:143], v[60:63], a[128:131], v[140:143]
    v_mfma_f32_16x16x32_bf16 v[112:115], v[28:31], a[132:135], v[112:115]
    v_mfma_f32_16x16x32_bf16 v[144:147], v[60:63], a[132:135], v[144:147]
    v_mfma_f32_16x16x32_bf16 v[116:119], v[32:35], a[128:131], v[116:119]
    v_mfma_f32_16x16x32_bf16 v[148:151], v[64:67], a[128:131], v[148:151]
    v_mfma_f32_16x16x32_bf16 v[120:123], v[32:35], a[132:135], v[120:123]
    v_mfma_f32_16x16x32_bf16 v[152:155], v[64:67], a[132:135], v[152:155]
    v_mfma_f32_16x16x32_bf16 v[124:127], v[36:39], a[128:131], v[124:127]
    v_mfma_f32_16x16x32_bf16 v[156:159], v[68:71], a[128:131], v[156:159]
    v_mfma_f32_16x16x32_bf16 v[128:131], v[36:39], a[132:135], v[128:131]
    v_mfma_f32_16x16x32_bf16 v[160:163], v[68:71], a[132:135], v[160:163]
    v_mfma_f32_16x16x32_bf16 v[132:135], v[40:43], a[128:131], v[132:135]
    v_mfma_f32_16x16x32_bf16 v[164:167], v[72:75], a[128:131], v[164:167]
    v_mfma_f32_16x16x32_bf16 v[136:139], v[40:43], a[132:135], v[136:139]
    v_mfma_f32_16x16x32_bf16 v[168:171], v[72:75], a[132:135], v[168:171]
    v_mfma_f32_16x16x32_bf16 v[108:111], v[12:15], a[136:139], v[108:111]
    v_mfma_f32_16x16x32_bf16 v[140:143], v[44:47], a[136:139], v[140:143]
    v_mfma_f32_16x16x32_bf16 v[112:115], v[12:15], a[140:143], v[112:115]
    v_mfma_f32_16x16x32_bf16 v[144:147], v[44:47], a[140:143], v[144:147]
    v_mfma_f32_16x16x32_bf16 v[116:119], v[16:19], a[136:139], v[116:119]
    v_mfma_f32_16x16x32_bf16 v[148:151], v[48:51], a[136:139], v[148:151]
    v_mfma_f32_16x16x32_bf16 v[120:123], v[16:19], a[140:143], v[120:123]
    v_mfma_f32_16x16x32_bf16 v[152:155], v[48:51], a[140:143], v[152:155]
    v_mfma_f32_16x16x32_bf16 v[124:127], v[20:23], a[136:139], v[124:127]
    v_mfma_f32_16x16x32_bf16 v[156:159], v[52:55], a[136:139], v[156:159]
    v_mfma_f32_16x16x32_bf16 v[128:131], v[20:23], a[140:143], v[128:131]
    v_mfma_f32_16x16x32_bf16 v[160:163], v[52:55], a[140:143], v[160:163]
    v_mfma_f32_16x16x32_bf16 v[132:135], v[24:27], a[136:139], v[132:135]
    v_mfma_f32_16x16x32_bf16 v[164:167], v[56:59], a[136:139], v[164:167]
    v_mfma_f32_16x16x32_bf16 v[136:139], v[24:27], a[140:143], v[136:139]
    v_mfma_f32_16x16x32_bf16 v[168:171], v[56:59], a[140:143], v[168:171]
    v_mfma_f32_16x16x32_bf16 v[108:111], v[76:79], a[144:147], v[108:111]
    v_mfma_f32_16x16x32_bf16 v[140:143], v[12:15], a[144:147], v[140:143]
    v_mfma_f32_16x16x32_bf16 v[112:115], v[76:79], a[148:151], v[112:115]
    v_mfma_f32_16x16x32_bf16 v[144:147], v[12:15], a[148:151], v[144:147]
    v_mfma_f32_16x16x32_bf16 v[116:119], v[80:83], a[144:147], v[116:119]
    v_mfma_f32_16x16x32_bf16 v[148:151], v[16:19], a[144:147], v[148:151]
    v_mfma_f32_16x16x32_bf16 v[120:123], v[80:83], a[148:151], v[120:123]
    v_mfma_f32_16x16x32_bf16 v[152:155], v[16:19], a[148:151], v[152:155]
    v_mfma_f32_16x16x32_bf16 v[124:127], v[84:87], a[144:147], v[124:127]
    v_mfma_f32_16x16x32_bf16 v[156:159], v[20:23], a[144:147], v[156:159]
    v_mfma_f32_16x16x32_bf16 v[128:131], v[84:87], a[148:151], v[128:131]
    v_mfma_f32_16x16x32_bf16 v[160:163], v[20:23], a[148:151], v[160:163]
    v_mfma_f32_16x16x32_bf16 v[132:135], v[88:91], a[144:147], v[132:135]
    v_mfma_f32_16x16x32_bf16 v[164:167], v[24:27], a[144:147], v[164:167]
    v_mfma_f32_16x16x32_bf16 v[136:139], v[88:91], a[148:151], v[136:139]
    v_mfma_f32_16x16x32_bf16 v[168:171], v[24:27], a[148:151], v[168:171]
    v_mfma_f32_16x16x32_bf16 v[108:111], v[92:95], a[144:147], v[108:111]
    v_mfma_f32_16x16x32_bf16 v[140:143], v[28:31], a[144:147], v[140:143]
    v_mfma_f32_16x16x32_bf16 v[112:115], v[92:95], a[148:151], v[112:115]
    v_mfma_f32_16x16x32_bf16 v[144:147], v[28:31], a[148:151], v[144:147]
    v_mfma_f32_16x16x32_bf16 v[116:119], v[96:99], a[144:147], v[116:119]
    v_mfma_f32_16x16x32_bf16 v[148:151], v[32:35], a[144:147], v[148:151]
    v_mfma_f32_16x16x32_bf16 v[120:123], v[96:99], a[148:151], v[120:123]
    v_mfma_f32_16x16x32_bf16 v[152:155], v[32:35], a[148:151], v[152:155]
    v_mfma_f32_16x16x32_bf16 v[124:127], v[100:103], a[144:147], v[124:127]
    v_mfma_f32_16x16x32_bf16 v[156:159], v[36:39], a[144:147], v[156:159]
    v_mfma_f32_16x16x32_bf16 v[128:131], v[100:103], a[148:151], v[128:131]
    v_mfma_f32_16x16x32_bf16 v[160:163], v[36:39], a[148:151], v[160:163]
    v_mfma_f32_16x16x32_bf16 v[132:135], v[104:107], a[144:147], v[132:135]
    v_mfma_f32_16x16x32_bf16 v[164:167], v[40:43], a[144:147], v[164:167]
    v_mfma_f32_16x16x32_bf16 v[136:139], v[104:107], a[148:151], v[136:139]
    v_mfma_f32_16x16x32_bf16 v[168:171], v[40:43], a[148:151], v[168:171]
    v_mfma_f32_16x16x32_bf16 v[108:111], v[76:79], a[152:155], v[108:111]
    v_mfma_f32_16x16x32_bf16 v[140:143], v[12:15], a[152:155], v[140:143]
    v_mfma_f32_16x16x32_bf16 v[112:115], v[76:79], a[156:159], v[112:115]
    v_mfma_f32_16x16x32_bf16 v[144:147], v[12:15], a[156:159], v[144:147]
    v_mfma_f32_16x16x32_bf16 v[116:119], v[80:83], a[152:155], v[116:119]
    v_mfma_f32_16x16x32_bf16 v[148:151], v[16:19], a[152:155], v[148:151]
    v_mfma_f32_16x16x32_bf16 v[120:123], v[80:83], a[156:159], v[120:123]
    v_mfma_f32_16x16x32_bf16 v[152:155], v[16:19], a[156:159], v[152:155]
    v_mfma_f32_16x16x32_bf16 v[124:127], v[84:87], a[152:155], v[124:127]
    v_mfma_f32_16x16x32_bf16 v[156:159], v[20:23], a[152:155], v[156:159]
    v_mfma_f32_16x16x32_bf16 v[128:131], v[84:87], a[156:159], v[128:131]
    v_mfma_f32_16x16x32_bf16 v[160:163], v[20:23], a[156:159], v[160:163]
    v_mfma_f32_16x16x32_bf16 v[132:135], v[88:91], a[152:155], v[132:135]
    v_mfma_f32_16x16x32_bf16 v[164:167], v[24:27], a[152:155], v[164:167]
    v_mfma_f32_16x16x32_bf16 v[136:139], v[88:91], a[156:159], v[136:139]
    v_mfma_f32_16x16x32_bf16 v[168:171], v[24:27], a[156:159], v[168:171]
    s_nop 7
    s_lshl_b32 s52, s42, 14
    v_lshlrev_b32 v10, 7, v2
    v_lshl_add_u32 v10, v3, 3, v10
    v_add_u32 v10, s52, v10
    v_cvt_pk_bf16_f32 v12, v108, v109
    v_lshlrev_b32 v6, 16, v12
    v_and_b32 v7, 0xffff0000, v12
    v_sub_f32 v6, v108, v6
    v_sub_f32 v7, v109, v7
    v_cvt_pk_bf16_f32 v14, v6, v7
    v_cvt_pk_bf16_f32 v13, v110, v111
    v_lshlrev_b32 v6, 16, v13
    v_and_b32 v7, 0xffff0000, v13
    v_sub_f32 v6, v110, v6
    v_sub_f32 v7, v111, v7
    v_cvt_pk_bf16_f32 v15, v6, v7
    ds_write_b64 v10, v[12:13] offset:0
    ds_write_b64 v10, v[14:15] offset:4096
    v_cvt_pk_bf16_f32 v16, v112, v113
    v_lshlrev_b32 v6, 16, v16
    v_and_b32 v7, 0xffff0000, v16
    v_sub_f32 v6, v112, v6
    v_sub_f32 v7, v113, v7
    v_cvt_pk_bf16_f32 v18, v6, v7
    v_cvt_pk_bf16_f32 v17, v114, v115
    v_lshlrev_b32 v6, 16, v17
    v_and_b32 v7, 0xffff0000, v17
    v_sub_f32 v6, v114, v6
    v_sub_f32 v7, v115, v7
    v_cvt_pk_bf16_f32 v19, v6, v7
    ds_write_b64 v10, v[16:17] offset:2048
    ds_write_b64 v10, v[18:19] offset:6144
    v_cvt_pk_bf16_f32 v20, v116, v117
    v_lshlrev_b32 v6, 16, v20
    v_and_b32 v7, 0xffff0000, v20
    v_sub_f32 v6, v116, v6
    v_sub_f32 v7, v117, v7
    v_cvt_pk_bf16_f32 v22, v6, v7
    v_cvt_pk_bf16_f32 v21, v118, v119
    v_lshlrev_b32 v6, 16, v21
    v_and_b32 v7, 0xffff0000, v21
    v_sub_f32 v6, v118, v6
    v_sub_f32 v7, v119, v7
    v_cvt_pk_bf16_f32 v23, v6, v7
    ds_write_b64 v10, v[20:21] offset:32
    ds_write_b64 v10, v[22:23] offset:4128
    v_cvt_pk_bf16_f32 v24, v120, v121
    v_lshlrev_b32 v6, 16, v24
    v_and_b32 v7, 0xffff0000, v24
    v_sub_f32 v6, v120, v6
    v_sub_f32 v7, v121, v7
    v_cvt_pk_bf16_f32 v26, v6, v7
    v_cvt_pk_bf16_f32 v25, v122, v123
    v_lshlrev_b32 v6, 16, v25
    v_and_b32 v7, 0xffff0000, v25
    v_sub_f32 v6, v122, v6
    v_sub_f32 v7, v123, v7
    v_cvt_pk_bf16_f32 v27, v6, v7
    ds_write_b64 v10, v[24:25] offset:2080
    ds_write_b64 v10, v[26:27] offset:6176
    v_cvt_pk_bf16_f32 v28, v124, v125
    v_lshlrev_b32 v6, 16, v28
    v_and_b32 v7, 0xffff0000, v28
    v_sub_f32 v6, v124, v6
    v_sub_f32 v7, v125, v7
    v_cvt_pk_bf16_f32 v30, v6, v7
    v_cvt_pk_bf16_f32 v29, v126, v127
    v_lshlrev_b32 v6, 16, v29
    v_and_b32 v7, 0xffff0000, v29
    v_sub_f32 v6, v126, v6
    v_sub_f32 v7, v127, v7
    v_cvt_pk_bf16_f32 v31, v6, v7
    ds_write_b64 v10, v[28:29] offset:64
    ds_write_b64 v10, v[30:31] offset:4160
    v_cvt_pk_bf16_f32 v32, v128, v129
    v_lshlrev_b32 v6, 16, v32
    v_and_b32 v7, 0xffff0000, v32
    v_sub_f32 v6, v128, v6
    v_sub_f32 v7, v129, v7
    v_cvt_pk_bf16_f32 v34, v6, v7
    v_cvt_pk_bf16_f32 v33, v130, v131
    v_lshlrev_b32 v6, 16, v33
    v_and_b32 v7, 0xffff0000, v33
    v_sub_f32 v6, v130, v6
    v_sub_f32 v7, v131, v7
    v_cvt_pk_bf16_f32 v35, v6, v7
    ds_write_b64 v10, v[32:33] offset:2112
    ds_write_b64 v10, v[34:35] offset:6208
    v_cvt_pk_bf16_f32 v36, v132, v133
    v_lshlrev_b32 v6, 16, v36
    v_and_b32 v7, 0xffff0000, v36
    v_sub_f32 v6, v132, v6
    v_sub_f32 v7, v133, v7
    v_cvt_pk_bf16_f32 v38, v6, v7
    v_cvt_pk_bf16_f32 v37, v134, v135
    v_lshlrev_b32 v6, 16, v37
    v_and_b32 v7, 0xffff0000, v37
    v_sub_f32 v6, v134, v6
    v_sub_f32 v7, v135, v7
    v_cvt_pk_bf16_f32 v39, v6, v7
    ds_write_b64 v10, v[36:37] offset:96
    ds_write_b64 v10, v[38:39] offset:4192
    v_cvt_pk_bf16_f32 v40, v136, v137
    v_lshlrev_b32 v6, 16, v40
    v_and_b32 v7, 0xffff0000, v40
    v_sub_f32 v6, v136, v6
    v_sub_f32 v7, v137, v7
    v_cvt_pk_bf16_f32 v42, v6, v7
    v_cvt_pk_bf16_f32 v41, v138, v139
    v_lshlrev_b32 v6, 16, v41
    v_and_b32 v7, 0xffff0000, v41
    v_sub_f32 v6, v138, v6
    v_sub_f32 v7, v139, v7
    v_cvt_pk_bf16_f32 v43, v6, v7
    ds_write_b64 v10, v[40:41] offset:2144
    ds_write_b64 v10, v[42:43] offset:6240
    v_cvt_pk_bf16_f32 v12, v140, v141
    v_lshlrev_b32 v6, 16, v12
    v_and_b32 v7, 0xffff0000, v12
    v_sub_f32 v6, v140, v6
    v_sub_f32 v7, v141, v7
    v_cvt_pk_bf16_f32 v14, v6, v7
    v_cvt_pk_bf16_f32 v13, v142, v143
    v_lshlrev_b32 v6, 16, v13
    v_and_b32 v7, 0xffff0000, v13
    v_sub_f32 v6, v142, v6
    v_sub_f32 v7, v143, v7
    v_cvt_pk_bf16_f32 v15, v6, v7
    ds_write_b64 v10, v[12:13] offset:8192
    ds_write_b64 v10, v[14:15] offset:12288
    v_cvt_pk_bf16_f32 v16, v144, v145
    v_lshlrev_b32 v6, 16, v16
    v_and_b32 v7, 0xffff0000, v16
    v_sub_f32 v6, v144, v6
    v_sub_f32 v7, v145, v7
    v_cvt_pk_bf16_f32 v18, v6, v7
    v_cvt_pk_bf16_f32 v17, v146, v147
    v_lshlrev_b32 v6, 16, v17
    v_and_b32 v7, 0xffff0000, v17
    v_sub_f32 v6, v146, v6
    v_sub_f32 v7, v147, v7
    v_cvt_pk_bf16_f32 v19, v6, v7
    ds_write_b64 v10, v[16:17] offset:10240
    ds_write_b64 v10, v[18:19] offset:14336
    v_cvt_pk_bf16_f32 v20, v148, v149
    v_lshlrev_b32 v6, 16, v20
    v_and_b32 v7, 0xffff0000, v20
    v_sub_f32 v6, v148, v6
    v_sub_f32 v7, v149, v7
    v_cvt_pk_bf16_f32 v22, v6, v7
    v_cvt_pk_bf16_f32 v21, v150, v151
    v_lshlrev_b32 v6, 16, v21
    v_and_b32 v7, 0xffff0000, v21
    v_sub_f32 v6, v150, v6
    v_sub_f32 v7, v151, v7
    v_cvt_pk_bf16_f32 v23, v6, v7
    ds_write_b64 v10, v[20:21] offset:8224
    ds_write_b64 v10, v[22:23] offset:12320
    v_cvt_pk_bf16_f32 v24, v152, v153
    v_lshlrev_b32 v6, 16, v24
    v_and_b32 v7, 0xffff0000, v24
    v_sub_f32 v6, v152, v6
    v_sub_f32 v7, v153, v7
    v_cvt_pk_bf16_f32 v26, v6, v7
    v_cvt_pk_bf16_f32 v25, v154, v155
    v_lshlrev_b32 v6, 16, v25
    v_and_b32 v7, 0xffff0000, v25
    v_sub_f32 v6, v154, v6
    v_sub_f32 v7, v155, v7
    v_cvt_pk_bf16_f32 v27, v6, v7
    ds_write_b64 v10, v[24:25] offset:10272
    ds_write_b64 v10, v[26:27] offset:14368
    v_cvt_pk_bf16_f32 v28, v156, v157
    v_lshlrev_b32 v6, 16, v28
    v_and_b32 v7, 0xffff0000, v28
    v_sub_f32 v6, v156, v6
    v_sub_f32 v7, v157, v7
    v_cvt_pk_bf16_f32 v30, v6, v7
    v_cvt_pk_bf16_f32 v29, v158, v159
    v_lshlrev_b32 v6, 16, v29
    v_and_b32 v7, 0xffff0000, v29
    v_sub_f32 v6, v158, v6
    v_sub_f32 v7, v159, v7
    v_cvt_pk_bf16_f32 v31, v6, v7
    ds_write_b64 v10, v[28:29] offset:8256
    ds_write_b64 v10, v[30:31] offset:12352
    v_cvt_pk_bf16_f32 v32, v160, v161
    v_lshlrev_b32 v6, 16, v32
    v_and_b32 v7, 0xffff0000, v32
    v_sub_f32 v6, v160, v6
    v_sub_f32 v7, v161, v7
    v_cvt_pk_bf16_f32 v34, v6, v7
    v_cvt_pk_bf16_f32 v33, v162, v163
    v_lshlrev_b32 v6, 16, v33
    v_and_b32 v7, 0xffff0000, v33
    v_sub_f32 v6, v162, v6
    v_sub_f32 v7, v163, v7
    v_cvt_pk_bf16_f32 v35, v6, v7
    ds_write_b64 v10, v[32:33] offset:10304
    ds_write_b64 v10, v[34:35] offset:14400
    v_cvt_pk_bf16_f32 v36, v164, v165
    v_lshlrev_b32 v6, 16, v36
    v_and_b32 v7, 0xffff0000, v36
    v_sub_f32 v6, v164, v6
    v_sub_f32 v7, v165, v7
    v_cvt_pk_bf16_f32 v38, v6, v7
    v_cvt_pk_bf16_f32 v37, v166, v167
    v_lshlrev_b32 v6, 16, v37
    v_and_b32 v7, 0xffff0000, v37
    v_sub_f32 v6, v166, v6
    v_sub_f32 v7, v167, v7
    v_cvt_pk_bf16_f32 v39, v6, v7
    ds_write_b64 v10, v[36:37] offset:8288
    ds_write_b64 v10, v[38:39] offset:12384
    v_cvt_pk_bf16_f32 v40, v168, v169
    v_lshlrev_b32 v6, 16, v40
    v_and_b32 v7, 0xffff0000, v40
    v_sub_f32 v6, v168, v6
    v_sub_f32 v7, v169, v7
    v_cvt_pk_bf16_f32 v42, v6, v7
    v_cvt_pk_bf16_f32 v41, v170, v171
    v_lshlrev_b32 v6, 16, v41
    v_and_b32 v7, 0xffff0000, v41
    v_sub_f32 v6, v170, v6
    v_sub_f32 v7, v171, v7
    v_cvt_pk_bf16_f32 v43, v6, v7
    ds_write_b64 v10, v[40:41] offset:10336
    ds_write_b64 v10, v[42:43] offset:14432
    v_add_u32 v10, s52, v8
    s_lshl_b32 s44, s41, 12
    s_add_u32 s44, s44, 0xa800000
    s_waitcnt lgkmcnt(0)
    ds_read_b128 v[108:111], v10 offset:0
    ds_read_b128 v[112:115], v10 offset:1024
    ds_read_b128 v[116:119], v10 offset:2048
    ds_read_b128 v[120:123], v10 offset:3072
    ds_read_b128 v[124:127], v10 offset:4096
    ds_read_b128 v[128:131], v10 offset:5120
    ds_read_b128 v[132:135], v10 offset:6144
    ds_read_b128 v[136:139], v10 offset:7168
    ds_read_b128 v[140:143], v10 offset:8192
    ds_read_b128 v[144:147], v10 offset:9216
    ds_read_b128 v[148:151], v10 offset:10240
    ds_read_b128 v[152:155], v10 offset:11264
    s_waitcnt lgkmcnt(4)
    ds_read_b128 v[156:159], v10 offset:12288
    ds_read_b128 v[160:163], v10 offset:13312
    ds_read_b128 v[164:167], v10 offset:14336
    ds_read_b128 v[168:171], v10 offset:15360
    s_waitcnt lgkmcnt(0)
    s_add_u32 s51, s44, 0
    buffer_store_dwordx4 v[108:111], v8, s[4:7], s51 offen offset:0 sc1
    s_add_u32 s51, s44, 0
    buffer_store_dwordx4 v[112:115], v8, s[4:7], s51 offen offset:1024 sc1
    s_add_u32 s51, s44, 0
    buffer_store_dwordx4 v[116:119], v8, s[4:7], s51 offen offset:2048 sc1
    s_add_u32 s51, s44, 0
    buffer_store_dwordx4 v[120:123], v8, s[4:7], s51 offen offset:3072 sc1
    s_add_u32 s51, s44, 2621440
    buffer_store_dwordx4 v[124:127], v8, s[4:7], s51 offen offset:0 sc1
    s_add_u32 s51, s44, 2621440
    buffer_store_dwordx4 v[128:131], v8, s[4:7], s51 offen offset:1024 sc1
    s_add_u32 s51, s44, 2621440
    buffer_store_dwordx4 v[132:135], v8, s[4:7], s51 offen offset:2048 sc1
    s_add_u32 s51, s44, 2621440
    buffer_store_dwordx4 v[136:139], v8, s[4:7], s51 offen offset:3072 sc1
    s_add_u32 s51, s44, 1310720
    buffer_store_dwordx4 v[140:143], v9, s[4:7], s51 offen offset:0 sc1
    s_add_u32 s51, s44, 1310720
    buffer_store_dwordx4 v[144:147], v9, s[4:7], s51 offen offset:1024 sc1
    s_add_u32 s51, s44, 1310720
    buffer_store_dwordx4 v[148:151], v9, s[4:7], s51 offen offset:2048 sc1
    s_add_u32 s51, s44, 1310720
    buffer_store_dwordx4 v[152:155], v9, s[4:7], s51 offen offset:3072 sc1
    s_add_u32 s51, s44, 3932160
    buffer_store_dwordx4 v[156:159], v9, s[4:7], s51 offen offset:0 sc1
    s_add_u32 s51, s44, 3932160
    buffer_store_dwordx4 v[160:163], v9, s[4:7], s51 offen offset:1024 sc1
    s_add_u32 s51, s44, 3932160
    buffer_store_dwordx4 v[164:167], v9, s[4:7], s51 offen offset:2048 sc1
    s_add_u32 s51, s44, 3932160
    buffer_store_dwordx4 v[168:171], v9, s[4:7], s51 offen offset:3072 sc1
Lcs_134:
    s_mov_b32 s75, 0x8c23080
    s_waitcnt vmcnt(0)
    s_barrier
    s_cmp_lg_u32 s42, 0
    s_cbranch_scc1 Lsig_136
    s_mov_b64 exec, 1
    v_mov_b32 v4, 1
    v_mov_b32 v5, 0
    buffer_atomic_add v4, v5, s[4:7], s75 offen
    s_mov_b64 exec, -1
Lsig_136:
    s_add_u32 s85, s85, 32
    s_cmp_lt_u32 s85, 64
    s_cbranch_scc0 La2e_137
    s_branch La2l_133
La2e_137:
Lcs_129:
    s_cmp_eq_u32 s71, 3
    s_cbranch_scc1 Lcg_139
    s_branch Lcs_138
Lcg_139:
    s_mov_b32 s75, 0x8c23080
    s_cmp_lg_u32 s42, 0
    s_cbranch_scc1 Lwtd_141
    v_mov_b32 v5, 0
    s_mov_b32 s74, 0
Lwt_140:
    buffer_load_dword v4, v5, s[4:7], s75 offen sc1
    s_waitcnt vmcnt(0)
    v_cmp_gt_u32 vcc, 0x51, v4
    s_cbranch_vccz Lwtd_141
    s_sleep 8
    s_add_u32 s74, s74, 1
    s_cmp_lt_u32 s74, 4000000
    s_cbranch_scc1 Lwt_140
Lwtd_141:
    s_barrier
    s_and_b32 s40, s72, 1
    s_lshr_b32 s41, s72, 1
    s_mov_b32 s20, s38
    s_and_b32 s21, s39, 0xffff
    s_mov_b32 s22, 0x500000
    s_mov_b32 s23, 0x00020000
    s_and_b32 s44, s42, 1
    s_lshl_b32 s44, s44, 2
    v_or_b32 v6, s44, v3
    v_lshrrev_b32 v7, 1, v2
    v_xor_b32 v7, v7, v6
    v_and_b32 v8, 1, v2
    v_lshl_add_u32 v7, v7, 1, v8
    v_lshlrev_b32 v7, 4, v7
    v_mul_u32_u24 v8, 4096, v3
    v_add_u32 v7, v7, v8
    s_mul_i32 s44, s42, 32768
    s_lshl_b32 s45, s41, 8
    s_add_u32 s44, s44, s45
    v_add_u32 v9, s44, v7
    v_lshrrev_b32 v6, 2, v1
    v_mul_u32_u24 v6, 3840, v6
    v_and_b32 v7, 3, v1
    v_xor_b32 v7, v7, v3
    v_lshl_add_u32 v6, v7, 4, v6
    s_lshl_b32 s44, s40, 2
    s_add_u32 s44, s44, s42
    s_mul_i32 s44, s44, 307200
    v_add_u32 v10, s44, v6
    v_lshrrev_b32 v6, 2, v2
    v_and_b32 v7, 1, v3
    v_lshl_or_b32 v7, v7, 2, v6
    v_lshl_add_u32 v6, v3, 3, v6
    v_lshlrev_b32 v6, 8, v6
    v_and_b32 v8, 3, v2
    v_lshl_add_u32 v6, v8, 3, v6
    v_xor_b32 v8, 0, v7
    v_lshl_add_u32 v12, v8, 5, v6
    v_add_u32 v20, 0x10000, v12
    v_add_u32 v28, 0x20000, v12
    v_xor_b32 v8, 1, v7
    v_lshl_add_u32 v13, v8, 5, v6
    v_add_u32 v21, 0x10000, v13
    v_add_u32 v29, 0x20000, v13
    v_xor_b32 v8, 2, v7
    v_lshl_add_u32 v14, v8, 5, v6
    v_add_u32 v22, 0x10000, v14
    v_add_u32 v30, 0x20000, v14
    v_xor_b32 v8, 3, v7
    v_lshl_add_u32 v15, v8, 5, v6
    v_add_u32 v23, 0x10000, v15
    v_add_u32 v31, 0x20000, v15
    v_xor_b32 v8, 4, v7
    v_lshl_add_u32 v16, v8, 5, v6
    v_add_u32 v24, 0x10000, v16
    v_add_u32 v32, 0x20000, v16
    v_xor_b32 v8, 5, v7
    v_lshl_add_u32 v17, v8, 5, v6
    v_add_u32 v25, 0x10000, v17
    v_add_u32 v33, 0x20000, v17
    v_xor_b32 v8, 6, v7
    v_lshl_add_u32 v18, v8, 5, v6
    v_add_u32 v26, 0x10000, v18
    v_add_u32 v34, 0x20000, v18
    v_xor_b32 v8, 7, v7
    v_lshl_add_u32 v19, v8, 5, v6
    v_add_u32 v27, 0x10000, v19
    v_add_u32 v35, 0x20000, v19
    v_lshrrev_b32 v6, 2, v2
    v_xor_b32 v6, v6, v3
    v_lshlrev_b32 v6, 4, v6
    v_lshl_add_u32 v6, v2, 6, v6
    s_mul_i32 s44, s42, 5120
    s_add_u32 s44, s44, 8192
    v_add_u32 v36, s44, v6
    v_add_u32 v37, 0x10000, v36
    v_add_u32 v38, 0x20000, v36
    s_lshl_b32 s50, s42, 11
    s_mov_b32 s51, s44
    s_mov_b32 s46, 0
    s_mov_b32 s47, 0x9a00000
    s_mov_b32 s53, 0
    s_add_u32 m0, s50, 0
    s_add_u32 s52, s46, 0xa800000
    buffer_load_dwordx4 v9, s[4:7], s52 offen lds
    s_add_u32 m0, s50, 1024
    s_add_u32 s52, s46, 0xa804000
    buffer_load_dwordx4 v9, s[4:7], s52 offen lds
    s_add_u32 m0, s51, 0
    s_add_u32 s52, s47, 0
    buffer_load_dwordx4 v10, s[4:7], s52 offen lds
    s_add_u32 m0, s51, 1024
    s_add_u32 s52, s47, 61440
    buffer_load_dwordx4 v10, s[4:7], s52 offen lds
    s_add_u32 m0, s51, 2048
    s_add_u32 s52, s47, 122880
    buffer_load_dwordx4 v10, s[4:7], s52 offen lds
    s_add_u32 m0, s51, 3072
    s_add_u32 s52, s47, 184320
    buffer_load_dwordx4 v10, s[4:7], s52 offen lds
    s_add_u32 m0, s51, 4096
    s_add_u32 s52, s47, 245760
    buffer_load_dwordx4 v10, s[4:7], s52 offen lds
    s_add_u32 s46, s46, 131072
    s_add_u32 s47, s47, 64
    s_add_u32 s53, s53, 1
    s_cmp_eq_u32 s53, 20
    s_cselect_b32 s46, 0, s46
    s_add_u32 m0, s50, 28672
    s_add_u32 s52, s46, 0xa800000
    buffer_load_dwordx4 v9, s[4:7], s52 offen lds
    s_add_u32 m0, s50, 29696
    s_add_u32 s52, s46, 0xa804000
    buffer_load_dwordx4 v9, s[4:7], s52 offen lds
    s_add_u32 m0, s51, 28672
    s_add_u32 s52, s47, 0
    buffer_load_dwordx4 v10, s[4:7], s52 offen lds
    s_add_u32 m0, s51, 29696
    s_add_u32 s52, s47, 61440
    buffer_load_dwordx4 v10, s[4:7], s52 offen lds
    s_add_u32 m0, s51, 30720
    s_add_u32 s52, s47, 122880
    buffer_load_dwordx4 v10, s[4:7], s52 offen lds
    s_add_u32 m0, s51, 31744
    s_add_u32 s52, s47, 184320
    buffer_load_dwordx4 v10, s[4:7], s52 offen lds
    s_add_u32 m0, s51, 32768
    s_add_u32 s52, s47, 245760
    buffer_load_dwordx4 v10, s[4:7], s52 offen lds
    s_add_u32 s46, s46, 131072
    s_add_u32 s47, s47, 64
    s_add_u32 s53, s53, 1
    s_cmp_eq_u32 s53, 20
    s_cselect_b32 s46, 0, s46
    s_add_u32 m0, s50, 57344
    s_add_u32 s52, s46, 0xa800000
    buffer_load_dwordx4 v9, s[4:7], s52 offen lds
    s_add_u32 m0, s50, 58368
    s_add_u32 s52, s46, 0xa804000
    buffer_load_dwordx4 v9, s[4:7], s52 offen lds
    s_add_u32 m0, s51, 57344
    s_add_u32 s52, s47, 0
    buffer_load_dwordx4 v10, s[4:7], s52 offen lds
    s_add_u32 m0, s51, 58368
    s_add_u32 s52, s47, 61440
    buffer_load_dwordx4 v10, s[4:7], s52 offen lds
    s_add_u32 m0, s51, 59392
    s_add_u32 s52, s47, 122880
    buffer_load_dwordx4 v10, s[4:7], s52 offen lds
    s_add_u32 m0, s51, 60416
    s_add_u32 s52, s47, 184320
    buffer_load_dwordx4 v10, s[4:7], s52 offen lds
    s_add_u32 m0, s51, 61440
    s_add_u32 s52, s47, 245760
    buffer_load_dwordx4 v10, s[4:7], s52 offen lds
    s_add_u32 s46, s46, 131072
    s_add_u32 s47, s47, 64
    s_add_u32 s53, s53, 1
    s_cmp_eq_u32 s53, 20
    s_cselect_b32 s46, 0, s46
    s_add_u32 m0, s50, 86016
    s_add_u32 s52, s46, 0xa800000
    buffer_load_dwordx4 v9, s[4:7], s52 offen lds
    s_add_u32 m0, s50, 87040
    s_add_u32 s52, s46, 0xa804000
    buffer_load_dwordx4 v9, s[4:7], s52 offen lds
    s_add_u32 m0, s51, 86016
    s_add_u32 s52, s47, 0
    buffer_load_dwordx4 v10, s[4:7], s52 offen lds
    s_add_u32 m0, s51, 87040
    s_add_u32 s52, s47, 61440
    buffer_load_dwordx4 v10, s[4:7], s52 offen lds
    s_add_u32 m0, s51, 88064
    s_add_u32 s52, s47, 122880
    buffer_load_dwordx4 v10, s[4:7], s52 offen lds
    s_add_u32 m0, s51, 89088
    s_add_u32 s52, s47, 184320
    buffer_load_dwordx4 v10, s[4:7], s52 offen lds
    s_add_u32 m0, s51, 90112
    s_add_u32 s52, s47, 245760
    buffer_load_dwordx4 v10, s[4:7], s52 offen lds
    s_add_u32 s46, s46, 131072
    s_add_u32 s47, s47, 64
    s_add_u32 s53, s53, 1
    s_cmp_eq_u32 s53, 20
    s_cselect_b32 s46, 0, s46
    v_accvgpr_write_b32 a0, 0
    v_accvgpr_write_b32 a1, 0
    v_accvgpr_write_b32 a2, 0
    v_accvgpr_write_b32 a3, 0
    v_accvgpr_write_b32 a4, 0
    v_accvgpr_write_b32 a5, 0
    v_accvgpr_write_b32 a6, 0
    v_accvgpr_write_b32 a7, 0
    v_accvgpr_write_b32 a8, 0
    v_accvgpr_write_b32 a9, 0
    v_accvgpr_write_b32 a10, 0
    v_accvgpr_write_b32 a11, 0
    v_accvgpr_write_b32 a12, 0
    v_accvgpr_write_b32 a13, 0
    v_accvgpr_write_b32 a14, 0
    v_accvgpr_write_b32 a15, 0
    v_accvgpr_write_b32 a16, 0
    v_accvgpr_write_b32 a17, 0
    v_accvgpr_write_b32 a18, 0
    v_accvgpr_write_b32 a19, 0
    v_accvgpr_write_b32 a20, 0
    v_accvgpr_write_b32 a21, 0
    v_accvgpr_write_b32 a22, 0
    v_accvgpr_write_b32 a23, 0
    v_accvgpr_write_b32 a24, 0
    v_accvgpr_write_b32 a25, 0
    v_accvgpr_write_b32 a26, 0
    v_accvgpr_write_b32 a27, 0
    v_accvgpr_write_b32 a28, 0
    v_accvgpr_write_b32 a29, 0
    v_accvgpr_write_b32 a30, 0
    v_accvgpr_write_b32 a31, 0
    v_accvgpr_write_b32 a32, 0
    v_accvgpr_write_b32 a33, 0
    v_accvgpr_write_b32 a34, 0
    v_accvgpr_write_b32 a35, 0
    v_accvgpr_write_b32 a36, 0
    v_accvgpr_write_b32 a37, 0
    v_accvgpr_write_b32 a38, 0
    v_accvgpr_write_b32 a39, 0
    v_accvgpr_write_b32 a40, 0
    v_accvgpr_write_b32 a41, 0
    v_accvgpr_write_b32 a42, 0
    v_accvgpr_write_b32 a43, 0
    v_accvgpr_write_b32 a44, 0
    v_accvgpr_write_b32 a45, 0
    v_accvgpr_write_b32 a46, 0
    v_accvgpr_write_b32 a47, 0
    v_accvgpr_write_b32 a48, 0
    v_accvgpr_write_b32 a49, 0
    v_accvgpr_write_b32 a50, 0
    v_accvgpr_write_b32 a51, 0
    v_accvgpr_write_b32 a52, 0
    v_accvgpr_write_b32 a53, 0
    v_accvgpr_write_b32 a54, 0
    v_accvgpr_write_b32 a55, 0
    v_accvgpr_write_b32 a56, 0
    v_accvgpr_write_b32 a57, 0
    v_accvgpr_write_b32 a58, 0
    v_accvgpr_write_b32 a59, 0
    v_accvgpr_write_b32 a60, 0
    v_accvgpr_write_b32 a61, 0
    v_accvgpr_write_b32 a62, 0
    v_accvgpr_write_b32 a63, 0
    v_accvgpr_write_b32 a64, 0
    v_accvgpr_write_b32 a65, 0
    v_accvgpr_write_b32 a66, 0
    v_accvgpr_write_b32 a67, 0
    v_accvgpr_write_b32 a68, 0
    v_accvgpr_write_b32 a69, 0
    v_accvgpr_write_b32 a70, 0
    v_accvgpr_write_b32 a71, 0
    v_accvgpr_write_b32 a72, 0
    v_accvgpr_write_b32 a73, 0
    v_accvgpr_write_b32 a74, 0
    v_accvgpr_write_b32 a75, 0
    v_accvgpr_write_b32 a76, 0
    v_accvgpr_write_b32 a77, 0
    v_accvgpr_write_b32 a78, 0
    v_accvgpr_write_b32 a79, 0
    v_accvgpr_write_b32 a80, 0
    v_accvgpr_write_b32 a81, 0
    v_accvgpr_write_b32 a82, 0
    v_accvgpr_write_b32 a83, 0
    v_accvgpr_write_b32 a84, 0
    v_accvgpr_write_b32 a85, 0
    v_accvgpr_write_b32 a86, 0
    v_accvgpr_write_b32 a87, 0
    v_accvgpr_write_b32 a88, 0
    v_accvgpr_write_b32 a89, 0
    v_accvgpr_write_b32 a90, 0
    v_accvgpr_write_b32 a91, 0
    v_accvgpr_write_b32 a92, 0
    v_accvgpr_write_b32 a93, 0
    v_accvgpr_write_b32 a94, 0
    v_accvgpr_write_b32 a95, 0
    v_accvgpr_write_b32 a96, 0
    v_accvgpr_write_b32 a97, 0
    v_accvgpr_write_b32 a98, 0
    v_accvgpr_write_b32 a99, 0
    v_accvgpr_write_b32 a100, 0
    v_accvgpr_write_b32 a101, 0
    v_accvgpr_write_b32 a102, 0
    v_accvgpr_write_b32 a103, 0
    v_accvgpr_write_b32 a104, 0
    v_accvgpr_write_b32 a105, 0
    v_accvgpr_write_b32 a106, 0
    v_accvgpr_write_b32 a107, 0
    v_accvgpr_write_b32 a108, 0
    v_accvgpr_write_b32 a109, 0
    v_accvgpr_write_b32 a110, 0
    v_accvgpr_write_b32 a111, 0
    v_accvgpr_write_b32 a112, 0
    v_accvgpr_write_b32 a113, 0
    v_accvgpr_write_b32 a114, 0
    v_accvgpr_write_b32 a115, 0
    v_accvgpr_write_b32 a116, 0
    v_accvgpr_write_b32 a117, 0
    v_accvgpr_write_b32 a118, 0
    v_accvgpr_write_b32 a119, 0
    v_accvgpr_write_b32 a120, 0
    v_accvgpr_write_b32 a121, 0
    v_accvgpr_write_b32 a122, 0
    v_accvgpr_write_b32 a123, 0
    v_accvgpr_write_b32 a124, 0
    v_accvgpr_write_b32 a125, 0
    v_accvgpr_write_b32 a126, 0
    v_accvgpr_write_b32 a127, 0
    v_accvgpr_write_b32 a128, 0
    v_accvgpr_write_b32 a129, 0
    v_accvgpr_write_b32 a130, 0
    v_accvgpr_write_b32 a131, 0
    v_accvgpr_write_b32 a132, 0
    v_accvgpr_write_b32 a133, 0
    v_accvgpr_write_b32 a134, 0
    v_accvgpr_write_b32 a135, 0
    v_accvgpr_write_b32 a136, 0
    v_accvgpr_write_b32 a137, 0
    v_accvgpr_write_b32 a138, 0
    v_accvgpr_write_b32 a139, 0
    v_accvgpr_write_b32 a140, 0
    v_accvgpr_write_b32 a141, 0
    v_accvgpr_write_b32 a142, 0
    v_accvgpr_write_b32 a143, 0
    v_accvgpr_write_b32 a144, 0
    v_accvgpr_write_b32 a145, 0
    v_accvgpr_write_b32 a146, 0
    v_accvgpr_write_b32 a147, 0
    v_accvgpr_write_b32 a148, 0
    v_accvgpr_write_b32 a149, 0
    v_accvgpr_write_b32 a150, 0
    v_accvgpr_write_b32 a151, 0
    v_accvgpr_write_b32 a152, 0
    v_accvgpr_write_b32 a153, 0
    v_accvgpr_write_b32 a154, 0
    v_accvgpr_write_b32 a155, 0
    v_accvgpr_write_b32 a156, 0
    v_accvgpr_write_b32 a157, 0
    v_accvgpr_write_b32 a158, 0
    v_accvgpr_write_b32 a159, 0
    s_waitcnt vmcnt(21)
    s_barrier
    ds_read_b128 v[40:43], v36 offset:0
    ds_read_b128 v[44:47], v36 offset:1024
    ds_read_b128 v[48:51], v36 offset:2048
    ds_read_b128 v[52:55], v36 offset:3072
    ds_read_b128 v[56:59], v36 offset:4096
    ds_read_b64_tr_b16 v[80:81], v12 offset:0
    ds_read_b64_tr_b16 v[82:83], v12 offset:1024
    ds_read_b64_tr_b16 v[84:85], v13 offset:0
    ds_read_b64_tr_b16 v[86:87], v13 offset:1024
    s_mov_b32 s43, 0
Lpg_142:
    ds_read_b64_tr_b16 v[88:89], v14 offset:0
    ds_read_b64_tr_b16 v[90:91], v14 offset:1024
    s_waitcnt lgkmcnt(6)
    s_waitcnt lgkmcnt(4)
    v_mfma_f32_16x16x32_bf16 a[0:3], v[40:43], v[80:83], a[0:3]
    v_mfma_f32_16x16x32_bf16 a[4:7], v[44:47], v[80:83], a[4:7]
    v_mfma_f32_16x16x32_bf16 a[8:11], v[48:51], v[80:83], a[8:11]
    v_mfma_f32_16x16x32_bf16 a[12:15], v[52:55], v[80:83], a[12:15]
    v_mfma_f32_16x16x32_bf16 a[16:19], v[56:59], v[80:83], a[16:19]
    ds_read_b64_tr_b16 v[92:93], v15 offset:0
    ds_read_b64_tr_b16 v[94:95], v15 offset:1024
    s_waitcnt lgkmcnt(4)
    v_mfma_f32_16x16x32_bf16 a[20:23], v[40:43], v[84:87], a[20:23]
    v_mfma_f32_16x16x32_bf16 a[24:27], v[44:47], v[84:87], a[24:27]
    v_mfma_f32_16x16x32_bf16 a[28:31], v[48:51], v[84:87], a[28:31]
    v_mfma_f32_16x16x32_bf16 a[32:35], v[52:55], v[84:87], a[32:35]
    v_mfma_f32_16x16x32_bf16 a[36:39], v[56:59], v[84:87], a[36:39]
    ds_read_b64_tr_b16 v[80:81], v16 offset:0
    ds_read_b64_tr_b16 v[82:83], v16 offset:1024
    s_waitcnt lgkmcnt(4)
    v_mfma_f32_16x16x32_bf16 a[40:43], v[40:43], v[88:91], a[40:43]
    v_mfma_f32_16x16x32_bf16 a[44:47], v[44:47], v[88:91], a[44:47]
    v_mfma_f32_16x16x32_bf16 a[48:51], v[48:51], v[88:91], a[48:51]
    v_mfma_f32_16x16x32_bf16 a[52:55], v[52:55], v[88:91], a[52:55]
    v_mfma_f32_16x16x32_bf16 a[56:59], v[56:59], v[88:91], a[56:59]
    ds_read_b64_tr_b16 v[84:85], v17 offset:0
    ds_read_b64_tr_b16 v[86:87], v17 offset:1024
    s_waitcnt lgkmcnt(4)
    v_mfma_f32_16x16x32_bf16 a[60:63], v[40:43], v[92:95], a[60:63]
    v_mfma_f32_16x16x32_bf16 a[64:67], v[44:47], v[92:95], a[64:67]
    v_mfma_f32_16x16x32_bf16 a[68:71], v[48:51], v[92:95], a[68:71]
    v_mfma_f32_16x16x32_bf16 a[72:75], v[52:55], v[92:95], a[72:75]
    v_mfma_f32_16x16x32_bf16 a[76:79], v[56:59], v[92:95], a[76:79]
    s_waitcnt vmcnt(14)
    s_barrier
    ds_read_b64_tr_b16 v[88:89], v18 offset:0
    ds_read_b64_tr_b16 v[90:91], v18 offset:1024
    s_waitcnt lgkmcnt(4)
    v_mfma_f32_16x16x32_bf16 a[80:83], v[40:43], v[80:83], a[80:83]
    v_mfma_f32_16x16x32_bf16 a[84:87], v[44:47], v[80:83], a[84:87]
    s_add_u32 m0, s50, 114688
    s_add_u32 s52, s46, 0xa800000
    buffer_load_dwordx4 v9, s[4:7], s52 offen lds
    v_mfma_f32_16x16x32_bf16 a[88:91], v[48:51], v[80:83], a[88:91]
    v_mfma_f32_16x16x32_bf16 a[92:95], v[52:55], v[80:83], a[92:95]
    s_add_u32 m0, s50, 115712
    s_add_u32 s52, s46, 0xa804000
    buffer_load_dwordx4 v9, s[4:7], s52 offen lds
    v_mfma_f32_16x16x32_bf16 a[96:99], v[56:59], v[80:83], a[96:99]
    ds_read_b64_tr_b16 v[92:93], v19 offset:0
    ds_read_b64_tr_b16 v[94:95], v19 offset:1024
    s_waitcnt lgkmcnt(4)
    v_mfma_f32_16x16x32_bf16 a[100:103], v[40:43], v[84:87], a[100:103]
    v_mfma_f32_16x16x32_bf16 a[104:107], v[44:47], v[84:87], a[104:107]
    s_add_u32 m0, s51, 114688
    s_add_u32 s52, s47, 0
    buffer_load_dwordx4 v10, s[4:7], s52 offen lds
    v_mfma_f32_16x16x32_bf16 a[108:111], v[48:51], v[84:87], a[108:111]
    v_mfma_f32_16x16x32_bf16 a[112:115], v[52:55], v[84:87], a[112:115]
    s_add_u32 m0, s51, 115712
    s_add_u32 s52, s47, 61440
    buffer_load_dwordx4 v10, s[4:7], s52 offen lds
    v_mfma_f32_16x16x32_bf16 a[116:119], v[56:59], v[84:87], a[116:119]
    ds_read_b128 v[60:63], v36 offset:28672
    ds_read_b128 v[64:67], v36 offset:29696
    ds_read_b128 v[68:71], v36 offset:30720
    ds_read_b128 v[72:75], v36 offset:31744
    ds_read_b128 v[76:79], v36 offset:32768
    ds_read_b64_tr_b16 v[80:81], v12 offset:28672
    ds_read_b64_tr_b16 v[82:83], v12 offset:29696
    s_waitcnt lgkmcnt(9)
    v_mfma_f32_16x16x32_bf16 a[120:123], v[40:43], v[88:91], a[120:123]
    v_mfma_f32_16x16x32_bf16 a[124:127], v[44:47], v[88:91], a[124:127]
    s_add_u32 m0, s51, 116736
    s_add_u32 s52, s47, 122880
    buffer_load_dwordx4 v10, s[4:7], s52 offen lds
    v_mfma_f32_16x16x32_bf16 a[128:131], v[48:51], v[88:91], a[128:131]
    v_mfma_f32_16x16x32_bf16 a[132:135], v[52:55], v[88:91], a[132:135]
    s_add_u32 m0, s51, 117760
    s_add_u32 s52, s47, 184320
    buffer_load_dwordx4 v10, s[4:7], s52 offen lds
    v_mfma_f32_16x16x32_bf16 a[136:139], v[56:59], v[88:91], a[136:139]
    ds_read_b64_tr_b16 v[84:85], v13 offset:28672
    ds_read_b64_tr_b16 v[86:87], v13 offset:29696
    s_waitcnt lgkmcnt(9)
    v_mfma_f32_16x16x32_bf16 a[140:143], v[40:43], v[92:95], a[140:143]
    v_mfma_f32_16x16x32_bf16 a[144:147], v[44:47], v[92:95], a[144:147]
    s_add_u32 m0, s51, 118784
    s_add_u32 s52, s47, 245760
    buffer_load_dwordx4 v10, s[4:7], s52 offen lds
    v_mfma_f32_16x16x32_bf16 a[148:151], v[48:51], v[92:95], a[148:151]
    v_mfma_f32_16x16x32_bf16 a[152:155], v[52:55], v[92:95], a[152:155]
    s_add_u32 s46, s46, 131072
    s_add_u32 s47, s47, 64
    s_add_u32 s53, s53, 1
    s_cmp_eq_u32 s53, 20
    s_cselect_b32 s46, 0, s46
    v_mfma_f32_16x16x32_bf16 a[156:159], v[56:59], v[92:95], a[156:159]
    ds_read_b64_tr_b16 v[88:89], v14 offset:28672
    ds_read_b64_tr_b16 v[90:91], v14 offset:29696
    s_waitcnt lgkmcnt(6)
    s_waitcnt lgkmcnt(4)
    v_mfma_f32_16x16x32_bf16 a[0:3], v[60:63], v[80:83], a[0:3]
    v_mfma_f32_16x16x32_bf16 a[4:7], v[64:67], v[80:83], a[4:7]
    v_mfma_f32_16x16x32_bf16 a[8:11], v[68:71], v[80:83], a[8:11]
    v_mfma_f32_16x16x32_bf16 a[12:15], v[72:75], v[80:83], a[12:15]
    v_mfma_f32_16x16x32_bf16 a[16:19], v[76:79], v[80:83], a[16:19]
    ds_read_b64_tr_b16 v[92:93], v15 offset:28672
    ds_read_b64_tr_b16 v[94:95], v15 offset:29696
    s_waitcnt lgkmcnt(4)
    v_mfma_f32_16x16x32_bf16 a[20:23], v[60:63], v[84:87], a[20:23]
    v_mfma_f32_16x16x32_bf16 a[24:27], v[64:67], v[84:87], a[24:27]
    v_mfma_f32_16x16x32_bf16 a[28:31], v[68:71], v[84:87], a[28:31]
    v_mfma_f32_16x16x32_bf16 a[32:35], v[72:75], v[84:87], a[32:35]
    v_mfma_f32_16x16x32_bf16 a[36:39], v[76:79], v[84:87], a[36:39]
    ds_read_b64_tr_b16 v[80:81], v16 offset:28672
    ds_read_b64_tr_b16 v[82:83], v16 offset:29696
    s_waitcnt lgkmcnt(4)
    v_mfma_f32_16x16x32_bf16 a[40:43], v[60:63], v[88:91], a[40:43]
    v_mfma_f32_16x16x32_bf16 a[44:47], v[64:67], v[88:91], a[44:47]
    v_mfma_f32_16x16x32_bf16 a[48:51], v[68:71], v[88:91], a[48:51]
    v_mfma_f32_16x16x32_bf16 a[52:55], v[72:75], v[88:91], a[52:55]
    v_mfma_f32_16x16x32_bf16 a[56:59], v[76:79], v[88:91], a[56:59]
    ds_read_b64_tr_b16 v[84:85], v17 offset:28672
    ds_read_b64_tr_b16 v[86:87], v17 offset:29696
    s_waitcnt lgkmcnt(4)
    v_mfma_f32_16x16x32_bf16 a[60:63], v[60:63], v[92:95], a[60:63]
    v_mfma_f32_16x16x32_bf16 a[64:67], v[64:67], v[92:95], a[64:67]
    v_mfma_f32_16x16x32_bf16 a[68:71], v[68:71], v[92:95], a[68:71]
    v_mfma_f32_16x16x32_bf16 a[72:75], v[72:75], v[92:95], a[72:75]
    v_mfma_f32_16x16x32_bf16 a[76:79], v[76:79], v[92:95], a[76:79]
    s_waitcnt vmcnt(14)
    s_barrier
    ds_read_b64_tr_b16 v[88:89], v18 offset:28672
    ds_read_b64_tr_b16 v[90:91], v18 offset:29696
    s_waitcnt lgkmcnt(4)
    v_mfma_f32_16x16x32_bf16 a[80:83], v[60:63], v[80:83], a[80:83]
    v_mfma_f32_16x16x32_bf16 a[84:87], v[64:67], v[80:83], a[84:87]
    s_add_u32 m0, s50, 0
    s_add_u32 s52, s46, 0xa800000
    buffer_load_dwordx4 v9, s[4:7], s52 offen lds
    v_mfma_f32_16x16x32_bf16 a[88:91], v[68:71], v[80:83], a[88:91]
    v_mfma_f32_16x16x32_bf16 a[92:95], v[72:75], v[80:83], a[92:95]
    s_add_u32 m0, s50, 1024
    s_add_u32 s52, s46, 0xa804000
    buffer_load_dwordx4 v9, s[4:7], s52 offen lds
    v_mfma_f32_16x16x32_bf16 a[96:99], v[76:79], v[80:83], a[96:99]
    ds_read_b64_tr_b16 v[92:93], v19 offset:28672
    ds_read_b64_tr_b16 v[94:95], v19 offset:29696
    s_waitcnt lgkmcnt(4)
    v_mfma_f32_16x16x32_bf16 a[100:103], v[60:63], v[84:87], a[100:103]
    v_mfma_f32_16x16x32_bf16 a[104:107], v[64:67], v[84:87], a[104:107]
    s_add_u32 m0, s51, 0
    s_add_u32 s52, s47, 0
    buffer_load_dwordx4 v10, s[4:7], s52 offen lds
    v_mfma_f32_16x16x32_bf16 a[108:111], v[68:71], v[84:87], a[108:111]
    v_mfma_f32_16x16x32_bf16 a[112:115], v[72:75], v[84:87], a[112:115]
    s_add_u32 m0, s51, 1024
    s_add_u32 s52, s47, 61440
    buffer_load_dwordx4 v10, s[4:7], s52 offen lds
    v_mfma_f32_16x16x32_bf16 a[116:119], v[76:79], v[84:87], a[116:119]
    ds_read_b128 v[40:43], v36 offset:57344
    ds_read_b128 v[44:47], v36 offset:58368
    ds_read_b128 v[48:51], v36 offset:59392
    ds_read_b128 v[52:55], v36 offset:60416
    ds_read_b128 v[56:59], v36 offset:61440
    ds_read_b64_tr_b16 v[80:81], v12 offset:57344
    ds_read_b64_tr_b16 v[82:83], v12 offset:58368
    s_waitcnt lgkmcnt(9)
    v_mfma_f32_16x16x32_bf16 a[120:123], v[60:63], v[88:91], a[120:123]
    v_mfma_f32_16x16x32_bf16 a[124:127], v[64:67], v[88:91], a[124:127]
    s_add_u32 m0, s51, 2048
    s_add_u32 s52, s47, 122880
    buffer_load_dwordx4 v10, s[4:7], s52 offen lds
    v_mfma_f32_16x16x32_bf16 a[128:131], v[68:71], v[88:91], a[128:131]
    v_mfma_f32_16x16x32_bf16 a[132:135], v[72:75], v[88:91], a[132:135]
    s_add_u32 m0, s51, 3072
    s_add_u32 s52, s47, 184320
    buffer_load_dwordx4 v10, s[4:7], s52 offen lds
    v_mfma_f32_16x16x32_bf16 a[136:139], v[76:79], v[88:91], a[136:139]
    ds_read_b64_tr_b16 v[84:85], v13 offset:57344
    ds_read_b64_tr_b16 v[86:87], v13 offset:58368
    s_waitcnt lgkmcnt(9)
    v_mfma_f32_16x16x32_bf16 a[140:143], v[60:63], v[92:95], a[140:143]
    v_mfma_f32_16x16x32_bf16 a[144:147], v[64:67], v[92:95], a[144:147]
    s_add_u32 m0, s51, 4096
    s_add_u32 s52, s47, 245760
    buffer_load_dwordx4 v10, s[4:7], s52 offen lds
    v_mfma_f32_16x16x32_bf16 a[148:151], v[68:71], v[92:95], a[148:151]
    v_mfma_f32_16x16x32_bf16 a[152:155], v[72:75], v[92:95], a[152:155]
    s_add_u32 s46, s46, 131072
    s_add_u32 s47, s47, 64
    s_add_u32 s53, s53, 1
    s_cmp_eq_u32 s53, 20
    s_cselect_b32 s46, 0, s46
    v_mfma_f32_16x16x32_bf16 a[156:159], v[76:79], v[92:95], a[156:159]
    ds_read_b64_tr_b16 v[88:89], v14 offset:57344
    ds_read_b64_tr_b16 v[90:91], v14 offset:58368
    s_waitcnt lgkmcnt(6)
    s_waitcnt lgkmcnt(4)
    v_mfma_f32_16x16x32_bf16 a[0:3], v[40:43], v[80:83], a[0:3]
    v_mfma_f32_16x16x32_bf16 a[4:7], v[44:47], v[80:83], a[4:7]
    v_mfma_f32_16x16x32_bf16 a[8:11], v[48:51], v[80:83], a[8:11]
    v_mfma_f32_16x16x32_bf16 a[12:15], v[52:55], v[80:83], a[12:15]
    v_mfma_f32_16x16x32_bf16 a[16:19], v[56:59], v[80:83], a[16:19]
    ds_read_b64_tr_b16 v[92:93], v15 offset:57344
    ds_read_b64_tr_b16 v[94:95], v15 offset:58368
    s_waitcnt lgkmcnt(4)
    v_mfma_f32_16x16x32_bf16 a[20:23], v[40:43], v[84:87], a[20:23]
    v_mfma_f32_16x16x32_bf16 a[24:27], v[44:47], v[84:87], a[24:27]
    v_mfma_f32_16x16x32_bf16 a[28:31], v[48:51], v[84:87], a[28:31]
    v_mfma_f32_16x16x32_bf16 a[32:35], v[52:55], v[84:87], a[32:35]
    v_mfma_f32_16x16x32_bf16 a[36:39], v[56:59], v[84:87], a[36:39]
    ds_read_b64_tr_b16 v[80:81], v16 offset:57344
    ds_read_b64_tr_b16 v[82:83], v16 offset:58368
    s_waitcnt lgkmcnt(4)
    v_mfma_f32_16x16x32_bf16 a[40:43], v[40:43], v[88:91], a[40:43]
    v_mfma_f32_16x16x32_bf16 a[44:47], v[44:47], v[88:91], a[44:47]
    v_mfma_f32_16x16x32_bf16 a[48:51], v[48:51], v[88:91], a[48:51]
    v_mfma_f32_16x16x32_bf16 a[52:55], v[52:55], v[88:91], a[52:55]
    v_mfma_f32_16x16x32_bf16 a[56:59], v[56:59], v[88:91], a[56:59]
    ds_read_b64_tr_b16 v[84:85], v17 offset:57344
    ds_read_b64_tr_b16 v[86:87], v17 offset:58368
    s_waitcnt lgkmcnt(4)
    v_mfma_f32_16x16x32_bf16 a[60:63], v[40:43], v[92:95], a[60:63]
    v_mfma_f32_16x16x32_bf16 a[64:67], v[44:47], v[92:95], a[64:67]
    v_mfma_f32_16x16x32_bf16 a[68:71], v[48:51], v[92:95], a[68:71]
    v_mfma_f32_16x16x32_bf16 a[72:75], v[52:55], v[92:95], a[72:75]
    v_mfma_f32_16x16x32_bf16 a[76:79], v[56:59], v[92:95], a[76:79]
    s_waitcnt vmcnt(14)
    s_barrier
    ds_read_b64_tr_b16 v[88:89], v18 offset:57344
    ds_read_b64_tr_b16 v[90:91], v18 offset:58368
    s_waitcnt lgkmcnt(4)
    v_mfma_f32_16x16x32_bf16 a[80:83], v[40:43], v[80:83], a[80:83]
    v_mfma_f32_16x16x32_bf16 a[84:87], v[44:47], v[80:83], a[84:87]
    s_add_u32 m0, s50, 28672
    s_add_u32 s52, s46, 0xa800000
    buffer_load_dwordx4 v9, s[4:7], s52 offen lds
    v_mfma_f32_16x16x32_bf16 a[88:91], v[48:51], v[80:83], a[88:91]
    v_mfma_f32_16x16x32_bf16 a[92:95], v[52:55], v[80:83], a[92:95]
    s_add_u32 m0, s50, 29696
    s_add_u32 s52, s46, 0xa804000
    buffer_load_dwordx4 v9, s[4:7], s52 offen lds
    v_mfma_f32_16x16x32_bf16 a[96:99], v[56:59], v[80:83], a[96:99]
    ds_read_b64_tr_b16 v[92:93], v19 offset:57344
    ds_read_b64_tr_b16 v[94:95], v19 offset:58368
    s_waitcnt lgkmcnt(4)
    v_mfma_f32_16x16x32_bf16 a[100:103], v[40:43], v[84:87], a[100:103]
    v_mfma_f32_16x16x32_bf16 a[104:107], v[44:47], v[84:87], a[104:107]
    s_add_u32 m0, s51, 28672
    s_add_u32 s52, s47, 0
    buffer_load_dwordx4 v10, s[4:7], s52 offen lds
    v_mfma_f32_16x16x32_bf16 a[108:111], v[48:51], v[84:87], a[108:111]
    v_mfma_f32_16x16x32_bf16 a[112:115], v[52:55], v[84:87], a[112:115]
    s_add_u32 m0, s51, 29696
    s_add_u32 s52, s47, 61440
    buffer_load_dwordx4 v10, s[4:7], s52 offen lds
    v_mfma_f32_16x16x32_bf16 a[116:119], v[56:59], v[84:87], a[116:119]
    ds_read_b128 v[60:63], v37 offset:20480
    ds_read_b128 v[64:67], v37 offset:21504
    ds_read_b128 v[68:71], v37 offset:22528
    ds_read_b128 v[72:75], v37 offset:23552
    ds_read_b128 v[76:79], v37 offset:24576
    ds_read_b64_tr_b16 v[80:81], v20 offset:20480
    ds_read_b64_tr_b16 v[82:83], v20 offset:21504
    s_waitcnt lgkmcnt(9)
    v_mfma_f32_16x16x32_bf16 a[120:123], v[40:43], v[88:91], a[120:123]
    v_mfma_f32_16x16x32_bf16 a[124:127], v[44:47], v[88:91], a[124:127]
    s_add_u32 m0, s51, 30720
    s_add_u32 s52, s47, 122880
    buffer_load_dwordx4 v10, s[4:7], s52 offen lds
    v_mfma_f32_16x16x32_bf16 a[128:131], v[48:51], v[88:91], a[128:131]
    v_mfma_f32_16x16x32_bf16 a[132:135], v[52:55], v[88:91], a[132:135]
    s_add_u32 m0, s51, 31744
    s_add_u32 s52, s47, 184320
    buffer_load_dwordx4 v10, s[4:7], s52 offen lds
    v_mfma_f32_16x16x32_bf16 a[136:139], v[56:59], v[88:91], a[136:139]
    ds_read_b64_tr_b16 v[84:85], v21 offset:20480
    ds_read_b64_tr_b16 v[86:87], v21 offset:21504
    s_waitcnt lgkmcnt(9)
    v_mfma_f32_16x16x32_bf16 a[140:143], v[40:43], v[92:95], a[140:143]
    v_mfma_f32_16x16x32_bf16 a[144:147], v[44:47], v[92:95], a[144:147]
    s_add_u32 m0, s51, 32768
    s_add_u32 s52, s47, 245760
    buffer_load_dwordx4 v10, s[4:7], s52 offen lds
    v_mfma_f32_16x16x32_bf16 a[148:151], v[48:51], v[92:95], a[148:151]
    v_mfma_f32_16x16x32_bf16 a[152:155], v[52:55], v[92:95], a[152:155]
    s_add_u32 s46, s46, 131072
    s_add_u32 s47, s47, 64
    s_add_u32 s53, s53, 1
    s_cmp_eq_u32 s53, 20
    s_cselect_b32 s46, 0, s46
    v_mfma_f32_16x16x32_bf16 a[156:159], v[56:59], v[92:95], a[156:159]
    ds_read_b64_tr_b16 v[88:89], v22 offset:20480
    ds_read_b64_tr_b16 v[90:91], v22 offset:21504
    s_waitcnt lgkmcnt(6)
    s_waitcnt lgkmcnt(4)
    v_mfma_f32_16x16x32_bf16 a[0:3], v[60:63], v[80:83], a[0:3]
    v_mfma_f32_16x16x32_bf16 a[4:7], v[64:67], v[80:83], a[4:7]
    v_mfma_f32_16x16x32_bf16 a[8:11], v[68:71], v[80:83], a[8:11]
    v_mfma_f32_16x16x32_bf16 a[12:15], v[72:75], v[80:83], a[12:15]
    v_mfma_f32_16x16x32_bf16 a[16:19], v[76:79], v[80:83], a[16:19]
    ds_read_b64_tr_b16 v[92:93], v23 offset:20480
    ds_read_b64_tr_b16 v[94:95], v23 offset:21504
    s_waitcnt lgkmcnt(4)
    v_mfma_f32_16x16x32_bf16 a[20:23], v[60:63], v[84:87], a[20:23]
    v_mfma_f32_16x16x32_bf16 a[24:27], v[64:67], v[84:87], a[24:27]
    v_mfma_f32_16x16x32_bf16 a[28:31], v[68:71], v[84:87], a[28:31]
    v_mfma_f32_16x16x32_bf16 a[32:35], v[72:75], v[84:87], a[32:35]
    v_mfma_f32_16x16x32_bf16 a[36:39], v[76:79], v[84:87], a[36:39]
    ds_read_b64_tr_b16 v[80:81], v24 offset:20480
    ds_read_b64_tr_b16 v[82:83], v24 offset:21504
    s_waitcnt lgkmcnt(4)
    v_mfma_f32_16x16x32_bf16 a[40:43], v[60:63], v[88:91], a[40:43]
    v_mfma_f32_16x16x32_bf16 a[44:47], v[64:67], v[88:91], a[44:47]
    v_mfma_f32_16x16x32_bf16 a[48:51], v[68:71], v[88:91], a[48:51]
    v_mfma_f32_16x16x32_bf16 a[52:55], v[72:75], v[88:91], a[52:55]
    v_mfma_f32_16x16x32_bf16 a[56:59], v[76:79], v[88:91], a[56:59]
    ds_read_b64_tr_b16 v[84:85], v25 offset:20480
    ds_read_b64_tr_b16 v[86:87], v25 offset:21504
    s_waitcnt lgkmcnt(4)
    v_mfma_f32_16x16x32_bf16 a[60:63], v[60:63], v[92:95], a[60:63]
    v_mfma_f32_16x16x32_bf16 a[64:67], v[64:67], v[92:95], a[64:67]
    v_mfma_f32_16x16x32_bf16 a[68:71], v[68:71], v[92:95], a[68:71]
    v_mfma_f32_16x16x32_bf16 a[72:75], v[72:75], v[92:95], a[72:75]
    v_mfma_f32_16x16x32_bf16 a[76:79], v[76:79], v[92:95], a[76:79]
    s_waitcnt vmcnt(14)
    s_barrier
    ds_read_b64_tr_b16 v[88:89], v26 offset:20480
    ds_read_b64_tr_b16 v[90:91], v26 offset:21504
    s_waitcnt lgkmcnt(4)
    v_mfma_f32_16x16x32_bf16 a[80:83], v[60:63], v[80:83], a[80:83]
    v_mfma_f32_16x16x32_bf16 a[84:87], v[64:67], v[80:83], a[84:87]
    s_add_u32 m0, s50, 57344
    s_add_u32 s52, s46, 0xa800000
    buffer_load_dwordx4 v9, s[4:7], s52 offen lds
    v_mfma_f32_16x16x32_bf16 a[88:91], v[68:71], v[80:83], a[88:91]
    v_mfma_f32_16x16x32_bf16 a[92:95], v[72:75], v[80:83], a[92:95]
    s_add_u32 m0, s50, 58368
    s_add_u32 s52, s46, 0xa804000
    buffer_load_dwordx4 v9, s[4:7], s52 offen lds
    v_mfma_f32_16x16x32_bf16 a[96:99], v[76:79], v[80:83], a[96:99]
    ds_read_b64_tr_b16 v[92:93], v27 offset:20480
    ds_read_b64_tr_b16 v[94:95], v27 offset:21504
    s_waitcnt lgkmcnt(4)
    v_mfma_f32_16x16x32_bf16 a[100:103], v[60:63], v[84:87], a[100:103]
    v_mfma_f32_16x16x32_bf16 a[104:107], v[64:67], v[84:87], a[104:107]
    s_add_u32 m0, s51, 57344
    s_add_u32 s52, s47, 0
    buffer_load_dwordx4 v10, s[4:7], s52 offen lds
    v_mfma_f32_16x16x32_bf16 a[108:111], v[68:71], v[84:87], a[108:111]
    v_mfma_f32_16x16x32_bf16 a[112:115], v[72:75], v[84:87], a[112:115]
    s_add_u32 m0, s51, 58368
    s_add_u32 s52, s47, 61440
    buffer_load_dwordx4 v10, s[4:7], s52 offen lds
    v_mfma_f32_16x16x32_bf16 a[116:119], v[76:79], v[84:87], a[116:119]
    ds_read_b128 v[40:43], v37 offset:49152
    ds_read_b128 v[44:47], v37 offset:50176
    ds_read_b128 v[48:51], v37 offset:51200
    ds_read_b128 v[52:55], v37 offset:52224
    ds_read_b128 v[56:59], v37 offset:53248
    ds_read_b64_tr_b16 v[80:81], v20 offset:49152
    ds_read_b64_tr_b16 v[82:83], v20 offset:50176
    s_waitcnt lgkmcnt(9)
    v_mfma_f32_16x16x32_bf16 a[120:123], v[60:63], v[88:91], a[120:123]
    v_mfma_f32_16x16x32_bf16 a[124:127], v[64:67], v[88:91], a[124:127]
    s_add_u32 m0, s51, 59392
    s_add_u32 s52, s47, 122880
    buffer_load_dwordx4 v10, s[4:7], s52 offen lds
    v_mfma_f32_16x16x32_bf16 a[128:131], v[68:71], v[88:91], a[128:131]
    v_mfma_f32_16x16x32_bf16 a[132:135], v[72:75], v[88:91], a[132:135]
    s_add_u32 m0, s51, 60416
    s_add_u32 s52, s47, 184320
    buffer_load_dwordx4 v10, s[4:7], s52 offen lds
    v_mfma_f32_16x16x32_bf16 a[136:139], v[76:79], v[88:91], a[136:139]
    ds_read_b64_tr_b16 v[84:85], v21 offset:49152
    ds_read_b64_tr_b16 v[86:87], v21 offset:50176
    s_waitcnt lgkmcnt(9)
    v_mfma_f32_16x16x32_bf16 a[140:143], v[60:63], v[92:95], a[140:143]
    v_mfma_f32_16x16x32_bf16 a[144:147], v[64:67], v[92:95], a[144:147]
    s_add_u32 m0, s51, 61440
    s_add_u32 s52, s47, 245760
    buffer_load_dwordx4 v10, s[4:7], s52 offen lds
    v_mfma_f32_16x16x32_bf16 a[148:151], v[68:71], v[92:95], a[148:151]
    v_mfma_f32_16x16x32_bf16 a[152:155], v[72:75], v[92:95], a[152:155]
    s_add_u32 s46, s46, 131072
    s_add_u32 s47, s47, 64
    s_add_u32 s53, s53, 1
    s_cmp_eq_u32 s53, 20
    s_cselect_b32 s46, 0, s46
    v_mfma_f32_16x16x32_bf16 a[156:159], v[76:79], v[92:95], a[156:159]
    ds_read_b64_tr_b16 v[88:89], v22 offset:49152
    ds_read_b64_tr_b16 v[90:91], v22 offset:50176
    s_waitcnt lgkmcnt(6)
    s_waitcnt lgkmcnt(4)
    v_mfma_f32_16x16x32_bf16 a[0:3], v[40:43], v[80:83], a[0:3]
    v_mfma_f32_16x16x32_bf16 a[4:7], v[44:47], v[80:83], a[4:7]
    v_mfma_f32_16x16x32_bf16 a[8:11], v[48:51], v[80:83], a[8:11]
    v_mfma_f32_16x16x32_bf16 a[12:15], v[52:55], v[80:83], a[12:15]
    v_mfma_f32_16x16x32_bf16 a[16:19], v[56:59], v[80:83], a[16:19]
    ds_read_b64_tr_b16 v[92:93], v23 offset:49152
    ds_read_b64_tr_b16 v[94:95], v23 offset:50176
    s_waitcnt lgkmcnt(4)
    v_mfma_f32_16x16x32_bf16 a[20:23], v[40:43], v[84:87], a[20:23]
    v_mfma_f32_16x16x32_bf16 a[24:27], v[44:47], v[84:87], a[24:27]
    v_mfma_f32_16x16x32_bf16 a[28:31], v[48:51], v[84:87], a[28:31]
    v_mfma_f32_16x16x32_bf16 a[32:35], v[52:55], v[84:87], a[32:35]
    v_mfma_f32_16x16x32_bf16 a[36:39], v[56:59], v[84:87], a[36:39]
    ds_read_b64_tr_b16 v[80:81], v24 offset:49152
    ds_read_b64_tr_b16 v[82:83], v24 offset:50176
    s_waitcnt lgkmcnt(4)
    v_mfma_f32_16x16x32_bf16 a[40:43], v[40:43], v[88:91], a[40:43]
    v_mfma_f32_16x16x32_bf16 a[44:47], v[44:47], v[88:91], a[44:47]
    v_mfma_f32_16x16x32_bf16 a[48:51], v[48:51], v[88:91], a[48:51]
    v_mfma_f32_16x16x32_bf16 a[52:55], v[52:55], v[88:91], a[52:55]
    v_mfma_f32_16x16x32_bf16 a[56:59], v[56:59], v[88:91], a[56:59]
    ds_read_b64_tr_b16 v[84:85], v25 offset:49152
    ds_read_b64_tr_b16 v[86:87], v25 offset:50176
    s_waitcnt lgkmcnt(4)
    v_mfma_f32_16x16x32_bf16 a[60:63], v[40:43], v[92:95], a[60:63]
    v_mfma_f32_16x16x32_bf16 a[64:67], v[44:47], v[92:95], a[64:67]
    v_mfma_f32_16x16x32_bf16 a[68:71], v[48:51], v[92:95], a[68:71]
    v_mfma_f32_16x16x32_bf16 a[72:75], v[52:55], v[92:95], a[72:75]
    v_mfma_f32_16x16x32_bf16 a[76:79], v[56:59], v[92:95], a[76:79]
    s_waitcnt vmcnt(14)
    s_barrier
    ds_read_b64_tr_b16 v[88:89], v26 offset:49152
    ds_read_b64_tr_b16 v[90:91], v26 offset:50176
    s_waitcnt lgkmcnt(4)
    v_mfma_f32_16x16x32_bf16 a[80:83], v[40:43], v[80:83], a[80:83]
    v_mfma_f32_16x16x32_bf16 a[84:87], v[44:47], v[80:83], a[84:87]
    s_add_u32 m0, s50, 86016
    s_add_u32 s52, s46, 0xa800000
    buffer_load_dwordx4 v9, s[4:7], s52 offen lds
    v_mfma_f32_16x16x32_bf16 a[88:91], v[48:51], v[80:83], a[88:91]
    v_mfma_f32_16x16x32_bf16 a[92:95], v[52:55], v[80:83], a[92:95]
    s_add_u32 m0, s50, 87040
    s_add_u32 s52, s46, 0xa804000
    buffer_load_dwordx4 v9, s[4:7], s52 offen lds
    v_mfma_f32_16x16x32_bf16 a[96:99], v[56:59], v[80:83], a[96:99]
    ds_read_b64_tr_b16 v[92:93], v27 offset:49152
    ds_read_b64_tr_b16 v[94:95], v27 offset:50176
    s_waitcnt lgkmcnt(4)
    v_mfma_f32_16x16x32_bf16 a[100:103], v[40:43], v[84:87], a[100:103]
    v_mfma_f32_16x16x32_bf16 a[104:107], v[44:47], v[84:87], a[104:107]
    s_add_u32 m0, s51, 86016
    s_add_u32 s52, s47, 0
    buffer_load_dwordx4 v10, s[4:7], s52 offen lds
    v_mfma_f32_16x16x32_bf16 a[108:111], v[48:51], v[84:87], a[108:111]
    v_mfma_f32_16x16x32_bf16 a[112:115], v[52:55], v[84:87], a[112:115]
    s_add_u32 m0, s51, 87040
    s_add_u32 s52, s47, 61440
    buffer_load_dwordx4 v10, s[4:7], s52 offen lds
    v_mfma_f32_16x16x32_bf16 a[116:119], v[56:59], v[84:87], a[116:119]
    ds_read_b128 v[60:63], v36 offset:0
    ds_read_b128 v[64:67], v36 offset:1024
    ds_read_b128 v[68:71], v36 offset:2048
    ds_read_b128 v[72:75], v36 offset:3072
    ds_read_b128 v[76:79], v36 offset:4096
    ds_read_b64_tr_b16 v[80:81], v12 offset:0
    ds_read_b64_tr_b16 v[82:83], v12 offset:1024
    s_waitcnt lgkmcnt(9)
    v_mfma_f32_16x16x32_bf16 a[120:123], v[40:43], v[88:91], a[120:123]
    v_mfma_f32_16x16x32_bf16 a[124:127], v[44:47], v[88:91], a[124:127]
    s_add_u32 m0, s51, 88064
    s_add_u32 s52, s47, 122880
    buffer_load_dwordx4 v10, s[4:7], s52 offen lds
    v_mfma_f32_16x16x32_bf16 a[128:131], v[48:51], v[88:91], a[128:131]
    v_mfma_f32_16x16x32_bf16 a[132:135], v[52:55], v[88:91], a[132:135]
    s_add_u32 m0, s51, 89088
    s_add_u32 s52, s47, 184320
    buffer_load_dwordx4 v10, s[4:7], s52 offen lds
    v_mfma_f32_16x16x32_bf16 a[136:139], v[56:59], v[88:91], a[136:139]
    ds_read_b64_tr_b16 v[84:85], v13 offset:0
    ds_read_b64_tr_b16 v[86:87], v13 offset:1024
    s_waitcnt lgkmcnt(9)
    v_mfma_f32_16x16x32_bf16 a[140:143], v[40:43], v[92:95], a[140:143]
    v_mfma_f32_16x16x32_bf16 a[144:147], v[44:47], v[92:95], a[144:147]
    s_add_u32 m0, s51, 90112
    s_add_u32 s52, s47, 245760
    buffer_load_dwordx4 v10, s[4:7], s52 offen lds
    v_mfma_f32_16x16x32_bf16 a[148:151], v[48:51], v[92:95], a[148:151]
    v_mfma_f32_16x16x32_bf16 a[152:155], v[52:55], v[92:95], a[152:155]
    s_add_u32 s46, s46, 131072
    s_add_u32 s47, s47, 64
    s_add_u32 s53, s53, 1
    s_cmp_eq_u32 s53, 20
    s_cselect_b32 s46, 0, s46
    v_mfma_f32_16x16x32_bf16 a[156:159], v[56:59], v[92:95], a[156:159]
    ds_read_b64_tr_b16 v[88:89], v14 offset:0
    ds_read_b64_tr_b16 v[90:91], v14 offset:1024
    s_waitcnt lgkmcnt(6)
    s_waitcnt lgkmcnt(4)
    v_mfma_f32_16x16x32_bf16 a[0:3], v[60:63], v[80:83], a[0:3]
    v_mfma_f32_16x16x32_bf16 a[4:7], v[64:67], v[80:83], a[4:7]
    v_mfma_f32_16x16x32_bf16 a[8:11], v[68:71], v[80:83], a[8:11]
    v_mfma_f32_16x16x32_bf16 a[12:15], v[72:75], v[80:83], a[12:15]
    v_mfma_f32_16x16x32_bf16 a[16:19], v[76:79], v[80:83], a[16:19]
    ds_read_b64_tr_b16 v[92:93], v15 offset:0
    ds_read_b64_tr_b16 v[94:95], v15 offset:1024
    s_waitcnt lgkmcnt(4)
    v_mfma_f32_16x16x32_bf16 a[20:23], v[60:63], v[84:87], a[20:23]
    v_mfma_f32_16x16x32_bf16 a[24:27], v[64:67], v[84:87], a[24:27]
    v_mfma_f32_16x16x32_bf16 a[28:31], v[68:71], v[84:87], a[28:31]
    v_mfma_f32_16x16x32_bf16 a[32:35], v[72:75], v[84:87], a[32:35]
    v_mfma_f32_16x16x32_bf16 a[36:39], v[76:79], v[84:87], a[36:39]
    ds_read_b64_tr_b16 v[80:81], v16 offset:0
    ds_read_b64_tr_b16 v[82:83], v16 offset:1024
    s_waitcnt lgkmcnt(4)
    v_mfma_f32_16x16x32_bf16 a[40:43], v[60:63], v[88:91], a[40:43]
    v_mfma_f32_16x16x32_bf16 a[44:47], v[64:67], v[88:91], a[44:47]
    v_mfma_f32_16x16x32_bf16 a[48:51], v[68:71], v[88:91], a[48:51]
    v_mfma_f32_16x16x32_bf16 a[52:55], v[72:75], v[88:91], a[52:55]
    v_mfma_f32_16x16x32_bf16 a[56:59], v[76:79], v[88:91], a[56:59]
    ds_read_b64_tr_b16 v[84:85], v17 offset:0
    ds_read_b64_tr_b16 v[86:87], v17 offset:1024
    s_waitcnt lgkmcnt(4)
    v_mfma_f32_16x16x32_bf16 a[60:63], v[60:63], v[92:95], a[60:63]
    v_mfma_f32_16x16x32_bf16 a[64:67], v[64:67], v[92:95], a[64:67]
    v_mfma_f32_16x16x32_bf16 a[68:71], v[68:71], v[92:95], a[68:71]
    v_mfma_f32_16x16x32_bf16 a[72:75], v[72:75], v[92:95], a[72:75]
    v_mfma_f32_16x16x32_bf16 a[76:79], v[76:79], v[92:95], a[76:79]
    s_waitcnt vmcnt(14)
    s_barrier
    ds_read_b64_tr_b16 v[88:89], v18 offset:0
    ds_read_b64_tr_b16 v[90:91], v18 offset:1024
    s_waitcnt lgkmcnt(4)
    v_mfma_f32_16x16x32_bf16 a[80:83], v[60:63], v[80:83], a[80:83]
    v_mfma_f32_16x16x32_bf16 a[84:87], v[64:67], v[80:83], a[84:87]
    s_add_u32 m0, s50, 114688
    s_add_u32 s52, s46, 0xa800000
    buffer_load_dwordx4 v9, s[4:7], s52 offen lds
    v_mfma_f32_16x16x32_bf16 a[88:91], v[68:71], v[80:83], a[88:91]
    v_mfma_f32_16x16x32_bf16 a[92:95], v[72:75], v[80:83], a[92:95]
    s_add_u32 m0, s50, 115712
    s_add_u32 s52, s46, 0xa804000
    buffer_load_dwordx4 v9, s[4:7], s52 offen lds
    v_mfma_f32_16x16x32_bf16 a[96:99], v[76:79], v[80:83], a[96:99]
    ds_read_b64_tr_b16 v[92:93], v19 offset:0
    ds_read_b64_tr_b16 v[94:95], v19 offset:1024
    s_waitcnt lgkmcnt(4)
    v_mfma_f32_16x16x32_bf16 a[100:103], v[60:63], v[84:87], a[100:103]
    v_mfma_f32_16x16x32_bf16 a[104:107], v[64:67], v[84:87], a[104:107]
    s_add_u32 m0, s51, 114688
    s_add_u32 s52, s47, 0
    buffer_load_dwordx4 v10, s[4:7], s52 offen lds
    v_mfma_f32_16x16x32_bf16 a[108:111], v[68:71], v[84:87], a[108:111]
    v_mfma_f32_16x16x32_bf16 a[112:115], v[72:75], v[84:87], a[112:115]
    s_add_u32 m0, s51, 115712
    s_add_u32 s52, s47, 61440
    buffer_load_dwordx4 v10, s[4:7], s52 offen lds
    v_mfma_f32_16x16x32_bf16 a[116:119], v[76:79], v[84:87], a[116:119]
    ds_read_b128 v[40:43], v36 offset:28672
    ds_read_b128 v[44:47], v36 offset:29696
    ds_read_b128 v[48:51], v36 offset:30720
    ds_read_b128 v[52:55], v36 offset:31744
    ds_read_b128 v[56:59], v36 offset:32768
    ds_read_b64_tr_b16 v[80:81], v12 offset:28672
    ds_read_b64_tr_b16 v[82:83], v12 offset:29696
    s_waitcnt lgkmcnt(9)
    v_mfma_f32_16x16x32_bf16 a[120:123], v[60:63], v[88:91], a[120:123]
    v_mfma_f32_16x16x32_bf16 a[124:127], v[64:67], v[88:91], a[124:127]
    s_add_u32 m0, s51, 116736
    s_add_u32 s52, s47, 122880
    buffer_load_dwordx4 v10, s[4:7], s52 offen lds
    v_mfma_f32_16x16x32_bf16 a[128:131], v[68:71], v[88:91], a[128:131]
    v_mfma_f32_16x16x32_bf16 a[132:135], v[72:75], v[88:91], a[132:135]
    s_add_u32 m0, s51, 117760
    s_add_u32 s52, s47, 184320
    buffer_load_dwordx4 v10, s[4:7], s52 offen lds
    v_mfma_f32_16x16x32_bf16 a[136:139], v[76:79], v[88:91], a[136:139]
    ds_read_b64_tr_b16 v[84:85], v13 offset:28672
    ds_read_b64_tr_b16 v[86:87], v13 offset:29696
    s_waitcnt lgkmcnt(9)
    v_mfma_f32_16x16x32_bf16 a[140:143], v[60:63], v[92:95], a[140:143]
    v_mfma_f32_16x16x32_bf16 a[144:147], v[64:67], v[92:95], a[144:147]
    s_add_u32 m0, s51, 118784
    s_add_u32 s52, s47, 245760
    buffer_load_dwordx4 v10, s[4:7], s52 offen lds
    v_mfma_f32_16x16x32_bf16 a[148:151], v[68:71], v[92:95], a[148:151]
    v_mfma_f32_16x16x32_bf16 a[152:155], v[72:75], v[92:95], a[152:155]
    s_add_u32 s46, s46, 131072
    s_add_u32 s47, s47, 64
    s_add_u32 s53, s53, 1
    s_cmp_eq_u32 s53, 20
    s_cselect_b32 s46, 0, s46
    v_mfma_f32_16x16x32_bf16 a[156:159], v[76:79], v[92:95], a[156:159]
    ds_read_b64_tr_b16 v[88:89], v14 offset:28672
    ds_read_b64_tr_b16 v[90:91], v14 offset:29696
    s_waitcnt lgkmcnt(6)
    s_waitcnt lgkmcnt(4)
    v_mfma_f32_16x16x32_bf16 a[0:3], v[40:43], v[80:83], a[0:3]
    v_mfma_f32_16x16x32_bf16 a[4:7], v[44:47], v[80:83], a[4:7]
    v_mfma_f32_16x16x32_bf16 a[8:11], v[48:51], v[80:83], a[8:11]
    v_mfma_f32_16x16x32_bf16 a[12:15], v[52:55], v[80:83], a[12:15]
    v_mfma_f32_16x16x32_bf16 a[16:19], v[56:59], v[80:83], a[16:19]
    ds_read_b64_tr_b16 v[92:93], v15 offset:28672
    ds_read_b64_tr_b16 v[94:95], v15 offset:29696
    s_waitcnt lgkmcnt(4)
    v_mfma_f32_16x16x32_bf16 a[20:23], v[40:43], v[84:87], a[20:23]
    v_mfma_f32_16x16x32_bf16 a[24:27], v[44:47], v[84:87], a[24:27]
    v_mfma_f32_16x16x32_bf16 a[28:31], v[48:51], v[84:87], a[28:31]
    v_mfma_f32_16x16x32_bf16 a[32:35], v[52:55], v[84:87], a[32:35]
    v_mfma_f32_16x16x32_bf16 a[36:39], v[56:59], v[84:87], a[36:39]
    ds_read_b64_tr_b16 v[80:81], v16 offset:28672
    ds_read_b64_tr_b16 v[82:83], v16 offset:29696
    s_waitcnt lgkmcnt(4)
    v_mfma_f32_16x16x32_bf16 a[40:43], v[40:43], v[88:91], a[40:43]
    v_mfma_f32_16x16x32_bf16 a[44:47], v[44:47], v[88:91], a[44:47]
    v_mfma_f32_16x16x32_bf16 a[48:51], v[48:51], v[88:91], a[48:51]
    v_mfma_f32_16x16x32_bf16 a[52:55], v[52:55], v[88:91], a[52:55]
    v_mfma_f32_16x16x32_bf16 a[56:59], v[56:59], v[88:91], a[56:59]
    ds_read_b64_tr_b16 v[84:85], v17 offset:28672
    ds_read_b64_tr_b16 v[86:87], v17 offset:29696
    s_waitcnt lgkmcnt(4)
    v_mfma_f32_16x16x32_bf16 a[60:63], v[40:43], v[92:95], a[60:63]
    v_mfma_f32_16x16x32_bf16 a[64:67], v[44:47], v[92:95], a[64:67]
    v_mfma_f32_16x16x32_bf16 a[68:71], v[48:51], v[92:95], a[68:71]
    v_mfma_f32_16x16x32_bf16 a[72:75], v[52:55], v[92:95], a[72:75]
    v_mfma_f32_16x16x32_bf16 a[76:79], v[56:59], v[92:95], a[76:79]
    s_waitcnt vmcnt(14)
    s_barrier
    ds_read_b64_tr_b16 v[88:89], v18 offset:28672
    ds_read_b64_tr_b16 v[90:91], v18 offset:29696
    s_waitcnt lgkmcnt(4)
    v_mfma_f32_16x16x32_bf16 a[80:83], v[40:43], v[80:83], a[80:83]
    v_mfma_f32_16x16x32_bf16 a[84:87], v[44:47], v[80:83], a[84:87]
    s_add_u32 m0, s50, 0
    s_add_u32 s52, s46, 0xa800000
    buffer_load_dwordx4 v9, s[4:7], s52 offen lds
    v_mfma_f32_16x16x32_bf16 a[88:91], v[48:51], v[80:83], a[88:91]
    v_mfma_f32_16x16x32_bf16 a[92:95], v[52:55], v[80:83], a[92:95]
    s_add_u32 m0, s50, 1024
    s_add_u32 s52, s46, 0xa804000
    buffer_load_dwordx4 v9, s[4:7], s52 offen lds
    v_mfma_f32_16x16x32_bf16 a[96:99], v[56:59], v[80:83], a[96:99]
    ds_read_b64_tr_b16 v[92:93], v19 offset:28672
    ds_read_b64_tr_b16 v[94:95], v19 offset:29696
    s_waitcnt lgkmcnt(4)
    v_mfma_f32_16x16x32_bf16 a[100:103], v[40:43], v[84:87], a[100:103]
    v_mfma_f32_16x16x32_bf16 a[104:107], v[44:47], v[84:87], a[104:107]
    s_add_u32 m0, s51, 0
    s_add_u32 s52, s47, 0
    buffer_load_dwordx4 v10, s[4:7], s52 offen lds
    v_mfma_f32_16x16x32_bf16 a[108:111], v[48:51], v[84:87], a[108:111]
    v_mfma_f32_16x16x32_bf16 a[112:115], v[52:55], v[84:87], a[112:115]
    s_add_u32 m0, s51, 1024
    s_add_u32 s52, s47, 61440
    buffer_load_dwordx4 v10, s[4:7], s52 offen lds
    v_mfma_f32_16x16x32_bf16 a[116:119], v[56:59], v[84:87], a[116:119]
    ds_read_b128 v[60:63], v36 offset:57344
    ds_read_b128 v[64:67], v36 offset:58368
    ds_read_b128 v[68:71], v36 offset:59392
    ds_read_b128 v[72:75], v36 offset:60416
    ds_read_b128 v[76:79], v36 offset:61440
    ds_read_b64_tr_b16 v[80:81], v12 offset:57344
    ds_read_b64_tr_b16 v[82:83], v12 offset:58368
    s_waitcnt lgkmcnt(9)
    v_mfma_f32_16x16x32_bf16 a[120:123], v[40:43], v[88:91], a[120:123]
    v_mfma_f32_16x16x32_bf16 a[124:127], v[44:47], v[88:91], a[124:127]
    s_add_u32 m0, s51, 2048
    s_add_u32 s52, s47, 122880
    buffer_load_dwordx4 v10, s[4:7], s52 offen lds
    v_mfma_f32_16x16x32_bf16 a[128:131], v[48:51], v[88:91], a[128:131]
    v_mfma_f32_16x16x32_bf16 a[132:135], v[52:55], v[88:91], a[132:135]
    s_add_u32 m0, s51, 3072
    s_add_u32 s52, s47, 184320
    buffer_load_dwordx4 v10, s[4:7], s52 offen lds
    v_mfma_f32_16x16x32_bf16 a[136:139], v[56:59], v[88:91], a[136:139]
    ds_read_b64_tr_b16 v[84:85], v13 offset:57344
    ds_read_b64_tr_b16 v[86:87], v13 offset:58368
    s_waitcnt lgkmcnt(9)
    v_mfma_f32_16x16x32_bf16 a[140:143], v[40:43], v[92:95], a[140:143]
    v_mfma_f32_16x16x32_bf16 a[144:147], v[44:47], v[92:95], a[144:147]
    s_add_u32 m0, s51, 4096
    s_add_u32 s52, s47, 245760
    buffer_load_dwordx4 v10, s[4:7], s52 offen lds
    v_mfma_f32_16x16x32_bf16 a[148:151], v[48:51], v[92:95], a[148:151]
    v_mfma_f32_16x16x32_bf16 a[152:155], v[52:55], v[92:95], a[152:155]
    s_add_u32 s46, s46, 131072
    s_add_u32 s47, s47, 64
    s_add_u32 s53, s53, 1
    s_cmp_eq_u32 s53, 20
    s_cselect_b32 s46, 0, s46
    v_mfma_f32_16x16x32_bf16 a[156:159], v[56:59], v[92:95], a[156:159]
    ds_read_b64_tr_b16 v[88:89], v14 offset:57344
    ds_read_b64_tr_b16 v[90:91], v14 offset:58368
    s_waitcnt lgkmcnt(6)
    s_waitcnt lgkmcnt(4)
    v_mfma_f32_16x16x32_bf16 a[0:3], v[60:63], v[80:83], a[0:3]
    v_mfma_f32_16x16x32_bf16 a[4:7], v[64:67], v[80:83], a[4:7]
    v_mfma_f32_16x16x32_bf16 a[8:11], v[68:71], v[80:83], a[8:11]
    v_mfma_f32_16x16x32_bf16 a[12:15], v[72:75], v[80:83], a[12:15]
    v_mfma_f32_16x16x32_bf16 a[16:19], v[76:79], v[80:83], a[16:19]
    ds_read_b64_tr_b16 v[92:93], v15 offset:57344
    ds_read_b64_tr_b16 v[94:95], v15 offset:58368
    s_waitcnt lgkmcnt(4)
    v_mfma_f32_16x16x32_bf16 a[20:23], v[60:63], v[84:87], a[20:23]
    v_mfma_f32_16x16x32_bf16 a[24:27], v[64:67], v[84:87], a[24:27]
    v_mfma_f32_16x16x32_bf16 a[28:31], v[68:71], v[84:87], a[28:31]
    v_mfma_f32_16x16x32_bf16 a[32:35], v[72:75], v[84:87], a[32:35]
    v_mfma_f32_16x16x32_bf16 a[36:39], v[76:79], v[84:87], a[36:39]
    ds_read_b64_tr_b16 v[80:81], v16 offset:57344
    ds_read_b64_tr_b16 v[82:83], v16 offset:58368
    s_waitcnt lgkmcnt(4)
    v_mfma_f32_16x16x32_bf16 a[40:43], v[60:63], v[88:91], a[40:43]
    v_mfma_f32_16x16x32_bf16 a[44:47], v[64:67], v[88:91], a[44:47]
    v_mfma_f32_16x16x32_bf16 a[48:51], v[68:71], v[88:91], a[48:51]
    v_mfma_f32_16x16x32_bf16 a[52:55], v[72:75], v[88:91], a[52:55]
    v_mfma_f32_16x16x32_bf16 a[56:59], v[76:79], v[88:91], a[56:59]
    ds_read_b64_tr_b16 v[84:85], v17 offset:57344
    ds_read_b64_tr_b16 v[86:87], v17 offset:58368
    s_waitcnt lgkmcnt(4)
    v_mfma_f32_16x16x32_bf16 a[60:63], v[60:63], v[92:95], a[60:63]
    v_mfma_f32_16x16x32_bf16 a[64:67], v[64:67], v[92:95], a[64:67]
    v_mfma_f32_16x16x32_bf16 a[68:71], v[68:71], v[92:95], a[68:71]
    v_mfma_f32_16x16x32_bf16 a[72:75], v[72:75], v[92:95], a[72:75]
    v_mfma_f32_16x16x32_bf16 a[76:79], v[76:79], v[92:95], a[76:79]
    s_waitcnt vmcnt(14)
    s_barrier
    ds_read_b64_tr_b16 v[88:89], v18 offset:57344
    ds_read_b64_tr_b16 v[90:91], v18 offset:58368
    s_waitcnt lgkmcnt(4)
    v_mfma_f32_16x16x32_bf16 a[80:83], v[60:63], v[80:83], a[80:83]
    v_mfma_f32_16x16x32_bf16 a[84:87], v[64:67], v[80:83], a[84:87]
    s_add_u32 m0, s50, 28672
    s_add_u32 s52, s46, 0xa800000
    buffer_load_dwordx4 v9, s[4:7], s52 offen lds
    v_mfma_f32_16x16x32_bf16 a[88:91], v[68:71], v[80:83], a[88:91]
    v_mfma_f32_16x16x32_bf16 a[92:95], v[72:75], v[80:83], a[92:95]
    s_add_u32 m0, s50, 29696
    s_add_u32 s52, s46, 0xa804000
    buffer_load_dwordx4 v9, s[4:7], s52 offen lds
    v_mfma_f32_16x16x32_bf16 a[96:99], v[76:79], v[80:83], a[96:99]
    ds_read_b64_tr_b16 v[92:93], v19 offset:57344
    ds_read_b64_tr_b16 v[94:95], v19 offset:58368
    s_waitcnt lgkmcnt(4)
    v_mfma_f32_16x16x32_bf16 a[100:103], v[60:63], v[84:87], a[100:103]
    v_mfma_f32_16x16x32_bf16 a[104:107], v[64:67], v[84:87], a[104:107]
    s_add_u32 m0, s51, 28672
    s_add_u32 s52, s47, 0
    buffer_load_dwordx4 v10, s[4:7], s52 offen lds
    v_mfma_f32_16x16x32_bf16 a[108:111], v[68:71], v[84:87], a[108:111]
    v_mfma_f32_16x16x32_bf16 a[112:115], v[72:75], v[84:87], a[112:115]
    s_add_u32 m0, s51, 29696
    s_add_u32 s52, s47, 61440
    buffer_load_dwordx4 v10, s[4:7], s52 offen lds
    v_mfma_f32_16x16x32_bf16 a[116:119], v[76:79], v[84:87], a[116:119]
    ds_read_b128 v[40:43], v37 offset:20480
    ds_read_b128 v[44:47], v37 offset:21504
    ds_read_b128 v[48:51], v37 offset:22528
    ds_read_b128 v[52:55], v37 offset:23552
    ds_read_b128 v[56:59], v37 offset:24576
    ds_read_b64_tr_b16 v[80:81], v20 offset:20480
    ds_read_b64_tr_b16 v[82:83], v20 offset:21504
    s_waitcnt lgkmcnt(9)
    v_mfma_f32_16x16x32_bf16 a[120:123], v[60:63], v[88:91], a[120:123]
    v_mfma_f32_16x16x32_bf16 a[124:127], v[64:67], v[88:91], a[124:127]
    s_add_u32 m0, s51, 30720
    s_add_u32 s52, s47, 122880
    buffer_load_dwordx4 v10, s[4:7], s52 offen lds
    v_mfma_f32_16x16x32_bf16 a[128:131], v[68:71], v[88:91], a[128:131]
    v_mfma_f32_16x16x32_bf16 a[132:135], v[72:75], v[88:91], a[132:135]
    s_add_u32 m0, s51, 31744
    s_add_u32 s52, s47, 184320
    buffer_load_dwordx4 v10, s[4:7], s52 offen lds
    v_mfma_f32_16x16x32_bf16 a[136:139], v[76:79], v[88:91], a[136:139]
    ds_read_b64_tr_b16 v[84:85], v21 offset:20480
    ds_read_b64_tr_b16 v[86:87], v21 offset:21504
    s_waitcnt lgkmcnt(9)
    v_mfma_f32_16x16x32_bf16 a[140:143], v[60:63], v[92:95], a[140:143]
    v_mfma_f32_16x16x32_bf16 a[144:147], v[64:67], v[92:95], a[144:147]
    s_add_u32 m0, s51, 32768
    s_add_u32 s52, s47, 245760
    buffer_load_dwordx4 v10, s[4:7], s52 offen lds
    v_mfma_f32_16x16x32_bf16 a[148:151], v[68:71], v[92:95], a[148:151]
    v_mfma_f32_16x16x32_bf16 a[152:155], v[72:75], v[92:95], a[152:155]
    s_add_u32 s46, s46, 131072
    s_add_u32 s47, s47, 64
    s_add_u32 s53, s53, 1
    s_cmp_eq_u32 s53, 20
    s_cselect_b32 s46, 0, s46
    v_mfma_f32_16x16x32_bf16 a[156:159], v[76:79], v[92:95], a[156:159]
    ds_read_b64_tr_b16 v[88:89], v22 offset:20480
    ds_read_b64_tr_b16 v[90:91], v22 offset:21504
    s_waitcnt lgkmcnt(6)
    s_waitcnt lgkmcnt(4)
    v_mfma_f32_16x16x32_bf16 a[0:3], v[40:43], v[80:83], a[0:3]
    v_mfma_f32_16x16x32_bf16 a[4:7], v[44:47], v[80:83], a[4:7]
    v_mfma_f32_16x16x32_bf16 a[8:11], v[48:51], v[80:83], a[8:11]
    v_mfma_f32_16x16x32_bf16 a[12:15], v[52:55], v[80:83], a[12:15]
    v_mfma_f32_16x16x32_bf16 a[16:19], v[56:59], v[80:83], a[16:19]
    ds_read_b64_tr_b16 v[92:93], v23 offset:20480
    ds_read_b64_tr_b16 v[94:95], v23 offset:21504
    s_waitcnt lgkmcnt(4)
    v_mfma_f32_16x16x32_bf16 a[20:23], v[40:43], v[84:87], a[20:23]
    v_mfma_f32_16x16x32_bf16 a[24:27], v[44:47], v[84:87], a[24:27]
    v_mfma_f32_16x16x32_bf16 a[28:31], v[48:51], v[84:87], a[28:31]
    v_mfma_f32_16x16x32_bf16 a[32:35], v[52:55], v[84:87], a[32:35]
    v_mfma_f32_16x16x32_bf16 a[36:39], v[56:59], v[84:87], a[36:39]
    ds_read_b64_tr_b16 v[80:81], v24 offset:20480
    ds_read_b64_tr_b16 v[82:83], v24 offset:21504
    s_waitcnt lgkmcnt(4)
    v_mfma_f32_16x16x32_bf16 a[40:43], v[40:43], v[88:91], a[40:43]
    v_mfma_f32_16x16x32_bf16 a[44:47], v[44:47], v[88:91], a[44:47]
    v_mfma_f32_16x16x32_bf16 a[48:51], v[48:51], v[88:91], a[48:51]
    v_mfma_f32_16x16x32_bf16 a[52:55], v[52:55], v[88:91], a[52:55]
    v_mfma_f32_16x16x32_bf16 a[56:59], v[56:59], v[88:91], a[56:59]
    ds_read_b64_tr_b16 v[84:85], v25 offset:20480
    ds_read_b64_tr_b16 v[86:87], v25 offset:21504
    s_waitcnt lgkmcnt(4)
    v_mfma_f32_16x16x32_bf16 a[60:63], v[40:43], v[92:95], a[60:63]
    v_mfma_f32_16x16x32_bf16 a[64:67], v[44:47], v[92:95], a[64:67]
    v_mfma_f32_16x16x32_bf16 a[68:71], v[48:51], v[92:95], a[68:71]
    v_mfma_f32_16x16x32_bf16 a[72:75], v[52:55], v[92:95], a[72:75]
    v_mfma_f32_16x16x32_bf16 a[76:79], v[56:59], v[92:95], a[76:79]
    s_waitcnt vmcnt(14)
    s_barrier
    ds_read_b64_tr_b16 v[88:89], v26 offset:20480
    ds_read_b64_tr_b16 v[90:91], v26 offset:21504
    s_waitcnt lgkmcnt(4)
    v_mfma_f32_16x16x32_bf16 a[80:83], v[40:43], v[80:83], a[80:83]
    v_mfma_f32_16x16x32_bf16 a[84:87], v[44:47], v[80:83], a[84:87]
    s_add_u32 m0, s50, 57344
    s_add_u32 s52, s46, 0xa800000
    buffer_load_dwordx4 v9, s[4:7], s52 offen lds
    v_mfma_f32_16x16x32_bf16 a[88:91], v[48:51], v[80:83], a[88:91]
    v_mfma_f32_16x16x32_bf16 a[92:95], v[52:55], v[80:83], a[92:95]
    s_add_u32 m0, s50, 58368
    s_add_u32 s52, s46, 0xa804000
    buffer_load_dwordx4 v9, s[4:7], s52 offen lds
    v_mfma_f32_16x16x32_bf16 a[96:99], v[56:59], v[80:83], a[96:99]
    ds_read_b64_tr_b16 v[92:93], v27 offset:20480
    ds_read_b64_tr_b16 v[94:95], v27 offset:21504
    s_waitcnt lgkmcnt(4)
    v_mfma_f32_16x16x32_bf16 a[100:103], v[40:43], v[84:87], a[100:103]
    v_mfma_f32_16x16x32_bf16 a[104:107], v[44:47], v[84:87], a[104:107]
    s_add_u32 m0, s51, 57344
    s_add_u32 s52, s47, 0
    buffer_load_dwordx4 v10, s[4:7], s52 offen lds
    v_mfma_f32_16x16x32_bf16 a[108:111], v[48:51], v[84:87], a[108:111]
    v_mfma_f32_16x16x32_bf16 a[112:115], v[52:55], v[84:87], a[112:115]
    s_add_u32 m0, s51, 58368
    s_add_u32 s52, s47, 61440
    buffer_load_dwordx4 v10, s[4:7], s52 offen lds
    v_mfma_f32_16x16x32_bf16 a[116:119], v[56:59], v[84:87], a[116:119]
    ds_read_b128 v[60:63], v37 offset:49152
    ds_read_b128 v[64:67], v37 offset:50176
    ds_read_b128 v[68:71], v37 offset:51200
    ds_read_b128 v[72:75], v37 offset:52224
    ds_read_b128 v[76:79], v37 offset:53248
    ds_read_b64_tr_b16 v[80:81], v20 offset:49152
    ds_read_b64_tr_b16 v[82:83], v20 offset:50176
    s_waitcnt lgkmcnt(9)
    v_mfma_f32_16x16x32_bf16 a[120:123], v[40:43], v[88:91], a[120:123]
    v_mfma_f32_16x16x32_bf16 a[124:127], v[44:47], v[88:91], a[124:127]
    s_add_u32 m0, s51, 59392
    s_add_u32 s52, s47, 122880
    buffer_load_dwordx4 v10, s[4:7], s52 offen lds
    v_mfma_f32_16x16x32_bf16 a[128:131], v[48:51], v[88:91], a[128:131]
    v_mfma_f32_16x16x32_bf16 a[132:135], v[52:55], v[88:91], a[132:135]
    s_add_u32 m0, s51, 60416
    s_add_u32 s52, s47, 184320
    buffer_load_dwordx4 v10, s[4:7], s52 offen lds
    v_mfma_f32_16x16x32_bf16 a[136:139], v[56:59], v[88:91], a[136:139]
    ds_read_b64_tr_b16 v[84:85], v21 offset:49152
    ds_read_b64_tr_b16 v[86:87], v21 offset:50176
    s_waitcnt lgkmcnt(9)
    v_mfma_f32_16x16x32_bf16 a[140:143], v[40:43], v[92:95], a[140:143]
    v_mfma_f32_16x16x32_bf16 a[144:147], v[44:47], v[92:95], a[144:147]
    s_add_u32 m0, s51, 61440
    s_add_u32 s52, s47, 245760
    buffer_load_dwordx4 v10, s[4:7], s52 offen lds
    v_mfma_f32_16x16x32_bf16 a[148:151], v[48:51], v[92:95], a[148:151]
    v_mfma_f32_16x16x32_bf16 a[152:155], v[52:55], v[92:95], a[152:155]
    s_add_u32 s46, s46, 131072
    s_add_u32 s47, s47, 64
    s_add_u32 s53, s53, 1
    s_cmp_eq_u32 s53, 20
    s_cselect_b32 s46, 0, s46
    v_mfma_f32_16x16x32_bf16 a[156:159], v[56:59], v[92:95], a[156:159]
    ds_read_b64_tr_b16 v[88:89], v22 offset:49152
    ds_read_b64_tr_b16 v[90:91], v22 offset:50176
    s_waitcnt lgkmcnt(6)
    s_waitcnt lgkmcnt(4)
    v_mfma_f32_16x16x32_bf16 a[0:3], v[60:63], v[80:83], a[0:3]
    v_mfma_f32_16x16x32_bf16 a[4:7], v[64:67], v[80:83], a[4:7]
    v_mfma_f32_16x16x32_bf16 a[8:11], v[68:71], v[80:83], a[8:11]
    v_mfma_f32_16x16x32_bf16 a[12:15], v[72:75], v[80:83], a[12:15]
    v_mfma_f32_16x16x32_bf16 a[16:19], v[76:79], v[80:83], a[16:19]
    ds_read_b64_tr_b16 v[92:93], v23 offset:49152
    ds_read_b64_tr_b16 v[94:95], v23 offset:50176
    s_waitcnt lgkmcnt(4)
    v_mfma_f32_16x16x32_bf16 a[20:23], v[60:63], v[84:87], a[20:23]
    v_mfma_f32_16x16x32_bf16 a[24:27], v[64:67], v[84:87], a[24:27]
    v_mfma_f32_16x16x32_bf16 a[28:31], v[68:71], v[84:87], a[28:31]
    v_mfma_f32_16x16x32_bf16 a[32:35], v[72:75], v[84:87], a[32:35]
    v_mfma_f32_16x16x32_bf16 a[36:39], v[76:79], v[84:87], a[36:39]
    ds_read_b64_tr_b16 v[80:81], v24 offset:49152
    ds_read_b64_tr_b16 v[82:83], v24 offset:50176
    s_waitcnt lgkmcnt(4)
    v_mfma_f32_16x16x32_bf16 a[40:43], v[60:63], v[88:91], a[40:43]
    v_mfma_f32_16x16x32_bf16 a[44:47], v[64:67], v[88:91], a[44:47]
    v_mfma_f32_16x16x32_bf16 a[48:51], v[68:71], v[88:91], a[48:51]
    v_mfma_f32_16x16x32_bf16 a[52:55], v[72:75], v[88:91], a[52:55]
    v_mfma_f32_16x16x32_bf16 a[56:59], v[76:79], v[88:91], a[56:59]
    ds_read_b64_tr_b16 v[84:85], v25 offset:49152
    ds_read_b64_tr_b16 v[86:87], v25 offset:50176
    s_waitcnt lgkmcnt(4)
    v_mfma_f32_16x16x32_bf16 a[60:63], v[60:63], v[92:95], a[60:63]
    v_mfma_f32_16x16x32_bf16 a[64:67], v[64:67], v[92:95], a[64:67]
    v_mfma_f32_16x16x32_bf16 a[68:71], v[68:71], v[92:95], a[68:71]
    v_mfma_f32_16x16x32_bf16 a[72:75], v[72:75], v[92:95], a[72:75]
    v_mfma_f32_16x16x32_bf16 a[76:79], v[76:79], v[92:95], a[76:79]
    s_waitcnt vmcnt(14)
    s_barrier
    ds_read_b64_tr_b16 v[88:89], v26 offset:49152
    ds_read_b64_tr_b16 v[90:91], v26 offset:50176
    s_waitcnt lgkmcnt(4)
    v_mfma_f32_16x16x32_bf16 a[80:83], v[60:63], v[80:83], a[80:83]
    v_mfma_f32_16x16x32_bf16 a[84:87], v[64:67], v[80:83], a[84:87]
    s_add_u32 m0, s50, 86016
    s_add_u32 s52, s46, 0xa800000
    buffer_load_dwordx4 v9, s[4:7], s52 offen lds
    v_mfma_f32_16x16x32_bf16 a[88:91], v[68:71], v[80:83], a[88:91]
    v_mfma_f32_16x16x32_bf16 a[92:95], v[72:75], v[80:83], a[92:95]
    s_add_u32 m0, s50, 87040
    s_add_u32 s52, s46, 0xa804000
    buffer_load_dwordx4 v9, s[4:7], s52 offen lds
    v_mfma_f32_16x16x32_bf16 a[96:99], v[76:79], v[80:83], a[96:99]
    ds_read_b64_tr_b16 v[92:93], v27 offset:49152
    ds_read_b64_tr_b16 v[94:95], v27 offset:50176
    s_waitcnt lgkmcnt(4)
    v_mfma_f32_16x16x32_bf16 a[100:103], v[60:63], v[84:87], a[100:103]
    v_mfma_f32_16x16x32_bf16 a[104:107], v[64:67], v[84:87], a[104:107]
    s_add_u32 m0, s51, 86016
    s_add_u32 s52, s47, 0
    buffer_load_dwordx4 v10, s[4:7], s52 offen lds
    v_mfma_f32_16x16x32_bf16 a[108:111], v[68:71], v[84:87], a[108:111]
    v_mfma_f32_16x16x32_bf16 a[112:115], v[72:75], v[84:87], a[112:115]
    s_add_u32 m0, s51, 87040
    s_add_u32 s52, s47, 61440
    buffer_load_dwordx4 v10, s[4:7], s52 offen lds
    v_mfma_f32_16x16x32_bf16 a[116:119], v[76:79], v[84:87], a[116:119]
    ds_read_b128 v[40:43], v36 offset:0
    ds_read_b128 v[44:47], v36 offset:1024
    ds_read_b128 v[48:51], v36 offset:2048
    ds_read_b128 v[52:55], v36 offset:3072
    ds_read_b128 v[56:59], v36 offset:4096
    ds_read_b64_tr_b16 v[80:81], v12 offset:0
    ds_read_b64_tr_b16 v[82:83], v12 offset:1024
    s_waitcnt lgkmcnt(9)
    v_mfma_f32_16x16x32_bf16 a[120:123], v[60:63], v[88:91], a[120:123]
    v_mfma_f32_16x16x32_bf16 a[124:127], v[64:67], v[88:91], a[124:127]
    s_add_u32 m0, s51, 88064
    s_add_u32 s52, s47, 122880
    buffer_load_dwordx4 v10, s[4:7], s52 offen lds
    v_mfma_f32_16x16x32_bf16 a[128:131], v[68:71], v[88:91], a[128:131]
    v_mfma_f32_16x16x32_bf16 a[132:135], v[72:75], v[88:91], a[132:135]
    s_add_u32 m0, s51, 89088
    s_add_u32 s52, s47, 184320
    buffer_load_dwordx4 v10, s[4:7], s52 offen lds
    v_mfma_f32_16x16x32_bf16 a[136:139], v[76:79], v[88:91], a[136:139]
    ds_read_b64_tr_b16 v[84:85], v13 offset:0
    ds_read_b64_tr_b16 v[86:87], v13 offset:1024
    s_waitcnt lgkmcnt(9)
    v_mfma_f32_16x16x32_bf16 a[140:143], v[60:63], v[92:95], a[140:143]
    v_mfma_f32_16x16x32_bf16 a[144:147], v[64:67], v[92:95], a[144:147]
    s_add_u32 m0, s51, 90112
    s_add_u32 s52, s47, 245760
    buffer_load_dwordx4 v10, s[4:7], s52 offen lds
    v_mfma_f32_16x16x32_bf16 a[148:151], v[68:71], v[92:95], a[148:151]
    v_mfma_f32_16x16x32_bf16 a[152:155], v[72:75], v[92:95], a[152:155]
    s_add_u32 s46, s46, 131072
    s_add_u32 s47, s47, 64
    s_add_u32 s53, s53, 1
    s_cmp_eq_u32 s53, 20
    s_cselect_b32 s46, 0, s46
    v_mfma_f32_16x16x32_bf16 a[156:159], v[76:79], v[92:95], a[156:159]
    s_add_u32 s43, s43, 1
    s_cmp_lt_u32 s43, 6
    s_cbranch_scc1 Lpg_142
    s_waitcnt vmcnt(0) lgkmcnt(0)
    s_barrier
    s_nop 3
    s_lshl_b32 s44, s40, 2
    s_add_u32 s44, s44, s42
    s_mul_i32 s44, s44, 160
    s_mul_i32 s45, s41, 327680
    s_add_u32 s44, s44, s45
    v_mul_u32_u24 v6, 2560, v2
    v_lshl_add_u32 v6, v3, 3, v6
    v_add_u32 v7, s44, v6
    s_mov_b32 s44, 0
    v_accvgpr_read_b32 v8, a0
    v_accvgpr_read_b32 v9, a1
    v_accvgpr_read_b32 v10, a2
    v_accvgpr_read_b32 v11, a3
    v_cvt_pk_bf16_f32 v12, v8, v9
    v_cvt_pk_bf16_f32 v13, v10, v11
    buffer_store_dwordx2 v[12:13], v7, s[20:23], s44 offen offset:0
    v_accvgpr_read_b32 v8, a4
    v_accvgpr_read_b32 v9, a5
    v_accvgpr_read_b32 v10, a6
    v_accvgpr_read_b32 v11, a7
    v_cvt_pk_bf16_f32 v14, v8, v9
    v_cvt_pk_bf16_f32 v15, v10, v11
    buffer_store_dwordx2 v[14:15], v7, s[20:23], s44 offen offset:32
    v_accvgpr_read_b32 v8, a8
    v_accvgpr_read_b32 v9, a9
    v_accvgpr_read_b32 v10, a10
    v_accvgpr_read_b32 v11, a11
    v_cvt_pk_bf16_f32 v16, v8, v9
    v_cvt_pk_bf16_f32 v17, v10, v11
    buffer_store_dwordx2 v[16:17], v7, s[20:23], s44 offen offset:64
    v_accvgpr_read_b32 v8, a12
    v_accvgpr_read_b32 v9, a13
    v_accvgpr_read_b32 v10, a14
    v_accvgpr_read_b32 v11, a15
    v_cvt_pk_bf16_f32 v18, v8, v9
    v_cvt_pk_bf16_f32 v19, v10, v11
    buffer_store_dwordx2 v[18:19], v7, s[20:23], s44 offen offset:96
    v_accvgpr_read_b32 v8, a16
    v_accvgpr_read_b32 v9, a17
    v_accvgpr_read_b32 v10, a18
    v_accvgpr_read_b32 v11, a19
    v_cvt_pk_bf16_f32 v12, v8, v9
    v_cvt_pk_bf16_f32 v13, v10, v11
    buffer_store_dwordx2 v[12:13], v7, s[20:23], s44 offen offset:128
    s_mov_b32 s44, 40960
    v_accvgpr_read_b32 v8, a20
    v_accvgpr_read_b32 v9, a21
    v_accvgpr_read_b32 v10, a22
    v_accvgpr_read_b32 v11, a23
    v_cvt_pk_bf16_f32 v14, v8, v9
    v_cvt_pk_bf16_f32 v15, v10, v11
    buffer_store_dwordx2 v[14:15], v7, s[20:23], s44 offen offset:0
    v_accvgpr_read_b32 v8, a24
    v_accvgpr_read_b32 v9, a25
    v_accvgpr_read_b32 v10, a26
    v_accvgpr_read_b32 v11, a27
    v_cvt_pk_bf16_f32 v16, v8, v9
    v_cvt_pk_bf16_f32 v17, v10, v11
    buffer_store_dwordx2 v[16:17], v7, s[20:23], s44 offen offset:32
    v_accvgpr_read_b32 v8, a28
    v_accvgpr_read_b32 v9, a29
    v_accvgpr_read_b32 v10, a30
    v_accvgpr_read_b32 v11, a31
    v_cvt_pk_bf16_f32 v18, v8, v9
    v_cvt_pk_bf16_f32 v19, v10, v11
    buffer_store_dwordx2 v[18:19], v7, s[20:23], s44 offen offset:64
    v_accvgpr_read_b32 v8, a32
    v_accvgpr_read_b32 v9, a33
    v_accvgpr_read_b32 v10, a34
    v_accvgpr_read_b32 v11, a35
    v_cvt_pk_bf16_f32 v12, v8, v9
    v_cvt_pk_bf16_f32 v13, v10, v11
    buffer_store_dwordx2 v[12:13], v7, s[20:23], s44 offen offset:96
    v_accvgpr_read_b32 v8, a36
    v_accvgpr_read_b32 v9, a37
    v_accvgpr_read_b32 v10, a38
    v_accvgpr_read_b32 v11, a39
    v_cvt_pk_bf16_f32 v14, v8, v9
    v_cvt_pk_bf16_f32 v15, v10, v11
    buffer_store_dwordx2 v[14:15], v7, s[20:23], s44 offen offset:128
    s_mov_b32 s44, 81920
    v_accvgpr_read_b32 v8, a40
    v_accvgpr_read_b32 v9, a41
    v_accvgpr_read_b32 v10, a42
    v_accvgpr_read_b32 v11, a43
    v_cvt_pk_bf16_f32 v16, v8, v9
    v_cvt_pk_bf16_f32 v17, v10, v11
    buffer_store_dwordx2 v[16:17], v7, s[20:23], s44 offen offset:0
    v_accvgpr_read_b32 v8, a44
    v_accvgpr_read_b32 v9, a45
    v_accvgpr_read_b32 v10, a46
    v_accvgpr_read_b32 v11, a47
    v_cvt_pk_bf16_f32 v18, v8, v9
    v_cvt_pk_bf16_f32 v19, v10, v11
    buffer_store_dwordx2 v[18:19], v7, s[20:23], s44 offen offset:32
    v_accvgpr_read_b32 v8, a48
    v_accvgpr_read_b32 v9, a49
    v_accvgpr_read_b32 v10, a50
    v_accvgpr_read_b32 v11, a51
    v_cvt_pk_bf16_f32 v12, v8, v9
    v_cvt_pk_bf16_f32 v13, v10, v11
    buffer_store_dwordx2 v[12:13], v7, s[20:23], s44 offen offset:64
    v_accvgpr_read_b32 v8, a52
    v_accvgpr_read_b32 v9, a53
    v_accvgpr_read_b32 v10, a54
    v_accvgpr_read_b32 v11, a55
    v_cvt_pk_bf16_f32 v14, v8, v9
    v_cvt_pk_bf16_f32 v15, v10, v11
    buffer_store_dwordx2 v[14:15], v7, s[20:23], s44 offen offset:96
    v_accvgpr_read_b32 v8, a56
    v_accvgpr_read_b32 v9, a57
    v_accvgpr_read_b32 v10, a58
    v_accvgpr_read_b32 v11, a59
    v_cvt_pk_bf16_f32 v16, v8, v9
    v_cvt_pk_bf16_f32 v17, v10, v11
    buffer_store_dwordx2 v[16:17], v7, s[20:23], s44 offen offset:128
    s_mov_b32 s44, 122880
    v_accvgpr_read_b32 v8, a60
    v_accvgpr_read_b32 v9, a61
    v_accvgpr_read_b32 v10, a62
    v_accvgpr_read_b32 v11, a63
    v_cvt_pk_bf16_f32 v18, v8, v9
    v_cvt_pk_bf16_f32 v19, v10, v11
    buffer_store_dwordx2 v[18:19], v7, s[20:23], s44 offen offset:0
    v_accvgpr_read_b32 v8, a64
    v_accvgpr_read_b32 v9, a65
    v_accvgpr_read_b32 v10, a66
    v_accvgpr_read_b32 v11, a67
    v_cvt_pk_bf16_f32 v12, v8, v9
    v_cvt_pk_bf16_f32 v13, v10, v11
    buffer_store_dwordx2 v[12:13], v7, s[20:23], s44 offen offset:32
    v_accvgpr_read_b32 v8, a68
    v_accvgpr_read_b32 v9, a69
    v_accvgpr_read_b32 v10, a70
    v_accvgpr_read_b32 v11, a71
    v_cvt_pk_bf16_f32 v14, v8, v9
    v_cvt_pk_bf16_f32 v15, v10, v11
    buffer_store_dwordx2 v[14:15], v7, s[20:23], s44 offen offset:64
    v_accvgpr_read_b32 v8, a72
    v_accvgpr_read_b32 v9, a73
    v_accvgpr_read_b32 v10, a74
    v_accvgpr_read_b32 v11, a75
    v_cvt_pk_bf16_f32 v16, v8, v9
    v_cvt_pk_bf16_f32 v17, v10, v11
    buffer_store_dwordx2 v[16:17], v7, s[20:23], s44 offen offset:96
    v_accvgpr_read_b32 v8, a76
    v_accvgpr_read_b32 v9, a77
    v_accvgpr_read_b32 v10, a78
    v_accvgpr_read_b32 v11, a79
    v_cvt_pk_bf16_f32 v18, v8, v9
    v_cvt_pk_bf16_f32 v19, v10, v11
    buffer_store_dwordx2 v[18:19], v7, s[20:23], s44 offen offset:128
    s_mov_b32 s44, 163840
    v_accvgpr_read_b32 v8, a80
    v_accvgpr_read_b32 v9, a81
    v_accvgpr_read_b32 v10, a82
    v_accvgpr_read_b32 v11, a83
    v_cvt_pk_bf16_f32 v12, v8, v9
    v_cvt_pk_bf16_f32 v13, v10, v11
    buffer_store_dwordx2 v[12:13], v7, s[20:23], s44 offen offset:0
    v_accvgpr_read_b32 v8, a84
    v_accvgpr_read_b32 v9, a85
    v_accvgpr_read_b32 v10, a86
    v_accvgpr_read_b32 v11, a87
    v_cvt_pk_bf16_f32 v14, v8, v9
    v_cvt_pk_bf16_f32 v15, v10, v11
    buffer_store_dwordx2 v[14:15], v7, s[20:23], s44 offen offset:32
    v_accvgpr_read_b32 v8, a88
    v_accvgpr_read_b32 v9, a89
    v_accvgpr_read_b32 v10, a90
    v_accvgpr_read_b32 v11, a91
    v_cvt_pk_bf16_f32 v16, v8, v9
    v_cvt_pk_bf16_f32 v17, v10, v11
    buffer_store_dwordx2 v[16:17], v7, s[20:23], s44 offen offset:64
    v_accvgpr_read_b32 v8, a92
    v_accvgpr_read_b32 v9, a93
    v_accvgpr_read_b32 v10, a94
    v_accvgpr_read_b32 v11, a95
    v_cvt_pk_bf16_f32 v18, v8, v9
    v_cvt_pk_bf16_f32 v19, v10, v11
    buffer_store_dwordx2 v[18:19], v7, s[20:23], s44 offen offset:96
    v_accvgpr_read_b32 v8, a96
    v_accvgpr_read_b32 v9, a97
    v_accvgpr_read_b32 v10, a98
    v_accvgpr_read_b32 v11, a99
    v_cvt_pk_bf16_f32 v12, v8, v9
    v_cvt_pk_bf16_f32 v13, v10, v11
    buffer_store_dwordx2 v[12:13], v7, s[20:23], s44 offen offset:128
    s_mov_b32 s44, 204800
    v_accvgpr_read_b32 v8, a100
    v_accvgpr_read_b32 v9, a101
    v_accvgpr_read_b32 v10, a102
    v_accvgpr_read_b32 v11, a103
    v_cvt_pk_bf16_f32 v14, v8, v9
    v_cvt_pk_bf16_f32 v15, v10, v11
    buffer_store_dwordx2 v[14:15], v7, s[20:23], s44 offen offset:0
    v_accvgpr_read_b32 v8, a104
    v_accvgpr_read_b32 v9, a105
    v_accvgpr_read_b32 v10, a106
    v_accvgpr_read_b32 v11, a107
    v_cvt_pk_bf16_f32 v16, v8, v9
    v_cvt_pk_bf16_f32 v17, v10, v11
    buffer_store_dwordx2 v[16:17], v7, s[20:23], s44 offen offset:32
    v_accvgpr_read_b32 v8, a108
    v_accvgpr_read_b32 v9, a109
    v_accvgpr_read_b32 v10, a110
    v_accvgpr_read_b32 v11, a111
    v_cvt_pk_bf16_f32 v18, v8, v9
    v_cvt_pk_bf16_f32 v19, v10, v11
    buffer_store_dwordx2 v[18:19], v7, s[20:23], s44 offen offset:64
    v_accvgpr_read_b32 v8, a112
    v_accvgpr_read_b32 v9, a113
    v_accvgpr_read_b32 v10, a114
    v_accvgpr_read_b32 v11, a115
    v_cvt_pk_bf16_f32 v12, v8, v9
    v_cvt_pk_bf16_f32 v13, v10, v11
    buffer_store_dwordx2 v[12:13], v7, s[20:23], s44 offen offset:96
    v_accvgpr_read_b32 v8, a116
    v_accvgpr_read_b32 v9, a117
    v_accvgpr_read_b32 v10, a118
    v_accvgpr_read_b32 v11, a119
    v_cvt_pk_bf16_f32 v14, v8, v9
    v_cvt_pk_bf16_f32 v15, v10, v11
    buffer_store_dwordx2 v[14:15], v7, s[20:23], s44 offen offset:128
    s_mov_b32 s44, 245760
    v_accvgpr_read_b32 v8, a120
    v_accvgpr_read_b32 v9, a121
    v_accvgpr_read_b32 v10, a122
    v_accvgpr_read_b32 v11, a123
    v_cvt_pk_bf16_f32 v16, v8, v9
    v_cvt_pk_bf16_f32 v17, v10, v11
    buffer_store_dwordx2 v[16:17], v7, s[20:23], s44 offen offset:0
    v_accvgpr_read_b32 v8, a124
    v_accvgpr_read_b32 v9, a125
    v_accvgpr_read_b32 v10, a126
    v_accvgpr_read_b32 v11, a127
    v_cvt_pk_bf16_f32 v18, v8, v9
    v_cvt_pk_bf16_f32 v19, v10, v11
    buffer_store_dwordx2 v[18:19], v7, s[20:23], s44 offen offset:32
    v_accvgpr_read_b32 v8, a128
    v_accvgpr_read_b32 v9, a129
    v_accvgpr_read_b32 v10, a130
    v_accvgpr_read_b32 v11, a131
    v_cvt_pk_bf16_f32 v12, v8, v9
    v_cvt_pk_bf16_f32 v13, v10, v11
    buffer_store_dwordx2 v[12:13], v7, s[20:23], s44 offen offset:64
    v_accvgpr_read_b32 v8, a132
    v_accvgpr_read_b32 v9, a133
    v_accvgpr_read_b32 v10, a134
    v_accvgpr_read_b32 v11, a135
    v_cvt_pk_bf16_f32 v14, v8, v9
    v_cvt_pk_bf16_f32 v15, v10, v11
    buffer_store_dwordx2 v[14:15], v7, s[20:23], s44 offen offset:96
    v_accvgpr_read_b32 v8, a136
    v_accvgpr_read_b32 v9, a137
    v_accvgpr_read_b32 v10, a138
    v_accvgpr_read_b32 v11, a139
    v_cvt_pk_bf16_f32 v16, v8, v9
    v_cvt_pk_bf16_f32 v17, v10, v11
    buffer_store_dwordx2 v[16:17], v7, s[20:23], s44 offen offset:128
    s_mov_b32 s44, 286720
    v_accvgpr_read_b32 v8, a140
    v_accvgpr_read_b32 v9, a141
    v_accvgpr_read_b32 v10, a142
    v_accvgpr_read_b32 v11, a143
    v_cvt_pk_bf16_f32 v18, v8, v9
    v_cvt_pk_bf16_f32 v19, v10, v11
    buffer_store_dwordx2 v[18:19], v7, s[20:23], s44 offen offset:0
    v_accvgpr_read_b32 v8, a144
    v_accvgpr_read_b32 v9, a145
    v_accvgpr_read_b32 v10, a146
    v_accvgpr_read_b32 v11, a147
    v_cvt_pk_bf16_f32 v12, v8, v9
    v_cvt_pk_bf16_f32 v13, v10, v11
    buffer_store_dwordx2 v[12:13], v7, s[20:23], s44 offen offset:32
    v_accvgpr_read_b32 v8, a148
    v_accvgpr_read_b32 v9, a149
    v_accvgpr_read_b32 v10, a150
    v_accvgpr_read_b32 v11, a151
    v_cvt_pk_bf16_f32 v14, v8, v9
    v_cvt_pk_bf16_f32 v15, v10, v11
    buffer_store_dwordx2 v[14:15], v7, s[20:23], s44 offen offset:64
    v_accvgpr_read_b32 v8, a152
    v_accvgpr_read_b32 v9, a153
    v_accvgpr_read_b32 v10, a154
    v_accvgpr_read_b32 v11, a155
    v_cvt_pk_bf16_f32 v16, v8, v9
    v_cvt_pk_bf16_f32 v17, v10, v11
    buffer_store_dwordx2 v[16:17], v7, s[20:23], s44 offen offset:96
    v_accvgpr_read_b32 v8, a156
    v_accvgpr_read_b32 v9, a157
    v_accvgpr_read_b32 v10, a158
    v_accvgpr_read_b32 v11, a159
    v_cvt_pk_bf16_f32 v18, v8, v9
    v_cvt_pk_bf16_f32 v19, v10, v11
    buffer_store_dwordx2 v[18:19], v7, s[20:23], s44 offen offset:128
    s_barrier
Lcs_138:
    s_cmp_lt_u32 s71, 3
    s_cbranch_scc1 Lcg_144
    s_branch Lcs_143
Lcg_144:
    s_mov_b32 s73, s71
Lq_145:
    s_mov_b32 s40, s73
    s_mov_b32 s41, s72
    s_mov_b32 s8, s24
    s_and_b32 s9, s25, 0xffff
    s_mov_b32 s10, 0x280000
    s_mov_b32 s11, 0x00020000
    s_mov_b32 s12, s28
    s_and_b32 s13, s29, 0xffff
    s_mov_b32 s14, 0x500000
    s_mov_b32 s15, 0x00020000
    s_and_b32 s44, s42, 1
    s_lshl_b32 s44, s44, 2
    v_or_b32 v6, s44, v3
    v_lshrrev_b32 v7, 1, v2
    v_xor_b32 v7, v7, v6
    v_and_b32 v8, 1, v2
    v_lshl_add_u32 v7, v7, 1, v8
    v_lshlrev_b32 v7, 4, v7
    v_mul_u32_u24 v8, 8192, v3
    v_add_u32 v7, v7, v8
    s_mul_i32 s44, s42, 65536
    s_lshl_b32 s45, s41, 8
    s_add_u32 s44, s44, s45
    v_add_u32 v9, s44, v7
    v_lshrrev_b32 v6, 2, v1
    v_mul_u32_u24 v6, 1280, v6
    v_and_b32 v7, 3, v1
    v_xor_b32 v7, v7, v3
    v_lshl_add_u32 v6, v7, 4, v6
    s_lshl_b32 s44, s40, 2
    s_add_u32 s44, s44, s42
    s_mul_i32 s44, s44, 163840
    v_add_u32 v10, s44, v6
    v_lshrrev_b32 v6, 2, v2
    v_and_b32 v7, 1, v3
    v_lshl_or_b32 v7, v7, 2, v6
    v_lshl_add_u32 v6, v3, 3, v6
    v_lshlrev_b32 v6, 8, v6
    v_and_b32 v8, 3, v2
    v_lshl_add_u32 v6, v8, 3, v6
    v_xor_b32 v8, 0, v7
    v_lshl_add_u32 v12, v8, 5, v6
    v_add_u32 v20, 0x10000, v12
    v_add_u32 v28, 0x20000, v12
    v_xor_b32 v8, 1, v7
    v_lshl_add_u32 v13, v8, 5, v6
    v_add_u32 v21, 0x10000, v13
    v_add_u32 v29, 0x20000, v13
    v_xor_b32 v8, 2, v7
    v_lshl_add_u32 v14, v8, 5, v6
    v_add_u32 v22, 0x10000, v14
    v_add_u32 v30, 0x20000, v14
    v_xor_b32 v8, 3, v7
    v_lshl_add_u32 v15, v8, 5, v6
    v_add_u32 v23, 0x10000, v15
    v_add_u32 v31, 0x20000, v15
    v_xor_b32 v8, 4, v7
    v_lshl_add_u32 v16, v8, 5, v6
    v_add_u32 v24, 0x10000, v16
    v_add_u32 v32, 0x20000, v16
    v_xor_b32 v8, 5, v7
    v_lshl_add_u32 v17, v8, 5, v6
    v_add_u32 v25, 0x10000, v17
    v_add_u32 v33, 0x20000, v17
    v_xor_b32 v8, 6, v7
    v_lshl_add_u32 v18, v8, 5, v6
    v_add_u32 v26, 0x10000, v18
    v_add_u32 v34, 0x20000, v18
    v_xor_b32 v8, 7, v7
    v_lshl_add_u32 v19, v8, 5, v6
    v_add_u32 v27, 0x10000, v19
    v_add_u32 v35, 0x20000, v19
    v_lshrrev_b32 v6, 2, v2
    v_xor_b32 v6, v6, v3
    v_lshlrev_b32 v6, 4, v6
    v_lshl_add_u32 v6, v2, 6, v6
    s_mul_i32 s44, s42, 8192
    s_add_u32 s44, s44, 8192
    v_add_u32 v36, s44, v6
    v_add_u32 v37, 0x10000, v36
    v_add_u32 v38, 0x20000, v36
    s_lshl_b32 s50, s42, 11
    s_mov_b32 s51, s44
    s_mov_b32 s46, 0
    s_mov_b32 s47, 0x0
    s_mov_b32 s53, 0
    s_add_u32 m0, s50, 0
    s_add_u32 s52, s46, 0x0
    buffer_load_dwordx4 v9, s[12:15], s52 offen lds
    s_add_u32 m0, s50, 1024
    s_add_u32 s52, s46, 0x8000
    buffer_load_dwordx4 v9, s[12:15], s52 offen lds
    s_add_u32 m0, s51, 0
    s_add_u32 s52, s47, 0
    buffer_load_dwordx4 v10, s[8:11], s52 offen lds
    s_add_u32 m0, s51, 1024
    s_add_u32 s52, s47, 20480
    buffer_load_dwordx4 v10, s[8:11], s52 offen lds
    s_add_u32 m0, s51, 2048
    s_add_u32 s52, s47, 40960
    buffer_load_dwordx4 v10, s[8:11], s52 offen lds
    s_add_u32 m0, s51, 3072
    s_add_u32 s52, s47, 61440
    buffer_load_dwordx4 v10, s[8:11], s52 offen lds
    s_add_u32 m0, s51, 4096
    s_add_u32 s52, s47, 81920
    buffer_load_dwordx4 v10, s[8:11], s52 offen lds
    s_add_u32 m0, s51, 5120
    s_add_u32 s52, s47, 102400
    buffer_load_dwordx4 v10, s[8:11], s52 offen lds
    s_add_u32 m0, s51, 6144
    s_add_u32 s52, s47, 122880
    buffer_load_dwordx4 v10, s[8:11], s52 offen lds
    s_add_u32 m0, s51, 7168
    s_add_u32 s52, s47, 143360
    buffer_load_dwordx4 v10, s[8:11], s52 offen lds
    s_add_u32 s46, s46, 262144
    s_add_u32 s47, s47, 64
    s_add_u32 m0, s50, 40960
    s_add_u32 s52, s46, 0x0
    buffer_load_dwordx4 v9, s[12:15], s52 offen lds
    s_add_u32 m0, s50, 41984
    s_add_u32 s52, s46, 0x8000
    buffer_load_dwordx4 v9, s[12:15], s52 offen lds
    s_add_u32 m0, s51, 40960
    s_add_u32 s52, s47, 0
    buffer_load_dwordx4 v10, s[8:11], s52 offen lds
    s_add_u32 m0, s51, 41984
    s_add_u32 s52, s47, 20480
    buffer_load_dwordx4 v10, s[8:11], s52 offen lds
    s_add_u32 m0, s51, 43008
    s_add_u32 s52, s47, 40960
    buffer_load_dwordx4 v10, s[8:11], s52 offen lds
    s_add_u32 m0, s51, 44032
    s_add_u32 s52, s47, 61440
    buffer_load_dwordx4 v10, s[8:11], s52 offen lds
    s_add_u32 m0, s51, 45056
    s_add_u32 s52, s47, 81920
    buffer_load_dwordx4 v10, s[8:11], s52 offen lds
    s_add_u32 m0, s51, 46080
    s_add_u32 s52, s47, 102400
    buffer_load_dwordx4 v10, s[8:11], s52 offen lds
    s_add_u32 m0, s51, 47104
    s_add_u32 s52, s47, 122880
    buffer_load_dwordx4 v10, s[8:11], s52 offen lds
    s_add_u32 m0, s51, 48128
    s_add_u32 s52, s47, 143360
    buffer_load_dwordx4 v10, s[8:11], s52 offen lds
    s_add_u32 s46, s46, 262144
    s_add_u32 s47, s47, 64
    s_add_u32 m0, s50, 81920
    s_add_u32 s52, s46, 0x0
    buffer_load_dwordx4 v9, s[12:15], s52 offen lds
    s_add_u32 m0, s50, 82944
    s_add_u32 s52, s46, 0x8000
    buffer_load_dwordx4 v9, s[12:15], s52 offen lds
    s_add_u32 m0, s51, 81920
    s_add_u32 s52, s47, 0
    buffer_load_dwordx4 v10, s[8:11], s52 offen lds
    s_add_u32 m0, s51, 82944
    s_add_u32 s52, s47, 20480
    buffer_load_dwordx4 v10, s[8:11], s52 offen lds
    s_add_u32 m0, s51, 83968
    s_add_u32 s52, s47, 40960
    buffer_load_dwordx4 v10, s[8:11], s52 offen lds
    s_add_u32 m0, s51, 84992
    s_add_u32 s52, s47, 61440
    buffer_load_dwordx4 v10, s[8:11], s52 offen lds
    s_add_u32 m0, s51, 86016
    s_add_u32 s52, s47, 81920
    buffer_load_dwordx4 v10, s[8:11], s52 offen lds
    s_add_u32 m0, s51, 87040
    s_add_u32 s52, s47, 102400
    buffer_load_dwordx4 v10, s[8:11], s52 offen lds
    s_add_u32 m0, s51, 88064
    s_add_u32 s52, s47, 122880
    buffer_load_dwordx4 v10, s[8:11], s52 offen lds
    s_add_u32 m0, s51, 89088
    s_add_u32 s52, s47, 143360
    buffer_load_dwordx4 v10, s[8:11], s52 offen lds
    s_add_u32 s46, s46, 262144
    s_add_u32 s47, s47, 64
    v_accvgpr_write_b32 a0, 0
    v_accvgpr_write_b32 a1, 0
    v_accvgpr_write_b32 a2, 0
    v_accvgpr_write_b32 a3, 0
    v_accvgpr_write_b32 a4, 0
    v_accvgpr_write_b32 a5, 0
    v_accvgpr_write_b32 a6, 0
    v_accvgpr_write_b32 a7, 0
    v_accvgpr_write_b32 a8, 0
    v_accvgpr_write_b32 a9, 0
    v_accvgpr_write_b32 a10, 0
    v_accvgpr_write_b32 a11, 0
    v_accvgpr_write_b32 a12, 0
    v_accvgpr_write_b32 a13, 0
    v_accvgpr_write_b32 a14, 0
    v_accvgpr_write_b32 a15, 0
    v_accvgpr_write_b32 a16, 0
    v_accvgpr_write_b32 a17, 0
    v_accvgpr_write_b32 a18, 0
    v_accvgpr_write_b32 a19, 0
    v_accvgpr_write_b32 a20, 0
    v_accvgpr_write_b32 a21, 0
    v_accvgpr_write_b32 a22, 0
    v_accvgpr_write_b32 a23, 0
    v_accvgpr_write_b32 a24, 0
    v_accvgpr_write_b32 a25, 0
    v_accvgpr_write_b32 a26, 0
    v_accvgpr_write_b32 a27, 0
    v_accvgpr_write_b32 a28, 0
    v_accvgpr_write_b32 a29, 0
    v_accvgpr_write_b32 a30, 0
    v_accvgpr_write_b32 a31, 0
    v_accvgpr_write_b32 a32, 0
    v_accvgpr_write_b32 a33, 0
    v_accvgpr_write_b32 a34, 0
    v_accvgpr_write_b32 a35, 0
    v_accvgpr_write_b32 a36, 0
    v_accvgpr_write_b32 a37, 0
    v_accvgpr_write_b32 a38, 0
    v_accvgpr_write_b32 a39, 0
    v_accvgpr_write_b32 a40, 0
    v_accvgpr_write_b32 a41, 0
    v_accvgpr_write_b32 a42, 0
    v_accvgpr_write_b32 a43, 0
    v_accvgpr_write_b32 a44, 0
    v_accvgpr_write_b32 a45, 0
    v_accvgpr_write_b32 a46, 0
    v_accvgpr_write_b32 a47, 0
    v_accvgpr_write_b32 a48, 0
    v_accvgpr_write_b32 a49, 0
    v_accvgpr_write_b32 a50, 0
    v_accvgpr_write_b32 a51, 0
    v_accvgpr_write_b32 a52, 0
    v_accvgpr_write_b32 a53, 0
    v_accvgpr_write_b32 a54, 0
    v_accvgpr_write_b32 a55, 0
    v_accvgpr_write_b32 a56, 0
    v_accvgpr_write_b32 a57, 0
    v_accvgpr_write_b32 a58, 0
    v_accvgpr_write_b32 a59, 0
    v_accvgpr_write_b32 a60, 0
    v_accvgpr_write_b32 a61, 0
    v_accvgpr_write_b32 a62, 0
    v_accvgpr_write_b32 a63, 0
    v_accvgpr_write_b32 a64, 0
    v_accvgpr_write_b32 a65, 0
    v_accvgpr_write_b32 a66, 0
    v_accvgpr_write_b32 a67, 0
    v_accvgpr_write_b32 a68, 0
    v_accvgpr_write_b32 a69, 0
    v_accvgpr_write_b32 a70, 0
    v_accvgpr_write_b32 a71, 0
    v_accvgpr_write_b32 a72, 0
    v_accvgpr_write_b32 a73, 0
    v_accvgpr_write_b32 a74, 0
    v_accvgpr_write_b32 a75, 0
    v_accvgpr_write_b32 a76, 0
    v_accvgpr_write_b32 a77, 0
    v_accvgpr_write_b32 a78, 0
    v_accvgpr_write_b32 a79, 0
    v_accvgpr_write_b32 a80, 0
    v_accvgpr_write_b32 a81, 0
    v_accvgpr_write_b32 a82, 0
    v_accvgpr_write_b32 a83, 0
    v_accvgpr_write_b32 a84, 0
    v_accvgpr_write_b32 a85, 0
    v_accvgpr_write_b32 a86, 0
    v_accvgpr_write_b32 a87, 0
    v_accvgpr_write_b32 a88, 0
    v_accvgpr_write_b32 a89, 0
    v_accvgpr_write_b32 a90, 0
    v_accvgpr_write_b32 a91, 0
    v_accvgpr_write_b32 a92, 0
    v_accvgpr_write_b32 a93, 0
    v_accvgpr_write_b32 a94, 0
    v_accvgpr_write_b32 a95, 0
    v_accvgpr_write_b32 a96, 0
    v_accvgpr_write_b32 a97, 0
    v_accvgpr_write_b32 a98, 0
    v_accvgpr_write_b32 a99, 0
    v_accvgpr_write_b32 a100, 0
    v_accvgpr_write_b32 a101, 0
    v_accvgpr_write_b32 a102, 0
    v_accvgpr_write_b32 a103, 0
    v_accvgpr_write_b32 a104, 0
    v_accvgpr_write_b32 a105, 0
    v_accvgpr_write_b32 a106, 0
    v_accvgpr_write_b32 a107, 0
    v_accvgpr_write_b32 a108, 0
    v_accvgpr_write_b32 a109, 0
    v_accvgpr_write_b32 a110, 0
    v_accvgpr_write_b32 a111, 0
    v_accvgpr_write_b32 a112, 0
    v_accvgpr_write_b32 a113, 0
    v_accvgpr_write_b32 a114, 0
    v_accvgpr_write_b32 a115, 0
    v_accvgpr_write_b32 a116, 0
    v_accvgpr_write_b32 a117, 0
    v_accvgpr_write_b32 a118, 0
    v_accvgpr_write_b32 a119, 0
    v_accvgpr_write_b32 a120, 0
    v_accvgpr_write_b32 a121, 0
    v_accvgpr_write_b32 a122, 0
    v_accvgpr_write_b32 a123, 0
    v_accvgpr_write_b32 a124, 0
    v_accvgpr_write_b32 a125, 0
    v_accvgpr_write_b32 a126, 0
    v_accvgpr_write_b32 a127, 0
    v_accvgpr_write_b32 a128, 0
    v_accvgpr_write_b32 a129, 0
    v_accvgpr_write_b32 a130, 0
    v_accvgpr_write_b32 a131, 0
    v_accvgpr_write_b32 a132, 0
    v_accvgpr_write_b32 a133, 0
    v_accvgpr_write_b32 a134, 0
    v_accvgpr_write_b32 a135, 0
    v_accvgpr_write_b32 a136, 0
    v_accvgpr_write_b32 a137, 0
    v_accvgpr_write_b32 a138, 0
    v_accvgpr_write_b32 a139, 0
    v_accvgpr_write_b32 a140, 0
    v_accvgpr_write_b32 a141, 0
    v_accvgpr_write_b32 a142, 0
    v_accvgpr_write_b32 a143, 0
    v_accvgpr_write_b32 a144, 0
    v_accvgpr_write_b32 a145, 0
    v_accvgpr_write_b32 a146, 0
    v_accvgpr_write_b32 a147, 0
    v_accvgpr_write_b32 a148, 0
    v_accvgpr_write_b32 a149, 0
    v_accvgpr_write_b32 a150, 0
    v_accvgpr_write_b32 a151, 0
    v_accvgpr_write_b32 a152, 0
    v_accvgpr_write_b32 a153, 0
    v_accvgpr_write_b32 a154, 0
    v_accvgpr_write_b32 a155, 0
    v_accvgpr_write_b32 a156, 0
    v_accvgpr_write_b32 a157, 0
    v_accvgpr_write_b32 a158, 0
    v_accvgpr_write_b32 a159, 0
    v_accvgpr_write_b32 a160, 0
    v_accvgpr_write_b32 a161, 0
    v_accvgpr_write_b32 a162, 0
    v_accvgpr_write_b32 a163, 0
    v_accvgpr_write_b32 a164, 0
    v_accvgpr_write_b32 a165, 0
    v_accvgpr_write_b32 a166, 0
    v_accvgpr_write_b32 a167, 0
    v_accvgpr_write_b32 a168, 0
    v_accvgpr_write_b32 a169, 0
    v_accvgpr_write_b32 a170, 0
    v_accvgpr_write_b32 a171, 0
    v_accvgpr_write_b32 a172, 0
    v_accvgpr_write_b32 a173, 0
    v_accvgpr_write_b32 a174, 0
    v_accvgpr_write_b32 a175, 0
    v_accvgpr_write_b32 a176, 0
    v_accvgpr_write_b32 a177, 0
    v_accvgpr_write_b32 a178, 0
    v_accvgpr_write_b32 a179, 0
    v_accvgpr_write_b32 a180, 0
    v_accvgpr_write_b32 a181, 0
    v_accvgpr_write_b32 a182, 0
    v_accvgpr_write_b32 a183, 0
    v_accvgpr_write_b32 a184, 0
    v_accvgpr_write_b32 a185, 0
    v_accvgpr_write_b32 a186, 0
    v_accvgpr_write_b32 a187, 0
    v_accvgpr_write_b32 a188, 0
    v_accvgpr_write_b32 a189, 0
    v_accvgpr_write_b32 a190, 0
    v_accvgpr_write_b32 a191, 0
    v_accvgpr_write_b32 a192, 0
    v_accvgpr_write_b32 a193, 0
    v_accvgpr_write_b32 a194, 0
    v_accvgpr_write_b32 a195, 0
    v_accvgpr_write_b32 a196, 0
    v_accvgpr_write_b32 a197, 0
    v_accvgpr_write_b32 a198, 0
    v_accvgpr_write_b32 a199, 0
    v_accvgpr_write_b32 a200, 0
    v_accvgpr_write_b32 a201, 0
    v_accvgpr_write_b32 a202, 0
    v_accvgpr_write_b32 a203, 0
    v_accvgpr_write_b32 a204, 0
    v_accvgpr_write_b32 a205, 0
    v_accvgpr_write_b32 a206, 0
    v_accvgpr_write_b32 a207, 0
    v_accvgpr_write_b32 a208, 0
    v_accvgpr_write_b32 a209, 0
    v_accvgpr_write_b32 a210, 0
    v_accvgpr_write_b32 a211, 0
    v_accvgpr_write_b32 a212, 0
    v_accvgpr_write_b32 a213, 0
    v_accvgpr_write_b32 a214, 0
    v_accvgpr_write_b32 a215, 0
    v_accvgpr_write_b32 a216, 0
    v_accvgpr_write_b32 a217, 0
    v_accvgpr_write_b32 a218, 0
    v_accvgpr_write_b32 a219, 0
    v_accvgpr_write_b32 a220, 0
    v_accvgpr_write_b32 a221, 0
    v_accvgpr_write_b32 a222, 0
    v_accvgpr_write_b32 a223, 0
    v_accvgpr_write_b32 a224, 0
    v_accvgpr_write_b32 a225, 0
    v_accvgpr_write_b32 a226, 0
    v_accvgpr_write_b32 a227, 0
    v_accvgpr_write_b32 a228, 0
    v_accvgpr_write_b32 a229, 0
    v_accvgpr_write_b32 a230, 0
    v_accvgpr_write_b32 a231, 0
    v_accvgpr_write_b32 a232, 0
    v_accvgpr_write_b32 a233, 0
    v_accvgpr_write_b32 a234, 0
    v_accvgpr_write_b32 a235, 0
    v_accvgpr_write_b32 a236, 0
    v_accvgpr_write_b32 a237, 0
    v_accvgpr_write_b32 a238, 0
    v_accvgpr_write_b32 a239, 0
    v_accvgpr_write_b32 a240, 0
    v_accvgpr_write_b32 a241, 0
    v_accvgpr_write_b32 a242, 0
    v_accvgpr_write_b32 a243, 0
    v_accvgpr_write_b32 a244, 0
    v_accvgpr_write_b32 a245, 0
    v_accvgpr_write_b32 a246, 0
    v_accvgpr_write_b32 a247, 0
    v_accvgpr_write_b32 a248, 0
    v_accvgpr_write_b32 a249, 0
    v_accvgpr_write_b32 a250, 0
    v_accvgpr_write_b32 a251, 0
    v_accvgpr_write_b32 a252, 0
    v_accvgpr_write_b32 a253, 0
    v_accvgpr_write_b32 a254, 0
    v_accvgpr_write_b32 a255, 0
    s_waitcnt vmcnt(20)
    s_barrier
    ds_read_b128 v[40:43], v36 offset:0
    ds_read_b128 v[44:47], v36 offset:1024
    ds_read_b128 v[48:51], v36 offset:2048
    ds_read_b128 v[52:55], v36 offset:3072
    ds_read_b128 v[56:59], v36 offset:4096
    ds_read_b128 v[60:63], v36 offset:5120
    ds_read_b128 v[64:67], v36 offset:6144
    ds_read_b128 v[68:71], v36 offset:7168
    ds_read_b64_tr_b16 v[104:105], v12 offset:0
    ds_read_b64_tr_b16 v[106:107], v12 offset:1024
    ds_read_b64_tr_b16 v[108:109], v13 offset:0
    ds_read_b64_tr_b16 v[110:111], v13 offset:1024
    s_mov_b32 s43, 0
Lpg_146:
    ds_read_b64_tr_b16 v[112:113], v14 offset:0
    ds_read_b64_tr_b16 v[114:115], v14 offset:1024
    s_waitcnt lgkmcnt(6)
    s_waitcnt lgkmcnt(4)
    v_mfma_f32_16x16x32_bf16 a[0:3], v[104:107], v[40:43], a[0:3]
    v_mfma_f32_16x16x32_bf16 a[4:7], v[104:107], v[44:47], a[4:7]
    v_mfma_f32_16x16x32_bf16 a[8:11], v[104:107], v[48:51], a[8:11]
    v_mfma_f32_16x16x32_bf16 a[12:15], v[104:107], v[52:55], a[12:15]
    v_mfma_f32_16x16x32_bf16 a[16:19], v[104:107], v[56:59], a[16:19]
    v_mfma_f32_16x16x32_bf16 a[20:23], v[104:107], v[60:63], a[20:23]
    v_mfma_f32_16x16x32_bf16 a[24:27], v[104:107], v[64:67], a[24:27]
    v_mfma_f32_16x16x32_bf16 a[28:31], v[104:107], v[68:71], a[28:31]
    ds_read_b64_tr_b16 v[116:117], v15 offset:0
    ds_read_b64_tr_b16 v[118:119], v15 offset:1024
    s_waitcnt lgkmcnt(4)
    v_mfma_f32_16x16x32_bf16 a[32:35], v[108:111], v[40:43], a[32:35]
    v_mfma_f32_16x16x32_bf16 a[36:39], v[108:111], v[44:47], a[36:39]
    v_mfma_f32_16x16x32_bf16 a[40:43], v[108:111], v[48:51], a[40:43]
    v_mfma_f32_16x16x32_bf16 a[44:47], v[108:111], v[52:55], a[44:47]
    v_mfma_f32_16x16x32_bf16 a[48:51], v[108:111], v[56:59], a[48:51]
    v_mfma_f32_16x16x32_bf16 a[52:55], v[108:111], v[60:63], a[52:55]
    v_mfma_f32_16x16x32_bf16 a[56:59], v[108:111], v[64:67], a[56:59]
    v_mfma_f32_16x16x32_bf16 a[60:63], v[108:111], v[68:71], a[60:63]
    ds_read_b64_tr_b16 v[104:105], v16 offset:0
    ds_read_b64_tr_b16 v[106:107], v16 offset:1024
    s_waitcnt lgkmcnt(4)
    v_mfma_f32_16x16x32_bf16 a[64:67], v[112:115], v[40:43], a[64:67]
    v_mfma_f32_16x16x32_bf16 a[68:71], v[112:115], v[44:47], a[68:71]
    v_mfma_f32_16x16x32_bf16 a[72:75], v[112:115], v[48:51], a[72:75]
    v_mfma_f32_16x16x32_bf16 a[76:79], v[112:115], v[52:55], a[76:79]
    v_mfma_f32_16x16x32_bf16 a[80:83], v[112:115], v[56:59], a[80:83]
    v_mfma_f32_16x16x32_bf16 a[84:87], v[112:115], v[60:63], a[84:87]
    v_mfma_f32_16x16x32_bf16 a[88:91], v[112:115], v[64:67], a[88:91]
    v_mfma_f32_16x16x32_bf16 a[92:95], v[112:115], v[68:71], a[92:95]
    ds_read_b64_tr_b16 v[108:109], v17 offset:0
    ds_read_b64_tr_b16 v[110:111], v17 offset:1024
    s_waitcnt lgkmcnt(4)
    v_mfma_f32_16x16x32_bf16 a[96:99], v[116:119], v[40:43], a[96:99]
    v_mfma_f32_16x16x32_bf16 a[100:103], v[116:119], v[44:47], a[100:103]
    v_mfma_f32_16x16x32_bf16 a[104:107], v[116:119], v[48:51], a[104:107]
    v_mfma_f32_16x16x32_bf16 a[108:111], v[116:119], v[52:55], a[108:111]
    v_mfma_f32_16x16x32_bf16 a[112:115], v[116:119], v[56:59], a[112:115]
    v_mfma_f32_16x16x32_bf16 a[116:119], v[116:119], v[60:63], a[116:119]
    v_mfma_f32_16x16x32_bf16 a[120:123], v[116:119], v[64:67], a[120:123]
    v_mfma_f32_16x16x32_bf16 a[124:127], v[116:119], v[68:71], a[124:127]
    s_waitcnt vmcnt(10)
    s_barrier
    ds_read_b64_tr_b16 v[112:113], v18 offset:0
    ds_read_b64_tr_b16 v[114:115], v18 offset:1024
    s_waitcnt lgkmcnt(4)
    v_mfma_f32_16x16x32_bf16 a[128:131], v[104:107], v[40:43], a[128:131]
    v_mfma_f32_16x16x32_bf16 a[132:135], v[104:107], v[44:47], a[132:135]
    s_add_u32 m0, s50, 122880
    s_add_u32 s52, s46, 0x0
    buffer_load_dwordx4 v9, s[12:15], s52 offen lds
    v_mfma_f32_16x16x32_bf16 a[136:139], v[104:107], v[48:51], a[136:139]
    v_mfma_f32_16x16x32_bf16 a[140:143], v[104:107], v[52:55], a[140:143]
    s_add_u32 m0, s50, 123904
    s_add_u32 s52, s46, 0x8000
    buffer_load_dwordx4 v9, s[12:15], s52 offen lds
    v_mfma_f32_16x16x32_bf16 a[144:147], v[104:107], v[56:59], a[144:147]
    v_mfma_f32_16x16x32_bf16 a[148:151], v[104:107], v[60:63], a[148:151]
    s_add_u32 m0, s51, 122880
    s_add_u32 s52, s47, 0
    buffer_load_dwordx4 v10, s[8:11], s52 offen lds
    v_mfma_f32_16x16x32_bf16 a[152:155], v[104:107], v[64:67], a[152:155]
    v_mfma_f32_16x16x32_bf16 a[156:159], v[104:107], v[68:71], a[156:159]
    s_add_u32 m0, s51, 123904
    s_add_u32 s52, s47, 20480
    buffer_load_dwordx4 v10, s[8:11], s52 offen lds
    ds_read_b64_tr_b16 v[116:117], v19 offset:0
    ds_read_b64_tr_b16 v[118:119], v19 offset:1024
    s_waitcnt lgkmcnt(4)
    v_mfma_f32_16x16x32_bf16 a[160:163], v[108:111], v[40:43], a[160:163]
    v_mfma_f32_16x16x32_bf16 a[164:167], v[108:111], v[44:47], a[164:167]
    s_add_u32 m0, s51, 124928
    s_add_u32 s52, s47, 40960
    buffer_load_dwordx4 v10, s[8:11], s52 offen lds
    v_mfma_f32_16x16x32_bf16 a[168:171], v[108:111], v[48:51], a[168:171]
    v_mfma_f32_16x16x32_bf16 a[172:175], v[108:111], v[52:55], a[172:175]
    s_add_u32 m0, s51, 125952
    s_add_u32 s52, s47, 61440
    buffer_load_dwordx4 v10, s[8:11], s52 offen lds
    v_mfma_f32_16x16x32_bf16 a[176:179], v[108:111], v[56:59], a[176:179]
    v_mfma_f32_16x16x32_bf16 a[180:183], v[108:111], v[60:63], a[180:183]
    s_add_u32 m0, s51, 126976
    s_add_u32 s52, s47, 81920
    buffer_load_dwordx4 v10, s[8:11], s52 offen lds
    v_mfma_f32_16x16x32_bf16 a[184:187], v[108:111], v[64:67], a[184:187]
    v_mfma_f32_16x16x32_bf16 a[188:191], v[108:111], v[68:71], a[188:191]
    s_add_u32 m0, s51, 128000
    s_add_u32 s52, s47, 102400
    buffer_load_dwordx4 v10, s[8:11], s52 offen lds
    ds_read_b128 v[72:75], v36 offset:40960
    ds_read_b128 v[76:79], v36 offset:41984
    ds_read_b128 v[80:83], v36 offset:43008
    ds_read_b128 v[84:87], v36 offset:44032
    ds_read_b128 v[88:91], v36 offset:45056
    ds_read_b128 v[92:95], v36 offset:46080
    ds_read_b128 v[96:99], v36 offset:47104
    ds_read_b128 v[100:103], v36 offset:48128
    ds_read_b64_tr_b16 v[104:105], v12 offset:40960
    ds_read_b64_tr_b16 v[106:107], v12 offset:41984
    s_waitcnt lgkmcnt(12)
    v_mfma_f32_16x16x32_bf16 a[192:195], v[112:115], v[40:43], a[192:195]
    v_mfma_f32_16x16x32_bf16 a[196:199], v[112:115], v[44:47], a[196:199]
    s_add_u32 m0, s51, 129024
    s_add_u32 s52, s47, 122880
    buffer_load_dwordx4 v10, s[8:11], s52 offen lds
    v_mfma_f32_16x16x32_bf16 a[200:203], v[112:115], v[48:51], a[200:203]
    v_mfma_f32_16x16x32_bf16 a[204:207], v[112:115], v[52:55], a[204:207]
    s_add_u32 m0, s51, 130048
    s_add_u32 s52, s47, 143360
    buffer_load_dwordx4 v10, s[8:11], s52 offen lds
    v_mfma_f32_16x16x32_bf16 a[208:211], v[112:115], v[56:59], a[208:211]
    v_mfma_f32_16x16x32_bf16 a[212:215], v[112:115], v[60:63], a[212:215]
    s_add_u32 s46, s46, 262144
    s_add_u32 s47, s47, 64
    v_mfma_f32_16x16x32_bf16 a[216:219], v[112:115], v[64:67], a[216:219]
    v_mfma_f32_16x16x32_bf16 a[220:223], v[112:115], v[68:71], a[220:223]
    ds_read_b64_tr_b16 v[108:109], v13 offset:40960
    ds_read_b64_tr_b16 v[110:111], v13 offset:41984
    s_waitcnt lgkmcnt(12)
    v_mfma_f32_16x16x32_bf16 a[224:227], v[116:119], v[40:43], a[224:227]
    v_mfma_f32_16x16x32_bf16 a[228:231], v[116:119], v[44:47], a[228:231]
    v_mfma_f32_16x16x32_bf16 a[232:235], v[116:119], v[48:51], a[232:235]
    v_mfma_f32_16x16x32_bf16 a[236:239], v[116:119], v[52:55], a[236:239]
    v_mfma_f32_16x16x32_bf16 a[240:243], v[116:119], v[56:59], a[240:243]
    v_mfma_f32_16x16x32_bf16 a[244:247], v[116:119], v[60:63], a[244:247]
    v_mfma_f32_16x16x32_bf16 a[248:251], v[116:119], v[64:67], a[248:251]
    v_mfma_f32_16x16x32_bf16 a[252:255], v[116:119], v[68:71], a[252:255]
    ds_read_b64_tr_b16 v[112:113], v14 offset:40960
    ds_read_b64_tr_b16 v[114:115], v14 offset:41984
    s_waitcnt lgkmcnt(6)
    s_waitcnt lgkmcnt(4)
    v_mfma_f32_16x16x32_bf16 a[0:3], v[104:107], v[72:75], a[0:3]
    v_mfma_f32_16x16x32_bf16 a[4:7], v[104:107], v[76:79], a[4:7]
    v_mfma_f32_16x16x32_bf16 a[8:11], v[104:107], v[80:83], a[8:11]
    v_mfma_f32_16x16x32_bf16 a[12:15], v[104:107], v[84:87], a[12:15]
    v_mfma_f32_16x16x32_bf16 a[16:19], v[104:107], v[88:91], a[16:19]
    v_mfma_f32_16x16x32_bf16 a[20:23], v[104:107], v[92:95], a[20:23]
    v_mfma_f32_16x16x32_bf16 a[24:27], v[104:107], v[96:99], a[24:27]
    v_mfma_f32_16x16x32_bf16 a[28:31], v[104:107], v[100:103], a[28:31]
    ds_read_b64_tr_b16 v[116:117], v15 offset:40960
    ds_read_b64_tr_b16 v[118:119], v15 offset:41984
    s_waitcnt lgkmcnt(4)
    v_mfma_f32_16x16x32_bf16 a[32:35], v[108:111], v[72:75], a[32:35]
    v_mfma_f32_16x16x32_bf16 a[36:39], v[108:111], v[76:79], a[36:39]
    v_mfma_f32_16x16x32_bf16 a[40:43], v[108:111], v[80:83], a[40:43]
    v_mfma_f32_16x16x32_bf16 a[44:47], v[108:111], v[84:87], a[44:47]
    v_mfma_f32_16x16x32_bf16 a[48:51], v[108:111], v[88:91], a[48:51]
    v_mfma_f32_16x16x32_bf16 a[52:55], v[108:111], v[92:95], a[52:55]
    v_mfma_f32_16x16x32_bf16 a[56:59], v[108:111], v[96:99], a[56:59]
    v_mfma_f32_16x16x32_bf16 a[60:63], v[108:111], v[100:103], a[60:63]
    ds_read_b64_tr_b16 v[104:105], v16 offset:40960
    ds_read_b64_tr_b16 v[106:107], v16 offset:41984
    s_waitcnt lgkmcnt(4)
    v_mfma_f32_16x16x32_bf16 a[64:67], v[112:115], v[72:75], a[64:67]
    v_mfma_f32_16x16x32_bf16 a[68:71], v[112:115], v[76:79], a[68:71]
    v_mfma_f32_16x16x32_bf16 a[72:75], v[112:115], v[80:83], a[72:75]
    v_mfma_f32_16x16x32_bf16 a[76:79], v[112:115], v[84:87], a[76:79]
    v_mfma_f32_16x16x32_bf16 a[80:83], v[112:115], v[88:91], a[80:83]
    v_mfma_f32_16x16x32_bf16 a[84:87], v[112:115], v[92:95], a[84:87]
    v_mfma_f32_16x16x32_bf16 a[88:91], v[112:115], v[96:99], a[88:91]
    v_mfma_f32_16x16x32_bf16 a[92:95], v[112:115], v[100:103], a[92:95]
    ds_read_b64_tr_b16 v[108:109], v17 offset:40960
    ds_read_b64_tr_b16 v[110:111], v17 offset:41984
    s_waitcnt lgkmcnt(4)
    v_mfma_f32_16x16x32_bf16 a[96:99], v[116:119], v[72:75], a[96:99]
    v_mfma_f32_16x16x32_bf16 a[100:103], v[116:119], v[76:79], a[100:103]
    v_mfma_f32_16x16x32_bf16 a[104:107], v[116:119], v[80:83], a[104:107]
    v_mfma_f32_16x16x32_bf16 a[108:111], v[116:119], v[84:87], a[108:111]
    v_mfma_f32_16x16x32_bf16 a[112:115], v[116:119], v[88:91], a[112:115]
    v_mfma_f32_16x16x32_bf16 a[116:119], v[116:119], v[92:95], a[116:119]
    v_mfma_f32_16x16x32_bf16 a[120:123], v[116:119], v[96:99], a[120:123]
    v_mfma_f32_16x16x32_bf16 a[124:127], v[116:119], v[100:103], a[124:127]
    s_waitcnt vmcnt(10)
    s_barrier
    ds_read_b64_tr_b16 v[112:113], v18 offset:40960
    ds_read_b64_tr_b16 v[114:115], v18 offset:41984
    s_waitcnt lgkmcnt(4)
    v_mfma_f32_16x16x32_bf16 a[128:131], v[104:107], v[72:75], a[128:131]
    v_mfma_f32_16x16x32_bf16 a[132:135], v[104:107], v[76:79], a[132:135]
    s_add_u32 m0, s50, 0
    s_add_u32 s52, s46, 0x0
    buffer_load_dwordx4 v9, s[12:15], s52 offen lds
    v_mfma_f32_16x16x32_bf16 a[136:139], v[104:107], v[80:83], a[136:139]
    v_mfma_f32_16x16x32_bf16 a[140:143], v[104:107], v[84:87], a[140:143]
    s_add_u32 m0, s50, 1024
    s_add_u32 s52, s46, 0x8000
    buffer_load_dwordx4 v9, s[12:15], s52 offen lds
    v_mfma_f32_16x16x32_bf16 a[144:147], v[104:107], v[88:91], a[144:147]
    v_mfma_f32_16x16x32_bf16 a[148:151], v[104:107], v[92:95], a[148:151]
    s_add_u32 m0, s51, 0
    s_add_u32 s52, s47, 0
    buffer_load_dwordx4 v10, s[8:11], s52 offen lds
    v_mfma_f32_16x16x32_bf16 a[152:155], v[104:107], v[96:99], a[152:155]
    v_mfma_f32_16x16x32_bf16 a[156:159], v[104:107], v[100:103], a[156:159]
    s_add_u32 m0, s51, 1024
    s_add_u32 s52, s47, 20480
    buffer_load_dwordx4 v10, s[8:11], s52 offen lds
    ds_read_b64_tr_b16 v[116:117], v19 offset:40960
    ds_read_b64_tr_b16 v[118:119], v19 offset:41984
    s_waitcnt lgkmcnt(4)
    v_mfma_f32_16x16x32_bf16 a[160:163], v[108:111], v[72:75], a[160:163]
    v_mfma_f32_16x16x32_bf16 a[164:167], v[108:111], v[76:79], a[164:167]
    s_add_u32 m0, s51, 2048
    s_add_u32 s52, s47, 40960
    buffer_load_dwordx4 v10, s[8:11], s52 offen lds
    v_mfma_f32_16x16x32_bf16 a[168:171], v[108:111], v[80:83], a[168:171]
    v_mfma_f32_16x16x32_bf16 a[172:175], v[108:111], v[84:87], a[172:175]
    s_add_u32 m0, s51, 3072
    s_add_u32 s52, s47, 61440
    buffer_load_dwordx4 v10, s[8:11], s52 offen lds
    v_mfma_f32_16x16x32_bf16 a[176:179], v[108:111], v[88:91], a[176:179]
    v_mfma_f32_16x16x32_bf16 a[180:183], v[108:111], v[92:95], a[180:183]
    s_add_u32 m0, s51, 4096
    s_add_u32 s52, s47, 81920
    buffer_load_dwordx4 v10, s[8:11], s52 offen lds
    v_mfma_f32_16x16x32_bf16 a[184:187], v[108:111], v[96:99], a[184:187]
    v_mfma_f32_16x16x32_bf16 a[188:191], v[108:111], v[100:103], a[188:191]
    s_add_u32 m0, s51, 5120
    s_add_u32 s52, s47, 102400
    buffer_load_dwordx4 v10, s[8:11], s52 offen lds
    ds_read_b128 v[40:43], v37 offset:16384
    ds_read_b128 v[44:47], v37 offset:17408
    ds_read_b128 v[48:51], v37 offset:18432
    ds_read_b128 v[52:55], v37 offset:19456
    ds_read_b128 v[56:59], v37 offset:20480
    ds_read_b128 v[60:63], v37 offset:21504
    ds_read_b128 v[64:67], v37 offset:22528
    ds_read_b128 v[68:71], v37 offset:23552
    ds_read_b64_tr_b16 v[104:105], v20 offset:16384
    ds_read_b64_tr_b16 v[106:107], v20 offset:17408
    s_waitcnt lgkmcnt(12)
    v_mfma_f32_16x16x32_bf16 a[192:195], v[112:115], v[72:75], a[192:195]
    v_mfma_f32_16x16x32_bf16 a[196:199], v[112:115], v[76:79], a[196:199]
    s_add_u32 m0, s51, 6144
    s_add_u32 s52, s47, 122880
    buffer_load_dwordx4 v10, s[8:11], s52 offen lds
    v_mfma_f32_16x16x32_bf16 a[200:203], v[112:115], v[80:83], a[200:203]
    v_mfma_f32_16x16x32_bf16 a[204:207], v[112:115], v[84:87], a[204:207]
    s_add_u32 m0, s51, 7168
    s_add_u32 s52, s47, 143360
    buffer_load_dwordx4 v10, s[8:11], s52 offen lds
    v_mfma_f32_16x16x32_bf16 a[208:211], v[112:115], v[88:91], a[208:211]
    v_mfma_f32_16x16x32_bf16 a[212:215], v[112:115], v[92:95], a[212:215]
    s_add_u32 s46, s46, 262144
    s_add_u32 s47, s47, 64
    v_mfma_f32_16x16x32_bf16 a[216:219], v[112:115], v[96:99], a[216:219]
    v_mfma_f32_16x16x32_bf16 a[220:223], v[112:115], v[100:103], a[220:223]
    ds_read_b64_tr_b16 v[108:109], v21 offset:16384
    ds_read_b64_tr_b16 v[110:111], v21 offset:17408
    s_waitcnt lgkmcnt(12)
    v_mfma_f32_16x16x32_bf16 a[224:227], v[116:119], v[72:75], a[224:227]
    v_mfma_f32_16x16x32_bf16 a[228:231], v[116:119], v[76:79], a[228:231]
    v_mfma_f32_16x16x32_bf16 a[232:235], v[116:119], v[80:83], a[232:235]
    v_mfma_f32_16x16x32_bf16 a[236:239], v[116:119], v[84:87], a[236:239]
    v_mfma_f32_16x16x32_bf16 a[240:243], v[116:119], v[88:91], a[240:243]
    v_mfma_f32_16x16x32_bf16 a[244:247], v[116:119], v[92:95], a[244:247]
    v_mfma_f32_16x16x32_bf16 a[248:251], v[116:119], v[96:99], a[248:251]
    v_mfma_f32_16x16x32_bf16 a[252:255], v[116:119], v[100:103], a[252:255]
    ds_read_b64_tr_b16 v[112:113], v22 offset:16384
    ds_read_b64_tr_b16 v[114:115], v22 offset:17408
    s_waitcnt lgkmcnt(6)
    s_waitcnt lgkmcnt(4)
    v_mfma_f32_16x16x32_bf16 a[0:3], v[104:107], v[40:43], a[0:3]
    v_mfma_f32_16x16x32_bf16 a[4:7], v[104:107], v[44:47], a[4:7]
    v_mfma_f32_16x16x32_bf16 a[8:11], v[104:107], v[48:51], a[8:11]
    v_mfma_f32_16x16x32_bf16 a[12:15], v[104:107], v[52:55], a[12:15]
    v_mfma_f32_16x16x32_bf16 a[16:19], v[104:107], v[56:59], a[16:19]
    v_mfma_f32_16x16x32_bf16 a[20:23], v[104:107], v[60:63], a[20:23]
    v_mfma_f32_16x16x32_bf16 a[24:27], v[104:107], v[64:67], a[24:27]
    v_mfma_f32_16x16x32_bf16 a[28:31], v[104:107], v[68:71], a[28:31]
    ds_read_b64_tr_b16 v[116:117], v23 offset:16384
    ds_read_b64_tr_b16 v[118:119], v23 offset:17408
    s_waitcnt lgkmcnt(4)
    v_mfma_f32_16x16x32_bf16 a[32:35], v[108:111], v[40:43], a[32:35]
    v_mfma_f32_16x16x32_bf16 a[36:39], v[108:111], v[44:47], a[36:39]
    v_mfma_f32_16x16x32_bf16 a[40:43], v[108:111], v[48:51], a[40:43]
    v_mfma_f32_16x16x32_bf16 a[44:47], v[108:111], v[52:55], a[44:47]
    v_mfma_f32_16x16x32_bf16 a[48:51], v[108:111], v[56:59], a[48:51]
    v_mfma_f32_16x16x32_bf16 a[52:55], v[108:111], v[60:63], a[52:55]
    v_mfma_f32_16x16x32_bf16 a[56:59], v[108:111], v[64:67], a[56:59]
    v_mfma_f32_16x16x32_bf16 a[60:63], v[108:111], v[68:71], a[60:63]
    ds_read_b64_tr_b16 v[104:105], v24 offset:16384
    ds_read_b64_tr_b16 v[106:107], v24 offset:17408
    s_waitcnt lgkmcnt(4)
    v_mfma_f32_16x16x32_bf16 a[64:67], v[112:115], v[40:43], a[64:67]
    v_mfma_f32_16x16x32_bf16 a[68:71], v[112:115], v[44:47], a[68:71]
    v_mfma_f32_16x16x32_bf16 a[72:75], v[112:115], v[48:51], a[72:75]
    v_mfma_f32_16x16x32_bf16 a[76:79], v[112:115], v[52:55], a[76:79]
    v_mfma_f32_16x16x32_bf16 a[80:83], v[112:115], v[56:59], a[80:83]
    v_mfma_f32_16x16x32_bf16 a[84:87], v[112:115], v[60:63], a[84:87]
    v_mfma_f32_16x16x32_bf16 a[88:91], v[112:115], v[64:67], a[88:91]
    v_mfma_f32_16x16x32_bf16 a[92:95], v[112:115], v[68:71], a[92:95]
    ds_read_b64_tr_b16 v[108:109], v25 offset:16384
    ds_read_b64_tr_b16 v[110:111], v25 offset:17408
    s_waitcnt lgkmcnt(4)
    v_mfma_f32_16x16x32_bf16 a[96:99], v[116:119], v[40:43], a[96:99]
    v_mfma_f32_16x16x32_bf16 a[100:103], v[116:119], v[44:47], a[100:103]
    v_mfma_f32_16x16x32_bf16 a[104:107], v[116:119], v[48:51], a[104:107]
    v_mfma_f32_16x16x32_bf16 a[108:111], v[116:119], v[52:55], a[108:111]
    v_mfma_f32_16x16x32_bf16 a[112:115], v[116:119], v[56:59], a[112:115]
    v_mfma_f32_16x16x32_bf16 a[116:119], v[116:119], v[60:63], a[116:119]
    v_mfma_f32_16x16x32_bf16 a[120:123], v[116:119], v[64:67], a[120:123]
    v_mfma_f32_16x16x32_bf16 a[124:127], v[116:119], v[68:71], a[124:127]
    s_waitcnt vmcnt(10)
    s_barrier
    ds_read_b64_tr_b16 v[112:113], v26 offset:16384
    ds_read_b64_tr_b16 v[114:115], v26 offset:17408
    s_waitcnt lgkmcnt(4)
    v_mfma_f32_16x16x32_bf16 a[128:131], v[104:107], v[40:43], a[128:131]
    v_mfma_f32_16x16x32_bf16 a[132:135], v[104:107], v[44:47], a[132:135]
    s_add_u32 m0, s50, 40960
    s_add_u32 s52, s46, 0x0
    buffer_load_dwordx4 v9, s[12:15], s52 offen lds
    v_mfma_f32_16x16x32_bf16 a[136:139], v[104:107], v[48:51], a[136:139]
    v_mfma_f32_16x16x32_bf16 a[140:143], v[104:107], v[52:55], a[140:143]
    s_add_u32 m0, s50, 41984
    s_add_u32 s52, s46, 0x8000
    buffer_load_dwordx4 v9, s[12:15], s52 offen lds
    v_mfma_f32_16x16x32_bf16 a[144:147], v[104:107], v[56:59], a[144:147]
    v_mfma_f32_16x16x32_bf16 a[148:151], v[104:107], v[60:63], a[148:151]
    s_add_u32 m0, s51, 40960
    s_add_u32 s52, s47, 0
    buffer_load_dwordx4 v10, s[8:11], s52 offen lds
    v_mfma_f32_16x16x32_bf16 a[152:155], v[104:107], v[64:67], a[152:155]
    v_mfma_f32_16x16x32_bf16 a[156:159], v[104:107], v[68:71], a[156:159]
    s_add_u32 m0, s51, 41984
    s_add_u32 s52, s47, 20480
    buffer_load_dwordx4 v10, s[8:11], s52 offen lds
    ds_read_b64_tr_b16 v[116:117], v27 offset:16384
    ds_read_b64_tr_b16 v[118:119], v27 offset:17408
    s_waitcnt lgkmcnt(4)
    v_mfma_f32_16x16x32_bf16 a[160:163], v[108:111], v[40:43], a[160:163]
    v_mfma_f32_16x16x32_bf16 a[164:167], v[108:111], v[44:47], a[164:167]
    s_add_u32 m0, s51, 43008
    s_add_u32 s52, s47, 40960
    buffer_load_dwordx4 v10, s[8:11], s52 offen lds
    v_mfma_f32_16x16x32_bf16 a[168:171], v[108:111], v[48:51], a[168:171]
    v_mfma_f32_16x16x32_bf16 a[172:175], v[108:111], v[52:55], a[172:175]
    s_add_u32 m0, s51, 44032
    s_add_u32 s52, s47, 61440
    buffer_load_dwordx4 v10, s[8:11], s52 offen lds
    v_mfma_f32_16x16x32_bf16 a[176:179], v[108:111], v[56:59], a[176:179]
    v_mfma_f32_16x16x32_bf16 a[180:183], v[108:111], v[60:63], a[180:183]
    s_add_u32 m0, s51, 45056
    s_add_u32 s52, s47, 81920
    buffer_load_dwordx4 v10, s[8:11], s52 offen lds
    v_mfma_f32_16x16x32_bf16 a[184:187], v[108:111], v[64:67], a[184:187]
    v_mfma_f32_16x16x32_bf16 a[188:191], v[108:111], v[68:71], a[188:191]
    s_add_u32 m0, s51, 46080
    s_add_u32 s52, s47, 102400
    buffer_load_dwordx4 v10, s[8:11], s52 offen lds
    ds_read_b128 v[72:75], v37 offset:57344
    ds_read_b128 v[76:79], v37 offset:58368
    ds_read_b128 v[80:83], v37 offset:59392
    ds_read_b128 v[84:87], v37 offset:60416
    ds_read_b128 v[88:91], v37 offset:61440
    ds_read_b128 v[92:95], v37 offset:62464
    ds_read_b128 v[96:99], v37 offset:63488
    ds_read_b128 v[100:103], v37 offset:64512
    ds_read_b64_tr_b16 v[104:105], v20 offset:57344
    ds_read_b64_tr_b16 v[106:107], v20 offset:58368
    s_waitcnt lgkmcnt(12)
    v_mfma_f32_16x16x32_bf16 a[192:195], v[112:115], v[40:43], a[192:195]
    v_mfma_f32_16x16x32_bf16 a[196:199], v[112:115], v[44:47], a[196:199]
    s_add_u32 m0, s51, 47104
    s_add_u32 s52, s47, 122880
    buffer_load_dwordx4 v10, s[8:11], s52 offen lds
    v_mfma_f32_16x16x32_bf16 a[200:203], v[112:115], v[48:51], a[200:203]
    v_mfma_f32_16x16x32_bf16 a[204:207], v[112:115], v[52:55], a[204:207]
    s_add_u32 m0, s51, 48128
    s_add_u32 s52, s47, 143360
    buffer_load_dwordx4 v10, s[8:11], s52 offen lds
    v_mfma_f32_16x16x32_bf16 a[208:211], v[112:115], v[56:59], a[208:211]
    v_mfma_f32_16x16x32_bf16 a[212:215], v[112:115], v[60:63], a[212:215]
    s_add_u32 s46, s46, 262144
    s_add_u32 s47, s47, 64
    v_mfma_f32_16x16x32_bf16 a[216:219], v[112:115], v[64:67], a[216:219]
    v_mfma_f32_16x16x32_bf16 a[220:223], v[112:115], v[68:71], a[220:223]
    ds_read_b64_tr_b16 v[108:109], v21 offset:57344
    ds_read_b64_tr_b16 v[110:111], v21 offset:58368
    s_waitcnt lgkmcnt(12)
    v_mfma_f32_16x16x32_bf16 a[224:227], v[116:119], v[40:43], a[224:227]
    v_mfma_f32_16x16x32_bf16 a[228:231], v[116:119], v[44:47], a[228:231]
    v_mfma_f32_16x16x32_bf16 a[232:235], v[116:119], v[48:51], a[232:235]
    v_mfma_f32_16x16x32_bf16 a[236:239], v[116:119], v[52:55], a[236:239]
    v_mfma_f32_16x16x32_bf16 a[240:243], v[116:119], v[56:59], a[240:243]
    v_mfma_f32_16x16x32_bf16 a[244:247], v[116:119], v[60:63], a[244:247]
    v_mfma_f32_16x16x32_bf16 a[248:251], v[116:119], v[64:67], a[248:251]
    v_mfma_f32_16x16x32_bf16 a[252:255], v[116:119], v[68:71], a[252:255]
    ds_read_b64_tr_b16 v[112:113], v22 offset:57344
    ds_read_b64_tr_b16 v[114:115], v22 offset:58368
    s_waitcnt lgkmcnt(6)
    s_waitcnt lgkmcnt(4)
    v_mfma_f32_16x16x32_bf16 a[0:3], v[104:107], v[72:75], a[0:3]
    v_mfma_f32_16x16x32_bf16 a[4:7], v[104:107], v[76:79], a[4:7]
    v_mfma_f32_16x16x32_bf16 a[8:11], v[104:107], v[80:83], a[8:11]
    v_mfma_f32_16x16x32_bf16 a[12:15], v[104:107], v[84:87], a[12:15]
    v_mfma_f32_16x16x32_bf16 a[16:19], v[104:107], v[88:91], a[16:19]
    v_mfma_f32_16x16x32_bf16 a[20:23], v[104:107], v[92:95], a[20:23]
    v_mfma_f32_16x16x32_bf16 a[24:27], v[104:107], v[96:99], a[24:27]
    v_mfma_f32_16x16x32_bf16 a[28:31], v[104:107], v[100:103], a[28:31]
    ds_read_b64_tr_b16 v[116:117], v23 offset:57344
    ds_read_b64_tr_b16 v[118:119], v23 offset:58368
    s_waitcnt lgkmcnt(4)
    v_mfma_f32_16x16x32_bf16 a[32:35], v[108:111], v[72:75], a[32:35]
    v_mfma_f32_16x16x32_bf16 a[36:39], v[108:111], v[76:79], a[36:39]
    v_mfma_f32_16x16x32_bf16 a[40:43], v[108:111], v[80:83], a[40:43]
    v_mfma_f32_16x16x32_bf16 a[44:47], v[108:111], v[84:87], a[44:47]
    v_mfma_f32_16x16x32_bf16 a[48:51], v[108:111], v[88:91], a[48:51]
    v_mfma_f32_16x16x32_bf16 a[52:55], v[108:111], v[92:95], a[52:55]
    v_mfma_f32_16x16x32_bf16 a[56:59], v[108:111], v[96:99], a[56:59]
    v_mfma_f32_16x16x32_bf16 a[60:63], v[108:111], v[100:103], a[60:63]
    ds_read_b64_tr_b16 v[104:105], v24 offset:57344
    ds_read_b64_tr_b16 v[106:107], v24 offset:58368
    s_waitcnt lgkmcnt(4)
    v_mfma_f32_16x16x32_bf16 a[64:67], v[112:115], v[72:75], a[64:67]
    v_mfma_f32_16x16x32_bf16 a[68:71], v[112:115], v[76:79], a[68:71]
    v_mfma_f32_16x16x32_bf16 a[72:75], v[112:115], v[80:83], a[72:75]
    v_mfma_f32_16x16x32_bf16 a[76:79], v[112:115], v[84:87], a[76:79]
    v_mfma_f32_16x16x32_bf16 a[80:83], v[112:115], v[88:91], a[80:83]
    v_mfma_f32_16x16x32_bf16 a[84:87], v[112:115], v[92:95], a[84:87]
    v_mfma_f32_16x16x32_bf16 a[88:91], v[112:115], v[96:99], a[88:91]
    v_mfma_f32_16x16x32_bf16 a[92:95], v[112:115], v[100:103], a[92:95]
    ds_read_b64_tr_b16 v[108:109], v25 offset:57344
    ds_read_b64_tr_b16 v[110:111], v25 offset:58368
    s_waitcnt lgkmcnt(4)
    v_mfma_f32_16x16x32_bf16 a[96:99], v[116:119], v[72:75], a[96:99]
    v_mfma_f32_16x16x32_bf16 a[100:103], v[116:119], v[76:79], a[100:103]
    v_mfma_f32_16x16x32_bf16 a[104:107], v[116:119], v[80:83], a[104:107]
    v_mfma_f32_16x16x32_bf16 a[108:111], v[116:119], v[84:87], a[108:111]
    v_mfma_f32_16x16x32_bf16 a[112:115], v[116:119], v[88:91], a[112:115]
    v_mfma_f32_16x16x32_bf16 a[116:119], v[116:119], v[92:95], a[116:119]
    v_mfma_f32_16x16x32_bf16 a[120:123], v[116:119], v[96:99], a[120:123]
    v_mfma_f32_16x16x32_bf16 a[124:127], v[116:119], v[100:103], a[124:127]
    s_waitcnt vmcnt(10)
    s_barrier
    ds_read_b64_tr_b16 v[112:113], v26 offset:57344
    ds_read_b64_tr_b16 v[114:115], v26 offset:58368
    s_waitcnt lgkmcnt(4)
    v_mfma_f32_16x16x32_bf16 a[128:131], v[104:107], v[72:75], a[128:131]
    v_mfma_f32_16x16x32_bf16 a[132:135], v[104:107], v[76:79], a[132:135]
    s_add_u32 m0, s50, 81920
    s_add_u32 s52, s46, 0x0
    buffer_load_dwordx4 v9, s[12:15], s52 offen lds
    v_mfma_f32_16x16x32_bf16 a[136:139], v[104:107], v[80:83], a[136:139]
    v_mfma_f32_16x16x32_bf16 a[140:143], v[104:107], v[84:87], a[140:143]
    s_add_u32 m0, s50, 82944
    s_add_u32 s52, s46, 0x8000
    buffer_load_dwordx4 v9, s[12:15], s52 offen lds
    v_mfma_f32_16x16x32_bf16 a[144:147], v[104:107], v[88:91], a[144:147]
    v_mfma_f32_16x16x32_bf16 a[148:151], v[104:107], v[92:95], a[148:151]
    s_add_u32 m0, s51, 81920
    s_add_u32 s52, s47, 0
    buffer_load_dwordx4 v10, s[8:11], s52 offen lds
    v_mfma_f32_16x16x32_bf16 a[152:155], v[104:107], v[96:99], a[152:155]
    v_mfma_f32_16x16x32_bf16 a[156:159], v[104:107], v[100:103], a[156:159]
    s_add_u32 m0, s51, 82944
    s_add_u32 s52, s47, 20480
    buffer_load_dwordx4 v10, s[8:11], s52 offen lds
    ds_read_b64_tr_b16 v[116:117], v27 offset:57344
    ds_read_b64_tr_b16 v[118:119], v27 offset:58368
    s_waitcnt lgkmcnt(4)
    v_mfma_f32_16x16x32_bf16 a[160:163], v[108:111], v[72:75], a[160:163]
    v_mfma_f32_16x16x32_bf16 a[164:167], v[108:111], v[76:79], a[164:167]
    s_add_u32 m0, s51, 83968
    s_add_u32 s52, s47, 40960
    buffer_load_dwordx4 v10, s[8:11], s52 offen lds
    v_mfma_f32_16x16x32_bf16 a[168:171], v[108:111], v[80:83], a[168:171]
    v_mfma_f32_16x16x32_bf16 a[172:175], v[108:111], v[84:87], a[172:175]
    s_add_u32 m0, s51, 84992
    s_add_u32 s52, s47, 61440
    buffer_load_dwordx4 v10, s[8:11], s52 offen lds
    v_mfma_f32_16x16x32_bf16 a[176:179], v[108:111], v[88:91], a[176:179]
    v_mfma_f32_16x16x32_bf16 a[180:183], v[108:111], v[92:95], a[180:183]
    s_add_u32 m0, s51, 86016
    s_add_u32 s52, s47, 81920
    buffer_load_dwordx4 v10, s[8:11], s52 offen lds
    v_mfma_f32_16x16x32_bf16 a[184:187], v[108:111], v[96:99], a[184:187]
    v_mfma_f32_16x16x32_bf16 a[188:191], v[108:111], v[100:103], a[188:191]
    s_add_u32 m0, s51, 87040
    s_add_u32 s52, s47, 102400
    buffer_load_dwordx4 v10, s[8:11], s52 offen lds
    ds_read_b128 v[40:43], v36 offset:0
    ds_read_b128 v[44:47], v36 offset:1024
    ds_read_b128 v[48:51], v36 offset:2048
    ds_read_b128 v[52:55], v36 offset:3072
    ds_read_b128 v[56:59], v36 offset:4096
    ds_read_b128 v[60:63], v36 offset:5120
    ds_read_b128 v[64:67], v36 offset:6144
    ds_read_b128 v[68:71], v36 offset:7168
    ds_read_b64_tr_b16 v[104:105], v12 offset:0
    ds_read_b64_tr_b16 v[106:107], v12 offset:1024
    s_waitcnt lgkmcnt(12)
    v_mfma_f32_16x16x32_bf16 a[192:195], v[112:115], v[72:75], a[192:195]
    v_mfma_f32_16x16x32_bf16 a[196:199], v[112:115], v[76:79], a[196:199]
    s_add_u32 m0, s51, 88064
    s_add_u32 s52, s47, 122880
    buffer_load_dwordx4 v10, s[8:11], s52 offen lds
    v_mfma_f32_16x16x32_bf16 a[200:203], v[112:115], v[80:83], a[200:203]
    v_mfma_f32_16x16x32_bf16 a[204:207], v[112:115], v[84:87], a[204:207]
    s_add_u32 m0, s51, 89088
    s_add_u32 s52, s47, 143360
    buffer_load_dwordx4 v10, s[8:11], s52 offen lds
    v_mfma_f32_16x16x32_bf16 a[208:211], v[112:115], v[88:91], a[208:211]
    v_mfma_f32_16x16x32_bf16 a[212:215], v[112:115], v[92:95], a[212:215]
    s_add_u32 s46, s46, 262144
    s_add_u32 s47, s47, 64
    v_mfma_f32_16x16x32_bf16 a[216:219], v[112:115], v[96:99], a[216:219]
    v_mfma_f32_16x16x32_bf16 a[220:223], v[112:115], v[100:103], a[220:223]
    ds_read_b64_tr_b16 v[108:109], v13 offset:0
    ds_read_b64_tr_b16 v[110:111], v13 offset:1024
    s_waitcnt lgkmcnt(12)
    v_mfma_f32_16x16x32_bf16 a[224:227], v[116:119], v[72:75], a[224:227]
    v_mfma_f32_16x16x32_bf16 a[228:231], v[116:119], v[76:79], a[228:231]
    v_mfma_f32_16x16x32_bf16 a[232:235], v[116:119], v[80:83], a[232:235]
    v_mfma_f32_16x16x32_bf16 a[236:239], v[116:119], v[84:87], a[236:239]
    v_mfma_f32_16x16x32_bf16 a[240:243], v[116:119], v[88:91], a[240:243]
    v_mfma_f32_16x16x32_bf16 a[244:247], v[116:119], v[92:95], a[244:247]
    v_mfma_f32_16x16x32_bf16 a[248:251], v[116:119], v[96:99], a[248:251]
    v_mfma_f32_16x16x32_bf16 a[252:255], v[116:119], v[100:103], a[252:255]
    s_add_u32 s43, s43, 1
    s_cmp_lt_u32 s43, 5
    s_cbranch_scc1 Lpg_146
    s_waitcnt vmcnt(0) lgkmcnt(0)
    s_barrier
    s_nop 3
    s_lshl_b32 s44, s40, 2
    s_add_u32 s44, s44, s42
    s_mul_i32 s44, s44, 128
    s_add_u32 s44, s44, s41
    s_lshl_b32 s44, s44, 13
    v_lshlrev_b32 v6, 4, v1
    v_add_u32 v6, s44, v6
    v_accvgpr_read_b32 v8, a0
    v_accvgpr_read_b32 v9, a1
    v_accvgpr_read_b32 v10, a2
    v_accvgpr_read_b32 v11, a3
    v_accvgpr_read_b32 v12, a32
    v_accvgpr_read_b32 v13, a33
    v_accvgpr_read_b32 v14, a34
    v_accvgpr_read_b32 v15, a35
    v_cvt_pk_bf16_f32 v16, v8, v9
    v_cvt_pk_bf16_f32 v17, v10, v11
    v_cvt_pk_bf16_f32 v18, v12, v13
    v_cvt_pk_bf16_f32 v19, v14, v15
    s_mov_b32 s45, 0xb000000
    buffer_store_dwordx4 v[16:19], v6, s[4:7], s45 offen sc1
    v_accvgpr_read_b32 v8, a64
    v_accvgpr_read_b32 v9, a65
    v_accvgpr_read_b32 v10, a66
    v_accvgpr_read_b32 v11, a67
    v_accvgpr_read_b32 v12, a96
    v_accvgpr_read_b32 v13, a97
    v_accvgpr_read_b32 v14, a98
    v_accvgpr_read_b32 v15, a99
    v_cvt_pk_bf16_f32 v20, v8, v9
    v_cvt_pk_bf16_f32 v21, v10, v11
    v_cvt_pk_bf16_f32 v22, v12, v13
    v_cvt_pk_bf16_f32 v23, v14, v15
    s_mov_b32 s45, 0xb000400
    buffer_store_dwordx4 v[20:23], v6, s[4:7], s45 offen sc1
    v_accvgpr_read_b32 v8, a128
    v_accvgpr_read_b32 v9, a129
    v_accvgpr_read_b32 v10, a130
    v_accvgpr_read_b32 v11, a131
    v_accvgpr_read_b32 v12, a160
    v_accvgpr_read_b32 v13, a161
    v_accvgpr_read_b32 v14, a162
    v_accvgpr_read_b32 v15, a163
    v_cvt_pk_bf16_f32 v24, v8, v9
    v_cvt_pk_bf16_f32 v25, v10, v11
    v_cvt_pk_bf16_f32 v26, v12, v13
    v_cvt_pk_bf16_f32 v27, v14, v15
    s_mov_b32 s45, 0xb000800
    buffer_store_dwordx4 v[24:27], v6, s[4:7], s45 offen sc1
    v_accvgpr_read_b32 v8, a192
    v_accvgpr_read_b32 v9, a193
    v_accvgpr_read_b32 v10, a194
    v_accvgpr_read_b32 v11, a195
    v_accvgpr_read_b32 v12, a224
    v_accvgpr_read_b32 v13, a225
    v_accvgpr_read_b32 v14, a226
    v_accvgpr_read_b32 v15, a227
    v_cvt_pk_bf16_f32 v28, v8, v9
    v_cvt_pk_bf16_f32 v29, v10, v11
    v_cvt_pk_bf16_f32 v30, v12, v13
    v_cvt_pk_bf16_f32 v31, v14, v15
    s_mov_b32 s45, 0xb000c00
    buffer_store_dwordx4 v[28:31], v6, s[4:7], s45 offen sc1
    v_accvgpr_read_b32 v8, a4
    v_accvgpr_read_b32 v9, a5
    v_accvgpr_read_b32 v10, a6
    v_accvgpr_read_b32 v11, a7
    v_accvgpr_read_b32 v12, a36
    v_accvgpr_read_b32 v13, a37
    v_accvgpr_read_b32 v14, a38
    v_accvgpr_read_b32 v15, a39
    v_cvt_pk_bf16_f32 v16, v8, v9
    v_cvt_pk_bf16_f32 v17, v10, v11
    v_cvt_pk_bf16_f32 v18, v12, v13
    v_cvt_pk_bf16_f32 v19, v14, v15
    s_mov_b32 s45, 0xb001000
    buffer_store_dwordx4 v[16:19], v6, s[4:7], s45 offen sc1
    v_accvgpr_read_b32 v8, a68
    v_accvgpr_read_b32 v9, a69
    v_accvgpr_read_b32 v10, a70
    v_accvgpr_read_b32 v11, a71
    v_accvgpr_read_b32 v12, a100
    v_accvgpr_read_b32 v13, a101
    v_accvgpr_read_b32 v14, a102
    v_accvgpr_read_b32 v15, a103
    v_cvt_pk_bf16_f32 v20, v8, v9
    v_cvt_pk_bf16_f32 v21, v10, v11
    v_cvt_pk_bf16_f32 v22, v12, v13
    v_cvt_pk_bf16_f32 v23, v14, v15
    s_mov_b32 s45, 0xb001400
    buffer_store_dwordx4 v[20:23], v6, s[4:7], s45 offen sc1
    v_accvgpr_read_b32 v8, a132
    v_accvgpr_read_b32 v9, a133
    v_accvgpr_read_b32 v10, a134
    v_accvgpr_read_b32 v11, a135
    v_accvgpr_read_b32 v12, a164
    v_accvgpr_read_b32 v13, a165
    v_accvgpr_read_b32 v14, a166
    v_accvgpr_read_b32 v15, a167
    v_cvt_pk_bf16_f32 v24, v8, v9
    v_cvt_pk_bf16_f32 v25, v10, v11
    v_cvt_pk_bf16_f32 v26, v12, v13
    v_cvt_pk_bf16_f32 v27, v14, v15
    s_mov_b32 s45, 0xb001800
    buffer_store_dwordx4 v[24:27], v6, s[4:7], s45 offen sc1
    v_accvgpr_read_b32 v8, a196
    v_accvgpr_read_b32 v9, a197
    v_accvgpr_read_b32 v10, a198
    v_accvgpr_read_b32 v11, a199
    v_accvgpr_read_b32 v12, a228
    v_accvgpr_read_b32 v13, a229
    v_accvgpr_read_b32 v14, a230
    v_accvgpr_read_b32 v15, a231
    v_cvt_pk_bf16_f32 v28, v8, v9
    v_cvt_pk_bf16_f32 v29, v10, v11
    v_cvt_pk_bf16_f32 v30, v12, v13
    v_cvt_pk_bf16_f32 v31, v14, v15
    s_mov_b32 s45, 0xb001c00
    buffer_store_dwordx4 v[28:31], v6, s[4:7], s45 offen sc1
    v_accvgpr_read_b32 v8, a8
    v_accvgpr_read_b32 v9, a9
    v_accvgpr_read_b32 v10, a10
    v_accvgpr_read_b32 v11, a11
    v_accvgpr_read_b32 v12, a40
    v_accvgpr_read_b32 v13, a41
    v_accvgpr_read_b32 v14, a42
    v_accvgpr_read_b32 v15, a43
    v_cvt_pk_bf16_f32 v16, v8, v9
    v_cvt_pk_bf16_f32 v17, v10, v11
    v_cvt_pk_bf16_f32 v18, v12, v13
    v_cvt_pk_bf16_f32 v19, v14, v15
    s_mov_b32 s45, 0xb040000
    buffer_store_dwordx4 v[16:19], v6, s[4:7], s45 offen sc1
    v_accvgpr_read_b32 v8, a72
    v_accvgpr_read_b32 v9, a73
    v_accvgpr_read_b32 v10, a74
    v_accvgpr_read_b32 v11, a75
    v_accvgpr_read_b32 v12, a104
    v_accvgpr_read_b32 v13, a105
    v_accvgpr_read_b32 v14, a106
    v_accvgpr_read_b32 v15, a107
    v_cvt_pk_bf16_f32 v20, v8, v9
    v_cvt_pk_bf16_f32 v21, v10, v11
    v_cvt_pk_bf16_f32 v22, v12, v13
    v_cvt_pk_bf16_f32 v23, v14, v15
    s_mov_b32 s45, 0xb040400
    buffer_store_dwordx4 v[20:23], v6, s[4:7], s45 offen sc1
    v_accvgpr_read_b32 v8, a136
    v_accvgpr_read_b32 v9, a137
    v_accvgpr_read_b32 v10, a138
    v_accvgpr_read_b32 v11, a139
    v_accvgpr_read_b32 v12, a168
    v_accvgpr_read_b32 v13, a169
    v_accvgpr_read_b32 v14, a170
    v_accvgpr_read_b32 v15, a171
    v_cvt_pk_bf16_f32 v24, v8, v9
    v_cvt_pk_bf16_f32 v25, v10, v11
    v_cvt_pk_bf16_f32 v26, v12, v13
    v_cvt_pk_bf16_f32 v27, v14, v15
    s_mov_b32 s45, 0xb040800
    buffer_store_dwordx4 v[24:27], v6, s[4:7], s45 offen sc1
    v_accvgpr_read_b32 v8, a200
    v_accvgpr_read_b32 v9, a201
    v_accvgpr_read_b32 v10, a202
    v_accvgpr_read_b32 v11, a203
    v_accvgpr_read_b32 v12, a232
    v_accvgpr_read_b32 v13, a233
    v_accvgpr_read_b32 v14, a234
    v_accvgpr_read_b32 v15, a235
    v_cvt_pk_bf16_f32 v28, v8, v9
    v_cvt_pk_bf16_f32 v29, v10, v11
    v_cvt_pk_bf16_f32 v30, v12, v13
    v_cvt_pk_bf16_f32 v31, v14, v15
    s_mov_b32 s45, 0xb040c00
    buffer_store_dwordx4 v[28:31], v6, s[4:7], s45 offen sc1
    v_accvgpr_read_b32 v8, a12
    v_accvgpr_read_b32 v9, a13
    v_accvgpr_read_b32 v10, a14
    v_accvgpr_read_b32 v11, a15
    v_accvgpr_read_b32 v12, a44
    v_accvgpr_read_b32 v13, a45
    v_accvgpr_read_b32 v14, a46
    v_accvgpr_read_b32 v15, a47
    v_cvt_pk_bf16_f32 v16, v8, v9
    v_cvt_pk_bf16_f32 v17, v10, v11
    v_cvt_pk_bf16_f32 v18, v12, v13
    v_cvt_pk_bf16_f32 v19, v14, v15
    s_mov_b32 s45, 0xb041000
    buffer_store_dwordx4 v[16:19], v6, s[4:7], s45 offen sc1
    v_accvgpr_read_b32 v8, a76
    v_accvgpr_read_b32 v9, a77
    v_accvgpr_read_b32 v10, a78
    v_accvgpr_read_b32 v11, a79
    v_accvgpr_read_b32 v12, a108
    v_accvgpr_read_b32 v13, a109
    v_accvgpr_read_b32 v14, a110
    v_accvgpr_read_b32 v15, a111
    v_cvt_pk_bf16_f32 v20, v8, v9
    v_cvt_pk_bf16_f32 v21, v10, v11
    v_cvt_pk_bf16_f32 v22, v12, v13
    v_cvt_pk_bf16_f32 v23, v14, v15
    s_mov_b32 s45, 0xb041400
    buffer_store_dwordx4 v[20:23], v6, s[4:7], s45 offen sc1
    v_accvgpr_read_b32 v8, a140
    v_accvgpr_read_b32 v9, a141
    v_accvgpr_read_b32 v10, a142
    v_accvgpr_read_b32 v11, a143
    v_accvgpr_read_b32 v12, a172
    v_accvgpr_read_b32 v13, a173
    v_accvgpr_read_b32 v14, a174
    v_accvgpr_read_b32 v15, a175
    v_cvt_pk_bf16_f32 v24, v8, v9
    v_cvt_pk_bf16_f32 v25, v10, v11
    v_cvt_pk_bf16_f32 v26, v12, v13
    v_cvt_pk_bf16_f32 v27, v14, v15
    s_mov_b32 s45, 0xb041800
    buffer_store_dwordx4 v[24:27], v6, s[4:7], s45 offen sc1
    v_accvgpr_read_b32 v8, a204
    v_accvgpr_read_b32 v9, a205
    v_accvgpr_read_b32 v10, a206
    v_accvgpr_read_b32 v11, a207
    v_accvgpr_read_b32 v12, a236
    v_accvgpr_read_b32 v13, a237
    v_accvgpr_read_b32 v14, a238
    v_accvgpr_read_b32 v15, a239
    v_cvt_pk_bf16_f32 v28, v8, v9
    v_cvt_pk_bf16_f32 v29, v10, v11
    v_cvt_pk_bf16_f32 v30, v12, v13
    v_cvt_pk_bf16_f32 v31, v14, v15
    s_mov_b32 s45, 0xb041c00
    buffer_store_dwordx4 v[28:31], v6, s[4:7], s45 offen sc1
    v_accvgpr_read_b32 v8, a16
    v_accvgpr_read_b32 v9, a17
    v_accvgpr_read_b32 v10, a18
    v_accvgpr_read_b32 v11, a19
    v_accvgpr_read_b32 v12, a48
    v_accvgpr_read_b32 v13, a49
    v_accvgpr_read_b32 v14, a50
    v_accvgpr_read_b32 v15, a51
    v_cvt_pk_bf16_f32 v16, v8, v9
    v_cvt_pk_bf16_f32 v17, v10, v11
    v_cvt_pk_bf16_f32 v18, v12, v13
    v_cvt_pk_bf16_f32 v19, v14, v15
    s_mov_b32 s45, 0xb080000
    buffer_store_dwordx4 v[16:19], v6, s[4:7], s45 offen sc1
    v_accvgpr_read_b32 v8, a80
    v_accvgpr_read_b32 v9, a81
    v_accvgpr_read_b32 v10, a82
    v_accvgpr_read_b32 v11, a83
    v_accvgpr_read_b32 v12, a112
    v_accvgpr_read_b32 v13, a113
    v_accvgpr_read_b32 v14, a114
    v_accvgpr_read_b32 v15, a115
    v_cvt_pk_bf16_f32 v20, v8, v9
    v_cvt_pk_bf16_f32 v21, v10, v11
    v_cvt_pk_bf16_f32 v22, v12, v13
    v_cvt_pk_bf16_f32 v23, v14, v15
    s_mov_b32 s45, 0xb080400
    buffer_store_dwordx4 v[20:23], v6, s[4:7], s45 offen sc1
    v_accvgpr_read_b32 v8, a144
    v_accvgpr_read_b32 v9, a145
    v_accvgpr_read_b32 v10, a146
    v_accvgpr_read_b32 v11, a147
    v_accvgpr_read_b32 v12, a176
    v_accvgpr_read_b32 v13, a177
    v_accvgpr_read_b32 v14, a178
    v_accvgpr_read_b32 v15, a179
    v_cvt_pk_bf16_f32 v24, v8, v9
    v_cvt_pk_bf16_f32 v25, v10, v11
    v_cvt_pk_bf16_f32 v26, v12, v13
    v_cvt_pk_bf16_f32 v27, v14, v15
    s_mov_b32 s45, 0xb080800
    buffer_store_dwordx4 v[24:27], v6, s[4:7], s45 offen sc1
    v_accvgpr_read_b32 v8, a208
    v_accvgpr_read_b32 v9, a209
    v_accvgpr_read_b32 v10, a210
    v_accvgpr_read_b32 v11, a211
    v_accvgpr_read_b32 v12, a240
    v_accvgpr_read_b32 v13, a241
    v_accvgpr_read_b32 v14, a242
    v_accvgpr_read_b32 v15, a243
    v_cvt_pk_bf16_f32 v28, v8, v9
    v_cvt_pk_bf16_f32 v29, v10, v11
    v_cvt_pk_bf16_f32 v30, v12, v13
    v_cvt_pk_bf16_f32 v31, v14, v15
    s_mov_b32 s45, 0xb080c00
    buffer_store_dwordx4 v[28:31], v6, s[4:7], s45 offen sc1
    v_accvgpr_read_b32 v8, a20
    v_accvgpr_read_b32 v9, a21
    v_accvgpr_read_b32 v10, a22
    v_accvgpr_read_b32 v11, a23
    v_accvgpr_read_b32 v12, a52
    v_accvgpr_read_b32 v13, a53
    v_accvgpr_read_b32 v14, a54
    v_accvgpr_read_b32 v15, a55
    v_cvt_pk_bf16_f32 v16, v8, v9
    v_cvt_pk_bf16_f32 v17, v10, v11
    v_cvt_pk_bf16_f32 v18, v12, v13
    v_cvt_pk_bf16_f32 v19, v14, v15
    s_mov_b32 s45, 0xb081000
    buffer_store_dwordx4 v[16:19], v6, s[4:7], s45 offen sc1
    v_accvgpr_read_b32 v8, a84
    v_accvgpr_read_b32 v9, a85
    v_accvgpr_read_b32 v10, a86
    v_accvgpr_read_b32 v11, a87
    v_accvgpr_read_b32 v12, a116
    v_accvgpr_read_b32 v13, a117
    v_accvgpr_read_b32 v14, a118
    v_accvgpr_read_b32 v15, a119
    v_cvt_pk_bf16_f32 v20, v8, v9
    v_cvt_pk_bf16_f32 v21, v10, v11
    v_cvt_pk_bf16_f32 v22, v12, v13
    v_cvt_pk_bf16_f32 v23, v14, v15
    s_mov_b32 s45, 0xb081400
    buffer_store_dwordx4 v[20:23], v6, s[4:7], s45 offen sc1
    v_accvgpr_read_b32 v8, a148
    v_accvgpr_read_b32 v9, a149
    v_accvgpr_read_b32 v10, a150
    v_accvgpr_read_b32 v11, a151
    v_accvgpr_read_b32 v12, a180
    v_accvgpr_read_b32 v13, a181
    v_accvgpr_read_b32 v14, a182
    v_accvgpr_read_b32 v15, a183
    v_cvt_pk_bf16_f32 v24, v8, v9
    v_cvt_pk_bf16_f32 v25, v10, v11
    v_cvt_pk_bf16_f32 v26, v12, v13
    v_cvt_pk_bf16_f32 v27, v14, v15
    s_mov_b32 s45, 0xb081800
    buffer_store_dwordx4 v[24:27], v6, s[4:7], s45 offen sc1
    v_accvgpr_read_b32 v8, a212
    v_accvgpr_read_b32 v9, a213
    v_accvgpr_read_b32 v10, a214
    v_accvgpr_read_b32 v11, a215
    v_accvgpr_read_b32 v12, a244
    v_accvgpr_read_b32 v13, a245
    v_accvgpr_read_b32 v14, a246
    v_accvgpr_read_b32 v15, a247
    v_cvt_pk_bf16_f32 v28, v8, v9
    v_cvt_pk_bf16_f32 v29, v10, v11
    v_cvt_pk_bf16_f32 v30, v12, v13
    v_cvt_pk_bf16_f32 v31, v14, v15
    s_mov_b32 s45, 0xb081c00
    buffer_store_dwordx4 v[28:31], v6, s[4:7], s45 offen sc1
    v_accvgpr_read_b32 v8, a24
    v_accvgpr_read_b32 v9, a25
    v_accvgpr_read_b32 v10, a26
    v_accvgpr_read_b32 v11, a27
    v_accvgpr_read_b32 v12, a56
    v_accvgpr_read_b32 v13, a57
    v_accvgpr_read_b32 v14, a58
    v_accvgpr_read_b32 v15, a59
    v_cvt_pk_bf16_f32 v16, v8, v9
    v_cvt_pk_bf16_f32 v17, v10, v11
    v_cvt_pk_bf16_f32 v18, v12, v13
    v_cvt_pk_bf16_f32 v19, v14, v15
    s_mov_b32 s45, 0xb0c0000
    buffer_store_dwordx4 v[16:19], v6, s[4:7], s45 offen sc1
    v_accvgpr_read_b32 v8, a88
    v_accvgpr_read_b32 v9, a89
    v_accvgpr_read_b32 v10, a90
    v_accvgpr_read_b32 v11, a91
    v_accvgpr_read_b32 v12, a120
    v_accvgpr_read_b32 v13, a121
    v_accvgpr_read_b32 v14, a122
    v_accvgpr_read_b32 v15, a123
    v_cvt_pk_bf16_f32 v20, v8, v9
    v_cvt_pk_bf16_f32 v21, v10, v11
    v_cvt_pk_bf16_f32 v22, v12, v13
    v_cvt_pk_bf16_f32 v23, v14, v15
    s_mov_b32 s45, 0xb0c0400
    buffer_store_dwordx4 v[20:23], v6, s[4:7], s45 offen sc1
    v_accvgpr_read_b32 v8, a152
    v_accvgpr_read_b32 v9, a153
    v_accvgpr_read_b32 v10, a154
    v_accvgpr_read_b32 v11, a155
    v_accvgpr_read_b32 v12, a184
    v_accvgpr_read_b32 v13, a185
    v_accvgpr_read_b32 v14, a186
    v_accvgpr_read_b32 v15, a187
    v_cvt_pk_bf16_f32 v24, v8, v9
    v_cvt_pk_bf16_f32 v25, v10, v11
    v_cvt_pk_bf16_f32 v26, v12, v13
    v_cvt_pk_bf16_f32 v27, v14, v15
    s_mov_b32 s45, 0xb0c0800
    buffer_store_dwordx4 v[24:27], v6, s[4:7], s45 offen sc1
    v_accvgpr_read_b32 v8, a216
    v_accvgpr_read_b32 v9, a217
    v_accvgpr_read_b32 v10, a218
    v_accvgpr_read_b32 v11, a219
    v_accvgpr_read_b32 v12, a248
    v_accvgpr_read_b32 v13, a249
    v_accvgpr_read_b32 v14, a250
    v_accvgpr_read_b32 v15, a251
    v_cvt_pk_bf16_f32 v28, v8, v9
    v_cvt_pk_bf16_f32 v29, v10, v11
    v_cvt_pk_bf16_f32 v30, v12, v13
    v_cvt_pk_bf16_f32 v31, v14, v15
    s_mov_b32 s45, 0xb0c0c00
    buffer_store_dwordx4 v[28:31], v6, s[4:7], s45 offen sc1
    v_accvgpr_read_b32 v8, a28
    v_accvgpr_read_b32 v9, a29
    v_accvgpr_read_b32 v10, a30
    v_accvgpr_read_b32 v11, a31
    v_accvgpr_read_b32 v12, a60
    v_accvgpr_read_b32 v13, a61
    v_accvgpr_read_b32 v14, a62
    v_accvgpr_read_b32 v15, a63
    v_cvt_pk_bf16_f32 v16, v8, v9
    v_cvt_pk_bf16_f32 v17, v10, v11
    v_cvt_pk_bf16_f32 v18, v12, v13
    v_cvt_pk_bf16_f32 v19, v14, v15
    s_mov_b32 s45, 0xb0c1000
    buffer_store_dwordx4 v[16:19], v6, s[4:7], s45 offen sc1
    v_accvgpr_read_b32 v8, a92
    v_accvgpr_read_b32 v9, a93
    v_accvgpr_read_b32 v10, a94
    v_accvgpr_read_b32 v11, a95
    v_accvgpr_read_b32 v12, a124
    v_accvgpr_read_b32 v13, a125
    v_accvgpr_read_b32 v14, a126
    v_accvgpr_read_b32 v15, a127
    v_cvt_pk_bf16_f32 v20, v8, v9
    v_cvt_pk_bf16_f32 v21, v10, v11
    v_cvt_pk_bf16_f32 v22, v12, v13
    v_cvt_pk_bf16_f32 v23, v14, v15
    s_mov_b32 s45, 0xb0c1400
    buffer_store_dwordx4 v[20:23], v6, s[4:7], s45 offen sc1
    v_accvgpr_read_b32 v8, a156
    v_accvgpr_read_b32 v9, a157
    v_accvgpr_read_b32 v10, a158
    v_accvgpr_read_b32 v11, a159
    v_accvgpr_read_b32 v12, a188
    v_accvgpr_read_b32 v13, a189
    v_accvgpr_read_b32 v14, a190
    v_accvgpr_read_b32 v15, a191
    v_cvt_pk_bf16_f32 v24, v8, v9
    v_cvt_pk_bf16_f32 v25, v10, v11
    v_cvt_pk_bf16_f32 v26, v12, v13
    v_cvt_pk_bf16_f32 v27, v14, v15
    s_mov_b32 s45, 0xb0c1800
    buffer_store_dwordx4 v[24:27], v6, s[4:7], s45 offen sc1
    v_accvgpr_read_b32 v8, a220
    v_accvgpr_read_b32 v9, a221
    v_accvgpr_read_b32 v10, a222
    v_accvgpr_read_b32 v11, a223
    v_accvgpr_read_b32 v12, a252
    v_accvgpr_read_b32 v13, a253
    v_accvgpr_read_b32 v14, a254
    v_accvgpr_read_b32 v15, a255
    v_cvt_pk_bf16_f32 v28, v8, v9
    v_cvt_pk_bf16_f32 v29, v10, v11
    v_cvt_pk_bf16_f32 v30, v12, v13
    v_cvt_pk_bf16_f32 v31, v14, v15
    s_mov_b32 s45, 0xb0c1c00
    buffer_store_dwordx4 v[28:31], v6, s[4:7], s45 offen sc1
    s_lshl_b32 s75, s40, 12
    s_lshl_b32 s44, s41, 7
    s_add_u32 s75, s75, s44
    s_add_u32 s75, s75, 0x8c23100
    s_waitcnt vmcnt(0)
    s_barrier
    s_cmp_lg_u32 s42, 0
    s_cbranch_scc1 Lsig_147
    s_mov_b64 exec, 1
    v_mov_b32 v4, 1
    v_mov_b32 v5, 0
    buffer_atomic_add v4, v5, s[4:7], s75 offen
    s_mov_b64 exec, -1
Lsig_147:
    s_add_u32 s73, s73, 2
    s_cmp_eq_u32 s73, 3
    s_cbranch_scc0 Lq_148
    s_branch Lq_145
Lq_148:
Lcs_143:
    s_cmp_eq_u32 s71, 0
    s_cbranch_scc1 Lcg_150
    s_branch Lcs_149
Lcg_150:
    s_mov_b32 s73, 0
Latt_151:
    s_mov_b32 s41, s72
    s_and_b32 s86, s73, 3
    s_cmp_eq_u32 s86, 0
    s_cbranch_scc1 Lcg_153
    s_branch Lcs_152
Lcg_153:
    s_cmp_lt_u32 s73, 16
    s_cbranch_scc1 Lcg_154
    s_branch Lcs_152
Lcg_154:
    s_lshr_b32 s40, s73, 2
    s_lshl_b32 s75, s40, 12
    s_lshl_b32 s44, s41, 7
    s_add_u32 s75, s75, s44
    s_add_u32 s75, s75, 0x8c23100
    s_cmp_lg_u32 s42, 0
    s_cbranch_scc1 Lwtd_156
    v_mov_b32 v5, 0
    s_mov_b32 s74, 0
Lwt_155:
    buffer_load_dword v4, v5, s[4:7], s75 offen sc1
    s_waitcnt vmcnt(0)
    v_cmp_gt_u32 vcc, 0x1, v4
    s_cbranch_vccz Lwtd_156
    s_sleep 8
    s_add_u32 s74, s74, 1
    s_cmp_lt_u32 s74, 4000000
    s_cbranch_scc1 Lwt_155
Lwtd_156:
    s_barrier
Lcs_152:
    s_min_u32 s40, s73, 15
    s_lshr_b32 s86, s42, 1
    s_add_u32 s86, s86, 15
    s_cmp_lg_u32 s86, s73
    s_cselect_b32 s87, 1, 0
    s_cmp_lt_u32 s73, 15
    s_cselect_b32 s87, 0, s87
    s_cmp_eq_u32 s73, 0
    s_cbranch_scc1 Lcg_158
    s_branch Lcs_157
Lcg_158:
    s_lshl_b32 s75, s40, 12
    s_lshl_b32 s44, s41, 7
    s_add_u32 s75, s75, s44
    s_add_u32 s75, s75, 0x8c01000
    s_cmp_lg_u32 s42, 0
    s_cbranch_scc1 Lwtd_160
    v_mov_b32 v5, 0
    s_mov_b32 s74, 0
Lwt_159:
    buffer_load_dword v4, v5, s[4:7], s75 offen sc1
    s_waitcnt vmcnt(0)
    v_cmp_gt_u32 vcc, 0x1, v4
    s_cbranch_vccz Lwtd_160
    s_sleep 8
    s_add_u32 s74, s74, 1
    s_cmp_lt_u32 s74, 4000000
    s_cbranch_scc1 Lwt_159
Lwtd_160:
    s_barrier
    s_lshl_b32 s75, s40, 12
    s_lshl_b32 s44, s41, 7
    s_add_u32 s75, s75, s44
    s_add_u32 s75, s75, 0x8c27180
    s_cmp_lg_u32 s42, 0
    s_cbranch_scc1 Lwtd_162
    v_mov_b32 v5, 0
    s_mov_b32 s74, 0
Lwt_161:
    buffer_load_dword v4, v5, s[4:7], s75 offen sc1
    s_waitcnt vmcnt(0)
    v_cmp_gt_u32 vcc, 0x1, v4
    s_cbranch_vccz Lwtd_162
    s_sleep 8
    s_add_u32 s74, s74, 1
    s_cmp_lt_u32 s74, 4000000
    s_cbranch_scc1 Lwt_161
Lwtd_162:
    s_barrier
Lcs_157:
    s_mov_b32 s66, 0x3e0293ee
    v_mov_b32 v13, 0xff800000
    s_mov_b32 s64, -1
    s_mov_b32 s65, 0
    v_lshlrev_b32 v9, 4, v1
    v_lshl_add_u32 v6, v3, 2, 0
    v_cmp_le_u32 s[56:57], v6, v2
    v_lshl_add_u32 v6, v3, 2, 1
    v_cmp_le_u32 s[58:59], v6, v2
    v_lshl_add_u32 v6, v3, 2, 2
    v_cmp_le_u32 s[60:61], v6, v2
    v_lshl_add_u32 v6, v3, 2, 3
    v_cmp_le_u32 s[62:63], v6, v2
    v_and_b32 v6, 7, v2
    v_lshl_add_u32 v6, v3, 3, v6
    v_lshlrev_b32 v10, 4, v6
    s_lshl_b32 s68, s42, 15
    v_lshrrev_b32 v6, 2, v2
    v_lshl_add_u32 v6, v3, 2, v6
    v_and_b32 v7, 3, v2
    v_lshl_add_u32 v8, v7, 4, v6
    v_lshlrev_b32 v8, 4, v8
    v_add_u32 v11, s68, v8
    v_and_b32 v6, 7, v6
    v_lshl_add_u32 v8, v7, 3, v6
    v_lshlrev_b32 v8, 4, v8
    v_add_u32 v12, s68, v8
    s_lshl_b32 s44, s40, 2
    s_add_u32 s44, s44, s42
    s_mul_i32 s44, s44, 32
    s_add_u32 s67, s44, s41
    s_add_u32 s44, s67, 0
    s_lshl_b32 s44, s44, 13
    s_add_u32 s45, s44, 0x0
    buffer_load_dwordx4 a[128:131], v9, s[4:7], s45 offen
    s_add_u32 s45, s44, 0x400
    buffer_load_dwordx4 a[132:135], v9, s[4:7], s45 offen
    s_add_u32 s45, s44, 0x800
    buffer_load_dwordx4 a[136:139], v9, s[4:7], s45 offen
    s_add_u32 s45, s44, 0xc00
    buffer_load_dwordx4 a[140:143], v9, s[4:7], s45 offen
    s_add_u32 s45, s44, 0x1000
    buffer_load_dwordx4 a[144:147], v9, s[4:7], s45 offen
    s_add_u32 s45, s44, 0x1400
    buffer_load_dwordx4 a[148:151], v9, s[4:7], s45 offen
    s_add_u32 s45, s44, 0x1800
    buffer_load_dwordx4 a[152:155], v9, s[4:7], s45 offen
    s_add_u32 s45, s44, 0x1c00
    buffer_load_dwordx4 a[156:159], v9, s[4:7], s45 offen
    s_add_u32 m0, s68, 0
    s_add_u32 s45, s44, 0x1000000
    buffer_load_dwordx4 v9, s[4:7], s45 offen lds
    s_add_u32 m0, s68, 1024
    s_add_u32 s45, s44, 0x1000400
    buffer_load_dwordx4 v9, s[4:7], s45 offen lds
    s_add_u32 m0, s68, 2048
    s_add_u32 s45, s44, 0x1000800
    buffer_load_dwordx4 v9, s[4:7], s45 offen lds
    s_add_u32 m0, s68, 3072
    s_add_u32 s45, s44, 0x1000c00
    buffer_load_dwordx4 v9, s[4:7], s45 offen lds
    s_add_u32 m0, s68, 4096
    s_add_u32 s45, s44, 0x1001000
    buffer_load_dwordx4 v9, s[4:7], s45 offen lds
    s_add_u32 m0, s68, 5120
    s_add_u32 s45, s44, 0x1001400
    buffer_load_dwordx4 v9, s[4:7], s45 offen lds
    s_add_u32 m0, s68, 6144
    s_add_u32 s45, s44, 0x1001800
    buffer_load_dwordx4 v9, s[4:7], s45 offen lds
    s_add_u32 m0, s68, 7168
    s_add_u32 s45, s44, 0x1001c00
    buffer_load_dwordx4 v9, s[4:7], s45 offen lds
    s_add_u32 s45, s44, 0xb000000
    buffer_load_dwordx4 v[20:23], v9, s[4:7], s45 offen
    s_add_u32 s45, s44, 0xb000400
    buffer_load_dwordx4 v[24:27], v9, s[4:7], s45 offen
    s_add_u32 s45, s44, 0xb000800
    buffer_load_dwordx4 v[28:31], v9, s[4:7], s45 offen
    s_add_u32 s45, s44, 0xb000c00
    buffer_load_dwordx4 v[32:35], v9, s[4:7], s45 offen
    s_add_u32 s45, s44, 0xb001000
    buffer_load_dwordx4 v[36:39], v9, s[4:7], s45 offen
    s_add_u32 s45, s44, 0xb001400
    buffer_load_dwordx4 v[40:43], v9, s[4:7], s45 offen
    s_add_u32 s45, s44, 0xb001800
    buffer_load_dwordx4 v[44:47], v9, s[4:7], s45 offen
    s_add_u32 s45, s44, 0xb001c00
    buffer_load_dwordx4 v[48:51], v9, s[4:7], s45 offen
    s_lshl_b32 s75, s40, 12
    s_lshl_b32 s44, s41, 7
    s_add_u32 s75, s75, s44
    s_add_u32 s75, s75, 0x8c11000
    s_cmp_eq_u32 s73, 15
    s_cselect_b32 s86, 4096, 0
    s_add_u32 s75, s75, s86
    s_cmp_lg_u32 s42, 0
    s_cbranch_scc1 Lwtd_164
    v_mov_b32 v5, 0
    s_mov_b32 s74, 0
Lwt_163:
    buffer_load_dword v4, v5, s[4:7], s75 offen sc1
    s_waitcnt vmcnt(0)
    v_cmp_gt_u32 vcc, 0x10, v4
    s_cbranch_vccz Lwtd_164
    s_sleep 8
    s_add_u32 s74, s74, 1
    s_cmp_lt_u32 s74, 4000000
    s_cbranch_scc1 Lwt_163
Lwtd_164:
    s_barrier
    s_cmp_eq_u32 s87, 0
    s_cbranch_scc1 Latg_166
    s_branch Lats_165
Latg_166:
    s_add_u32 s44, s67, 0
    s_lshl_b32 s44, s44, 11
    s_add_u32 m0, s68, 8192
    s_add_u32 s45, s44, 0x7600000
    buffer_load_dwordx4 v9, s[4:7], s45 offen lds
    s_add_u32 m0, s68, 9216
    s_add_u32 s45, s44, 0x7600400
    buffer_load_dwordx4 v9, s[4:7], s45 offen lds
    s_add_u32 s44, s67, 0
    s_lshl_b32 s44, s44, 11
    s_add_u32 s44, s44, 0x7200000
    buffer_load_dwordx4 v[92:95], v10, s[4:7], s44 offen offset:0
    buffer_load_dwordx4 v[96:99], v10, s[4:7], s44 offen offset:512
    buffer_load_dwordx4 v[100:103], v10, s[4:7], s44 offen offset:1024
    buffer_load_dwordx4 v[104:107], v10, s[4:7], s44 offen offset:1536
    s_waitcnt vmcnt(0)
    ds_read_b64_tr_b16 v[140:141], v11 offset:0
    ds_read_b64_tr_b16 v[142:143], v11 offset:4096
    ds_read_b64_tr_b16 v[172:173], v12 offset:8192
    ds_read_b64_tr_b16 v[144:145], v11 offset:8
    ds_read_b64_tr_b16 v[146:147], v11 offset:4104
    ds_read_b64_tr_b16 v[174:175], v12 offset:8200
    ds_read_b64_tr_b16 v[148:149], v11 offset:1024
    ds_read_b64_tr_b16 v[150:151], v11 offset:5120
    ds_read_b64_tr_b16 v[176:177], v12 offset:8704
    ds_read_b64_tr_b16 v[152:153], v11 offset:1032
    ds_read_b64_tr_b16 v[154:155], v11 offset:5128
    ds_read_b64_tr_b16 v[178:179], v12 offset:8712
    s_waitcnt lgkmcnt(0)
    ds_read_b64_tr_b16 v[156:157], v11 offset:2048
    ds_read_b64_tr_b16 v[158:159], v11 offset:6144
    ds_read_b64_tr_b16 v[180:181], v12 offset:9216
    ds_read_b64_tr_b16 v[160:161], v11 offset:2056
    ds_read_b64_tr_b16 v[162:163], v11 offset:6152
    ds_read_b64_tr_b16 v[182:183], v12 offset:9224
    ds_read_b64_tr_b16 v[164:165], v11 offset:3072
    ds_read_b64_tr_b16 v[166:167], v11 offset:7168
    ds_read_b64_tr_b16 v[184:185], v12 offset:9728
    ds_read_b64_tr_b16 v[168:169], v11 offset:3080
    ds_read_b64_tr_b16 v[170:171], v11 offset:7176
    ds_read_b64_tr_b16 v[186:187], v12 offset:9736
    s_waitcnt lgkmcnt(0)
    v_mfma_f32_16x16x32_bf16 v[108:111], v[92:95], v[20:23], 0
    v_mfma_f32_16x16x32_bf16 v[112:115], a[128:131], v[20:23], 0
    v_mfma_f32_16x16x32_bf16 v[116:119], v[92:95], v[36:39], 0
    v_mfma_f32_16x16x32_bf16 v[120:123], a[128:131], v[36:39], 0
    v_mfma_f32_16x16x32_bf16 v[124:127], a[144:147], v[36:39], 0
    v_mfma_f32_16x16x32_bf16 v[108:111], v[96:99], v[24:27], v[108:111]
    v_mfma_f32_16x16x32_bf16 v[112:115], a[132:135], v[24:27], v[112:115]
    v_mfma_f32_16x16x32_bf16 v[116:119], v[96:99], v[40:43], v[116:119]
    v_mfma_f32_16x16x32_bf16 v[120:123], a[132:135], v[40:43], v[120:123]
    v_mfma_f32_16x16x32_bf16 v[124:127], a[148:151], v[40:43], v[124:127]
    v_mfma_f32_16x16x32_bf16 v[108:111], v[100:103], v[28:31], v[108:111]
    v_mfma_f32_16x16x32_bf16 v[112:115], a[136:139], v[28:31], v[112:115]
    v_mfma_f32_16x16x32_bf16 v[116:119], v[100:103], v[44:47], v[116:119]
    v_mfma_f32_16x16x32_bf16 v[120:123], a[136:139], v[44:47], v[120:123]
    v_mfma_f32_16x16x32_bf16 v[124:127], a[152:155], v[44:47], v[124:127]
    v_mfma_f32_16x16x32_bf16 v[108:111], v[104:107], v[32:35], v[108:111]
    v_mfma_f32_16x16x32_bf16 v[112:115], a[140:143], v[32:35], v[112:115]
    v_mfma_f32_16x16x32_bf16 v[116:119], v[104:107], v[48:51], v[116:119]
    v_mfma_f32_16x16x32_bf16 v[120:123], a[140:143], v[48:51], v[120:123]
    v_mfma_f32_16x16x32_bf16 v[124:127], a[156:159], v[48:51], v[124:127]
    s_nop 7
    v_cndmask_b32 v108, v13, v108, s[64:65]
    v_cndmask_b32 v112, v13, v112, s[56:57]
    v_cndmask_b32 v109, v13, v109, s[64:65]
    v_cndmask_b32 v113, v13, v113, s[58:59]
    v_cndmask_b32 v110, v13, v110, s[64:65]
    v_cndmask_b32 v114, v13, v114, s[60:61]
    v_cndmask_b32 v111, v13, v111, s[64:65]
    v_cndmask_b32 v115, v13, v115, s[62:63]
    v_max3_f32 v14, v108, v109, v110
    v_max3_f32 v14, v14, v111, v112
    v_max3_f32 v14, v14, v113, v114
    v_max_f32 v14, v14, v115
    v_mov_b32 v15, v14
    s_nop 1
    v_permlane16_swap_b32 v14, v15
    s_nop 0
    v_max_f32 v14, v14, v15
    v_mov_b32 v15, v14
    s_nop 1
    v_permlane32_swap_b32 v14, v15
    s_nop 0
    v_max_f32 v14, v14, v15
    v_mul_f32 v14, s66, v14
    v_fma_f32 v108, v108, s66, -v14
    v_fma_f32 v109, v109, s66, -v14
    v_fma_f32 v110, v110, s66, -v14
    v_fma_f32 v111, v111, s66, -v14
    v_fma_f32 v112, v112, s66, -v14
    v_fma_f32 v113, v113, s66, -v14
    v_fma_f32 v114, v114, s66, -v14
    v_fma_f32 v115, v115, s66, -v14
    v_exp_f32 v108, v108
    v_exp_f32 v109, v109
    v_exp_f32 v110, v110
    v_exp_f32 v111, v111
    v_exp_f32 v112, v112
    v_exp_f32 v113, v113
    v_exp_f32 v114, v114
    v_exp_f32 v115, v115
    s_nop 0
    v_add_f32 v16, v108, v109
    v_add_f32 v16, v16, v110
    v_add_f32 v16, v16, v111
    v_add_f32 v16, v16, v112
    v_add_f32 v16, v16, v113
    v_add_f32 v16, v16, v114
    v_add_f32 v16, v16, v115
    v_mov_b32 v15, v16
    s_nop 1
    v_permlane16_swap_b32 v16, v15
    s_nop 0
    v_add_f32 v16, v16, v15
    v_mov_b32 v15, v16
    s_nop 1
    v_permlane32_swap_b32 v16, v15
    s_nop 0
    v_add_f32 v16, v16, v15
    v_rcp_f32 v16, v16
    s_nop 0
    v_mul_f32 v108, v108, v16
    v_mul_f32 v109, v109, v16
    v_mul_f32 v110, v110, v16
    v_mul_f32 v111, v111, v16
    v_mul_f32 v112, v112, v16
    v_mul_f32 v113, v113, v16
    v_mul_f32 v114, v114, v16
    v_mul_f32 v115, v115, v16
    v_cvt_pk_bf16_f32 v132, v108, v109
    v_cvt_pk_bf16_f32 v133, v110, v111
    v_cvt_pk_bf16_f32 v84, v112, v113
    v_cvt_pk_bf16_f32 v85, v114, v115
    v_mov_b32 v86, 0
    v_mov_b32 v87, 0
    s_nop 1
    v_mfma_f32_16x16x32_bf16 v[188:191], v[140:143], v[84:87], 0
    v_mfma_f32_16x16x32_bf16 v[192:195], v[144:147], v[84:87], 0
    v_mfma_f32_16x16x32_bf16 v[196:199], v[148:151], v[84:87], 0
    v_mfma_f32_16x16x32_bf16 v[200:203], v[152:155], v[84:87], 0
    v_mfma_f32_16x16x32_bf16 v[204:207], v[156:159], v[84:87], 0
    v_mfma_f32_16x16x32_bf16 v[208:211], v[160:163], v[84:87], 0
    v_mfma_f32_16x16x32_bf16 v[212:215], v[164:167], v[84:87], 0
    v_mfma_f32_16x16x32_bf16 v[216:219], v[168:171], v[84:87], 0
    v_mfma_f32_16x16x16_bf16 v[188:191], v[172:173], v[132:133], v[188:191]
    v_mfma_f32_16x16x16_bf16 v[192:195], v[174:175], v[132:133], v[192:195]
    v_mfma_f32_16x16x16_bf16 v[196:199], v[176:177], v[132:133], v[196:199]
    v_mfma_f32_16x16x16_bf16 v[200:203], v[178:179], v[132:133], v[200:203]
    v_mfma_f32_16x16x16_bf16 v[204:207], v[180:181], v[132:133], v[204:207]
    v_mfma_f32_16x16x16_bf16 v[208:211], v[182:183], v[132:133], v[208:211]
    v_mfma_f32_16x16x16_bf16 v[212:215], v[184:185], v[132:133], v[212:215]
    v_mfma_f32_16x16x16_bf16 v[216:219], v[186:187], v[132:133], v[216:219]
    s_nop 7
    s_add_u32 s44, s67, 0
    s_lshl_b32 s44, s44, 1
    s_sub_u32 s44, s44, s41
    s_add_u32 s44, s44, 0
    s_lshl_b32 s44, s44, 12
    s_add_u32 s44, s44, 0x7a00000
    v_cvt_pk_bf16_f32 v220, v188, v189
    v_cvt_pk_bf16_f32 v221, v190, v191
    v_cvt_pk_bf16_f32 v222, v192, v193
    v_cvt_pk_bf16_f32 v223, v194, v195
    v_cvt_pk_bf16_f32 v224, v196, v197
    v_cvt_pk_bf16_f32 v225, v198, v199
    v_cvt_pk_bf16_f32 v226, v200, v201
    v_cvt_pk_bf16_f32 v227, v202, v203
    v_cvt_pk_bf16_f32 v228, v204, v205
    v_cvt_pk_bf16_f32 v229, v206, v207
    v_cvt_pk_bf16_f32 v230, v208, v209
    v_cvt_pk_bf16_f32 v231, v210, v211
    v_cvt_pk_bf16_f32 v232, v212, v213
    v_cvt_pk_bf16_f32 v233, v214, v215
    v_cvt_pk_bf16_f32 v234, v216, v217
    v_cvt_pk_bf16_f32 v235, v218, v219
    s_cmp_lt_u32 s40, 6
    s_cbranch_scc1 Lrm_167
    buffer_store_dwordx4 v[220:223], v9, s[4:7], s44 offen offset:0 sc1
    buffer_store_dwordx4 v[224:227], v9, s[4:7], s44 offen offset:1024 sc1
    buffer_store_dwordx4 v[228:231], v9, s[4:7], s44 offen offset:2048 sc1
    buffer_store_dwordx4 v[232:235], v9, s[4:7], s44 offen offset:3072 sc1
    s_branch Lrd_168
Lrm_167:
    s_add_u32 s44, s67, 0
    s_sub_u32 s44, s44, s41
    s_add_u32 s44, s44, 0
    s_lshl_b32 s44, s44, 13
    s_lshl_b32 s45, s41, 8
    s_add_u32 s44, s44, s45
    s_add_u32 s44, s44, 0x7a00000
    v_lshlrev_b32 v6, 13, v2
    v_lshl_add_u32 v6, v3, 3, v6
    buffer_store_dwordx2 v[220:221], v6, s[4:7], s44 offen offset:0 sc1
    buffer_store_dwordx2 v[222:223], v6, s[4:7], s44 offen offset:32 sc1
    buffer_store_dwordx2 v[224:225], v6, s[4:7], s44 offen offset:64 sc1
    buffer_store_dwordx2 v[226:227], v6, s[4:7], s44 offen offset:96 sc1
    buffer_store_dwordx2 v[228:229], v6, s[4:7], s44 offen offset:128 sc1
    buffer_store_dwordx2 v[230:231], v6, s[4:7], s44 offen offset:160 sc1
    buffer_store_dwordx2 v[232:233], v6, s[4:7], s44 offen offset:192 sc1
    buffer_store_dwordx2 v[234:235], v6, s[4:7], s44 offen offset:224 sc1
Lrd_168:
    s_nop 1
    v_cndmask_b32 v116, v13, v116, s[64:65]
    v_cndmask_b32 v124, v13, v124, s[56:57]
    v_cndmask_b32 v117, v13, v117, s[64:65]
    v_cndmask_b32 v125, v13, v125, s[58:59]
    v_cndmask_b32 v118, v13, v118, s[64:65]
    v_cndmask_b32 v126, v13, v126, s[60:61]
    v_cndmask_b32 v119, v13, v119, s[64:65]
    v_cndmask_b32 v127, v13, v127, s[62:63]
    v_max3_f32 v14, v116, v117, v118
    v_max3_f32 v14, v14, v119, v120
    v_max3_f32 v14, v14, v121, v122
    v_max3_f32 v14, v14, v123, v124
    v_max3_f32 v14, v14, v125, v126
    v_max_f32 v14, v14, v127
    v_mov_b32 v15, v14
    s_nop 1
    v_permlane16_swap_b32 v14, v15
    s_nop 0
    v_max_f32 v14, v14, v15
    v_mov_b32 v15, v14
    s_nop 1
    v_permlane32_swap_b32 v14, v15
    s_nop 0
    v_max_f32 v14, v14, v15
    v_mul_f32 v14, s66, v14
    v_fma_f32 v116, v116, s66, -v14
    v_fma_f32 v117, v117, s66, -v14
    v_fma_f32 v118, v118, s66, -v14
    v_fma_f32 v119, v119, s66, -v14
    v_fma_f32 v120, v120, s66, -v14
    v_fma_f32 v121, v121, s66, -v14
    v_fma_f32 v122, v122, s66, -v14
    v_fma_f32 v123, v123, s66, -v14
    v_fma_f32 v124, v124, s66, -v14
    v_fma_f32 v125, v125, s66, -v14
    v_fma_f32 v126, v126, s66, -v14
    v_fma_f32 v127, v127, s66, -v14
    v_exp_f32 v116, v116
    v_exp_f32 v117, v117
    v_exp_f32 v118, v118
    v_exp_f32 v119, v119
    v_exp_f32 v120, v120
    v_exp_f32 v121, v121
    v_exp_f32 v122, v122
    v_exp_f32 v123, v123
    v_exp_f32 v124, v124
    v_exp_f32 v125, v125
    v_exp_f32 v126, v126
    v_exp_f32 v127, v127
    s_nop 0
    v_add_f32 v16, v116, v117
    v_add_f32 v16, v16, v118
    v_add_f32 v16, v16, v119
    v_add_f32 v16, v16, v120
    v_add_f32 v16, v16, v121
    v_add_f32 v16, v16, v122
    v_add_f32 v16, v16, v123
    v_add_f32 v16, v16, v124
    v_add_f32 v16, v16, v125
    v_add_f32 v16, v16, v126
    v_add_f32 v16, v16, v127
    v_mov_b32 v15, v16
    s_nop 1
    v_permlane16_swap_b32 v16, v15
    s_nop 0
    v_add_f32 v16, v16, v15
    v_mov_b32 v15, v16
    s_nop 1
    v_permlane32_swap_b32 v16, v15
    s_nop 0
    v_add_f32 v16, v16, v15
    v_rcp_f32 v16, v16
    s_nop 0
    v_mul_f32 v116, v116, v16
    v_mul_f32 v117, v117, v16
    v_mul_f32 v118, v118, v16
    v_mul_f32 v119, v119, v16
    v_mul_f32 v120, v120, v16
    v_mul_f32 v121, v121, v16
    v_mul_f32 v122, v122, v16
    v_mul_f32 v123, v123, v16
    v_mul_f32 v124, v124, v16
    v_mul_f32 v125, v125, v16
    v_mul_f32 v126, v126, v16
    v_mul_f32 v127, v127, v16
    v_cvt_pk_bf16_f32 v138, v116, v117
    v_cvt_pk_bf16_f32 v139, v118, v119
    v_cvt_pk_bf16_f32 v84, v120, v121
    v_cvt_pk_bf16_f32 v85, v122, v123
    v_cvt_pk_bf16_f32 v86, v124, v125
    v_cvt_pk_bf16_f32 v87, v126, v127
    s_nop 1
    v_mfma_f32_16x16x32_bf16 v[188:191], v[140:143], v[84:87], 0
    v_mfma_f32_16x16x32_bf16 v[192:195], v[144:147], v[84:87], 0
    v_mfma_f32_16x16x32_bf16 v[196:199], v[148:151], v[84:87], 0
    v_mfma_f32_16x16x32_bf16 v[200:203], v[152:155], v[84:87], 0
    v_mfma_f32_16x16x32_bf16 v[204:207], v[156:159], v[84:87], 0
    v_mfma_f32_16x16x32_bf16 v[208:211], v[160:163], v[84:87], 0
    v_mfma_f32_16x16x32_bf16 v[212:215], v[164:167], v[84:87], 0
    v_mfma_f32_16x16x32_bf16 v[216:219], v[168:171], v[84:87], 0
    v_mfma_f32_16x16x16_bf16 v[188:191], v[172:173], v[138:139], v[188:191]
    v_mfma_f32_16x16x16_bf16 v[192:195], v[174:175], v[138:139], v[192:195]
    v_mfma_f32_16x16x16_bf16 v[196:199], v[176:177], v[138:139], v[196:199]
    v_mfma_f32_16x16x16_bf16 v[200:203], v[178:179], v[138:139], v[200:203]
    v_mfma_f32_16x16x16_bf16 v[204:207], v[180:181], v[138:139], v[204:207]
    v_mfma_f32_16x16x16_bf16 v[208:211], v[182:183], v[138:139], v[208:211]
    v_mfma_f32_16x16x16_bf16 v[212:215], v[184:185], v[138:139], v[212:215]
    v_mfma_f32_16x16x16_bf16 v[216:219], v[186:187], v[138:139], v[216:219]
    s_nop 7
    s_add_u32 s44, s67, 0
    s_lshl_b32 s44, s44, 1
    s_sub_u32 s44, s44, s41
    s_add_u32 s44, s44, 32
    s_lshl_b32 s44, s44, 12
    s_add_u32 s44, s44, 0x7a00000
    v_cvt_pk_bf16_f32 v220, v188, v189
    v_cvt_pk_bf16_f32 v221, v190, v191
    v_cvt_pk_bf16_f32 v222, v192, v193
    v_cvt_pk_bf16_f32 v223, v194, v195
    v_cvt_pk_bf16_f32 v224, v196, v197
    v_cvt_pk_bf16_f32 v225, v198, v199
    v_cvt_pk_bf16_f32 v226, v200, v201
    v_cvt_pk_bf16_f32 v227, v202, v203
    v_cvt_pk_bf16_f32 v228, v204, v205
    v_cvt_pk_bf16_f32 v229, v206, v207
    v_cvt_pk_bf16_f32 v230, v208, v209
    v_cvt_pk_bf16_f32 v231, v210, v211
    v_cvt_pk_bf16_f32 v232, v212, v213
    v_cvt_pk_bf16_f32 v233, v214, v215
    v_cvt_pk_bf16_f32 v234, v216, v217
    v_cvt_pk_bf16_f32 v235, v218, v219
    s_cmp_lt_u32 s40, 6
    s_cbranch_scc1 Lrm_169
    buffer_store_dwordx4 v[220:223], v9, s[4:7], s44 offen offset:0 sc1
    buffer_store_dwordx4 v[224:227], v9, s[4:7], s44 offen offset:1024 sc1
    buffer_store_dwordx4 v[228:231], v9, s[4:7], s44 offen offset:2048 sc1
    buffer_store_dwordx4 v[232:235], v9, s[4:7], s44 offen offset:3072 sc1
    s_branch Lrd_170
Lrm_169:
    s_add_u32 s44, s67, 0
    s_sub_u32 s44, s44, s41
    s_add_u32 s44, s44, 16
    s_lshl_b32 s44, s44, 13
    s_lshl_b32 s45, s41, 8
    s_add_u32 s44, s44, s45
    s_add_u32 s44, s44, 0x7a00000
    v_lshlrev_b32 v6, 13, v2
    v_lshl_add_u32 v6, v3, 3, v6
    buffer_store_dwordx2 v[220:221], v6, s[4:7], s44 offen offset:0 sc1
    buffer_store_dwordx2 v[222:223], v6, s[4:7], s44 offen offset:32 sc1
    buffer_store_dwordx2 v[224:225], v6, s[4:7], s44 offen offset:64 sc1
    buffer_store_dwordx2 v[226:227], v6, s[4:7], s44 offen offset:96 sc1
    buffer_store_dwordx2 v[228:229], v6, s[4:7], s44 offen offset:128 sc1
    buffer_store_dwordx2 v[230:231], v6, s[4:7], s44 offen offset:160 sc1
    buffer_store_dwordx2 v[232:233], v6, s[4:7], s44 offen offset:192 sc1
    buffer_store_dwordx2 v[234:235], v6, s[4:7], s44 offen offset:224 sc1
Lrd_170:
    s_nop 1
Lats_165:
    s_lshl_b32 s75, s73, 7
    s_add_u32 s75, s75, 0x8c22000
    s_waitcnt vmcnt(0)
    s_barrier
    s_cmp_lg_u32 s42, 0
    s_cbranch_scc1 Lsig_171
    s_mov_b64 exec, 1
    v_mov_b32 v4, 1
    v_mov_b32 v5, 0
    buffer_atomic_add v4, v5, s[4:7], s75 offen
    s_mov_b64 exec, -1
Lsig_171:
    s_add_u32 s73, s73, 1
    s_cmp_lt_u32 s73, 17
    s_cbranch_scc0 Latte_172
    s_branch Latt_151
Latte_172:
    s_endpgm
Lcs_149:
    s_add_u32 s85, s72, 32
    s_cmp_eq_u32 s71, 1
    s_cselect_b32 s85, s85, 99
    s_cmp_eq_u32 s71, 2
    s_cselect_b32 s85, s72, s85
    s_cmp_lt_u32 s85, 30
    s_cbranch_scc1 Lcg_174
    s_branch Lcs_173
Lcg_174:
    s_mul_i32 s40, s85, 52
    s_lshr_b32 s40, s40, 8
    s_mul_i32 s44, s40, 5
    s_sub_u32 s41, s85, s44
    s_lshl_b32 s75, s40, 7
    s_add_u32 s75, s75, 0x8c22000
    s_cmp_lg_u32 s42, 0
    s_cbranch_scc1 Lwtd_176
    v_mov_b32 v5, 0
    s_mov_b32 s74, 0
Lwt_175:
    buffer_load_dword v4, v5, s[4:7], s75 offen sc1
    s_waitcnt vmcnt(0)
    v_cmp_gt_u32 vcc, 0x20, v4
    s_cbranch_vccz Lwtd_176
    s_sleep 8
    s_add_u32 s74, s74, 1
    s_cmp_lt_u32 s74, 4000000
    s_cbranch_scc1 Lwt_175
Lwtd_176:
    s_barrier
    s_mov_b32 s20, s34
    s_and_b32 s21, s35, 0xffff
    s_mov_b32 s22, 0x500000
    s_mov_b32 s23, 0x00020000
    s_mov_b32 s12, s38
    s_and_b32 s13, s39, 0xffff
    s_mov_b32 s14, 0x500000
    s_mov_b32 s15, 0x00020000
    s_and_b32 s44, s42, 1
    s_lshl_b32 s44, s44, 2
    v_or_b32 v6, s44, v3
    v_lshrrev_b32 v7, 1, v2
    v_xor_b32 v7, v7, v6
    v_and_b32 v8, 1, v2
    v_lshl_add_u32 v7, v7, 1, v8
    v_lshlrev_b32 v7, 4, v7
    v_mul_u32_u24 v8, 1280, v3
    v_add_u32 v7, v7, v8
    s_mul_i32 s44, s42, 10240
    s_lshl_b32 s45, s41, 8
    s_add_u32 s44, s44, s45
    v_add_u32 v9, s44, v7
    v_lshrrev_b32 v6, 2, v1
    v_mul_u32_u24 v6, 8192, v6
    v_and_b32 v7, 3, v1
    v_xor_b32 v7, v7, v3
    v_lshl_add_u32 v6, v7, 4, v6
    s_lshl_b32 s44, s40, 2
    s_add_u32 s44, s44, s42
    s_mul_i32 s44, s44, 262144
    v_add_u32 v10, s44, v6
    v_lshrrev_b32 v6, 2, v2
    v_and_b32 v7, 1, v3
    v_lshl_or_b32 v7, v7, 2, v6
    v_lshl_add_u32 v6, v3, 3, v6
    v_lshlrev_b32 v6, 8, v6
    v_and_b32 v8, 3, v2
    v_lshl_add_u32 v6, v8, 3, v6
    v_xor_b32 v8, 0, v7
    v_lshl_add_u32 v12, v8, 5, v6
    v_add_u32 v20, 0x10000, v12
    v_xor_b32 v8, 1, v7
    v_lshl_add_u32 v13, v8, 5, v6
    v_add_u32 v21, 0x10000, v13
    v_xor_b32 v8, 2, v7
    v_lshl_add_u32 v14, v8, 5, v6
    v_add_u32 v22, 0x10000, v14
    v_xor_b32 v8, 3, v7
    v_lshl_add_u32 v15, v8, 5, v6
    v_add_u32 v23, 0x10000, v15
    v_xor_b32 v8, 4, v7
    v_lshl_add_u32 v16, v8, 5, v6
    v_add_u32 v24, 0x10000, v16
    v_xor_b32 v8, 5, v7
    v_lshl_add_u32 v17, v8, 5, v6
    v_add_u32 v25, 0x10000, v17
    v_xor_b32 v8, 6, v7
    v_lshl_add_u32 v18, v8, 5, v6
    v_add_u32 v26, 0x10000, v18
    v_xor_b32 v8, 7, v7
    v_lshl_add_u32 v19, v8, 5, v6
    v_add_u32 v27, 0x10000, v19
    v_lshrrev_b32 v6, 2, v2
    v_xor_b32 v6, v6, v3
    v_lshlrev_b32 v6, 4, v6
    v_lshl_add_u32 v6, v2, 6, v6
    s_mul_i32 s44, s42, 2048
    s_add_u32 s44, s44, 8192
    v_add_u32 v28, s44, v6
    v_add_u32 v29, 0x10000, v28
    s_lshl_b32 s50, s42, 11
    s_mov_b32 s51, s44
    s_mov_b32 s46, 0
    s_mov_b32 s47, 0x7a00000
    s_mov_b32 s53, 0
    s_add_u32 m0, s50, 0
    s_add_u32 s52, s46, 0x0
    buffer_load_dwordx4 v9, s[20:23], s52 offen lds
    s_add_u32 m0, s50, 1024
    s_add_u32 s52, s46, 0x1400
    buffer_load_dwordx4 v9, s[20:23], s52 offen lds
    s_add_u32 m0, s51, 0
    s_add_u32 s52, s47, 0
    buffer_load_dwordx4 v10, s[4:7], s52 offen lds
    s_add_u32 m0, s51, 1024
    s_add_u32 s52, s47, 131072
    buffer_load_dwordx4 v10, s[4:7], s52 offen lds
    s_add_u32 s46, s46, 40960
    s_add_u32 s47, s47, 64
    s_add_u32 m0, s50, 16384
    s_add_u32 s52, s46, 0x0
    buffer_load_dwordx4 v9, s[20:23], s52 offen lds
    s_add_u32 m0, s50, 17408
    s_add_u32 s52, s46, 0x1400
    buffer_load_dwordx4 v9, s[20:23], s52 offen lds
    s_add_u32 m0, s51, 16384
    s_add_u32 s52, s47, 0
    buffer_load_dwordx4 v10, s[4:7], s52 offen lds
    s_add_u32 m0, s51, 17408
    s_add_u32 s52, s47, 131072
    buffer_load_dwordx4 v10, s[4:7], s52 offen lds
    s_add_u32 s46, s46, 40960
    s_add_u32 s47, s47, 64
    s_add_u32 m0, s50, 32768
    s_add_u32 s52, s46, 0x0
    buffer_load_dwordx4 v9, s[20:23], s52 offen lds
    s_add_u32 m0, s50, 33792
    s_add_u32 s52, s46, 0x1400
    buffer_load_dwordx4 v9, s[20:23], s52 offen lds
    s_add_u32 m0, s51, 32768
    s_add_u32 s52, s47, 0
    buffer_load_dwordx4 v10, s[4:7], s52 offen lds
    s_add_u32 m0, s51, 33792
    s_add_u32 s52, s47, 131072
    buffer_load_dwordx4 v10, s[4:7], s52 offen lds
    s_add_u32 s46, s46, 40960
    s_add_u32 s47, s47, 64
    s_add_u32 m0, s50, 49152
    s_add_u32 s52, s46, 0x0
    buffer_load_dwordx4 v9, s[20:23], s52 offen lds
    s_add_u32 m0, s50, 50176
    s_add_u32 s52, s46, 0x1400
    buffer_load_dwordx4 v9, s[20:23], s52 offen lds
    s_add_u32 m0, s51, 49152
    s_add_u32 s52, s47, 0
    buffer_load_dwordx4 v10, s[4:7], s52 offen lds
    s_add_u32 m0, s51, 50176
    s_add_u32 s52, s47, 131072
    buffer_load_dwordx4 v10, s[4:7], s52 offen lds
    s_add_u32 s46, s46, 40960
    s_add_u32 s47, s47, 64
    s_add_u32 m0, s50, 65536
    s_add_u32 s52, s46, 0x0
    buffer_load_dwordx4 v9, s[20:23], s52 offen lds
    s_add_u32 m0, s50, 66560
    s_add_u32 s52, s46, 0x1400
    buffer_load_dwordx4 v9, s[20:23], s52 offen lds
    s_add_u32 m0, s51, 65536
    s_add_u32 s52, s47, 0
    buffer_load_dwordx4 v10, s[4:7], s52 offen lds
    s_add_u32 m0, s51, 66560
    s_add_u32 s52, s47, 131072
    buffer_load_dwordx4 v10, s[4:7], s52 offen lds
    s_add_u32 s46, s46, 40960
    s_add_u32 s47, s47, 64
    s_add_u32 m0, s50, 81920
    s_add_u32 s52, s46, 0x0
    buffer_load_dwordx4 v9, s[20:23], s52 offen lds
    s_add_u32 m0, s50, 82944
    s_add_u32 s52, s46, 0x1400
    buffer_load_dwordx4 v9, s[20:23], s52 offen lds
    s_add_u32 m0, s51, 81920
    s_add_u32 s52, s47, 0
    buffer_load_dwordx4 v10, s[4:7], s52 offen lds
    s_add_u32 m0, s51, 82944
    s_add_u32 s52, s47, 131072
    buffer_load_dwordx4 v10, s[4:7], s52 offen lds
    s_add_u32 s46, s46, 40960
    s_add_u32 s47, s47, 64
    s_add_u32 m0, s50, 98304
    s_add_u32 s52, s46, 0x0
    buffer_load_dwordx4 v9, s[20:23], s52 offen lds
    s_add_u32 m0, s50, 99328
    s_add_u32 s52, s46, 0x1400
    buffer_load_dwordx4 v9, s[20:23], s52 offen lds
    s_add_u32 m0, s51, 98304
    s_add_u32 s52, s47, 0
    buffer_load_dwordx4 v10, s[4:7], s52 offen lds
    s_add_u32 m0, s51, 99328
    s_add_u32 s52, s47, 131072
    buffer_load_dwordx4 v10, s[4:7], s52 offen lds
    s_add_u32 s46, s46, 40960
    s_add_u32 s47, s47, 64
    v_accvgpr_write_b32 a0, 0
    v_accvgpr_write_b32 a1, 0
    v_accvgpr_write_b32 a2, 0
    v_accvgpr_write_b32 a3, 0
    v_accvgpr_write_b32 a4, 0
    v_accvgpr_write_b32 a5, 0
    v_accvgpr_write_b32 a6, 0
    v_accvgpr_write_b32 a7, 0
    v_accvgpr_write_b32 a8, 0
    v_accvgpr_write_b32 a9, 0
    v_accvgpr_write_b32 a10, 0
    v_accvgpr_write_b32 a11, 0
    v_accvgpr_write_b32 a12, 0
    v_accvgpr_write_b32 a13, 0
    v_accvgpr_write_b32 a14, 0
    v_accvgpr_write_b32 a15, 0
    v_accvgpr_write_b32 a16, 0
    v_accvgpr_write_b32 a17, 0
    v_accvgpr_write_b32 a18, 0
    v_accvgpr_write_b32 a19, 0
    v_accvgpr_write_b32 a20, 0
    v_accvgpr_write_b32 a21, 0
    v_accvgpr_write_b32 a22, 0
    v_accvgpr_write_b32 a23, 0
    v_accvgpr_write_b32 a24, 0
    v_accvgpr_write_b32 a25, 0
    v_accvgpr_write_b32 a26, 0
    v_accvgpr_write_b32 a27, 0
    v_accvgpr_write_b32 a28, 0
    v_accvgpr_write_b32 a29, 0
    v_accvgpr_write_b32 a30, 0
    v_accvgpr_write_b32 a31, 0
    v_accvgpr_write_b32 a32, 0
    v_accvgpr_write_b32 a33, 0
    v_accvgpr_write_b32 a34, 0
    v_accvgpr_write_b32 a35, 0
    v_accvgpr_write_b32 a36, 0
    v_accvgpr_write_b32 a37, 0
    v_accvgpr_write_b32 a38, 0
    v_accvgpr_write_b32 a39, 0
    v_accvgpr_write_b32 a40, 0
    v_accvgpr_write_b32 a41, 0
    v_accvgpr_write_b32 a42, 0
    v_accvgpr_write_b32 a43, 0
    v_accvgpr_write_b32 a44, 0
    v_accvgpr_write_b32 a45, 0
    v_accvgpr_write_b32 a46, 0
    v_accvgpr_write_b32 a47, 0
    v_accvgpr_write_b32 a48, 0
    v_accvgpr_write_b32 a49, 0
    v_accvgpr_write_b32 a50, 0
    v_accvgpr_write_b32 a51, 0
    v_accvgpr_write_b32 a52, 0
    v_accvgpr_write_b32 a53, 0
    v_accvgpr_write_b32 a54, 0
    v_accvgpr_write_b32 a55, 0
    v_accvgpr_write_b32 a56, 0
    v_accvgpr_write_b32 a57, 0
    v_accvgpr_write_b32 a58, 0
    v_accvgpr_write_b32 a59, 0
    v_accvgpr_write_b32 a60, 0
    v_accvgpr_write_b32 a61, 0
    v_accvgpr_write_b32 a62, 0
    v_accvgpr_write_b32 a63, 0
    s_waitcnt vmcnt(24)
    s_barrier
    ds_read_b128 v[32:35], v28 offset:0
    ds_read_b128 v[36:39], v28 offset:1024
    ds_read_b64_tr_b16 v[48:49], v12 offset:0
    ds_read_b64_tr_b16 v[50:51], v12 offset:1024
    ds_read_b64_tr_b16 v[52:53], v13 offset:0
    ds_read_b64_tr_b16 v[54:55], v13 offset:1024
    s_mov_b32 s43, 0
Lpg_177:
    ds_read_b64_tr_b16 v[56:57], v14 offset:0
    ds_read_b64_tr_b16 v[58:59], v14 offset:1024
    s_waitcnt lgkmcnt(6)
    s_waitcnt lgkmcnt(4)
    v_mfma_f32_16x16x32_bf16 a[0:3], v[48:51], v[32:35], a[0:3]
    v_mfma_f32_16x16x32_bf16 a[4:7], v[48:51], v[36:39], a[4:7]
    ds_read_b64_tr_b16 v[60:61], v15 offset:0
    ds_read_b64_tr_b16 v[62:63], v15 offset:1024
    s_waitcnt lgkmcnt(4)
    v_mfma_f32_16x16x32_bf16 a[8:11], v[52:55], v[32:35], a[8:11]
    v_mfma_f32_16x16x32_bf16 a[12:15], v[52:55], v[36:39], a[12:15]
    ds_read_b64_tr_b16 v[48:49], v16 offset:0
    ds_read_b64_tr_b16 v[50:51], v16 offset:1024
    s_waitcnt lgkmcnt(4)
    v_mfma_f32_16x16x32_bf16 a[16:19], v[56:59], v[32:35], a[16:19]
    v_mfma_f32_16x16x32_bf16 a[20:23], v[56:59], v[36:39], a[20:23]
    ds_read_b64_tr_b16 v[52:53], v17 offset:0
    ds_read_b64_tr_b16 v[54:55], v17 offset:1024
    s_waitcnt lgkmcnt(4)
    v_mfma_f32_16x16x32_bf16 a[24:27], v[60:63], v[32:35], a[24:27]
    v_mfma_f32_16x16x32_bf16 a[28:31], v[60:63], v[36:39], a[28:31]
    s_waitcnt vmcnt(20)
    s_barrier
    ds_read_b64_tr_b16 v[56:57], v18 offset:0
    ds_read_b64_tr_b16 v[58:59], v18 offset:1024
    s_waitcnt lgkmcnt(4)
    v_mfma_f32_16x16x32_bf16 a[32:35], v[48:51], v[32:35], a[32:35]
    v_mfma_f32_16x16x32_bf16 a[36:39], v[48:51], v[36:39], a[36:39]
    s_add_u32 m0, s50, 114688
    s_add_u32 s52, s46, 0x0
    buffer_load_dwordx4 v9, s[20:23], s52 offen lds
    ds_read_b64_tr_b16 v[60:61], v19 offset:0
    ds_read_b64_tr_b16 v[62:63], v19 offset:1024
    s_waitcnt lgkmcnt(4)
    v_mfma_f32_16x16x32_bf16 a[40:43], v[52:55], v[32:35], a[40:43]
    v_mfma_f32_16x16x32_bf16 a[44:47], v[52:55], v[36:39], a[44:47]
    s_add_u32 m0, s50, 115712
    s_add_u32 s52, s46, 0x1400
    buffer_load_dwordx4 v9, s[20:23], s52 offen lds
    ds_read_b128 v[40:43], v28 offset:16384
    ds_read_b128 v[44:47], v28 offset:17408
    ds_read_b64_tr_b16 v[48:49], v12 offset:16384
    ds_read_b64_tr_b16 v[50:51], v12 offset:17408
    s_waitcnt lgkmcnt(6)
    v_mfma_f32_16x16x32_bf16 a[48:51], v[56:59], v[32:35], a[48:51]
    v_mfma_f32_16x16x32_bf16 a[52:55], v[56:59], v[36:39], a[52:55]
    s_add_u32 m0, s51, 114688
    s_add_u32 s52, s47, 0
    buffer_load_dwordx4 v10, s[4:7], s52 offen lds
    ds_read_b64_tr_b16 v[52:53], v13 offset:16384
    ds_read_b64_tr_b16 v[54:55], v13 offset:17408
    s_waitcnt lgkmcnt(6)
    v_mfma_f32_16x16x32_bf16 a[56:59], v[60:63], v[32:35], a[56:59]
    v_mfma_f32_16x16x32_bf16 a[60:63], v[60:63], v[36:39], a[60:63]
    s_add_u32 m0, s51, 115712
    s_add_u32 s52, s47, 131072
    buffer_load_dwordx4 v10, s[4:7], s52 offen lds
    s_add_u32 s46, s46, 40960
    s_add_u32 s47, s47, 64
    ds_read_b64_tr_b16 v[56:57], v14 offset:16384
    ds_read_b64_tr_b16 v[58:59], v14 offset:17408
    s_waitcnt lgkmcnt(6)
    s_waitcnt lgkmcnt(4)
    v_mfma_f32_16x16x32_bf16 a[0:3], v[48:51], v[40:43], a[0:3]
    v_mfma_f32_16x16x32_bf16 a[4:7], v[48:51], v[44:47], a[4:7]
    ds_read_b64_tr_b16 v[60:61], v15 offset:16384
    ds_read_b64_tr_b16 v[62:63], v15 offset:17408
    s_waitcnt lgkmcnt(4)
    v_mfma_f32_16x16x32_bf16 a[8:11], v[52:55], v[40:43], a[8:11]
    v_mfma_f32_16x16x32_bf16 a[12:15], v[52:55], v[44:47], a[12:15]
    ds_read_b64_tr_b16 v[48:49], v16 offset:16384
    ds_read_b64_tr_b16 v[50:51], v16 offset:17408
    s_waitcnt lgkmcnt(4)
    v_mfma_f32_16x16x32_bf16 a[16:19], v[56:59], v[40:43], a[16:19]
    v_mfma_f32_16x16x32_bf16 a[20:23], v[56:59], v[44:47], a[20:23]
    ds_read_b64_tr_b16 v[52:53], v17 offset:16384
    ds_read_b64_tr_b16 v[54:55], v17 offset:17408
    s_waitcnt lgkmcnt(4)
    v_mfma_f32_16x16x32_bf16 a[24:27], v[60:63], v[40:43], a[24:27]
    v_mfma_f32_16x16x32_bf16 a[28:31], v[60:63], v[44:47], a[28:31]
    s_waitcnt vmcnt(20)
    s_barrier
    ds_read_b64_tr_b16 v[56:57], v18 offset:16384
    ds_read_b64_tr_b16 v[58:59], v18 offset:17408
    s_waitcnt lgkmcnt(4)
    v_mfma_f32_16x16x32_bf16 a[32:35], v[48:51], v[40:43], a[32:35]
    v_mfma_f32_16x16x32_bf16 a[36:39], v[48:51], v[44:47], a[36:39]
    s_add_u32 m0, s50, 0
    s_add_u32 s52, s46, 0x0
    buffer_load_dwordx4 v9, s[20:23], s52 offen lds
    ds_read_b64_tr_b16 v[60:61], v19 offset:16384
    ds_read_b64_tr_b16 v[62:63], v19 offset:17408
    s_waitcnt lgkmcnt(4)
    v_mfma_f32_16x16x32_bf16 a[40:43], v[52:55], v[40:43], a[40:43]
    v_mfma_f32_16x16x32_bf16 a[44:47], v[52:55], v[44:47], a[44:47]
    s_add_u32 m0, s50, 1024
    s_add_u32 s52, s46, 0x1400
    buffer_load_dwordx4 v9, s[20:23], s52 offen lds
    ds_read_b128 v[32:35], v28 offset:32768
    ds_read_b128 v[36:39], v28 offset:33792
    ds_read_b64_tr_b16 v[48:49], v12 offset:32768
    ds_read_b64_tr_b16 v[50:51], v12 offset:33792
    s_waitcnt lgkmcnt(6)
    v_mfma_f32_16x16x32_bf16 a[48:51], v[56:59], v[40:43], a[48:51]
    v_mfma_f32_16x16x32_bf16 a[52:55], v[56:59], v[44:47], a[52:55]
    s_add_u32 m0, s51, 0
    s_add_u32 s52, s47, 0
    buffer_load_dwordx4 v10, s[4:7], s52 offen lds
    ds_read_b64_tr_b16 v[52:53], v13 offset:32768
    ds_read_b64_tr_b16 v[54:55], v13 offset:33792
    s_waitcnt lgkmcnt(6)
    v_mfma_f32_16x16x32_bf16 a[56:59], v[60:63], v[40:43], a[56:59]
    v_mfma_f32_16x16x32_bf16 a[60:63], v[60:63], v[44:47], a[60:63]
    s_add_u32 m0, s51, 1024
    s_add_u32 s52, s47, 131072
    buffer_load_dwordx4 v10, s[4:7], s52 offen lds
    s_add_u32 s46, s46, 40960
    s_add_u32 s47, s47, 64
    ds_read_b64_tr_b16 v[56:57], v14 offset:32768
    ds_read_b64_tr_b16 v[58:59], v14 offset:33792
    s_waitcnt lgkmcnt(6)
    s_waitcnt lgkmcnt(4)
    v_mfma_f32_16x16x32_bf16 a[0:3], v[48:51], v[32:35], a[0:3]
    v_mfma_f32_16x16x32_bf16 a[4:7], v[48:51], v[36:39], a[4:7]
    ds_read_b64_tr_b16 v[60:61], v15 offset:32768
    ds_read_b64_tr_b16 v[62:63], v15 offset:33792
    s_waitcnt lgkmcnt(4)
    v_mfma_f32_16x16x32_bf16 a[8:11], v[52:55], v[32:35], a[8:11]
    v_mfma_f32_16x16x32_bf16 a[12:15], v[52:55], v[36:39], a[12:15]
    ds_read_b64_tr_b16 v[48:49], v16 offset:32768
    ds_read_b64_tr_b16 v[50:51], v16 offset:33792
    s_waitcnt lgkmcnt(4)
    v_mfma_f32_16x16x32_bf16 a[16:19], v[56:59], v[32:35], a[16:19]
    v_mfma_f32_16x16x32_bf16 a[20:23], v[56:59], v[36:39], a[20:23]
    ds_read_b64_tr_b16 v[52:53], v17 offset:32768
    ds_read_b64_tr_b16 v[54:55], v17 offset:33792
    s_waitcnt lgkmcnt(4)
    v_mfma_f32_16x16x32_bf16 a[24:27], v[60:63], v[32:35], a[24:27]
    v_mfma_f32_16x16x32_bf16 a[28:31], v[60:63], v[36:39], a[28:31]
    s_waitcnt vmcnt(20)
    s_barrier
    ds_read_b64_tr_b16 v[56:57], v18 offset:32768
    ds_read_b64_tr_b16 v[58:59], v18 offset:33792
    s_waitcnt lgkmcnt(4)
    v_mfma_f32_16x16x32_bf16 a[32:35], v[48:51], v[32:35], a[32:35]
    v_mfma_f32_16x16x32_bf16 a[36:39], v[48:51], v[36:39], a[36:39]
    s_add_u32 m0, s50, 16384
    s_add_u32 s52, s46, 0x0
    buffer_load_dwordx4 v9, s[20:23], s52 offen lds
    ds_read_b64_tr_b16 v[60:61], v19 offset:32768
    ds_read_b64_tr_b16 v[62:63], v19 offset:33792
    s_waitcnt lgkmcnt(4)
    v_mfma_f32_16x16x32_bf16 a[40:43], v[52:55], v[32:35], a[40:43]
    v_mfma_f32_16x16x32_bf16 a[44:47], v[52:55], v[36:39], a[44:47]
    s_add_u32 m0, s50, 17408
    s_add_u32 s52, s46, 0x1400
    buffer_load_dwordx4 v9, s[20:23], s52 offen lds
    ds_read_b128 v[40:43], v28 offset:49152
    ds_read_b128 v[44:47], v28 offset:50176
    ds_read_b64_tr_b16 v[48:49], v12 offset:49152
    ds_read_b64_tr_b16 v[50:51], v12 offset:50176
    s_waitcnt lgkmcnt(6)
    v_mfma_f32_16x16x32_bf16 a[48:51], v[56:59], v[32:35], a[48:51]
    v_mfma_f32_16x16x32_bf16 a[52:55], v[56:59], v[36:39], a[52:55]
    s_add_u32 m0, s51, 16384
    s_add_u32 s52, s47, 0
    buffer_load_dwordx4 v10, s[4:7], s52 offen lds
    ds_read_b64_tr_b16 v[52:53], v13 offset:49152
    ds_read_b64_tr_b16 v[54:55], v13 offset:50176
    s_waitcnt lgkmcnt(6)
    v_mfma_f32_16x16x32_bf16 a[56:59], v[60:63], v[32:35], a[56:59]
    v_mfma_f32_16x16x32_bf16 a[60:63], v[60:63], v[36:39], a[60:63]
    s_add_u32 m0, s51, 17408
    s_add_u32 s52, s47, 131072
    buffer_load_dwordx4 v10, s[4:7], s52 offen lds
    s_add_u32 s46, s46, 40960
    s_add_u32 s47, s47, 64
    ds_read_b64_tr_b16 v[56:57], v14 offset:49152
    ds_read_b64_tr_b16 v[58:59], v14 offset:50176
    s_waitcnt lgkmcnt(6)
    s_waitcnt lgkmcnt(4)
    v_mfma_f32_16x16x32_bf16 a[0:3], v[48:51], v[40:43], a[0:3]
    v_mfma_f32_16x16x32_bf16 a[4:7], v[48:51], v[44:47], a[4:7]
    ds_read_b64_tr_b16 v[60:61], v15 offset:49152
    ds_read_b64_tr_b16 v[62:63], v15 offset:50176
    s_waitcnt lgkmcnt(4)
    v_mfma_f32_16x16x32_bf16 a[8:11], v[52:55], v[40:43], a[8:11]
    v_mfma_f32_16x16x32_bf16 a[12:15], v[52:55], v[44:47], a[12:15]
    ds_read_b64_tr_b16 v[48:49], v16 offset:49152
    ds_read_b64_tr_b16 v[50:51], v16 offset:50176
    s_waitcnt lgkmcnt(4)
    v_mfma_f32_16x16x32_bf16 a[16:19], v[56:59], v[40:43], a[16:19]
    v_mfma_f32_16x16x32_bf16 a[20:23], v[56:59], v[44:47], a[20:23]
    ds_read_b64_tr_b16 v[52:53], v17 offset:49152
    ds_read_b64_tr_b16 v[54:55], v17 offset:50176
    s_waitcnt lgkmcnt(4)
    v_mfma_f32_16x16x32_bf16 a[24:27], v[60:63], v[40:43], a[24:27]
    v_mfma_f32_16x16x32_bf16 a[28:31], v[60:63], v[44:47], a[28:31]
    s_waitcnt vmcnt(20)
    s_barrier
    ds_read_b64_tr_b16 v[56:57], v18 offset:49152
    ds_read_b64_tr_b16 v[58:59], v18 offset:50176
    s_waitcnt lgkmcnt(4)
    v_mfma_f32_16x16x32_bf16 a[32:35], v[48:51], v[40:43], a[32:35]
    v_mfma_f32_16x16x32_bf16 a[36:39], v[48:51], v[44:47], a[36:39]
    s_add_u32 m0, s50, 32768
    s_add_u32 s52, s46, 0x0
    buffer_load_dwordx4 v9, s[20:23], s52 offen lds
    ds_read_b64_tr_b16 v[60:61], v19 offset:49152
    ds_read_b64_tr_b16 v[62:63], v19 offset:50176
    s_waitcnt lgkmcnt(4)
    v_mfma_f32_16x16x32_bf16 a[40:43], v[52:55], v[40:43], a[40:43]
    v_mfma_f32_16x16x32_bf16 a[44:47], v[52:55], v[44:47], a[44:47]
    s_add_u32 m0, s50, 33792
    s_add_u32 s52, s46, 0x1400
    buffer_load_dwordx4 v9, s[20:23], s52 offen lds
    ds_read_b128 v[32:35], v29 offset:0
    ds_read_b128 v[36:39], v29 offset:1024
    ds_read_b64_tr_b16 v[48:49], v20 offset:0
    ds_read_b64_tr_b16 v[50:51], v20 offset:1024
    s_waitcnt lgkmcnt(6)
    v_mfma_f32_16x16x32_bf16 a[48:51], v[56:59], v[40:43], a[48:51]
    v_mfma_f32_16x16x32_bf16 a[52:55], v[56:59], v[44:47], a[52:55]
    s_add_u32 m0, s51, 32768
    s_add_u32 s52, s47, 0
    buffer_load_dwordx4 v10, s[4:7], s52 offen lds
    ds_read_b64_tr_b16 v[52:53], v21 offset:0
    ds_read_b64_tr_b16 v[54:55], v21 offset:1024
    s_waitcnt lgkmcnt(6)
    v_mfma_f32_16x16x32_bf16 a[56:59], v[60:63], v[40:43], a[56:59]
    v_mfma_f32_16x16x32_bf16 a[60:63], v[60:63], v[44:47], a[60:63]
    s_add_u32 m0, s51, 33792
    s_add_u32 s52, s47, 131072
    buffer_load_dwordx4 v10, s[4:7], s52 offen lds
    s_add_u32 s46, s46, 40960
    s_add_u32 s47, s47, 64
    ds_read_b64_tr_b16 v[56:57], v22 offset:0
    ds_read_b64_tr_b16 v[58:59], v22 offset:1024
    s_waitcnt lgkmcnt(6)
    s_waitcnt lgkmcnt(4)
    v_mfma_f32_16x16x32_bf16 a[0:3], v[48:51], v[32:35], a[0:3]
    v_mfma_f32_16x16x32_bf16 a[4:7], v[48:51], v[36:39], a[4:7]
    ds_read_b64_tr_b16 v[60:61], v23 offset:0
    ds_read_b64_tr_b16 v[62:63], v23 offset:1024
    s_waitcnt lgkmcnt(4)
    v_mfma_f32_16x16x32_bf16 a[8:11], v[52:55], v[32:35], a[8:11]
    v_mfma_f32_16x16x32_bf16 a[12:15], v[52:55], v[36:39], a[12:15]
    ds_read_b64_tr_b16 v[48:49], v24 offset:0
    ds_read_b64_tr_b16 v[50:51], v24 offset:1024
    s_waitcnt lgkmcnt(4)
    v_mfma_f32_16x16x32_bf16 a[16:19], v[56:59], v[32:35], a[16:19]
    v_mfma_f32_16x16x32_bf16 a[20:23], v[56:59], v[36:39], a[20:23]
    ds_read_b64_tr_b16 v[52:53], v25 offset:0
    ds_read_b64_tr_b16 v[54:55], v25 offset:1024
    s_waitcnt lgkmcnt(4)
    v_mfma_f32_16x16x32_bf16 a[24:27], v[60:63], v[32:35], a[24:27]
    v_mfma_f32_16x16x32_bf16 a[28:31], v[60:63], v[36:39], a[28:31]
    s_waitcnt vmcnt(20)
    s_barrier
    ds_read_b64_tr_b16 v[56:57], v26 offset:0
    ds_read_b64_tr_b16 v[58:59], v26 offset:1024
    s_waitcnt lgkmcnt(4)
    v_mfma_f32_16x16x32_bf16 a[32:35], v[48:51], v[32:35], a[32:35]
    v_mfma_f32_16x16x32_bf16 a[36:39], v[48:51], v[36:39], a[36:39]
    s_add_u32 m0, s50, 49152
    s_add_u32 s52, s46, 0x0
    buffer_load_dwordx4 v9, s[20:23], s52 offen lds
    ds_read_b64_tr_b16 v[60:61], v27 offset:0
    ds_read_b64_tr_b16 v[62:63], v27 offset:1024
    s_waitcnt lgkmcnt(4)
    v_mfma_f32_16x16x32_bf16 a[40:43], v[52:55], v[32:35], a[40:43]
    v_mfma_f32_16x16x32_bf16 a[44:47], v[52:55], v[36:39], a[44:47]
    s_add_u32 m0, s50, 50176
    s_add_u32 s52, s46, 0x1400
    buffer_load_dwordx4 v9, s[20:23], s52 offen lds
    ds_read_b128 v[40:43], v29 offset:16384
    ds_read_b128 v[44:47], v29 offset:17408
    ds_read_b64_tr_b16 v[48:49], v20 offset:16384
    ds_read_b64_tr_b16 v[50:51], v20 offset:17408
    s_waitcnt lgkmcnt(6)
    v_mfma_f32_16x16x32_bf16 a[48:51], v[56:59], v[32:35], a[48:51]
    v_mfma_f32_16x16x32_bf16 a[52:55], v[56:59], v[36:39], a[52:55]
    s_add_u32 m0, s51, 49152
    s_add_u32 s52, s47, 0
    buffer_load_dwordx4 v10, s[4:7], s52 offen lds
    ds_read_b64_tr_b16 v[52:53], v21 offset:16384
    ds_read_b64_tr_b16 v[54:55], v21 offset:17408
    s_waitcnt lgkmcnt(6)
    v_mfma_f32_16x16x32_bf16 a[56:59], v[60:63], v[32:35], a[56:59]
    v_mfma_f32_16x16x32_bf16 a[60:63], v[60:63], v[36:39], a[60:63]
    s_add_u32 m0, s51, 50176
    s_add_u32 s52, s47, 131072
    buffer_load_dwordx4 v10, s[4:7], s52 offen lds
    s_add_u32 s46, s46, 40960
    s_add_u32 s47, s47, 64
    ds_read_b64_tr_b16 v[56:57], v22 offset:16384
    ds_read_b64_tr_b16 v[58:59], v22 offset:17408
    s_waitcnt lgkmcnt(6)
    s_waitcnt lgkmcnt(4)
    v_mfma_f32_16x16x32_bf16 a[0:3], v[48:51], v[40:43], a[0:3]
    v_mfma_f32_16x16x32_bf16 a[4:7], v[48:51], v[44:47], a[4:7]
    ds_read_b64_tr_b16 v[60:61], v23 offset:16384
    ds_read_b64_tr_b16 v[62:63], v23 offset:17408
    s_waitcnt lgkmcnt(4)
    v_mfma_f32_16x16x32_bf16 a[8:11], v[52:55], v[40:43], a[8:11]
    v_mfma_f32_16x16x32_bf16 a[12:15], v[52:55], v[44:47], a[12:15]
    ds_read_b64_tr_b16 v[48:49], v24 offset:16384
    ds_read_b64_tr_b16 v[50:51], v24 offset:17408
    s_waitcnt lgkmcnt(4)
    v_mfma_f32_16x16x32_bf16 a[16:19], v[56:59], v[40:43], a[16:19]
    v_mfma_f32_16x16x32_bf16 a[20:23], v[56:59], v[44:47], a[20:23]
    ds_read_b64_tr_b16 v[52:53], v25 offset:16384
    ds_read_b64_tr_b16 v[54:55], v25 offset:17408
    s_waitcnt lgkmcnt(4)
    v_mfma_f32_16x16x32_bf16 a[24:27], v[60:63], v[40:43], a[24:27]
    v_mfma_f32_16x16x32_bf16 a[28:31], v[60:63], v[44:47], a[28:31]
    s_waitcnt vmcnt(20)
    s_barrier
    ds_read_b64_tr_b16 v[56:57], v26 offset:16384
    ds_read_b64_tr_b16 v[58:59], v26 offset:17408
    s_waitcnt lgkmcnt(4)
    v_mfma_f32_16x16x32_bf16 a[32:35], v[48:51], v[40:43], a[32:35]
    v_mfma_f32_16x16x32_bf16 a[36:39], v[48:51], v[44:47], a[36:39]
    s_add_u32 m0, s50, 65536
    s_add_u32 s52, s46, 0x0
    buffer_load_dwordx4 v9, s[20:23], s52 offen lds
    ds_read_b64_tr_b16 v[60:61], v27 offset:16384
    ds_read_b64_tr_b16 v[62:63], v27 offset:17408
    s_waitcnt lgkmcnt(4)
    v_mfma_f32_16x16x32_bf16 a[40:43], v[52:55], v[40:43], a[40:43]
    v_mfma_f32_16x16x32_bf16 a[44:47], v[52:55], v[44:47], a[44:47]
    s_add_u32 m0, s50, 66560
    s_add_u32 s52, s46, 0x1400
    buffer_load_dwordx4 v9, s[20:23], s52 offen lds
    ds_read_b128 v[32:35], v29 offset:32768
    ds_read_b128 v[36:39], v29 offset:33792
    ds_read_b64_tr_b16 v[48:49], v20 offset:32768
    ds_read_b64_tr_b16 v[50:51], v20 offset:33792
    s_waitcnt lgkmcnt(6)
    v_mfma_f32_16x16x32_bf16 a[48:51], v[56:59], v[40:43], a[48:51]
    v_mfma_f32_16x16x32_bf16 a[52:55], v[56:59], v[44:47], a[52:55]
    s_add_u32 m0, s51, 65536
    s_add_u32 s52, s47, 0
    buffer_load_dwordx4 v10, s[4:7], s52 offen lds
    ds_read_b64_tr_b16 v[52:53], v21 offset:32768
    ds_read_b64_tr_b16 v[54:55], v21 offset:33792
    s_waitcnt lgkmcnt(6)
    v_mfma_f32_16x16x32_bf16 a[56:59], v[60:63], v[40:43], a[56:59]
    v_mfma_f32_16x16x32_bf16 a[60:63], v[60:63], v[44:47], a[60:63]
    s_add_u32 m0, s51, 66560
    s_add_u32 s52, s47, 131072
    buffer_load_dwordx4 v10, s[4:7], s52 offen lds
    s_add_u32 s46, s46, 40960
    s_add_u32 s47, s47, 64
    ds_read_b64_tr_b16 v[56:57], v22 offset:32768
    ds_read_b64_tr_b16 v[58:59], v22 offset:33792
    s_waitcnt lgkmcnt(6)
    s_waitcnt lgkmcnt(4)
    v_mfma_f32_16x16x32_bf16 a[0:3], v[48:51], v[32:35], a[0:3]
    v_mfma_f32_16x16x32_bf16 a[4:7], v[48:51], v[36:39], a[4:7]
    ds_read_b64_tr_b16 v[60:61], v23 offset:32768
    ds_read_b64_tr_b16 v[62:63], v23 offset:33792
    s_waitcnt lgkmcnt(4)
    v_mfma_f32_16x16x32_bf16 a[8:11], v[52:55], v[32:35], a[8:11]
    v_mfma_f32_16x16x32_bf16 a[12:15], v[52:55], v[36:39], a[12:15]
    ds_read_b64_tr_b16 v[48:49], v24 offset:32768
    ds_read_b64_tr_b16 v[50:51], v24 offset:33792
    s_waitcnt lgkmcnt(4)
    v_mfma_f32_16x16x32_bf16 a[16:19], v[56:59], v[32:35], a[16:19]
    v_mfma_f32_16x16x32_bf16 a[20:23], v[56:59], v[36:39], a[20:23]
    ds_read_b64_tr_b16 v[52:53], v25 offset:32768
    ds_read_b64_tr_b16 v[54:55], v25 offset:33792
    s_waitcnt lgkmcnt(4)
    v_mfma_f32_16x16x32_bf16 a[24:27], v[60:63], v[32:35], a[24:27]
    v_mfma_f32_16x16x32_bf16 a[28:31], v[60:63], v[36:39], a[28:31]
    s_waitcnt vmcnt(20)
    s_barrier
    ds_read_b64_tr_b16 v[56:57], v26 offset:32768
    ds_read_b64_tr_b16 v[58:59], v26 offset:33792
    s_waitcnt lgkmcnt(4)
    v_mfma_f32_16x16x32_bf16 a[32:35], v[48:51], v[32:35], a[32:35]
    v_mfma_f32_16x16x32_bf16 a[36:39], v[48:51], v[36:39], a[36:39]
    s_add_u32 m0, s50, 81920
    s_add_u32 s52, s46, 0x0
    buffer_load_dwordx4 v9, s[20:23], s52 offen lds
    ds_read_b64_tr_b16 v[60:61], v27 offset:32768
    ds_read_b64_tr_b16 v[62:63], v27 offset:33792
    s_waitcnt lgkmcnt(4)
    v_mfma_f32_16x16x32_bf16 a[40:43], v[52:55], v[32:35], a[40:43]
    v_mfma_f32_16x16x32_bf16 a[44:47], v[52:55], v[36:39], a[44:47]
    s_add_u32 m0, s50, 82944
    s_add_u32 s52, s46, 0x1400
    buffer_load_dwordx4 v9, s[20:23], s52 offen lds
    ds_read_b128 v[40:43], v29 offset:49152
    ds_read_b128 v[44:47], v29 offset:50176
    ds_read_b64_tr_b16 v[48:49], v20 offset:49152
    ds_read_b64_tr_b16 v[50:51], v20 offset:50176
    s_waitcnt lgkmcnt(6)
    v_mfma_f32_16x16x32_bf16 a[48:51], v[56:59], v[32:35], a[48:51]
    v_mfma_f32_16x16x32_bf16 a[52:55], v[56:59], v[36:39], a[52:55]
    s_add_u32 m0, s51, 81920
    s_add_u32 s52, s47, 0
    buffer_load_dwordx4 v10, s[4:7], s52 offen lds
    ds_read_b64_tr_b16 v[52:53], v21 offset:49152
    ds_read_b64_tr_b16 v[54:55], v21 offset:50176
    s_waitcnt lgkmcnt(6)
    v_mfma_f32_16x16x32_bf16 a[56:59], v[60:63], v[32:35], a[56:59]
    v_mfma_f32_16x16x32_bf16 a[60:63], v[60:63], v[36:39], a[60:63]
    s_add_u32 m0, s51, 82944
    s_add_u32 s52, s47, 131072
    buffer_load_dwordx4 v10, s[4:7], s52 offen lds
    s_add_u32 s46, s46, 40960
    s_add_u32 s47, s47, 64
    ds_read_b64_tr_b16 v[56:57], v22 offset:49152
    ds_read_b64_tr_b16 v[58:59], v22 offset:50176
    s_waitcnt lgkmcnt(6)
    s_waitcnt lgkmcnt(4)
    v_mfma_f32_16x16x32_bf16 a[0:3], v[48:51], v[40:43], a[0:3]
    v_mfma_f32_16x16x32_bf16 a[4:7], v[48:51], v[44:47], a[4:7]
    ds_read_b64_tr_b16 v[60:61], v23 offset:49152
    ds_read_b64_tr_b16 v[62:63], v23 offset:50176
    s_waitcnt lgkmcnt(4)
    v_mfma_f32_16x16x32_bf16 a[8:11], v[52:55], v[40:43], a[8:11]
    v_mfma_f32_16x16x32_bf16 a[12:15], v[52:55], v[44:47], a[12:15]
    ds_read_b64_tr_b16 v[48:49], v24 offset:49152
    ds_read_b64_tr_b16 v[50:51], v24 offset:50176
    s_waitcnt lgkmcnt(4)
    v_mfma_f32_16x16x32_bf16 a[16:19], v[56:59], v[40:43], a[16:19]
    v_mfma_f32_16x16x32_bf16 a[20:23], v[56:59], v[44:47], a[20:23]
    ds_read_b64_tr_b16 v[52:53], v25 offset:49152
    ds_read_b64_tr_b16 v[54:55], v25 offset:50176
    s_waitcnt lgkmcnt(4)
    v_mfma_f32_16x16x32_bf16 a[24:27], v[60:63], v[40:43], a[24:27]
    v_mfma_f32_16x16x32_bf16 a[28:31], v[60:63], v[44:47], a[28:31]
    s_waitcnt vmcnt(20)
    s_barrier
    ds_read_b64_tr_b16 v[56:57], v26 offset:49152
    ds_read_b64_tr_b16 v[58:59], v26 offset:50176
    s_waitcnt lgkmcnt(4)
    v_mfma_f32_16x16x32_bf16 a[32:35], v[48:51], v[40:43], a[32:35]
    v_mfma_f32_16x16x32_bf16 a[36:39], v[48:51], v[44:47], a[36:39]
    s_add_u32 m0, s50, 98304
    s_add_u32 s52, s46, 0x0
    buffer_load_dwordx4 v9, s[20:23], s52 offen lds
    ds_read_b64_tr_b16 v[60:61], v27 offset:49152
    ds_read_b64_tr_b16 v[62:63], v27 offset:50176
    s_waitcnt lgkmcnt(4)
    v_mfma_f32_16x16x32_bf16 a[40:43], v[52:55], v[40:43], a[40:43]
    v_mfma_f32_16x16x32_bf16 a[44:47], v[52:55], v[44:47], a[44:47]
    s_add_u32 m0, s50, 99328
    s_add_u32 s52, s46, 0x1400
    buffer_load_dwordx4 v9, s[20:23], s52 offen lds
    ds_read_b128 v[32:35], v28 offset:0
    ds_read_b128 v[36:39], v28 offset:1024
    ds_read_b64_tr_b16 v[48:49], v12 offset:0
    ds_read_b64_tr_b16 v[50:51], v12 offset:1024
    s_waitcnt lgkmcnt(6)
    v_mfma_f32_16x16x32_bf16 a[48:51], v[56:59], v[40:43], a[48:51]
    v_mfma_f32_16x16x32_bf16 a[52:55], v[56:59], v[44:47], a[52:55]
    s_add_u32 m0, s51, 98304
    s_add_u32 s52, s47, 0
    buffer_load_dwordx4 v10, s[4:7], s52 offen lds
    ds_read_b64_tr_b16 v[52:53], v13 offset:0
    ds_read_b64_tr_b16 v[54:55], v13 offset:1024
    s_waitcnt lgkmcnt(6)
    v_mfma_f32_16x16x32_bf16 a[56:59], v[60:63], v[40:43], a[56:59]
    v_mfma_f32_16x16x32_bf16 a[60:63], v[60:63], v[44:47], a[60:63]
    s_add_u32 m0, s51, 99328
    s_add_u32 s52, s47, 131072
    buffer_load_dwordx4 v10, s[4:7], s52 offen lds
    s_add_u32 s46, s46, 40960
    s_add_u32 s47, s47, 64
    s_add_u32 s43, s43, 1
    s_cmp_lt_u32 s43, 16
    s_cbranch_scc1 Lpg_177
    s_waitcnt vmcnt(0) lgkmcnt(0)
    s_barrier
    s_nop 3
    s_lshl_b32 s44, s40, 2
    s_add_u32 s44, s44, s42
    s_mul_i32 s44, s44, 81920
    s_lshl_b32 s45, s41, 8
    s_add_u32 s44, s44, s45
    s_add_u32 s44, s44, 1280
    v_mul_u32_u24 v6, 2560, v2
    v_lshl_add_u32 v6, v3, 3, v6
    v_add_u32 v7, s44, v6
    s_mov_b32 s44, 0
    v_accvgpr_read_b32 v8, a0
    v_accvgpr_read_b32 v9, a1
    v_accvgpr_read_b32 v10, a2
    v_accvgpr_read_b32 v11, a3
    v_cvt_pk_bf16_f32 v12, v8, v9
    v_cvt_pk_bf16_f32 v13, v10, v11
    buffer_store_dwordx2 v[12:13], v7, s[12:15], s44 offen offset:0
    v_accvgpr_read_b32 v8, a8
    v_accvgpr_read_b32 v9, a9
    v_accvgpr_read_b32 v10, a10
    v_accvgpr_read_b32 v11, a11
    v_cvt_pk_bf16_f32 v14, v8, v9
    v_cvt_pk_bf16_f32 v15, v10, v11
    buffer_store_dwordx2 v[14:15], v7, s[12:15], s44 offen offset:32
    v_accvgpr_read_b32 v8, a16
    v_accvgpr_read_b32 v9, a17
    v_accvgpr_read_b32 v10, a18
    v_accvgpr_read_b32 v11, a19
    v_cvt_pk_bf16_f32 v16, v8, v9
    v_cvt_pk_bf16_f32 v17, v10, v11
    buffer_store_dwordx2 v[16:17], v7, s[12:15], s44 offen offset:64
    v_accvgpr_read_b32 v8, a24
    v_accvgpr_read_b32 v9, a25
    v_accvgpr_read_b32 v10, a26
    v_accvgpr_read_b32 v11, a27
    v_cvt_pk_bf16_f32 v18, v8, v9
    v_cvt_pk_bf16_f32 v19, v10, v11
    buffer_store_dwordx2 v[18:19], v7, s[12:15], s44 offen offset:96
    v_accvgpr_read_b32 v8, a32
    v_accvgpr_read_b32 v9, a33
    v_accvgpr_read_b32 v10, a34
    v_accvgpr_read_b32 v11, a35
    v_cvt_pk_bf16_f32 v12, v8, v9
    v_cvt_pk_bf16_f32 v13, v10, v11
    buffer_store_dwordx2 v[12:13], v7, s[12:15], s44 offen offset:128
    v_accvgpr_read_b32 v8, a40
    v_accvgpr_read_b32 v9, a41
    v_accvgpr_read_b32 v10, a42
    v_accvgpr_read_b32 v11, a43
    v_cvt_pk_bf16_f32 v14, v8, v9
    v_cvt_pk_bf16_f32 v15, v10, v11
    buffer_store_dwordx2 v[14:15], v7, s[12:15], s44 offen offset:160
    v_accvgpr_read_b32 v8, a48
    v_accvgpr_read_b32 v9, a49
    v_accvgpr_read_b32 v10, a50
    v_accvgpr_read_b32 v11, a51
    v_cvt_pk_bf16_f32 v16, v8, v9
    v_cvt_pk_bf16_f32 v17, v10, v11
    buffer_store_dwordx2 v[16:17], v7, s[12:15], s44 offen offset:192
    v_accvgpr_read_b32 v8, a56
    v_accvgpr_read_b32 v9, a57
    v_accvgpr_read_b32 v10, a58
    v_accvgpr_read_b32 v11, a59
    v_cvt_pk_bf16_f32 v18, v8, v9
    v_cvt_pk_bf16_f32 v19, v10, v11
    buffer_store_dwordx2 v[18:19], v7, s[12:15], s44 offen offset:224
    s_mov_b32 s44, 40960
    v_accvgpr_read_b32 v8, a4
    v_accvgpr_read_b32 v9, a5
    v_accvgpr_read_b32 v10, a6
    v_accvgpr_read_b32 v11, a7
    v_cvt_pk_bf16_f32 v12, v8, v9
    v_cvt_pk_bf16_f32 v13, v10, v11
    buffer_store_dwordx2 v[12:13], v7, s[12:15], s44 offen offset:0
    v_accvgpr_read_b32 v8, a12
    v_accvgpr_read_b32 v9, a13
    v_accvgpr_read_b32 v10, a14
    v_accvgpr_read_b32 v11, a15
    v_cvt_pk_bf16_f32 v14, v8, v9
    v_cvt_pk_bf16_f32 v15, v10, v11
    buffer_store_dwordx2 v[14:15], v7, s[12:15], s44 offen offset:32
    v_accvgpr_read_b32 v8, a20
    v_accvgpr_read_b32 v9, a21
    v_accvgpr_read_b32 v10, a22
    v_accvgpr_read_b32 v11, a23
    v_cvt_pk_bf16_f32 v16, v8, v9
    v_cvt_pk_bf16_f32 v17, v10, v11
    buffer_store_dwordx2 v[16:17], v7, s[12:15], s44 offen offset:64
    v_accvgpr_read_b32 v8, a28
    v_accvgpr_read_b32 v9, a29
    v_accvgpr_read_b32 v10, a30
    v_accvgpr_read_b32 v11, a31
    v_cvt_pk_bf16_f32 v18, v8, v9
    v_cvt_pk_bf16_f32 v19, v10, v11
    buffer_store_dwordx2 v[18:19], v7, s[12:15], s44 offen offset:96
    v_accvgpr_read_b32 v8, a36
    v_accvgpr_read_b32 v9, a37
    v_accvgpr_read_b32 v10, a38
    v_accvgpr_read_b32 v11, a39
    v_cvt_pk_bf16_f32 v12, v8, v9
    v_cvt_pk_bf16_f32 v13, v10, v11
    buffer_store_dwordx2 v[12:13], v7, s[12:15], s44 offen offset:128
    v_accvgpr_read_b32 v8, a44
    v_accvgpr_read_b32 v9, a45
    v_accvgpr_read_b32 v10, a46
    v_accvgpr_read_b32 v11, a47
    v_cvt_pk_bf16_f32 v14, v8, v9
    v_cvt_pk_bf16_f32 v15, v10, v11
    buffer_store_dwordx2 v[14:15], v7, s[12:15], s44 offen offset:160
    v_accvgpr_read_b32 v8, a52
    v_accvgpr_read_b32 v9, a53
    v_accvgpr_read_b32 v10, a54
    v_accvgpr_read_b32 v11, a55
    v_cvt_pk_bf16_f32 v16, v8, v9
    v_cvt_pk_bf16_f32 v17, v10, v11
    buffer_store_dwordx2 v[16:17], v7, s[12:15], s44 offen offset:192
    v_accvgpr_read_b32 v8, a60
    v_accvgpr_read_b32 v9, a61
    v_accvgpr_read_b32 v10, a62
    v_accvgpr_read_b32 v11, a63
    v_cvt_pk_bf16_f32 v18, v8, v9
    v_cvt_pk_bf16_f32 v19, v10, v11
    buffer_store_dwordx2 v[18:19], v7, s[12:15], s44 offen offset:224
    s_barrier
Lcs_173:
    s_sub_u32 s84, s71, 2
    s_lshl_b32 s84, s84, 5
    s_cmp_eq_u32 s71, 1
    s_cselect_b32 s84, 64, s84
    s_add_u32 s84, s84, s72
    s_mov_b32 s20, s34
    s_and_b32 s21, s35, 0xffff
    s_mov_b32 s22, 0x500000
    s_mov_b32 s23, 0x00020000
    s_mov_b32 s8, s38
    s_and_b32 s9, s39, 0xffff
    s_mov_b32 s10, 0x500000
    s_mov_b32 s11, 0x00020000
    s_and_b32 s51, s84, 15
    s_lshl_b32 s50, s42, 15
    s_mul_i32 s44, s42, 1310720
    s_mul_i32 s45, s51, 80
    s_add_u32 s44, s44, s45
    v_lshrrev_b32 v6, 3, v1
    v_mul_u32_u24 v6, 1280, v6
    v_and_b32 v7, 7, v1
    v_lshl_add_u32 v6, v7, 4, v6
    v_add_u32 v9, s44, v6
    v_lshrrev_b32 v6, 2, v2
    v_lshl_add_u32 v6, v3, 2, v6
    v_lshlrev_b32 v6, 7, v6
    v_and_b32 v7, 3, v2
    v_lshl_add_u32 v6, v7, 3, v6
    v_add_u32 v10, s50, v6
    s_add_u32 m0, s50, 0
    s_mov_b32 s44, 0
    buffer_load_dwordx4 v9, s[20:23], s44 offen lds
    s_add_u32 m0, s50, 1024
    s_mov_b32 s44, 10240
    buffer_load_dwordx4 v9, s[20:23], s44 offen lds
    s_add_u32 m0, s50, 2048
    s_mov_b32 s44, 20480
    buffer_load_dwordx4 v9, s[20:23], s44 offen lds
    s_add_u32 m0, s50, 3072
    s_mov_b32 s44, 30720
    buffer_load_dwordx4 v9, s[20:23], s44 offen lds
    s_add_u32 m0, s50, 4096
    s_mov_b32 s44, 40960
    buffer_load_dwordx4 v9, s[20:23], s44 offen lds
    s_add_u32 m0, s50, 5120
    s_mov_b32 s44, 51200
    buffer_load_dwordx4 v9, s[20:23], s44 offen lds
    s_add_u32 m0, s50, 6144
    s_mov_b32 s44, 61440
    buffer_load_dwordx4 v9, s[20:23], s44 offen lds
    s_add_u32 m0, s50, 7168
    s_mov_b32 s44, 71680
    buffer_load_dwordx4 v9, s[20:23], s44 offen lds
    s_add_u32 m0, s50, 8192
    s_mov_b32 s44, 81920
    buffer_load_dwordx4 v9, s[20:23], s44 offen lds
    s_add_u32 m0, s50, 9216
    s_mov_b32 s44, 92160
    buffer_load_dwordx4 v9, s[20:23], s44 offen lds
    s_add_u32 m0, s50, 10240
    s_mov_b32 s44, 102400
    buffer_load_dwordx4 v9, s[20:23], s44 offen lds
    s_add_u32 m0, s50, 11264
    s_mov_b32 s44, 112640
    buffer_load_dwordx4 v9, s[20:23], s44 offen lds
    s_add_u32 m0, s50, 12288
    s_mov_b32 s44, 122880
    buffer_load_dwordx4 v9, s[20:23], s44 offen lds
    s_add_u32 m0, s50, 13312
    s_mov_b32 s44, 133120
    buffer_load_dwordx4 v9, s[20:23], s44 offen lds
    s_add_u32 m0, s50, 14336
    s_mov_b32 s44, 143360
    buffer_load_dwordx4 v9, s[20:23], s44 offen lds
    s_add_u32 m0, s50, 15360
    s_mov_b32 s44, 153600
    buffer_load_dwordx4 v9, s[20:23], s44 offen lds
    s_add_u32 m0, s50, 16384
    s_mov_b32 s44, 163840
    buffer_load_dwordx4 v9, s[20:23], s44 offen lds
    s_add_u32 m0, s50, 17408
    s_mov_b32 s44, 174080
    buffer_load_dwordx4 v9, s[20:23], s44 offen lds
    s_add_u32 m0, s50, 18432
    s_mov_b32 s44, 184320
    buffer_load_dwordx4 v9, s[20:23], s44 offen lds
    s_add_u32 m0, s50, 19456
    s_mov_b32 s44, 194560
    buffer_load_dwordx4 v9, s[20:23], s44 offen lds
    s_add_u32 m0, s50, 20480
    s_mov_b32 s44, 204800
    buffer_load_dwordx4 v9, s[20:23], s44 offen lds
    s_add_u32 m0, s50, 21504
    s_mov_b32 s44, 215040
    buffer_load_dwordx4 v9, s[20:23], s44 offen lds
    s_add_u32 m0, s50, 22528
    s_mov_b32 s44, 225280
    buffer_load_dwordx4 v9, s[20:23], s44 offen lds
    s_add_u32 m0, s50, 23552
    s_mov_b32 s44, 235520
    buffer_load_dwordx4 v9, s[20:23], s44 offen lds
    s_add_u32 m0, s50, 24576
    s_mov_b32 s44, 245760
    buffer_load_dwordx4 v9, s[20:23], s44 offen lds
    s_add_u32 m0, s50, 25600
    s_mov_b32 s44, 256000
    buffer_load_dwordx4 v9, s[20:23], s44 offen lds
    s_add_u32 m0, s50, 26624
    s_mov_b32 s44, 266240
    buffer_load_dwordx4 v9, s[20:23], s44 offen lds
    s_add_u32 m0, s50, 27648
    s_mov_b32 s44, 276480
    buffer_load_dwordx4 v9, s[20:23], s44 offen lds
    s_add_u32 m0, s50, 28672
    s_mov_b32 s44, 286720
    buffer_load_dwordx4 v9, s[20:23], s44 offen lds
    s_add_u32 m0, s50, 29696
    s_mov_b32 s44, 296960
    buffer_load_dwordx4 v9, s[20:23], s44 offen lds
    s_add_u32 m0, s50, 30720
    s_mov_b32 s44, 307200
    buffer_load_dwordx4 v9, s[20:23], s44 offen lds
    s_add_u32 m0, s50, 31744
    s_mov_b32 s44, 317440
    buffer_load_dwordx4 v9, s[20:23], s44 offen lds
    s_waitcnt vmcnt(16)
    ds_read_b64_tr_b16 a[0:1], v10 offset:0
    ds_read_b64_tr_b16 a[2:3], v10 offset:2048
    ds_read_b64_tr_b16 a[4:5], v10 offset:4096
    ds_read_b64_tr_b16 a[6:7], v10 offset:6144
    ds_read_b64_tr_b16 a[8:9], v10 offset:8192
    ds_read_b64_tr_b16 a[10:11], v10 offset:10240
    ds_read_b64_tr_b16 a[12:13], v10 offset:12288
    ds_read_b64_tr_b16 a[14:15], v10 offset:14336
    s_waitcnt lgkmcnt(0)
    ds_read_b64_tr_b16 a[16:17], v10 offset:32
    ds_read_b64_tr_b16 a[18:19], v10 offset:2080
    ds_read_b64_tr_b16 a[20:21], v10 offset:4128
    ds_read_b64_tr_b16 a[22:23], v10 offset:6176
    ds_read_b64_tr_b16 a[24:25], v10 offset:8224
    ds_read_b64_tr_b16 a[26:27], v10 offset:10272
    ds_read_b64_tr_b16 a[28:29], v10 offset:12320
    ds_read_b64_tr_b16 a[30:31], v10 offset:14368
    s_waitcnt lgkmcnt(0)
    ds_read_b64_tr_b16 a[32:33], v10 offset:64
    ds_read_b64_tr_b16 a[34:35], v10 offset:2112
    ds_read_b64_tr_b16 a[36:37], v10 offset:4160
    ds_read_b64_tr_b16 a[38:39], v10 offset:6208
    ds_read_b64_tr_b16 a[40:41], v10 offset:8256
    ds_read_b64_tr_b16 a[42:43], v10 offset:10304
    ds_read_b64_tr_b16 a[44:45], v10 offset:12352
    ds_read_b64_tr_b16 a[46:47], v10 offset:14400
    s_waitcnt lgkmcnt(0)
    s_add_u32 m0, s50, 0
    s_mov_b32 s44, 327680
    buffer_load_dwordx4 v9, s[20:23], s44 offen lds
    s_add_u32 m0, s50, 1024
    s_mov_b32 s44, 337920
    buffer_load_dwordx4 v9, s[20:23], s44 offen lds
    s_add_u32 m0, s50, 2048
    s_mov_b32 s44, 348160
    buffer_load_dwordx4 v9, s[20:23], s44 offen lds
    s_add_u32 m0, s50, 3072
    s_mov_b32 s44, 358400
    buffer_load_dwordx4 v9, s[20:23], s44 offen lds
    s_add_u32 m0, s50, 4096
    s_mov_b32 s44, 368640
    buffer_load_dwordx4 v9, s[20:23], s44 offen lds
    s_add_u32 m0, s50, 5120
    s_mov_b32 s44, 378880
    buffer_load_dwordx4 v9, s[20:23], s44 offen lds
    s_add_u32 m0, s50, 6144
    s_mov_b32 s44, 389120
    buffer_load_dwordx4 v9, s[20:23], s44 offen lds
    s_add_u32 m0, s50, 7168
    s_mov_b32 s44, 399360
    buffer_load_dwordx4 v9, s[20:23], s44 offen lds
    s_add_u32 m0, s50, 8192
    s_mov_b32 s44, 409600
    buffer_load_dwordx4 v9, s[20:23], s44 offen lds
    s_add_u32 m0, s50, 9216
    s_mov_b32 s44, 419840
    buffer_load_dwordx4 v9, s[20:23], s44 offen lds
    s_add_u32 m0, s50, 10240
    s_mov_b32 s44, 430080
    buffer_load_dwordx4 v9, s[20:23], s44 offen lds
    s_add_u32 m0, s50, 11264
    s_mov_b32 s44, 440320
    buffer_load_dwordx4 v9, s[20:23], s44 offen lds
    s_add_u32 m0, s50, 12288
    s_mov_b32 s44, 450560
    buffer_load_dwordx4 v9, s[20:23], s44 offen lds
    s_add_u32 m0, s50, 13312
    s_mov_b32 s44, 460800
    buffer_load_dwordx4 v9, s[20:23], s44 offen lds
    s_add_u32 m0, s50, 14336
    s_mov_b32 s44, 471040
    buffer_load_dwordx4 v9, s[20:23], s44 offen lds
    s_add_u32 m0, s50, 15360
    s_mov_b32 s44, 481280
    buffer_load_dwordx4 v9, s[20:23], s44 offen lds
    s_waitcnt vmcnt(16)
    ds_read_b64_tr_b16 a[48:49], v10 offset:16384
    ds_read_b64_tr_b16 a[50:51], v10 offset:18432
    ds_read_b64_tr_b16 a[52:53], v10 offset:20480
    ds_read_b64_tr_b16 a[54:55], v10 offset:22528
    ds_read_b64_tr_b16 a[56:57], v10 offset:24576
    ds_read_b64_tr_b16 a[58:59], v10 offset:26624
    ds_read_b64_tr_b16 a[60:61], v10 offset:28672
    ds_read_b64_tr_b16 a[62:63], v10 offset:30720
    s_waitcnt lgkmcnt(0)
    ds_read_b64_tr_b16 a[64:65], v10 offset:16416
    ds_read_b64_tr_b16 a[66:67], v10 offset:18464
    ds_read_b64_tr_b16 a[68:69], v10 offset:20512
    ds_read_b64_tr_b16 a[70:71], v10 offset:22560
    ds_read_b64_tr_b16 a[72:73], v10 offset:24608
    ds_read_b64_tr_b16 a[74:75], v10 offset:26656
    ds_read_b64_tr_b16 a[76:77], v10 offset:28704
    ds_read_b64_tr_b16 a[78:79], v10 offset:30752
    s_waitcnt lgkmcnt(0)
    ds_read_b64_tr_b16 a[80:81], v10 offset:16448
    ds_read_b64_tr_b16 a[82:83], v10 offset:18496
    ds_read_b64_tr_b16 a[84:85], v10 offset:20544
    ds_read_b64_tr_b16 a[86:87], v10 offset:22592
    ds_read_b64_tr_b16 a[88:89], v10 offset:24640
    ds_read_b64_tr_b16 a[90:91], v10 offset:26688
    ds_read_b64_tr_b16 a[92:93], v10 offset:28736
    ds_read_b64_tr_b16 a[94:95], v10 offset:30784
    s_waitcnt lgkmcnt(0)
    s_add_u32 m0, s50, 16384
    s_mov_b32 s44, 491520
    buffer_load_dwordx4 v9, s[20:23], s44 offen lds
    s_add_u32 m0, s50, 17408
    s_mov_b32 s44, 501760
    buffer_load_dwordx4 v9, s[20:23], s44 offen lds
    s_add_u32 m0, s50, 18432
    s_mov_b32 s44, 512000
    buffer_load_dwordx4 v9, s[20:23], s44 offen lds
    s_add_u32 m0, s50, 19456
    s_mov_b32 s44, 522240
    buffer_load_dwordx4 v9, s[20:23], s44 offen lds
    s_add_u32 m0, s50, 20480
    s_mov_b32 s44, 532480
    buffer_load_dwordx4 v9, s[20:23], s44 offen lds
    s_add_u32 m0, s50, 21504
    s_mov_b32 s44, 542720
    buffer_load_dwordx4 v9, s[20:23], s44 offen lds
    s_add_u32 m0, s50, 22528
    s_mov_b32 s44, 552960
    buffer_load_dwordx4 v9, s[20:23], s44 offen lds
    s_add_u32 m0, s50, 23552
    s_mov_b32 s44, 563200
    buffer_load_dwordx4 v9, s[20:23], s44 offen lds
    s_add_u32 m0, s50, 24576
    s_mov_b32 s44, 573440
    buffer_load_dwordx4 v9, s[20:23], s44 offen lds
    s_add_u32 m0, s50, 25600
    s_mov_b32 s44, 583680
    buffer_load_dwordx4 v9, s[20:23], s44 offen lds
    s_add_u32 m0, s50, 26624
    s_mov_b32 s44, 593920
    buffer_load_dwordx4 v9, s[20:23], s44 offen lds
    s_add_u32 m0, s50, 27648
    s_mov_b32 s44, 604160
    buffer_load_dwordx4 v9, s[20:23], s44 offen lds
    s_add_u32 m0, s50, 28672
    s_mov_b32 s44, 614400
    buffer_load_dwordx4 v9, s[20:23], s44 offen lds
    s_add_u32 m0, s50, 29696
    s_mov_b32 s44, 624640
    buffer_load_dwordx4 v9, s[20:23], s44 offen lds
    s_add_u32 m0, s50, 30720
    s_mov_b32 s44, 634880
    buffer_load_dwordx4 v9, s[20:23], s44 offen lds
    s_add_u32 m0, s50, 31744
    s_mov_b32 s44, 645120
    buffer_load_dwordx4 v9, s[20:23], s44 offen lds
    s_waitcnt vmcnt(16)
    ds_read_b64_tr_b16 a[96:97], v10 offset:0
    ds_read_b64_tr_b16 a[98:99], v10 offset:2048
    ds_read_b64_tr_b16 a[100:101], v10 offset:4096
    ds_read_b64_tr_b16 a[102:103], v10 offset:6144
    ds_read_b64_tr_b16 a[104:105], v10 offset:8192
    ds_read_b64_tr_b16 a[106:107], v10 offset:10240
    ds_read_b64_tr_b16 a[108:109], v10 offset:12288
    ds_read_b64_tr_b16 a[110:111], v10 offset:14336
    s_waitcnt lgkmcnt(0)
    ds_read_b64_tr_b16 a[112:113], v10 offset:32
    ds_read_b64_tr_b16 a[114:115], v10 offset:2080
    ds_read_b64_tr_b16 a[116:117], v10 offset:4128
    ds_read_b64_tr_b16 a[118:119], v10 offset:6176
    ds_read_b64_tr_b16 a[120:121], v10 offset:8224
    ds_read_b64_tr_b16 a[122:123], v10 offset:10272
    ds_read_b64_tr_b16 a[124:125], v10 offset:12320
    ds_read_b64_tr_b16 a[126:127], v10 offset:14368
    s_waitcnt lgkmcnt(0)
    ds_read_b64_tr_b16 a[128:129], v10 offset:64
    ds_read_b64_tr_b16 a[130:131], v10 offset:2112
    ds_read_b64_tr_b16 a[132:133], v10 offset:4160
    ds_read_b64_tr_b16 a[134:135], v10 offset:6208
    ds_read_b64_tr_b16 a[136:137], v10 offset:8256
    ds_read_b64_tr_b16 a[138:139], v10 offset:10304
    ds_read_b64_tr_b16 a[140:141], v10 offset:12352
    ds_read_b64_tr_b16 a[142:143], v10 offset:14400
    s_waitcnt lgkmcnt(0)
    s_add_u32 m0, s50, 0
    s_mov_b32 s44, 655360
    buffer_load_dwordx4 v9, s[20:23], s44 offen lds
    s_add_u32 m0, s50, 1024
    s_mov_b32 s44, 665600
    buffer_load_dwordx4 v9, s[20:23], s44 offen lds
    s_add_u32 m0, s50, 2048
    s_mov_b32 s44, 675840
    buffer_load_dwordx4 v9, s[20:23], s44 offen lds
    s_add_u32 m0, s50, 3072
    s_mov_b32 s44, 686080
    buffer_load_dwordx4 v9, s[20:23], s44 offen lds
    s_add_u32 m0, s50, 4096
    s_mov_b32 s44, 696320
    buffer_load_dwordx4 v9, s[20:23], s44 offen lds
    s_add_u32 m0, s50, 5120
    s_mov_b32 s44, 706560
    buffer_load_dwordx4 v9, s[20:23], s44 offen lds
    s_add_u32 m0, s50, 6144
    s_mov_b32 s44, 716800
    buffer_load_dwordx4 v9, s[20:23], s44 offen lds
    s_add_u32 m0, s50, 7168
    s_mov_b32 s44, 727040
    buffer_load_dwordx4 v9, s[20:23], s44 offen lds
    s_add_u32 m0, s50, 8192
    s_mov_b32 s44, 737280
    buffer_load_dwordx4 v9, s[20:23], s44 offen lds
    s_add_u32 m0, s50, 9216
    s_mov_b32 s44, 747520
    buffer_load_dwordx4 v9, s[20:23], s44 offen lds
    s_add_u32 m0, s50, 10240
    s_mov_b32 s44, 757760
    buffer_load_dwordx4 v9, s[20:23], s44 offen lds
    s_add_u32 m0, s50, 11264
    s_mov_b32 s44, 768000
    buffer_load_dwordx4 v9, s[20:23], s44 offen lds
    s_add_u32 m0, s50, 12288
    s_mov_b32 s44, 778240
    buffer_load_dwordx4 v9, s[20:23], s44 offen lds
    s_add_u32 m0, s50, 13312
    s_mov_b32 s44, 788480
    buffer_load_dwordx4 v9, s[20:23], s44 offen lds
    s_add_u32 m0, s50, 14336
    s_mov_b32 s44, 798720
    buffer_load_dwordx4 v9, s[20:23], s44 offen lds
    s_add_u32 m0, s50, 15360
    s_mov_b32 s44, 808960
    buffer_load_dwordx4 v9, s[20:23], s44 offen lds
    s_waitcnt vmcnt(16)
    ds_read_b64_tr_b16 a[144:145], v10 offset:16384
    ds_read_b64_tr_b16 a[146:147], v10 offset:18432
    ds_read_b64_tr_b16 a[148:149], v10 offset:20480
    ds_read_b64_tr_b16 a[150:151], v10 offset:22528
    ds_read_b64_tr_b16 a[152:153], v10 offset:24576
    ds_read_b64_tr_b16 a[154:155], v10 offset:26624
    ds_read_b64_tr_b16 a[156:157], v10 offset:28672
    ds_read_b64_tr_b16 a[158:159], v10 offset:30720
    s_waitcnt lgkmcnt(0)
    ds_read_b64_tr_b16 a[160:161], v10 offset:16416
    ds_read_b64_tr_b16 a[162:163], v10 offset:18464
    ds_read_b64_tr_b16 a[164:165], v10 offset:20512
    ds_read_b64_tr_b16 a[166:167], v10 offset:22560
    ds_read_b64_tr_b16 a[168:169], v10 offset:24608
    ds_read_b64_tr_b16 a[170:171], v10 offset:26656
    ds_read_b64_tr_b16 a[172:173], v10 offset:28704
    ds_read_b64_tr_b16 a[174:175], v10 offset:30752
    s_waitcnt lgkmcnt(0)
    ds_read_b64_tr_b16 a[176:177], v10 offset:16448
    ds_read_b64_tr_b16 a[178:179], v10 offset:18496
    ds_read_b64_tr_b16 a[180:181], v10 offset:20544
    ds_read_b64_tr_b16 a[182:183], v10 offset:22592
    ds_read_b64_tr_b16 a[184:185], v10 offset:24640
    ds_read_b64_tr_b16 a[186:187], v10 offset:26688
    ds_read_b64_tr_b16 a[188:189], v10 offset:28736
    ds_read_b64_tr_b16 a[190:191], v10 offset:30784
    s_waitcnt lgkmcnt(0)
    s_add_u32 m0, s50, 16384
    s_mov_b32 s44, 819200
    buffer_load_dwordx4 v9, s[20:23], s44 offen lds
    s_add_u32 m0, s50, 17408
    s_mov_b32 s44, 829440
    buffer_load_dwordx4 v9, s[20:23], s44 offen lds
    s_add_u32 m0, s50, 18432
    s_mov_b32 s44, 839680
    buffer_load_dwordx4 v9, s[20:23], s44 offen lds
    s_add_u32 m0, s50, 19456
    s_mov_b32 s44, 849920
    buffer_load_dwordx4 v9, s[20:23], s44 offen lds
    s_add_u32 m0, s50, 20480
    s_mov_b32 s44, 860160
    buffer_load_dwordx4 v9, s[20:23], s44 offen lds
    s_add_u32 m0, s50, 21504
    s_mov_b32 s44, 870400
    buffer_load_dwordx4 v9, s[20:23], s44 offen lds
    s_add_u32 m0, s50, 22528
    s_mov_b32 s44, 880640
    buffer_load_dwordx4 v9, s[20:23], s44 offen lds
    s_add_u32 m0, s50, 23552
    s_mov_b32 s44, 890880
    buffer_load_dwordx4 v9, s[20:23], s44 offen lds
    s_add_u32 m0, s50, 24576
    s_mov_b32 s44, 901120
    buffer_load_dwordx4 v9, s[20:23], s44 offen lds
    s_add_u32 m0, s50, 25600
    s_mov_b32 s44, 911360
    buffer_load_dwordx4 v9, s[20:23], s44 offen lds
    s_add_u32 m0, s50, 26624
    s_mov_b32 s44, 921600
    buffer_load_dwordx4 v9, s[20:23], s44 offen lds
    s_add_u32 m0, s50, 27648
    s_mov_b32 s44, 931840
    buffer_load_dwordx4 v9, s[20:23], s44 offen lds
    s_add_u32 m0, s50, 28672
    s_mov_b32 s44, 942080
    buffer_load_dwordx4 v9, s[20:23], s44 offen lds
    s_add_u32 m0, s50, 29696
    s_mov_b32 s44, 952320
    buffer_load_dwordx4 v9, s[20:23], s44 offen lds
    s_add_u32 m0, s50, 30720
    s_mov_b32 s44, 962560
    buffer_load_dwordx4 v9, s[20:23], s44 offen lds
    s_add_u32 m0, s50, 31744
    s_mov_b32 s44, 972800
    buffer_load_dwordx4 v9, s[20:23], s44 offen lds
    s_waitcnt vmcnt(16)
    ds_read_b64_tr_b16 a[192:193], v10 offset:0
    ds_read_b64_tr_b16 a[194:195], v10 offset:2048
    ds_read_b64_tr_b16 a[196:197], v10 offset:4096
    ds_read_b64_tr_b16 a[198:199], v10 offset:6144
    ds_read_b64_tr_b16 a[200:201], v10 offset:8192
    ds_read_b64_tr_b16 a[202:203], v10 offset:10240
    ds_read_b64_tr_b16 a[204:205], v10 offset:12288
    ds_read_b64_tr_b16 a[206:207], v10 offset:14336
    s_waitcnt lgkmcnt(0)
    ds_read_b64_tr_b16 a[208:209], v10 offset:32
    ds_read_b64_tr_b16 a[210:211], v10 offset:2080
    ds_read_b64_tr_b16 a[212:213], v10 offset:4128
    ds_read_b64_tr_b16 a[214:215], v10 offset:6176
    ds_read_b64_tr_b16 a[216:217], v10 offset:8224
    ds_read_b64_tr_b16 a[218:219], v10 offset:10272
    ds_read_b64_tr_b16 a[220:221], v10 offset:12320
    ds_read_b64_tr_b16 a[222:223], v10 offset:14368
    s_waitcnt lgkmcnt(0)
    ds_read_b64_tr_b16 a[224:225], v10 offset:64
    ds_read_b64_tr_b16 a[226:227], v10 offset:2112
    ds_read_b64_tr_b16 a[228:229], v10 offset:4160
    ds_read_b64_tr_b16 a[230:231], v10 offset:6208
    ds_read_b64_tr_b16 a[232:233], v10 offset:8256
    ds_read_b64_tr_b16 a[234:235], v10 offset:10304
    ds_read_b64_tr_b16 a[236:237], v10 offset:12352
    ds_read_b64_tr_b16 a[238:239], v10 offset:14400
    s_waitcnt lgkmcnt(0)
    s_add_u32 m0, s50, 0
    s_mov_b32 s44, 983040
    buffer_load_dwordx4 v9, s[20:23], s44 offen lds
    s_add_u32 m0, s50, 1024
    s_mov_b32 s44, 993280
    buffer_load_dwordx4 v9, s[20:23], s44 offen lds
    s_add_u32 m0, s50, 2048
    s_mov_b32 s44, 1003520
    buffer_load_dwordx4 v9, s[20:23], s44 offen lds
    s_add_u32 m0, s50, 3072
    s_mov_b32 s44, 1013760
    buffer_load_dwordx4 v9, s[20:23], s44 offen lds
    s_add_u32 m0, s50, 4096
    s_mov_b32 s44, 1024000
    buffer_load_dwordx4 v9, s[20:23], s44 offen lds
    s_add_u32 m0, s50, 5120
    s_mov_b32 s44, 1034240
    buffer_load_dwordx4 v9, s[20:23], s44 offen lds
    s_add_u32 m0, s50, 6144
    s_mov_b32 s44, 1044480
    buffer_load_dwordx4 v9, s[20:23], s44 offen lds
    s_add_u32 m0, s50, 7168
    s_mov_b32 s44, 1054720
    buffer_load_dwordx4 v9, s[20:23], s44 offen lds
    s_add_u32 m0, s50, 8192
    s_mov_b32 s44, 1064960
    buffer_load_dwordx4 v9, s[20:23], s44 offen lds
    s_add_u32 m0, s50, 9216
    s_mov_b32 s44, 1075200
    buffer_load_dwordx4 v9, s[20:23], s44 offen lds
    s_add_u32 m0, s50, 10240
    s_mov_b32 s44, 1085440
    buffer_load_dwordx4 v9, s[20:23], s44 offen lds
    s_add_u32 m0, s50, 11264
    s_mov_b32 s44, 1095680
    buffer_load_dwordx4 v9, s[20:23], s44 offen lds
    s_add_u32 m0, s50, 12288
    s_mov_b32 s44, 1105920
    buffer_load_dwordx4 v9, s[20:23], s44 offen lds
    s_add_u32 m0, s50, 13312
    s_mov_b32 s44, 1116160
    buffer_load_dwordx4 v9, s[20:23], s44 offen lds
    s_add_u32 m0, s50, 14336
    s_mov_b32 s44, 1126400
    buffer_load_dwordx4 v9, s[20:23], s44 offen lds
    s_add_u32 m0, s50, 15360
    s_mov_b32 s44, 1136640
    buffer_load_dwordx4 v9, s[20:23], s44 offen lds
    s_waitcnt vmcnt(16)
    ds_read_b64_tr_b16 a[240:241], v10 offset:16384
    ds_read_b64_tr_b16 a[242:243], v10 offset:18432
    ds_read_b64_tr_b16 a[244:245], v10 offset:20480
    ds_read_b64_tr_b16 a[246:247], v10 offset:22528
    ds_read_b64_tr_b16 a[248:249], v10 offset:24576
    ds_read_b64_tr_b16 a[250:251], v10 offset:26624
    ds_read_b64_tr_b16 a[252:253], v10 offset:28672
    ds_read_b64_tr_b16 a[254:255], v10 offset:30720
    s_waitcnt lgkmcnt(0)
    ds_read_b64_tr_b16 v[96:97], v10 offset:16416
    ds_read_b64_tr_b16 v[98:99], v10 offset:18464
    ds_read_b64_tr_b16 v[100:101], v10 offset:20512
    ds_read_b64_tr_b16 v[102:103], v10 offset:22560
    ds_read_b64_tr_b16 v[104:105], v10 offset:24608
    ds_read_b64_tr_b16 v[106:107], v10 offset:26656
    ds_read_b64_tr_b16 v[108:109], v10 offset:28704
    ds_read_b64_tr_b16 v[110:111], v10 offset:30752
    s_waitcnt lgkmcnt(0)
    ds_read_b64_tr_b16 v[112:113], v10 offset:16448
    ds_read_b64_tr_b16 v[114:115], v10 offset:18496
    ds_read_b64_tr_b16 v[116:117], v10 offset:20544
    ds_read_b64_tr_b16 v[118:119], v10 offset:22592
    ds_read_b64_tr_b16 v[120:121], v10 offset:24640
    ds_read_b64_tr_b16 v[122:123], v10 offset:26688
    ds_read_b64_tr_b16 v[124:125], v10 offset:28736
    ds_read_b64_tr_b16 v[126:127], v10 offset:30784
    s_waitcnt lgkmcnt(0)
    s_add_u32 m0, s50, 16384
    s_mov_b32 s44, 1146880
    buffer_load_dwordx4 v9, s[20:23], s44 offen lds
    s_add_u32 m0, s50, 17408
    s_mov_b32 s44, 1157120
    buffer_load_dwordx4 v9, s[20:23], s44 offen lds
    s_add_u32 m0, s50, 18432
    s_mov_b32 s44, 1167360
    buffer_load_dwordx4 v9, s[20:23], s44 offen lds
    s_add_u32 m0, s50, 19456
    s_mov_b32 s44, 1177600
    buffer_load_dwordx4 v9, s[20:23], s44 offen lds
    s_add_u32 m0, s50, 20480
    s_mov_b32 s44, 1187840
    buffer_load_dwordx4 v9, s[20:23], s44 offen lds
    s_add_u32 m0, s50, 21504
    s_mov_b32 s44, 1198080
    buffer_load_dwordx4 v9, s[20:23], s44 offen lds
    s_add_u32 m0, s50, 22528
    s_mov_b32 s44, 1208320
    buffer_load_dwordx4 v9, s[20:23], s44 offen lds
    s_add_u32 m0, s50, 23552
    s_mov_b32 s44, 1218560
    buffer_load_dwordx4 v9, s[20:23], s44 offen lds
    s_add_u32 m0, s50, 24576
    s_mov_b32 s44, 1228800
    buffer_load_dwordx4 v9, s[20:23], s44 offen lds
    s_add_u32 m0, s50, 25600
    s_mov_b32 s44, 1239040
    buffer_load_dwordx4 v9, s[20:23], s44 offen lds
    s_add_u32 m0, s50, 26624
    s_mov_b32 s44, 1249280
    buffer_load_dwordx4 v9, s[20:23], s44 offen lds
    s_add_u32 m0, s50, 27648
    s_mov_b32 s44, 1259520
    buffer_load_dwordx4 v9, s[20:23], s44 offen lds
    s_add_u32 m0, s50, 28672
    s_mov_b32 s44, 1269760
    buffer_load_dwordx4 v9, s[20:23], s44 offen lds
    s_add_u32 m0, s50, 29696
    s_mov_b32 s44, 1280000
    buffer_load_dwordx4 v9, s[20:23], s44 offen lds
    s_add_u32 m0, s50, 30720
    s_mov_b32 s44, 1290240
    buffer_load_dwordx4 v9, s[20:23], s44 offen lds
    s_add_u32 m0, s50, 31744
    s_mov_b32 s44, 1300480
    buffer_load_dwordx4 v9, s[20:23], s44 offen lds
    s_waitcnt vmcnt(0)
    s_lshl_b32 s55, s51, 7
    s_add_u32 s55, s55, 0x8c37200
    s_cmp_lg_u32 s42, 3
    s_cbranch_scc1 Lofc_178
    s_mov_b64 exec, 1
    v_mov_b32 v7, 1
    v_mov_b32 v8, 0
    buffer_atomic_add v7, v8, s[4:7], s55 offen sc0
    v_mov_b32 v8, 0x23000
    s_waitcnt vmcnt(0)
    ds_write_b32 v8, v7
    s_waitcnt lgkmcnt(0)
    s_mov_b64 exec, -1
Lofc_178:
Lofl_179:
    s_barrier
    v_mov_b32 v8, 0x23000
    ds_read_b32 v7, v8
    s_waitcnt lgkmcnt(0)
    v_readfirstlane_b32 s52, v7
    s_nop 3
    s_cmp_ge_u32 s52, 80
    s_cbranch_scc1 Lofe_180
    s_lshr_b32 s54, s52, 3
    s_cmp_ge_u32 s52, 76
    s_cselect_b32 s86, 1, 0
    s_add_u32 s75, s54, s86
    s_lshl_b32 s75, s75, 7
    s_add_u32 s75, s75, 0x8c22300
    s_cmp_lg_u32 s42, 0
    s_cbranch_scc1 Lwtd_182
    v_mov_b32 v5, 0
    s_mov_b32 s74, 0
Lwt_181:
    buffer_load_dword v4, v5, s[4:7], s75 offen sc1
    s_waitcnt vmcnt(0)
    v_cmp_gt_u32 vcc, 0x20, v4
    s_cbranch_vccz Lwtd_182
    s_sleep 8
    s_add_u32 s74, s74, 1
    s_cmp_lt_u32 s74, 4000000
    s_cbranch_scc1 Lwt_181
Lwtd_182:
    s_barrier
    s_add_u32 s44, s52, 48
    s_lshl_b32 s44, s44, 17
    s_lshl_b32 s45, s42, 15
    s_add_u32 s44, s44, s45
    s_add_u32 s44, s44, 0x7a00000
    v_lshlrev_b32 v6, 4, v1
    v_add_u32 v11, s44, v6
    s_mov_b32 s44, 24576
    buffer_load_dwordx4 v[224:227], v11, s[4:7], s44 offen offset:0
    s_mov_b32 s44, 24576
    buffer_load_dwordx4 v[228:231], v11, s[4:7], s44 offen offset:1024
    s_mov_b32 s44, 24576
    buffer_load_dwordx4 v[232:235], v11, s[4:7], s44 offen offset:2048
    s_mov_b32 s44, 24576
    buffer_load_dwordx4 v[236:239], v11, s[4:7], s44 offen offset:3072
    s_mov_b32 s44, 0
    buffer_load_dwordx4 v[128:131], v11, s[4:7], s44 offen offset:0
    s_mov_b32 s44, 0
    buffer_load_dwordx4 v[132:135], v11, s[4:7], s44 offen offset:1024
    s_mov_b32 s44, 0
    buffer_load_dwordx4 v[136:139], v11, s[4:7], s44 offen offset:2048
    s_mov_b32 s44, 0
    buffer_load_dwordx4 v[140:143], v11, s[4:7], s44 offen offset:3072
    s_mov_b32 s44, 4096
    buffer_load_dwordx4 v[144:147], v11, s[4:7], s44 offen offset:0
    s_mov_b32 s44, 4096
    buffer_load_dwordx4 v[148:151], v11, s[4:7], s44 offen offset:1024
    s_mov_b32 s44, 4096
    buffer_load_dwordx4 v[152:155], v11, s[4:7], s44 offen offset:2048
    s_mov_b32 s44, 4096
    buffer_load_dwordx4 v[156:159], v11, s[4:7], s44 offen offset:3072
    s_mov_b32 s44, 8192
    buffer_load_dwordx4 v[160:163], v11, s[4:7], s44 offen offset:0
    s_mov_b32 s44, 8192
    buffer_load_dwordx4 v[164:167], v11, s[4:7], s44 offen offset:1024
    s_mov_b32 s44, 8192
    buffer_load_dwordx4 v[168:171], v11, s[4:7], s44 offen offset:2048
    s_mov_b32 s44, 8192
    buffer_load_dwordx4 v[172:175], v11, s[4:7], s44 offen offset:3072
    s_mov_b32 s44, 12288
    buffer_load_dwordx4 v[176:179], v11, s[4:7], s44 offen offset:0
    s_mov_b32 s44, 12288
    buffer_load_dwordx4 v[180:183], v11, s[4:7], s44 offen offset:1024
    s_mov_b32 s44, 12288
    buffer_load_dwordx4 v[184:187], v11, s[4:7], s44 offen offset:2048
    s_mov_b32 s44, 12288
    buffer_load_dwordx4 v[188:191], v11, s[4:7], s44 offen offset:3072
    s_mov_b32 s44, 16384
    buffer_load_dwordx4 v[192:195], v11, s[4:7], s44 offen offset:0
    s_mov_b32 s44, 16384
    buffer_load_dwordx4 v[196:199], v11, s[4:7], s44 offen offset:1024
    s_mov_b32 s44, 16384
    buffer_load_dwordx4 v[200:203], v11, s[4:7], s44 offen offset:2048
    s_mov_b32 s44, 16384
    buffer_load_dwordx4 v[204:207], v11, s[4:7], s44 offen offset:3072
    s_mov_b32 s44, 20480
    buffer_load_dwordx4 v[208:211], v11, s[4:7], s44 offen offset:0
    s_mov_b32 s44, 20480
    buffer_load_dwordx4 v[212:215], v11, s[4:7], s44 offen offset:1024
    s_mov_b32 s44, 20480
    buffer_load_dwordx4 v[216:219], v11, s[4:7], s44 offen offset:2048
    s_mov_b32 s44, 20480
    buffer_load_dwordx4 v[220:223], v11, s[4:7], s44 offen offset:3072
    s_mov_b32 s44, 28672
    buffer_load_dwordx4 v[240:243], v11, s[4:7], s44 offen offset:0
    s_mov_b32 s44, 28672
    buffer_load_dwordx4 v[244:247], v11, s[4:7], s44 offen offset:1024
    s_mov_b32 s44, 28672
    buffer_load_dwordx4 v[248:251], v11, s[4:7], s44 offen offset:2048
    s_mov_b32 s44, 28672
    buffer_load_dwordx4 v[252:255], v11, s[4:7], s44 offen offset:3072
    ds_read_b64_tr_b16 v[44:45], v10 offset:0
    ds_read_b64_tr_b16 v[46:47], v10 offset:2048
    ds_read_b64_tr_b16 v[48:49], v10 offset:4096
    ds_read_b64_tr_b16 v[50:51], v10 offset:6144
    ds_read_b64_tr_b16 v[52:53], v10 offset:8192
    ds_read_b64_tr_b16 v[54:55], v10 offset:10240
    ds_read_b64_tr_b16 v[56:57], v10 offset:12288
    ds_read_b64_tr_b16 v[58:59], v10 offset:14336
    s_waitcnt lgkmcnt(0)
    ds_read_b64_tr_b16 v[60:61], v10 offset:32
    ds_read_b64_tr_b16 v[62:63], v10 offset:2080
    ds_read_b64_tr_b16 v[64:65], v10 offset:4128
    ds_read_b64_tr_b16 v[66:67], v10 offset:6176
    ds_read_b64_tr_b16 v[68:69], v10 offset:8224
    ds_read_b64_tr_b16 v[70:71], v10 offset:10272
    ds_read_b64_tr_b16 v[72:73], v10 offset:12320
    ds_read_b64_tr_b16 v[74:75], v10 offset:14368
    s_waitcnt lgkmcnt(0)
    ds_read_b64_tr_b16 v[76:77], v10 offset:64
    ds_read_b64_tr_b16 v[78:79], v10 offset:2112
    ds_read_b64_tr_b16 v[80:81], v10 offset:4160
    ds_read_b64_tr_b16 v[82:83], v10 offset:6208
    ds_read_b64_tr_b16 v[84:85], v10 offset:8256
    ds_read_b64_tr_b16 v[86:87], v10 offset:10304
    ds_read_b64_tr_b16 v[88:89], v10 offset:12352
    ds_read_b64_tr_b16 v[90:91], v10 offset:14400
    s_waitcnt lgkmcnt(0)
    s_waitcnt vmcnt(28)
    v_mfma_f32_16x16x32_bf16 v[16:19], v[44:47], v[224:227], 0
    v_mfma_f32_16x16x32_bf16 v[20:23], v[60:63], v[224:227], 0
    v_mfma_f32_16x16x32_bf16 v[24:27], v[76:79], v[224:227], 0
    v_mfma_f32_16x16x32_bf16 v[16:19], v[48:51], v[228:231], v[16:19]
    v_mfma_f32_16x16x32_bf16 v[20:23], v[64:67], v[228:231], v[20:23]
    v_mfma_f32_16x16x32_bf16 v[24:27], v[80:83], v[228:231], v[24:27]
    v_mfma_f32_16x16x32_bf16 v[16:19], v[52:55], v[232:235], v[16:19]
    v_mfma_f32_16x16x32_bf16 v[20:23], v[68:71], v[232:235], v[20:23]
    v_mfma_f32_16x16x32_bf16 v[24:27], v[84:87], v[232:235], v[24:27]
    v_mfma_f32_16x16x32_bf16 v[16:19], v[56:59], v[236:239], v[16:19]
    v_mfma_f32_16x16x32_bf16 v[20:23], v[72:75], v[236:239], v[20:23]
    v_mfma_f32_16x16x32_bf16 v[24:27], v[88:91], v[236:239], v[24:27]
    s_waitcnt vmcnt(24)
    v_mfma_f32_16x16x32_bf16 v[16:19], a[0:3], v[128:131], v[16:19]
    v_mfma_f32_16x16x32_bf16 v[20:23], a[16:19], v[128:131], v[20:23]
    v_mfma_f32_16x16x32_bf16 v[24:27], a[32:35], v[128:131], v[24:27]
    v_mfma_f32_16x16x32_bf16 v[16:19], a[4:7], v[132:135], v[16:19]
    v_mfma_f32_16x16x32_bf16 v[20:23], a[20:23], v[132:135], v[20:23]
    v_mfma_f32_16x16x32_bf16 v[24:27], a[36:39], v[132:135], v[24:27]
    v_mfma_f32_16x16x32_bf16 v[16:19], a[8:11], v[136:139], v[16:19]
    v_mfma_f32_16x16x32_bf16 v[20:23], a[24:27], v[136:139], v[20:23]
    v_mfma_f32_16x16x32_bf16 v[24:27], a[40:43], v[136:139], v[24:27]
    v_mfma_f32_16x16x32_bf16 v[16:19], a[12:15], v[140:143], v[16:19]
    v_mfma_f32_16x16x32_bf16 v[20:23], a[28:31], v[140:143], v[20:23]
    v_mfma_f32_16x16x32_bf16 v[24:27], a[44:47], v[140:143], v[24:27]
    ds_read_b64_tr_b16 v[44:45], v10 offset:16384
    ds_read_b64_tr_b16 v[46:47], v10 offset:18432
    ds_read_b64_tr_b16 v[48:49], v10 offset:20480
    ds_read_b64_tr_b16 v[50:51], v10 offset:22528
    ds_read_b64_tr_b16 v[52:53], v10 offset:24576
    ds_read_b64_tr_b16 v[54:55], v10 offset:26624
    ds_read_b64_tr_b16 v[56:57], v10 offset:28672
    ds_read_b64_tr_b16 v[58:59], v10 offset:30720
    s_waitcnt lgkmcnt(8)
    ds_read_b64_tr_b16 v[60:61], v10 offset:16416
    ds_read_b64_tr_b16 v[62:63], v10 offset:18464
    ds_read_b64_tr_b16 v[64:65], v10 offset:20512
    ds_read_b64_tr_b16 v[66:67], v10 offset:22560
    ds_read_b64_tr_b16 v[68:69], v10 offset:24608
    ds_read_b64_tr_b16 v[70:71], v10 offset:26656
    ds_read_b64_tr_b16 v[72:73], v10 offset:28704
    ds_read_b64_tr_b16 v[74:75], v10 offset:30752
    s_waitcnt lgkmcnt(8)
    ds_read_b64_tr_b16 v[76:77], v10 offset:16448
    ds_read_b64_tr_b16 v[78:79], v10 offset:18496
    ds_read_b64_tr_b16 v[80:81], v10 offset:20544
    ds_read_b64_tr_b16 v[82:83], v10 offset:22592
    ds_read_b64_tr_b16 v[84:85], v10 offset:24640
    ds_read_b64_tr_b16 v[86:87], v10 offset:26688
    ds_read_b64_tr_b16 v[88:89], v10 offset:28736
    ds_read_b64_tr_b16 v[90:91], v10 offset:30784
    s_waitcnt vmcnt(20)
    v_mfma_f32_16x16x32_bf16 v[16:19], a[48:51], v[144:147], v[16:19]
    v_mfma_f32_16x16x32_bf16 v[20:23], a[64:67], v[144:147], v[20:23]
    v_mfma_f32_16x16x32_bf16 v[24:27], a[80:83], v[144:147], v[24:27]
    v_mfma_f32_16x16x32_bf16 v[16:19], a[52:55], v[148:151], v[16:19]
    v_mfma_f32_16x16x32_bf16 v[20:23], a[68:71], v[148:151], v[20:23]
    v_mfma_f32_16x16x32_bf16 v[24:27], a[84:87], v[148:151], v[24:27]
    v_mfma_f32_16x16x32_bf16 v[16:19], a[56:59], v[152:155], v[16:19]
    v_mfma_f32_16x16x32_bf16 v[20:23], a[72:75], v[152:155], v[20:23]
    v_mfma_f32_16x16x32_bf16 v[24:27], a[88:91], v[152:155], v[24:27]
    v_mfma_f32_16x16x32_bf16 v[16:19], a[60:63], v[156:159], v[16:19]
    v_mfma_f32_16x16x32_bf16 v[20:23], a[76:79], v[156:159], v[20:23]
    v_mfma_f32_16x16x32_bf16 v[24:27], a[92:95], v[156:159], v[24:27]
    s_waitcnt vmcnt(16)
    v_mfma_f32_16x16x32_bf16 v[16:19], a[96:99], v[160:163], v[16:19]
    v_mfma_f32_16x16x32_bf16 v[20:23], a[112:115], v[160:163], v[20:23]
    v_mfma_f32_16x16x32_bf16 v[24:27], a[128:131], v[160:163], v[24:27]
    v_mfma_f32_16x16x32_bf16 v[16:19], a[100:103], v[164:167], v[16:19]
    v_mfma_f32_16x16x32_bf16 v[20:23], a[116:119], v[164:167], v[20:23]
    v_mfma_f32_16x16x32_bf16 v[24:27], a[132:135], v[164:167], v[24:27]
    v_mfma_f32_16x16x32_bf16 v[16:19], a[104:107], v[168:171], v[16:19]
    v_mfma_f32_16x16x32_bf16 v[20:23], a[120:123], v[168:171], v[20:23]
    v_mfma_f32_16x16x32_bf16 v[24:27], a[136:139], v[168:171], v[24:27]
    v_mfma_f32_16x16x32_bf16 v[16:19], a[108:111], v[172:175], v[16:19]
    v_mfma_f32_16x16x32_bf16 v[20:23], a[124:127], v[172:175], v[20:23]
    v_mfma_f32_16x16x32_bf16 v[24:27], a[140:143], v[172:175], v[24:27]
    s_waitcnt vmcnt(12)
    v_mfma_f32_16x16x32_bf16 v[16:19], a[144:147], v[176:179], v[16:19]
    v_mfma_f32_16x16x32_bf16 v[20:23], a[160:163], v[176:179], v[20:23]
    v_mfma_f32_16x16x32_bf16 v[24:27], a[176:179], v[176:179], v[24:27]
    v_mfma_f32_16x16x32_bf16 v[16:19], a[148:151], v[180:183], v[16:19]
    v_mfma_f32_16x16x32_bf16 v[20:23], a[164:167], v[180:183], v[20:23]
    v_mfma_f32_16x16x32_bf16 v[24:27], a[180:183], v[180:183], v[24:27]
    v_mfma_f32_16x16x32_bf16 v[16:19], a[152:155], v[184:187], v[16:19]
    v_mfma_f32_16x16x32_bf16 v[20:23], a[168:171], v[184:187], v[20:23]
    v_mfma_f32_16x16x32_bf16 v[24:27], a[184:187], v[184:187], v[24:27]
    v_mfma_f32_16x16x32_bf16 v[16:19], a[156:159], v[188:191], v[16:19]
    v_mfma_f32_16x16x32_bf16 v[20:23], a[172:175], v[188:191], v[20:23]
    v_mfma_f32_16x16x32_bf16 v[24:27], a[188:191], v[188:191], v[24:27]
    s_waitcnt vmcnt(8)
    v_mfma_f32_16x16x32_bf16 v[16:19], a[192:195], v[192:195], v[16:19]
    v_mfma_f32_16x16x32_bf16 v[20:23], a[208:211], v[192:195], v[20:23]
    v_mfma_f32_16x16x32_bf16 v[24:27], a[224:227], v[192:195], v[24:27]
    v_mfma_f32_16x16x32_bf16 v[16:19], a[196:199], v[196:199], v[16:19]
    v_mfma_f32_16x16x32_bf16 v[20:23], a[212:215], v[196:199], v[20:23]
    v_mfma_f32_16x16x32_bf16 v[24:27], a[228:231], v[196:199], v[24:27]
    v_mfma_f32_16x16x32_bf16 v[16:19], a[200:203], v[200:203], v[16:19]
    v_mfma_f32_16x16x32_bf16 v[20:23], a[216:219], v[200:203], v[20:23]
    v_mfma_f32_16x16x32_bf16 v[24:27], a[232:235], v[200:203], v[24:27]
    v_mfma_f32_16x16x32_bf16 v[16:19], a[204:207], v[204:207], v[16:19]
    v_mfma_f32_16x16x32_bf16 v[20:23], a[220:223], v[204:207], v[20:23]
    v_mfma_f32_16x16x32_bf16 v[24:27], a[236:239], v[204:207], v[24:27]
    s_waitcnt vmcnt(4)
    v_mfma_f32_16x16x32_bf16 v[16:19], a[240:243], v[208:211], v[16:19]
    v_mfma_f32_16x16x32_bf16 v[20:23], v[96:99], v[208:211], v[20:23]
    v_mfma_f32_16x16x32_bf16 v[24:27], v[112:115], v[208:211], v[24:27]
    v_mfma_f32_16x16x32_bf16 v[16:19], a[244:247], v[212:215], v[16:19]
    v_mfma_f32_16x16x32_bf16 v[20:23], v[100:103], v[212:215], v[20:23]
    v_mfma_f32_16x16x32_bf16 v[24:27], v[116:119], v[212:215], v[24:27]
    v_mfma_f32_16x16x32_bf16 v[16:19], a[248:251], v[216:219], v[16:19]
    v_mfma_f32_16x16x32_bf16 v[20:23], v[104:107], v[216:219], v[20:23]
    v_mfma_f32_16x16x32_bf16 v[24:27], v[120:123], v[216:219], v[24:27]
    v_mfma_f32_16x16x32_bf16 v[16:19], a[252:255], v[220:223], v[16:19]
    v_mfma_f32_16x16x32_bf16 v[20:23], v[108:111], v[220:223], v[20:23]
    v_mfma_f32_16x16x32_bf16 v[24:27], v[124:127], v[220:223], v[24:27]
    s_waitcnt vmcnt(0)
    s_waitcnt lgkmcnt(0)
    v_mfma_f32_16x16x32_bf16 v[16:19], v[44:47], v[240:243], v[16:19]
    v_mfma_f32_16x16x32_bf16 v[20:23], v[60:63], v[240:243], v[20:23]
    v_mfma_f32_16x16x32_bf16 v[24:27], v[76:79], v[240:243], v[24:27]
    v_mfma_f32_16x16x32_bf16 v[16:19], v[48:51], v[244:247], v[16:19]
    v_mfma_f32_16x16x32_bf16 v[20:23], v[64:67], v[244:247], v[20:23]
    v_mfma_f32_16x16x32_bf16 v[24:27], v[80:83], v[244:247], v[24:27]
    v_mfma_f32_16x16x32_bf16 v[16:19], v[52:55], v[248:251], v[16:19]
    v_mfma_f32_16x16x32_bf16 v[20:23], v[68:71], v[248:251], v[20:23]
    v_mfma_f32_16x16x32_bf16 v[24:27], v[84:87], v[248:251], v[24:27]
    v_mfma_f32_16x16x32_bf16 v[16:19], v[56:59], v[252:255], v[16:19]
    v_mfma_f32_16x16x32_bf16 v[20:23], v[72:75], v[252:255], v[20:23]
    v_mfma_f32_16x16x32_bf16 v[24:27], v[88:91], v[252:255], v[24:27]
    s_barrier
    s_mul_i32 s44, s42, 3072
    s_add_u32 s44, s44, 0x20000
    v_add_u32 v12, s44, v6
    s_nop 5
    ds_write_b128 v12, v[16:19] offset:0
    ds_write_b128 v12, v[20:23] offset:1024
    ds_write_b128 v12, v[24:27] offset:2048
    s_waitcnt lgkmcnt(0)
    s_barrier
    s_cmp_lg_u32 s42, 3
    s_cbranch_scc1 Lofx3_184
    s_mov_b64 exec, 1
    v_mov_b32 v7, 1
    v_mov_b32 v8, 0
    buffer_atomic_add v7, v8, s[4:7], s55 offen sc0
    v_mov_b32 v8, 0x23000
    s_waitcnt vmcnt(0)
    ds_write_b32 v8, v7
    s_waitcnt lgkmcnt(0)
    s_mov_b64 exec, -1
    s_branch Lofx_183
Lofx3_184:
    s_lshl_b32 s44, s42, 10
    s_add_u32 s44, s44, 0x20000
    v_add_u32 v12, s44, v6
    ds_read_b128 v[28:31], v12 offset:0
    ds_read_b128 v[32:35], v12 offset:3072
    ds_read_b128 v[36:39], v12 offset:6144
    ds_read_b128 v[40:43], v12 offset:9216
    s_add_u32 s44, s52, 48
    s_mul_i32 s44, s44, 40960
    s_mul_i32 s45, s51, 80
    s_add_u32 s44, s44, s45
    s_lshl_b32 s45, s42, 5
    s_add_u32 s44, s44, s45
    s_add_u32 s44, s44, 1280
    v_mul_u32_u24 v7, 2560, v2
    v_lshl_add_u32 v7, v3, 3, v7
    v_add_u32 v13, s44, v7
    s_cmp_eq_u32 s42, 2
    s_cselect_b32 exec_hi, 0, -1
    s_waitcnt lgkmcnt(0)
    v_add_f32 v28, v28, v32
    v_add_f32 v36, v36, v40
    v_add_f32 v29, v29, v33
    v_add_f32 v37, v37, v41
    v_add_f32 v30, v30, v34
    v_add_f32 v38, v38, v42
    v_add_f32 v31, v31, v35
    v_add_f32 v39, v39, v43
    v_add_f32 v28, v28, v36
    v_add_f32 v29, v29, v37
    v_add_f32 v30, v30, v38
    v_add_f32 v31, v31, v39
    v_cvt_pk_bf16_f32 v32, v28, v29
    v_cvt_pk_bf16_f32 v33, v30, v31
    buffer_store_dwordx2 v[32:33], v13, s[8:11], 0 offen
    s_mov_b64 exec, -1
Lofx_183:
    s_waitcnt vmcnt(0)
    s_branch Lofl_179
Lofe_180:
    s_endpgm
.section .rodata,"a"
.p2align 6
.amdhsa_kernel main_kernel
  .amdhsa_next_free_vgpr 512
  .amdhsa_next_free_sgpr 102
  .amdhsa_accum_offset 256
  .amdhsa_group_segment_fixed_size 0
  .amdhsa_kernarg_size 104
  .amdhsa_user_sgpr_count 2
  .amdhsa_user_sgpr_kernarg_segment_ptr 1
  .amdhsa_system_sgpr_workgroup_id_x 1
.end_amdhsa_kernel
```
